```python
import torch

def _softmax(x, axis=-1):
    return torch.softmax(x, dim=axis)

def _gelu(x):
    return torch.nn.functional.gelu(x, approximate='tanh')

def _silu(x):
    return torch.nn.functional.silu(x)

def _sigmoid(x):
    return torch.sigmoid(x)

def _layernorm(x, axis=-1, eps=1e-05):
    m = x.mean(dim=axis, keepdim=True)
    v = x.var(dim=axis, keepdim=True, unbiased=False)
    return (x - m) / torch.sqrt(v + eps)

def _scatter_add(tgt, idx, src, axis=0):
    return tgt.clone().index_add_(axis, idx, src)

def _segment_sum(src, seg, n):
    out = torch.zeros((n,) + src.shape[1:], dtype=src.dtype)
    return out.index_add_(0, seg, src)

def _pad(x, pw):
    flat = tuple((v for pair in reversed(pw) for v in pair))
    return torch.nn.functional.pad(x, flat)
kernel_name = 'gather_scatter__tensor_product_equiv_tfn__graph'

def setup_inputs():

    _w = lambda a: (lambda t: t.to(torch.bfloat16) if t.is_floating_point() else t)(torch.as_tensor(a))
    N, deg, C, L, DE = (10000, 32, 128, 1, 4)
    E = N * deg
    M = (L + 1) ** 2
    src = (lambda lo, hi, *s: torch.randint(lo, hi, s))(0, N, E).to(torch.int64)
    dst = (lambda lo, hi, *s: torch.randint(lo, hi, s))(0, N, E).to(torch.int64)
    r = (lambda *s: torch.randn(*s, dtype=torch.bfloat16) * 0.05)(E, 3)
    r = r / (torch.linalg.norm(r, dim=-1, keepdim=True) + 1e-09)
    rx, ry, rz = (r[:, 0].clone(), r[:, 1].clone(), r[:, 2].clone())
    Ys = [torch.ones((E, 1), dtype=float)]
    if L >= 1:
        Ys.append(r.to(float))
    if L >= 2:
        Ys.append(torch.stack([2 * rx * ry, 2 * ry * rz, (3 * rz * rz - 1.0) / (lambda _x: torch.sqrt(torch.as_tensor(_x)))(3.0), 2 * rx * rz, rx * rx - ry * ry], dim=-1).to(float))
    for _l in range(3, L + 1):
        Ys.append(((lambda *s: torch.randn(*s, dtype=torch.bfloat16) * 0.05)(E, 2 * _l + 1) * 0.3).to(float))
    Y = torch.cat(Ys, dim=-1)
    cg = torch.zeros((M, M, M), dtype=float)
    off = [_l * _l for _l in range(L + 2)]
    for l1 in range(L + 1):
        for l2 in range(L + 1):
            for l3 in range(abs(l1 - l2), min(L, l1 + l2) + 1):
                d1, d2, d3 = (2 * l1 + 1, 2 * l2 + 1, 2 * l3 + 1)
                cg[off[l1]:off[l1 + 1], off[l2]:off[l2 + 1], off[l3]:off[l3 + 1]] = (lambda *s: torch.randn(*s, dtype=torch.bfloat16) * 0.05)(d1, d2, d3) / (lambda _x: torch.sqrt(torch.as_tensor(_x)))(float(d1 * d2))
    return {'x': _w((lambda *s: torch.randn(*s, dtype=torch.bfloat16) * 0.05)(N, C, M) * 0.2), 'src': _w(src), 'dst': _w(dst), 'Y': _w(Y), 'edge_feat': _w((lambda *s: torch.randn(*s, dtype=torch.bfloat16) * 0.05)(E, DE)), 'w_rad': _w((lambda *s: torch.randn(*s, dtype=torch.bfloat16) * 0.05)(DE, C) * (1.0 / max(1.0, DE) ** 0.5)), 'cg': _w(cg), 'w_mix': _w((lambda *s: torch.randn(*s, dtype=torch.bfloat16) * 0.05)(C, C) * (1.0 / max(1.0, C) ** 0.5))}

def reference(x, src, dst, Y, edge_feat, w_rad, cg, w_mix):
    N, C, M = (x.shape[0], x.shape[1], x.shape[2])
    R = _silu(edge_feat @ w_rad)
    xs = x[src]
    tp = torch.einsum('eci,ef,ifo->eco', xs, Y, cg)
    msg = R[:, :, None] * tp
    agg = _segment_sum(msg.reshape(-1, C * M), dst, N).reshape(N, C, M)
    return torch.einsum('ncm,cd->ndm', agg, w_mix)
```

```asm
; @launch kernel=bin_kernel grid=(255,1,1) block=(320,1,1) lds=27648
; @launch kernel=main_kernel grid=(256,1,1) block=(512,1,1) lds=93696
.amdgcn_target "amdgcn-amd-amdhsa--gfx950"
.text
.globl bin_kernel
.p2align 8
.type bin_kernel,@function
bin_kernel:
    s_cmp_ge_u32 s2, 255
    s_cbranch_scc1 K1_END
    s_load_dwordx4 s[4:7], s[0:1], 8
    s_load_dwordx4 s[8:11], s[0:1], 24
    s_load_dwordx2 s[12:13], s[0:1], 80
    s_load_dwordx4 s[16:19], s[0:1], 40
    s_load_dwordx2 s[20:21], s[0:1], 56
    s_cmp_ge_u32 s2, 250
    s_cbranch_scc1 K1_AUX
    s_mul_i32 s14, s2, 5120
    v_lshl_add_u32 v1, v0, 4, s14
    v_lshlrev_b32 v2, 1, v1
    v_lshlrev_b32 v3, 2, v0
    v_mov_b32 v4, 0
    v_mov_b32 v5, 1
    s_waitcnt lgkmcnt(0)
    global_load_dwordx4 v[8:11], v1, s[6:7]
    global_load_dwordx4 v[12:15], v1, s[4:5]
    global_load_dwordx4 v[16:19], v2, s[8:9]
    global_load_dwordx4 v[20:23], v2, s[8:9] offset:16
    global_load_dwordx4 v[24:27], v2, s[10:11]
    global_load_dwordx4 v[28:31], v2, s[10:11] offset:16
    ds_write_b32 v3, v4 offset:0
    s_waitcnt lgkmcnt(0)
    s_barrier
    s_waitcnt vmcnt(5)
    v_and_b32 v32, 0xff, v8
    v_lshlrev_b32 v32, 2, v32
    ds_add_rtn_u32 v36, v32, v5 offset:0
    v_and_b32 v33, 0xff, v9
    v_lshlrev_b32 v33, 2, v33
    ds_add_rtn_u32 v37, v33, v5 offset:0
    v_and_b32 v34, 0xff, v10
    v_lshlrev_b32 v34, 2, v34
    ds_add_rtn_u32 v38, v34, v5 offset:0
    v_and_b32 v35, 0xff, v11
    v_lshlrev_b32 v35, 2, v35
    ds_add_rtn_u32 v39, v35, v5 offset:0
    s_waitcnt vmcnt(4)
    v_lshrrev_b32 v8, 8, v8
    v_lshl_or_b32 v8, v12, 10, v8
    v_lshrrev_b32 v9, 8, v9
    v_lshl_or_b32 v9, v13, 10, v9
    v_lshrrev_b32 v10, 8, v10
    v_lshl_or_b32 v10, v14, 10, v10
    v_lshrrev_b32 v11, 8, v11
    v_lshl_or_b32 v11, v15, 10, v11
    v_and_b32 v6, 63, v0
    v_lshlrev_b32 v6, 4, v6
    s_waitcnt lgkmcnt(0)
    s_barrier
    ds_read_b128 v[40:43], v6 offset:0
    s_waitcnt lgkmcnt(0)
    v_add_u32 v48, v40, v41
    v_add3_u32 v48, v48, v42, v43
    v_mov_b32 v49, v48
    s_nop 1
    v_add_u32_dpp v49, v49, v49 row_shr:1 row_mask:0xf bank_mask:0xf bound_ctrl:0
    s_nop 1
    v_add_u32_dpp v49, v49, v49 row_shr:2 row_mask:0xf bank_mask:0xf bound_ctrl:0
    s_nop 1
    v_add_u32_dpp v49, v49, v49 row_shr:4 row_mask:0xf bank_mask:0xf bound_ctrl:0
    s_nop 1
    v_add_u32_dpp v49, v49, v49 row_shr:8 row_mask:0xf bank_mask:0xf bound_ctrl:0
    s_nop 1
    v_add_u32_dpp v49, v49, v49 row_bcast:15 row_mask:0xa bank_mask:0xf
    s_nop 1
    v_add_u32_dpp v49, v49, v49 row_bcast:31 row_mask:0xc bank_mask:0xf
    v_sub_u32 v44, v49, v48
    v_add_u32 v45, v44, v40
    v_add_u32 v46, v45, v41
    v_add_u32 v47, v46, v42
    ds_write_b128 v6, v[44:47] offset:1024
    v_lshl_or_b32 v52, v40, 16, v44
    v_lshl_or_b32 v53, v41, 16, v45
    v_lshl_or_b32 v54, v42, 16, v46
    v_lshl_or_b32 v55, v43, 16, v47
    ds_read_b32 v40, v32 offset:1024
    ds_read_b32 v41, v33 offset:1024
    ds_read_b32 v42, v34 offset:1024
    ds_read_b32 v43, v35 offset:1024
    s_waitcnt lgkmcnt(3)
    v_add_u32 v36, v36, v40
    v_lshlrev_b32 v32, 2, v36
    v_lshlrev_b32 v36, 4, v36
    s_waitcnt lgkmcnt(2)
    v_add_u32 v37, v37, v41
    v_lshlrev_b32 v33, 2, v37
    v_lshlrev_b32 v37, 4, v37
    s_waitcnt lgkmcnt(1)
    v_add_u32 v38, v38, v42
    v_lshlrev_b32 v34, 2, v38
    v_lshlrev_b32 v38, 4, v38
    s_waitcnt lgkmcnt(0)
    v_add_u32 v39, v39, v43
    v_lshlrev_b32 v35, 2, v39
    v_lshlrev_b32 v39, 4, v39
    ds_write_b32 v32, v8 offset:2048
    ds_write_b32 v33, v9 offset:2048
    ds_write_b32 v34, v10 offset:2048
    ds_write_b32 v35, v11 offset:2048
    s_waitcnt vmcnt(0)
    v_add_u32 v36, 7168, v36
    ds_write2_b64 v36, v[16:17], v[24:25] offset0:0 offset1:1
    v_add_u32 v37, 7168, v37
    ds_write2_b64 v37, v[18:19], v[26:27] offset0:0 offset1:1
    v_add_u32 v38, 7168, v38
    ds_write2_b64 v38, v[20:21], v[28:29] offset0:0 offset1:1
    v_add_u32 v39, 7168, v39
    ds_write2_b64 v39, v[22:23], v[30:31] offset0:0 offset1:1
    v_lshlrev_b32 v3, 4, v0
    s_lshl_b32 s15, s14, 2
    s_add_u32 s15, s15, 1310720
    v_add_u32 v2, s15, v3
    s_waitcnt lgkmcnt(0)
    s_barrier
    ds_read_b128 v[8:11], v3 offset:2048
    ds_read_b128 v[12:15], v3 offset:7168
    ds_read_b128 v[16:19], v3 offset:12288
    ds_read_b128 v[20:23], v3 offset:17408
    ds_read_b128 v[24:27], v3 offset:22528
    s_lshl_b32 s15, s2, 10
    s_add_u32 s15, s15, 6815744
    v_add_u32 v7, s15, v6
    v_cmp_gt_u32 vcc, 64, v0
    s_and_saveexec_b64 s[22:23], vcc
    s_cbranch_execz K1_NOTAB
    global_store_dwordx4 v7, v[52:55], s[12:13]
K1_NOTAB:
    s_mov_b64 exec, s[22:23]
    s_waitcnt lgkmcnt(4)
    global_store_dwordx4 v1, v[8:11], s[12:13]
    s_waitcnt lgkmcnt(3)
    global_store_dwordx4 v2, v[12:15], s[12:13]
    v_add_u32 v2, 5120, v2
    s_waitcnt lgkmcnt(2)
    global_store_dwordx4 v2, v[16:19], s[12:13]
    v_add_u32 v2, 5120, v2
    s_waitcnt lgkmcnt(1)
    global_store_dwordx4 v2, v[20:23], s[12:13]
    v_add_u32 v2, 5120, v2
    s_waitcnt lgkmcnt(0)
    global_store_dwordx4 v2, v[24:27], s[12:13]
    s_endpgm
K1_AUX:
    v_lshrrev_b32 v1, 6, v0
    v_and_b32 v2, 63, v0
    s_nop 0
    v_readfirstlane_b32 s14, v1
    s_cmp_eq_u32 s2, 254
    s_cbranch_scc1 K1_CONST
    s_cmp_ge_u32 s14, 4
    s_cbranch_scc1 K1_END
    s_sub_u32 s15, s2, 250
    s_lshl_b32 s22, s14, 13
    s_lshl_b32 s23, s15, 6
    s_add_u32 s22, s22, s23
    v_lshrrev_b32 v3, 4, v2
    v_lshlrev_b32 v3, 11, v3
    v_and_b32 v4, 15, v2
    v_lshl_add_u32 v3, v4, 2, v3
    v_add_u32 v3, s22, v3
    s_lshl_b32 s22, s15, 13
    s_lshl_b32 s23, s14, 10
    s_add_u32 s22, s22, s23
    s_add_u32 s22, s22, 6488064
    v_lshl_add_u32 v4, v2, 4, s22
    s_mov_b32 s24, 0x05040100
    s_mov_b32 s25, 0x07060302
    s_waitcnt lgkmcnt(0)
    global_load_dword v8, v3, s[20:21] offset:0
    global_load_dword v9, v3, s[20:21] offset:256
    global_load_dword v10, v3, s[20:21] offset:512
    global_load_dword v11, v3, s[20:21] offset:768
    global_load_dword v12, v3, s[20:21] offset:1024
    global_load_dword v13, v3, s[20:21] offset:1280
    global_load_dword v14, v3, s[20:21] offset:1536
    global_load_dword v15, v3, s[20:21] offset:1792
    s_waitcnt vmcnt(0)
    v_perm_b32 v16, v9, v8, s24
    v_perm_b32 v20, v9, v8, s25
    v_perm_b32 v17, v11, v10, s24
    v_perm_b32 v21, v11, v10, s25
    v_perm_b32 v18, v13, v12, s24
    v_perm_b32 v22, v13, v12, s25
    v_perm_b32 v19, v15, v14, s24
    v_perm_b32 v23, v15, v14, s25
    global_store_dwordx4 v4, v[16:19], s[12:13]
    v_add_u32 v4, 4096, v4
    global_store_dwordx4 v4, v[20:23], s[12:13]
    s_endpgm
K1_CONST:
    s_cmp_ge_u32 s14, 1
    s_cbranch_scc1 K1_END
    v_lshlrev_b32 v3, 2, v2
    v_and_b32 v4, 3, v2
    v_lshlrev_b32 v4, 1, v4
    s_mov_b32 s22, 6520832
    v_lshl_add_u32 v5, v2, 4, s22
    s_mov_b32 s24, 0xbfb8aa3b
    s_mov_b32 s25, 0xffff0000
    s_waitcnt lgkmcnt(0)
    global_load_dword v8, v3, s[16:17] offset:0
    global_load_dword v9, v3, s[16:17] offset:256
    global_load_dword v10, v3, s[16:17] offset:512
    global_load_dword v11, v3, s[16:17] offset:768
    global_load_ushort v32, v4, s[18:19] offset:0
    global_load_ushort v33, v4, s[18:19] offset:8
    global_load_ushort v34, v4, s[18:19] offset:16
    global_load_ushort v35, v4, s[18:19] offset:24
    global_load_ushort v36, v4, s[18:19] offset:32
    global_load_ushort v37, v4, s[18:19] offset:40
    global_load_ushort v38, v4, s[18:19] offset:48
    global_load_ushort v39, v4, s[18:19] offset:56
    global_load_ushort v40, v4, s[18:19] offset:64
    global_load_ushort v41, v4, s[18:19] offset:72
    global_load_ushort v42, v4, s[18:19] offset:80
    global_load_ushort v43, v4, s[18:19] offset:88
    global_load_ushort v44, v4, s[18:19] offset:96
    global_load_ushort v45, v4, s[18:19] offset:104
    global_load_ushort v46, v4, s[18:19] offset:112
    global_load_ushort v47, v4, s[18:19] offset:120
    s_waitcnt vmcnt(16)
    v_lshlrev_b32 v12, 16, v8
    v_and_b32 v16, s25, v8
    v_mul_f32 v12, s24, v12
    v_mul_f32 v16, s24, v16
    v_lshlrev_b32 v13, 16, v9
    v_and_b32 v17, s25, v9
    v_mul_f32 v13, s24, v13
    v_mul_f32 v17, s24, v17
    v_lshlrev_b32 v14, 16, v10
    v_and_b32 v18, s25, v10
    v_mul_f32 v14, s24, v14
    v_mul_f32 v18, s24, v18
    v_lshlrev_b32 v15, 16, v11
    v_and_b32 v19, s25, v11
    v_mul_f32 v15, s24, v15
    v_mul_f32 v19, s24, v19
    v_cvt_pk_bf16_f32 v20, v12, v13
    v_cvt_pk_bf16_f32 v21, v14, v15
    v_lshlrev_b32 v28, 16, v20
    v_and_b32 v29, s25, v20
    v_sub_f32 v28, v12, v28
    v_sub_f32 v29, v13, v29
    v_cvt_pk_bf16_f32 v22, v28, v29
    v_lshlrev_b32 v28, 16, v21
    v_and_b32 v29, s25, v21
    v_sub_f32 v28, v14, v28
    v_sub_f32 v29, v15, v29
    v_cvt_pk_bf16_f32 v23, v28, v29
    v_cvt_pk_bf16_f32 v24, v16, v17
    v_cvt_pk_bf16_f32 v25, v18, v19
    v_lshlrev_b32 v28, 16, v24
    v_and_b32 v29, s25, v24
    v_sub_f32 v28, v16, v28
    v_sub_f32 v29, v17, v29
    v_cvt_pk_bf16_f32 v26, v28, v29
    v_lshlrev_b32 v28, 16, v25
    v_and_b32 v29, s25, v25
    v_sub_f32 v28, v18, v28
    v_sub_f32 v29, v19, v29
    v_cvt_pk_bf16_f32 v27, v28, v29
    global_store_dwordx4 v5, v[20:23], s[12:13]
    global_store_dwordx4 v5, v[24:27], s[12:13] offset:1024
    s_waitcnt vmcnt(2)
    v_lshl_or_b32 v48, v33, 16, v32
    v_lshl_or_b32 v49, v35, 16, v34
    v_lshl_or_b32 v50, v37, 16, v36
    v_lshl_or_b32 v51, v39, 16, v38
    v_lshl_or_b32 v52, v41, 16, v40
    v_lshl_or_b32 v53, v43, 16, v42
    v_lshl_or_b32 v54, v45, 16, v44
    v_lshl_or_b32 v55, v47, 16, v46
    global_store_dwordx4 v5, v[48:51], s[12:13] offset:2048
    global_store_dwordx4 v5, v[52:55], s[12:13] offset:3072
K1_END:
    s_endpgm
.globl main_kernel
.p2align 8
.type main_kernel,@function
main_kernel:
    s_cmp_ge_u32 s2, 256
    s_cbranch_scc1 K2_END
    s_load_dwordx2 s[4:5], s[0:1], 0
    s_load_dwordx2 s[6:7], s[0:1], 64
    s_load_dwordx2 s[8:9], s[0:1], 80
    s_and_b32 s10, s2, 7
    s_lshl_b32 s10, s10, 5
    s_lshr_b32 s11, s2, 3
    s_or_b32 s24, s10, s11
    v_lshrrev_b32 v8, 6, v0
    v_and_b32 v9, 63, v0
    v_lshlrev_b32 v1, 4, v9
    v_readfirstlane_b32 s25, v8
    v_lshrrev_b32 v4, 1, v0
    s_lshl_b32 s10, s24, 2
    s_add_u32 s10, s10, 6815744
    v_lshl_add_u32 v10, v4, 10, s10
    s_mov_b32 s14, 10240000
    s_mov_b32 s15, 0x20000
    s_mov_b32 s18, 7071744
    s_mov_b32 s19, 0x20000
    s_mov_b32 s22, 10240000
    s_mov_b32 s23, 0x20000
    s_mov_b32 s34, 0xfffffc00
    s_and_b32 s10, s25, 3
    s_lshl_b32 s10, s10, 13
    s_add_u32 s10, s10, 6488064
    s_mov_b32 s11, 6520832
    s_waitcnt lgkmcnt(0)
    s_mov_b32 s12, s4
    s_mov_b32 s13, s5
    s_mov_b32 s16, s8
    s_mov_b32 s17, s9
    s_mov_b32 s20, s6
    s_mov_b32 s21, s7
    buffer_load_dword v2, v10, s[16:19], 0 offen
    buffer_load_dwordx4 v[176:179], v1, s[16:19], s11 offen offset:0
    buffer_load_dwordx4 v[180:183], v1, s[16:19], s11 offen offset:1024
    buffer_load_dwordx4 v[184:187], v1, s[16:19], s11 offen offset:2048
    buffer_load_dwordx4 v[188:191], v1, s[16:19], s11 offen offset:3072
    buffer_load_dwordx4 v[192:195], v1, s[16:19], s10 offen offset:0
    buffer_load_dwordx4 v[196:199], v1, s[16:19], s10 offen offset:1024
    buffer_load_dwordx4 v[200:203], v1, s[16:19], s10 offen offset:2048
    buffer_load_dwordx4 v[204:207], v1, s[16:19], s10 offen offset:3072
    s_add_u32 s10, s10, 4096
    buffer_load_dwordx4 v[208:211], v1, s[16:19], s10 offen offset:0
    buffer_load_dwordx4 v[212:215], v1, s[16:19], s10 offen offset:1024
    buffer_load_dwordx4 v[216:219], v1, s[16:19], s10 offen offset:2048
    buffer_load_dwordx4 v[220:223], v1, s[16:19], s10 offen offset:3072
    v_lshlrev_b32 v10, 2, v0
    v_mov_b32 v11, 0
    ds_write_b32 v10, v11
    v_mov_b32 v16, 0
    v_mov_b32 v17, 0
    v_mov_b32 v18, 0
    v_mov_b32 v19, 0
    v_mov_b32 v20, 0
    v_mov_b32 v21, 0
    v_mov_b32 v22, 0
    v_mov_b32 v23, 0
    v_mov_b32 v24, 0
    v_mov_b32 v25, 0
    v_mov_b32 v26, 0
    v_mov_b32 v27, 0
    v_mov_b32 v28, 0
    v_mov_b32 v29, 0
    v_mov_b32 v30, 0
    v_mov_b32 v31, 0
    v_mov_b32 v32, 0
    v_mov_b32 v33, 0
    v_mov_b32 v34, 0
    v_mov_b32 v35, 0
    v_mov_b32 v36, 0
    v_mov_b32 v37, 0
    v_mov_b32 v38, 0
    v_mov_b32 v39, 0
    v_mov_b32 v40, 0
    v_mov_b32 v41, 0
    v_mov_b32 v42, 0
    v_mov_b32 v43, 0
    v_mov_b32 v44, 0
    v_mov_b32 v45, 0
    v_mov_b32 v46, 0
    v_mov_b32 v47, 0
    v_mov_b32 v48, 0
    v_mov_b32 v49, 0
    v_mov_b32 v50, 0
    v_mov_b32 v51, 0
    v_mov_b32 v52, 0
    v_mov_b32 v53, 0
    v_mov_b32 v54, 0
    v_mov_b32 v55, 0
    v_mov_b32 v56, 0
    v_mov_b32 v57, 0
    v_mov_b32 v58, 0
    v_mov_b32 v59, 0
    v_mov_b32 v60, 0
    v_mov_b32 v61, 0
    v_mov_b32 v62, 0
    v_mov_b32 v63, 0
    v_mul_u32_u24 v4, 1280, v4
    v_and_b32 v12, 1, v0
    v_cmp_eq_u32 s[42:43], 1, v12
    s_mov_b32 s27, 0
    s_waitcnt lgkmcnt(0)
    s_barrier
    s_waitcnt vmcnt(12)
    v_and_b32 v13, 0xffff, v2
    v_lshrrev_b32 v2, 16, v2
    v_add_u32 v4, v4, v13
    v_cndmask_b32 v13, 0, v2, s[42:43]
    v_mov_b32 v3, v13
    s_nop 1
    v_add_u32_dpp v3, v3, v3 row_shr:1 row_mask:0xf bank_mask:0xf bound_ctrl:0
    s_nop 1
    v_add_u32_dpp v3, v3, v3 row_shr:2 row_mask:0xf bank_mask:0xf bound_ctrl:0
    s_nop 1
    v_add_u32_dpp v3, v3, v3 row_shr:4 row_mask:0xf bank_mask:0xf bound_ctrl:0
    s_nop 1
    v_add_u32_dpp v3, v3, v3 row_shr:8 row_mask:0xf bank_mask:0xf bound_ctrl:0
    s_nop 1
    v_add_u32_dpp v3, v3, v3 row_bcast:15 row_mask:0xa bank_mask:0xf
    s_nop 1
    v_add_u32_dpp v3, v3, v3 row_bcast:31 row_mask:0xc bank_mask:0xf
    s_nop 0
    v_readlane_b32 s44, v3, 63
    v_sub_u32 v3, v3, v13
    v_cmp_lt_u32 vcc, s25, v9
    v_cmp_gt_u32 s[42:43], 9, v9
    v_lshlrev_b32 v10, 2, v9
    v_mov_b32 v11, s44
    s_and_b64 vcc, vcc, s[42:43]
    s_and_saveexec_b64 s[42:43], vcc
    ds_add_u32 v10, v11 offset:1024
    s_mov_b64 exec, s[42:43]
    s_lshl_b32 s10, s25, 2
    v_mov_b32 v10, s10
    v_mov_b32 v11, 32
    s_waitcnt lgkmcnt(0)
    s_barrier
    ds_read_b32 v10, v10 offset:1024
    ds_read_b32 v11, v11 offset:1024
    s_waitcnt lgkmcnt(0)
    v_add_u32 v3, v3, v10
    v_readfirstlane_b32 s26, v11
ROUND:
    v_and_b32 v8, 1, v0
    v_subrev_u32 v9, s27, v3
    v_add_u32 v9, v9, v8
    v_add_u32 v10, v4, v8
    s_mov_b32 s10, 1536
EXPAND:
    v_cmp_lt_u32 vcc, v8, v2
    s_and_b64 exec, exec, vcc
    s_cbranch_execz EXPAND_DONE
    v_cmp_gt_u32 vcc, s10, v9
    v_lshlrev_b32 v11, 2, v9
    s_and_saveexec_b64 s[42:43], vcc
    ds_write_b32 v11, v10 offset:3072
    s_mov_b64 exec, s[42:43]
    v_add_u32 v8, 2, v8
    v_add_u32 v9, 2, v9
    v_add_u32 v10, 2, v10
    s_branch EXPAND
EXPAND_DONE:
    s_mov_b64 exec, -1
    s_sub_u32 s28, s26, s27
    s_min_u32 s28, s28, 1536
    v_lshlrev_b32 v8, 2, v0
    v_add_u32 v9, 0, v0
    v_cmp_gt_u32 s[36:37], s28, v9
    v_add_u32 v9, 512, v0
    v_cmp_gt_u32 s[38:39], s28, v9
    v_add_u32 v9, 1024, v0
    v_cmp_gt_u32 s[40:41], s28, v9
    s_waitcnt lgkmcnt(0)
    s_barrier
    ds_read_b32 v64, v8 offset:3072
    ds_read_b32 v65, v8 offset:5120
    ds_read_b32 v66, v8 offset:7168
    s_lshl_b32 s10, s25, 10
    s_add_u32 s10, s10, 23040
    s_mov_b32 s11, 1310720
    v_mov_b32 v13, 1
    s_waitcnt lgkmcnt(0)
    v_lshlrev_b32 v68, 2, v64
    v_lshlrev_b32 v64, 4, v64
    v_lshlrev_b32 v69, 2, v65
    v_lshlrev_b32 v65, 4, v65
    v_lshlrev_b32 v70, 2, v66
    v_lshlrev_b32 v66, 4, v66
    s_mov_b64 exec, s[36:37]
    buffer_load_dword v68, v68, s[16:19], 0 offen
    s_mov_b64 exec, s[38:39]
    buffer_load_dword v69, v69, s[16:19], 0 offen
    s_mov_b64 exec, s[40:41]
    s_cbranch_execz SKIP3
    s_add_u32 m0, s10, 16384
    buffer_load_dword v70, v70, s[16:19], 0 offen
    buffer_load_dwordx4 v66, s[16:19], s11 offen lds
SKIP3:
    s_add_u32 m0, s10, 0
    s_mov_b64 exec, s[36:37]
    buffer_load_dwordx4 v64, s[16:19], s11 offen lds
    s_add_u32 m0, s10, 8192
    s_mov_b64 exec, s[38:39]
    buffer_load_dwordx4 v65, s[16:19], s11 offen lds
    s_mov_b64 exec, -1
    s_waitcnt vmcnt(2)
    v_and_b32 v72, 7, v68
    v_lshrrev_b32 v9, 19, v68
    v_lshl_or_b32 v72, v72, 5, v9
    v_lshlrev_b32 v72, 2, v72
    v_and_b32 v73, 7, v69
    v_lshrrev_b32 v9, 19, v69
    v_lshl_or_b32 v73, v73, 5, v9
    v_lshlrev_b32 v73, 2, v73
    v_and_b32 v74, 7, v70
    v_lshrrev_b32 v9, 19, v70
    v_lshl_or_b32 v74, v74, 5, v9
    v_lshlrev_b32 v74, 2, v74
    s_mov_b64 exec, s[36:37]
    ds_add_rtn_u32 v76, v72, v13 offset:0
    s_mov_b64 exec, s[38:39]
    ds_add_rtn_u32 v77, v73, v13 offset:0
    s_mov_b64 exec, s[40:41]
    ds_add_rtn_u32 v78, v74, v13 offset:0
    s_mov_b64 exec, -1
    v_and_b32 v80, -8, v68
    v_lshlrev_b32 v81, 4, v0
    v_add_u32 v81, 23040, v81
    v_and_b32 v82, -8, v69
    v_lshlrev_b32 v83, 4, v0
    v_add_u32 v83, 31232, v83
    v_and_b32 v84, -8, v70
    v_lshlrev_b32 v85, 4, v0
    v_add_u32 v85, 39424, v85
    s_lshl_b32 s10, s25, 3
    s_add_u32 s11, s10, 8
    s_and_b32 s11, s11, 63
    s_waitcnt lgkmcnt(0)
    s_barrier
    ds_read_b128 v[88:91], v1 offset:0
    s_waitcnt lgkmcnt(0)
    v_add_u32 v8, v88, v89
    v_add3_u32 v8, v8, v90, v91
    v_mov_b32 v9, v8
    s_nop 1
    v_add_u32_dpp v9, v9, v9 row_shr:1 row_mask:0xf bank_mask:0xf bound_ctrl:0
    s_nop 1
    v_add_u32_dpp v9, v9, v9 row_shr:2 row_mask:0xf bank_mask:0xf bound_ctrl:0
    s_nop 1
    v_add_u32_dpp v9, v9, v9 row_shr:4 row_mask:0xf bank_mask:0xf bound_ctrl:0
    s_nop 1
    v_add_u32_dpp v9, v9, v9 row_shr:8 row_mask:0xf bank_mask:0xf bound_ctrl:0
    s_nop 1
    v_add_u32_dpp v9, v9, v9 row_bcast:15 row_mask:0xa bank_mask:0xf
    s_nop 1
    v_add_u32_dpp v9, v9, v9 row_bcast:31 row_mask:0xc bank_mask:0xf
    v_sub_u32 v92, v9, v8
    v_add_u32 v93, v92, v88
    v_add_u32 v94, v93, v89
    v_add_u32 v95, v94, v90
    ds_write_b128 v1, v[92:95] offset:2048
    v_readlane_b32 s29, v92, s10
    v_readlane_b32 s30, v92, s11
    ds_read_b32 v72, v72 offset:2048
    ds_read_b32 v73, v73 offset:2048
    ds_read_b32 v74, v74 offset:2048
    s_cmp_eq_u32 s25, 7
    s_cselect_b32 s30, s28, s30
    v_lshrrev_b32 v6, 4, v1
    v_add_u32 v6, s29, v6
    v_lshlrev_b32 v5, 3, v6
    v_add_u32 v5, 9216, v5
    s_waitcnt lgkmcnt(0)
    v_add_lshl_u32 v72, v72, v76, 3
    s_mov_b64 exec, s[36:37]
    ds_write_b64 v72, v[80:81] offset:9216
    s_mov_b64 exec, -1
    v_add_lshl_u32 v73, v73, v77, 3
    s_mov_b64 exec, s[38:39]
    ds_write_b64 v73, v[82:83] offset:9216
    s_mov_b64 exec, -1
    v_add_lshl_u32 v74, v74, v78, 3
    s_mov_b64 exec, s[40:41]
    ds_write_b64 v74, v[84:85] offset:9216
    s_mov_b64 exec, -1
    s_sub_u32 s10, s30, s29
    s_add_u32 s10, s10, 3
    s_and_b32 s10, s10, -4
    s_min_u32 s32, s10, 8
    s_sub_u32 s31, s10, s32
    s_waitcnt vmcnt(0) lgkmcnt(0)
    s_barrier
    ds_read_b64 v[166:167], v5
    v_lshlrev_b32 v10, 2, v0
    v_mov_b32 v11, 0
    v_cmp_gt_u32 vcc, 0x100, v0
    s_and_saveexec_b64 s[42:43], vcc
    ds_write_b32 v10, v11 offset:0
    s_mov_b64 exec, s[42:43]
    s_waitcnt lgkmcnt(0)
    v_cmp_gt_u32 vcc, s30, v6
    v_add_u32 v6, 64, v6
    v_add_u32 v5, 512, v5
    v_mov_b32 v8, 23040
    v_cndmask_b32 v166, 40, v166, vcc
    v_cndmask_b32 v167, v8, v167, vcc
    ds_read_b128 v[168:171], v167
    v_readlane_b32 s48, v166, 0
    s_and_b32 s33, s48, s34
    buffer_load_dwordx4 v[64:67], v1, s[12:15], s33 offen
    v_readlane_b32 s49, v166, 1
    s_and_b32 s33, s49, s34
    buffer_load_dwordx4 v[68:71], v1, s[12:15], s33 offen
    v_readlane_b32 s50, v166, 2
    s_and_b32 s33, s50, s34
    buffer_load_dwordx4 v[72:75], v1, s[12:15], s33 offen
    v_readlane_b32 s51, v166, 3
    s_and_b32 s33, s51, s34
    buffer_load_dwordx4 v[76:79], v1, s[12:15], s33 offen
    v_readlane_b32 s52, v166, 4
    s_and_b32 s33, s52, s34
    buffer_load_dwordx4 v[80:83], v1, s[12:15], s33 offen
    v_readlane_b32 s53, v166, 5
    s_and_b32 s33, s53, s34
    buffer_load_dwordx4 v[84:87], v1, s[12:15], s33 offen
    v_readlane_b32 s54, v166, 6
    s_and_b32 s33, s54, s34
    buffer_load_dwordx4 v[88:91], v1, s[12:15], s33 offen
    v_readlane_b32 s55, v166, 7
    s_and_b32 s33, s55, s34
    buffer_load_dwordx4 v[92:95], v1, s[12:15], s33 offen
    v_mov_b32 v164, v166
    s_waitcnt lgkmcnt(0)
    v_mov_b32 v172, v170
    v_mov_b32 v173, v171
    v_mfma_f32_4x4x4_16b_bf16 v[148:151], v[168:169], v[184:185], 0
    v_mfma_f32_4x4x4_16b_bf16 v[152:155], v[168:169], v[186:187], 0
    v_mfma_f32_4x4x4_16b_bf16 v[156:159], v[168:169], v[188:189], 0
    v_mfma_f32_4x4x4_16b_bf16 v[160:163], v[168:169], v[190:191], 0
    v_mfma_f32_4x4x4_16b_bf16 v[112:115], v[172:173], v[176:177], 0 cbsz:4 abid:0
    v_mfma_f32_4x4x4_16b_bf16 v[116:119], v[172:173], v[180:181], 0 cbsz:4 abid:0
    v_mfma_f32_4x4x4_16b_bf16 v[120:123], v[172:173], v[176:177], 0 cbsz:4 abid:1
    v_mfma_f32_4x4x4_16b_bf16 v[112:115], v[172:173], v[178:179], v[112:115] cbsz:4 abid:0
    v_mfma_f32_4x4x4_16b_bf16 v[116:119], v[172:173], v[182:183], v[116:119] cbsz:4 abid:0
    v_mfma_f32_4x4x4_16b_bf16 v[120:123], v[172:173], v[178:179], v[120:123] cbsz:4 abid:1
    v_cvt_pk_bf16_f32 v140, v148, v152
    v_cvt_pk_bf16_f32 v141, v156, v160
    v_cvt_pk_bf16_f32 v142, v149, v153
    v_cvt_pk_bf16_f32 v143, v157, v161
    v_cvt_pk_bf16_f32 v144, v150, v154
    v_cvt_pk_bf16_f32 v145, v158, v162
    v_cvt_pk_bf16_f32 v146, v151, v155
    v_cvt_pk_bf16_f32 v147, v159, v163
    v_exp_f32 v136, v112
    v_exp_f32 v137, v113
    s_nop 0
    v_pk_add_f32 v[136:137], v[136:137], 1.0 op_sel_hi:[1,0]
    v_rcp_f32 v136, v136
    v_rcp_f32 v137, v137
    s_nop 0
    v_pk_mul_f32 v[128:129], v[136:137], v[112:113]
    v_exp_f32 v136, v116
    v_exp_f32 v137, v117
    s_nop 0
    v_pk_add_f32 v[136:137], v[136:137], 1.0 op_sel_hi:[1,0]
    v_rcp_f32 v136, v136
    v_rcp_f32 v137, v137
    s_nop 0
    v_pk_mul_f32 v[130:131], v[136:137], v[116:117]
    s_waitcnt vmcnt(7)
    v_mfma_f32_4x4x4_16b_bf16 v[96:99], v[140:141], v[64:65], 0 cbsz:4 abid:0
    v_mfma_f32_4x4x4_16b_bf16 v[100:103], v[140:141], v[66:67], 0 cbsz:4 abid:0
A_0:
    s_sub_u32 s31, s31, 4
    s_cbranch_scc1 B_0
    s_waitcnt vmcnt(6)
    v_mfma_f32_4x4x4_16b_bf16 v[104:107], v[142:143], v[68:69], 0 cbsz:4 abid:0
    v_readlane_b32 s56, v164, 8
    v_mfma_f32_4x4x4_16b_bf16 v[124:127], v[172:173], v[180:181], 0 cbsz:4 abid:1
    v_exp_f32 v136, v114
    v_exp_f32 v137, v115
    s_and_b32 s33, s56, s34
    v_pk_add_f32 v[136:137], v[136:137], 1.0 op_sel_hi:[1,0]
    v_mfma_f32_4x4x4_16b_bf16 v[108:111], v[142:143], v[70:71], 0 cbsz:4 abid:0
    v_rcp_f32 v136, v136
    v_rcp_f32 v137, v137
    buffer_load_dwordx4 v[64:67], v1, s[12:15], s33 offen
    v_pk_mul_f32 v[132:133], v[136:137], v[114:115]
    s_set_gpr_idx_on s48, 0xc
    v_pk_fma_f32 v[16:17], v[128:129], v[96:97], v[16:17] op_sel:[0,0,0] op_sel_hi:[0,1,1]
    v_pk_fma_f32 v[18:19], v[128:129], v[98:99], v[18:19] op_sel:[0,0,0] op_sel_hi:[0,1,1]
    v_pk_fma_f32 v[20:21], v[130:131], v[100:101], v[20:21] op_sel:[0,0,0] op_sel_hi:[0,1,1]
    v_pk_fma_f32 v[22:23], v[130:131], v[102:103], v[22:23] op_sel:[0,0,0] op_sel_hi:[0,1,1]
    s_set_gpr_idx_off
    s_waitcnt vmcnt(6)
    v_mfma_f32_4x4x4_16b_bf16 v[96:99], v[144:145], v[72:73], 0 cbsz:4 abid:0
    v_readlane_b32 s57, v164, 9
    v_mfma_f32_4x4x4_16b_bf16 v[124:127], v[172:173], v[182:183], v[124:127] cbsz:4 abid:1
    v_exp_f32 v136, v118
    v_exp_f32 v137, v119
    s_and_b32 s33, s57, s34
    v_pk_add_f32 v[136:137], v[136:137], 1.0 op_sel_hi:[1,0]
    v_mfma_f32_4x4x4_16b_bf16 v[100:103], v[144:145], v[74:75], 0 cbsz:4 abid:0
    v_rcp_f32 v136, v136
    v_rcp_f32 v137, v137
    buffer_load_dwordx4 v[68:71], v1, s[12:15], s33 offen
    v_pk_mul_f32 v[134:135], v[136:137], v[118:119]
    s_set_gpr_idx_on s49, 0xc
    v_pk_fma_f32 v[16:17], v[128:129], v[104:105], v[16:17] op_sel:[1,0,0] op_sel_hi:[1,1,1]
    v_pk_fma_f32 v[18:19], v[128:129], v[106:107], v[18:19] op_sel:[1,0,0] op_sel_hi:[1,1,1]
    v_pk_fma_f32 v[20:21], v[130:131], v[108:109], v[20:21] op_sel:[1,0,0] op_sel_hi:[1,1,1]
    v_pk_fma_f32 v[22:23], v[130:131], v[110:111], v[22:23] op_sel:[1,0,0] op_sel_hi:[1,1,1]
    s_set_gpr_idx_off
    s_waitcnt vmcnt(6)
    v_mfma_f32_4x4x4_16b_bf16 v[104:107], v[146:147], v[76:77], 0 cbsz:4 abid:0
    v_readlane_b32 s58, v164, 10
    v_mfma_f32_4x4x4_16b_bf16 v[112:115], v[172:173], v[176:177], 0 cbsz:4 abid:2
    v_exp_f32 v136, v120
    v_exp_f32 v137, v121
    s_and_b32 s33, s58, s34
    v_pk_add_f32 v[136:137], v[136:137], 1.0 op_sel_hi:[1,0]
    v_mfma_f32_4x4x4_16b_bf16 v[108:111], v[146:147], v[78:79], 0 cbsz:4 abid:0
    v_rcp_f32 v136, v136
    v_rcp_f32 v137, v137
    buffer_load_dwordx4 v[72:75], v1, s[12:15], s33 offen
    v_pk_mul_f32 v[128:129], v[136:137], v[120:121]
    s_set_gpr_idx_on s50, 0xc
    v_pk_fma_f32 v[16:17], v[132:133], v[96:97], v[16:17] op_sel:[0,0,0] op_sel_hi:[0,1,1]
    v_pk_fma_f32 v[18:19], v[132:133], v[98:99], v[18:19] op_sel:[0,0,0] op_sel_hi:[0,1,1]
    v_pk_fma_f32 v[20:21], v[134:135], v[100:101], v[20:21] op_sel:[0,0,0] op_sel_hi:[0,1,1]
    v_pk_fma_f32 v[22:23], v[134:135], v[102:103], v[22:23] op_sel:[0,0,0] op_sel_hi:[0,1,1]
    s_set_gpr_idx_off
    s_waitcnt vmcnt(6)
    v_mfma_f32_4x4x4_16b_bf16 v[96:99], v[140:141], v[80:81], 0 cbsz:4 abid:1
    v_readlane_b32 s59, v164, 11
    v_mfma_f32_4x4x4_16b_bf16 v[112:115], v[172:173], v[178:179], v[112:115] cbsz:4 abid:2
    v_exp_f32 v136, v124
    v_exp_f32 v137, v125
    s_and_b32 s33, s59, s34
    v_pk_add_f32 v[136:137], v[136:137], 1.0 op_sel_hi:[1,0]
    v_mfma_f32_4x4x4_16b_bf16 v[100:103], v[140:141], v[82:83], 0 cbsz:4 abid:1
    v_rcp_f32 v136, v136
    v_rcp_f32 v137, v137
    buffer_load_dwordx4 v[76:79], v1, s[12:15], s33 offen
    v_pk_mul_f32 v[130:131], v[136:137], v[124:125]
    s_set_gpr_idx_on s51, 0xc
    v_pk_fma_f32 v[16:17], v[132:133], v[104:105], v[16:17] op_sel:[1,0,0] op_sel_hi:[1,1,1]
    v_pk_fma_f32 v[18:19], v[132:133], v[106:107], v[18:19] op_sel:[1,0,0] op_sel_hi:[1,1,1]
    v_pk_fma_f32 v[20:21], v[134:135], v[108:109], v[20:21] op_sel:[1,0,0] op_sel_hi:[1,1,1]
    v_pk_fma_f32 v[22:23], v[134:135], v[110:111], v[22:23] op_sel:[1,0,0] op_sel_hi:[1,1,1]
    s_set_gpr_idx_off
A_4:
    s_sub_u32 s31, s31, 4
    s_cbranch_scc1 B_4
    s_waitcnt vmcnt(6)
    v_mfma_f32_4x4x4_16b_bf16 v[104:107], v[142:143], v[84:85], 0 cbsz:4 abid:1
    v_readlane_b32 s60, v164, 12
    v_mfma_f32_4x4x4_16b_bf16 v[116:119], v[172:173], v[180:181], 0 cbsz:4 abid:2
    v_exp_f32 v136, v122
    v_exp_f32 v137, v123
    s_and_b32 s33, s60, s34
    v_pk_add_f32 v[136:137], v[136:137], 1.0 op_sel_hi:[1,0]
    v_mfma_f32_4x4x4_16b_bf16 v[108:111], v[142:143], v[86:87], 0 cbsz:4 abid:1
    v_rcp_f32 v136, v136
    v_rcp_f32 v137, v137
    buffer_load_dwordx4 v[80:83], v1, s[12:15], s33 offen
    v_pk_mul_f32 v[132:133], v[136:137], v[122:123]
    s_set_gpr_idx_on s52, 0xc
    v_pk_fma_f32 v[16:17], v[128:129], v[96:97], v[16:17] op_sel:[0,0,0] op_sel_hi:[0,1,1]
    v_pk_fma_f32 v[18:19], v[128:129], v[98:99], v[18:19] op_sel:[0,0,0] op_sel_hi:[0,1,1]
    v_pk_fma_f32 v[20:21], v[130:131], v[100:101], v[20:21] op_sel:[0,0,0] op_sel_hi:[0,1,1]
    v_pk_fma_f32 v[22:23], v[130:131], v[102:103], v[22:23] op_sel:[0,0,0] op_sel_hi:[0,1,1]
    s_set_gpr_idx_off
    s_waitcnt vmcnt(6)
    v_mfma_f32_4x4x4_16b_bf16 v[96:99], v[144:145], v[88:89], 0 cbsz:4 abid:1
    v_readlane_b32 s61, v164, 13
    v_mfma_f32_4x4x4_16b_bf16 v[116:119], v[172:173], v[182:183], v[116:119] cbsz:4 abid:2
    v_exp_f32 v136, v126
    v_exp_f32 v137, v127
    s_and_b32 s33, s61, s34
    v_pk_add_f32 v[136:137], v[136:137], 1.0 op_sel_hi:[1,0]
    v_mfma_f32_4x4x4_16b_bf16 v[100:103], v[144:145], v[90:91], 0 cbsz:4 abid:1
    v_rcp_f32 v136, v136
    v_rcp_f32 v137, v137
    buffer_load_dwordx4 v[84:87], v1, s[12:15], s33 offen
    v_pk_mul_f32 v[134:135], v[136:137], v[126:127]
    s_set_gpr_idx_on s53, 0xc
    v_pk_fma_f32 v[16:17], v[128:129], v[104:105], v[16:17] op_sel:[1,0,0] op_sel_hi:[1,1,1]
    v_pk_fma_f32 v[18:19], v[128:129], v[106:107], v[18:19] op_sel:[1,0,0] op_sel_hi:[1,1,1]
    v_pk_fma_f32 v[20:21], v[130:131], v[108:109], v[20:21] op_sel:[1,0,0] op_sel_hi:[1,1,1]
    v_pk_fma_f32 v[22:23], v[130:131], v[110:111], v[22:23] op_sel:[1,0,0] op_sel_hi:[1,1,1]
    s_set_gpr_idx_off
    s_waitcnt vmcnt(6)
    v_mfma_f32_4x4x4_16b_bf16 v[104:107], v[146:147], v[92:93], 0 cbsz:4 abid:1
    v_readlane_b32 s62, v164, 14
    v_mfma_f32_4x4x4_16b_bf16 v[120:123], v[172:173], v[176:177], 0 cbsz:4 abid:3
    v_exp_f32 v136, v112
    v_exp_f32 v137, v113
    s_and_b32 s33, s62, s34
    v_pk_add_f32 v[136:137], v[136:137], 1.0 op_sel_hi:[1,0]
    v_mfma_f32_4x4x4_16b_bf16 v[108:111], v[146:147], v[94:95], 0 cbsz:4 abid:1
    v_rcp_f32 v136, v136
    v_rcp_f32 v137, v137
    buffer_load_dwordx4 v[88:91], v1, s[12:15], s33 offen
    v_pk_mul_f32 v[128:129], v[136:137], v[112:113]
    s_set_gpr_idx_on s54, 0xc
    v_pk_fma_f32 v[16:17], v[132:133], v[96:97], v[16:17] op_sel:[0,0,0] op_sel_hi:[0,1,1]
    v_pk_fma_f32 v[18:19], v[132:133], v[98:99], v[18:19] op_sel:[0,0,0] op_sel_hi:[0,1,1]
    v_pk_fma_f32 v[20:21], v[134:135], v[100:101], v[20:21] op_sel:[0,0,0] op_sel_hi:[0,1,1]
    v_pk_fma_f32 v[22:23], v[134:135], v[102:103], v[22:23] op_sel:[0,0,0] op_sel_hi:[0,1,1]
    s_set_gpr_idx_off
    s_waitcnt vmcnt(6)
    v_mfma_f32_4x4x4_16b_bf16 v[96:99], v[140:141], v[64:65], 0 cbsz:4 abid:2
    v_readlane_b32 s63, v164, 15
    v_mfma_f32_4x4x4_16b_bf16 v[120:123], v[172:173], v[178:179], v[120:123] cbsz:4 abid:3
    v_exp_f32 v136, v116
    v_exp_f32 v137, v117
    s_and_b32 s33, s63, s34
    v_pk_add_f32 v[136:137], v[136:137], 1.0 op_sel_hi:[1,0]
    v_mfma_f32_4x4x4_16b_bf16 v[100:103], v[140:141], v[66:67], 0 cbsz:4 abid:2
    v_rcp_f32 v136, v136
    v_rcp_f32 v137, v137
    buffer_load_dwordx4 v[92:95], v1, s[12:15], s33 offen
    v_pk_mul_f32 v[130:131], v[136:137], v[116:117]
    s_set_gpr_idx_on s55, 0xc
    v_pk_fma_f32 v[16:17], v[132:133], v[104:105], v[16:17] op_sel:[1,0,0] op_sel_hi:[1,1,1]
    v_pk_fma_f32 v[18:19], v[132:133], v[106:107], v[18:19] op_sel:[1,0,0] op_sel_hi:[1,1,1]
    v_pk_fma_f32 v[20:21], v[134:135], v[108:109], v[20:21] op_sel:[1,0,0] op_sel_hi:[1,1,1]
    v_pk_fma_f32 v[22:23], v[134:135], v[110:111], v[22:23] op_sel:[1,0,0] op_sel_hi:[1,1,1]
    s_set_gpr_idx_off
A_8:
    s_sub_u32 s31, s31, 4
    s_cbranch_scc1 B_8
    s_waitcnt vmcnt(6)
    v_mfma_f32_4x4x4_16b_bf16 v[104:107], v[142:143], v[68:69], 0 cbsz:4 abid:2
    v_readlane_b32 s48, v164, 16
    v_mfma_f32_4x4x4_16b_bf16 v[124:127], v[172:173], v[180:181], 0 cbsz:4 abid:3
    v_exp_f32 v136, v114
    v_exp_f32 v137, v115
    s_and_b32 s33, s48, s34
    v_pk_add_f32 v[136:137], v[136:137], 1.0 op_sel_hi:[1,0]
    v_mfma_f32_4x4x4_16b_bf16 v[108:111], v[142:143], v[70:71], 0 cbsz:4 abid:2
    v_rcp_f32 v136, v136
    v_rcp_f32 v137, v137
    buffer_load_dwordx4 v[64:67], v1, s[12:15], s33 offen
    v_pk_mul_f32 v[132:133], v[136:137], v[114:115]
    s_set_gpr_idx_on s56, 0xc
    v_pk_fma_f32 v[16:17], v[128:129], v[96:97], v[16:17] op_sel:[0,0,0] op_sel_hi:[0,1,1]
    v_pk_fma_f32 v[18:19], v[128:129], v[98:99], v[18:19] op_sel:[0,0,0] op_sel_hi:[0,1,1]
    v_pk_fma_f32 v[20:21], v[130:131], v[100:101], v[20:21] op_sel:[0,0,0] op_sel_hi:[0,1,1]
    v_pk_fma_f32 v[22:23], v[130:131], v[102:103], v[22:23] op_sel:[0,0,0] op_sel_hi:[0,1,1]
    s_set_gpr_idx_off
    ds_read_b64 v[166:167], v5
    s_waitcnt vmcnt(6)
    v_mfma_f32_4x4x4_16b_bf16 v[96:99], v[144:145], v[72:73], 0 cbsz:4 abid:2
    v_readlane_b32 s49, v164, 17
    v_mfma_f32_4x4x4_16b_bf16 v[124:127], v[172:173], v[182:183], v[124:127] cbsz:4 abid:3
    v_exp_f32 v136, v118
    v_exp_f32 v137, v119
    s_and_b32 s33, s49, s34
    v_pk_add_f32 v[136:137], v[136:137], 1.0 op_sel_hi:[1,0]
    v_mfma_f32_4x4x4_16b_bf16 v[100:103], v[144:145], v[74:75], 0 cbsz:4 abid:2
    v_rcp_f32 v136, v136
    v_rcp_f32 v137, v137
    buffer_load_dwordx4 v[68:71], v1, s[12:15], s33 offen
    v_pk_mul_f32 v[134:135], v[136:137], v[118:119]
    s_set_gpr_idx_on s57, 0xc
    v_pk_fma_f32 v[16:17], v[128:129], v[104:105], v[16:17] op_sel:[1,0,0] op_sel_hi:[1,1,1]
    v_pk_fma_f32 v[18:19], v[128:129], v[106:107], v[18:19] op_sel:[1,0,0] op_sel_hi:[1,1,1]
    v_pk_fma_f32 v[20:21], v[130:131], v[108:109], v[20:21] op_sel:[1,0,0] op_sel_hi:[1,1,1]
    v_pk_fma_f32 v[22:23], v[130:131], v[110:111], v[22:23] op_sel:[1,0,0] op_sel_hi:[1,1,1]
    s_set_gpr_idx_off
    s_waitcnt vmcnt(6)
    v_mfma_f32_4x4x4_16b_bf16 v[104:107], v[146:147], v[76:77], 0 cbsz:4 abid:2
    v_readlane_b32 s50, v164, 18
    v_mfma_f32_4x4x4_16b_bf16 v[112:115], v[172:173], v[176:177], 0 cbsz:4 abid:4
    v_exp_f32 v136, v120
    v_exp_f32 v137, v121
    s_and_b32 s33, s50, s34
    v_pk_add_f32 v[136:137], v[136:137], 1.0 op_sel_hi:[1,0]
    v_mfma_f32_4x4x4_16b_bf16 v[108:111], v[146:147], v[78:79], 0 cbsz:4 abid:2
    v_rcp_f32 v136, v136
    v_rcp_f32 v137, v137
    buffer_load_dwordx4 v[72:75], v1, s[12:15], s33 offen
    v_pk_mul_f32 v[128:129], v[136:137], v[120:121]
    s_set_gpr_idx_on s58, 0xc
    v_pk_fma_f32 v[16:17], v[132:133], v[96:97], v[16:17] op_sel:[0,0,0] op_sel_hi:[0,1,1]
    v_pk_fma_f32 v[18:19], v[132:133], v[98:99], v[18:19] op_sel:[0,0,0] op_sel_hi:[0,1,1]
    v_pk_fma_f32 v[20:21], v[134:135], v[100:101], v[20:21] op_sel:[0,0,0] op_sel_hi:[0,1,1]
    v_pk_fma_f32 v[22:23], v[134:135], v[102:103], v[22:23] op_sel:[0,0,0] op_sel_hi:[0,1,1]
    s_set_gpr_idx_off
    s_waitcnt vmcnt(6)
    v_mfma_f32_4x4x4_16b_bf16 v[96:99], v[140:141], v[80:81], 0 cbsz:4 abid:3
    v_readlane_b32 s51, v164, 19
    v_mfma_f32_4x4x4_16b_bf16 v[112:115], v[172:173], v[178:179], v[112:115] cbsz:4 abid:4
    v_exp_f32 v136, v124
    v_exp_f32 v137, v125
    s_and_b32 s33, s51, s34
    v_pk_add_f32 v[136:137], v[136:137], 1.0 op_sel_hi:[1,0]
    v_mfma_f32_4x4x4_16b_bf16 v[100:103], v[140:141], v[82:83], 0 cbsz:4 abid:3
    v_rcp_f32 v136, v136
    v_rcp_f32 v137, v137
    buffer_load_dwordx4 v[76:79], v1, s[12:15], s33 offen
    v_pk_mul_f32 v[130:131], v[136:137], v[124:125]
    s_set_gpr_idx_on s59, 0xc
    v_pk_fma_f32 v[16:17], v[132:133], v[104:105], v[16:17] op_sel:[1,0,0] op_sel_hi:[1,1,1]
    v_pk_fma_f32 v[18:19], v[132:133], v[106:107], v[18:19] op_sel:[1,0,0] op_sel_hi:[1,1,1]
    v_pk_fma_f32 v[20:21], v[134:135], v[108:109], v[20:21] op_sel:[1,0,0] op_sel_hi:[1,1,1]
    v_pk_fma_f32 v[22:23], v[134:135], v[110:111], v[22:23] op_sel:[1,0,0] op_sel_hi:[1,1,1]
    s_set_gpr_idx_off
A_12:
    s_sub_u32 s31, s31, 4
    s_cbranch_scc1 B_12
    s_waitcnt vmcnt(6)
    v_mfma_f32_4x4x4_16b_bf16 v[104:107], v[142:143], v[84:85], 0 cbsz:4 abid:3
    v_readlane_b32 s52, v164, 20
    v_mfma_f32_4x4x4_16b_bf16 v[116:119], v[172:173], v[180:181], 0 cbsz:4 abid:4
    v_exp_f32 v136, v122
    v_exp_f32 v137, v123
    s_and_b32 s33, s52, s34
    v_pk_add_f32 v[136:137], v[136:137], 1.0 op_sel_hi:[1,0]
    v_mfma_f32_4x4x4_16b_bf16 v[108:111], v[142:143], v[86:87], 0 cbsz:4 abid:3
    v_rcp_f32 v136, v136
    v_rcp_f32 v137, v137
    buffer_load_dwordx4 v[80:83], v1, s[12:15], s33 offen
    v_pk_mul_f32 v[132:133], v[136:137], v[122:123]
    s_set_gpr_idx_on s60, 0xc
    v_pk_fma_f32 v[16:17], v[128:129], v[96:97], v[16:17] op_sel:[0,0,0] op_sel_hi:[0,1,1]
    v_pk_fma_f32 v[18:19], v[128:129], v[98:99], v[18:19] op_sel:[0,0,0] op_sel_hi:[0,1,1]
    v_pk_fma_f32 v[20:21], v[130:131], v[100:101], v[20:21] op_sel:[0,0,0] op_sel_hi:[0,1,1]
    v_pk_fma_f32 v[22:23], v[130:131], v[102:103], v[22:23] op_sel:[0,0,0] op_sel_hi:[0,1,1]
    s_set_gpr_idx_off
    s_waitcnt lgkmcnt(0)
    v_cmp_gt_u32 vcc, s30, v6
    v_add_u32 v6, 64, v6
    v_add_u32 v5, 512, v5
    v_mov_b32 v8, 23040
    v_cndmask_b32 v166, 40, v166, vcc
    v_cndmask_b32 v167, v8, v167, vcc
    ds_read_b128 v[168:171], v167
    s_waitcnt vmcnt(6)
    v_mfma_f32_4x4x4_16b_bf16 v[96:99], v[144:145], v[88:89], 0 cbsz:4 abid:3
    v_readlane_b32 s53, v164, 21
    v_mfma_f32_4x4x4_16b_bf16 v[116:119], v[172:173], v[182:183], v[116:119] cbsz:4 abid:4
    v_exp_f32 v136, v126
    v_exp_f32 v137, v127
    s_and_b32 s33, s53, s34
    v_pk_add_f32 v[136:137], v[136:137], 1.0 op_sel_hi:[1,0]
    v_mfma_f32_4x4x4_16b_bf16 v[100:103], v[144:145], v[90:91], 0 cbsz:4 abid:3
    v_rcp_f32 v136, v136
    v_rcp_f32 v137, v137
    buffer_load_dwordx4 v[84:87], v1, s[12:15], s33 offen
    v_pk_mul_f32 v[134:135], v[136:137], v[126:127]
    s_set_gpr_idx_on s61, 0xc
    v_pk_fma_f32 v[16:17], v[128:129], v[104:105], v[16:17] op_sel:[1,0,0] op_sel_hi:[1,1,1]
    v_pk_fma_f32 v[18:19], v[128:129], v[106:107], v[18:19] op_sel:[1,0,0] op_sel_hi:[1,1,1]
    v_pk_fma_f32 v[20:21], v[130:131], v[108:109], v[20:21] op_sel:[1,0,0] op_sel_hi:[1,1,1]
    v_pk_fma_f32 v[22:23], v[130:131], v[110:111], v[22:23] op_sel:[1,0,0] op_sel_hi:[1,1,1]
    s_set_gpr_idx_off
    s_waitcnt vmcnt(6)
    v_mfma_f32_4x4x4_16b_bf16 v[104:107], v[146:147], v[92:93], 0 cbsz:4 abid:3
    v_readlane_b32 s54, v164, 22
    v_mfma_f32_4x4x4_16b_bf16 v[120:123], v[172:173], v[176:177], 0 cbsz:4 abid:5
    v_exp_f32 v136, v112
    v_exp_f32 v137, v113
    s_and_b32 s33, s54, s34
    v_pk_add_f32 v[136:137], v[136:137], 1.0 op_sel_hi:[1,0]
    v_mfma_f32_4x4x4_16b_bf16 v[108:111], v[146:147], v[94:95], 0 cbsz:4 abid:3
    v_rcp_f32 v136, v136
    v_rcp_f32 v137, v137
    buffer_load_dwordx4 v[88:91], v1, s[12:15], s33 offen
    v_pk_mul_f32 v[128:129], v[136:137], v[112:113]
    s_set_gpr_idx_on s62, 0xc
    v_pk_fma_f32 v[16:17], v[132:133], v[96:97], v[16:17] op_sel:[0,0,0] op_sel_hi:[0,1,1]
    v_pk_fma_f32 v[18:19], v[132:133], v[98:99], v[18:19] op_sel:[0,0,0] op_sel_hi:[0,1,1]
    v_pk_fma_f32 v[20:21], v[134:135], v[100:101], v[20:21] op_sel:[0,0,0] op_sel_hi:[0,1,1]
    v_pk_fma_f32 v[22:23], v[134:135], v[102:103], v[22:23] op_sel:[0,0,0] op_sel_hi:[0,1,1]
    s_set_gpr_idx_off
    s_waitcnt vmcnt(6)
    v_mfma_f32_4x4x4_16b_bf16 v[96:99], v[140:141], v[64:65], 0 cbsz:4 abid:4
    v_readlane_b32 s55, v164, 23
    v_mfma_f32_4x4x4_16b_bf16 v[120:123], v[172:173], v[178:179], v[120:123] cbsz:4 abid:5
    v_exp_f32 v136, v116
    v_exp_f32 v137, v117
    s_and_b32 s33, s55, s34
    v_pk_add_f32 v[136:137], v[136:137], 1.0 op_sel_hi:[1,0]
    v_mfma_f32_4x4x4_16b_bf16 v[100:103], v[140:141], v[66:67], 0 cbsz:4 abid:4
    v_rcp_f32 v136, v136
    v_rcp_f32 v137, v137
    buffer_load_dwordx4 v[92:95], v1, s[12:15], s33 offen
    v_pk_mul_f32 v[130:131], v[136:137], v[116:117]
    s_set_gpr_idx_on s63, 0xc
    v_pk_fma_f32 v[16:17], v[132:133], v[104:105], v[16:17] op_sel:[1,0,0] op_sel_hi:[1,1,1]
    v_pk_fma_f32 v[18:19], v[132:133], v[106:107], v[18:19] op_sel:[1,0,0] op_sel_hi:[1,1,1]
    v_pk_fma_f32 v[20:21], v[134:135], v[108:109], v[20:21] op_sel:[1,0,0] op_sel_hi:[1,1,1]
    v_pk_fma_f32 v[22:23], v[134:135], v[110:111], v[22:23] op_sel:[1,0,0] op_sel_hi:[1,1,1]
    s_set_gpr_idx_off
A_16:
    s_sub_u32 s31, s31, 4
    s_cbranch_scc1 B_16
    s_waitcnt vmcnt(6)
    v_mfma_f32_4x4x4_16b_bf16 v[104:107], v[142:143], v[68:69], 0 cbsz:4 abid:4
    v_readlane_b32 s56, v164, 24
    v_mfma_f32_4x4x4_16b_bf16 v[124:127], v[172:173], v[180:181], 0 cbsz:4 abid:5
    v_exp_f32 v136, v114
    v_exp_f32 v137, v115
    s_and_b32 s33, s56, s34
    v_pk_add_f32 v[136:137], v[136:137], 1.0 op_sel_hi:[1,0]
    v_mfma_f32_4x4x4_16b_bf16 v[108:111], v[142:143], v[70:71], 0 cbsz:4 abid:4
    v_rcp_f32 v136, v136
    v_rcp_f32 v137, v137
    buffer_load_dwordx4 v[64:67], v1, s[12:15], s33 offen
    v_pk_mul_f32 v[132:133], v[136:137], v[114:115]
    s_set_gpr_idx_on s48, 0xc
    v_pk_fma_f32 v[16:17], v[128:129], v[96:97], v[16:17] op_sel:[0,0,0] op_sel_hi:[0,1,1]
    v_pk_fma_f32 v[18:19], v[128:129], v[98:99], v[18:19] op_sel:[0,0,0] op_sel_hi:[0,1,1]
    v_pk_fma_f32 v[20:21], v[130:131], v[100:101], v[20:21] op_sel:[0,0,0] op_sel_hi:[0,1,1]
    v_pk_fma_f32 v[22:23], v[130:131], v[102:103], v[22:23] op_sel:[0,0,0] op_sel_hi:[0,1,1]
    s_set_gpr_idx_off
    s_waitcnt vmcnt(6)
    v_mfma_f32_4x4x4_16b_bf16 v[96:99], v[144:145], v[72:73], 0 cbsz:4 abid:4
    v_readlane_b32 s57, v164, 25
    v_mfma_f32_4x4x4_16b_bf16 v[124:127], v[172:173], v[182:183], v[124:127] cbsz:4 abid:5
    v_exp_f32 v136, v118
    v_exp_f32 v137, v119
    s_and_b32 s33, s57, s34
    v_pk_add_f32 v[136:137], v[136:137], 1.0 op_sel_hi:[1,0]
    v_mfma_f32_4x4x4_16b_bf16 v[100:103], v[144:145], v[74:75], 0 cbsz:4 abid:4
    v_rcp_f32 v136, v136
    v_rcp_f32 v137, v137
    buffer_load_dwordx4 v[68:71], v1, s[12:15], s33 offen
    v_pk_mul_f32 v[134:135], v[136:137], v[118:119]
    s_set_gpr_idx_on s49, 0xc
    v_pk_fma_f32 v[16:17], v[128:129], v[104:105], v[16:17] op_sel:[1,0,0] op_sel_hi:[1,1,1]
    v_pk_fma_f32 v[18:19], v[128:129], v[106:107], v[18:19] op_sel:[1,0,0] op_sel_hi:[1,1,1]
    v_pk_fma_f32 v[20:21], v[130:131], v[108:109], v[20:21] op_sel:[1,0,0] op_sel_hi:[1,1,1]
    v_pk_fma_f32 v[22:23], v[130:131], v[110:111], v[22:23] op_sel:[1,0,0] op_sel_hi:[1,1,1]
    s_set_gpr_idx_off
    s_waitcnt vmcnt(6)
    v_mfma_f32_4x4x4_16b_bf16 v[104:107], v[146:147], v[76:77], 0 cbsz:4 abid:4
    v_readlane_b32 s58, v164, 26
    v_mfma_f32_4x4x4_16b_bf16 v[112:115], v[172:173], v[176:177], 0 cbsz:4 abid:6
    v_exp_f32 v136, v120
    v_exp_f32 v137, v121
    s_and_b32 s33, s58, s34
    v_pk_add_f32 v[136:137], v[136:137], 1.0 op_sel_hi:[1,0]
    v_mfma_f32_4x4x4_16b_bf16 v[108:111], v[146:147], v[78:79], 0 cbsz:4 abid:4
    v_rcp_f32 v136, v136
    v_rcp_f32 v137, v137
    buffer_load_dwordx4 v[72:75], v1, s[12:15], s33 offen
    v_pk_mul_f32 v[128:129], v[136:137], v[120:121]
    s_set_gpr_idx_on s50, 0xc
    v_pk_fma_f32 v[16:17], v[132:133], v[96:97], v[16:17] op_sel:[0,0,0] op_sel_hi:[0,1,1]
    v_pk_fma_f32 v[18:19], v[132:133], v[98:99], v[18:19] op_sel:[0,0,0] op_sel_hi:[0,1,1]
    v_pk_fma_f32 v[20:21], v[134:135], v[100:101], v[20:21] op_sel:[0,0,0] op_sel_hi:[0,1,1]
    v_pk_fma_f32 v[22:23], v[134:135], v[102:103], v[22:23] op_sel:[0,0,0] op_sel_hi:[0,1,1]
    s_set_gpr_idx_off
    s_waitcnt vmcnt(6)
    v_mfma_f32_4x4x4_16b_bf16 v[96:99], v[140:141], v[80:81], 0 cbsz:4 abid:5
    v_readlane_b32 s59, v164, 27
    v_mfma_f32_4x4x4_16b_bf16 v[112:115], v[172:173], v[178:179], v[112:115] cbsz:4 abid:6
    v_exp_f32 v136, v124
    v_exp_f32 v137, v125
    s_and_b32 s33, s59, s34
    v_pk_add_f32 v[136:137], v[136:137], 1.0 op_sel_hi:[1,0]
    v_mfma_f32_4x4x4_16b_bf16 v[100:103], v[140:141], v[82:83], 0 cbsz:4 abid:5
    v_rcp_f32 v136, v136
    v_rcp_f32 v137, v137
    buffer_load_dwordx4 v[76:79], v1, s[12:15], s33 offen
    v_pk_mul_f32 v[130:131], v[136:137], v[124:125]
    s_set_gpr_idx_on s51, 0xc
    v_pk_fma_f32 v[16:17], v[132:133], v[104:105], v[16:17] op_sel:[1,0,0] op_sel_hi:[1,1,1]
    v_pk_fma_f32 v[18:19], v[132:133], v[106:107], v[18:19] op_sel:[1,0,0] op_sel_hi:[1,1,1]
    v_pk_fma_f32 v[20:21], v[134:135], v[108:109], v[20:21] op_sel:[1,0,0] op_sel_hi:[1,1,1]
    v_pk_fma_f32 v[22:23], v[134:135], v[110:111], v[22:23] op_sel:[1,0,0] op_sel_hi:[1,1,1]
    s_set_gpr_idx_off
A_20:
    s_sub_u32 s31, s31, 4
    s_cbranch_scc1 B_20
    s_waitcnt vmcnt(6)
    v_mfma_f32_4x4x4_16b_bf16 v[104:107], v[142:143], v[84:85], 0 cbsz:4 abid:5
    v_readlane_b32 s60, v164, 28
    v_mfma_f32_4x4x4_16b_bf16 v[116:119], v[172:173], v[180:181], 0 cbsz:4 abid:6
    v_exp_f32 v136, v122
    v_exp_f32 v137, v123
    s_and_b32 s33, s60, s34
    v_pk_add_f32 v[136:137], v[136:137], 1.0 op_sel_hi:[1,0]
    v_mfma_f32_4x4x4_16b_bf16 v[108:111], v[142:143], v[86:87], 0 cbsz:4 abid:5
    v_rcp_f32 v136, v136
    v_rcp_f32 v137, v137
    buffer_load_dwordx4 v[80:83], v1, s[12:15], s33 offen
    v_pk_mul_f32 v[132:133], v[136:137], v[122:123]
    s_set_gpr_idx_on s52, 0xc
    v_pk_fma_f32 v[16:17], v[128:129], v[96:97], v[16:17] op_sel:[0,0,0] op_sel_hi:[0,1,1]
    v_pk_fma_f32 v[18:19], v[128:129], v[98:99], v[18:19] op_sel:[0,0,0] op_sel_hi:[0,1,1]
    v_pk_fma_f32 v[20:21], v[130:131], v[100:101], v[20:21] op_sel:[0,0,0] op_sel_hi:[0,1,1]
    v_pk_fma_f32 v[22:23], v[130:131], v[102:103], v[22:23] op_sel:[0,0,0] op_sel_hi:[0,1,1]
    s_set_gpr_idx_off
    s_waitcnt lgkmcnt(0)
    s_waitcnt vmcnt(6)
    v_mfma_f32_4x4x4_16b_bf16 v[96:99], v[144:145], v[88:89], 0 cbsz:4 abid:5
    v_readlane_b32 s61, v164, 29
    v_mfma_f32_4x4x4_16b_bf16 v[116:119], v[172:173], v[182:183], v[116:119] cbsz:4 abid:6
    v_exp_f32 v136, v126
    v_exp_f32 v137, v127
    s_and_b32 s33, s61, s34
    v_pk_add_f32 v[136:137], v[136:137], 1.0 op_sel_hi:[1,0]
    v_mfma_f32_4x4x4_16b_bf16 v[100:103], v[144:145], v[90:91], 0 cbsz:4 abid:5
    v_rcp_f32 v136, v136
    v_rcp_f32 v137, v137
    buffer_load_dwordx4 v[84:87], v1, s[12:15], s33 offen
    v_pk_mul_f32 v[134:135], v[136:137], v[126:127]
    s_set_gpr_idx_on s53, 0xc
    v_pk_fma_f32 v[16:17], v[128:129], v[104:105], v[16:17] op_sel:[1,0,0] op_sel_hi:[1,1,1]
    v_pk_fma_f32 v[18:19], v[128:129], v[106:107], v[18:19] op_sel:[1,0,0] op_sel_hi:[1,1,1]
    v_pk_fma_f32 v[20:21], v[130:131], v[108:109], v[20:21] op_sel:[1,0,0] op_sel_hi:[1,1,1]
    v_pk_fma_f32 v[22:23], v[130:131], v[110:111], v[22:23] op_sel:[1,0,0] op_sel_hi:[1,1,1]
    s_set_gpr_idx_off
    s_waitcnt vmcnt(6)
    v_mfma_f32_4x4x4_16b_bf16 v[104:107], v[146:147], v[92:93], 0 cbsz:4 abid:5
    v_readlane_b32 s62, v164, 30
    v_mfma_f32_4x4x4_16b_bf16 v[120:123], v[172:173], v[176:177], 0 cbsz:4 abid:7
    v_exp_f32 v136, v112
    v_exp_f32 v137, v113
    s_and_b32 s33, s62, s34
    v_pk_add_f32 v[136:137], v[136:137], 1.0 op_sel_hi:[1,0]
    v_mfma_f32_4x4x4_16b_bf16 v[108:111], v[146:147], v[94:95], 0 cbsz:4 abid:5
    v_rcp_f32 v136, v136
    v_rcp_f32 v137, v137
    buffer_load_dwordx4 v[88:91], v1, s[12:15], s33 offen
    v_pk_mul_f32 v[128:129], v[136:137], v[112:113]
    s_set_gpr_idx_on s54, 0xc
    v_pk_fma_f32 v[16:17], v[132:133], v[96:97], v[16:17] op_sel:[0,0,0] op_sel_hi:[0,1,1]
    v_pk_fma_f32 v[18:19], v[132:133], v[98:99], v[18:19] op_sel:[0,0,0] op_sel_hi:[0,1,1]
    v_pk_fma_f32 v[20:21], v[134:135], v[100:101], v[20:21] op_sel:[0,0,0] op_sel_hi:[0,1,1]
    v_pk_fma_f32 v[22:23], v[134:135], v[102:103], v[22:23] op_sel:[0,0,0] op_sel_hi:[0,1,1]
    s_set_gpr_idx_off
    s_waitcnt vmcnt(6)
    v_mfma_f32_4x4x4_16b_bf16 v[96:99], v[140:141], v[64:65], 0 cbsz:4 abid:6
    v_readlane_b32 s63, v164, 31
    v_mfma_f32_4x4x4_16b_bf16 v[120:123], v[172:173], v[178:179], v[120:123] cbsz:4 abid:7
    v_exp_f32 v136, v116
    v_exp_f32 v137, v117
    s_and_b32 s33, s63, s34
    v_pk_add_f32 v[136:137], v[136:137], 1.0 op_sel_hi:[1,0]
    v_mfma_f32_4x4x4_16b_bf16 v[100:103], v[140:141], v[66:67], 0 cbsz:4 abid:6
    v_rcp_f32 v136, v136
    v_rcp_f32 v137, v137
    buffer_load_dwordx4 v[92:95], v1, s[12:15], s33 offen
    v_pk_mul_f32 v[130:131], v[136:137], v[116:117]
    s_set_gpr_idx_on s55, 0xc
    v_pk_fma_f32 v[16:17], v[132:133], v[104:105], v[16:17] op_sel:[1,0,0] op_sel_hi:[1,1,1]
    v_pk_fma_f32 v[18:19], v[132:133], v[106:107], v[18:19] op_sel:[1,0,0] op_sel_hi:[1,1,1]
    v_pk_fma_f32 v[20:21], v[134:135], v[108:109], v[20:21] op_sel:[1,0,0] op_sel_hi:[1,1,1]
    v_pk_fma_f32 v[22:23], v[134:135], v[110:111], v[22:23] op_sel:[1,0,0] op_sel_hi:[1,1,1]
    s_set_gpr_idx_off
A_24:
    s_sub_u32 s31, s31, 4
    s_cbranch_scc1 B_24
    s_waitcnt vmcnt(6)
    v_mfma_f32_4x4x4_16b_bf16 v[104:107], v[142:143], v[68:69], 0 cbsz:4 abid:6
    v_readlane_b32 s48, v164, 32
    v_mfma_f32_4x4x4_16b_bf16 v[124:127], v[172:173], v[180:181], 0 cbsz:4 abid:7
    v_exp_f32 v136, v114
    v_exp_f32 v137, v115
    s_and_b32 s33, s48, s34
    v_pk_add_f32 v[136:137], v[136:137], 1.0 op_sel_hi:[1,0]
    v_mfma_f32_4x4x4_16b_bf16 v[108:111], v[142:143], v[70:71], 0 cbsz:4 abid:6
    v_rcp_f32 v136, v136
    v_rcp_f32 v137, v137
    buffer_load_dwordx4 v[64:67], v1, s[12:15], s33 offen
    v_pk_mul_f32 v[132:133], v[136:137], v[114:115]
    s_set_gpr_idx_on s56, 0xc
    v_pk_fma_f32 v[16:17], v[128:129], v[96:97], v[16:17] op_sel:[0,0,0] op_sel_hi:[0,1,1]
    v_pk_fma_f32 v[18:19], v[128:129], v[98:99], v[18:19] op_sel:[0,0,0] op_sel_hi:[0,1,1]
    v_pk_fma_f32 v[20:21], v[130:131], v[100:101], v[20:21] op_sel:[0,0,0] op_sel_hi:[0,1,1]
    v_pk_fma_f32 v[22:23], v[130:131], v[102:103], v[22:23] op_sel:[0,0,0] op_sel_hi:[0,1,1]
    s_set_gpr_idx_off
    s_waitcnt vmcnt(6)
    v_mfma_f32_4x4x4_16b_bf16 v[96:99], v[144:145], v[72:73], 0 cbsz:4 abid:6
    v_readlane_b32 s49, v164, 33
    v_mfma_f32_4x4x4_16b_bf16 v[124:127], v[172:173], v[182:183], v[124:127] cbsz:4 abid:7
    v_exp_f32 v136, v118
    v_exp_f32 v137, v119
    s_and_b32 s33, s49, s34
    v_pk_add_f32 v[136:137], v[136:137], 1.0 op_sel_hi:[1,0]
    v_mfma_f32_4x4x4_16b_bf16 v[100:103], v[144:145], v[74:75], 0 cbsz:4 abid:6
    v_rcp_f32 v136, v136
    v_rcp_f32 v137, v137
    buffer_load_dwordx4 v[68:71], v1, s[12:15], s33 offen
    v_pk_mul_f32 v[134:135], v[136:137], v[118:119]
    s_set_gpr_idx_on s57, 0xc
    v_pk_fma_f32 v[16:17], v[128:129], v[104:105], v[16:17] op_sel:[1,0,0] op_sel_hi:[1,1,1]
    v_pk_fma_f32 v[18:19], v[128:129], v[106:107], v[18:19] op_sel:[1,0,0] op_sel_hi:[1,1,1]
    v_pk_fma_f32 v[20:21], v[130:131], v[108:109], v[20:21] op_sel:[1,0,0] op_sel_hi:[1,1,1]
    v_pk_fma_f32 v[22:23], v[130:131], v[110:111], v[22:23] op_sel:[1,0,0] op_sel_hi:[1,1,1]
    s_set_gpr_idx_off
    s_waitcnt vmcnt(6)
    v_mfma_f32_4x4x4_16b_bf16 v[104:107], v[146:147], v[76:77], 0 cbsz:4 abid:6
    v_readlane_b32 s50, v164, 34
    v_mfma_f32_4x4x4_16b_bf16 v[112:115], v[172:173], v[176:177], 0 cbsz:4 abid:8
    v_exp_f32 v136, v120
    v_exp_f32 v137, v121
    s_and_b32 s33, s50, s34
    v_pk_add_f32 v[136:137], v[136:137], 1.0 op_sel_hi:[1,0]
    v_mfma_f32_4x4x4_16b_bf16 v[108:111], v[146:147], v[78:79], 0 cbsz:4 abid:6
    v_rcp_f32 v136, v136
    v_rcp_f32 v137, v137
    buffer_load_dwordx4 v[72:75], v1, s[12:15], s33 offen
    v_pk_mul_f32 v[128:129], v[136:137], v[120:121]
    s_set_gpr_idx_on s58, 0xc
    v_pk_fma_f32 v[16:17], v[132:133], v[96:97], v[16:17] op_sel:[0,0,0] op_sel_hi:[0,1,1]
    v_pk_fma_f32 v[18:19], v[132:133], v[98:99], v[18:19] op_sel:[0,0,0] op_sel_hi:[0,1,1]
    v_pk_fma_f32 v[20:21], v[134:135], v[100:101], v[20:21] op_sel:[0,0,0] op_sel_hi:[0,1,1]
    v_pk_fma_f32 v[22:23], v[134:135], v[102:103], v[22:23] op_sel:[0,0,0] op_sel_hi:[0,1,1]
    s_set_gpr_idx_off
    s_waitcnt vmcnt(6)
    v_mfma_f32_4x4x4_16b_bf16 v[96:99], v[140:141], v[80:81], 0 cbsz:4 abid:7
    v_readlane_b32 s51, v164, 35
    v_mfma_f32_4x4x4_16b_bf16 v[112:115], v[172:173], v[178:179], v[112:115] cbsz:4 abid:8
    v_exp_f32 v136, v124
    v_exp_f32 v137, v125
    s_and_b32 s33, s51, s34
    v_pk_add_f32 v[136:137], v[136:137], 1.0 op_sel_hi:[1,0]
    v_mfma_f32_4x4x4_16b_bf16 v[100:103], v[140:141], v[82:83], 0 cbsz:4 abid:7
    v_rcp_f32 v136, v136
    v_rcp_f32 v137, v137
    buffer_load_dwordx4 v[76:79], v1, s[12:15], s33 offen
    v_pk_mul_f32 v[130:131], v[136:137], v[124:125]
    s_set_gpr_idx_on s59, 0xc
    v_pk_fma_f32 v[16:17], v[132:133], v[104:105], v[16:17] op_sel:[1,0,0] op_sel_hi:[1,1,1]
    v_pk_fma_f32 v[18:19], v[132:133], v[106:107], v[18:19] op_sel:[1,0,0] op_sel_hi:[1,1,1]
    v_pk_fma_f32 v[20:21], v[134:135], v[108:109], v[20:21] op_sel:[1,0,0] op_sel_hi:[1,1,1]
    v_pk_fma_f32 v[22:23], v[134:135], v[110:111], v[22:23] op_sel:[1,0,0] op_sel_hi:[1,1,1]
    s_set_gpr_idx_off
A_28:
    s_sub_u32 s31, s31, 4
    s_cbranch_scc1 B_28
    s_waitcnt vmcnt(6)
    v_mfma_f32_4x4x4_16b_bf16 v[104:107], v[142:143], v[84:85], 0 cbsz:4 abid:7
    v_readlane_b32 s52, v164, 36
    v_mfma_f32_4x4x4_16b_bf16 v[116:119], v[172:173], v[180:181], 0 cbsz:4 abid:8
    v_exp_f32 v136, v122
    v_exp_f32 v137, v123
    s_and_b32 s33, s52, s34
    v_pk_add_f32 v[136:137], v[136:137], 1.0 op_sel_hi:[1,0]
    v_mfma_f32_4x4x4_16b_bf16 v[108:111], v[142:143], v[86:87], 0 cbsz:4 abid:7
    v_rcp_f32 v136, v136
    v_rcp_f32 v137, v137
    buffer_load_dwordx4 v[80:83], v1, s[12:15], s33 offen
    v_pk_mul_f32 v[132:133], v[136:137], v[122:123]
    s_set_gpr_idx_on s60, 0xc
    v_pk_fma_f32 v[16:17], v[128:129], v[96:97], v[16:17] op_sel:[0,0,0] op_sel_hi:[0,1,1]
    v_pk_fma_f32 v[18:19], v[128:129], v[98:99], v[18:19] op_sel:[0,0,0] op_sel_hi:[0,1,1]
    v_pk_fma_f32 v[20:21], v[130:131], v[100:101], v[20:21] op_sel:[0,0,0] op_sel_hi:[0,1,1]
    v_pk_fma_f32 v[22:23], v[130:131], v[102:103], v[22:23] op_sel:[0,0,0] op_sel_hi:[0,1,1]
    s_set_gpr_idx_off
    s_waitcnt vmcnt(6)
    v_mfma_f32_4x4x4_16b_bf16 v[96:99], v[144:145], v[88:89], 0 cbsz:4 abid:7
    v_readlane_b32 s53, v164, 37
    v_mfma_f32_4x4x4_16b_bf16 v[116:119], v[172:173], v[182:183], v[116:119] cbsz:4 abid:8
    v_exp_f32 v136, v126
    v_exp_f32 v137, v127
    s_and_b32 s33, s53, s34
    v_pk_add_f32 v[136:137], v[136:137], 1.0 op_sel_hi:[1,0]
    v_mfma_f32_4x4x4_16b_bf16 v[100:103], v[144:145], v[90:91], 0 cbsz:4 abid:7
    v_rcp_f32 v136, v136
    v_rcp_f32 v137, v137
    buffer_load_dwordx4 v[84:87], v1, s[12:15], s33 offen
    v_pk_mul_f32 v[134:135], v[136:137], v[126:127]
    s_set_gpr_idx_on s61, 0xc
    v_pk_fma_f32 v[16:17], v[128:129], v[104:105], v[16:17] op_sel:[1,0,0] op_sel_hi:[1,1,1]
    v_pk_fma_f32 v[18:19], v[128:129], v[106:107], v[18:19] op_sel:[1,0,0] op_sel_hi:[1,1,1]
    v_pk_fma_f32 v[20:21], v[130:131], v[108:109], v[20:21] op_sel:[1,0,0] op_sel_hi:[1,1,1]
    v_pk_fma_f32 v[22:23], v[130:131], v[110:111], v[22:23] op_sel:[1,0,0] op_sel_hi:[1,1,1]
    s_set_gpr_idx_off
    s_waitcnt vmcnt(6)
    v_mfma_f32_4x4x4_16b_bf16 v[104:107], v[146:147], v[92:93], 0 cbsz:4 abid:7
    v_readlane_b32 s54, v164, 38
    v_mfma_f32_4x4x4_16b_bf16 v[120:123], v[172:173], v[176:177], 0 cbsz:4 abid:9
    v_exp_f32 v136, v112
    v_exp_f32 v137, v113
    s_and_b32 s33, s54, s34
    v_pk_add_f32 v[136:137], v[136:137], 1.0 op_sel_hi:[1,0]
    v_mfma_f32_4x4x4_16b_bf16 v[108:111], v[146:147], v[94:95], 0 cbsz:4 abid:7
    v_rcp_f32 v136, v136
    v_rcp_f32 v137, v137
    buffer_load_dwordx4 v[88:91], v1, s[12:15], s33 offen
    v_pk_mul_f32 v[128:129], v[136:137], v[112:113]
    s_set_gpr_idx_on s62, 0xc
    v_pk_fma_f32 v[16:17], v[132:133], v[96:97], v[16:17] op_sel:[0,0,0] op_sel_hi:[0,1,1]
    v_pk_fma_f32 v[18:19], v[132:133], v[98:99], v[18:19] op_sel:[0,0,0] op_sel_hi:[0,1,1]
    v_pk_fma_f32 v[20:21], v[134:135], v[100:101], v[20:21] op_sel:[0,0,0] op_sel_hi:[0,1,1]
    v_pk_fma_f32 v[22:23], v[134:135], v[102:103], v[22:23] op_sel:[0,0,0] op_sel_hi:[0,1,1]
    s_set_gpr_idx_off
    s_waitcnt vmcnt(6)
    v_mfma_f32_4x4x4_16b_bf16 v[96:99], v[140:141], v[64:65], 0 cbsz:4 abid:8
    v_readlane_b32 s55, v164, 39
    v_mfma_f32_4x4x4_16b_bf16 v[120:123], v[172:173], v[178:179], v[120:123] cbsz:4 abid:9
    v_exp_f32 v136, v116
    v_exp_f32 v137, v117
    s_and_b32 s33, s55, s34
    v_pk_add_f32 v[136:137], v[136:137], 1.0 op_sel_hi:[1,0]
    v_mfma_f32_4x4x4_16b_bf16 v[100:103], v[140:141], v[66:67], 0 cbsz:4 abid:8
    v_rcp_f32 v136, v136
    v_rcp_f32 v137, v137
    buffer_load_dwordx4 v[92:95], v1, s[12:15], s33 offen
    v_pk_mul_f32 v[130:131], v[136:137], v[116:117]
    s_set_gpr_idx_on s63, 0xc
    v_pk_fma_f32 v[16:17], v[132:133], v[104:105], v[16:17] op_sel:[1,0,0] op_sel_hi:[1,1,1]
    v_pk_fma_f32 v[18:19], v[132:133], v[106:107], v[18:19] op_sel:[1,0,0] op_sel_hi:[1,1,1]
    v_pk_fma_f32 v[20:21], v[134:135], v[108:109], v[20:21] op_sel:[1,0,0] op_sel_hi:[1,1,1]
    v_pk_fma_f32 v[22:23], v[134:135], v[110:111], v[22:23] op_sel:[1,0,0] op_sel_hi:[1,1,1]
    s_set_gpr_idx_off
A_32:
    s_sub_u32 s31, s31, 4
    s_cbranch_scc1 B_32
    s_waitcnt vmcnt(6)
    v_mfma_f32_4x4x4_16b_bf16 v[104:107], v[142:143], v[68:69], 0 cbsz:4 abid:8
    v_readlane_b32 s56, v164, 40
    v_mfma_f32_4x4x4_16b_bf16 v[124:127], v[172:173], v[180:181], 0 cbsz:4 abid:9
    v_exp_f32 v136, v114
    v_exp_f32 v137, v115
    s_and_b32 s33, s56, s34
    v_pk_add_f32 v[136:137], v[136:137], 1.0 op_sel_hi:[1,0]
    v_mfma_f32_4x4x4_16b_bf16 v[108:111], v[142:143], v[70:71], 0 cbsz:4 abid:8
    v_rcp_f32 v136, v136
    v_rcp_f32 v137, v137
    buffer_load_dwordx4 v[64:67], v1, s[12:15], s33 offen
    v_pk_mul_f32 v[132:133], v[136:137], v[114:115]
    s_set_gpr_idx_on s48, 0xc
    v_pk_fma_f32 v[16:17], v[128:129], v[96:97], v[16:17] op_sel:[0,0,0] op_sel_hi:[0,1,1]
    v_pk_fma_f32 v[18:19], v[128:129], v[98:99], v[18:19] op_sel:[0,0,0] op_sel_hi:[0,1,1]
    v_pk_fma_f32 v[20:21], v[130:131], v[100:101], v[20:21] op_sel:[0,0,0] op_sel_hi:[0,1,1]
    v_pk_fma_f32 v[22:23], v[130:131], v[102:103], v[22:23] op_sel:[0,0,0] op_sel_hi:[0,1,1]
    s_set_gpr_idx_off
    s_waitcnt vmcnt(6)
    v_mfma_f32_4x4x4_16b_bf16 v[96:99], v[144:145], v[72:73], 0 cbsz:4 abid:8
    v_readlane_b32 s57, v164, 41
    v_mfma_f32_4x4x4_16b_bf16 v[124:127], v[172:173], v[182:183], v[124:127] cbsz:4 abid:9
    v_exp_f32 v136, v118
    v_exp_f32 v137, v119
    s_and_b32 s33, s57, s34
    v_pk_add_f32 v[136:137], v[136:137], 1.0 op_sel_hi:[1,0]
    v_mfma_f32_4x4x4_16b_bf16 v[100:103], v[144:145], v[74:75], 0 cbsz:4 abid:8
    v_rcp_f32 v136, v136
    v_rcp_f32 v137, v137
    buffer_load_dwordx4 v[68:71], v1, s[12:15], s33 offen
    v_pk_mul_f32 v[134:135], v[136:137], v[118:119]
    s_set_gpr_idx_on s49, 0xc
    v_pk_fma_f32 v[16:17], v[128:129], v[104:105], v[16:17] op_sel:[1,0,0] op_sel_hi:[1,1,1]
    v_pk_fma_f32 v[18:19], v[128:129], v[106:107], v[18:19] op_sel:[1,0,0] op_sel_hi:[1,1,1]
    v_pk_fma_f32 v[20:21], v[130:131], v[108:109], v[20:21] op_sel:[1,0,0] op_sel_hi:[1,1,1]
    v_pk_fma_f32 v[22:23], v[130:131], v[110:111], v[22:23] op_sel:[1,0,0] op_sel_hi:[1,1,1]
    s_set_gpr_idx_off
    s_waitcnt vmcnt(6)
    v_mfma_f32_4x4x4_16b_bf16 v[104:107], v[146:147], v[76:77], 0 cbsz:4 abid:8
    v_readlane_b32 s58, v164, 42
    v_mfma_f32_4x4x4_16b_bf16 v[112:115], v[172:173], v[176:177], 0 cbsz:4 abid:10
    v_exp_f32 v136, v120
    v_exp_f32 v137, v121
    s_and_b32 s33, s58, s34
    v_pk_add_f32 v[136:137], v[136:137], 1.0 op_sel_hi:[1,0]
    v_mfma_f32_4x4x4_16b_bf16 v[108:111], v[146:147], v[78:79], 0 cbsz:4 abid:8
    v_rcp_f32 v136, v136
    v_rcp_f32 v137, v137
    buffer_load_dwordx4 v[72:75], v1, s[12:15], s33 offen
    v_pk_mul_f32 v[128:129], v[136:137], v[120:121]
    s_set_gpr_idx_on s50, 0xc
    v_pk_fma_f32 v[16:17], v[132:133], v[96:97], v[16:17] op_sel:[0,0,0] op_sel_hi:[0,1,1]
    v_pk_fma_f32 v[18:19], v[132:133], v[98:99], v[18:19] op_sel:[0,0,0] op_sel_hi:[0,1,1]
    v_pk_fma_f32 v[20:21], v[134:135], v[100:101], v[20:21] op_sel:[0,0,0] op_sel_hi:[0,1,1]
    v_pk_fma_f32 v[22:23], v[134:135], v[102:103], v[22:23] op_sel:[0,0,0] op_sel_hi:[0,1,1]
    s_set_gpr_idx_off
    s_waitcnt vmcnt(6)
    v_mfma_f32_4x4x4_16b_bf16 v[96:99], v[140:141], v[80:81], 0 cbsz:4 abid:9
    v_readlane_b32 s59, v164, 43
    v_mfma_f32_4x4x4_16b_bf16 v[112:115], v[172:173], v[178:179], v[112:115] cbsz:4 abid:10
    v_exp_f32 v136, v124
    v_exp_f32 v137, v125
    s_and_b32 s33, s59, s34
    v_pk_add_f32 v[136:137], v[136:137], 1.0 op_sel_hi:[1,0]
    v_mfma_f32_4x4x4_16b_bf16 v[100:103], v[140:141], v[82:83], 0 cbsz:4 abid:9
    v_rcp_f32 v136, v136
    v_rcp_f32 v137, v137
    buffer_load_dwordx4 v[76:79], v1, s[12:15], s33 offen
    v_pk_mul_f32 v[130:131], v[136:137], v[124:125]
    s_set_gpr_idx_on s51, 0xc
    v_pk_fma_f32 v[16:17], v[132:133], v[104:105], v[16:17] op_sel:[1,0,0] op_sel_hi:[1,1,1]
    v_pk_fma_f32 v[18:19], v[132:133], v[106:107], v[18:19] op_sel:[1,0,0] op_sel_hi:[1,1,1]
    v_pk_fma_f32 v[20:21], v[134:135], v[108:109], v[20:21] op_sel:[1,0,0] op_sel_hi:[1,1,1]
    v_pk_fma_f32 v[22:23], v[134:135], v[110:111], v[22:23] op_sel:[1,0,0] op_sel_hi:[1,1,1]
    s_set_gpr_idx_off
A_36:
    s_sub_u32 s31, s31, 4
    s_cbranch_scc1 B_36
    s_waitcnt vmcnt(6)
    v_mfma_f32_4x4x4_16b_bf16 v[104:107], v[142:143], v[84:85], 0 cbsz:4 abid:9
    v_readlane_b32 s60, v164, 44
    v_mfma_f32_4x4x4_16b_bf16 v[116:119], v[172:173], v[180:181], 0 cbsz:4 abid:10
    v_exp_f32 v136, v122
    v_exp_f32 v137, v123
    s_and_b32 s33, s60, s34
    v_pk_add_f32 v[136:137], v[136:137], 1.0 op_sel_hi:[1,0]
    v_mfma_f32_4x4x4_16b_bf16 v[108:111], v[142:143], v[86:87], 0 cbsz:4 abid:9
    v_rcp_f32 v136, v136
    v_rcp_f32 v137, v137
    buffer_load_dwordx4 v[80:83], v1, s[12:15], s33 offen
    v_pk_mul_f32 v[132:133], v[136:137], v[122:123]
    s_set_gpr_idx_on s52, 0xc
    v_pk_fma_f32 v[16:17], v[128:129], v[96:97], v[16:17] op_sel:[0,0,0] op_sel_hi:[0,1,1]
    v_pk_fma_f32 v[18:19], v[128:129], v[98:99], v[18:19] op_sel:[0,0,0] op_sel_hi:[0,1,1]
    v_pk_fma_f32 v[20:21], v[130:131], v[100:101], v[20:21] op_sel:[0,0,0] op_sel_hi:[0,1,1]
    v_pk_fma_f32 v[22:23], v[130:131], v[102:103], v[22:23] op_sel:[0,0,0] op_sel_hi:[0,1,1]
    s_set_gpr_idx_off
    s_waitcnt vmcnt(6)
    v_mfma_f32_4x4x4_16b_bf16 v[96:99], v[144:145], v[88:89], 0 cbsz:4 abid:9
    v_readlane_b32 s61, v164, 45
    v_mfma_f32_4x4x4_16b_bf16 v[116:119], v[172:173], v[182:183], v[116:119] cbsz:4 abid:10
    v_exp_f32 v136, v126
    v_exp_f32 v137, v127
    s_and_b32 s33, s61, s34
    v_pk_add_f32 v[136:137], v[136:137], 1.0 op_sel_hi:[1,0]
    v_mfma_f32_4x4x4_16b_bf16 v[100:103], v[144:145], v[90:91], 0 cbsz:4 abid:9
    v_rcp_f32 v136, v136
    v_rcp_f32 v137, v137
    buffer_load_dwordx4 v[84:87], v1, s[12:15], s33 offen
    v_pk_mul_f32 v[134:135], v[136:137], v[126:127]
    s_set_gpr_idx_on s53, 0xc
    v_pk_fma_f32 v[16:17], v[128:129], v[104:105], v[16:17] op_sel:[1,0,0] op_sel_hi:[1,1,1]
    v_pk_fma_f32 v[18:19], v[128:129], v[106:107], v[18:19] op_sel:[1,0,0] op_sel_hi:[1,1,1]
    v_pk_fma_f32 v[20:21], v[130:131], v[108:109], v[20:21] op_sel:[1,0,0] op_sel_hi:[1,1,1]
    v_pk_fma_f32 v[22:23], v[130:131], v[110:111], v[22:23] op_sel:[1,0,0] op_sel_hi:[1,1,1]
    s_set_gpr_idx_off
    s_waitcnt vmcnt(6)
    v_mfma_f32_4x4x4_16b_bf16 v[104:107], v[146:147], v[92:93], 0 cbsz:4 abid:9
    v_readlane_b32 s62, v164, 46
    v_mfma_f32_4x4x4_16b_bf16 v[120:123], v[172:173], v[176:177], 0 cbsz:4 abid:11
    v_exp_f32 v136, v112
    v_exp_f32 v137, v113
    s_and_b32 s33, s62, s34
    v_pk_add_f32 v[136:137], v[136:137], 1.0 op_sel_hi:[1,0]
    v_mfma_f32_4x4x4_16b_bf16 v[108:111], v[146:147], v[94:95], 0 cbsz:4 abid:9
    v_rcp_f32 v136, v136
    v_rcp_f32 v137, v137
    buffer_load_dwordx4 v[88:91], v1, s[12:15], s33 offen
    v_pk_mul_f32 v[128:129], v[136:137], v[112:113]
    s_set_gpr_idx_on s54, 0xc
    v_pk_fma_f32 v[16:17], v[132:133], v[96:97], v[16:17] op_sel:[0,0,0] op_sel_hi:[0,1,1]
    v_pk_fma_f32 v[18:19], v[132:133], v[98:99], v[18:19] op_sel:[0,0,0] op_sel_hi:[0,1,1]
    v_pk_fma_f32 v[20:21], v[134:135], v[100:101], v[20:21] op_sel:[0,0,0] op_sel_hi:[0,1,1]
    v_pk_fma_f32 v[22:23], v[134:135], v[102:103], v[22:23] op_sel:[0,0,0] op_sel_hi:[0,1,1]
    s_set_gpr_idx_off
    s_waitcnt vmcnt(6)
    v_mfma_f32_4x4x4_16b_bf16 v[96:99], v[140:141], v[64:65], 0 cbsz:4 abid:10
    v_readlane_b32 s63, v164, 47
    v_mfma_f32_4x4x4_16b_bf16 v[120:123], v[172:173], v[178:179], v[120:123] cbsz:4 abid:11
    v_exp_f32 v136, v116
    v_exp_f32 v137, v117
    s_and_b32 s33, s63, s34
    v_pk_add_f32 v[136:137], v[136:137], 1.0 op_sel_hi:[1,0]
    v_mfma_f32_4x4x4_16b_bf16 v[100:103], v[140:141], v[66:67], 0 cbsz:4 abid:10
    v_rcp_f32 v136, v136
    v_rcp_f32 v137, v137
    buffer_load_dwordx4 v[92:95], v1, s[12:15], s33 offen
    v_pk_mul_f32 v[130:131], v[136:137], v[116:117]
    s_set_gpr_idx_on s55, 0xc
    v_pk_fma_f32 v[16:17], v[132:133], v[104:105], v[16:17] op_sel:[1,0,0] op_sel_hi:[1,1,1]
    v_pk_fma_f32 v[18:19], v[132:133], v[106:107], v[18:19] op_sel:[1,0,0] op_sel_hi:[1,1,1]
    v_pk_fma_f32 v[20:21], v[134:135], v[108:109], v[20:21] op_sel:[1,0,0] op_sel_hi:[1,1,1]
    v_pk_fma_f32 v[22:23], v[134:135], v[110:111], v[22:23] op_sel:[1,0,0] op_sel_hi:[1,1,1]
    s_set_gpr_idx_off
A_40:
    s_sub_u32 s31, s31, 4
    s_cbranch_scc1 B_40
    s_waitcnt vmcnt(6)
    v_mfma_f32_4x4x4_16b_bf16 v[104:107], v[142:143], v[68:69], 0 cbsz:4 abid:10
    v_readlane_b32 s48, v164, 48
    v_mfma_f32_4x4x4_16b_bf16 v[124:127], v[172:173], v[180:181], 0 cbsz:4 abid:11
    v_exp_f32 v136, v114
    v_exp_f32 v137, v115
    s_and_b32 s33, s48, s34
    v_pk_add_f32 v[136:137], v[136:137], 1.0 op_sel_hi:[1,0]
    v_mfma_f32_4x4x4_16b_bf16 v[108:111], v[142:143], v[70:71], 0 cbsz:4 abid:10
    v_mfma_f32_4x4x4_16b_bf16 v[148:151], v[168:169], v[184:185], 0
    v_rcp_f32 v136, v136
    v_rcp_f32 v137, v137
    buffer_load_dwordx4 v[64:67], v1, s[12:15], s33 offen
    v_pk_mul_f32 v[132:133], v[136:137], v[114:115]
    s_set_gpr_idx_on s56, 0xc
    v_pk_fma_f32 v[16:17], v[128:129], v[96:97], v[16:17] op_sel:[0,0,0] op_sel_hi:[0,1,1]
    v_pk_fma_f32 v[18:19], v[128:129], v[98:99], v[18:19] op_sel:[0,0,0] op_sel_hi:[0,1,1]
    v_pk_fma_f32 v[20:21], v[130:131], v[100:101], v[20:21] op_sel:[0,0,0] op_sel_hi:[0,1,1]
    v_pk_fma_f32 v[22:23], v[130:131], v[102:103], v[22:23] op_sel:[0,0,0] op_sel_hi:[0,1,1]
    s_set_gpr_idx_off
    s_waitcnt vmcnt(6)
    v_mfma_f32_4x4x4_16b_bf16 v[96:99], v[144:145], v[72:73], 0 cbsz:4 abid:10
    v_readlane_b32 s49, v164, 49
    v_mfma_f32_4x4x4_16b_bf16 v[124:127], v[172:173], v[182:183], v[124:127] cbsz:4 abid:11
    v_exp_f32 v136, v118
    v_exp_f32 v137, v119
    s_and_b32 s33, s49, s34
    v_pk_add_f32 v[136:137], v[136:137], 1.0 op_sel_hi:[1,0]
    v_mfma_f32_4x4x4_16b_bf16 v[100:103], v[144:145], v[74:75], 0 cbsz:4 abid:10
    v_mfma_f32_4x4x4_16b_bf16 v[152:155], v[168:169], v[186:187], 0
    v_rcp_f32 v136, v136
    v_rcp_f32 v137, v137
    buffer_load_dwordx4 v[68:71], v1, s[12:15], s33 offen
    v_pk_mul_f32 v[134:135], v[136:137], v[118:119]
    s_set_gpr_idx_on s57, 0xc
    v_pk_fma_f32 v[16:17], v[128:129], v[104:105], v[16:17] op_sel:[1,0,0] op_sel_hi:[1,1,1]
    v_pk_fma_f32 v[18:19], v[128:129], v[106:107], v[18:19] op_sel:[1,0,0] op_sel_hi:[1,1,1]
    v_pk_fma_f32 v[20:21], v[130:131], v[108:109], v[20:21] op_sel:[1,0,0] op_sel_hi:[1,1,1]
    v_pk_fma_f32 v[22:23], v[130:131], v[110:111], v[22:23] op_sel:[1,0,0] op_sel_hi:[1,1,1]
    s_set_gpr_idx_off
    s_waitcnt vmcnt(6)
    v_mfma_f32_4x4x4_16b_bf16 v[104:107], v[146:147], v[76:77], 0 cbsz:4 abid:10
    v_readlane_b32 s50, v164, 50
    v_mfma_f32_4x4x4_16b_bf16 v[112:115], v[172:173], v[176:177], 0 cbsz:4 abid:12
    v_exp_f32 v136, v120
    v_exp_f32 v137, v121
    s_and_b32 s33, s50, s34
    v_pk_add_f32 v[136:137], v[136:137], 1.0 op_sel_hi:[1,0]
    v_mfma_f32_4x4x4_16b_bf16 v[108:111], v[146:147], v[78:79], 0 cbsz:4 abid:10
    v_mfma_f32_4x4x4_16b_bf16 v[156:159], v[168:169], v[188:189], 0
    v_rcp_f32 v136, v136
    v_rcp_f32 v137, v137
    buffer_load_dwordx4 v[72:75], v1, s[12:15], s33 offen
    v_pk_mul_f32 v[128:129], v[136:137], v[120:121]
    s_set_gpr_idx_on s58, 0xc
    v_pk_fma_f32 v[16:17], v[132:133], v[96:97], v[16:17] op_sel:[0,0,0] op_sel_hi:[0,1,1]
    v_pk_fma_f32 v[18:19], v[132:133], v[98:99], v[18:19] op_sel:[0,0,0] op_sel_hi:[0,1,1]
    v_pk_fma_f32 v[20:21], v[134:135], v[100:101], v[20:21] op_sel:[0,0,0] op_sel_hi:[0,1,1]
    v_pk_fma_f32 v[22:23], v[134:135], v[102:103], v[22:23] op_sel:[0,0,0] op_sel_hi:[0,1,1]
    s_set_gpr_idx_off
    s_waitcnt vmcnt(6)
    v_mfma_f32_4x4x4_16b_bf16 v[96:99], v[140:141], v[80:81], 0 cbsz:4 abid:11
    v_readlane_b32 s51, v164, 51
    v_mfma_f32_4x4x4_16b_bf16 v[112:115], v[172:173], v[178:179], v[112:115] cbsz:4 abid:12
    v_exp_f32 v136, v124
    v_exp_f32 v137, v125
    s_and_b32 s33, s51, s34
    v_pk_add_f32 v[136:137], v[136:137], 1.0 op_sel_hi:[1,0]
    v_mfma_f32_4x4x4_16b_bf16 v[100:103], v[140:141], v[82:83], 0 cbsz:4 abid:11
    v_mfma_f32_4x4x4_16b_bf16 v[160:163], v[168:169], v[190:191], 0
    v_rcp_f32 v136, v136
    v_rcp_f32 v137, v137
    buffer_load_dwordx4 v[76:79], v1, s[12:15], s33 offen
    v_pk_mul_f32 v[130:131], v[136:137], v[124:125]
    s_set_gpr_idx_on s59, 0xc
    v_pk_fma_f32 v[16:17], v[132:133], v[104:105], v[16:17] op_sel:[1,0,0] op_sel_hi:[1,1,1]
    v_pk_fma_f32 v[18:19], v[132:133], v[106:107], v[18:19] op_sel:[1,0,0] op_sel_hi:[1,1,1]
    v_pk_fma_f32 v[20:21], v[134:135], v[108:109], v[20:21] op_sel:[1,0,0] op_sel_hi:[1,1,1]
    v_pk_fma_f32 v[22:23], v[134:135], v[110:111], v[22:23] op_sel:[1,0,0] op_sel_hi:[1,1,1]
    s_set_gpr_idx_off
A_44:
    s_sub_u32 s31, s31, 4
    s_cbranch_scc1 B_44
    s_waitcnt vmcnt(6)
    v_mfma_f32_4x4x4_16b_bf16 v[104:107], v[142:143], v[84:85], 0 cbsz:4 abid:11
    v_readlane_b32 s52, v164, 52
    v_mfma_f32_4x4x4_16b_bf16 v[116:119], v[172:173], v[180:181], 0 cbsz:4 abid:12
    v_exp_f32 v136, v122
    v_exp_f32 v137, v123
    s_and_b32 s33, s52, s34
    v_pk_add_f32 v[136:137], v[136:137], 1.0 op_sel_hi:[1,0]
    v_mfma_f32_4x4x4_16b_bf16 v[108:111], v[142:143], v[86:87], 0 cbsz:4 abid:11
    v_rcp_f32 v136, v136
    v_rcp_f32 v137, v137
    buffer_load_dwordx4 v[80:83], v1, s[12:15], s33 offen
    v_pk_mul_f32 v[132:133], v[136:137], v[122:123]
    s_set_gpr_idx_on s60, 0xc
    v_pk_fma_f32 v[16:17], v[128:129], v[96:97], v[16:17] op_sel:[0,0,0] op_sel_hi:[0,1,1]
    v_pk_fma_f32 v[18:19], v[128:129], v[98:99], v[18:19] op_sel:[0,0,0] op_sel_hi:[0,1,1]
    v_pk_fma_f32 v[20:21], v[130:131], v[100:101], v[20:21] op_sel:[0,0,0] op_sel_hi:[0,1,1]
    v_pk_fma_f32 v[22:23], v[130:131], v[102:103], v[22:23] op_sel:[0,0,0] op_sel_hi:[0,1,1]
    s_set_gpr_idx_off
    s_waitcnt vmcnt(6)
    v_mfma_f32_4x4x4_16b_bf16 v[96:99], v[144:145], v[88:89], 0 cbsz:4 abid:11
    v_readlane_b32 s53, v164, 53
    v_mfma_f32_4x4x4_16b_bf16 v[116:119], v[172:173], v[182:183], v[116:119] cbsz:4 abid:12
    v_exp_f32 v136, v126
    v_exp_f32 v137, v127
    s_and_b32 s33, s53, s34
    v_pk_add_f32 v[136:137], v[136:137], 1.0 op_sel_hi:[1,0]
    v_mfma_f32_4x4x4_16b_bf16 v[100:103], v[144:145], v[90:91], 0 cbsz:4 abid:11
    v_rcp_f32 v136, v136
    v_rcp_f32 v137, v137
    buffer_load_dwordx4 v[84:87], v1, s[12:15], s33 offen
    v_pk_mul_f32 v[134:135], v[136:137], v[126:127]
    s_set_gpr_idx_on s61, 0xc
    v_pk_fma_f32 v[16:17], v[128:129], v[104:105], v[16:17] op_sel:[1,0,0] op_sel_hi:[1,1,1]
    v_pk_fma_f32 v[18:19], v[128:129], v[106:107], v[18:19] op_sel:[1,0,0] op_sel_hi:[1,1,1]
    v_pk_fma_f32 v[20:21], v[130:131], v[108:109], v[20:21] op_sel:[1,0,0] op_sel_hi:[1,1,1]
    v_pk_fma_f32 v[22:23], v[130:131], v[110:111], v[22:23] op_sel:[1,0,0] op_sel_hi:[1,1,1]
    s_set_gpr_idx_off
    s_waitcnt vmcnt(6)
    v_mfma_f32_4x4x4_16b_bf16 v[104:107], v[146:147], v[92:93], 0 cbsz:4 abid:11
    v_readlane_b32 s54, v164, 54
    v_mfma_f32_4x4x4_16b_bf16 v[120:123], v[172:173], v[176:177], 0 cbsz:4 abid:13
    v_exp_f32 v136, v112
    v_exp_f32 v137, v113
    s_and_b32 s33, s54, s34
    v_pk_add_f32 v[136:137], v[136:137], 1.0 op_sel_hi:[1,0]
    v_mfma_f32_4x4x4_16b_bf16 v[108:111], v[146:147], v[94:95], 0 cbsz:4 abid:11
    v_rcp_f32 v136, v136
    v_rcp_f32 v137, v137
    buffer_load_dwordx4 v[88:91], v1, s[12:15], s33 offen
    v_pk_mul_f32 v[128:129], v[136:137], v[112:113]
    s_set_gpr_idx_on s62, 0xc
    v_pk_fma_f32 v[16:17], v[132:133], v[96:97], v[16:17] op_sel:[0,0,0] op_sel_hi:[0,1,1]
    v_pk_fma_f32 v[18:19], v[132:133], v[98:99], v[18:19] op_sel:[0,0,0] op_sel_hi:[0,1,1]
    v_pk_fma_f32 v[20:21], v[134:135], v[100:101], v[20:21] op_sel:[0,0,0] op_sel_hi:[0,1,1]
    v_pk_fma_f32 v[22:23], v[134:135], v[102:103], v[22:23] op_sel:[0,0,0] op_sel_hi:[0,1,1]
    s_set_gpr_idx_off
    s_waitcnt vmcnt(6)
    v_mfma_f32_4x4x4_16b_bf16 v[96:99], v[140:141], v[64:65], 0 cbsz:4 abid:12
    v_readlane_b32 s55, v164, 55
    v_mfma_f32_4x4x4_16b_bf16 v[120:123], v[172:173], v[178:179], v[120:123] cbsz:4 abid:13
    v_exp_f32 v136, v116
    v_exp_f32 v137, v117
    s_and_b32 s33, s55, s34
    v_pk_add_f32 v[136:137], v[136:137], 1.0 op_sel_hi:[1,0]
    v_mfma_f32_4x4x4_16b_bf16 v[100:103], v[140:141], v[66:67], 0 cbsz:4 abid:12
    v_rcp_f32 v136, v136
    v_rcp_f32 v137, v137
    buffer_load_dwordx4 v[92:95], v1, s[12:15], s33 offen
    v_pk_mul_f32 v[130:131], v[136:137], v[116:117]
    s_set_gpr_idx_on s63, 0xc
    v_pk_fma_f32 v[16:17], v[132:133], v[104:105], v[16:17] op_sel:[1,0,0] op_sel_hi:[1,1,1]
    v_pk_fma_f32 v[18:19], v[132:133], v[106:107], v[18:19] op_sel:[1,0,0] op_sel_hi:[1,1,1]
    v_pk_fma_f32 v[20:21], v[134:135], v[108:109], v[20:21] op_sel:[1,0,0] op_sel_hi:[1,1,1]
    v_pk_fma_f32 v[22:23], v[134:135], v[110:111], v[22:23] op_sel:[1,0,0] op_sel_hi:[1,1,1]
    s_set_gpr_idx_off
A_48:
    s_sub_u32 s31, s31, 4
    s_cbranch_scc1 B_48
    s_waitcnt vmcnt(6)
    v_mfma_f32_4x4x4_16b_bf16 v[104:107], v[142:143], v[68:69], 0 cbsz:4 abid:12
    v_readlane_b32 s56, v164, 56
    v_mfma_f32_4x4x4_16b_bf16 v[124:127], v[172:173], v[180:181], 0 cbsz:4 abid:13
    v_exp_f32 v136, v114
    v_exp_f32 v137, v115
    s_and_b32 s33, s56, s34
    v_pk_add_f32 v[136:137], v[136:137], 1.0 op_sel_hi:[1,0]
    v_mfma_f32_4x4x4_16b_bf16 v[108:111], v[142:143], v[70:71], 0 cbsz:4 abid:12
    v_rcp_f32 v136, v136
    v_rcp_f32 v137, v137
    buffer_load_dwordx4 v[64:67], v1, s[12:15], s33 offen
    v_pk_mul_f32 v[132:133], v[136:137], v[114:115]
    s_set_gpr_idx_on s48, 0xc
    v_pk_fma_f32 v[16:17], v[128:129], v[96:97], v[16:17] op_sel:[0,0,0] op_sel_hi:[0,1,1]
    v_pk_fma_f32 v[18:19], v[128:129], v[98:99], v[18:19] op_sel:[0,0,0] op_sel_hi:[0,1,1]
    v_pk_fma_f32 v[20:21], v[130:131], v[100:101], v[20:21] op_sel:[0,0,0] op_sel_hi:[0,1,1]
    v_pk_fma_f32 v[22:23], v[130:131], v[102:103], v[22:23] op_sel:[0,0,0] op_sel_hi:[0,1,1]
    s_set_gpr_idx_off
    s_waitcnt vmcnt(6)
    v_mfma_f32_4x4x4_16b_bf16 v[96:99], v[144:145], v[72:73], 0 cbsz:4 abid:12
    v_readlane_b32 s57, v164, 57
    v_mfma_f32_4x4x4_16b_bf16 v[124:127], v[172:173], v[182:183], v[124:127] cbsz:4 abid:13
    v_exp_f32 v136, v118
    v_exp_f32 v137, v119
    s_and_b32 s33, s57, s34
    v_pk_add_f32 v[136:137], v[136:137], 1.0 op_sel_hi:[1,0]
    v_mfma_f32_4x4x4_16b_bf16 v[100:103], v[144:145], v[74:75], 0 cbsz:4 abid:12
    v_rcp_f32 v136, v136
    v_rcp_f32 v137, v137
    buffer_load_dwordx4 v[68:71], v1, s[12:15], s33 offen
    v_pk_mul_f32 v[134:135], v[136:137], v[118:119]
    s_set_gpr_idx_on s49, 0xc
    v_pk_fma_f32 v[16:17], v[128:129], v[104:105], v[16:17] op_sel:[1,0,0] op_sel_hi:[1,1,1]
    v_pk_fma_f32 v[18:19], v[128:129], v[106:107], v[18:19] op_sel:[1,0,0] op_sel_hi:[1,1,1]
    v_pk_fma_f32 v[20:21], v[130:131], v[108:109], v[20:21] op_sel:[1,0,0] op_sel_hi:[1,1,1]
    v_pk_fma_f32 v[22:23], v[130:131], v[110:111], v[22:23] op_sel:[1,0,0] op_sel_hi:[1,1,1]
    s_set_gpr_idx_off
    s_waitcnt vmcnt(6)
    v_mfma_f32_4x4x4_16b_bf16 v[104:107], v[146:147], v[76:77], 0 cbsz:4 abid:12
    v_readlane_b32 s58, v164, 58
    v_mfma_f32_4x4x4_16b_bf16 v[112:115], v[172:173], v[176:177], 0 cbsz:4 abid:14
    v_exp_f32 v136, v120
    v_exp_f32 v137, v121
    s_and_b32 s33, s58, s34
    v_pk_add_f32 v[136:137], v[136:137], 1.0 op_sel_hi:[1,0]
    v_mfma_f32_4x4x4_16b_bf16 v[108:111], v[146:147], v[78:79], 0 cbsz:4 abid:12
    v_rcp_f32 v136, v136
    v_rcp_f32 v137, v137
    buffer_load_dwordx4 v[72:75], v1, s[12:15], s33 offen
    v_pk_mul_f32 v[128:129], v[136:137], v[120:121]
    s_set_gpr_idx_on s50, 0xc
    v_pk_fma_f32 v[16:17], v[132:133], v[96:97], v[16:17] op_sel:[0,0,0] op_sel_hi:[0,1,1]
    v_pk_fma_f32 v[18:19], v[132:133], v[98:99], v[18:19] op_sel:[0,0,0] op_sel_hi:[0,1,1]
    v_pk_fma_f32 v[20:21], v[134:135], v[100:101], v[20:21] op_sel:[0,0,0] op_sel_hi:[0,1,1]
    v_pk_fma_f32 v[22:23], v[134:135], v[102:103], v[22:23] op_sel:[0,0,0] op_sel_hi:[0,1,1]
    s_set_gpr_idx_off
    s_waitcnt vmcnt(6)
    v_mfma_f32_4x4x4_16b_bf16 v[96:99], v[140:141], v[80:81], 0 cbsz:4 abid:13
    v_readlane_b32 s59, v164, 59
    v_mfma_f32_4x4x4_16b_bf16 v[112:115], v[172:173], v[178:179], v[112:115] cbsz:4 abid:14
    v_exp_f32 v136, v124
    v_exp_f32 v137, v125
    s_and_b32 s33, s59, s34
    v_pk_add_f32 v[136:137], v[136:137], 1.0 op_sel_hi:[1,0]
    v_mfma_f32_4x4x4_16b_bf16 v[100:103], v[140:141], v[82:83], 0 cbsz:4 abid:13
    v_rcp_f32 v136, v136
    v_rcp_f32 v137, v137
    buffer_load_dwordx4 v[76:79], v1, s[12:15], s33 offen
    v_pk_mul_f32 v[130:131], v[136:137], v[124:125]
    s_set_gpr_idx_on s51, 0xc
    v_pk_fma_f32 v[16:17], v[132:133], v[104:105], v[16:17] op_sel:[1,0,0] op_sel_hi:[1,1,1]
    v_pk_fma_f32 v[18:19], v[132:133], v[106:107], v[18:19] op_sel:[1,0,0] op_sel_hi:[1,1,1]
    v_pk_fma_f32 v[20:21], v[134:135], v[108:109], v[20:21] op_sel:[1,0,0] op_sel_hi:[1,1,1]
    v_pk_fma_f32 v[22:23], v[134:135], v[110:111], v[22:23] op_sel:[1,0,0] op_sel_hi:[1,1,1]
    s_set_gpr_idx_off
A_52:
    s_sub_u32 s31, s31, 4
    s_cbranch_scc1 B_52
    s_waitcnt vmcnt(6)
    v_mfma_f32_4x4x4_16b_bf16 v[104:107], v[142:143], v[84:85], 0 cbsz:4 abid:13
    v_readlane_b32 s60, v164, 60
    v_mfma_f32_4x4x4_16b_bf16 v[116:119], v[172:173], v[180:181], 0 cbsz:4 abid:14
    v_exp_f32 v136, v122
    v_exp_f32 v137, v123
    s_and_b32 s33, s60, s34
    v_pk_add_f32 v[136:137], v[136:137], 1.0 op_sel_hi:[1,0]
    v_mfma_f32_4x4x4_16b_bf16 v[108:111], v[142:143], v[86:87], 0 cbsz:4 abid:13
    v_rcp_f32 v136, v136
    v_rcp_f32 v137, v137
    buffer_load_dwordx4 v[80:83], v1, s[12:15], s33 offen
    v_pk_mul_f32 v[132:133], v[136:137], v[122:123]
    s_set_gpr_idx_on s52, 0xc
    v_pk_fma_f32 v[16:17], v[128:129], v[96:97], v[16:17] op_sel:[0,0,0] op_sel_hi:[0,1,1]
    v_pk_fma_f32 v[18:19], v[128:129], v[98:99], v[18:19] op_sel:[0,0,0] op_sel_hi:[0,1,1]
    v_pk_fma_f32 v[20:21], v[130:131], v[100:101], v[20:21] op_sel:[0,0,0] op_sel_hi:[0,1,1]
    v_pk_fma_f32 v[22:23], v[130:131], v[102:103], v[22:23] op_sel:[0,0,0] op_sel_hi:[0,1,1]
    s_set_gpr_idx_off
    s_waitcnt vmcnt(6)
    v_mfma_f32_4x4x4_16b_bf16 v[96:99], v[144:145], v[88:89], 0 cbsz:4 abid:13
    v_readlane_b32 s61, v164, 61
    v_mfma_f32_4x4x4_16b_bf16 v[116:119], v[172:173], v[182:183], v[116:119] cbsz:4 abid:14
    v_exp_f32 v136, v126
    v_exp_f32 v137, v127
    s_and_b32 s33, s61, s34
    v_pk_add_f32 v[136:137], v[136:137], 1.0 op_sel_hi:[1,0]
    v_mfma_f32_4x4x4_16b_bf16 v[100:103], v[144:145], v[90:91], 0 cbsz:4 abid:13
    v_rcp_f32 v136, v136
    v_rcp_f32 v137, v137
    buffer_load_dwordx4 v[84:87], v1, s[12:15], s33 offen
    v_pk_mul_f32 v[134:135], v[136:137], v[126:127]
    s_set_gpr_idx_on s53, 0xc
    v_pk_fma_f32 v[16:17], v[128:129], v[104:105], v[16:17] op_sel:[1,0,0] op_sel_hi:[1,1,1]
    v_pk_fma_f32 v[18:19], v[128:129], v[106:107], v[18:19] op_sel:[1,0,0] op_sel_hi:[1,1,1]
    v_pk_fma_f32 v[20:21], v[130:131], v[108:109], v[20:21] op_sel:[1,0,0] op_sel_hi:[1,1,1]
    v_pk_fma_f32 v[22:23], v[130:131], v[110:111], v[22:23] op_sel:[1,0,0] op_sel_hi:[1,1,1]
    s_set_gpr_idx_off
    s_waitcnt vmcnt(6)
    v_mfma_f32_4x4x4_16b_bf16 v[104:107], v[146:147], v[92:93], 0 cbsz:4 abid:13
    v_readlane_b32 s62, v164, 62
    v_mfma_f32_4x4x4_16b_bf16 v[120:123], v[172:173], v[176:177], 0 cbsz:4 abid:15
    v_exp_f32 v136, v112
    v_exp_f32 v137, v113
    s_and_b32 s33, s62, s34
    v_pk_add_f32 v[136:137], v[136:137], 1.0 op_sel_hi:[1,0]
    v_mfma_f32_4x4x4_16b_bf16 v[108:111], v[146:147], v[94:95], 0 cbsz:4 abid:13
    v_rcp_f32 v136, v136
    v_rcp_f32 v137, v137
    buffer_load_dwordx4 v[88:91], v1, s[12:15], s33 offen
    v_pk_mul_f32 v[128:129], v[136:137], v[112:113]
    s_set_gpr_idx_on s54, 0xc
    v_pk_fma_f32 v[16:17], v[132:133], v[96:97], v[16:17] op_sel:[0,0,0] op_sel_hi:[0,1,1]
    v_pk_fma_f32 v[18:19], v[132:133], v[98:99], v[18:19] op_sel:[0,0,0] op_sel_hi:[0,1,1]
    v_pk_fma_f32 v[20:21], v[134:135], v[100:101], v[20:21] op_sel:[0,0,0] op_sel_hi:[0,1,1]
    v_pk_fma_f32 v[22:23], v[134:135], v[102:103], v[22:23] op_sel:[0,0,0] op_sel_hi:[0,1,1]
    s_set_gpr_idx_off
    s_waitcnt vmcnt(6)
    v_mfma_f32_4x4x4_16b_bf16 v[96:99], v[140:141], v[64:65], 0 cbsz:4 abid:14
    v_readlane_b32 s63, v164, 63
    v_mfma_f32_4x4x4_16b_bf16 v[120:123], v[172:173], v[178:179], v[120:123] cbsz:4 abid:15
    v_exp_f32 v136, v116
    v_exp_f32 v137, v117
    s_and_b32 s33, s63, s34
    v_pk_add_f32 v[136:137], v[136:137], 1.0 op_sel_hi:[1,0]
    v_mfma_f32_4x4x4_16b_bf16 v[100:103], v[140:141], v[66:67], 0 cbsz:4 abid:14
    v_rcp_f32 v136, v136
    v_rcp_f32 v137, v137
    buffer_load_dwordx4 v[92:95], v1, s[12:15], s33 offen
    v_pk_mul_f32 v[130:131], v[136:137], v[116:117]
    s_set_gpr_idx_on s55, 0xc
    v_pk_fma_f32 v[16:17], v[132:133], v[104:105], v[16:17] op_sel:[1,0,0] op_sel_hi:[1,1,1]
    v_pk_fma_f32 v[18:19], v[132:133], v[106:107], v[18:19] op_sel:[1,0,0] op_sel_hi:[1,1,1]
    v_pk_fma_f32 v[20:21], v[134:135], v[108:109], v[20:21] op_sel:[1,0,0] op_sel_hi:[1,1,1]
    v_pk_fma_f32 v[22:23], v[134:135], v[110:111], v[22:23] op_sel:[1,0,0] op_sel_hi:[1,1,1]
    s_set_gpr_idx_off
A_56:
    s_sub_u32 s31, s31, 4
    s_cbranch_scc1 B_56
    s_waitcnt vmcnt(6)
    v_mfma_f32_4x4x4_16b_bf16 v[104:107], v[142:143], v[68:69], 0 cbsz:4 abid:14
    v_readlane_b32 s48, v166, 0
    v_mfma_f32_4x4x4_16b_bf16 v[124:127], v[172:173], v[180:181], 0 cbsz:4 abid:15
    v_exp_f32 v136, v114
    v_exp_f32 v137, v115
    s_and_b32 s33, s48, s34
    v_pk_add_f32 v[136:137], v[136:137], 1.0 op_sel_hi:[1,0]
    v_mfma_f32_4x4x4_16b_bf16 v[108:111], v[142:143], v[70:71], 0 cbsz:4 abid:14
    v_rcp_f32 v136, v136
    v_rcp_f32 v137, v137
    buffer_load_dwordx4 v[64:67], v1, s[12:15], s33 offen
    v_pk_mul_f32 v[132:133], v[136:137], v[114:115]
    s_set_gpr_idx_on s56, 0xc
    v_pk_fma_f32 v[16:17], v[128:129], v[96:97], v[16:17] op_sel:[0,0,0] op_sel_hi:[0,1,1]
    v_pk_fma_f32 v[18:19], v[128:129], v[98:99], v[18:19] op_sel:[0,0,0] op_sel_hi:[0,1,1]
    v_pk_fma_f32 v[20:21], v[130:131], v[100:101], v[20:21] op_sel:[0,0,0] op_sel_hi:[0,1,1]
    v_pk_fma_f32 v[22:23], v[130:131], v[102:103], v[22:23] op_sel:[0,0,0] op_sel_hi:[0,1,1]
    s_set_gpr_idx_off
    s_waitcnt vmcnt(6)
    v_mfma_f32_4x4x4_16b_bf16 v[96:99], v[144:145], v[72:73], 0 cbsz:4 abid:14
    v_readlane_b32 s49, v166, 1
    v_mfma_f32_4x4x4_16b_bf16 v[124:127], v[172:173], v[182:183], v[124:127] cbsz:4 abid:15
    v_exp_f32 v136, v118
    v_exp_f32 v137, v119
    s_and_b32 s33, s49, s34
    v_pk_add_f32 v[136:137], v[136:137], 1.0 op_sel_hi:[1,0]
    v_mfma_f32_4x4x4_16b_bf16 v[100:103], v[144:145], v[74:75], 0 cbsz:4 abid:14
    v_rcp_f32 v136, v136
    v_rcp_f32 v137, v137
    buffer_load_dwordx4 v[68:71], v1, s[12:15], s33 offen
    v_pk_mul_f32 v[134:135], v[136:137], v[118:119]
    s_set_gpr_idx_on s57, 0xc
    v_pk_fma_f32 v[16:17], v[128:129], v[104:105], v[16:17] op_sel:[1,0,0] op_sel_hi:[1,1,1]
    v_pk_fma_f32 v[18:19], v[128:129], v[106:107], v[18:19] op_sel:[1,0,0] op_sel_hi:[1,1,1]
    v_pk_fma_f32 v[20:21], v[130:131], v[108:109], v[20:21] op_sel:[1,0,0] op_sel_hi:[1,1,1]
    v_pk_fma_f32 v[22:23], v[130:131], v[110:111], v[22:23] op_sel:[1,0,0] op_sel_hi:[1,1,1]
    s_set_gpr_idx_off
    v_mov_b32 v172, v170
    v_mov_b32 v173, v171
    s_waitcnt vmcnt(6)
    v_mfma_f32_4x4x4_16b_bf16 v[104:107], v[146:147], v[76:77], 0 cbsz:4 abid:14
    v_readlane_b32 s50, v166, 2
    v_mfma_f32_4x4x4_16b_bf16 v[112:115], v[172:173], v[176:177], 0 cbsz:4 abid:0
    v_exp_f32 v136, v120
    v_exp_f32 v137, v121
    s_and_b32 s33, s50, s34
    v_pk_add_f32 v[136:137], v[136:137], 1.0 op_sel_hi:[1,0]
    v_mfma_f32_4x4x4_16b_bf16 v[108:111], v[146:147], v[78:79], 0 cbsz:4 abid:14
    v_rcp_f32 v136, v136
    v_rcp_f32 v137, v137
    buffer_load_dwordx4 v[72:75], v1, s[12:15], s33 offen
    v_pk_mul_f32 v[128:129], v[136:137], v[120:121]
    s_set_gpr_idx_on s58, 0xc
    v_pk_fma_f32 v[16:17], v[132:133], v[96:97], v[16:17] op_sel:[0,0,0] op_sel_hi:[0,1,1]
    v_pk_fma_f32 v[18:19], v[132:133], v[98:99], v[18:19] op_sel:[0,0,0] op_sel_hi:[0,1,1]
    v_pk_fma_f32 v[20:21], v[134:135], v[100:101], v[20:21] op_sel:[0,0,0] op_sel_hi:[0,1,1]
    v_pk_fma_f32 v[22:23], v[134:135], v[102:103], v[22:23] op_sel:[0,0,0] op_sel_hi:[0,1,1]
    s_set_gpr_idx_off
    s_waitcnt vmcnt(6)
    v_mfma_f32_4x4x4_16b_bf16 v[96:99], v[140:141], v[80:81], 0 cbsz:4 abid:15
    v_readlane_b32 s51, v166, 3
    v_mfma_f32_4x4x4_16b_bf16 v[112:115], v[172:173], v[178:179], v[112:115] cbsz:4 abid:0
    v_exp_f32 v136, v124
    v_exp_f32 v137, v125
    s_and_b32 s33, s51, s34
    v_pk_add_f32 v[136:137], v[136:137], 1.0 op_sel_hi:[1,0]
    v_mfma_f32_4x4x4_16b_bf16 v[100:103], v[140:141], v[82:83], 0 cbsz:4 abid:15
    v_rcp_f32 v136, v136
    v_rcp_f32 v137, v137
    buffer_load_dwordx4 v[76:79], v1, s[12:15], s33 offen
    v_pk_mul_f32 v[130:131], v[136:137], v[124:125]
    s_set_gpr_idx_on s59, 0xc
    v_pk_fma_f32 v[16:17], v[132:133], v[104:105], v[16:17] op_sel:[1,0,0] op_sel_hi:[1,1,1]
    v_pk_fma_f32 v[18:19], v[132:133], v[106:107], v[18:19] op_sel:[1,0,0] op_sel_hi:[1,1,1]
    v_pk_fma_f32 v[20:21], v[134:135], v[108:109], v[20:21] op_sel:[1,0,0] op_sel_hi:[1,1,1]
    v_pk_fma_f32 v[22:23], v[134:135], v[110:111], v[22:23] op_sel:[1,0,0] op_sel_hi:[1,1,1]
    s_set_gpr_idx_off
A_60:
    s_sub_u32 s31, s31, 4
    s_cbranch_scc1 B_60
    s_waitcnt vmcnt(6)
    v_mfma_f32_4x4x4_16b_bf16 v[104:107], v[142:143], v[84:85], 0 cbsz:4 abid:15
    v_readlane_b32 s52, v166, 4
    v_mfma_f32_4x4x4_16b_bf16 v[116:119], v[172:173], v[180:181], 0 cbsz:4 abid:0
    v_exp_f32 v136, v122
    v_exp_f32 v137, v123
    s_and_b32 s33, s52, s34
    v_pk_add_f32 v[136:137], v[136:137], 1.0 op_sel_hi:[1,0]
    v_mfma_f32_4x4x4_16b_bf16 v[108:111], v[142:143], v[86:87], 0 cbsz:4 abid:15
    v_rcp_f32 v136, v136
    v_rcp_f32 v137, v137
    buffer_load_dwordx4 v[80:83], v1, s[12:15], s33 offen
    v_pk_mul_f32 v[132:133], v[136:137], v[122:123]
    s_set_gpr_idx_on s60, 0xc
    v_pk_fma_f32 v[16:17], v[128:129], v[96:97], v[16:17] op_sel:[0,0,0] op_sel_hi:[0,1,1]
    v_pk_fma_f32 v[18:19], v[128:129], v[98:99], v[18:19] op_sel:[0,0,0] op_sel_hi:[0,1,1]
    v_pk_fma_f32 v[20:21], v[130:131], v[100:101], v[20:21] op_sel:[0,0,0] op_sel_hi:[0,1,1]
    v_pk_fma_f32 v[22:23], v[130:131], v[102:103], v[22:23] op_sel:[0,0,0] op_sel_hi:[0,1,1]
    s_set_gpr_idx_off
    v_cvt_pk_bf16_f32 v140, v148, v152
    v_cvt_pk_bf16_f32 v141, v156, v160
    s_waitcnt vmcnt(6)
    v_mfma_f32_4x4x4_16b_bf16 v[96:99], v[144:145], v[88:89], 0 cbsz:4 abid:15
    v_readlane_b32 s53, v166, 5
    v_mfma_f32_4x4x4_16b_bf16 v[116:119], v[172:173], v[182:183], v[116:119] cbsz:4 abid:0
    v_exp_f32 v136, v126
    v_exp_f32 v137, v127
    s_and_b32 s33, s53, s34
    v_pk_add_f32 v[136:137], v[136:137], 1.0 op_sel_hi:[1,0]
    v_mfma_f32_4x4x4_16b_bf16 v[100:103], v[144:145], v[90:91], 0 cbsz:4 abid:15
    v_rcp_f32 v136, v136
    v_rcp_f32 v137, v137
    buffer_load_dwordx4 v[84:87], v1, s[12:15], s33 offen
    v_pk_mul_f32 v[134:135], v[136:137], v[126:127]
    s_set_gpr_idx_on s61, 0xc
    v_pk_fma_f32 v[16:17], v[128:129], v[104:105], v[16:17] op_sel:[1,0,0] op_sel_hi:[1,1,1]
    v_pk_fma_f32 v[18:19], v[128:129], v[106:107], v[18:19] op_sel:[1,0,0] op_sel_hi:[1,1,1]
    v_pk_fma_f32 v[20:21], v[130:131], v[108:109], v[20:21] op_sel:[1,0,0] op_sel_hi:[1,1,1]
    v_pk_fma_f32 v[22:23], v[130:131], v[110:111], v[22:23] op_sel:[1,0,0] op_sel_hi:[1,1,1]
    s_set_gpr_idx_off
    v_cvt_pk_bf16_f32 v142, v149, v153
    v_cvt_pk_bf16_f32 v143, v157, v161
    s_waitcnt vmcnt(6)
    v_mfma_f32_4x4x4_16b_bf16 v[104:107], v[146:147], v[92:93], 0 cbsz:4 abid:15
    v_readlane_b32 s54, v166, 6
    v_mfma_f32_4x4x4_16b_bf16 v[120:123], v[172:173], v[176:177], 0 cbsz:4 abid:1
    v_exp_f32 v136, v112
    v_exp_f32 v137, v113
    s_and_b32 s33, s54, s34
    v_pk_add_f32 v[136:137], v[136:137], 1.0 op_sel_hi:[1,0]
    v_mfma_f32_4x4x4_16b_bf16 v[108:111], v[146:147], v[94:95], 0 cbsz:4 abid:15
    v_rcp_f32 v136, v136
    v_rcp_f32 v137, v137
    buffer_load_dwordx4 v[88:91], v1, s[12:15], s33 offen
    v_pk_mul_f32 v[128:129], v[136:137], v[112:113]
    s_set_gpr_idx_on s62, 0xc
    v_pk_fma_f32 v[16:17], v[132:133], v[96:97], v[16:17] op_sel:[0,0,0] op_sel_hi:[0,1,1]
    v_pk_fma_f32 v[18:19], v[132:133], v[98:99], v[18:19] op_sel:[0,0,0] op_sel_hi:[0,1,1]
    v_pk_fma_f32 v[20:21], v[134:135], v[100:101], v[20:21] op_sel:[0,0,0] op_sel_hi:[0,1,1]
    v_pk_fma_f32 v[22:23], v[134:135], v[102:103], v[22:23] op_sel:[0,0,0] op_sel_hi:[0,1,1]
    s_set_gpr_idx_off
    v_cvt_pk_bf16_f32 v144, v150, v154
    v_cvt_pk_bf16_f32 v145, v158, v162
    s_waitcnt vmcnt(6)
    v_mfma_f32_4x4x4_16b_bf16 v[96:99], v[140:141], v[64:65], 0 cbsz:4 abid:0
    v_readlane_b32 s55, v166, 7
    v_mfma_f32_4x4x4_16b_bf16 v[120:123], v[172:173], v[178:179], v[120:123] cbsz:4 abid:1
    v_exp_f32 v136, v116
    v_exp_f32 v137, v117
    s_and_b32 s33, s55, s34
    v_pk_add_f32 v[136:137], v[136:137], 1.0 op_sel_hi:[1,0]
    v_mfma_f32_4x4x4_16b_bf16 v[100:103], v[140:141], v[66:67], 0 cbsz:4 abid:0
    v_rcp_f32 v136, v136
    v_rcp_f32 v137, v137
    buffer_load_dwordx4 v[92:95], v1, s[12:15], s33 offen
    v_pk_mul_f32 v[130:131], v[136:137], v[116:117]
    s_set_gpr_idx_on s63, 0xc
    v_pk_fma_f32 v[16:17], v[132:133], v[104:105], v[16:17] op_sel:[1,0,0] op_sel_hi:[1,1,1]
    v_pk_fma_f32 v[18:19], v[132:133], v[106:107], v[18:19] op_sel:[1,0,0] op_sel_hi:[1,1,1]
    v_pk_fma_f32 v[20:21], v[134:135], v[108:109], v[20:21] op_sel:[1,0,0] op_sel_hi:[1,1,1]
    v_pk_fma_f32 v[22:23], v[134:135], v[110:111], v[22:23] op_sel:[1,0,0] op_sel_hi:[1,1,1]
    s_set_gpr_idx_off
    v_mov_b32 v164, v166
    v_cvt_pk_bf16_f32 v146, v151, v155
    v_cvt_pk_bf16_f32 v147, v159, v163
    s_branch A_0
B_0:
    s_sub_u32 s32, s32, 4
    s_cbranch_scc1 MAIN_DONE
    s_waitcnt vmcnt(2)
    v_mfma_f32_4x4x4_16b_bf16 v[104:107], v[142:143], v[68:69], 0 cbsz:4 abid:0
    v_mfma_f32_4x4x4_16b_bf16 v[124:127], v[172:173], v[180:181], 0 cbsz:4 abid:1
    v_exp_f32 v136, v114
    v_exp_f32 v137, v115
    s_nop 0
    v_pk_add_f32 v[136:137], v[136:137], 1.0 op_sel_hi:[1,0]
    v_mfma_f32_4x4x4_16b_bf16 v[108:111], v[142:143], v[70:71], 0 cbsz:4 abid:0
    v_rcp_f32 v136, v136
    v_rcp_f32 v137, v137
    s_nop 0
    v_pk_mul_f32 v[132:133], v[136:137], v[114:115]
    s_set_gpr_idx_on s48, 0xc
    v_pk_fma_f32 v[16:17], v[128:129], v[96:97], v[16:17] op_sel:[0,0,0] op_sel_hi:[0,1,1]
    v_pk_fma_f32 v[18:19], v[128:129], v[98:99], v[18:19] op_sel:[0,0,0] op_sel_hi:[0,1,1]
    v_pk_fma_f32 v[20:21], v[130:131], v[100:101], v[20:21] op_sel:[0,0,0] op_sel_hi:[0,1,1]
    v_pk_fma_f32 v[22:23], v[130:131], v[102:103], v[22:23] op_sel:[0,0,0] op_sel_hi:[0,1,1]
    s_set_gpr_idx_off
    s_waitcnt vmcnt(1)
    v_mfma_f32_4x4x4_16b_bf16 v[96:99], v[144:145], v[72:73], 0 cbsz:4 abid:0
    v_mfma_f32_4x4x4_16b_bf16 v[124:127], v[172:173], v[182:183], v[124:127] cbsz:4 abid:1
    v_exp_f32 v136, v118
    v_exp_f32 v137, v119
    s_nop 0
    v_pk_add_f32 v[136:137], v[136:137], 1.0 op_sel_hi:[1,0]
    v_mfma_f32_4x4x4_16b_bf16 v[100:103], v[144:145], v[74:75], 0 cbsz:4 abid:0
    v_rcp_f32 v136, v136
    v_rcp_f32 v137, v137
    s_nop 0
    v_pk_mul_f32 v[134:135], v[136:137], v[118:119]
    s_set_gpr_idx_on s49, 0xc
    v_pk_fma_f32 v[16:17], v[128:129], v[104:105], v[16:17] op_sel:[1,0,0] op_sel_hi:[1,1,1]
    v_pk_fma_f32 v[18:19], v[128:129], v[106:107], v[18:19] op_sel:[1,0,0] op_sel_hi:[1,1,1]
    v_pk_fma_f32 v[20:21], v[130:131], v[108:109], v[20:21] op_sel:[1,0,0] op_sel_hi:[1,1,1]
    v_pk_fma_f32 v[22:23], v[130:131], v[110:111], v[22:23] op_sel:[1,0,0] op_sel_hi:[1,1,1]
    s_set_gpr_idx_off
    s_waitcnt vmcnt(0)
    v_mfma_f32_4x4x4_16b_bf16 v[104:107], v[146:147], v[76:77], 0 cbsz:4 abid:0
    v_mfma_f32_4x4x4_16b_bf16 v[112:115], v[172:173], v[176:177], 0 cbsz:4 abid:2
    v_exp_f32 v136, v120
    v_exp_f32 v137, v121
    s_nop 0
    v_pk_add_f32 v[136:137], v[136:137], 1.0 op_sel_hi:[1,0]
    v_mfma_f32_4x4x4_16b_bf16 v[108:111], v[146:147], v[78:79], 0 cbsz:4 abid:0
    v_rcp_f32 v136, v136
    v_rcp_f32 v137, v137
    s_nop 0
    v_pk_mul_f32 v[128:129], v[136:137], v[120:121]
    s_set_gpr_idx_on s50, 0xc
    v_pk_fma_f32 v[16:17], v[132:133], v[96:97], v[16:17] op_sel:[0,0,0] op_sel_hi:[0,1,1]
    v_pk_fma_f32 v[18:19], v[132:133], v[98:99], v[18:19] op_sel:[0,0,0] op_sel_hi:[0,1,1]
    v_pk_fma_f32 v[20:21], v[134:135], v[100:101], v[20:21] op_sel:[0,0,0] op_sel_hi:[0,1,1]
    v_pk_fma_f32 v[22:23], v[134:135], v[102:103], v[22:23] op_sel:[0,0,0] op_sel_hi:[0,1,1]
    s_set_gpr_idx_off
    s_waitcnt vmcnt(0)
    v_mfma_f32_4x4x4_16b_bf16 v[96:99], v[140:141], v[80:81], 0 cbsz:4 abid:1
    v_mfma_f32_4x4x4_16b_bf16 v[112:115], v[172:173], v[178:179], v[112:115] cbsz:4 abid:2
    v_exp_f32 v136, v124
    v_exp_f32 v137, v125
    s_nop 0
    v_pk_add_f32 v[136:137], v[136:137], 1.0 op_sel_hi:[1,0]
    v_mfma_f32_4x4x4_16b_bf16 v[100:103], v[140:141], v[82:83], 0 cbsz:4 abid:1
    v_rcp_f32 v136, v136
    v_rcp_f32 v137, v137
    s_nop 0
    v_pk_mul_f32 v[130:131], v[136:137], v[124:125]
    s_set_gpr_idx_on s51, 0xc
    v_pk_fma_f32 v[16:17], v[132:133], v[104:105], v[16:17] op_sel:[1,0,0] op_sel_hi:[1,1,1]
    v_pk_fma_f32 v[18:19], v[132:133], v[106:107], v[18:19] op_sel:[1,0,0] op_sel_hi:[1,1,1]
    v_pk_fma_f32 v[20:21], v[134:135], v[108:109], v[20:21] op_sel:[1,0,0] op_sel_hi:[1,1,1]
    v_pk_fma_f32 v[22:23], v[134:135], v[110:111], v[22:23] op_sel:[1,0,0] op_sel_hi:[1,1,1]
    s_set_gpr_idx_off
B_4:
    s_sub_u32 s32, s32, 4
    s_cbranch_scc1 MAIN_DONE
    s_waitcnt vmcnt(2)
    v_mfma_f32_4x4x4_16b_bf16 v[104:107], v[142:143], v[84:85], 0 cbsz:4 abid:1
    v_mfma_f32_4x4x4_16b_bf16 v[116:119], v[172:173], v[180:181], 0 cbsz:4 abid:2
    v_exp_f32 v136, v122
    v_exp_f32 v137, v123
    s_nop 0
    v_pk_add_f32 v[136:137], v[136:137], 1.0 op_sel_hi:[1,0]
    v_mfma_f32_4x4x4_16b_bf16 v[108:111], v[142:143], v[86:87], 0 cbsz:4 abid:1
    v_rcp_f32 v136, v136
    v_rcp_f32 v137, v137
    s_nop 0
    v_pk_mul_f32 v[132:133], v[136:137], v[122:123]
    s_set_gpr_idx_on s52, 0xc
    v_pk_fma_f32 v[16:17], v[128:129], v[96:97], v[16:17] op_sel:[0,0,0] op_sel_hi:[0,1,1]
    v_pk_fma_f32 v[18:19], v[128:129], v[98:99], v[18:19] op_sel:[0,0,0] op_sel_hi:[0,1,1]
    v_pk_fma_f32 v[20:21], v[130:131], v[100:101], v[20:21] op_sel:[0,0,0] op_sel_hi:[0,1,1]
    v_pk_fma_f32 v[22:23], v[130:131], v[102:103], v[22:23] op_sel:[0,0,0] op_sel_hi:[0,1,1]
    s_set_gpr_idx_off
    s_waitcnt vmcnt(1)
    v_mfma_f32_4x4x4_16b_bf16 v[96:99], v[144:145], v[88:89], 0 cbsz:4 abid:1
    v_mfma_f32_4x4x4_16b_bf16 v[116:119], v[172:173], v[182:183], v[116:119] cbsz:4 abid:2
    v_exp_f32 v136, v126
    v_exp_f32 v137, v127
    s_nop 0
    v_pk_add_f32 v[136:137], v[136:137], 1.0 op_sel_hi:[1,0]
    v_mfma_f32_4x4x4_16b_bf16 v[100:103], v[144:145], v[90:91], 0 cbsz:4 abid:1
    v_rcp_f32 v136, v136
    v_rcp_f32 v137, v137
    s_nop 0
    v_pk_mul_f32 v[134:135], v[136:137], v[126:127]
    s_set_gpr_idx_on s53, 0xc
    v_pk_fma_f32 v[16:17], v[128:129], v[104:105], v[16:17] op_sel:[1,0,0] op_sel_hi:[1,1,1]
    v_pk_fma_f32 v[18:19], v[128:129], v[106:107], v[18:19] op_sel:[1,0,0] op_sel_hi:[1,1,1]
    v_pk_fma_f32 v[20:21], v[130:131], v[108:109], v[20:21] op_sel:[1,0,0] op_sel_hi:[1,1,1]
    v_pk_fma_f32 v[22:23], v[130:131], v[110:111], v[22:23] op_sel:[1,0,0] op_sel_hi:[1,1,1]
    s_set_gpr_idx_off
    s_waitcnt vmcnt(0)
    v_mfma_f32_4x4x4_16b_bf16 v[104:107], v[146:147], v[92:93], 0 cbsz:4 abid:1
    v_mfma_f32_4x4x4_16b_bf16 v[120:123], v[172:173], v[176:177], 0 cbsz:4 abid:3
    v_exp_f32 v136, v112
    v_exp_f32 v137, v113
    s_nop 0
    v_pk_add_f32 v[136:137], v[136:137], 1.0 op_sel_hi:[1,0]
    v_mfma_f32_4x4x4_16b_bf16 v[108:111], v[146:147], v[94:95], 0 cbsz:4 abid:1
    v_rcp_f32 v136, v136
    v_rcp_f32 v137, v137
    s_nop 0
    v_pk_mul_f32 v[128:129], v[136:137], v[112:113]
    s_set_gpr_idx_on s54, 0xc
    v_pk_fma_f32 v[16:17], v[132:133], v[96:97], v[16:17] op_sel:[0,0,0] op_sel_hi:[0,1,1]
    v_pk_fma_f32 v[18:19], v[132:133], v[98:99], v[18:19] op_sel:[0,0,0] op_sel_hi:[0,1,1]
    v_pk_fma_f32 v[20:21], v[134:135], v[100:101], v[20:21] op_sel:[0,0,0] op_sel_hi:[0,1,1]
    v_pk_fma_f32 v[22:23], v[134:135], v[102:103], v[22:23] op_sel:[0,0,0] op_sel_hi:[0,1,1]
    s_set_gpr_idx_off
    s_waitcnt vmcnt(0)
    v_mfma_f32_4x4x4_16b_bf16 v[96:99], v[140:141], v[64:65], 0 cbsz:4 abid:2
    v_mfma_f32_4x4x4_16b_bf16 v[120:123], v[172:173], v[178:179], v[120:123] cbsz:4 abid:3
    v_exp_f32 v136, v116
    v_exp_f32 v137, v117
    s_nop 0
    v_pk_add_f32 v[136:137], v[136:137], 1.0 op_sel_hi:[1,0]
    v_mfma_f32_4x4x4_16b_bf16 v[100:103], v[140:141], v[66:67], 0 cbsz:4 abid:2
    v_rcp_f32 v136, v136
    v_rcp_f32 v137, v137
    s_nop 0
    v_pk_mul_f32 v[130:131], v[136:137], v[116:117]
    s_set_gpr_idx_on s55, 0xc
    v_pk_fma_f32 v[16:17], v[132:133], v[104:105], v[16:17] op_sel:[1,0,0] op_sel_hi:[1,1,1]
    v_pk_fma_f32 v[18:19], v[132:133], v[106:107], v[18:19] op_sel:[1,0,0] op_sel_hi:[1,1,1]
    v_pk_fma_f32 v[20:21], v[134:135], v[108:109], v[20:21] op_sel:[1,0,0] op_sel_hi:[1,1,1]
    v_pk_fma_f32 v[22:23], v[134:135], v[110:111], v[22:23] op_sel:[1,0,0] op_sel_hi:[1,1,1]
    s_set_gpr_idx_off
B_8:
    s_sub_u32 s32, s32, 4
    s_cbranch_scc1 MAIN_DONE
    s_waitcnt vmcnt(2)
    v_mfma_f32_4x4x4_16b_bf16 v[104:107], v[142:143], v[68:69], 0 cbsz:4 abid:2
    v_mfma_f32_4x4x4_16b_bf16 v[124:127], v[172:173], v[180:181], 0 cbsz:4 abid:3
    v_exp_f32 v136, v114
    v_exp_f32 v137, v115
    s_nop 0
    v_pk_add_f32 v[136:137], v[136:137], 1.0 op_sel_hi:[1,0]
    v_mfma_f32_4x4x4_16b_bf16 v[108:111], v[142:143], v[70:71], 0 cbsz:4 abid:2
    v_rcp_f32 v136, v136
    v_rcp_f32 v137, v137
    s_nop 0
    v_pk_mul_f32 v[132:133], v[136:137], v[114:115]
    s_set_gpr_idx_on s56, 0xc
    v_pk_fma_f32 v[16:17], v[128:129], v[96:97], v[16:17] op_sel:[0,0,0] op_sel_hi:[0,1,1]
    v_pk_fma_f32 v[18:19], v[128:129], v[98:99], v[18:19] op_sel:[0,0,0] op_sel_hi:[0,1,1]
    v_pk_fma_f32 v[20:21], v[130:131], v[100:101], v[20:21] op_sel:[0,0,0] op_sel_hi:[0,1,1]
    v_pk_fma_f32 v[22:23], v[130:131], v[102:103], v[22:23] op_sel:[0,0,0] op_sel_hi:[0,1,1]
    s_set_gpr_idx_off
    ds_read_b64 v[166:167], v5
    s_waitcnt vmcnt(1)
    v_mfma_f32_4x4x4_16b_bf16 v[96:99], v[144:145], v[72:73], 0 cbsz:4 abid:2
    v_mfma_f32_4x4x4_16b_bf16 v[124:127], v[172:173], v[182:183], v[124:127] cbsz:4 abid:3
    v_exp_f32 v136, v118
    v_exp_f32 v137, v119
    s_nop 0
    v_pk_add_f32 v[136:137], v[136:137], 1.0 op_sel_hi:[1,0]
    v_mfma_f32_4x4x4_16b_bf16 v[100:103], v[144:145], v[74:75], 0 cbsz:4 abid:2
    v_rcp_f32 v136, v136
    v_rcp_f32 v137, v137
    s_nop 0
    v_pk_mul_f32 v[134:135], v[136:137], v[118:119]
    s_set_gpr_idx_on s57, 0xc
    v_pk_fma_f32 v[16:17], v[128:129], v[104:105], v[16:17] op_sel:[1,0,0] op_sel_hi:[1,1,1]
    v_pk_fma_f32 v[18:19], v[128:129], v[106:107], v[18:19] op_sel:[1,0,0] op_sel_hi:[1,1,1]
    v_pk_fma_f32 v[20:21], v[130:131], v[108:109], v[20:21] op_sel:[1,0,0] op_sel_hi:[1,1,1]
    v_pk_fma_f32 v[22:23], v[130:131], v[110:111], v[22:23] op_sel:[1,0,0] op_sel_hi:[1,1,1]
    s_set_gpr_idx_off
    s_waitcnt vmcnt(0)
    v_mfma_f32_4x4x4_16b_bf16 v[104:107], v[146:147], v[76:77], 0 cbsz:4 abid:2
    v_mfma_f32_4x4x4_16b_bf16 v[112:115], v[172:173], v[176:177], 0 cbsz:4 abid:4
    v_exp_f32 v136, v120
    v_exp_f32 v137, v121
    s_nop 0
    v_pk_add_f32 v[136:137], v[136:137], 1.0 op_sel_hi:[1,0]
    v_mfma_f32_4x4x4_16b_bf16 v[108:111], v[146:147], v[78:79], 0 cbsz:4 abid:2
    v_rcp_f32 v136, v136
    v_rcp_f32 v137, v137
    s_nop 0
    v_pk_mul_f32 v[128:129], v[136:137], v[120:121]
    s_set_gpr_idx_on s58, 0xc
    v_pk_fma_f32 v[16:17], v[132:133], v[96:97], v[16:17] op_sel:[0,0,0] op_sel_hi:[0,1,1]
    v_pk_fma_f32 v[18:19], v[132:133], v[98:99], v[18:19] op_sel:[0,0,0] op_sel_hi:[0,1,1]
    v_pk_fma_f32 v[20:21], v[134:135], v[100:101], v[20:21] op_sel:[0,0,0] op_sel_hi:[0,1,1]
    v_pk_fma_f32 v[22:23], v[134:135], v[102:103], v[22:23] op_sel:[0,0,0] op_sel_hi:[0,1,1]
    s_set_gpr_idx_off
    s_waitcnt vmcnt(0)
    v_mfma_f32_4x4x4_16b_bf16 v[96:99], v[140:141], v[80:81], 0 cbsz:4 abid:3
    v_mfma_f32_4x4x4_16b_bf16 v[112:115], v[172:173], v[178:179], v[112:115] cbsz:4 abid:4
    v_exp_f32 v136, v124
    v_exp_f32 v137, v125
    s_nop 0
    v_pk_add_f32 v[136:137], v[136:137], 1.0 op_sel_hi:[1,0]
    v_mfma_f32_4x4x4_16b_bf16 v[100:103], v[140:141], v[82:83], 0 cbsz:4 abid:3
    v_rcp_f32 v136, v136
    v_rcp_f32 v137, v137
    s_nop 0
    v_pk_mul_f32 v[130:131], v[136:137], v[124:125]
    s_set_gpr_idx_on s59, 0xc
    v_pk_fma_f32 v[16:17], v[132:133], v[104:105], v[16:17] op_sel:[1,0,0] op_sel_hi:[1,1,1]
    v_pk_fma_f32 v[18:19], v[132:133], v[106:107], v[18:19] op_sel:[1,0,0] op_sel_hi:[1,1,1]
    v_pk_fma_f32 v[20:21], v[134:135], v[108:109], v[20:21] op_sel:[1,0,0] op_sel_hi:[1,1,1]
    v_pk_fma_f32 v[22:23], v[134:135], v[110:111], v[22:23] op_sel:[1,0,0] op_sel_hi:[1,1,1]
    s_set_gpr_idx_off
B_12:
    s_sub_u32 s32, s32, 4
    s_cbranch_scc1 MAIN_DONE
    s_waitcnt vmcnt(2)
    v_mfma_f32_4x4x4_16b_bf16 v[104:107], v[142:143], v[84:85], 0 cbsz:4 abid:3
    v_mfma_f32_4x4x4_16b_bf16 v[116:119], v[172:173], v[180:181], 0 cbsz:4 abid:4
    v_exp_f32 v136, v122
    v_exp_f32 v137, v123
    s_nop 0
    v_pk_add_f32 v[136:137], v[136:137], 1.0 op_sel_hi:[1,0]
    v_mfma_f32_4x4x4_16b_bf16 v[108:111], v[142:143], v[86:87], 0 cbsz:4 abid:3
    v_rcp_f32 v136, v136
    v_rcp_f32 v137, v137
    s_nop 0
    v_pk_mul_f32 v[132:133], v[136:137], v[122:123]
    s_set_gpr_idx_on s60, 0xc
    v_pk_fma_f32 v[16:17], v[128:129], v[96:97], v[16:17] op_sel:[0,0,0] op_sel_hi:[0,1,1]
    v_pk_fma_f32 v[18:19], v[128:129], v[98:99], v[18:19] op_sel:[0,0,0] op_sel_hi:[0,1,1]
    v_pk_fma_f32 v[20:21], v[130:131], v[100:101], v[20:21] op_sel:[0,0,0] op_sel_hi:[0,1,1]
    v_pk_fma_f32 v[22:23], v[130:131], v[102:103], v[22:23] op_sel:[0,0,0] op_sel_hi:[0,1,1]
    s_set_gpr_idx_off
    s_waitcnt lgkmcnt(0)
    v_cmp_gt_u32 vcc, s30, v6
    v_add_u32 v6, 64, v6
    v_add_u32 v5, 512, v5
    v_mov_b32 v8, 23040
    v_cndmask_b32 v166, 40, v166, vcc
    v_cndmask_b32 v167, v8, v167, vcc
    ds_read_b128 v[168:171], v167
    s_waitcnt vmcnt(1)
    v_mfma_f32_4x4x4_16b_bf16 v[96:99], v[144:145], v[88:89], 0 cbsz:4 abid:3
    v_mfma_f32_4x4x4_16b_bf16 v[116:119], v[172:173], v[182:183], v[116:119] cbsz:4 abid:4
    v_exp_f32 v136, v126
    v_exp_f32 v137, v127
    s_nop 0
    v_pk_add_f32 v[136:137], v[136:137], 1.0 op_sel_hi:[1,0]
    v_mfma_f32_4x4x4_16b_bf16 v[100:103], v[144:145], v[90:91], 0 cbsz:4 abid:3
    v_rcp_f32 v136, v136
    v_rcp_f32 v137, v137
    s_nop 0
    v_pk_mul_f32 v[134:135], v[136:137], v[126:127]
    s_set_gpr_idx_on s61, 0xc
    v_pk_fma_f32 v[16:17], v[128:129], v[104:105], v[16:17] op_sel:[1,0,0] op_sel_hi:[1,1,1]
    v_pk_fma_f32 v[18:19], v[128:129], v[106:107], v[18:19] op_sel:[1,0,0] op_sel_hi:[1,1,1]
    v_pk_fma_f32 v[20:21], v[130:131], v[108:109], v[20:21] op_sel:[1,0,0] op_sel_hi:[1,1,1]
    v_pk_fma_f32 v[22:23], v[130:131], v[110:111], v[22:23] op_sel:[1,0,0] op_sel_hi:[1,1,1]
    s_set_gpr_idx_off
    s_waitcnt vmcnt(0)
    v_mfma_f32_4x4x4_16b_bf16 v[104:107], v[146:147], v[92:93], 0 cbsz:4 abid:3
    v_mfma_f32_4x4x4_16b_bf16 v[120:123], v[172:173], v[176:177], 0 cbsz:4 abid:5
    v_exp_f32 v136, v112
    v_exp_f32 v137, v113
    s_nop 0
    v_pk_add_f32 v[136:137], v[136:137], 1.0 op_sel_hi:[1,0]
    v_mfma_f32_4x4x4_16b_bf16 v[108:111], v[146:147], v[94:95], 0 cbsz:4 abid:3
    v_rcp_f32 v136, v136
    v_rcp_f32 v137, v137
    s_nop 0
    v_pk_mul_f32 v[128:129], v[136:137], v[112:113]
    s_set_gpr_idx_on s62, 0xc
    v_pk_fma_f32 v[16:17], v[132:133], v[96:97], v[16:17] op_sel:[0,0,0] op_sel_hi:[0,1,1]
    v_pk_fma_f32 v[18:19], v[132:133], v[98:99], v[18:19] op_sel:[0,0,0] op_sel_hi:[0,1,1]
    v_pk_fma_f32 v[20:21], v[134:135], v[100:101], v[20:21] op_sel:[0,0,0] op_sel_hi:[0,1,1]
    v_pk_fma_f32 v[22:23], v[134:135], v[102:103], v[22:23] op_sel:[0,0,0] op_sel_hi:[0,1,1]
    s_set_gpr_idx_off
    s_waitcnt vmcnt(0)
    v_mfma_f32_4x4x4_16b_bf16 v[96:99], v[140:141], v[64:65], 0 cbsz:4 abid:4
    v_mfma_f32_4x4x4_16b_bf16 v[120:123], v[172:173], v[178:179], v[120:123] cbsz:4 abid:5
    v_exp_f32 v136, v116
    v_exp_f32 v137, v117
    s_nop 0
    v_pk_add_f32 v[136:137], v[136:137], 1.0 op_sel_hi:[1,0]
    v_mfma_f32_4x4x4_16b_bf16 v[100:103], v[140:141], v[66:67], 0 cbsz:4 abid:4
    v_rcp_f32 v136, v136
    v_rcp_f32 v137, v137
    s_nop 0
    v_pk_mul_f32 v[130:131], v[136:137], v[116:117]
    s_set_gpr_idx_on s63, 0xc
    v_pk_fma_f32 v[16:17], v[132:133], v[104:105], v[16:17] op_sel:[1,0,0] op_sel_hi:[1,1,1]
    v_pk_fma_f32 v[18:19], v[132:133], v[106:107], v[18:19] op_sel:[1,0,0] op_sel_hi:[1,1,1]
    v_pk_fma_f32 v[20:21], v[134:135], v[108:109], v[20:21] op_sel:[1,0,0] op_sel_hi:[1,1,1]
    v_pk_fma_f32 v[22:23], v[134:135], v[110:111], v[22:23] op_sel:[1,0,0] op_sel_hi:[1,1,1]
    s_set_gpr_idx_off
B_16:
    s_sub_u32 s32, s32, 4
    s_cbranch_scc1 MAIN_DONE
    s_waitcnt vmcnt(2)
    v_mfma_f32_4x4x4_16b_bf16 v[104:107], v[142:143], v[68:69], 0 cbsz:4 abid:4
    v_mfma_f32_4x4x4_16b_bf16 v[124:127], v[172:173], v[180:181], 0 cbsz:4 abid:5
    v_exp_f32 v136, v114
    v_exp_f32 v137, v115
    s_nop 0
    v_pk_add_f32 v[136:137], v[136:137], 1.0 op_sel_hi:[1,0]
    v_mfma_f32_4x4x4_16b_bf16 v[108:111], v[142:143], v[70:71], 0 cbsz:4 abid:4
    v_rcp_f32 v136, v136
    v_rcp_f32 v137, v137
    s_nop 0
    v_pk_mul_f32 v[132:133], v[136:137], v[114:115]
    s_set_gpr_idx_on s48, 0xc
    v_pk_fma_f32 v[16:17], v[128:129], v[96:97], v[16:17] op_sel:[0,0,0] op_sel_hi:[0,1,1]
    v_pk_fma_f32 v[18:19], v[128:129], v[98:99], v[18:19] op_sel:[0,0,0] op_sel_hi:[0,1,1]
    v_pk_fma_f32 v[20:21], v[130:131], v[100:101], v[20:21] op_sel:[0,0,0] op_sel_hi:[0,1,1]
    v_pk_fma_f32 v[22:23], v[130:131], v[102:103], v[22:23] op_sel:[0,0,0] op_sel_hi:[0,1,1]
    s_set_gpr_idx_off
    s_waitcnt vmcnt(1)
    v_mfma_f32_4x4x4_16b_bf16 v[96:99], v[144:145], v[72:73], 0 cbsz:4 abid:4
    v_mfma_f32_4x4x4_16b_bf16 v[124:127], v[172:173], v[182:183], v[124:127] cbsz:4 abid:5
    v_exp_f32 v136, v118
    v_exp_f32 v137, v119
    s_nop 0
    v_pk_add_f32 v[136:137], v[136:137], 1.0 op_sel_hi:[1,0]
    v_mfma_f32_4x4x4_16b_bf16 v[100:103], v[144:145], v[74:75], 0 cbsz:4 abid:4
    v_rcp_f32 v136, v136
    v_rcp_f32 v137, v137
    s_nop 0
    v_pk_mul_f32 v[134:135], v[136:137], v[118:119]
    s_set_gpr_idx_on s49, 0xc
    v_pk_fma_f32 v[16:17], v[128:129], v[104:105], v[16:17] op_sel:[1,0,0] op_sel_hi:[1,1,1]
    v_pk_fma_f32 v[18:19], v[128:129], v[106:107], v[18:19] op_sel:[1,0,0] op_sel_hi:[1,1,1]
    v_pk_fma_f32 v[20:21], v[130:131], v[108:109], v[20:21] op_sel:[1,0,0] op_sel_hi:[1,1,1]
    v_pk_fma_f32 v[22:23], v[130:131], v[110:111], v[22:23] op_sel:[1,0,0] op_sel_hi:[1,1,1]
    s_set_gpr_idx_off
    s_waitcnt vmcnt(0)
    v_mfma_f32_4x4x4_16b_bf16 v[104:107], v[146:147], v[76:77], 0 cbsz:4 abid:4
    v_mfma_f32_4x4x4_16b_bf16 v[112:115], v[172:173], v[176:177], 0 cbsz:4 abid:6
    v_exp_f32 v136, v120
    v_exp_f32 v137, v121
    s_nop 0
    v_pk_add_f32 v[136:137], v[136:137], 1.0 op_sel_hi:[1,0]
    v_mfma_f32_4x4x4_16b_bf16 v[108:111], v[146:147], v[78:79], 0 cbsz:4 abid:4
    v_rcp_f32 v136, v136
    v_rcp_f32 v137, v137
    s_nop 0
    v_pk_mul_f32 v[128:129], v[136:137], v[120:121]
    s_set_gpr_idx_on s50, 0xc
    v_pk_fma_f32 v[16:17], v[132:133], v[96:97], v[16:17] op_sel:[0,0,0] op_sel_hi:[0,1,1]
    v_pk_fma_f32 v[18:19], v[132:133], v[98:99], v[18:19] op_sel:[0,0,0] op_sel_hi:[0,1,1]
    v_pk_fma_f32 v[20:21], v[134:135], v[100:101], v[20:21] op_sel:[0,0,0] op_sel_hi:[0,1,1]
    v_pk_fma_f32 v[22:23], v[134:135], v[102:103], v[22:23] op_sel:[0,0,0] op_sel_hi:[0,1,1]
    s_set_gpr_idx_off
    s_waitcnt vmcnt(0)
    v_mfma_f32_4x4x4_16b_bf16 v[96:99], v[140:141], v[80:81], 0 cbsz:4 abid:5
    v_mfma_f32_4x4x4_16b_bf16 v[112:115], v[172:173], v[178:179], v[112:115] cbsz:4 abid:6
    v_exp_f32 v136, v124
    v_exp_f32 v137, v125
    s_nop 0
    v_pk_add_f32 v[136:137], v[136:137], 1.0 op_sel_hi:[1,0]
    v_mfma_f32_4x4x4_16b_bf16 v[100:103], v[140:141], v[82:83], 0 cbsz:4 abid:5
    v_rcp_f32 v136, v136
    v_rcp_f32 v137, v137
    s_nop 0
    v_pk_mul_f32 v[130:131], v[136:137], v[124:125]
    s_set_gpr_idx_on s51, 0xc
    v_pk_fma_f32 v[16:17], v[132:133], v[104:105], v[16:17] op_sel:[1,0,0] op_sel_hi:[1,1,1]
    v_pk_fma_f32 v[18:19], v[132:133], v[106:107], v[18:19] op_sel:[1,0,0] op_sel_hi:[1,1,1]
    v_pk_fma_f32 v[20:21], v[134:135], v[108:109], v[20:21] op_sel:[1,0,0] op_sel_hi:[1,1,1]
    v_pk_fma_f32 v[22:23], v[134:135], v[110:111], v[22:23] op_sel:[1,0,0] op_sel_hi:[1,1,1]
    s_set_gpr_idx_off
B_20:
    s_sub_u32 s32, s32, 4
    s_cbranch_scc1 MAIN_DONE
    s_waitcnt vmcnt(2)
    v_mfma_f32_4x4x4_16b_bf16 v[104:107], v[142:143], v[84:85], 0 cbsz:4 abid:5
    v_mfma_f32_4x4x4_16b_bf16 v[116:119], v[172:173], v[180:181], 0 cbsz:4 abid:6
    v_exp_f32 v136, v122
    v_exp_f32 v137, v123
    s_nop 0
    v_pk_add_f32 v[136:137], v[136:137], 1.0 op_sel_hi:[1,0]
    v_mfma_f32_4x4x4_16b_bf16 v[108:111], v[142:143], v[86:87], 0 cbsz:4 abid:5
    v_rcp_f32 v136, v136
    v_rcp_f32 v137, v137
    s_nop 0
    v_pk_mul_f32 v[132:133], v[136:137], v[122:123]
    s_set_gpr_idx_on s52, 0xc
    v_pk_fma_f32 v[16:17], v[128:129], v[96:97], v[16:17] op_sel:[0,0,0] op_sel_hi:[0,1,1]
    v_pk_fma_f32 v[18:19], v[128:129], v[98:99], v[18:19] op_sel:[0,0,0] op_sel_hi:[0,1,1]
    v_pk_fma_f32 v[20:21], v[130:131], v[100:101], v[20:21] op_sel:[0,0,0] op_sel_hi:[0,1,1]
    v_pk_fma_f32 v[22:23], v[130:131], v[102:103], v[22:23] op_sel:[0,0,0] op_sel_hi:[0,1,1]
    s_set_gpr_idx_off
    s_waitcnt lgkmcnt(0)
    s_waitcnt vmcnt(1)
    v_mfma_f32_4x4x4_16b_bf16 v[96:99], v[144:145], v[88:89], 0 cbsz:4 abid:5
    v_mfma_f32_4x4x4_16b_bf16 v[116:119], v[172:173], v[182:183], v[116:119] cbsz:4 abid:6
    v_exp_f32 v136, v126
    v_exp_f32 v137, v127
    s_nop 0
    v_pk_add_f32 v[136:137], v[136:137], 1.0 op_sel_hi:[1,0]
    v_mfma_f32_4x4x4_16b_bf16 v[100:103], v[144:145], v[90:91], 0 cbsz:4 abid:5
    v_rcp_f32 v136, v136
    v_rcp_f32 v137, v137
    s_nop 0
    v_pk_mul_f32 v[134:135], v[136:137], v[126:127]
    s_set_gpr_idx_on s53, 0xc
    v_pk_fma_f32 v[16:17], v[128:129], v[104:105], v[16:17] op_sel:[1,0,0] op_sel_hi:[1,1,1]
    v_pk_fma_f32 v[18:19], v[128:129], v[106:107], v[18:19] op_sel:[1,0,0] op_sel_hi:[1,1,1]
    v_pk_fma_f32 v[20:21], v[130:131], v[108:109], v[20:21] op_sel:[1,0,0] op_sel_hi:[1,1,1]
    v_pk_fma_f32 v[22:23], v[130:131], v[110:111], v[22:23] op_sel:[1,0,0] op_sel_hi:[1,1,1]
    s_set_gpr_idx_off
    s_waitcnt vmcnt(0)
    v_mfma_f32_4x4x4_16b_bf16 v[104:107], v[146:147], v[92:93], 0 cbsz:4 abid:5
    v_mfma_f32_4x4x4_16b_bf16 v[120:123], v[172:173], v[176:177], 0 cbsz:4 abid:7
    v_exp_f32 v136, v112
    v_exp_f32 v137, v113
    s_nop 0
    v_pk_add_f32 v[136:137], v[136:137], 1.0 op_sel_hi:[1,0]
    v_mfma_f32_4x4x4_16b_bf16 v[108:111], v[146:147], v[94:95], 0 cbsz:4 abid:5
    v_rcp_f32 v136, v136
    v_rcp_f32 v137, v137
    s_nop 0
    v_pk_mul_f32 v[128:129], v[136:137], v[112:113]
    s_set_gpr_idx_on s54, 0xc
    v_pk_fma_f32 v[16:17], v[132:133], v[96:97], v[16:17] op_sel:[0,0,0] op_sel_hi:[0,1,1]
    v_pk_fma_f32 v[18:19], v[132:133], v[98:99], v[18:19] op_sel:[0,0,0] op_sel_hi:[0,1,1]
    v_pk_fma_f32 v[20:21], v[134:135], v[100:101], v[20:21] op_sel:[0,0,0] op_sel_hi:[0,1,1]
    v_pk_fma_f32 v[22:23], v[134:135], v[102:103], v[22:23] op_sel:[0,0,0] op_sel_hi:[0,1,1]
    s_set_gpr_idx_off
    s_waitcnt vmcnt(0)
    v_mfma_f32_4x4x4_16b_bf16 v[96:99], v[140:141], v[64:65], 0 cbsz:4 abid:6
    v_mfma_f32_4x4x4_16b_bf16 v[120:123], v[172:173], v[178:179], v[120:123] cbsz:4 abid:7
    v_exp_f32 v136, v116
    v_exp_f32 v137, v117
    s_nop 0
    v_pk_add_f32 v[136:137], v[136:137], 1.0 op_sel_hi:[1,0]
    v_mfma_f32_4x4x4_16b_bf16 v[100:103], v[140:141], v[66:67], 0 cbsz:4 abid:6
    v_rcp_f32 v136, v136
    v_rcp_f32 v137, v137
    s_nop 0
    v_pk_mul_f32 v[130:131], v[136:137], v[116:117]
    s_set_gpr_idx_on s55, 0xc
    v_pk_fma_f32 v[16:17], v[132:133], v[104:105], v[16:17] op_sel:[1,0,0] op_sel_hi:[1,1,1]
    v_pk_fma_f32 v[18:19], v[132:133], v[106:107], v[18:19] op_sel:[1,0,0] op_sel_hi:[1,1,1]
    v_pk_fma_f32 v[20:21], v[134:135], v[108:109], v[20:21] op_sel:[1,0,0] op_sel_hi:[1,1,1]
    v_pk_fma_f32 v[22:23], v[134:135], v[110:111], v[22:23] op_sel:[1,0,0] op_sel_hi:[1,1,1]
    s_set_gpr_idx_off
B_24:
    s_sub_u32 s32, s32, 4
    s_cbranch_scc1 MAIN_DONE
    s_waitcnt vmcnt(2)
    v_mfma_f32_4x4x4_16b_bf16 v[104:107], v[142:143], v[68:69], 0 cbsz:4 abid:6
    v_mfma_f32_4x4x4_16b_bf16 v[124:127], v[172:173], v[180:181], 0 cbsz:4 abid:7
    v_exp_f32 v136, v114
    v_exp_f32 v137, v115
    s_nop 0
    v_pk_add_f32 v[136:137], v[136:137], 1.0 op_sel_hi:[1,0]
    v_mfma_f32_4x4x4_16b_bf16 v[108:111], v[142:143], v[70:71], 0 cbsz:4 abid:6
    v_rcp_f32 v136, v136
    v_rcp_f32 v137, v137
    s_nop 0
    v_pk_mul_f32 v[132:133], v[136:137], v[114:115]
    s_set_gpr_idx_on s56, 0xc
    v_pk_fma_f32 v[16:17], v[128:129], v[96:97], v[16:17] op_sel:[0,0,0] op_sel_hi:[0,1,1]
    v_pk_fma_f32 v[18:19], v[128:129], v[98:99], v[18:19] op_sel:[0,0,0] op_sel_hi:[0,1,1]
    v_pk_fma_f32 v[20:21], v[130:131], v[100:101], v[20:21] op_sel:[0,0,0] op_sel_hi:[0,1,1]
    v_pk_fma_f32 v[22:23], v[130:131], v[102:103], v[22:23] op_sel:[0,0,0] op_sel_hi:[0,1,1]
    s_set_gpr_idx_off
    s_waitcnt vmcnt(1)
    v_mfma_f32_4x4x4_16b_bf16 v[96:99], v[144:145], v[72:73], 0 cbsz:4 abid:6
    v_mfma_f32_4x4x4_16b_bf16 v[124:127], v[172:173], v[182:183], v[124:127] cbsz:4 abid:7
    v_exp_f32 v136, v118
    v_exp_f32 v137, v119
    s_nop 0
    v_pk_add_f32 v[136:137], v[136:137], 1.0 op_sel_hi:[1,0]
    v_mfma_f32_4x4x4_16b_bf16 v[100:103], v[144:145], v[74:75], 0 cbsz:4 abid:6
    v_rcp_f32 v136, v136
    v_rcp_f32 v137, v137
    s_nop 0
    v_pk_mul_f32 v[134:135], v[136:137], v[118:119]
    s_set_gpr_idx_on s57, 0xc
    v_pk_fma_f32 v[16:17], v[128:129], v[104:105], v[16:17] op_sel:[1,0,0] op_sel_hi:[1,1,1]
    v_pk_fma_f32 v[18:19], v[128:129], v[106:107], v[18:19] op_sel:[1,0,0] op_sel_hi:[1,1,1]
    v_pk_fma_f32 v[20:21], v[130:131], v[108:109], v[20:21] op_sel:[1,0,0] op_sel_hi:[1,1,1]
    v_pk_fma_f32 v[22:23], v[130:131], v[110:111], v[22:23] op_sel:[1,0,0] op_sel_hi:[1,1,1]
    s_set_gpr_idx_off
    s_waitcnt vmcnt(0)
    v_mfma_f32_4x4x4_16b_bf16 v[104:107], v[146:147], v[76:77], 0 cbsz:4 abid:6
    v_mfma_f32_4x4x4_16b_bf16 v[112:115], v[172:173], v[176:177], 0 cbsz:4 abid:8
    v_exp_f32 v136, v120
    v_exp_f32 v137, v121
    s_nop 0
    v_pk_add_f32 v[136:137], v[136:137], 1.0 op_sel_hi:[1,0]
    v_mfma_f32_4x4x4_16b_bf16 v[108:111], v[146:147], v[78:79], 0 cbsz:4 abid:6
    v_rcp_f32 v136, v136
    v_rcp_f32 v137, v137
    s_nop 0
    v_pk_mul_f32 v[128:129], v[136:137], v[120:121]
    s_set_gpr_idx_on s58, 0xc
    v_pk_fma_f32 v[16:17], v[132:133], v[96:97], v[16:17] op_sel:[0,0,0] op_sel_hi:[0,1,1]
    v_pk_fma_f32 v[18:19], v[132:133], v[98:99], v[18:19] op_sel:[0,0,0] op_sel_hi:[0,1,1]
    v_pk_fma_f32 v[20:21], v[134:135], v[100:101], v[20:21] op_sel:[0,0,0] op_sel_hi:[0,1,1]
    v_pk_fma_f32 v[22:23], v[134:135], v[102:103], v[22:23] op_sel:[0,0,0] op_sel_hi:[0,1,1]
    s_set_gpr_idx_off
    s_waitcnt vmcnt(0)
    v_mfma_f32_4x4x4_16b_bf16 v[96:99], v[140:141], v[80:81], 0 cbsz:4 abid:7
    v_mfma_f32_4x4x4_16b_bf16 v[112:115], v[172:173], v[178:179], v[112:115] cbsz:4 abid:8
    v_exp_f32 v136, v124
    v_exp_f32 v137, v125
    s_nop 0
    v_pk_add_f32 v[136:137], v[136:137], 1.0 op_sel_hi:[1,0]
    v_mfma_f32_4x4x4_16b_bf16 v[100:103], v[140:141], v[82:83], 0 cbsz:4 abid:7
    v_rcp_f32 v136, v136
    v_rcp_f32 v137, v137
    s_nop 0
    v_pk_mul_f32 v[130:131], v[136:137], v[124:125]
    s_set_gpr_idx_on s59, 0xc
    v_pk_fma_f32 v[16:17], v[132:133], v[104:105], v[16:17] op_sel:[1,0,0] op_sel_hi:[1,1,1]
    v_pk_fma_f32 v[18:19], v[132:133], v[106:107], v[18:19] op_sel:[1,0,0] op_sel_hi:[1,1,1]
    v_pk_fma_f32 v[20:21], v[134:135], v[108:109], v[20:21] op_sel:[1,0,0] op_sel_hi:[1,1,1]
    v_pk_fma_f32 v[22:23], v[134:135], v[110:111], v[22:23] op_sel:[1,0,0] op_sel_hi:[1,1,1]
    s_set_gpr_idx_off
B_28:
    s_sub_u32 s32, s32, 4
    s_cbranch_scc1 MAIN_DONE
    s_waitcnt vmcnt(2)
    v_mfma_f32_4x4x4_16b_bf16 v[104:107], v[142:143], v[84:85], 0 cbsz:4 abid:7
    v_mfma_f32_4x4x4_16b_bf16 v[116:119], v[172:173], v[180:181], 0 cbsz:4 abid:8
    v_exp_f32 v136, v122
    v_exp_f32 v137, v123
    s_nop 0
    v_pk_add_f32 v[136:137], v[136:137], 1.0 op_sel_hi:[1,0]
    v_mfma_f32_4x4x4_16b_bf16 v[108:111], v[142:143], v[86:87], 0 cbsz:4 abid:7
    v_rcp_f32 v136, v136
    v_rcp_f32 v137, v137
    s_nop 0
    v_pk_mul_f32 v[132:133], v[136:137], v[122:123]
    s_set_gpr_idx_on s60, 0xc
    v_pk_fma_f32 v[16:17], v[128:129], v[96:97], v[16:17] op_sel:[0,0,0] op_sel_hi:[0,1,1]
    v_pk_fma_f32 v[18:19], v[128:129], v[98:99], v[18:19] op_sel:[0,0,0] op_sel_hi:[0,1,1]
    v_pk_fma_f32 v[20:21], v[130:131], v[100:101], v[20:21] op_sel:[0,0,0] op_sel_hi:[0,1,1]
    v_pk_fma_f32 v[22:23], v[130:131], v[102:103], v[22:23] op_sel:[0,0,0] op_sel_hi:[0,1,1]
    s_set_gpr_idx_off
    s_waitcnt vmcnt(1)
    v_mfma_f32_4x4x4_16b_bf16 v[96:99], v[144:145], v[88:89], 0 cbsz:4 abid:7
    v_mfma_f32_4x4x4_16b_bf16 v[116:119], v[172:173], v[182:183], v[116:119] cbsz:4 abid:8
    v_exp_f32 v136, v126
    v_exp_f32 v137, v127
    s_nop 0
    v_pk_add_f32 v[136:137], v[136:137], 1.0 op_sel_hi:[1,0]
    v_mfma_f32_4x4x4_16b_bf16 v[100:103], v[144:145], v[90:91], 0 cbsz:4 abid:7
    v_rcp_f32 v136, v136
    v_rcp_f32 v137, v137
    s_nop 0
    v_pk_mul_f32 v[134:135], v[136:137], v[126:127]
    s_set_gpr_idx_on s61, 0xc
    v_pk_fma_f32 v[16:17], v[128:129], v[104:105], v[16:17] op_sel:[1,0,0] op_sel_hi:[1,1,1]
    v_pk_fma_f32 v[18:19], v[128:129], v[106:107], v[18:19] op_sel:[1,0,0] op_sel_hi:[1,1,1]
    v_pk_fma_f32 v[20:21], v[130:131], v[108:109], v[20:21] op_sel:[1,0,0] op_sel_hi:[1,1,1]
    v_pk_fma_f32 v[22:23], v[130:131], v[110:111], v[22:23] op_sel:[1,0,0] op_sel_hi:[1,1,1]
    s_set_gpr_idx_off
    s_waitcnt vmcnt(0)
    v_mfma_f32_4x4x4_16b_bf16 v[104:107], v[146:147], v[92:93], 0 cbsz:4 abid:7
    v_mfma_f32_4x4x4_16b_bf16 v[120:123], v[172:173], v[176:177], 0 cbsz:4 abid:9
    v_exp_f32 v136, v112
    v_exp_f32 v137, v113
    s_nop 0
    v_pk_add_f32 v[136:137], v[136:137], 1.0 op_sel_hi:[1,0]
    v_mfma_f32_4x4x4_16b_bf16 v[108:111], v[146:147], v[94:95], 0 cbsz:4 abid:7
    v_rcp_f32 v136, v136
    v_rcp_f32 v137, v137
    s_nop 0
    v_pk_mul_f32 v[128:129], v[136:137], v[112:113]
    s_set_gpr_idx_on s62, 0xc
    v_pk_fma_f32 v[16:17], v[132:133], v[96:97], v[16:17] op_sel:[0,0,0] op_sel_hi:[0,1,1]
    v_pk_fma_f32 v[18:19], v[132:133], v[98:99], v[18:19] op_sel:[0,0,0] op_sel_hi:[0,1,1]
    v_pk_fma_f32 v[20:21], v[134:135], v[100:101], v[20:21] op_sel:[0,0,0] op_sel_hi:[0,1,1]
    v_pk_fma_f32 v[22:23], v[134:135], v[102:103], v[22:23] op_sel:[0,0,0] op_sel_hi:[0,1,1]
    s_set_gpr_idx_off
    s_waitcnt vmcnt(0)
    v_mfma_f32_4x4x4_16b_bf16 v[96:99], v[140:141], v[64:65], 0 cbsz:4 abid:8
    v_mfma_f32_4x4x4_16b_bf16 v[120:123], v[172:173], v[178:179], v[120:123] cbsz:4 abid:9
    v_exp_f32 v136, v116
    v_exp_f32 v137, v117
    s_nop 0
    v_pk_add_f32 v[136:137], v[136:137], 1.0 op_sel_hi:[1,0]
    v_mfma_f32_4x4x4_16b_bf16 v[100:103], v[140:141], v[66:67], 0 cbsz:4 abid:8
    v_rcp_f32 v136, v136
    v_rcp_f32 v137, v137
    s_nop 0
    v_pk_mul_f32 v[130:131], v[136:137], v[116:117]
    s_set_gpr_idx_on s63, 0xc
    v_pk_fma_f32 v[16:17], v[132:133], v[104:105], v[16:17] op_sel:[1,0,0] op_sel_hi:[1,1,1]
    v_pk_fma_f32 v[18:19], v[132:133], v[106:107], v[18:19] op_sel:[1,0,0] op_sel_hi:[1,1,1]
    v_pk_fma_f32 v[20:21], v[134:135], v[108:109], v[20:21] op_sel:[1,0,0] op_sel_hi:[1,1,1]
    v_pk_fma_f32 v[22:23], v[134:135], v[110:111], v[22:23] op_sel:[1,0,0] op_sel_hi:[1,1,1]
    s_set_gpr_idx_off
B_32:
    s_sub_u32 s32, s32, 4
    s_cbranch_scc1 MAIN_DONE
    s_waitcnt vmcnt(2)
    v_mfma_f32_4x4x4_16b_bf16 v[104:107], v[142:143], v[68:69], 0 cbsz:4 abid:8
    v_mfma_f32_4x4x4_16b_bf16 v[124:127], v[172:173], v[180:181], 0 cbsz:4 abid:9
    v_exp_f32 v136, v114
    v_exp_f32 v137, v115
    s_nop 0
    v_pk_add_f32 v[136:137], v[136:137], 1.0 op_sel_hi:[1,0]
    v_mfma_f32_4x4x4_16b_bf16 v[108:111], v[142:143], v[70:71], 0 cbsz:4 abid:8
    v_rcp_f32 v136, v136
    v_rcp_f32 v137, v137
    s_nop 0
    v_pk_mul_f32 v[132:133], v[136:137], v[114:115]
    s_set_gpr_idx_on s48, 0xc
    v_pk_fma_f32 v[16:17], v[128:129], v[96:97], v[16:17] op_sel:[0,0,0] op_sel_hi:[0,1,1]
    v_pk_fma_f32 v[18:19], v[128:129], v[98:99], v[18:19] op_sel:[0,0,0] op_sel_hi:[0,1,1]
    v_pk_fma_f32 v[20:21], v[130:131], v[100:101], v[20:21] op_sel:[0,0,0] op_sel_hi:[0,1,1]
    v_pk_fma_f32 v[22:23], v[130:131], v[102:103], v[22:23] op_sel:[0,0,0] op_sel_hi:[0,1,1]
    s_set_gpr_idx_off
    s_waitcnt vmcnt(1)
    v_mfma_f32_4x4x4_16b_bf16 v[96:99], v[144:145], v[72:73], 0 cbsz:4 abid:8
    v_mfma_f32_4x4x4_16b_bf16 v[124:127], v[172:173], v[182:183], v[124:127] cbsz:4 abid:9
    v_exp_f32 v136, v118
    v_exp_f32 v137, v119
    s_nop 0
    v_pk_add_f32 v[136:137], v[136:137], 1.0 op_sel_hi:[1,0]
    v_mfma_f32_4x4x4_16b_bf16 v[100:103], v[144:145], v[74:75], 0 cbsz:4 abid:8
    v_rcp_f32 v136, v136
    v_rcp_f32 v137, v137
    s_nop 0
    v_pk_mul_f32 v[134:135], v[136:137], v[118:119]
    s_set_gpr_idx_on s49, 0xc
    v_pk_fma_f32 v[16:17], v[128:129], v[104:105], v[16:17] op_sel:[1,0,0] op_sel_hi:[1,1,1]
    v_pk_fma_f32 v[18:19], v[128:129], v[106:107], v[18:19] op_sel:[1,0,0] op_sel_hi:[1,1,1]
    v_pk_fma_f32 v[20:21], v[130:131], v[108:109], v[20:21] op_sel:[1,0,0] op_sel_hi:[1,1,1]
    v_pk_fma_f32 v[22:23], v[130:131], v[110:111], v[22:23] op_sel:[1,0,0] op_sel_hi:[1,1,1]
    s_set_gpr_idx_off
    s_waitcnt vmcnt(0)
    v_mfma_f32_4x4x4_16b_bf16 v[104:107], v[146:147], v[76:77], 0 cbsz:4 abid:8
    v_mfma_f32_4x4x4_16b_bf16 v[112:115], v[172:173], v[176:177], 0 cbsz:4 abid:10
    v_exp_f32 v136, v120
    v_exp_f32 v137, v121
    s_nop 0
    v_pk_add_f32 v[136:137], v[136:137], 1.0 op_sel_hi:[1,0]
    v_mfma_f32_4x4x4_16b_bf16 v[108:111], v[146:147], v[78:79], 0 cbsz:4 abid:8
    v_rcp_f32 v136, v136
    v_rcp_f32 v137, v137
    s_nop 0
    v_pk_mul_f32 v[128:129], v[136:137], v[120:121]
    s_set_gpr_idx_on s50, 0xc
    v_pk_fma_f32 v[16:17], v[132:133], v[96:97], v[16:17] op_sel:[0,0,0] op_sel_hi:[0,1,1]
    v_pk_fma_f32 v[18:19], v[132:133], v[98:99], v[18:19] op_sel:[0,0,0] op_sel_hi:[0,1,1]
    v_pk_fma_f32 v[20:21], v[134:135], v[100:101], v[20:21] op_sel:[0,0,0] op_sel_hi:[0,1,1]
    v_pk_fma_f32 v[22:23], v[134:135], v[102:103], v[22:23] op_sel:[0,0,0] op_sel_hi:[0,1,1]
    s_set_gpr_idx_off
    s_waitcnt vmcnt(0)
    v_mfma_f32_4x4x4_16b_bf16 v[96:99], v[140:141], v[80:81], 0 cbsz:4 abid:9
    v_mfma_f32_4x4x4_16b_bf16 v[112:115], v[172:173], v[178:179], v[112:115] cbsz:4 abid:10
    v_exp_f32 v136, v124
    v_exp_f32 v137, v125
    s_nop 0
    v_pk_add_f32 v[136:137], v[136:137], 1.0 op_sel_hi:[1,0]
    v_mfma_f32_4x4x4_16b_bf16 v[100:103], v[140:141], v[82:83], 0 cbsz:4 abid:9
    v_rcp_f32 v136, v136
    v_rcp_f32 v137, v137
    s_nop 0
    v_pk_mul_f32 v[130:131], v[136:137], v[124:125]
    s_set_gpr_idx_on s51, 0xc
    v_pk_fma_f32 v[16:17], v[132:133], v[104:105], v[16:17] op_sel:[1,0,0] op_sel_hi:[1,1,1]
    v_pk_fma_f32 v[18:19], v[132:133], v[106:107], v[18:19] op_sel:[1,0,0] op_sel_hi:[1,1,1]
    v_pk_fma_f32 v[20:21], v[134:135], v[108:109], v[20:21] op_sel:[1,0,0] op_sel_hi:[1,1,1]
    v_pk_fma_f32 v[22:23], v[134:135], v[110:111], v[22:23] op_sel:[1,0,0] op_sel_hi:[1,1,1]
    s_set_gpr_idx_off
B_36:
    s_sub_u32 s32, s32, 4
    s_cbranch_scc1 MAIN_DONE
    s_waitcnt vmcnt(2)
    v_mfma_f32_4x4x4_16b_bf16 v[104:107], v[142:143], v[84:85], 0 cbsz:4 abid:9
    v_mfma_f32_4x4x4_16b_bf16 v[116:119], v[172:173], v[180:181], 0 cbsz:4 abid:10
    v_exp_f32 v136, v122
    v_exp_f32 v137, v123
    s_nop 0
    v_pk_add_f32 v[136:137], v[136:137], 1.0 op_sel_hi:[1,0]
    v_mfma_f32_4x4x4_16b_bf16 v[108:111], v[142:143], v[86:87], 0 cbsz:4 abid:9
    v_rcp_f32 v136, v136
    v_rcp_f32 v137, v137
    s_nop 0
    v_pk_mul_f32 v[132:133], v[136:137], v[122:123]
    s_set_gpr_idx_on s52, 0xc
    v_pk_fma_f32 v[16:17], v[128:129], v[96:97], v[16:17] op_sel:[0,0,0] op_sel_hi:[0,1,1]
    v_pk_fma_f32 v[18:19], v[128:129], v[98:99], v[18:19] op_sel:[0,0,0] op_sel_hi:[0,1,1]
    v_pk_fma_f32 v[20:21], v[130:131], v[100:101], v[20:21] op_sel:[0,0,0] op_sel_hi:[0,1,1]
    v_pk_fma_f32 v[22:23], v[130:131], v[102:103], v[22:23] op_sel:[0,0,0] op_sel_hi:[0,1,1]
    s_set_gpr_idx_off
    s_waitcnt vmcnt(1)
    v_mfma_f32_4x4x4_16b_bf16 v[96:99], v[144:145], v[88:89], 0 cbsz:4 abid:9
    v_mfma_f32_4x4x4_16b_bf16 v[116:119], v[172:173], v[182:183], v[116:119] cbsz:4 abid:10
    v_exp_f32 v136, v126
    v_exp_f32 v137, v127
    s_nop 0
    v_pk_add_f32 v[136:137], v[136:137], 1.0 op_sel_hi:[1,0]
    v_mfma_f32_4x4x4_16b_bf16 v[100:103], v[144:145], v[90:91], 0 cbsz:4 abid:9
    v_rcp_f32 v136, v136
    v_rcp_f32 v137, v137
    s_nop 0
    v_pk_mul_f32 v[134:135], v[136:137], v[126:127]
    s_set_gpr_idx_on s53, 0xc
    v_pk_fma_f32 v[16:17], v[128:129], v[104:105], v[16:17] op_sel:[1,0,0] op_sel_hi:[1,1,1]
    v_pk_fma_f32 v[18:19], v[128:129], v[106:107], v[18:19] op_sel:[1,0,0] op_sel_hi:[1,1,1]
    v_pk_fma_f32 v[20:21], v[130:131], v[108:109], v[20:21] op_sel:[1,0,0] op_sel_hi:[1,1,1]
    v_pk_fma_f32 v[22:23], v[130:131], v[110:111], v[22:23] op_sel:[1,0,0] op_sel_hi:[1,1,1]
    s_set_gpr_idx_off
    s_waitcnt vmcnt(0)
    v_mfma_f32_4x4x4_16b_bf16 v[104:107], v[146:147], v[92:93], 0 cbsz:4 abid:9
    v_mfma_f32_4x4x4_16b_bf16 v[120:123], v[172:173], v[176:177], 0 cbsz:4 abid:11
    v_exp_f32 v136, v112
    v_exp_f32 v137, v113
    s_nop 0
    v_pk_add_f32 v[136:137], v[136:137], 1.0 op_sel_hi:[1,0]
    v_mfma_f32_4x4x4_16b_bf16 v[108:111], v[146:147], v[94:95], 0 cbsz:4 abid:9
    v_rcp_f32 v136, v136
    v_rcp_f32 v137, v137
    s_nop 0
    v_pk_mul_f32 v[128:129], v[136:137], v[112:113]
    s_set_gpr_idx_on s54, 0xc
    v_pk_fma_f32 v[16:17], v[132:133], v[96:97], v[16:17] op_sel:[0,0,0] op_sel_hi:[0,1,1]
    v_pk_fma_f32 v[18:19], v[132:133], v[98:99], v[18:19] op_sel:[0,0,0] op_sel_hi:[0,1,1]
    v_pk_fma_f32 v[20:21], v[134:135], v[100:101], v[20:21] op_sel:[0,0,0] op_sel_hi:[0,1,1]
    v_pk_fma_f32 v[22:23], v[134:135], v[102:103], v[22:23] op_sel:[0,0,0] op_sel_hi:[0,1,1]
    s_set_gpr_idx_off
    s_waitcnt vmcnt(0)
    v_mfma_f32_4x4x4_16b_bf16 v[96:99], v[140:141], v[64:65], 0 cbsz:4 abid:10
    v_mfma_f32_4x4x4_16b_bf16 v[120:123], v[172:173], v[178:179], v[120:123] cbsz:4 abid:11
    v_exp_f32 v136, v116
    v_exp_f32 v137, v117
    s_nop 0
    v_pk_add_f32 v[136:137], v[136:137], 1.0 op_sel_hi:[1,0]
    v_mfma_f32_4x4x4_16b_bf16 v[100:103], v[140:141], v[66:67], 0 cbsz:4 abid:10
    v_rcp_f32 v136, v136
    v_rcp_f32 v137, v137
    s_nop 0
    v_pk_mul_f32 v[130:131], v[136:137], v[116:117]
    s_set_gpr_idx_on s55, 0xc
    v_pk_fma_f32 v[16:17], v[132:133], v[104:105], v[16:17] op_sel:[1,0,0] op_sel_hi:[1,1,1]
    v_pk_fma_f32 v[18:19], v[132:133], v[106:107], v[18:19] op_sel:[1,0,0] op_sel_hi:[1,1,1]
    v_pk_fma_f32 v[20:21], v[134:135], v[108:109], v[20:21] op_sel:[1,0,0] op_sel_hi:[1,1,1]
    v_pk_fma_f32 v[22:23], v[134:135], v[110:111], v[22:23] op_sel:[1,0,0] op_sel_hi:[1,1,1]
    s_set_gpr_idx_off
B_40:
    s_sub_u32 s32, s32, 4
    s_cbranch_scc1 MAIN_DONE
    s_waitcnt vmcnt(2)
    v_mfma_f32_4x4x4_16b_bf16 v[104:107], v[142:143], v[68:69], 0 cbsz:4 abid:10
    v_mfma_f32_4x4x4_16b_bf16 v[124:127], v[172:173], v[180:181], 0 cbsz:4 abid:11
    v_exp_f32 v136, v114
    v_exp_f32 v137, v115
    s_nop 0
    v_pk_add_f32 v[136:137], v[136:137], 1.0 op_sel_hi:[1,0]
    v_mfma_f32_4x4x4_16b_bf16 v[108:111], v[142:143], v[70:71], 0 cbsz:4 abid:10
    v_mfma_f32_4x4x4_16b_bf16 v[148:151], v[168:169], v[184:185], 0
    v_rcp_f32 v136, v136
    v_rcp_f32 v137, v137
    s_nop 0
    v_pk_mul_f32 v[132:133], v[136:137], v[114:115]
    s_set_gpr_idx_on s56, 0xc
    v_pk_fma_f32 v[16:17], v[128:129], v[96:97], v[16:17] op_sel:[0,0,0] op_sel_hi:[0,1,1]
    v_pk_fma_f32 v[18:19], v[128:129], v[98:99], v[18:19] op_sel:[0,0,0] op_sel_hi:[0,1,1]
    v_pk_fma_f32 v[20:21], v[130:131], v[100:101], v[20:21] op_sel:[0,0,0] op_sel_hi:[0,1,1]
    v_pk_fma_f32 v[22:23], v[130:131], v[102:103], v[22:23] op_sel:[0,0,0] op_sel_hi:[0,1,1]
    s_set_gpr_idx_off
    s_waitcnt vmcnt(1)
    v_mfma_f32_4x4x4_16b_bf16 v[96:99], v[144:145], v[72:73], 0 cbsz:4 abid:10
    v_mfma_f32_4x4x4_16b_bf16 v[124:127], v[172:173], v[182:183], v[124:127] cbsz:4 abid:11
    v_exp_f32 v136, v118
    v_exp_f32 v137, v119
    s_nop 0
    v_pk_add_f32 v[136:137], v[136:137], 1.0 op_sel_hi:[1,0]
    v_mfma_f32_4x4x4_16b_bf16 v[100:103], v[144:145], v[74:75], 0 cbsz:4 abid:10
    v_mfma_f32_4x4x4_16b_bf16 v[152:155], v[168:169], v[186:187], 0
    v_rcp_f32 v136, v136
    v_rcp_f32 v137, v137
    s_nop 0
    v_pk_mul_f32 v[134:135], v[136:137], v[118:119]
    s_set_gpr_idx_on s57, 0xc
    v_pk_fma_f32 v[16:17], v[128:129], v[104:105], v[16:17] op_sel:[1,0,0] op_sel_hi:[1,1,1]
    v_pk_fma_f32 v[18:19], v[128:129], v[106:107], v[18:19] op_sel:[1,0,0] op_sel_hi:[1,1,1]
    v_pk_fma_f32 v[20:21], v[130:131], v[108:109], v[20:21] op_sel:[1,0,0] op_sel_hi:[1,1,1]
    v_pk_fma_f32 v[22:23], v[130:131], v[110:111], v[22:23] op_sel:[1,0,0] op_sel_hi:[1,1,1]
    s_set_gpr_idx_off
    s_waitcnt vmcnt(0)
    v_mfma_f32_4x4x4_16b_bf16 v[104:107], v[146:147], v[76:77], 0 cbsz:4 abid:10
    v_mfma_f32_4x4x4_16b_bf16 v[112:115], v[172:173], v[176:177], 0 cbsz:4 abid:12
    v_exp_f32 v136, v120
    v_exp_f32 v137, v121
    s_nop 0
    v_pk_add_f32 v[136:137], v[136:137], 1.0 op_sel_hi:[1,0]
    v_mfma_f32_4x4x4_16b_bf16 v[108:111], v[146:147], v[78:79], 0 cbsz:4 abid:10
    v_mfma_f32_4x4x4_16b_bf16 v[156:159], v[168:169], v[188:189], 0
    v_rcp_f32 v136, v136
    v_rcp_f32 v137, v137
    s_nop 0
    v_pk_mul_f32 v[128:129], v[136:137], v[120:121]
    s_set_gpr_idx_on s58, 0xc
    v_pk_fma_f32 v[16:17], v[132:133], v[96:97], v[16:17] op_sel:[0,0,0] op_sel_hi:[0,1,1]
    v_pk_fma_f32 v[18:19], v[132:133], v[98:99], v[18:19] op_sel:[0,0,0] op_sel_hi:[0,1,1]
    v_pk_fma_f32 v[20:21], v[134:135], v[100:101], v[20:21] op_sel:[0,0,0] op_sel_hi:[0,1,1]
    v_pk_fma_f32 v[22:23], v[134:135], v[102:103], v[22:23] op_sel:[0,0,0] op_sel_hi:[0,1,1]
    s_set_gpr_idx_off
    s_waitcnt vmcnt(0)
    v_mfma_f32_4x4x4_16b_bf16 v[96:99], v[140:141], v[80:81], 0 cbsz:4 abid:11
    v_mfma_f32_4x4x4_16b_bf16 v[112:115], v[172:173], v[178:179], v[112:115] cbsz:4 abid:12
    v_exp_f32 v136, v124
    v_exp_f32 v137, v125
    s_nop 0
    v_pk_add_f32 v[136:137], v[136:137], 1.0 op_sel_hi:[1,0]
    v_mfma_f32_4x4x4_16b_bf16 v[100:103], v[140:141], v[82:83], 0 cbsz:4 abid:11
    v_mfma_f32_4x4x4_16b_bf16 v[160:163], v[168:169], v[190:191], 0
    v_rcp_f32 v136, v136
    v_rcp_f32 v137, v137
    s_nop 0
    v_pk_mul_f32 v[130:131], v[136:137], v[124:125]
    s_set_gpr_idx_on s59, 0xc
    v_pk_fma_f32 v[16:17], v[132:133], v[104:105], v[16:17] op_sel:[1,0,0] op_sel_hi:[1,1,1]
    v_pk_fma_f32 v[18:19], v[132:133], v[106:107], v[18:19] op_sel:[1,0,0] op_sel_hi:[1,1,1]
    v_pk_fma_f32 v[20:21], v[134:135], v[108:109], v[20:21] op_sel:[1,0,0] op_sel_hi:[1,1,1]
    v_pk_fma_f32 v[22:23], v[134:135], v[110:111], v[22:23] op_sel:[1,0,0] op_sel_hi:[1,1,1]
    s_set_gpr_idx_off
B_44:
    s_sub_u32 s32, s32, 4
    s_cbranch_scc1 MAIN_DONE
    s_waitcnt vmcnt(2)
    v_mfma_f32_4x4x4_16b_bf16 v[104:107], v[142:143], v[84:85], 0 cbsz:4 abid:11
    v_mfma_f32_4x4x4_16b_bf16 v[116:119], v[172:173], v[180:181], 0 cbsz:4 abid:12
    v_exp_f32 v136, v122
    v_exp_f32 v137, v123
    s_nop 0
    v_pk_add_f32 v[136:137], v[136:137], 1.0 op_sel_hi:[1,0]
    v_mfma_f32_4x4x4_16b_bf16 v[108:111], v[142:143], v[86:87], 0 cbsz:4 abid:11
    v_rcp_f32 v136, v136
    v_rcp_f32 v137, v137
    s_nop 0
    v_pk_mul_f32 v[132:133], v[136:137], v[122:123]
    s_set_gpr_idx_on s60, 0xc
    v_pk_fma_f32 v[16:17], v[128:129], v[96:97], v[16:17] op_sel:[0,0,0] op_sel_hi:[0,1,1]
    v_pk_fma_f32 v[18:19], v[128:129], v[98:99], v[18:19] op_sel:[0,0,0] op_sel_hi:[0,1,1]
    v_pk_fma_f32 v[20:21], v[130:131], v[100:101], v[20:21] op_sel:[0,0,0] op_sel_hi:[0,1,1]
    v_pk_fma_f32 v[22:23], v[130:131], v[102:103], v[22:23] op_sel:[0,0,0] op_sel_hi:[0,1,1]
    s_set_gpr_idx_off
    s_waitcnt vmcnt(1)
    v_mfma_f32_4x4x4_16b_bf16 v[96:99], v[144:145], v[88:89], 0 cbsz:4 abid:11
    v_mfma_f32_4x4x4_16b_bf16 v[116:119], v[172:173], v[182:183], v[116:119] cbsz:4 abid:12
    v_exp_f32 v136, v126
    v_exp_f32 v137, v127
    s_nop 0
    v_pk_add_f32 v[136:137], v[136:137], 1.0 op_sel_hi:[1,0]
    v_mfma_f32_4x4x4_16b_bf16 v[100:103], v[144:145], v[90:91], 0 cbsz:4 abid:11
    v_rcp_f32 v136, v136
    v_rcp_f32 v137, v137
    s_nop 0
    v_pk_mul_f32 v[134:135], v[136:137], v[126:127]
    s_set_gpr_idx_on s61, 0xc
    v_pk_fma_f32 v[16:17], v[128:129], v[104:105], v[16:17] op_sel:[1,0,0] op_sel_hi:[1,1,1]
    v_pk_fma_f32 v[18:19], v[128:129], v[106:107], v[18:19] op_sel:[1,0,0] op_sel_hi:[1,1,1]
    v_pk_fma_f32 v[20:21], v[130:131], v[108:109], v[20:21] op_sel:[1,0,0] op_sel_hi:[1,1,1]
    v_pk_fma_f32 v[22:23], v[130:131], v[110:111], v[22:23] op_sel:[1,0,0] op_sel_hi:[1,1,1]
    s_set_gpr_idx_off
    s_waitcnt vmcnt(0)
    v_mfma_f32_4x4x4_16b_bf16 v[104:107], v[146:147], v[92:93], 0 cbsz:4 abid:11
    v_mfma_f32_4x4x4_16b_bf16 v[120:123], v[172:173], v[176:177], 0 cbsz:4 abid:13
    v_exp_f32 v136, v112
    v_exp_f32 v137, v113
    s_nop 0
    v_pk_add_f32 v[136:137], v[136:137], 1.0 op_sel_hi:[1,0]
    v_mfma_f32_4x4x4_16b_bf16 v[108:111], v[146:147], v[94:95], 0 cbsz:4 abid:11
    v_rcp_f32 v136, v136
    v_rcp_f32 v137, v137
    s_nop 0
    v_pk_mul_f32 v[128:129], v[136:137], v[112:113]
    s_set_gpr_idx_on s62, 0xc
    v_pk_fma_f32 v[16:17], v[132:133], v[96:97], v[16:17] op_sel:[0,0,0] op_sel_hi:[0,1,1]
    v_pk_fma_f32 v[18:19], v[132:133], v[98:99], v[18:19] op_sel:[0,0,0] op_sel_hi:[0,1,1]
    v_pk_fma_f32 v[20:21], v[134:135], v[100:101], v[20:21] op_sel:[0,0,0] op_sel_hi:[0,1,1]
    v_pk_fma_f32 v[22:23], v[134:135], v[102:103], v[22:23] op_sel:[0,0,0] op_sel_hi:[0,1,1]
    s_set_gpr_idx_off
    s_waitcnt vmcnt(0)
    v_mfma_f32_4x4x4_16b_bf16 v[96:99], v[140:141], v[64:65], 0 cbsz:4 abid:12
    v_mfma_f32_4x4x4_16b_bf16 v[120:123], v[172:173], v[178:179], v[120:123] cbsz:4 abid:13
    v_exp_f32 v136, v116
    v_exp_f32 v137, v117
    s_nop 0
    v_pk_add_f32 v[136:137], v[136:137], 1.0 op_sel_hi:[1,0]
    v_mfma_f32_4x4x4_16b_bf16 v[100:103], v[140:141], v[66:67], 0 cbsz:4 abid:12
    v_rcp_f32 v136, v136
    v_rcp_f32 v137, v137
    s_nop 0
    v_pk_mul_f32 v[130:131], v[136:137], v[116:117]
    s_set_gpr_idx_on s63, 0xc
    v_pk_fma_f32 v[16:17], v[132:133], v[104:105], v[16:17] op_sel:[1,0,0] op_sel_hi:[1,1,1]
    v_pk_fma_f32 v[18:19], v[132:133], v[106:107], v[18:19] op_sel:[1,0,0] op_sel_hi:[1,1,1]
    v_pk_fma_f32 v[20:21], v[134:135], v[108:109], v[20:21] op_sel:[1,0,0] op_sel_hi:[1,1,1]
    v_pk_fma_f32 v[22:23], v[134:135], v[110:111], v[22:23] op_sel:[1,0,0] op_sel_hi:[1,1,1]
    s_set_gpr_idx_off
B_48:
    s_sub_u32 s32, s32, 4
    s_cbranch_scc1 MAIN_DONE
    s_waitcnt vmcnt(2)
    v_mfma_f32_4x4x4_16b_bf16 v[104:107], v[142:143], v[68:69], 0 cbsz:4 abid:12
    v_mfma_f32_4x4x4_16b_bf16 v[124:127], v[172:173], v[180:181], 0 cbsz:4 abid:13
    v_exp_f32 v136, v114
    v_exp_f32 v137, v115
    s_nop 0
    v_pk_add_f32 v[136:137], v[136:137], 1.0 op_sel_hi:[1,0]
    v_mfma_f32_4x4x4_16b_bf16 v[108:111], v[142:143], v[70:71], 0 cbsz:4 abid:12
    v_rcp_f32 v136, v136
    v_rcp_f32 v137, v137
    s_nop 0
    v_pk_mul_f32 v[132:133], v[136:137], v[114:115]
    s_set_gpr_idx_on s48, 0xc
    v_pk_fma_f32 v[16:17], v[128:129], v[96:97], v[16:17] op_sel:[0,0,0] op_sel_hi:[0,1,1]
    v_pk_fma_f32 v[18:19], v[128:129], v[98:99], v[18:19] op_sel:[0,0,0] op_sel_hi:[0,1,1]
    v_pk_fma_f32 v[20:21], v[130:131], v[100:101], v[20:21] op_sel:[0,0,0] op_sel_hi:[0,1,1]
    v_pk_fma_f32 v[22:23], v[130:131], v[102:103], v[22:23] op_sel:[0,0,0] op_sel_hi:[0,1,1]
    s_set_gpr_idx_off
    s_waitcnt vmcnt(1)
    v_mfma_f32_4x4x4_16b_bf16 v[96:99], v[144:145], v[72:73], 0 cbsz:4 abid:12
    v_mfma_f32_4x4x4_16b_bf16 v[124:127], v[172:173], v[182:183], v[124:127] cbsz:4 abid:13
    v_exp_f32 v136, v118
    v_exp_f32 v137, v119
    s_nop 0
    v_pk_add_f32 v[136:137], v[136:137], 1.0 op_sel_hi:[1,0]
    v_mfma_f32_4x4x4_16b_bf16 v[100:103], v[144:145], v[74:75], 0 cbsz:4 abid:12
    v_rcp_f32 v136, v136
    v_rcp_f32 v137, v137
    s_nop 0
    v_pk_mul_f32 v[134:135], v[136:137], v[118:119]
    s_set_gpr_idx_on s49, 0xc
    v_pk_fma_f32 v[16:17], v[128:129], v[104:105], v[16:17] op_sel:[1,0,0] op_sel_hi:[1,1,1]
    v_pk_fma_f32 v[18:19], v[128:129], v[106:107], v[18:19] op_sel:[1,0,0] op_sel_hi:[1,1,1]
    v_pk_fma_f32 v[20:21], v[130:131], v[108:109], v[20:21] op_sel:[1,0,0] op_sel_hi:[1,1,1]
    v_pk_fma_f32 v[22:23], v[130:131], v[110:111], v[22:23] op_sel:[1,0,0] op_sel_hi:[1,1,1]
    s_set_gpr_idx_off
    s_waitcnt vmcnt(0)
    v_mfma_f32_4x4x4_16b_bf16 v[104:107], v[146:147], v[76:77], 0 cbsz:4 abid:12
    v_mfma_f32_4x4x4_16b_bf16 v[112:115], v[172:173], v[176:177], 0 cbsz:4 abid:14
    v_exp_f32 v136, v120
    v_exp_f32 v137, v121
    s_nop 0
    v_pk_add_f32 v[136:137], v[136:137], 1.0 op_sel_hi:[1,0]
    v_mfma_f32_4x4x4_16b_bf16 v[108:111], v[146:147], v[78:79], 0 cbsz:4 abid:12
    v_rcp_f32 v136, v136
    v_rcp_f32 v137, v137
    s_nop 0
    v_pk_mul_f32 v[128:129], v[136:137], v[120:121]
    s_set_gpr_idx_on s50, 0xc
    v_pk_fma_f32 v[16:17], v[132:133], v[96:97], v[16:17] op_sel:[0,0,0] op_sel_hi:[0,1,1]
    v_pk_fma_f32 v[18:19], v[132:133], v[98:99], v[18:19] op_sel:[0,0,0] op_sel_hi:[0,1,1]
    v_pk_fma_f32 v[20:21], v[134:135], v[100:101], v[20:21] op_sel:[0,0,0] op_sel_hi:[0,1,1]
    v_pk_fma_f32 v[22:23], v[134:135], v[102:103], v[22:23] op_sel:[0,0,0] op_sel_hi:[0,1,1]
    s_set_gpr_idx_off
    s_waitcnt vmcnt(0)
    v_mfma_f32_4x4x4_16b_bf16 v[96:99], v[140:141], v[80:81], 0 cbsz:4 abid:13
    v_mfma_f32_4x4x4_16b_bf16 v[112:115], v[172:173], v[178:179], v[112:115] cbsz:4 abid:14
    v_exp_f32 v136, v124
    v_exp_f32 v137, v125
    s_nop 0
    v_pk_add_f32 v[136:137], v[136:137], 1.0 op_sel_hi:[1,0]
    v_mfma_f32_4x4x4_16b_bf16 v[100:103], v[140:141], v[82:83], 0 cbsz:4 abid:13
    v_rcp_f32 v136, v136
    v_rcp_f32 v137, v137
    s_nop 0
    v_pk_mul_f32 v[130:131], v[136:137], v[124:125]
    s_set_gpr_idx_on s51, 0xc
    v_pk_fma_f32 v[16:17], v[132:133], v[104:105], v[16:17] op_sel:[1,0,0] op_sel_hi:[1,1,1]
    v_pk_fma_f32 v[18:19], v[132:133], v[106:107], v[18:19] op_sel:[1,0,0] op_sel_hi:[1,1,1]
    v_pk_fma_f32 v[20:21], v[134:135], v[108:109], v[20:21] op_sel:[1,0,0] op_sel_hi:[1,1,1]
    v_pk_fma_f32 v[22:23], v[134:135], v[110:111], v[22:23] op_sel:[1,0,0] op_sel_hi:[1,1,1]
    s_set_gpr_idx_off
B_52:
    s_sub_u32 s32, s32, 4
    s_cbranch_scc1 MAIN_DONE
    s_waitcnt vmcnt(2)
    v_mfma_f32_4x4x4_16b_bf16 v[104:107], v[142:143], v[84:85], 0 cbsz:4 abid:13
    v_mfma_f32_4x4x4_16b_bf16 v[116:119], v[172:173], v[180:181], 0 cbsz:4 abid:14
    v_exp_f32 v136, v122
    v_exp_f32 v137, v123
    s_nop 0
    v_pk_add_f32 v[136:137], v[136:137], 1.0 op_sel_hi:[1,0]
    v_mfma_f32_4x4x4_16b_bf16 v[108:111], v[142:143], v[86:87], 0 cbsz:4 abid:13
    v_rcp_f32 v136, v136
    v_rcp_f32 v137, v137
    s_nop 0
    v_pk_mul_f32 v[132:133], v[136:137], v[122:123]
    s_set_gpr_idx_on s52, 0xc
    v_pk_fma_f32 v[16:17], v[128:129], v[96:97], v[16:17] op_sel:[0,0,0] op_sel_hi:[0,1,1]
    v_pk_fma_f32 v[18:19], v[128:129], v[98:99], v[18:19] op_sel:[0,0,0] op_sel_hi:[0,1,1]
    v_pk_fma_f32 v[20:21], v[130:131], v[100:101], v[20:21] op_sel:[0,0,0] op_sel_hi:[0,1,1]
    v_pk_fma_f32 v[22:23], v[130:131], v[102:103], v[22:23] op_sel:[0,0,0] op_sel_hi:[0,1,1]
    s_set_gpr_idx_off
    s_waitcnt vmcnt(1)
    v_mfma_f32_4x4x4_16b_bf16 v[96:99], v[144:145], v[88:89], 0 cbsz:4 abid:13
    v_mfma_f32_4x4x4_16b_bf16 v[116:119], v[172:173], v[182:183], v[116:119] cbsz:4 abid:14
    v_exp_f32 v136, v126
    v_exp_f32 v137, v127
    s_nop 0
    v_pk_add_f32 v[136:137], v[136:137], 1.0 op_sel_hi:[1,0]
    v_mfma_f32_4x4x4_16b_bf16 v[100:103], v[144:145], v[90:91], 0 cbsz:4 abid:13
    v_rcp_f32 v136, v136
    v_rcp_f32 v137, v137
    s_nop 0
    v_pk_mul_f32 v[134:135], v[136:137], v[126:127]
    s_set_gpr_idx_on s53, 0xc
    v_pk_fma_f32 v[16:17], v[128:129], v[104:105], v[16:17] op_sel:[1,0,0] op_sel_hi:[1,1,1]
    v_pk_fma_f32 v[18:19], v[128:129], v[106:107], v[18:19] op_sel:[1,0,0] op_sel_hi:[1,1,1]
    v_pk_fma_f32 v[20:21], v[130:131], v[108:109], v[20:21] op_sel:[1,0,0] op_sel_hi:[1,1,1]
    v_pk_fma_f32 v[22:23], v[130:131], v[110:111], v[22:23] op_sel:[1,0,0] op_sel_hi:[1,1,1]
    s_set_gpr_idx_off
    s_waitcnt vmcnt(0)
    v_mfma_f32_4x4x4_16b_bf16 v[104:107], v[146:147], v[92:93], 0 cbsz:4 abid:13
    v_mfma_f32_4x4x4_16b_bf16 v[120:123], v[172:173], v[176:177], 0 cbsz:4 abid:15
    v_exp_f32 v136, v112
    v_exp_f32 v137, v113
    s_nop 0
    v_pk_add_f32 v[136:137], v[136:137], 1.0 op_sel_hi:[1,0]
    v_mfma_f32_4x4x4_16b_bf16 v[108:111], v[146:147], v[94:95], 0 cbsz:4 abid:13
    v_rcp_f32 v136, v136
    v_rcp_f32 v137, v137
    s_nop 0
    v_pk_mul_f32 v[128:129], v[136:137], v[112:113]
    s_set_gpr_idx_on s54, 0xc
    v_pk_fma_f32 v[16:17], v[132:133], v[96:97], v[16:17] op_sel:[0,0,0] op_sel_hi:[0,1,1]
    v_pk_fma_f32 v[18:19], v[132:133], v[98:99], v[18:19] op_sel:[0,0,0] op_sel_hi:[0,1,1]
    v_pk_fma_f32 v[20:21], v[134:135], v[100:101], v[20:21] op_sel:[0,0,0] op_sel_hi:[0,1,1]
    v_pk_fma_f32 v[22:23], v[134:135], v[102:103], v[22:23] op_sel:[0,0,0] op_sel_hi:[0,1,1]
    s_set_gpr_idx_off
    s_waitcnt vmcnt(0)
    v_mfma_f32_4x4x4_16b_bf16 v[96:99], v[140:141], v[64:65], 0 cbsz:4 abid:14
    v_mfma_f32_4x4x4_16b_bf16 v[120:123], v[172:173], v[178:179], v[120:123] cbsz:4 abid:15
    v_exp_f32 v136, v116
    v_exp_f32 v137, v117
    s_nop 0
    v_pk_add_f32 v[136:137], v[136:137], 1.0 op_sel_hi:[1,0]
    v_mfma_f32_4x4x4_16b_bf16 v[100:103], v[140:141], v[66:67], 0 cbsz:4 abid:14
    v_rcp_f32 v136, v136
    v_rcp_f32 v137, v137
    s_nop 0
    v_pk_mul_f32 v[130:131], v[136:137], v[116:117]
    s_set_gpr_idx_on s55, 0xc
    v_pk_fma_f32 v[16:17], v[132:133], v[104:105], v[16:17] op_sel:[1,0,0] op_sel_hi:[1,1,1]
    v_pk_fma_f32 v[18:19], v[132:133], v[106:107], v[18:19] op_sel:[1,0,0] op_sel_hi:[1,1,1]
    v_pk_fma_f32 v[20:21], v[134:135], v[108:109], v[20:21] op_sel:[1,0,0] op_sel_hi:[1,1,1]
    v_pk_fma_f32 v[22:23], v[134:135], v[110:111], v[22:23] op_sel:[1,0,0] op_sel_hi:[1,1,1]
    s_set_gpr_idx_off
B_56:
    s_sub_u32 s32, s32, 4
    s_cbranch_scc1 MAIN_DONE
    s_waitcnt vmcnt(2)
    v_mfma_f32_4x4x4_16b_bf16 v[104:107], v[142:143], v[68:69], 0 cbsz:4 abid:14
    v_mfma_f32_4x4x4_16b_bf16 v[124:127], v[172:173], v[180:181], 0 cbsz:4 abid:15
    v_exp_f32 v136, v114
    v_exp_f32 v137, v115
    s_nop 0
    v_pk_add_f32 v[136:137], v[136:137], 1.0 op_sel_hi:[1,0]
    v_mfma_f32_4x4x4_16b_bf16 v[108:111], v[142:143], v[70:71], 0 cbsz:4 abid:14
    v_rcp_f32 v136, v136
    v_rcp_f32 v137, v137
    s_nop 0
    v_pk_mul_f32 v[132:133], v[136:137], v[114:115]
    s_set_gpr_idx_on s56, 0xc
    v_pk_fma_f32 v[16:17], v[128:129], v[96:97], v[16:17] op_sel:[0,0,0] op_sel_hi:[0,1,1]
    v_pk_fma_f32 v[18:19], v[128:129], v[98:99], v[18:19] op_sel:[0,0,0] op_sel_hi:[0,1,1]
    v_pk_fma_f32 v[20:21], v[130:131], v[100:101], v[20:21] op_sel:[0,0,0] op_sel_hi:[0,1,1]
    v_pk_fma_f32 v[22:23], v[130:131], v[102:103], v[22:23] op_sel:[0,0,0] op_sel_hi:[0,1,1]
    s_set_gpr_idx_off
    s_waitcnt vmcnt(1)
    v_mfma_f32_4x4x4_16b_bf16 v[96:99], v[144:145], v[72:73], 0 cbsz:4 abid:14
    v_mfma_f32_4x4x4_16b_bf16 v[124:127], v[172:173], v[182:183], v[124:127] cbsz:4 abid:15
    v_exp_f32 v136, v118
    v_exp_f32 v137, v119
    s_nop 0
    v_pk_add_f32 v[136:137], v[136:137], 1.0 op_sel_hi:[1,0]
    v_mfma_f32_4x4x4_16b_bf16 v[100:103], v[144:145], v[74:75], 0 cbsz:4 abid:14
    v_rcp_f32 v136, v136
    v_rcp_f32 v137, v137
    s_nop 0
    v_pk_mul_f32 v[134:135], v[136:137], v[118:119]
    s_set_gpr_idx_on s57, 0xc
    v_pk_fma_f32 v[16:17], v[128:129], v[104:105], v[16:17] op_sel:[1,0,0] op_sel_hi:[1,1,1]
    v_pk_fma_f32 v[18:19], v[128:129], v[106:107], v[18:19] op_sel:[1,0,0] op_sel_hi:[1,1,1]
    v_pk_fma_f32 v[20:21], v[130:131], v[108:109], v[20:21] op_sel:[1,0,0] op_sel_hi:[1,1,1]
    v_pk_fma_f32 v[22:23], v[130:131], v[110:111], v[22:23] op_sel:[1,0,0] op_sel_hi:[1,1,1]
    s_set_gpr_idx_off
    v_mov_b32 v172, v170
    v_mov_b32 v173, v171
    s_waitcnt vmcnt(0)
    v_mfma_f32_4x4x4_16b_bf16 v[104:107], v[146:147], v[76:77], 0 cbsz:4 abid:14
    v_mfma_f32_4x4x4_16b_bf16 v[112:115], v[172:173], v[176:177], 0 cbsz:4 abid:0
    v_exp_f32 v136, v120
    v_exp_f32 v137, v121
    s_nop 0
    v_pk_add_f32 v[136:137], v[136:137], 1.0 op_sel_hi:[1,0]
    v_mfma_f32_4x4x4_16b_bf16 v[108:111], v[146:147], v[78:79], 0 cbsz:4 abid:14
    v_rcp_f32 v136, v136
    v_rcp_f32 v137, v137
    s_nop 0
    v_pk_mul_f32 v[128:129], v[136:137], v[120:121]
    s_set_gpr_idx_on s58, 0xc
    v_pk_fma_f32 v[16:17], v[132:133], v[96:97], v[16:17] op_sel:[0,0,0] op_sel_hi:[0,1,1]
    v_pk_fma_f32 v[18:19], v[132:133], v[98:99], v[18:19] op_sel:[0,0,0] op_sel_hi:[0,1,1]
    v_pk_fma_f32 v[20:21], v[134:135], v[100:101], v[20:21] op_sel:[0,0,0] op_sel_hi:[0,1,1]
    v_pk_fma_f32 v[22:23], v[134:135], v[102:103], v[22:23] op_sel:[0,0,0] op_sel_hi:[0,1,1]
    s_set_gpr_idx_off
    s_waitcnt vmcnt(0)
    v_mfma_f32_4x4x4_16b_bf16 v[96:99], v[140:141], v[80:81], 0 cbsz:4 abid:15
    v_mfma_f32_4x4x4_16b_bf16 v[112:115], v[172:173], v[178:179], v[112:115] cbsz:4 abid:0
    v_exp_f32 v136, v124
    v_exp_f32 v137, v125
    s_nop 0
    v_pk_add_f32 v[136:137], v[136:137], 1.0 op_sel_hi:[1,0]
    v_mfma_f32_4x4x4_16b_bf16 v[100:103], v[140:141], v[82:83], 0 cbsz:4 abid:15
    v_rcp_f32 v136, v136
    v_rcp_f32 v137, v137
    s_nop 0
    v_pk_mul_f32 v[130:131], v[136:137], v[124:125]
    s_set_gpr_idx_on s59, 0xc
    v_pk_fma_f32 v[16:17], v[132:133], v[104:105], v[16:17] op_sel:[1,0,0] op_sel_hi:[1,1,1]
    v_pk_fma_f32 v[18:19], v[132:133], v[106:107], v[18:19] op_sel:[1,0,0] op_sel_hi:[1,1,1]
    v_pk_fma_f32 v[20:21], v[134:135], v[108:109], v[20:21] op_sel:[1,0,0] op_sel_hi:[1,1,1]
    v_pk_fma_f32 v[22:23], v[134:135], v[110:111], v[22:23] op_sel:[1,0,0] op_sel_hi:[1,1,1]
    s_set_gpr_idx_off
B_60:
    s_sub_u32 s32, s32, 4
    s_cbranch_scc1 MAIN_DONE
    s_waitcnt vmcnt(2)
    v_mfma_f32_4x4x4_16b_bf16 v[104:107], v[142:143], v[84:85], 0 cbsz:4 abid:15
    v_mfma_f32_4x4x4_16b_bf16 v[116:119], v[172:173], v[180:181], 0 cbsz:4 abid:0
    v_exp_f32 v136, v122
    v_exp_f32 v137, v123
    s_nop 0
    v_pk_add_f32 v[136:137], v[136:137], 1.0 op_sel_hi:[1,0]
    v_mfma_f32_4x4x4_16b_bf16 v[108:111], v[142:143], v[86:87], 0 cbsz:4 abid:15
    v_rcp_f32 v136, v136
    v_rcp_f32 v137, v137
    s_nop 0
    v_pk_mul_f32 v[132:133], v[136:137], v[122:123]
    s_set_gpr_idx_on s60, 0xc
    v_pk_fma_f32 v[16:17], v[128:129], v[96:97], v[16:17] op_sel:[0,0,0] op_sel_hi:[0,1,1]
    v_pk_fma_f32 v[18:19], v[128:129], v[98:99], v[18:19] op_sel:[0,0,0] op_sel_hi:[0,1,1]
    v_pk_fma_f32 v[20:21], v[130:131], v[100:101], v[20:21] op_sel:[0,0,0] op_sel_hi:[0,1,1]
    v_pk_fma_f32 v[22:23], v[130:131], v[102:103], v[22:23] op_sel:[0,0,0] op_sel_hi:[0,1,1]
    s_set_gpr_idx_off
    v_cvt_pk_bf16_f32 v140, v148, v152
    v_cvt_pk_bf16_f32 v141, v156, v160
    s_waitcnt vmcnt(1)
    v_mfma_f32_4x4x4_16b_bf16 v[96:99], v[144:145], v[88:89], 0 cbsz:4 abid:15
    v_mfma_f32_4x4x4_16b_bf16 v[116:119], v[172:173], v[182:183], v[116:119] cbsz:4 abid:0
    v_exp_f32 v136, v126
    v_exp_f32 v137, v127
    s_nop 0
    v_pk_add_f32 v[136:137], v[136:137], 1.0 op_sel_hi:[1,0]
    v_mfma_f32_4x4x4_16b_bf16 v[100:103], v[144:145], v[90:91], 0 cbsz:4 abid:15
    v_rcp_f32 v136, v136
    v_rcp_f32 v137, v137
    s_nop 0
    v_pk_mul_f32 v[134:135], v[136:137], v[126:127]
    s_set_gpr_idx_on s61, 0xc
    v_pk_fma_f32 v[16:17], v[128:129], v[104:105], v[16:17] op_sel:[1,0,0] op_sel_hi:[1,1,1]
    v_pk_fma_f32 v[18:19], v[128:129], v[106:107], v[18:19] op_sel:[1,0,0] op_sel_hi:[1,1,1]
    v_pk_fma_f32 v[20:21], v[130:131], v[108:109], v[20:21] op_sel:[1,0,0] op_sel_hi:[1,1,1]
    v_pk_fma_f32 v[22:23], v[130:131], v[110:111], v[22:23] op_sel:[1,0,0] op_sel_hi:[1,1,1]
    s_set_gpr_idx_off
    v_cvt_pk_bf16_f32 v142, v149, v153
    v_cvt_pk_bf16_f32 v143, v157, v161
    s_waitcnt vmcnt(0)
    v_mfma_f32_4x4x4_16b_bf16 v[104:107], v[146:147], v[92:93], 0 cbsz:4 abid:15
    v_mfma_f32_4x4x4_16b_bf16 v[120:123], v[172:173], v[176:177], 0 cbsz:4 abid:1
    v_exp_f32 v136, v112
    v_exp_f32 v137, v113
    s_nop 0
    v_pk_add_f32 v[136:137], v[136:137], 1.0 op_sel_hi:[1,0]
    v_mfma_f32_4x4x4_16b_bf16 v[108:111], v[146:147], v[94:95], 0 cbsz:4 abid:15
    v_rcp_f32 v136, v136
    v_rcp_f32 v137, v137
    s_nop 0
    v_pk_mul_f32 v[128:129], v[136:137], v[112:113]
    s_set_gpr_idx_on s62, 0xc
    v_pk_fma_f32 v[16:17], v[132:133], v[96:97], v[16:17] op_sel:[0,0,0] op_sel_hi:[0,1,1]
    v_pk_fma_f32 v[18:19], v[132:133], v[98:99], v[18:19] op_sel:[0,0,0] op_sel_hi:[0,1,1]
    v_pk_fma_f32 v[20:21], v[134:135], v[100:101], v[20:21] op_sel:[0,0,0] op_sel_hi:[0,1,1]
    v_pk_fma_f32 v[22:23], v[134:135], v[102:103], v[22:23] op_sel:[0,0,0] op_sel_hi:[0,1,1]
    s_set_gpr_idx_off
    v_cvt_pk_bf16_f32 v144, v150, v154
    v_cvt_pk_bf16_f32 v145, v158, v162
    s_waitcnt vmcnt(0)
    v_mfma_f32_4x4x4_16b_bf16 v[96:99], v[140:141], v[64:65], 0 cbsz:4 abid:0
    v_mfma_f32_4x4x4_16b_bf16 v[120:123], v[172:173], v[178:179], v[120:123] cbsz:4 abid:1
    v_exp_f32 v136, v116
    v_exp_f32 v137, v117
    s_nop 0
    v_pk_add_f32 v[136:137], v[136:137], 1.0 op_sel_hi:[1,0]
    v_mfma_f32_4x4x4_16b_bf16 v[100:103], v[140:141], v[66:67], 0 cbsz:4 abid:0
    v_rcp_f32 v136, v136
    v_rcp_f32 v137, v137
    s_nop 0
    v_pk_mul_f32 v[130:131], v[136:137], v[116:117]
    s_set_gpr_idx_on s63, 0xc
    v_pk_fma_f32 v[16:17], v[132:133], v[104:105], v[16:17] op_sel:[1,0,0] op_sel_hi:[1,1,1]
    v_pk_fma_f32 v[18:19], v[132:133], v[106:107], v[18:19] op_sel:[1,0,0] op_sel_hi:[1,1,1]
    v_pk_fma_f32 v[20:21], v[134:135], v[108:109], v[20:21] op_sel:[1,0,0] op_sel_hi:[1,1,1]
    v_pk_fma_f32 v[22:23], v[134:135], v[110:111], v[22:23] op_sel:[1,0,0] op_sel_hi:[1,1,1]
    s_set_gpr_idx_off
    v_mov_b32 v164, v166
    v_cvt_pk_bf16_f32 v146, v151, v155
    v_cvt_pk_bf16_f32 v147, v159, v163
    s_branch B_0
MAIN_DONE:
    s_waitcnt vmcnt(0) lgkmcnt(0)
    s_add_u32 s27, s27, 1536
    s_cmp_lt_u32 s27, s26
    s_cbranch_scc1 ROUND
    s_mov_b32 s10, 0xbf317218
    s_mov_b32 s11, 0xbf317218
    s_mul_i32 s42, s25, 1152
    s_add_u32 s42, s42, 47616
    v_lshrrev_b32 v8, 2, v1
    v_add_u32 v8, s42, v8
    v_pk_mul_f32 v[16:17], v[16:17], s[10:11]
    v_pk_mul_f32 v[18:19], v[18:19], s[10:11]
    v_pk_mul_f32 v[20:21], v[20:21], s[10:11]
    v_pk_mul_f32 v[22:23], v[22:23], s[10:11]
    v_cvt_pk_bf16_f32 v64, v16, v20
    ds_write_b32 v8, v64 offset:0
    v_cvt_pk_bf16_f32 v65, v17, v21
    ds_write_b32 v8, v65 offset:288
    v_cvt_pk_bf16_f32 v66, v18, v22
    ds_write_b32 v8, v66 offset:576
    v_cvt_pk_bf16_f32 v67, v19, v23
    ds_write_b32 v8, v67 offset:864
    v_pk_mul_f32 v[24:25], v[24:25], s[10:11]
    v_pk_mul_f32 v[26:27], v[26:27], s[10:11]
    v_pk_mul_f32 v[28:29], v[28:29], s[10:11]
    v_pk_mul_f32 v[30:31], v[30:31], s[10:11]
    v_cvt_pk_bf16_f32 v68, v24, v28
    ds_write_b32 v8, v68 offset:9216
    v_cvt_pk_bf16_f32 v69, v25, v29
    ds_write_b32 v8, v69 offset:9504
    v_cvt_pk_bf16_f32 v70, v26, v30
    ds_write_b32 v8, v70 offset:9792
    v_cvt_pk_bf16_f32 v71, v27, v31
    ds_write_b32 v8, v71 offset:10080
    v_pk_mul_f32 v[32:33], v[32:33], s[10:11]
    v_pk_mul_f32 v[34:35], v[34:35], s[10:11]
    v_pk_mul_f32 v[36:37], v[36:37], s[10:11]
    v_pk_mul_f32 v[38:39], v[38:39], s[10:11]
    v_cvt_pk_bf16_f32 v64, v32, v36
    ds_write_b32 v8, v64 offset:18432
    v_cvt_pk_bf16_f32 v65, v33, v37
    ds_write_b32 v8, v65 offset:18720
    v_cvt_pk_bf16_f32 v66, v34, v38
    ds_write_b32 v8, v66 offset:19008
    v_cvt_pk_bf16_f32 v67, v35, v39
    ds_write_b32 v8, v67 offset:19296
    v_pk_mul_f32 v[40:41], v[40:41], s[10:11]
    v_pk_mul_f32 v[42:43], v[42:43], s[10:11]
    v_pk_mul_f32 v[44:45], v[44:45], s[10:11]
    v_pk_mul_f32 v[46:47], v[46:47], s[10:11]
    v_cvt_pk_bf16_f32 v68, v40, v44
    ds_write_b32 v8, v68 offset:27648
    v_cvt_pk_bf16_f32 v69, v41, v45
    ds_write_b32 v8, v69 offset:27936
    v_cvt_pk_bf16_f32 v70, v42, v46
    ds_write_b32 v8, v70 offset:28224
    v_cvt_pk_bf16_f32 v71, v43, v47
    ds_write_b32 v8, v71 offset:28512
    v_pk_mul_f32 v[48:49], v[48:49], s[10:11]
    v_pk_mul_f32 v[50:51], v[50:51], s[10:11]
    v_pk_mul_f32 v[52:53], v[52:53], s[10:11]
    v_pk_mul_f32 v[54:55], v[54:55], s[10:11]
    v_cvt_pk_bf16_f32 v64, v48, v52
    ds_write_b32 v8, v64 offset:36864
    v_cvt_pk_bf16_f32 v65, v49, v53
    ds_write_b32 v8, v65 offset:37152
    v_cvt_pk_bf16_f32 v66, v50, v54
    ds_write_b32 v8, v66 offset:37440
    v_cvt_pk_bf16_f32 v67, v51, v55
    ds_write_b32 v8, v67 offset:37728
    v_lshrrev_b32 v9, 4, v1
    v_and_b32 v10, 15, v9
    v_lshrrev_b32 v11, 4, v9
    s_lshr_b32 s42, s25, 2
    s_mul_i32 s43, s42, 23040
    s_add_u32 s43, s43, 47616
    v_mul_u32_u24 v8, 288, v10
    v_lshl_add_u32 v8, v11, 4, v8
    v_add_u32 v8, s43, v8
    s_mul_i32 s42, s42, 5242880
    s_lshl_b32 s43, s24, 10
    s_add_u32 s42, s42, s43
    s_and_b32 s43, s25, 3
    s_lshl_b32 s43, s43, 8
    s_add_u32 s42, s42, s43
    v_lshlrev_b32 v11, 18, v11
    v_lshl_add_u32 v11, v10, 4, v11
    v_add_u32 v11, s42, v11
    s_waitcnt lgkmcnt(0)
    s_barrier
    ds_read_b128 v[64:67], v8 offset:0
    ds_read_b128 v[68:71], v8 offset:64
    ds_read_b128 v[72:75], v8 offset:128
    ds_read_b128 v[76:79], v8 offset:192
    ds_read_b128 v[80:83], v8 offset:4608
    ds_read_b128 v[84:87], v8 offset:4672
    ds_read_b128 v[88:91], v8 offset:4736
    ds_read_b128 v[92:95], v8 offset:4800
    s_waitcnt lgkmcnt(7)
    v_mfma_f32_16x16x32_bf16 v[16:19], v[64:67], v[192:195], 0
    v_mfma_f32_16x16x32_bf16 v[20:23], v[64:67], v[208:211], 0
    s_waitcnt lgkmcnt(6)
    v_mfma_f32_16x16x32_bf16 v[16:19], v[68:71], v[196:199], v[16:19]
    v_mfma_f32_16x16x32_bf16 v[20:23], v[68:71], v[212:215], v[20:23]
    s_waitcnt lgkmcnt(5)
    v_mfma_f32_16x16x32_bf16 v[16:19], v[72:75], v[200:203], v[16:19]
    v_mfma_f32_16x16x32_bf16 v[20:23], v[72:75], v[216:219], v[20:23]
    s_waitcnt lgkmcnt(4)
    v_mfma_f32_16x16x32_bf16 v[16:19], v[76:79], v[204:207], v[16:19]
    v_mfma_f32_16x16x32_bf16 v[20:23], v[76:79], v[220:223], v[20:23]
    ds_read_b128 v[64:67], v8 offset:9216
    ds_read_b128 v[68:71], v8 offset:9280
    ds_read_b128 v[72:75], v8 offset:9344
    ds_read_b128 v[76:79], v8 offset:9408
    s_waitcnt lgkmcnt(7)
    v_mfma_f32_16x16x32_bf16 v[24:27], v[80:83], v[192:195], 0
    v_mfma_f32_16x16x32_bf16 v[28:31], v[80:83], v[208:211], 0
    s_waitcnt lgkmcnt(6)
    v_mfma_f32_16x16x32_bf16 v[24:27], v[84:87], v[196:199], v[24:27]
    v_mfma_f32_16x16x32_bf16 v[28:31], v[84:87], v[212:215], v[28:31]
    s_waitcnt lgkmcnt(5)
    v_mfma_f32_16x16x32_bf16 v[24:27], v[88:91], v[200:203], v[24:27]
    v_mfma_f32_16x16x32_bf16 v[28:31], v[88:91], v[216:219], v[28:31]
    s_waitcnt lgkmcnt(4)
    v_mfma_f32_16x16x32_bf16 v[24:27], v[92:95], v[204:207], v[24:27]
    v_mfma_f32_16x16x32_bf16 v[28:31], v[92:95], v[220:223], v[28:31]
    v_cvt_pk_bf16_f32 v96, v16, v17
    v_cvt_pk_bf16_f32 v97, v18, v19
    v_cvt_pk_bf16_f32 v98, v20, v21
    v_cvt_pk_bf16_f32 v99, v22, v23
    buffer_store_dwordx4 v[96:99], v11, s[20:23], 0 offen
    v_add_u32 v11, 1048576, v11
    ds_read_b128 v[80:83], v8 offset:13824
    ds_read_b128 v[84:87], v8 offset:13888
    ds_read_b128 v[88:91], v8 offset:13952
    ds_read_b128 v[92:95], v8 offset:14016
    s_waitcnt lgkmcnt(7)
    v_mfma_f32_16x16x32_bf16 v[32:35], v[64:67], v[192:195], 0
    v_mfma_f32_16x16x32_bf16 v[36:39], v[64:67], v[208:211], 0
    s_waitcnt lgkmcnt(6)
    v_mfma_f32_16x16x32_bf16 v[32:35], v[68:71], v[196:199], v[32:35]
    v_mfma_f32_16x16x32_bf16 v[36:39], v[68:71], v[212:215], v[36:39]
    s_waitcnt lgkmcnt(5)
    v_mfma_f32_16x16x32_bf16 v[32:35], v[72:75], v[200:203], v[32:35]
    v_mfma_f32_16x16x32_bf16 v[36:39], v[72:75], v[216:219], v[36:39]
    s_waitcnt lgkmcnt(4)
    v_mfma_f32_16x16x32_bf16 v[32:35], v[76:79], v[204:207], v[32:35]
    v_mfma_f32_16x16x32_bf16 v[36:39], v[76:79], v[220:223], v[36:39]
    v_cvt_pk_bf16_f32 v100, v24, v25
    v_cvt_pk_bf16_f32 v101, v26, v27
    v_cvt_pk_bf16_f32 v102, v28, v29
    v_cvt_pk_bf16_f32 v103, v30, v31
    buffer_store_dwordx4 v[100:103], v11, s[20:23], 0 offen
    v_add_u32 v11, 1048576, v11
    ds_read_b128 v[64:67], v8 offset:18432
    ds_read_b128 v[68:71], v8 offset:18496
    ds_read_b128 v[72:75], v8 offset:18560
    ds_read_b128 v[76:79], v8 offset:18624
    s_waitcnt lgkmcnt(7)
    v_mfma_f32_16x16x32_bf16 v[40:43], v[80:83], v[192:195], 0
    v_mfma_f32_16x16x32_bf16 v[44:47], v[80:83], v[208:211], 0
    s_waitcnt lgkmcnt(6)
    v_mfma_f32_16x16x32_bf16 v[40:43], v[84:87], v[196:199], v[40:43]
    v_mfma_f32_16x16x32_bf16 v[44:47], v[84:87], v[212:215], v[44:47]
    s_waitcnt lgkmcnt(5)
    v_mfma_f32_16x16x32_bf16 v[40:43], v[88:91], v[200:203], v[40:43]
    v_mfma_f32_16x16x32_bf16 v[44:47], v[88:91], v[216:219], v[44:47]
    s_waitcnt lgkmcnt(4)
    v_mfma_f32_16x16x32_bf16 v[40:43], v[92:95], v[204:207], v[40:43]
    v_mfma_f32_16x16x32_bf16 v[44:47], v[92:95], v[220:223], v[44:47]
    v_cvt_pk_bf16_f32 v96, v32, v33
    v_cvt_pk_bf16_f32 v97, v34, v35
    v_cvt_pk_bf16_f32 v98, v36, v37
    v_cvt_pk_bf16_f32 v99, v38, v39
    buffer_store_dwordx4 v[96:99], v11, s[20:23], 0 offen
    v_add_u32 v11, 1048576, v11
    s_waitcnt lgkmcnt(3)
    v_mfma_f32_16x16x32_bf16 v[48:51], v[64:67], v[192:195], 0
    v_mfma_f32_16x16x32_bf16 v[52:55], v[64:67], v[208:211], 0
    s_waitcnt lgkmcnt(2)
    v_mfma_f32_16x16x32_bf16 v[48:51], v[68:71], v[196:199], v[48:51]
    v_mfma_f32_16x16x32_bf16 v[52:55], v[68:71], v[212:215], v[52:55]
    s_waitcnt lgkmcnt(1)
    v_mfma_f32_16x16x32_bf16 v[48:51], v[72:75], v[200:203], v[48:51]
    v_mfma_f32_16x16x32_bf16 v[52:55], v[72:75], v[216:219], v[52:55]
    s_waitcnt lgkmcnt(0)
    v_mfma_f32_16x16x32_bf16 v[48:51], v[76:79], v[204:207], v[48:51]
    v_mfma_f32_16x16x32_bf16 v[52:55], v[76:79], v[220:223], v[52:55]
    v_cvt_pk_bf16_f32 v100, v40, v41
    v_cvt_pk_bf16_f32 v101, v42, v43
    v_cvt_pk_bf16_f32 v102, v44, v45
    v_cvt_pk_bf16_f32 v103, v46, v47
    buffer_store_dwordx4 v[100:103], v11, s[20:23], 0 offen
    v_add_u32 v11, 1048576, v11
    s_nop 7
    v_cvt_pk_bf16_f32 v96, v48, v49
    v_cvt_pk_bf16_f32 v97, v50, v51
    v_cvt_pk_bf16_f32 v98, v52, v53
    v_cvt_pk_bf16_f32 v99, v54, v55
    buffer_store_dwordx4 v[96:99], v11, s[20:23], 0 offen
K2_END:
    s_endpgm
.section .rodata,"a"
.p2align 6
.amdhsa_kernel bin_kernel
  .amdhsa_next_free_vgpr 56
  .amdhsa_next_free_sgpr 48
  .amdhsa_accum_offset 56
  .amdhsa_group_segment_fixed_size 0
  .amdhsa_kernarg_size 88
  .amdhsa_user_sgpr_count 2
  .amdhsa_user_sgpr_kernarg_segment_ptr 1
  .amdhsa_system_sgpr_workgroup_id_x 1
  .amdhsa_float_denorm_mode_32 3
.end_amdhsa_kernel
.section .rodata,"a"
.p2align 6
.amdhsa_kernel main_kernel
  .amdhsa_next_free_vgpr 224
  .amdhsa_next_free_sgpr 82
  .amdhsa_accum_offset 224
  .amdhsa_group_segment_fixed_size 0
  .amdhsa_kernarg_size 88
  .amdhsa_user_sgpr_count 2
  .amdhsa_user_sgpr_kernarg_segment_ptr 1
  .amdhsa_system_sgpr_workgroup_id_x 1
  .amdhsa_float_denorm_mode_32 3
.end_amdhsa_kernel
```

```asm
; @launch kernel=bin_kernel grid=(255,1,1) block=(320,1,1) lds=27648
; @launch kernel=main_kernel grid=(256,1,1) block=(512,1,1) lds=147328
.amdgcn_target "amdgcn-amd-amdhsa--gfx950"
.text
.globl bin_kernel
.p2align 8
.type bin_kernel,@function
bin_kernel:
    s_cmp_ge_u32 s2, 255
    s_cbranch_scc1 K1_END
    s_load_dwordx4 s[4:7], s[0:1], 8
    s_load_dwordx4 s[8:11], s[0:1], 24
    s_load_dwordx2 s[12:13], s[0:1], 80
    s_load_dwordx4 s[16:19], s[0:1], 40
    s_load_dwordx2 s[20:21], s[0:1], 56
    s_load_dwordx2 s[26:27], s[0:1], 0
    s_cmp_ge_u32 s2, 250
    s_cbranch_scc1 K1_AUX
    s_mul_i32 s14, s2, 5120
    v_lshl_add_u32 v1, v0, 4, s14
    v_lshlrev_b32 v2, 1, v1
    v_lshlrev_b32 v3, 2, v0
    v_mov_b32 v4, 0
    v_mov_b32 v5, 1
    s_waitcnt lgkmcnt(0)
    global_load_dwordx4 v[8:11], v1, s[6:7]
    global_load_dwordx4 v[12:15], v1, s[4:5]
    global_load_dwordx4 v[16:19], v2, s[8:9]
    global_load_dwordx4 v[20:23], v2, s[8:9] offset:16
    global_load_dwordx4 v[24:27], v2, s[10:11]
    global_load_dwordx4 v[28:31], v2, s[10:11] offset:16
    ds_write_b32 v3, v4 offset:0
    s_waitcnt lgkmcnt(0)
    s_barrier
    s_waitcnt vmcnt(5)
    v_and_b32 v32, 0xff, v8
    v_lshlrev_b32 v32, 2, v32
    ds_add_rtn_u32 v36, v32, v5 offset:0
    v_and_b32 v33, 0xff, v9
    v_lshlrev_b32 v33, 2, v33
    ds_add_rtn_u32 v37, v33, v5 offset:0
    v_and_b32 v34, 0xff, v10
    v_lshlrev_b32 v34, 2, v34
    ds_add_rtn_u32 v38, v34, v5 offset:0
    v_and_b32 v35, 0xff, v11
    v_lshlrev_b32 v35, 2, v35
    ds_add_rtn_u32 v39, v35, v5 offset:0
    s_waitcnt vmcnt(4)
    v_lshrrev_b32 v8, 8, v8
    v_lshl_or_b32 v8, v12, 10, v8
    v_lshrrev_b32 v9, 8, v9
    v_lshl_or_b32 v9, v13, 10, v9
    v_lshrrev_b32 v10, 8, v10
    v_lshl_or_b32 v10, v14, 10, v10
    v_lshrrev_b32 v11, 8, v11
    v_lshl_or_b32 v11, v15, 10, v11
    v_and_b32 v6, 63, v0
    v_lshlrev_b32 v6, 4, v6
    s_waitcnt lgkmcnt(0)
    s_barrier
    ds_read_b128 v[40:43], v6 offset:0
    s_waitcnt lgkmcnt(0)
    v_add_u32 v48, v40, v41
    v_add3_u32 v48, v48, v42, v43
    v_mov_b32 v49, v48
    s_nop 1
    v_add_u32_dpp v49, v49, v49 row_shr:1 row_mask:0xf bank_mask:0xf bound_ctrl:0
    s_nop 1
    v_add_u32_dpp v49, v49, v49 row_shr:2 row_mask:0xf bank_mask:0xf bound_ctrl:0
    s_nop 1
    v_add_u32_dpp v49, v49, v49 row_shr:4 row_mask:0xf bank_mask:0xf bound_ctrl:0
    s_nop 1
    v_add_u32_dpp v49, v49, v49 row_shr:8 row_mask:0xf bank_mask:0xf bound_ctrl:0
    s_nop 1
    v_add_u32_dpp v49, v49, v49 row_bcast:15 row_mask:0xa bank_mask:0xf
    s_nop 1
    v_add_u32_dpp v49, v49, v49 row_bcast:31 row_mask:0xc bank_mask:0xf
    v_sub_u32 v44, v49, v48
    v_add_u32 v45, v44, v40
    v_add_u32 v46, v45, v41
    v_add_u32 v47, v46, v42
    ds_write_b128 v6, v[44:47] offset:1024
    v_lshl_or_b32 v52, v40, 16, v44
    v_lshl_or_b32 v53, v41, 16, v45
    v_lshl_or_b32 v54, v42, 16, v46
    v_lshl_or_b32 v55, v43, 16, v47
    ds_read_b32 v40, v32 offset:1024
    ds_read_b32 v41, v33 offset:1024
    ds_read_b32 v42, v34 offset:1024
    ds_read_b32 v43, v35 offset:1024
    s_waitcnt lgkmcnt(3)
    v_add_u32 v36, v36, v40
    v_lshlrev_b32 v32, 2, v36
    v_lshlrev_b32 v36, 4, v36
    s_waitcnt lgkmcnt(2)
    v_add_u32 v37, v37, v41
    v_lshlrev_b32 v33, 2, v37
    v_lshlrev_b32 v37, 4, v37
    s_waitcnt lgkmcnt(1)
    v_add_u32 v38, v38, v42
    v_lshlrev_b32 v34, 2, v38
    v_lshlrev_b32 v38, 4, v38
    s_waitcnt lgkmcnt(0)
    v_add_u32 v39, v39, v43
    v_lshlrev_b32 v35, 2, v39
    v_lshlrev_b32 v39, 4, v39
    ds_write_b32 v32, v8 offset:2048
    ds_write_b32 v33, v9 offset:2048
    ds_write_b32 v34, v10 offset:2048
    ds_write_b32 v35, v11 offset:2048
    s_waitcnt vmcnt(0)
    v_add_u32 v36, 7168, v36
    ds_write2_b64 v36, v[16:17], v[24:25] offset0:0 offset1:1
    v_add_u32 v37, 7168, v37
    ds_write2_b64 v37, v[18:19], v[26:27] offset0:0 offset1:1
    v_add_u32 v38, 7168, v38
    ds_write2_b64 v38, v[20:21], v[28:29] offset0:0 offset1:1
    v_add_u32 v39, 7168, v39
    ds_write2_b64 v39, v[22:23], v[30:31] offset0:0 offset1:1
    v_lshlrev_b32 v3, 4, v0
    s_lshl_b32 s15, s14, 2
    s_add_u32 s15, s15, 1310720
    v_add_u32 v2, s15, v3
    s_waitcnt lgkmcnt(0)
    s_barrier
    ds_read_b128 v[8:11], v3 offset:2048
    ds_read_b128 v[12:15], v3 offset:7168
    ds_read_b128 v[16:19], v3 offset:12288
    ds_read_b128 v[20:23], v3 offset:17408
    ds_read_b128 v[24:27], v3 offset:22528
    s_lshl_b32 s15, s2, 10
    s_add_u32 s15, s15, 7864320
    v_add_u32 v7, s15, v6
    v_cmp_gt_u32 vcc, 64, v0
    s_and_saveexec_b64 s[22:23], vcc
    s_cbranch_execz K1_NOTAB
    global_store_dwordx4 v7, v[52:55], s[12:13] sc0 sc1
K1_NOTAB:
    s_mov_b64 exec, s[22:23]
    s_waitcnt lgkmcnt(4)
    global_store_dwordx4 v1, v[8:11], s[12:13] sc0 sc1
    s_waitcnt lgkmcnt(3)
    global_store_dwordx4 v2, v[12:15], s[12:13] sc0 sc1
    v_add_u32 v2, 5120, v2
    s_waitcnt lgkmcnt(2)
    global_store_dwordx4 v2, v[16:19], s[12:13] sc0 sc1
    v_add_u32 v2, 5120, v2
    s_waitcnt lgkmcnt(1)
    global_store_dwordx4 v2, v[20:23], s[12:13] sc0 sc1
    v_add_u32 v2, 5120, v2
    s_waitcnt lgkmcnt(0)
    global_store_dwordx4 v2, v[24:27], s[12:13] sc0 sc1
    s_endpgm
K1_AUX:
    v_lshrrev_b32 v1, 6, v0
    v_and_b32 v2, 63, v0
    s_nop 0
    v_readfirstlane_b32 s14, v1
    s_cmp_eq_u32 s2, 254
    s_cbranch_scc1 K1_CONST
    s_cmp_ge_u32 s14, 4
    s_cbranch_scc1 K1_END
    s_sub_u32 s15, s2, 250
    s_lshl_b32 s22, s14, 13
    s_lshl_b32 s23, s15, 6
    s_add_u32 s22, s22, s23
    v_lshrrev_b32 v3, 4, v2
    v_lshlrev_b32 v3, 11, v3
    v_and_b32 v4, 15, v2
    v_lshl_add_u32 v3, v4, 2, v3
    v_add_u32 v3, s22, v3
    s_lshl_b32 s22, s15, 13
    s_lshl_b32 s23, s14, 10
    s_add_u32 s22, s22, s23
    s_add_u32 s22, s22, 6492160
    v_lshl_add_u32 v4, v2, 4, s22
    s_mov_b32 s24, 0x05040100
    s_mov_b32 s25, 0x07060302
    s_waitcnt lgkmcnt(0)
    global_load_dword v8, v3, s[20:21] offset:0
    global_load_dword v9, v3, s[20:21] offset:256
    global_load_dword v10, v3, s[20:21] offset:512
    global_load_dword v11, v3, s[20:21] offset:768
    global_load_dword v12, v3, s[20:21] offset:1024
    global_load_dword v13, v3, s[20:21] offset:1280
    global_load_dword v14, v3, s[20:21] offset:1536
    global_load_dword v15, v3, s[20:21] offset:1792
    s_waitcnt vmcnt(0)
    v_perm_b32 v16, v9, v8, s24
    v_perm_b32 v20, v9, v8, s25
    v_perm_b32 v17, v11, v10, s24
    v_perm_b32 v21, v11, v10, s25
    v_perm_b32 v18, v13, v12, s24
    v_perm_b32 v22, v13, v12, s25
    v_perm_b32 v19, v15, v14, s24
    v_perm_b32 v23, v15, v14, s25
    global_store_dwordx4 v4, v[16:19], s[12:13]
    v_add_u32 v4, 4096, v4
    global_store_dwordx4 v4, v[20:23], s[12:13]
    s_endpgm
K1_CONST:
    s_cmp_ge_u32 s14, 1
    s_cbranch_scc1 K1_END
    v_lshlrev_b32 v3, 2, v2
    v_and_b32 v4, 3, v2
    v_lshlrev_b32 v4, 1, v4
    s_mov_b32 s22, 6488064
    v_lshl_add_u32 v5, v2, 4, s22
    s_mov_b32 s24, 0xbfb8aa3b
    s_mov_b32 s25, 0xffff0000
    s_waitcnt lgkmcnt(0)
    global_load_dword v8, v3, s[16:17] offset:0
    global_load_dword v9, v3, s[16:17] offset:256
    global_load_dword v10, v3, s[16:17] offset:512
    global_load_dword v11, v3, s[16:17] offset:768
    global_load_ushort v32, v4, s[18:19] offset:0
    global_load_ushort v33, v4, s[18:19] offset:8
    global_load_ushort v34, v4, s[18:19] offset:16
    global_load_ushort v35, v4, s[18:19] offset:24
    global_load_ushort v36, v4, s[18:19] offset:32
    global_load_ushort v37, v4, s[18:19] offset:40
    global_load_ushort v38, v4, s[18:19] offset:48
    global_load_ushort v39, v4, s[18:19] offset:56
    global_load_ushort v40, v4, s[18:19] offset:64
    global_load_ushort v41, v4, s[18:19] offset:72
    global_load_ushort v42, v4, s[18:19] offset:80
    global_load_ushort v43, v4, s[18:19] offset:88
    global_load_ushort v44, v4, s[18:19] offset:96
    global_load_ushort v45, v4, s[18:19] offset:104
    global_load_ushort v46, v4, s[18:19] offset:112
    global_load_ushort v47, v4, s[18:19] offset:120
    s_waitcnt vmcnt(16)
    v_lshlrev_b32 v12, 16, v8
    v_and_b32 v16, s25, v8
    v_mul_f32 v12, s24, v12
    v_mul_f32 v16, s24, v16
    v_lshlrev_b32 v13, 16, v9
    v_and_b32 v17, s25, v9
    v_mul_f32 v13, s24, v13
    v_mul_f32 v17, s24, v17
    v_lshlrev_b32 v14, 16, v10
    v_and_b32 v18, s25, v10
    v_mul_f32 v14, s24, v14
    v_mul_f32 v18, s24, v18
    v_lshlrev_b32 v15, 16, v11
    v_and_b32 v19, s25, v11
    v_mul_f32 v15, s24, v15
    v_mul_f32 v19, s24, v19
    v_cvt_pk_bf16_f32 v20, v12, v13
    v_cvt_pk_bf16_f32 v21, v14, v15
    v_lshlrev_b32 v28, 16, v20
    v_and_b32 v29, s25, v20
    v_sub_f32 v28, v12, v28
    v_sub_f32 v29, v13, v29
    v_cvt_pk_bf16_f32 v22, v28, v29
    v_lshlrev_b32 v28, 16, v21
    v_and_b32 v29, s25, v21
    v_sub_f32 v28, v14, v28
    v_sub_f32 v29, v15, v29
    v_cvt_pk_bf16_f32 v23, v28, v29
    v_cvt_pk_bf16_f32 v24, v16, v17
    v_cvt_pk_bf16_f32 v25, v18, v19
    v_lshlrev_b32 v28, 16, v24
    v_and_b32 v29, s25, v24
    v_sub_f32 v28, v16, v28
    v_sub_f32 v29, v17, v29
    v_cvt_pk_bf16_f32 v26, v28, v29
    v_lshlrev_b32 v28, 16, v25
    v_and_b32 v29, s25, v25
    v_sub_f32 v28, v18, v28
    v_sub_f32 v29, v19, v29
    v_cvt_pk_bf16_f32 v27, v28, v29
    global_store_dwordx4 v5, v[20:23], s[12:13]
    global_store_dwordx4 v5, v[24:27], s[12:13] offset:1024
    s_waitcnt vmcnt(2)
    v_lshl_or_b32 v48, v33, 16, v32
    v_lshl_or_b32 v49, v35, 16, v34
    v_lshl_or_b32 v50, v37, 16, v36
    v_lshl_or_b32 v51, v39, 16, v38
    v_lshl_or_b32 v52, v41, 16, v40
    v_lshl_or_b32 v53, v43, 16, v42
    v_lshl_or_b32 v54, v45, 16, v44
    v_lshl_or_b32 v55, v47, 16, v46
    global_store_dwordx4 v5, v[48:51], s[12:13] offset:2048
    global_store_dwordx4 v5, v[52:55], s[12:13] offset:3072
K1_END:
    s_endpgm
.globl main_kernel
.p2align 8
.type main_kernel,@function
main_kernel:
    s_cmp_ge_u32 s2, 256
    s_cbranch_scc1 K2_END
    s_load_dwordx2 s[12:13], s[0:1], 0
    s_load_dwordx2 s[20:21], s[0:1], 64
    s_load_dwordx2 s[16:17], s[0:1], 80
    s_and_b32 s10, s2, 7
    s_lshl_b32 s10, s10, 5
    s_lshr_b32 s11, s2, 3
    s_or_b32 s24, s10, s11
    v_lshrrev_b32 v8, 6, v0
    v_and_b32 v9, 63, v0
    v_lshlrev_b32 v1, 4, v9
    v_readfirstlane_b32 s25, v8
    v_lshrrev_b32 v4, 1, v0
    s_lshl_b32 s10, s24, 2
    s_add_u32 s10, s10, 7864320
    v_lshl_add_u32 v10, v4, 10, s10
    v_lshlrev_b32 v11, 3, v0
    v_mov_b32 v12, 0
    v_mov_b32 v13, 0
    ds_write_b64 v11, v[12:13]
    s_mov_b32 s14, 10240000
    s_mov_b32 s15, 0x20000
    s_mov_b32 s18, 8120320
    s_mov_b32 s19, 0x20000
    s_mov_b32 s22, 10240000
    s_mov_b32 s23, 0x20000
    s_mov_b32 s34, 0xfffffc00
    s_mov_b32 s27, 0
    s_mov_b32 s35, 1536
    s_lshl_b32 s10, s25, 10
    s_add_u32 s11, s10, 6488064
    s_add_u32 s10, s10, 64384
    v_mov_b32 v16, 0
    v_mov_b32 v17, 0
    v_mov_b32 v18, 0
    v_mov_b32 v19, 0
    v_mov_b32 v20, 0
    v_mov_b32 v21, 0
    v_mov_b32 v22, 0
    v_mov_b32 v23, 0
    v_mov_b32 v24, 0
    v_mov_b32 v25, 0
    v_mov_b32 v26, 0
    v_mov_b32 v27, 0
    v_mov_b32 v28, 0
    v_mov_b32 v29, 0
    v_mov_b32 v30, 0
    v_mov_b32 v31, 0
    v_mov_b32 v32, 0
    v_mov_b32 v33, 0
    v_mov_b32 v34, 0
    v_mov_b32 v35, 0
    v_mov_b32 v36, 0
    v_mov_b32 v37, 0
    v_mov_b32 v38, 0
    v_mov_b32 v39, 0
    v_mov_b32 v40, 0
    v_mov_b32 v41, 0
    v_mov_b32 v42, 0
    v_mov_b32 v43, 0
    v_mov_b32 v44, 0
    v_mov_b32 v45, 0
    v_mov_b32 v46, 0
    v_mov_b32 v47, 0
    v_mov_b32 v48, 0
    v_mov_b32 v49, 0
    v_mov_b32 v50, 0
    v_mov_b32 v51, 0
    v_mov_b32 v52, 0
    v_mov_b32 v53, 0
    v_mov_b32 v54, 0
    v_mov_b32 v55, 0
    v_mov_b32 v56, 0
    v_mov_b32 v57, 0
    v_mov_b32 v58, 0
    v_mov_b32 v59, 0
    v_mov_b32 v60, 0
    v_mov_b32 v61, 0
    v_mov_b32 v62, 0
    v_mov_b32 v63, 0
    v_mul_u32_u24 v4, 1280, v4
    v_mul_u32_u24 v14, 52, v9
    v_lshrrev_b32 v14, 8, v14
    v_mul_u32_u24 v7, 5, v14
    v_sub_u32 v7, v9, v7
    v_lshlrev_b32 v14, 2, v14
    v_lshlrev_b32 v7, 2, v7
    v_and_b32 v12, 1, v0
    v_cmp_eq_u32 s[42:43], 1, v12
    s_mov_b32 m0, s10
    s_waitcnt lgkmcnt(0)
    buffer_load_dword v2, v10, s[16:19], 0 offen
    s_cmp_ge_u32 s25, 4
    s_cbranch_scc1 SKIP_PIECE
    s_add_u32 m0, s10, 32768
    s_add_u32 s44, s11, 32768
    buffer_load_dwordx4 v1, s[16:19], s44 offen lds
SKIP_PIECE:
    s_add_u32 m0, s10, 0
    s_add_u32 s44, s11, 0
    buffer_load_dwordx4 v1, s[16:19], s44 offen lds
    s_add_u32 m0, s10, 8192
    s_add_u32 s44, s11, 8192
    buffer_load_dwordx4 v1, s[16:19], s44 offen lds
    s_add_u32 m0, s10, 16384
    s_add_u32 s44, s11, 16384
    buffer_load_dwordx4 v1, s[16:19], s44 offen lds
    s_add_u32 m0, s10, 24576
    s_add_u32 s44, s11, 24576
    buffer_load_dwordx4 v1, s[16:19], s44 offen lds
    s_barrier
    s_cmp_ge_u32 s25, 4
    s_cbranch_scc1 TAB_W4
    s_waitcnt vmcnt(5)
    s_branch TAB_OK
TAB_W4:
    s_waitcnt vmcnt(4)
TAB_OK:
    v_and_b32 v13, 0xffff, v2
    v_lshrrev_b32 v2, 16, v2
    v_add_u32 v4, v4, v13
    v_cndmask_b32 v13, 0, v2, s[42:43]
    v_mov_b32 v3, v13
    s_nop 1
    v_add_u32_dpp v3, v3, v3 row_shr:1 row_mask:0xf bank_mask:0xf bound_ctrl:0
    s_nop 1
    v_add_u32_dpp v3, v3, v3 row_shr:2 row_mask:0xf bank_mask:0xf bound_ctrl:0
    s_nop 1
    v_add_u32_dpp v3, v3, v3 row_shr:4 row_mask:0xf bank_mask:0xf bound_ctrl:0
    s_nop 1
    v_add_u32_dpp v3, v3, v3 row_shr:8 row_mask:0xf bank_mask:0xf bound_ctrl:0
    s_nop 1
    v_add_u32_dpp v3, v3, v3 row_bcast:15 row_mask:0xa bank_mask:0xf
    s_nop 1
    v_add_u32_dpp v3, v3, v3 row_bcast:31 row_mask:0xc bank_mask:0xf
    s_nop 0
    v_readlane_b32 s44, v3, 63
    v_sub_u32 v3, v3, v13
    v_cmp_lt_u32 vcc, s25, v9
    v_cmp_gt_u32 s[42:43], 9, v9
    v_lshlrev_b32 v10, 2, v9
    v_mov_b32 v11, s44
    s_and_b64 vcc, vcc, s[42:43]
    s_and_saveexec_b64 s[42:43], vcc
    ds_add_u32 v10, v11 offset:3328
    s_mov_b64 exec, s[42:43]
    s_lshl_b32 s10, s25, 2
    v_mov_b32 v10, s10
    v_mov_b32 v11, 32
    s_waitcnt lgkmcnt(0)
    s_barrier
    ds_read_b32 v10, v10 offset:3328
    ds_read_b32 v11, v11 offset:3328
    s_waitcnt lgkmcnt(0)
    v_add_u32 v3, v3, v10
    v_readfirstlane_b32 s26, v11
ROUND:
    v_and_b32 v8, 1, v0
    v_subrev_u32 v9, s27, v3
    v_add_u32 v9, v9, v8
    v_add_u32 v10, v4, v8
EXPAND:
    v_cmp_lt_u32 vcc, v8, v2
    s_and_b64 exec, exec, vcc
    s_cbranch_execz EXPAND_DONE
    v_cmp_gt_u32 vcc, s35, v9
    v_lshlrev_b32 v11, 2, v9
    s_and_saveexec_b64 s[42:43], vcc
    ds_write_b32 v11, v10 offset:7552
    s_mov_b64 exec, s[42:43]
    v_add_u32 v8, 2, v8
    v_add_u32 v9, 2, v9
    v_add_u32 v10, 2, v10
    s_branch EXPAND
EXPAND_DONE:
    s_mov_b64 exec, -1
    s_sub_u32 s28, s26, s27
    s_min_u32 s28, s28, s35
    v_lshlrev_b32 v8, 2, v0
    v_add_u32 v9, 0, v0
    v_cmp_gt_u32 s[36:37], s28, v9
    v_add_u32 v9, 512, v0
    v_cmp_gt_u32 s[38:39], s28, v9
    v_add_u32 v9, 1024, v0
    v_cmp_gt_u32 s[40:41], s28, v9
    s_waitcnt lgkmcnt(0)
    s_barrier
    ds_read_b32 v64, v8 offset:7552
    ds_read_b32 v65, v8 offset:9600
    ds_read_b32 v66, v8 offset:11648
    s_lshl_b32 s10, s25, 10
    s_add_u32 s10, s10, 39808
    s_mov_b32 s11, 1310720
    s_mov_b32 s44, 5033
    v_mov_b32 v13, 1
    s_waitcnt lgkmcnt(0)
    v_lshlrev_b32 v68, 2, v64
    v_lshlrev_b32 v64, 4, v64
    v_lshlrev_b32 v69, 2, v65
    v_lshlrev_b32 v65, 4, v65
    v_lshlrev_b32 v70, 2, v66
    v_lshlrev_b32 v66, 4, v66
    s_mov_b64 exec, s[36:37]
    buffer_load_dword v68, v68, s[16:19], 0 offen
    s_mov_b64 exec, s[38:39]
    buffer_load_dword v69, v69, s[16:19], 0 offen
    s_mov_b64 exec, s[40:41]
    s_cbranch_execz SKIP3
    buffer_load_dword v70, v70, s[16:19], 0 offen
SKIP3:
    s_mov_b64 exec, -1
    s_waitcnt vmcnt(0)
    s_add_u32 m0, s10, 0
    s_mov_b64 exec, s[36:37]
    buffer_load_dwordx4 v64, s[16:19], s11 offen lds
    s_add_u32 m0, s10, 8192
    s_mov_b64 exec, s[38:39]
    buffer_load_dwordx4 v65, s[16:19], s11 offen lds
    s_add_u32 m0, s10, 16384
    s_mov_b64 exec, s[40:41]
    s_cbranch_execz SKIP3R
    buffer_load_dwordx4 v66, s[16:19], s11 offen lds
SKIP3R:
    s_mov_b64 exec, -1
    v_mul_hi_u32 v9, s44, v68
    v_and_b32 v72, 63, v68
    v_mul_u32_u24 v72, 80, v72
    v_lshl_add_u32 v72, v9, 2, v72
    v_mul_hi_u32 v9, s44, v69
    v_and_b32 v73, 63, v69
    v_mul_u32_u24 v73, 80, v73
    v_lshl_add_u32 v73, v9, 2, v73
    v_mul_hi_u32 v9, s44, v70
    v_and_b32 v74, 63, v70
    v_mul_u32_u24 v74, 80, v74
    v_lshl_add_u32 v74, v9, 2, v74
    s_mov_b64 exec, s[36:37]
    ds_add_rtn_u32 v76, v72, v13 offset:0
    s_mov_b64 exec, s[38:39]
    ds_add_rtn_u32 v77, v73, v13 offset:0
    s_mov_b64 exec, s[40:41]
    ds_add_rtn_u32 v78, v74, v13 offset:0
    s_mov_b64 exec, -1
    v_and_b32 v80, s34, v68
    v_lshlrev_b32 v81, 4, v0
    v_add_u32 v81, 39808, v81
    v_and_b32 v82, s34, v69
    v_lshlrev_b32 v83, 4, v0
    v_add_u32 v83, 48000, v83
    v_and_b32 v84, s34, v70
    v_lshlrev_b32 v85, 4, v0
    v_add_u32 v85, 56192, v85
    v_lshrrev_b32 v8, 4, v1
    v_min_u32 v9, 39, v8
    v_mul_u32_u24 v9, 80, v9
    v_cmp_gt_u32 s[42:43], 40, v8
    v_sub_u32 v10, 63, v8
    s_mul_i32 s10, s25, 5
    s_waitcnt lgkmcnt(0)
    s_barrier
    ds_read_b128 v[88:91], v9 offset:0
    ds_read_b128 v[92:95], v9 offset:16
    ds_read_b128 v[96:99], v9 offset:32
    s_waitcnt lgkmcnt(1)
    v_add3_u32 v88, v88, v89, v90
    v_add3_u32 v91, v91, v92, v93
    v_add3_u32 v88, v88, v94, v95
    s_waitcnt lgkmcnt(0)
    v_add3_u32 v91, v91, v96, v97
    v_add3_u32 v88, v88, v98, v99
    v_add_u32 v88, v88, v91
    v_cmp_lt_u32 vcc, 76, v88
    v_lshl_or_b32 v88, v88, 6, v10
    v_cndmask_b32 v88, 0, v88, s[42:43]
    s_cmp_eq_u32 s35, 384
    s_cbranch_scc1 DEG_OK
    s_cbranch_vccz DEG_OK
    s_mov_b32 s35, 384
    s_waitcnt vmcnt(0)
    s_barrier
    v_lshlrev_b32 v11, 3, v0
    v_mov_b32 v12, 0
    v_mov_b32 v13, 0
    v_cmp_gt_u32 vcc, 400, v0
    s_and_saveexec_b64 s[42:43], vcc
    ds_write_b64 v11, v[12:13] offset:0
    s_mov_b64 exec, s[42:43]
    s_branch ROUND
DEG_OK:
    s_cmp_lg_u32 s27, 0
    s_cbranch_scc1 DEALT
    v_readlane_b32 s4, v88, s10
    s_add_u32 s10, s10, 1
    v_readlane_b32 s5, v88, s10
    s_add_u32 s10, s10, 1
    v_readlane_b32 s6, v88, s10
    s_add_u32 s10, s10, 1
    v_readlane_b32 s7, v88, s10
    s_add_u32 s10, s10, 1
    v_readlane_b32 s8, v88, s10
    v_cmp_lt_u32 s[48:49], s4, v88
    v_cmp_lt_u32 s[50:51], s5, v88
    v_cmp_lt_u32 s[52:53], s6, v88
    v_cmp_lt_u32 s[54:55], s7, v88
    v_cmp_lt_u32 s[56:57], s8, v88
    s_bcnt1_i32_b64 s4, s[48:49]
    s_bcnt1_i32_b64 s5, s[50:51]
    s_bcnt1_i32_b64 s6, s[52:53]
    s_bcnt1_i32_b64 s7, s[54:55]
    s_bcnt1_i32_b64 s8, s[56:57]
    v_writelane_b32 v9, s4, 0
    v_writelane_b32 v9, s5, 1
    v_writelane_b32 v9, s6, 2
    v_writelane_b32 v9, s7, 3
    v_writelane_b32 v9, s8, 4
    s_sub_u32 s10, s10, 4
    v_add_u32 v10, s10, v8
    v_lshrrev_b32 v11, 3, v9
    v_and_b32 v9, 7, v9
    v_lshrrev_b32 v12, v11, 18
    v_and_b32 v12, 1, v12
    v_mul_u32_u24 v12, 7, v12
    v_xor_b32 v9, v9, v12
    v_lshl_or_b32 v9, v9, 3, v11
    v_lshlrev_b32 v9, 2, v9
    s_mov_b64 exec, 0x1f
    ds_write_b32 v9, v10 offset:7296
    s_mov_b64 exec, -1
DEALT:
    s_lshl_b32 s10, s25, 5
    v_add_u32 v9, s10, v7
    s_mul_i32 s29, s25, 384
    v_cmp_gt_u32 s[42:43], 60, v8
    s_waitcnt lgkmcnt(0)
    s_barrier
    ds_read_b32 v9, v9 offset:7296
    v_lshlrev_b32 v12, 17, v7
    v_add_u32 v12, s29, v12
    s_waitcnt lgkmcnt(0)
    v_mul_u32_u24 v10, 80, v9
    v_add_u32 v10, v10, v14
    ds_read_b32 v11, v10 offset:0
    v_readlane_b32 s4, v9, 0
    v_readlane_b32 s5, v9, 1
    v_readlane_b32 s6, v9, 2
    v_readlane_b32 s7, v9, 3
    v_readlane_b32 s8, v9, 4
    s_waitcnt lgkmcnt(0)
    v_cndmask_b32 v11, 0, v11, s[42:43]
    v_sub_u32 v12, v12, v11
    s_nop 1
    v_add_u32_dpp v11, v11, v11 row_shr:1 row_mask:0xf bank_mask:0xf bound_ctrl:0
    s_nop 1
    v_add_u32_dpp v11, v11, v11 row_shr:2 row_mask:0xf bank_mask:0xf bound_ctrl:0
    s_nop 1
    v_add_u32_dpp v11, v11, v11 row_shr:4 row_mask:0xf bank_mask:0xf bound_ctrl:0
    s_nop 1
    v_add_u32_dpp v11, v11, v11 row_shr:8 row_mask:0xf bank_mask:0xf bound_ctrl:0
    s_nop 1
    v_add_u32_dpp v11, v11, v11 row_bcast:15 row_mask:0xa bank_mask:0xf
    s_nop 1
    v_add_u32_dpp v11, v11, v11 row_bcast:31 row_mask:0xc bank_mask:0xf
    v_add_u32 v12, v12, v11
    v_readlane_b32 s30, v11, 63
    s_mov_b64 exec, s[42:43]
    ds_write_b32 v10, v12 offset:4096
    s_mov_b64 exec, -1
    v_add_u32 v6, s29, v8
    v_lshlrev_b32 v5, 3, v6
    v_add_u32 v5, 13696, v5
    s_add_u32 s10, s30, 3
    s_and_b32 s10, s10, -4
    s_min_u32 s32, s10, 8
    s_sub_u32 s31, s10, s32
    s_add_u32 s30, s30, s29
    s_waitcnt lgkmcnt(0)
    s_barrier
    ds_read_b32 v72, v72 offset:4096
    ds_read_b32 v73, v73 offset:4096
    ds_read_b32 v74, v74 offset:4096
    s_waitcnt lgkmcnt(2)
    v_lshrrev_b32 v9, 16, v72
    v_and_b32 v72, 0xffff, v72
    v_or_b32 v80, v80, v9
    v_add_lshl_u32 v72, v72, v76, 3
    s_waitcnt lgkmcnt(1)
    v_lshrrev_b32 v9, 16, v73
    v_and_b32 v73, 0xffff, v73
    v_or_b32 v82, v82, v9
    v_add_lshl_u32 v73, v73, v77, 3
    s_waitcnt lgkmcnt(0)
    v_lshrrev_b32 v9, 16, v74
    v_and_b32 v74, 0xffff, v74
    v_or_b32 v84, v84, v9
    v_add_lshl_u32 v74, v74, v78, 3
    s_mov_b64 exec, s[36:37]
    ds_write_b64 v72, v[80:81] offset:13696
    s_mov_b64 exec, s[38:39]
    ds_write_b64 v73, v[82:83] offset:13696
    s_mov_b64 exec, s[40:41]
    ds_write_b64 v74, v[84:85] offset:13696
    s_mov_b64 exec, -1
    s_waitcnt lgkmcnt(0)
    s_waitcnt vmcnt(0)
    s_barrier
    ds_read_b64 v[166:167], v5
    v_add_u32 v9, 64384, v1
    s_waitcnt lgkmcnt(0)
    v_cmp_gt_u32 vcc, s30, v6
    v_add_u32 v6, 64, v6
    v_add_u32 v5, 512, v5
    v_mov_b32 v8, 39808
    v_cndmask_b32 v166, 40, v166, vcc
    v_cndmask_b32 v167, v8, v167, vcc
    ds_read_b128 v[168:171], v167
    ds_read_b128 v[176:179], v9 offset:0
    ds_read_b128 v[180:183], v9 offset:1024
    ds_read_b128 v[184:187], v9 offset:2048
    ds_read_b128 v[188:191], v9 offset:3072
    v_readlane_b32 s48, v166, 0
    s_and_b32 s33, s48, s34
    buffer_load_dwordx4 v[64:67], v1, s[12:15], s33 offen
    v_readlane_b32 s49, v166, 1
    s_and_b32 s33, s49, s34
    buffer_load_dwordx4 v[68:71], v1, s[12:15], s33 offen
    v_readlane_b32 s50, v166, 2
    s_and_b32 s33, s50, s34
    buffer_load_dwordx4 v[72:75], v1, s[12:15], s33 offen
    v_readlane_b32 s51, v166, 3
    s_and_b32 s33, s51, s34
    buffer_load_dwordx4 v[76:79], v1, s[12:15], s33 offen
    v_readlane_b32 s52, v166, 4
    s_and_b32 s33, s52, s34
    buffer_load_dwordx4 v[80:83], v1, s[12:15], s33 offen
    v_readlane_b32 s53, v166, 5
    s_and_b32 s33, s53, s34
    buffer_load_dwordx4 v[84:87], v1, s[12:15], s33 offen
    v_readlane_b32 s54, v166, 6
    s_and_b32 s33, s54, s34
    buffer_load_dwordx4 v[88:91], v1, s[12:15], s33 offen
    v_readlane_b32 s55, v166, 7
    s_and_b32 s33, s55, s34
    buffer_load_dwordx4 v[92:95], v1, s[12:15], s33 offen
    v_mov_b32 v164, v166
    s_waitcnt lgkmcnt(0)
    v_mov_b32 v172, v170
    v_mov_b32 v173, v171
    v_mfma_f32_4x4x4_16b_bf16 v[148:151], v[168:169], v[184:185], 0
    v_mfma_f32_4x4x4_16b_bf16 v[152:155], v[168:169], v[186:187], 0
    v_mfma_f32_4x4x4_16b_bf16 v[156:159], v[168:169], v[188:189], 0
    v_mfma_f32_4x4x4_16b_bf16 v[160:163], v[168:169], v[190:191], 0
    v_mfma_f32_4x4x4_16b_bf16 v[112:115], v[172:173], v[176:177], 0 cbsz:4 abid:0
    v_mfma_f32_4x4x4_16b_bf16 v[116:119], v[172:173], v[180:181], 0 cbsz:4 abid:0
    v_mfma_f32_4x4x4_16b_bf16 v[120:123], v[172:173], v[176:177], 0 cbsz:4 abid:1
    v_mfma_f32_4x4x4_16b_bf16 v[112:115], v[172:173], v[178:179], v[112:115] cbsz:4 abid:0
    v_mfma_f32_4x4x4_16b_bf16 v[116:119], v[172:173], v[182:183], v[116:119] cbsz:4 abid:0
    v_mfma_f32_4x4x4_16b_bf16 v[120:123], v[172:173], v[178:179], v[120:123] cbsz:4 abid:1
    v_cvt_pk_bf16_f32 v140, v148, v152
    v_cvt_pk_bf16_f32 v141, v156, v160
    v_cvt_pk_bf16_f32 v142, v149, v153
    v_cvt_pk_bf16_f32 v143, v157, v161
    v_cvt_pk_bf16_f32 v144, v150, v154
    v_cvt_pk_bf16_f32 v145, v158, v162
    v_cvt_pk_bf16_f32 v146, v151, v155
    v_cvt_pk_bf16_f32 v147, v159, v163
    v_exp_f32 v136, v112
    v_exp_f32 v137, v113
    s_nop 0
    v_pk_add_f32 v[136:137], v[136:137], 1.0 op_sel_hi:[1,0]
    v_rcp_f32 v136, v136
    v_rcp_f32 v137, v137
    s_nop 0
    v_pk_mul_f32 v[128:129], v[136:137], v[112:113]
    v_exp_f32 v136, v116
    v_exp_f32 v137, v117
    s_nop 0
    v_pk_add_f32 v[136:137], v[136:137], 1.0 op_sel_hi:[1,0]
    v_rcp_f32 v136, v136
    v_rcp_f32 v137, v137
    s_nop 0
    v_pk_mul_f32 v[130:131], v[136:137], v[116:117]
    s_waitcnt vmcnt(7)
    v_mfma_f32_4x4x4_16b_bf16 v[96:99], v[140:141], v[64:65], 0 cbsz:4 abid:0
    v_mfma_f32_4x4x4_16b_bf16 v[100:103], v[140:141], v[66:67], 0 cbsz:4 abid:0
A_0:
    s_sub_u32 s31, s31, 4
    s_cbranch_scc1 B_0
    s_waitcnt vmcnt(6)
    v_mfma_f32_4x4x4_16b_bf16 v[104:107], v[142:143], v[68:69], 0 cbsz:4 abid:0
    v_readlane_b32 s56, v164, 8
    v_mfma_f32_4x4x4_16b_bf16 v[124:127], v[172:173], v[180:181], 0 cbsz:4 abid:1
    v_exp_f32 v136, v114
    v_exp_f32 v137, v115
    s_and_b32 s33, s56, s34
    v_pk_add_f32 v[136:137], v[136:137], 1.0 op_sel_hi:[1,0]
    v_mfma_f32_4x4x4_16b_bf16 v[108:111], v[142:143], v[70:71], 0 cbsz:4 abid:0
    v_rcp_f32 v136, v136
    v_rcp_f32 v137, v137
    buffer_load_dwordx4 v[64:67], v1, s[12:15], s33 offen
    v_pk_mul_f32 v[132:133], v[136:137], v[114:115]
    s_set_gpr_idx_on s48, 0xc
    v_pk_fma_f32 v[16:17], v[128:129], v[96:97], v[16:17] op_sel:[0,0,0] op_sel_hi:[0,1,1]
    v_pk_fma_f32 v[18:19], v[128:129], v[98:99], v[18:19] op_sel:[0,0,0] op_sel_hi:[0,1,1]
    v_pk_fma_f32 v[20:21], v[130:131], v[100:101], v[20:21] op_sel:[0,0,0] op_sel_hi:[0,1,1]
    v_pk_fma_f32 v[22:23], v[130:131], v[102:103], v[22:23] op_sel:[0,0,0] op_sel_hi:[0,1,1]
    s_set_gpr_idx_off
    s_waitcnt vmcnt(6)
    v_mfma_f32_4x4x4_16b_bf16 v[96:99], v[144:145], v[72:73], 0 cbsz:4 abid:0
    v_readlane_b32 s57, v164, 9
    v_mfma_f32_4x4x4_16b_bf16 v[124:127], v[172:173], v[182:183], v[124:127] cbsz:4 abid:1
    v_exp_f32 v136, v118
    v_exp_f32 v137, v119
    s_and_b32 s33, s57, s34
    v_pk_add_f32 v[136:137], v[136:137], 1.0 op_sel_hi:[1,0]
    v_mfma_f32_4x4x4_16b_bf16 v[100:103], v[144:145], v[74:75], 0 cbsz:4 abid:0
    v_rcp_f32 v136, v136
    v_rcp_f32 v137, v137
    buffer_load_dwordx4 v[68:71], v1, s[12:15], s33 offen
    v_pk_mul_f32 v[134:135], v[136:137], v[118:119]
    s_set_gpr_idx_on s49, 0xc
    v_pk_fma_f32 v[16:17], v[128:129], v[104:105], v[16:17] op_sel:[1,0,0] op_sel_hi:[1,1,1]
    v_pk_fma_f32 v[18:19], v[128:129], v[106:107], v[18:19] op_sel:[1,0,0] op_sel_hi:[1,1,1]
    v_pk_fma_f32 v[20:21], v[130:131], v[108:109], v[20:21] op_sel:[1,0,0] op_sel_hi:[1,1,1]
    v_pk_fma_f32 v[22:23], v[130:131], v[110:111], v[22:23] op_sel:[1,0,0] op_sel_hi:[1,1,1]
    s_set_gpr_idx_off
    s_waitcnt vmcnt(6)
    v_mfma_f32_4x4x4_16b_bf16 v[104:107], v[146:147], v[76:77], 0 cbsz:4 abid:0
    v_readlane_b32 s58, v164, 10
    v_mfma_f32_4x4x4_16b_bf16 v[112:115], v[172:173], v[176:177], 0 cbsz:4 abid:2
    v_exp_f32 v136, v120
    v_exp_f32 v137, v121
    s_and_b32 s33, s58, s34
    v_pk_add_f32 v[136:137], v[136:137], 1.0 op_sel_hi:[1,0]
    v_mfma_f32_4x4x4_16b_bf16 v[108:111], v[146:147], v[78:79], 0 cbsz:4 abid:0
    v_rcp_f32 v136, v136
    v_rcp_f32 v137, v137
    buffer_load_dwordx4 v[72:75], v1, s[12:15], s33 offen
    v_pk_mul_f32 v[128:129], v[136:137], v[120:121]
    s_set_gpr_idx_on s50, 0xc
    v_pk_fma_f32 v[16:17], v[132:133], v[96:97], v[16:17] op_sel:[0,0,0] op_sel_hi:[0,1,1]
    v_pk_fma_f32 v[18:19], v[132:133], v[98:99], v[18:19] op_sel:[0,0,0] op_sel_hi:[0,1,1]
    v_pk_fma_f32 v[20:21], v[134:135], v[100:101], v[20:21] op_sel:[0,0,0] op_sel_hi:[0,1,1]
    v_pk_fma_f32 v[22:23], v[134:135], v[102:103], v[22:23] op_sel:[0,0,0] op_sel_hi:[0,1,1]
    s_set_gpr_idx_off
    s_waitcnt vmcnt(6)
    v_mfma_f32_4x4x4_16b_bf16 v[96:99], v[140:141], v[80:81], 0 cbsz:4 abid:1
    v_readlane_b32 s59, v164, 11
    v_mfma_f32_4x4x4_16b_bf16 v[112:115], v[172:173], v[178:179], v[112:115] cbsz:4 abid:2
    v_exp_f32 v136, v124
    v_exp_f32 v137, v125
    s_and_b32 s33, s59, s34
    v_pk_add_f32 v[136:137], v[136:137], 1.0 op_sel_hi:[1,0]
    v_mfma_f32_4x4x4_16b_bf16 v[100:103], v[140:141], v[82:83], 0 cbsz:4 abid:1
    v_rcp_f32 v136, v136
    v_rcp_f32 v137, v137
    buffer_load_dwordx4 v[76:79], v1, s[12:15], s33 offen
    v_pk_mul_f32 v[130:131], v[136:137], v[124:125]
    s_set_gpr_idx_on s51, 0xc
    v_pk_fma_f32 v[16:17], v[132:133], v[104:105], v[16:17] op_sel:[1,0,0] op_sel_hi:[1,1,1]
    v_pk_fma_f32 v[18:19], v[132:133], v[106:107], v[18:19] op_sel:[1,0,0] op_sel_hi:[1,1,1]
    v_pk_fma_f32 v[20:21], v[134:135], v[108:109], v[20:21] op_sel:[1,0,0] op_sel_hi:[1,1,1]
    v_pk_fma_f32 v[22:23], v[134:135], v[110:111], v[22:23] op_sel:[1,0,0] op_sel_hi:[1,1,1]
    s_set_gpr_idx_off
A_4:
    s_sub_u32 s31, s31, 4
    s_cbranch_scc1 B_4
    s_waitcnt vmcnt(6)
    v_mfma_f32_4x4x4_16b_bf16 v[104:107], v[142:143], v[84:85], 0 cbsz:4 abid:1
    v_readlane_b32 s60, v164, 12
    v_mfma_f32_4x4x4_16b_bf16 v[116:119], v[172:173], v[180:181], 0 cbsz:4 abid:2
    v_exp_f32 v136, v122
    v_exp_f32 v137, v123
    s_and_b32 s33, s60, s34
    v_pk_add_f32 v[136:137], v[136:137], 1.0 op_sel_hi:[1,0]
    v_mfma_f32_4x4x4_16b_bf16 v[108:111], v[142:143], v[86:87], 0 cbsz:4 abid:1
    v_rcp_f32 v136, v136
    v_rcp_f32 v137, v137
    buffer_load_dwordx4 v[80:83], v1, s[12:15], s33 offen
    v_pk_mul_f32 v[132:133], v[136:137], v[122:123]
    s_set_gpr_idx_on s52, 0xc
    v_pk_fma_f32 v[16:17], v[128:129], v[96:97], v[16:17] op_sel:[0,0,0] op_sel_hi:[0,1,1]
    v_pk_fma_f32 v[18:19], v[128:129], v[98:99], v[18:19] op_sel:[0,0,0] op_sel_hi:[0,1,1]
    v_pk_fma_f32 v[20:21], v[130:131], v[100:101], v[20:21] op_sel:[0,0,0] op_sel_hi:[0,1,1]
    v_pk_fma_f32 v[22:23], v[130:131], v[102:103], v[22:23] op_sel:[0,0,0] op_sel_hi:[0,1,1]
    s_set_gpr_idx_off
    s_waitcnt vmcnt(6)
    v_mfma_f32_4x4x4_16b_bf16 v[96:99], v[144:145], v[88:89], 0 cbsz:4 abid:1
    v_readlane_b32 s61, v164, 13
    v_mfma_f32_4x4x4_16b_bf16 v[116:119], v[172:173], v[182:183], v[116:119] cbsz:4 abid:2
    v_exp_f32 v136, v126
    v_exp_f32 v137, v127
    s_and_b32 s33, s61, s34
    v_pk_add_f32 v[136:137], v[136:137], 1.0 op_sel_hi:[1,0]
    v_mfma_f32_4x4x4_16b_bf16 v[100:103], v[144:145], v[90:91], 0 cbsz:4 abid:1
    v_rcp_f32 v136, v136
    v_rcp_f32 v137, v137
    buffer_load_dwordx4 v[84:87], v1, s[12:15], s33 offen
    v_pk_mul_f32 v[134:135], v[136:137], v[126:127]
    s_set_gpr_idx_on s53, 0xc
    v_pk_fma_f32 v[16:17], v[128:129], v[104:105], v[16:17] op_sel:[1,0,0] op_sel_hi:[1,1,1]
    v_pk_fma_f32 v[18:19], v[128:129], v[106:107], v[18:19] op_sel:[1,0,0] op_sel_hi:[1,1,1]
    v_pk_fma_f32 v[20:21], v[130:131], v[108:109], v[20:21] op_sel:[1,0,0] op_sel_hi:[1,1,1]
    v_pk_fma_f32 v[22:23], v[130:131], v[110:111], v[22:23] op_sel:[1,0,0] op_sel_hi:[1,1,1]
    s_set_gpr_idx_off
    s_waitcnt vmcnt(6)
    v_mfma_f32_4x4x4_16b_bf16 v[104:107], v[146:147], v[92:93], 0 cbsz:4 abid:1
    v_readlane_b32 s62, v164, 14
    v_mfma_f32_4x4x4_16b_bf16 v[120:123], v[172:173], v[176:177], 0 cbsz:4 abid:3
    v_exp_f32 v136, v112
    v_exp_f32 v137, v113
    s_and_b32 s33, s62, s34
    v_pk_add_f32 v[136:137], v[136:137], 1.0 op_sel_hi:[1,0]
    v_mfma_f32_4x4x4_16b_bf16 v[108:111], v[146:147], v[94:95], 0 cbsz:4 abid:1
    v_rcp_f32 v136, v136
    v_rcp_f32 v137, v137
    buffer_load_dwordx4 v[88:91], v1, s[12:15], s33 offen
    v_pk_mul_f32 v[128:129], v[136:137], v[112:113]
    s_set_gpr_idx_on s54, 0xc
    v_pk_fma_f32 v[16:17], v[132:133], v[96:97], v[16:17] op_sel:[0,0,0] op_sel_hi:[0,1,1]
    v_pk_fma_f32 v[18:19], v[132:133], v[98:99], v[18:19] op_sel:[0,0,0] op_sel_hi:[0,1,1]
    v_pk_fma_f32 v[20:21], v[134:135], v[100:101], v[20:21] op_sel:[0,0,0] op_sel_hi:[0,1,1]
    v_pk_fma_f32 v[22:23], v[134:135], v[102:103], v[22:23] op_sel:[0,0,0] op_sel_hi:[0,1,1]
    s_set_gpr_idx_off
    s_waitcnt vmcnt(6)
    v_mfma_f32_4x4x4_16b_bf16 v[96:99], v[140:141], v[64:65], 0 cbsz:4 abid:2
    v_readlane_b32 s63, v164, 15
    v_mfma_f32_4x4x4_16b_bf16 v[120:123], v[172:173], v[178:179], v[120:123] cbsz:4 abid:3
    v_exp_f32 v136, v116
    v_exp_f32 v137, v117
    s_and_b32 s33, s63, s34
    v_pk_add_f32 v[136:137], v[136:137], 1.0 op_sel_hi:[1,0]
    v_mfma_f32_4x4x4_16b_bf16 v[100:103], v[140:141], v[66:67], 0 cbsz:4 abid:2
    v_rcp_f32 v136, v136
    v_rcp_f32 v137, v137
    buffer_load_dwordx4 v[92:95], v1, s[12:15], s33 offen
    v_pk_mul_f32 v[130:131], v[136:137], v[116:117]
    s_set_gpr_idx_on s55, 0xc
    v_pk_fma_f32 v[16:17], v[132:133], v[104:105], v[16:17] op_sel:[1,0,0] op_sel_hi:[1,1,1]
    v_pk_fma_f32 v[18:19], v[132:133], v[106:107], v[18:19] op_sel:[1,0,0] op_sel_hi:[1,1,1]
    v_pk_fma_f32 v[20:21], v[134:135], v[108:109], v[20:21] op_sel:[1,0,0] op_sel_hi:[1,1,1]
    v_pk_fma_f32 v[22:23], v[134:135], v[110:111], v[22:23] op_sel:[1,0,0] op_sel_hi:[1,1,1]
    s_set_gpr_idx_off
A_8:
    s_sub_u32 s31, s31, 4
    s_cbranch_scc1 B_8
    s_waitcnt vmcnt(6)
    v_mfma_f32_4x4x4_16b_bf16 v[104:107], v[142:143], v[68:69], 0 cbsz:4 abid:2
    v_readlane_b32 s48, v164, 16
    v_mfma_f32_4x4x4_16b_bf16 v[124:127], v[172:173], v[180:181], 0 cbsz:4 abid:3
    v_exp_f32 v136, v114
    v_exp_f32 v137, v115
    s_and_b32 s33, s48, s34
    v_pk_add_f32 v[136:137], v[136:137], 1.0 op_sel_hi:[1,0]
    v_mfma_f32_4x4x4_16b_bf16 v[108:111], v[142:143], v[70:71], 0 cbsz:4 abid:2
    v_rcp_f32 v136, v136
    v_rcp_f32 v137, v137
    buffer_load_dwordx4 v[64:67], v1, s[12:15], s33 offen
    v_pk_mul_f32 v[132:133], v[136:137], v[114:115]
    s_set_gpr_idx_on s56, 0xc
    v_pk_fma_f32 v[16:17], v[128:129], v[96:97], v[16:17] op_sel:[0,0,0] op_sel_hi:[0,1,1]
    v_pk_fma_f32 v[18:19], v[128:129], v[98:99], v[18:19] op_sel:[0,0,0] op_sel_hi:[0,1,1]
    v_pk_fma_f32 v[20:21], v[130:131], v[100:101], v[20:21] op_sel:[0,0,0] op_sel_hi:[0,1,1]
    v_pk_fma_f32 v[22:23], v[130:131], v[102:103], v[22:23] op_sel:[0,0,0] op_sel_hi:[0,1,1]
    s_set_gpr_idx_off
    ds_read_b64 v[166:167], v5
    s_waitcnt vmcnt(6)
    v_mfma_f32_4x4x4_16b_bf16 v[96:99], v[144:145], v[72:73], 0 cbsz:4 abid:2
    v_readlane_b32 s49, v164, 17
    v_mfma_f32_4x4x4_16b_bf16 v[124:127], v[172:173], v[182:183], v[124:127] cbsz:4 abid:3
    v_exp_f32 v136, v118
    v_exp_f32 v137, v119
    s_and_b32 s33, s49, s34
    v_pk_add_f32 v[136:137], v[136:137], 1.0 op_sel_hi:[1,0]
    v_mfma_f32_4x4x4_16b_bf16 v[100:103], v[144:145], v[74:75], 0 cbsz:4 abid:2
    v_rcp_f32 v136, v136
    v_rcp_f32 v137, v137
    buffer_load_dwordx4 v[68:71], v1, s[12:15], s33 offen
    v_pk_mul_f32 v[134:135], v[136:137], v[118:119]
    s_set_gpr_idx_on s57, 0xc
    v_pk_fma_f32 v[16:17], v[128:129], v[104:105], v[16:17] op_sel:[1,0,0] op_sel_hi:[1,1,1]
    v_pk_fma_f32 v[18:19], v[128:129], v[106:107], v[18:19] op_sel:[1,0,0] op_sel_hi:[1,1,1]
    v_pk_fma_f32 v[20:21], v[130:131], v[108:109], v[20:21] op_sel:[1,0,0] op_sel_hi:[1,1,1]
    v_pk_fma_f32 v[22:23], v[130:131], v[110:111], v[22:23] op_sel:[1,0,0] op_sel_hi:[1,1,1]
    s_set_gpr_idx_off
    s_waitcnt vmcnt(6)
    v_mfma_f32_4x4x4_16b_bf16 v[104:107], v[146:147], v[76:77], 0 cbsz:4 abid:2
    v_readlane_b32 s50, v164, 18
    v_mfma_f32_4x4x4_16b_bf16 v[112:115], v[172:173], v[176:177], 0 cbsz:4 abid:4
    v_exp_f32 v136, v120
    v_exp_f32 v137, v121
    s_and_b32 s33, s50, s34
    v_pk_add_f32 v[136:137], v[136:137], 1.0 op_sel_hi:[1,0]
    v_mfma_f32_4x4x4_16b_bf16 v[108:111], v[146:147], v[78:79], 0 cbsz:4 abid:2
    v_rcp_f32 v136, v136
    v_rcp_f32 v137, v137
    buffer_load_dwordx4 v[72:75], v1, s[12:15], s33 offen
    v_pk_mul_f32 v[128:129], v[136:137], v[120:121]
    s_set_gpr_idx_on s58, 0xc
    v_pk_fma_f32 v[16:17], v[132:133], v[96:97], v[16:17] op_sel:[0,0,0] op_sel_hi:[0,1,1]
    v_pk_fma_f32 v[18:19], v[132:133], v[98:99], v[18:19] op_sel:[0,0,0] op_sel_hi:[0,1,1]
    v_pk_fma_f32 v[20:21], v[134:135], v[100:101], v[20:21] op_sel:[0,0,0] op_sel_hi:[0,1,1]
    v_pk_fma_f32 v[22:23], v[134:135], v[102:103], v[22:23] op_sel:[0,0,0] op_sel_hi:[0,1,1]
    s_set_gpr_idx_off
    s_waitcnt vmcnt(6)
    v_mfma_f32_4x4x4_16b_bf16 v[96:99], v[140:141], v[80:81], 0 cbsz:4 abid:3
    v_readlane_b32 s51, v164, 19
    v_mfma_f32_4x4x4_16b_bf16 v[112:115], v[172:173], v[178:179], v[112:115] cbsz:4 abid:4
    v_exp_f32 v136, v124
    v_exp_f32 v137, v125
    s_and_b32 s33, s51, s34
    v_pk_add_f32 v[136:137], v[136:137], 1.0 op_sel_hi:[1,0]
    v_mfma_f32_4x4x4_16b_bf16 v[100:103], v[140:141], v[82:83], 0 cbsz:4 abid:3
    v_rcp_f32 v136, v136
    v_rcp_f32 v137, v137
    buffer_load_dwordx4 v[76:79], v1, s[12:15], s33 offen
    v_pk_mul_f32 v[130:131], v[136:137], v[124:125]
    s_set_gpr_idx_on s59, 0xc
    v_pk_fma_f32 v[16:17], v[132:133], v[104:105], v[16:17] op_sel:[1,0,0] op_sel_hi:[1,1,1]
    v_pk_fma_f32 v[18:19], v[132:133], v[106:107], v[18:19] op_sel:[1,0,0] op_sel_hi:[1,1,1]
    v_pk_fma_f32 v[20:21], v[134:135], v[108:109], v[20:21] op_sel:[1,0,0] op_sel_hi:[1,1,1]
    v_pk_fma_f32 v[22:23], v[134:135], v[110:111], v[22:23] op_sel:[1,0,0] op_sel_hi:[1,1,1]
    s_set_gpr_idx_off
A_12:
    s_sub_u32 s31, s31, 4
    s_cbranch_scc1 B_12
    s_waitcnt vmcnt(6)
    v_mfma_f32_4x4x4_16b_bf16 v[104:107], v[142:143], v[84:85], 0 cbsz:4 abid:3
    v_readlane_b32 s52, v164, 20
    v_mfma_f32_4x4x4_16b_bf16 v[116:119], v[172:173], v[180:181], 0 cbsz:4 abid:4
    v_exp_f32 v136, v122
    v_exp_f32 v137, v123
    s_and_b32 s33, s52, s34
    v_pk_add_f32 v[136:137], v[136:137], 1.0 op_sel_hi:[1,0]
    v_mfma_f32_4x4x4_16b_bf16 v[108:111], v[142:143], v[86:87], 0 cbsz:4 abid:3
    v_rcp_f32 v136, v136
    v_rcp_f32 v137, v137
    buffer_load_dwordx4 v[80:83], v1, s[12:15], s33 offen
    v_pk_mul_f32 v[132:133], v[136:137], v[122:123]
    s_set_gpr_idx_on s60, 0xc
    v_pk_fma_f32 v[16:17], v[128:129], v[96:97], v[16:17] op_sel:[0,0,0] op_sel_hi:[0,1,1]
    v_pk_fma_f32 v[18:19], v[128:129], v[98:99], v[18:19] op_sel:[0,0,0] op_sel_hi:[0,1,1]
    v_pk_fma_f32 v[20:21], v[130:131], v[100:101], v[20:21] op_sel:[0,0,0] op_sel_hi:[0,1,1]
    v_pk_fma_f32 v[22:23], v[130:131], v[102:103], v[22:23] op_sel:[0,0,0] op_sel_hi:[0,1,1]
    s_set_gpr_idx_off
    s_waitcnt lgkmcnt(0)
    v_cmp_gt_u32 vcc, s30, v6
    v_add_u32 v6, 64, v6
    v_add_u32 v5, 512, v5
    v_mov_b32 v8, 39808
    v_cndmask_b32 v166, 40, v166, vcc
    v_cndmask_b32 v167, v8, v167, vcc
    ds_read_b128 v[168:171], v167
    s_waitcnt vmcnt(6)
    v_mfma_f32_4x4x4_16b_bf16 v[96:99], v[144:145], v[88:89], 0 cbsz:4 abid:3
    v_readlane_b32 s53, v164, 21
    v_mfma_f32_4x4x4_16b_bf16 v[116:119], v[172:173], v[182:183], v[116:119] cbsz:4 abid:4
    v_exp_f32 v136, v126
    v_exp_f32 v137, v127
    s_and_b32 s33, s53, s34
    v_pk_add_f32 v[136:137], v[136:137], 1.0 op_sel_hi:[1,0]
    v_mfma_f32_4x4x4_16b_bf16 v[100:103], v[144:145], v[90:91], 0 cbsz:4 abid:3
    v_rcp_f32 v136, v136
    v_rcp_f32 v137, v137
    buffer_load_dwordx4 v[84:87], v1, s[12:15], s33 offen
    v_pk_mul_f32 v[134:135], v[136:137], v[126:127]
    s_set_gpr_idx_on s61, 0xc
    v_pk_fma_f32 v[16:17], v[128:129], v[104:105], v[16:17] op_sel:[1,0,0] op_sel_hi:[1,1,1]
    v_pk_fma_f32 v[18:19], v[128:129], v[106:107], v[18:19] op_sel:[1,0,0] op_sel_hi:[1,1,1]
    v_pk_fma_f32 v[20:21], v[130:131], v[108:109], v[20:21] op_sel:[1,0,0] op_sel_hi:[1,1,1]
    v_pk_fma_f32 v[22:23], v[130:131], v[110:111], v[22:23] op_sel:[1,0,0] op_sel_hi:[1,1,1]
    s_set_gpr_idx_off
    s_waitcnt vmcnt(6)
    v_mfma_f32_4x4x4_16b_bf16 v[104:107], v[146:147], v[92:93], 0 cbsz:4 abid:3
    v_readlane_b32 s54, v164, 22
    v_mfma_f32_4x4x4_16b_bf16 v[120:123], v[172:173], v[176:177], 0 cbsz:4 abid:5
    v_exp_f32 v136, v112
    v_exp_f32 v137, v113
    s_and_b32 s33, s54, s34
    v_pk_add_f32 v[136:137], v[136:137], 1.0 op_sel_hi:[1,0]
    v_mfma_f32_4x4x4_16b_bf16 v[108:111], v[146:147], v[94:95], 0 cbsz:4 abid:3
    v_rcp_f32 v136, v136
    v_rcp_f32 v137, v137
    buffer_load_dwordx4 v[88:91], v1, s[12:15], s33 offen
    v_pk_mul_f32 v[128:129], v[136:137], v[112:113]
    s_set_gpr_idx_on s62, 0xc
    v_pk_fma_f32 v[16:17], v[132:133], v[96:97], v[16:17] op_sel:[0,0,0] op_sel_hi:[0,1,1]
    v_pk_fma_f32 v[18:19], v[132:133], v[98:99], v[18:19] op_sel:[0,0,0] op_sel_hi:[0,1,1]
    v_pk_fma_f32 v[20:21], v[134:135], v[100:101], v[20:21] op_sel:[0,0,0] op_sel_hi:[0,1,1]
    v_pk_fma_f32 v[22:23], v[134:135], v[102:103], v[22:23] op_sel:[0,0,0] op_sel_hi:[0,1,1]
    s_set_gpr_idx_off
    s_waitcnt vmcnt(6)
    v_mfma_f32_4x4x4_16b_bf16 v[96:99], v[140:141], v[64:65], 0 cbsz:4 abid:4
    v_readlane_b32 s55, v164, 23
    v_mfma_f32_4x4x4_16b_bf16 v[120:123], v[172:173], v[178:179], v[120:123] cbsz:4 abid:5
    v_exp_f32 v136, v116
    v_exp_f32 v137, v117
    s_and_b32 s33, s55, s34
    v_pk_add_f32 v[136:137], v[136:137], 1.0 op_sel_hi:[1,0]
    v_mfma_f32_4x4x4_16b_bf16 v[100:103], v[140:141], v[66:67], 0 cbsz:4 abid:4
    v_rcp_f32 v136, v136
    v_rcp_f32 v137, v137
    buffer_load_dwordx4 v[92:95], v1, s[12:15], s33 offen
    v_pk_mul_f32 v[130:131], v[136:137], v[116:117]
    s_set_gpr_idx_on s63, 0xc
    v_pk_fma_f32 v[16:17], v[132:133], v[104:105], v[16:17] op_sel:[1,0,0] op_sel_hi:[1,1,1]
    v_pk_fma_f32 v[18:19], v[132:133], v[106:107], v[18:19] op_sel:[1,0,0] op_sel_hi:[1,1,1]
    v_pk_fma_f32 v[20:21], v[134:135], v[108:109], v[20:21] op_sel:[1,0,0] op_sel_hi:[1,1,1]
    v_pk_fma_f32 v[22:23], v[134:135], v[110:111], v[22:23] op_sel:[1,0,0] op_sel_hi:[1,1,1]
    s_set_gpr_idx_off
A_16:
    s_sub_u32 s31, s31, 4
    s_cbranch_scc1 B_16
    s_waitcnt vmcnt(6)
    v_mfma_f32_4x4x4_16b_bf16 v[104:107], v[142:143], v[68:69], 0 cbsz:4 abid:4
    v_readlane_b32 s56, v164, 24
    v_mfma_f32_4x4x4_16b_bf16 v[124:127], v[172:173], v[180:181], 0 cbsz:4 abid:5
    v_exp_f32 v136, v114
    v_exp_f32 v137, v115
    s_and_b32 s33, s56, s34
    v_pk_add_f32 v[136:137], v[136:137], 1.0 op_sel_hi:[1,0]
    v_mfma_f32_4x4x4_16b_bf16 v[108:111], v[142:143], v[70:71], 0 cbsz:4 abid:4
    v_rcp_f32 v136, v136
    v_rcp_f32 v137, v137
    buffer_load_dwordx4 v[64:67], v1, s[12:15], s33 offen
    v_pk_mul_f32 v[132:133], v[136:137], v[114:115]
    s_set_gpr_idx_on s48, 0xc
    v_pk_fma_f32 v[16:17], v[128:129], v[96:97], v[16:17] op_sel:[0,0,0] op_sel_hi:[0,1,1]
    v_pk_fma_f32 v[18:19], v[128:129], v[98:99], v[18:19] op_sel:[0,0,0] op_sel_hi:[0,1,1]
    v_pk_fma_f32 v[20:21], v[130:131], v[100:101], v[20:21] op_sel:[0,0,0] op_sel_hi:[0,1,1]
    v_pk_fma_f32 v[22:23], v[130:131], v[102:103], v[22:23] op_sel:[0,0,0] op_sel_hi:[0,1,1]
    s_set_gpr_idx_off
    s_waitcnt vmcnt(6)
    v_mfma_f32_4x4x4_16b_bf16 v[96:99], v[144:145], v[72:73], 0 cbsz:4 abid:4
    v_readlane_b32 s57, v164, 25
    v_mfma_f32_4x4x4_16b_bf16 v[124:127], v[172:173], v[182:183], v[124:127] cbsz:4 abid:5
    v_exp_f32 v136, v118
    v_exp_f32 v137, v119
    s_and_b32 s33, s57, s34
    v_pk_add_f32 v[136:137], v[136:137], 1.0 op_sel_hi:[1,0]
    v_mfma_f32_4x4x4_16b_bf16 v[100:103], v[144:145], v[74:75], 0 cbsz:4 abid:4
    v_rcp_f32 v136, v136
    v_rcp_f32 v137, v137
    buffer_load_dwordx4 v[68:71], v1, s[12:15], s33 offen
    v_pk_mul_f32 v[134:135], v[136:137], v[118:119]
    s_set_gpr_idx_on s49, 0xc
    v_pk_fma_f32 v[16:17], v[128:129], v[104:105], v[16:17] op_sel:[1,0,0] op_sel_hi:[1,1,1]
    v_pk_fma_f32 v[18:19], v[128:129], v[106:107], v[18:19] op_sel:[1,0,0] op_sel_hi:[1,1,1]
    v_pk_fma_f32 v[20:21], v[130:131], v[108:109], v[20:21] op_sel:[1,0,0] op_sel_hi:[1,1,1]
    v_pk_fma_f32 v[22:23], v[130:131], v[110:111], v[22:23] op_sel:[1,0,0] op_sel_hi:[1,1,1]
    s_set_gpr_idx_off
    s_waitcnt vmcnt(6)
    v_mfma_f32_4x4x4_16b_bf16 v[104:107], v[146:147], v[76:77], 0 cbsz:4 abid:4
    v_readlane_b32 s58, v164, 26
    v_mfma_f32_4x4x4_16b_bf16 v[112:115], v[172:173], v[176:177], 0 cbsz:4 abid:6
    v_exp_f32 v136, v120
    v_exp_f32 v137, v121
    s_and_b32 s33, s58, s34
    v_pk_add_f32 v[136:137], v[136:137], 1.0 op_sel_hi:[1,0]
    v_mfma_f32_4x4x4_16b_bf16 v[108:111], v[146:147], v[78:79], 0 cbsz:4 abid:4
    v_rcp_f32 v136, v136
    v_rcp_f32 v137, v137
    buffer_load_dwordx4 v[72:75], v1, s[12:15], s33 offen
    v_pk_mul_f32 v[128:129], v[136:137], v[120:121]
    s_set_gpr_idx_on s50, 0xc
    v_pk_fma_f32 v[16:17], v[132:133], v[96:97], v[16:17] op_sel:[0,0,0] op_sel_hi:[0,1,1]
    v_pk_fma_f32 v[18:19], v[132:133], v[98:99], v[18:19] op_sel:[0,0,0] op_sel_hi:[0,1,1]
    v_pk_fma_f32 v[20:21], v[134:135], v[100:101], v[20:21] op_sel:[0,0,0] op_sel_hi:[0,1,1]
    v_pk_fma_f32 v[22:23], v[134:135], v[102:103], v[22:23] op_sel:[0,0,0] op_sel_hi:[0,1,1]
    s_set_gpr_idx_off
    s_waitcnt vmcnt(6)
    v_mfma_f32_4x4x4_16b_bf16 v[96:99], v[140:141], v[80:81], 0 cbsz:4 abid:5
    v_readlane_b32 s59, v164, 27
    v_mfma_f32_4x4x4_16b_bf16 v[112:115], v[172:173], v[178:179], v[112:115] cbsz:4 abid:6
    v_exp_f32 v136, v124
    v_exp_f32 v137, v125
    s_and_b32 s33, s59, s34
    v_pk_add_f32 v[136:137], v[136:137], 1.0 op_sel_hi:[1,0]
    v_mfma_f32_4x4x4_16b_bf16 v[100:103], v[140:141], v[82:83], 0 cbsz:4 abid:5
    v_rcp_f32 v136, v136
    v_rcp_f32 v137, v137
    buffer_load_dwordx4 v[76:79], v1, s[12:15], s33 offen
    v_pk_mul_f32 v[130:131], v[136:137], v[124:125]
    s_set_gpr_idx_on s51, 0xc
    v_pk_fma_f32 v[16:17], v[132:133], v[104:105], v[16:17] op_sel:[1,0,0] op_sel_hi:[1,1,1]
    v_pk_fma_f32 v[18:19], v[132:133], v[106:107], v[18:19] op_sel:[1,0,0] op_sel_hi:[1,1,1]
    v_pk_fma_f32 v[20:21], v[134:135], v[108:109], v[20:21] op_sel:[1,0,0] op_sel_hi:[1,1,1]
    v_pk_fma_f32 v[22:23], v[134:135], v[110:111], v[22:23] op_sel:[1,0,0] op_sel_hi:[1,1,1]
    s_set_gpr_idx_off
A_20:
    s_sub_u32 s31, s31, 4
    s_cbranch_scc1 B_20
    s_waitcnt vmcnt(6)
    v_mfma_f32_4x4x4_16b_bf16 v[104:107], v[142:143], v[84:85], 0 cbsz:4 abid:5
    v_readlane_b32 s60, v164, 28
    v_mfma_f32_4x4x4_16b_bf16 v[116:119], v[172:173], v[180:181], 0 cbsz:4 abid:6
    v_exp_f32 v136, v122
    v_exp_f32 v137, v123
    s_and_b32 s33, s60, s34
    v_pk_add_f32 v[136:137], v[136:137], 1.0 op_sel_hi:[1,0]
    v_mfma_f32_4x4x4_16b_bf16 v[108:111], v[142:143], v[86:87], 0 cbsz:4 abid:5
    v_rcp_f32 v136, v136
    v_rcp_f32 v137, v137
    buffer_load_dwordx4 v[80:83], v1, s[12:15], s33 offen
    v_pk_mul_f32 v[132:133], v[136:137], v[122:123]
    s_set_gpr_idx_on s52, 0xc
    v_pk_fma_f32 v[16:17], v[128:129], v[96:97], v[16:17] op_sel:[0,0,0] op_sel_hi:[0,1,1]
    v_pk_fma_f32 v[18:19], v[128:129], v[98:99], v[18:19] op_sel:[0,0,0] op_sel_hi:[0,1,1]
    v_pk_fma_f32 v[20:21], v[130:131], v[100:101], v[20:21] op_sel:[0,0,0] op_sel_hi:[0,1,1]
    v_pk_fma_f32 v[22:23], v[130:131], v[102:103], v[22:23] op_sel:[0,0,0] op_sel_hi:[0,1,1]
    s_set_gpr_idx_off
    s_waitcnt lgkmcnt(0)
    s_waitcnt vmcnt(6)
    v_mfma_f32_4x4x4_16b_bf16 v[96:99], v[144:145], v[88:89], 0 cbsz:4 abid:5
    v_readlane_b32 s61, v164, 29
    v_mfma_f32_4x4x4_16b_bf16 v[116:119], v[172:173], v[182:183], v[116:119] cbsz:4 abid:6
    v_exp_f32 v136, v126
    v_exp_f32 v137, v127
    s_and_b32 s33, s61, s34
    v_pk_add_f32 v[136:137], v[136:137], 1.0 op_sel_hi:[1,0]
    v_mfma_f32_4x4x4_16b_bf16 v[100:103], v[144:145], v[90:91], 0 cbsz:4 abid:5
    v_rcp_f32 v136, v136
    v_rcp_f32 v137, v137
    buffer_load_dwordx4 v[84:87], v1, s[12:15], s33 offen
    v_pk_mul_f32 v[134:135], v[136:137], v[126:127]
    s_set_gpr_idx_on s53, 0xc
    v_pk_fma_f32 v[16:17], v[128:129], v[104:105], v[16:17] op_sel:[1,0,0] op_sel_hi:[1,1,1]
    v_pk_fma_f32 v[18:19], v[128:129], v[106:107], v[18:19] op_sel:[1,0,0] op_sel_hi:[1,1,1]
    v_pk_fma_f32 v[20:21], v[130:131], v[108:109], v[20:21] op_sel:[1,0,0] op_sel_hi:[1,1,1]
    v_pk_fma_f32 v[22:23], v[130:131], v[110:111], v[22:23] op_sel:[1,0,0] op_sel_hi:[1,1,1]
    s_set_gpr_idx_off
    s_waitcnt vmcnt(6)
    v_mfma_f32_4x4x4_16b_bf16 v[104:107], v[146:147], v[92:93], 0 cbsz:4 abid:5
    v_readlane_b32 s62, v164, 30
    v_mfma_f32_4x4x4_16b_bf16 v[120:123], v[172:173], v[176:177], 0 cbsz:4 abid:7
    v_exp_f32 v136, v112
    v_exp_f32 v137, v113
    s_and_b32 s33, s62, s34
    v_pk_add_f32 v[136:137], v[136:137], 1.0 op_sel_hi:[1,0]
    v_mfma_f32_4x4x4_16b_bf16 v[108:111], v[146:147], v[94:95], 0 cbsz:4 abid:5
    v_rcp_f32 v136, v136
    v_rcp_f32 v137, v137
    buffer_load_dwordx4 v[88:91], v1, s[12:15], s33 offen
    v_pk_mul_f32 v[128:129], v[136:137], v[112:113]
    s_set_gpr_idx_on s54, 0xc
    v_pk_fma_f32 v[16:17], v[132:133], v[96:97], v[16:17] op_sel:[0,0,0] op_sel_hi:[0,1,1]
    v_pk_fma_f32 v[18:19], v[132:133], v[98:99], v[18:19] op_sel:[0,0,0] op_sel_hi:[0,1,1]
    v_pk_fma_f32 v[20:21], v[134:135], v[100:101], v[20:21] op_sel:[0,0,0] op_sel_hi:[0,1,1]
    v_pk_fma_f32 v[22:23], v[134:135], v[102:103], v[22:23] op_sel:[0,0,0] op_sel_hi:[0,1,1]
    s_set_gpr_idx_off
    s_waitcnt vmcnt(6)
    v_mfma_f32_4x4x4_16b_bf16 v[96:99], v[140:141], v[64:65], 0 cbsz:4 abid:6
    v_readlane_b32 s63, v164, 31
    v_mfma_f32_4x4x4_16b_bf16 v[120:123], v[172:173], v[178:179], v[120:123] cbsz:4 abid:7
    v_exp_f32 v136, v116
    v_exp_f32 v137, v117
    s_and_b32 s33, s63, s34
    v_pk_add_f32 v[136:137], v[136:137], 1.0 op_sel_hi:[1,0]
    v_mfma_f32_4x4x4_16b_bf16 v[100:103], v[140:141], v[66:67], 0 cbsz:4 abid:6
    v_rcp_f32 v136, v136
    v_rcp_f32 v137, v137
    buffer_load_dwordx4 v[92:95], v1, s[12:15], s33 offen
    v_pk_mul_f32 v[130:131], v[136:137], v[116:117]
    s_set_gpr_idx_on s55, 0xc
    v_pk_fma_f32 v[16:17], v[132:133], v[104:105], v[16:17] op_sel:[1,0,0] op_sel_hi:[1,1,1]
    v_pk_fma_f32 v[18:19], v[132:133], v[106:107], v[18:19] op_sel:[1,0,0] op_sel_hi:[1,1,1]
    v_pk_fma_f32 v[20:21], v[134:135], v[108:109], v[20:21] op_sel:[1,0,0] op_sel_hi:[1,1,1]
    v_pk_fma_f32 v[22:23], v[134:135], v[110:111], v[22:23] op_sel:[1,0,0] op_sel_hi:[1,1,1]
    s_set_gpr_idx_off
A_24:
    s_sub_u32 s31, s31, 4
    s_cbranch_scc1 B_24
    s_waitcnt vmcnt(6)
    v_mfma_f32_4x4x4_16b_bf16 v[104:107], v[142:143], v[68:69], 0 cbsz:4 abid:6
    v_readlane_b32 s48, v164, 32
    v_mfma_f32_4x4x4_16b_bf16 v[124:127], v[172:173], v[180:181], 0 cbsz:4 abid:7
    v_exp_f32 v136, v114
    v_exp_f32 v137, v115
    s_and_b32 s33, s48, s34
    v_pk_add_f32 v[136:137], v[136:137], 1.0 op_sel_hi:[1,0]
    v_mfma_f32_4x4x4_16b_bf16 v[108:111], v[142:143], v[70:71], 0 cbsz:4 abid:6
    v_rcp_f32 v136, v136
    v_rcp_f32 v137, v137
    buffer_load_dwordx4 v[64:67], v1, s[12:15], s33 offen
    v_pk_mul_f32 v[132:133], v[136:137], v[114:115]
    s_set_gpr_idx_on s56, 0xc
    v_pk_fma_f32 v[16:17], v[128:129], v[96:97], v[16:17] op_sel:[0,0,0] op_sel_hi:[0,1,1]
    v_pk_fma_f32 v[18:19], v[128:129], v[98:99], v[18:19] op_sel:[0,0,0] op_sel_hi:[0,1,1]
    v_pk_fma_f32 v[20:21], v[130:131], v[100:101], v[20:21] op_sel:[0,0,0] op_sel_hi:[0,1,1]
    v_pk_fma_f32 v[22:23], v[130:131], v[102:103], v[22:23] op_sel:[0,0,0] op_sel_hi:[0,1,1]
    s_set_gpr_idx_off
    s_waitcnt vmcnt(6)
    v_mfma_f32_4x4x4_16b_bf16 v[96:99], v[144:145], v[72:73], 0 cbsz:4 abid:6
    v_readlane_b32 s49, v164, 33
    v_mfma_f32_4x4x4_16b_bf16 v[124:127], v[172:173], v[182:183], v[124:127] cbsz:4 abid:7
    v_exp_f32 v136, v118
    v_exp_f32 v137, v119
    s_and_b32 s33, s49, s34
    v_pk_add_f32 v[136:137], v[136:137], 1.0 op_sel_hi:[1,0]
    v_mfma_f32_4x4x4_16b_bf16 v[100:103], v[144:145], v[74:75], 0 cbsz:4 abid:6
    v_rcp_f32 v136, v136
    v_rcp_f32 v137, v137
    buffer_load_dwordx4 v[68:71], v1, s[12:15], s33 offen
    v_pk_mul_f32 v[134:135], v[136:137], v[118:119]
    s_set_gpr_idx_on s57, 0xc
    v_pk_fma_f32 v[16:17], v[128:129], v[104:105], v[16:17] op_sel:[1,0,0] op_sel_hi:[1,1,1]
    v_pk_fma_f32 v[18:19], v[128:129], v[106:107], v[18:19] op_sel:[1,0,0] op_sel_hi:[1,1,1]
    v_pk_fma_f32 v[20:21], v[130:131], v[108:109], v[20:21] op_sel:[1,0,0] op_sel_hi:[1,1,1]
    v_pk_fma_f32 v[22:23], v[130:131], v[110:111], v[22:23] op_sel:[1,0,0] op_sel_hi:[1,1,1]
    s_set_gpr_idx_off
    s_waitcnt vmcnt(6)
    v_mfma_f32_4x4x4_16b_bf16 v[104:107], v[146:147], v[76:77], 0 cbsz:4 abid:6
    v_readlane_b32 s50, v164, 34
    v_mfma_f32_4x4x4_16b_bf16 v[112:115], v[172:173], v[176:177], 0 cbsz:4 abid:8
    v_exp_f32 v136, v120
    v_exp_f32 v137, v121
    s_and_b32 s33, s50, s34
    v_pk_add_f32 v[136:137], v[136:137], 1.0 op_sel_hi:[1,0]
    v_mfma_f32_4x4x4_16b_bf16 v[108:111], v[146:147], v[78:79], 0 cbsz:4 abid:6
    v_rcp_f32 v136, v136
    v_rcp_f32 v137, v137
    buffer_load_dwordx4 v[72:75], v1, s[12:15], s33 offen
    v_pk_mul_f32 v[128:129], v[136:137], v[120:121]
    s_set_gpr_idx_on s58, 0xc
    v_pk_fma_f32 v[16:17], v[132:133], v[96:97], v[16:17] op_sel:[0,0,0] op_sel_hi:[0,1,1]
    v_pk_fma_f32 v[18:19], v[132:133], v[98:99], v[18:19] op_sel:[0,0,0] op_sel_hi:[0,1,1]
    v_pk_fma_f32 v[20:21], v[134:135], v[100:101], v[20:21] op_sel:[0,0,0] op_sel_hi:[0,1,1]
    v_pk_fma_f32 v[22:23], v[134:135], v[102:103], v[22:23] op_sel:[0,0,0] op_sel_hi:[0,1,1]
    s_set_gpr_idx_off
    s_waitcnt vmcnt(6)
    v_mfma_f32_4x4x4_16b_bf16 v[96:99], v[140:141], v[80:81], 0 cbsz:4 abid:7
    v_readlane_b32 s51, v164, 35
    v_mfma_f32_4x4x4_16b_bf16 v[112:115], v[172:173], v[178:179], v[112:115] cbsz:4 abid:8
    v_exp_f32 v136, v124
    v_exp_f32 v137, v125
    s_and_b32 s33, s51, s34
    v_pk_add_f32 v[136:137], v[136:137], 1.0 op_sel_hi:[1,0]
    v_mfma_f32_4x4x4_16b_bf16 v[100:103], v[140:141], v[82:83], 0 cbsz:4 abid:7
    v_rcp_f32 v136, v136
    v_rcp_f32 v137, v137
    buffer_load_dwordx4 v[76:79], v1, s[12:15], s33 offen
    v_pk_mul_f32 v[130:131], v[136:137], v[124:125]
    s_set_gpr_idx_on s59, 0xc
    v_pk_fma_f32 v[16:17], v[132:133], v[104:105], v[16:17] op_sel:[1,0,0] op_sel_hi:[1,1,1]
    v_pk_fma_f32 v[18:19], v[132:133], v[106:107], v[18:19] op_sel:[1,0,0] op_sel_hi:[1,1,1]
    v_pk_fma_f32 v[20:21], v[134:135], v[108:109], v[20:21] op_sel:[1,0,0] op_sel_hi:[1,1,1]
    v_pk_fma_f32 v[22:23], v[134:135], v[110:111], v[22:23] op_sel:[1,0,0] op_sel_hi:[1,1,1]
    s_set_gpr_idx_off
A_28:
    s_sub_u32 s31, s31, 4
    s_cbranch_scc1 B_28
    s_waitcnt vmcnt(6)
    v_mfma_f32_4x4x4_16b_bf16 v[104:107], v[142:143], v[84:85], 0 cbsz:4 abid:7
    v_readlane_b32 s52, v164, 36
    v_mfma_f32_4x4x4_16b_bf16 v[116:119], v[172:173], v[180:181], 0 cbsz:4 abid:8
    v_exp_f32 v136, v122
    v_exp_f32 v137, v123
    s_and_b32 s33, s52, s34
    v_pk_add_f32 v[136:137], v[136:137], 1.0 op_sel_hi:[1,0]
    v_mfma_f32_4x4x4_16b_bf16 v[108:111], v[142:143], v[86:87], 0 cbsz:4 abid:7
    v_rcp_f32 v136, v136
    v_rcp_f32 v137, v137
    buffer_load_dwordx4 v[80:83], v1, s[12:15], s33 offen
    v_pk_mul_f32 v[132:133], v[136:137], v[122:123]
    s_set_gpr_idx_on s60, 0xc
    v_pk_fma_f32 v[16:17], v[128:129], v[96:97], v[16:17] op_sel:[0,0,0] op_sel_hi:[0,1,1]
    v_pk_fma_f32 v[18:19], v[128:129], v[98:99], v[18:19] op_sel:[0,0,0] op_sel_hi:[0,1,1]
    v_pk_fma_f32 v[20:21], v[130:131], v[100:101], v[20:21] op_sel:[0,0,0] op_sel_hi:[0,1,1]
    v_pk_fma_f32 v[22:23], v[130:131], v[102:103], v[22:23] op_sel:[0,0,0] op_sel_hi:[0,1,1]
    s_set_gpr_idx_off
    s_waitcnt vmcnt(6)
    v_mfma_f32_4x4x4_16b_bf16 v[96:99], v[144:145], v[88:89], 0 cbsz:4 abid:7
    v_readlane_b32 s53, v164, 37
    v_mfma_f32_4x4x4_16b_bf16 v[116:119], v[172:173], v[182:183], v[116:119] cbsz:4 abid:8
    v_exp_f32 v136, v126
    v_exp_f32 v137, v127
    s_and_b32 s33, s53, s34
    v_pk_add_f32 v[136:137], v[136:137], 1.0 op_sel_hi:[1,0]
    v_mfma_f32_4x4x4_16b_bf16 v[100:103], v[144:145], v[90:91], 0 cbsz:4 abid:7
    v_rcp_f32 v136, v136
    v_rcp_f32 v137, v137
    buffer_load_dwordx4 v[84:87], v1, s[12:15], s33 offen
    v_pk_mul_f32 v[134:135], v[136:137], v[126:127]
    s_set_gpr_idx_on s61, 0xc
    v_pk_fma_f32 v[16:17], v[128:129], v[104:105], v[16:17] op_sel:[1,0,0] op_sel_hi:[1,1,1]
    v_pk_fma_f32 v[18:19], v[128:129], v[106:107], v[18:19] op_sel:[1,0,0] op_sel_hi:[1,1,1]
    v_pk_fma_f32 v[20:21], v[130:131], v[108:109], v[20:21] op_sel:[1,0,0] op_sel_hi:[1,1,1]
    v_pk_fma_f32 v[22:23], v[130:131], v[110:111], v[22:23] op_sel:[1,0,0] op_sel_hi:[1,1,1]
    s_set_gpr_idx_off
    s_waitcnt vmcnt(6)
    v_mfma_f32_4x4x4_16b_bf16 v[104:107], v[146:147], v[92:93], 0 cbsz:4 abid:7
    v_readlane_b32 s54, v164, 38
    v_mfma_f32_4x4x4_16b_bf16 v[120:123], v[172:173], v[176:177], 0 cbsz:4 abid:9
    v_exp_f32 v136, v112
    v_exp_f32 v137, v113
    s_and_b32 s33, s54, s34
    v_pk_add_f32 v[136:137], v[136:137], 1.0 op_sel_hi:[1,0]
    v_mfma_f32_4x4x4_16b_bf16 v[108:111], v[146:147], v[94:95], 0 cbsz:4 abid:7
    v_rcp_f32 v136, v136
    v_rcp_f32 v137, v137
    buffer_load_dwordx4 v[88:91], v1, s[12:15], s33 offen
    v_pk_mul_f32 v[128:129], v[136:137], v[112:113]
    s_set_gpr_idx_on s62, 0xc
    v_pk_fma_f32 v[16:17], v[132:133], v[96:97], v[16:17] op_sel:[0,0,0] op_sel_hi:[0,1,1]
    v_pk_fma_f32 v[18:19], v[132:133], v[98:99], v[18:19] op_sel:[0,0,0] op_sel_hi:[0,1,1]
    v_pk_fma_f32 v[20:21], v[134:135], v[100:101], v[20:21] op_sel:[0,0,0] op_sel_hi:[0,1,1]
    v_pk_fma_f32 v[22:23], v[134:135], v[102:103], v[22:23] op_sel:[0,0,0] op_sel_hi:[0,1,1]
    s_set_gpr_idx_off
    s_waitcnt vmcnt(6)
    v_mfma_f32_4x4x4_16b_bf16 v[96:99], v[140:141], v[64:65], 0 cbsz:4 abid:8
    v_readlane_b32 s55, v164, 39
    v_mfma_f32_4x4x4_16b_bf16 v[120:123], v[172:173], v[178:179], v[120:123] cbsz:4 abid:9
    v_exp_f32 v136, v116
    v_exp_f32 v137, v117
    s_and_b32 s33, s55, s34
    v_pk_add_f32 v[136:137], v[136:137], 1.0 op_sel_hi:[1,0]
    v_mfma_f32_4x4x4_16b_bf16 v[100:103], v[140:141], v[66:67], 0 cbsz:4 abid:8
    v_rcp_f32 v136, v136
    v_rcp_f32 v137, v137
    buffer_load_dwordx4 v[92:95], v1, s[12:15], s33 offen
    v_pk_mul_f32 v[130:131], v[136:137], v[116:117]
    s_set_gpr_idx_on s63, 0xc
    v_pk_fma_f32 v[16:17], v[132:133], v[104:105], v[16:17] op_sel:[1,0,0] op_sel_hi:[1,1,1]
    v_pk_fma_f32 v[18:19], v[132:133], v[106:107], v[18:19] op_sel:[1,0,0] op_sel_hi:[1,1,1]
    v_pk_fma_f32 v[20:21], v[134:135], v[108:109], v[20:21] op_sel:[1,0,0] op_sel_hi:[1,1,1]
    v_pk_fma_f32 v[22:23], v[134:135], v[110:111], v[22:23] op_sel:[1,0,0] op_sel_hi:[1,1,1]
    s_set_gpr_idx_off
A_32:
    s_sub_u32 s31, s31, 4
    s_cbranch_scc1 B_32
    s_waitcnt vmcnt(6)
    v_mfma_f32_4x4x4_16b_bf16 v[104:107], v[142:143], v[68:69], 0 cbsz:4 abid:8
    v_readlane_b32 s56, v164, 40
    v_mfma_f32_4x4x4_16b_bf16 v[124:127], v[172:173], v[180:181], 0 cbsz:4 abid:9
    v_exp_f32 v136, v114
    v_exp_f32 v137, v115
    s_and_b32 s33, s56, s34
    v_pk_add_f32 v[136:137], v[136:137], 1.0 op_sel_hi:[1,0]
    v_mfma_f32_4x4x4_16b_bf16 v[108:111], v[142:143], v[70:71], 0 cbsz:4 abid:8
    v_rcp_f32 v136, v136
    v_rcp_f32 v137, v137
    buffer_load_dwordx4 v[64:67], v1, s[12:15], s33 offen
    v_pk_mul_f32 v[132:133], v[136:137], v[114:115]
    s_set_gpr_idx_on s48, 0xc
    v_pk_fma_f32 v[16:17], v[128:129], v[96:97], v[16:17] op_sel:[0,0,0] op_sel_hi:[0,1,1]
    v_pk_fma_f32 v[18:19], v[128:129], v[98:99], v[18:19] op_sel:[0,0,0] op_sel_hi:[0,1,1]
    v_pk_fma_f32 v[20:21], v[130:131], v[100:101], v[20:21] op_sel:[0,0,0] op_sel_hi:[0,1,1]
    v_pk_fma_f32 v[22:23], v[130:131], v[102:103], v[22:23] op_sel:[0,0,0] op_sel_hi:[0,1,1]
    s_set_gpr_idx_off
    s_waitcnt vmcnt(6)
    v_mfma_f32_4x4x4_16b_bf16 v[96:99], v[144:145], v[72:73], 0 cbsz:4 abid:8
    v_readlane_b32 s57, v164, 41
    v_mfma_f32_4x4x4_16b_bf16 v[124:127], v[172:173], v[182:183], v[124:127] cbsz:4 abid:9
    v_exp_f32 v136, v118
    v_exp_f32 v137, v119
    s_and_b32 s33, s57, s34
    v_pk_add_f32 v[136:137], v[136:137], 1.0 op_sel_hi:[1,0]
    v_mfma_f32_4x4x4_16b_bf16 v[100:103], v[144:145], v[74:75], 0 cbsz:4 abid:8
    v_rcp_f32 v136, v136
    v_rcp_f32 v137, v137
    buffer_load_dwordx4 v[68:71], v1, s[12:15], s33 offen
    v_pk_mul_f32 v[134:135], v[136:137], v[118:119]
    s_set_gpr_idx_on s49, 0xc
    v_pk_fma_f32 v[16:17], v[128:129], v[104:105], v[16:17] op_sel:[1,0,0] op_sel_hi:[1,1,1]
    v_pk_fma_f32 v[18:19], v[128:129], v[106:107], v[18:19] op_sel:[1,0,0] op_sel_hi:[1,1,1]
    v_pk_fma_f32 v[20:21], v[130:131], v[108:109], v[20:21] op_sel:[1,0,0] op_sel_hi:[1,1,1]
    v_pk_fma_f32 v[22:23], v[130:131], v[110:111], v[22:23] op_sel:[1,0,0] op_sel_hi:[1,1,1]
    s_set_gpr_idx_off
    s_waitcnt vmcnt(6)
    v_mfma_f32_4x4x4_16b_bf16 v[104:107], v[146:147], v[76:77], 0 cbsz:4 abid:8
    v_readlane_b32 s58, v164, 42
    v_mfma_f32_4x4x4_16b_bf16 v[112:115], v[172:173], v[176:177], 0 cbsz:4 abid:10
    v_exp_f32 v136, v120
    v_exp_f32 v137, v121
    s_and_b32 s33, s58, s34
    v_pk_add_f32 v[136:137], v[136:137], 1.0 op_sel_hi:[1,0]
    v_mfma_f32_4x4x4_16b_bf16 v[108:111], v[146:147], v[78:79], 0 cbsz:4 abid:8
    v_rcp_f32 v136, v136
    v_rcp_f32 v137, v137
    buffer_load_dwordx4 v[72:75], v1, s[12:15], s33 offen
    v_pk_mul_f32 v[128:129], v[136:137], v[120:121]
    s_set_gpr_idx_on s50, 0xc
    v_pk_fma_f32 v[16:17], v[132:133], v[96:97], v[16:17] op_sel:[0,0,0] op_sel_hi:[0,1,1]
    v_pk_fma_f32 v[18:19], v[132:133], v[98:99], v[18:19] op_sel:[0,0,0] op_sel_hi:[0,1,1]
    v_pk_fma_f32 v[20:21], v[134:135], v[100:101], v[20:21] op_sel:[0,0,0] op_sel_hi:[0,1,1]
    v_pk_fma_f32 v[22:23], v[134:135], v[102:103], v[22:23] op_sel:[0,0,0] op_sel_hi:[0,1,1]
    s_set_gpr_idx_off
    s_waitcnt vmcnt(6)
    v_mfma_f32_4x4x4_16b_bf16 v[96:99], v[140:141], v[80:81], 0 cbsz:4 abid:9
    v_readlane_b32 s59, v164, 43
    v_mfma_f32_4x4x4_16b_bf16 v[112:115], v[172:173], v[178:179], v[112:115] cbsz:4 abid:10
    v_exp_f32 v136, v124
    v_exp_f32 v137, v125
    s_and_b32 s33, s59, s34
    v_pk_add_f32 v[136:137], v[136:137], 1.0 op_sel_hi:[1,0]
    v_mfma_f32_4x4x4_16b_bf16 v[100:103], v[140:141], v[82:83], 0 cbsz:4 abid:9
    v_rcp_f32 v136, v136
    v_rcp_f32 v137, v137
    buffer_load_dwordx4 v[76:79], v1, s[12:15], s33 offen
    v_pk_mul_f32 v[130:131], v[136:137], v[124:125]
    s_set_gpr_idx_on s51, 0xc
    v_pk_fma_f32 v[16:17], v[132:133], v[104:105], v[16:17] op_sel:[1,0,0] op_sel_hi:[1,1,1]
    v_pk_fma_f32 v[18:19], v[132:133], v[106:107], v[18:19] op_sel:[1,0,0] op_sel_hi:[1,1,1]
    v_pk_fma_f32 v[20:21], v[134:135], v[108:109], v[20:21] op_sel:[1,0,0] op_sel_hi:[1,1,1]
    v_pk_fma_f32 v[22:23], v[134:135], v[110:111], v[22:23] op_sel:[1,0,0] op_sel_hi:[1,1,1]
    s_set_gpr_idx_off
A_36:
    s_sub_u32 s31, s31, 4
    s_cbranch_scc1 B_36
    s_waitcnt vmcnt(6)
    v_mfma_f32_4x4x4_16b_bf16 v[104:107], v[142:143], v[84:85], 0 cbsz:4 abid:9
    v_readlane_b32 s60, v164, 44
    v_mfma_f32_4x4x4_16b_bf16 v[116:119], v[172:173], v[180:181], 0 cbsz:4 abid:10
    v_exp_f32 v136, v122
    v_exp_f32 v137, v123
    s_and_b32 s33, s60, s34
    v_pk_add_f32 v[136:137], v[136:137], 1.0 op_sel_hi:[1,0]
    v_mfma_f32_4x4x4_16b_bf16 v[108:111], v[142:143], v[86:87], 0 cbsz:4 abid:9
    v_rcp_f32 v136, v136
    v_rcp_f32 v137, v137
    buffer_load_dwordx4 v[80:83], v1, s[12:15], s33 offen
    v_pk_mul_f32 v[132:133], v[136:137], v[122:123]
    s_set_gpr_idx_on s52, 0xc
    v_pk_fma_f32 v[16:17], v[128:129], v[96:97], v[16:17] op_sel:[0,0,0] op_sel_hi:[0,1,1]
    v_pk_fma_f32 v[18:19], v[128:129], v[98:99], v[18:19] op_sel:[0,0,0] op_sel_hi:[0,1,1]
    v_pk_fma_f32 v[20:21], v[130:131], v[100:101], v[20:21] op_sel:[0,0,0] op_sel_hi:[0,1,1]
    v_pk_fma_f32 v[22:23], v[130:131], v[102:103], v[22:23] op_sel:[0,0,0] op_sel_hi:[0,1,1]
    s_set_gpr_idx_off
    s_waitcnt vmcnt(6)
    v_mfma_f32_4x4x4_16b_bf16 v[96:99], v[144:145], v[88:89], 0 cbsz:4 abid:9
    v_readlane_b32 s61, v164, 45
    v_mfma_f32_4x4x4_16b_bf16 v[116:119], v[172:173], v[182:183], v[116:119] cbsz:4 abid:10
    v_exp_f32 v136, v126
    v_exp_f32 v137, v127
    s_and_b32 s33, s61, s34
    v_pk_add_f32 v[136:137], v[136:137], 1.0 op_sel_hi:[1,0]
    v_mfma_f32_4x4x4_16b_bf16 v[100:103], v[144:145], v[90:91], 0 cbsz:4 abid:9
    v_rcp_f32 v136, v136
    v_rcp_f32 v137, v137
    buffer_load_dwordx4 v[84:87], v1, s[12:15], s33 offen
    v_pk_mul_f32 v[134:135], v[136:137], v[126:127]
    s_set_gpr_idx_on s53, 0xc
    v_pk_fma_f32 v[16:17], v[128:129], v[104:105], v[16:17] op_sel:[1,0,0] op_sel_hi:[1,1,1]
    v_pk_fma_f32 v[18:19], v[128:129], v[106:107], v[18:19] op_sel:[1,0,0] op_sel_hi:[1,1,1]
    v_pk_fma_f32 v[20:21], v[130:131], v[108:109], v[20:21] op_sel:[1,0,0] op_sel_hi:[1,1,1]
    v_pk_fma_f32 v[22:23], v[130:131], v[110:111], v[22:23] op_sel:[1,0,0] op_sel_hi:[1,1,1]
    s_set_gpr_idx_off
    s_waitcnt vmcnt(6)
    v_mfma_f32_4x4x4_16b_bf16 v[104:107], v[146:147], v[92:93], 0 cbsz:4 abid:9
    v_readlane_b32 s62, v164, 46
    v_mfma_f32_4x4x4_16b_bf16 v[120:123], v[172:173], v[176:177], 0 cbsz:4 abid:11
    v_exp_f32 v136, v112
    v_exp_f32 v137, v113
    s_and_b32 s33, s62, s34
    v_pk_add_f32 v[136:137], v[136:137], 1.0 op_sel_hi:[1,0]
    v_mfma_f32_4x4x4_16b_bf16 v[108:111], v[146:147], v[94:95], 0 cbsz:4 abid:9
    v_rcp_f32 v136, v136
    v_rcp_f32 v137, v137
    buffer_load_dwordx4 v[88:91], v1, s[12:15], s33 offen
    v_pk_mul_f32 v[128:129], v[136:137], v[112:113]
    s_set_gpr_idx_on s54, 0xc
    v_pk_fma_f32 v[16:17], v[132:133], v[96:97], v[16:17] op_sel:[0,0,0] op_sel_hi:[0,1,1]
    v_pk_fma_f32 v[18:19], v[132:133], v[98:99], v[18:19] op_sel:[0,0,0] op_sel_hi:[0,1,1]
    v_pk_fma_f32 v[20:21], v[134:135], v[100:101], v[20:21] op_sel:[0,0,0] op_sel_hi:[0,1,1]
    v_pk_fma_f32 v[22:23], v[134:135], v[102:103], v[22:23] op_sel:[0,0,0] op_sel_hi:[0,1,1]
    s_set_gpr_idx_off
    s_waitcnt vmcnt(6)
    v_mfma_f32_4x4x4_16b_bf16 v[96:99], v[140:141], v[64:65], 0 cbsz:4 abid:10
    v_readlane_b32 s63, v164, 47
    v_mfma_f32_4x4x4_16b_bf16 v[120:123], v[172:173], v[178:179], v[120:123] cbsz:4 abid:11
    v_exp_f32 v136, v116
    v_exp_f32 v137, v117
    s_and_b32 s33, s63, s34
    v_pk_add_f32 v[136:137], v[136:137], 1.0 op_sel_hi:[1,0]
    v_mfma_f32_4x4x4_16b_bf16 v[100:103], v[140:141], v[66:67], 0 cbsz:4 abid:10
    v_rcp_f32 v136, v136
    v_rcp_f32 v137, v137
    buffer_load_dwordx4 v[92:95], v1, s[12:15], s33 offen
    v_pk_mul_f32 v[130:131], v[136:137], v[116:117]
    s_set_gpr_idx_on s55, 0xc
    v_pk_fma_f32 v[16:17], v[132:133], v[104:105], v[16:17] op_sel:[1,0,0] op_sel_hi:[1,1,1]
    v_pk_fma_f32 v[18:19], v[132:133], v[106:107], v[18:19] op_sel:[1,0,0] op_sel_hi:[1,1,1]
    v_pk_fma_f32 v[20:21], v[134:135], v[108:109], v[20:21] op_sel:[1,0,0] op_sel_hi:[1,1,1]
    v_pk_fma_f32 v[22:23], v[134:135], v[110:111], v[22:23] op_sel:[1,0,0] op_sel_hi:[1,1,1]
    s_set_gpr_idx_off
A_40:
    s_sub_u32 s31, s31, 4
    s_cbranch_scc1 B_40
    s_waitcnt vmcnt(6)
    v_mfma_f32_4x4x4_16b_bf16 v[104:107], v[142:143], v[68:69], 0 cbsz:4 abid:10
    v_readlane_b32 s48, v164, 48
    v_mfma_f32_4x4x4_16b_bf16 v[124:127], v[172:173], v[180:181], 0 cbsz:4 abid:11
    v_exp_f32 v136, v114
    v_exp_f32 v137, v115
    s_and_b32 s33, s48, s34
    v_pk_add_f32 v[136:137], v[136:137], 1.0 op_sel_hi:[1,0]
    v_mfma_f32_4x4x4_16b_bf16 v[108:111], v[142:143], v[70:71], 0 cbsz:4 abid:10
    v_mfma_f32_4x4x4_16b_bf16 v[148:151], v[168:169], v[184:185], 0
    v_rcp_f32 v136, v136
    v_rcp_f32 v137, v137
    buffer_load_dwordx4 v[64:67], v1, s[12:15], s33 offen
    v_pk_mul_f32 v[132:133], v[136:137], v[114:115]
    s_set_gpr_idx_on s56, 0xc
    v_pk_fma_f32 v[16:17], v[128:129], v[96:97], v[16:17] op_sel:[0,0,0] op_sel_hi:[0,1,1]
    v_pk_fma_f32 v[18:19], v[128:129], v[98:99], v[18:19] op_sel:[0,0,0] op_sel_hi:[0,1,1]
    v_pk_fma_f32 v[20:21], v[130:131], v[100:101], v[20:21] op_sel:[0,0,0] op_sel_hi:[0,1,1]
    v_pk_fma_f32 v[22:23], v[130:131], v[102:103], v[22:23] op_sel:[0,0,0] op_sel_hi:[0,1,1]
    s_set_gpr_idx_off
    s_waitcnt vmcnt(6)
    v_mfma_f32_4x4x4_16b_bf16 v[96:99], v[144:145], v[72:73], 0 cbsz:4 abid:10
    v_readlane_b32 s49, v164, 49
    v_mfma_f32_4x4x4_16b_bf16 v[124:127], v[172:173], v[182:183], v[124:127] cbsz:4 abid:11
    v_exp_f32 v136, v118
    v_exp_f32 v137, v119
    s_and_b32 s33, s49, s34
    v_pk_add_f32 v[136:137], v[136:137], 1.0 op_sel_hi:[1,0]
    v_mfma_f32_4x4x4_16b_bf16 v[100:103], v[144:145], v[74:75], 0 cbsz:4 abid:10
    v_mfma_f32_4x4x4_16b_bf16 v[152:155], v[168:169], v[186:187], 0
    v_rcp_f32 v136, v136
    v_rcp_f32 v137, v137
    buffer_load_dwordx4 v[68:71], v1, s[12:15], s33 offen
    v_pk_mul_f32 v[134:135], v[136:137], v[118:119]
    s_set_gpr_idx_on s57, 0xc
    v_pk_fma_f32 v[16:17], v[128:129], v[104:105], v[16:17] op_sel:[1,0,0] op_sel_hi:[1,1,1]
    v_pk_fma_f32 v[18:19], v[128:129], v[106:107], v[18:19] op_sel:[1,0,0] op_sel_hi:[1,1,1]
    v_pk_fma_f32 v[20:21], v[130:131], v[108:109], v[20:21] op_sel:[1,0,0] op_sel_hi:[1,1,1]
    v_pk_fma_f32 v[22:23], v[130:131], v[110:111], v[22:23] op_sel:[1,0,0] op_sel_hi:[1,1,1]
    s_set_gpr_idx_off
    s_waitcnt vmcnt(6)
    v_mfma_f32_4x4x4_16b_bf16 v[104:107], v[146:147], v[76:77], 0 cbsz:4 abid:10
    v_readlane_b32 s50, v164, 50
    v_mfma_f32_4x4x4_16b_bf16 v[112:115], v[172:173], v[176:177], 0 cbsz:4 abid:12
    v_exp_f32 v136, v120
    v_exp_f32 v137, v121
    s_and_b32 s33, s50, s34
    v_pk_add_f32 v[136:137], v[136:137], 1.0 op_sel_hi:[1,0]
    v_mfma_f32_4x4x4_16b_bf16 v[108:111], v[146:147], v[78:79], 0 cbsz:4 abid:10
    v_mfma_f32_4x4x4_16b_bf16 v[156:159], v[168:169], v[188:189], 0
    v_rcp_f32 v136, v136
    v_rcp_f32 v137, v137
    buffer_load_dwordx4 v[72:75], v1, s[12:15], s33 offen
    v_pk_mul_f32 v[128:129], v[136:137], v[120:121]
    s_set_gpr_idx_on s58, 0xc
    v_pk_fma_f32 v[16:17], v[132:133], v[96:97], v[16:17] op_sel:[0,0,0] op_sel_hi:[0,1,1]
    v_pk_fma_f32 v[18:19], v[132:133], v[98:99], v[18:19] op_sel:[0,0,0] op_sel_hi:[0,1,1]
    v_pk_fma_f32 v[20:21], v[134:135], v[100:101], v[20:21] op_sel:[0,0,0] op_sel_hi:[0,1,1]
    v_pk_fma_f32 v[22:23], v[134:135], v[102:103], v[22:23] op_sel:[0,0,0] op_sel_hi:[0,1,1]
    s_set_gpr_idx_off
    s_waitcnt vmcnt(6)
    v_mfma_f32_4x4x4_16b_bf16 v[96:99], v[140:141], v[80:81], 0 cbsz:4 abid:11
    v_readlane_b32 s51, v164, 51
    v_mfma_f32_4x4x4_16b_bf16 v[112:115], v[172:173], v[178:179], v[112:115] cbsz:4 abid:12
    v_exp_f32 v136, v124
    v_exp_f32 v137, v125
    s_and_b32 s33, s51, s34
    v_pk_add_f32 v[136:137], v[136:137], 1.0 op_sel_hi:[1,0]
    v_mfma_f32_4x4x4_16b_bf16 v[100:103], v[140:141], v[82:83], 0 cbsz:4 abid:11
    v_mfma_f32_4x4x4_16b_bf16 v[160:163], v[168:169], v[190:191], 0
    v_rcp_f32 v136, v136
    v_rcp_f32 v137, v137
    buffer_load_dwordx4 v[76:79], v1, s[12:15], s33 offen
    v_pk_mul_f32 v[130:131], v[136:137], v[124:125]
    s_set_gpr_idx_on s59, 0xc
    v_pk_fma_f32 v[16:17], v[132:133], v[104:105], v[16:17] op_sel:[1,0,0] op_sel_hi:[1,1,1]
    v_pk_fma_f32 v[18:19], v[132:133], v[106:107], v[18:19] op_sel:[1,0,0] op_sel_hi:[1,1,1]
    v_pk_fma_f32 v[20:21], v[134:135], v[108:109], v[20:21] op_sel:[1,0,0] op_sel_hi:[1,1,1]
    v_pk_fma_f32 v[22:23], v[134:135], v[110:111], v[22:23] op_sel:[1,0,0] op_sel_hi:[1,1,1]
    s_set_gpr_idx_off
A_44:
    s_sub_u32 s31, s31, 4
    s_cbranch_scc1 B_44
    s_waitcnt vmcnt(6)
    v_mfma_f32_4x4x4_16b_bf16 v[104:107], v[142:143], v[84:85], 0 cbsz:4 abid:11
    v_readlane_b32 s52, v164, 52
    v_mfma_f32_4x4x4_16b_bf16 v[116:119], v[172:173], v[180:181], 0 cbsz:4 abid:12
    v_exp_f32 v136, v122
    v_exp_f32 v137, v123
    s_and_b32 s33, s52, s34
    v_pk_add_f32 v[136:137], v[136:137], 1.0 op_sel_hi:[1,0]
    v_mfma_f32_4x4x4_16b_bf16 v[108:111], v[142:143], v[86:87], 0 cbsz:4 abid:11
    v_rcp_f32 v136, v136
    v_rcp_f32 v137, v137
    buffer_load_dwordx4 v[80:83], v1, s[12:15], s33 offen
    v_pk_mul_f32 v[132:133], v[136:137], v[122:123]
    s_set_gpr_idx_on s60, 0xc
    v_pk_fma_f32 v[16:17], v[128:129], v[96:97], v[16:17] op_sel:[0,0,0] op_sel_hi:[0,1,1]
    v_pk_fma_f32 v[18:19], v[128:129], v[98:99], v[18:19] op_sel:[0,0,0] op_sel_hi:[0,1,1]
    v_pk_fma_f32 v[20:21], v[130:131], v[100:101], v[20:21] op_sel:[0,0,0] op_sel_hi:[0,1,1]
    v_pk_fma_f32 v[22:23], v[130:131], v[102:103], v[22:23] op_sel:[0,0,0] op_sel_hi:[0,1,1]
    s_set_gpr_idx_off
    s_waitcnt vmcnt(6)
    v_mfma_f32_4x4x4_16b_bf16 v[96:99], v[144:145], v[88:89], 0 cbsz:4 abid:11
    v_readlane_b32 s53, v164, 53
    v_mfma_f32_4x4x4_16b_bf16 v[116:119], v[172:173], v[182:183], v[116:119] cbsz:4 abid:12
    v_exp_f32 v136, v126
    v_exp_f32 v137, v127
    s_and_b32 s33, s53, s34
    v_pk_add_f32 v[136:137], v[136:137], 1.0 op_sel_hi:[1,0]
    v_mfma_f32_4x4x4_16b_bf16 v[100:103], v[144:145], v[90:91], 0 cbsz:4 abid:11
    v_rcp_f32 v136, v136
    v_rcp_f32 v137, v137
    buffer_load_dwordx4 v[84:87], v1, s[12:15], s33 offen
    v_pk_mul_f32 v[134:135], v[136:137], v[126:127]
    s_set_gpr_idx_on s61, 0xc
    v_pk_fma_f32 v[16:17], v[128:129], v[104:105], v[16:17] op_sel:[1,0,0] op_sel_hi:[1,1,1]
    v_pk_fma_f32 v[18:19], v[128:129], v[106:107], v[18:19] op_sel:[1,0,0] op_sel_hi:[1,1,1]
    v_pk_fma_f32 v[20:21], v[130:131], v[108:109], v[20:21] op_sel:[1,0,0] op_sel_hi:[1,1,1]
    v_pk_fma_f32 v[22:23], v[130:131], v[110:111], v[22:23] op_sel:[1,0,0] op_sel_hi:[1,1,1]
    s_set_gpr_idx_off
    s_waitcnt vmcnt(6)
    v_mfma_f32_4x4x4_16b_bf16 v[104:107], v[146:147], v[92:93], 0 cbsz:4 abid:11
    v_readlane_b32 s54, v164, 54
    v_mfma_f32_4x4x4_16b_bf16 v[120:123], v[172:173], v[176:177], 0 cbsz:4 abid:13
    v_exp_f32 v136, v112
    v_exp_f32 v137, v113
    s_and_b32 s33, s54, s34
    v_pk_add_f32 v[136:137], v[136:137], 1.0 op_sel_hi:[1,0]
    v_mfma_f32_4x4x4_16b_bf16 v[108:111], v[146:147], v[94:95], 0 cbsz:4 abid:11
    v_rcp_f32 v136, v136
    v_rcp_f32 v137, v137
    buffer_load_dwordx4 v[88:91], v1, s[12:15], s33 offen
    v_pk_mul_f32 v[128:129], v[136:137], v[112:113]
    s_set_gpr_idx_on s62, 0xc
    v_pk_fma_f32 v[16:17], v[132:133], v[96:97], v[16:17] op_sel:[0,0,0] op_sel_hi:[0,1,1]
    v_pk_fma_f32 v[18:19], v[132:133], v[98:99], v[18:19] op_sel:[0,0,0] op_sel_hi:[0,1,1]
    v_pk_fma_f32 v[20:21], v[134:135], v[100:101], v[20:21] op_sel:[0,0,0] op_sel_hi:[0,1,1]
    v_pk_fma_f32 v[22:23], v[134:135], v[102:103], v[22:23] op_sel:[0,0,0] op_sel_hi:[0,1,1]
    s_set_gpr_idx_off
    s_waitcnt vmcnt(6)
    v_mfma_f32_4x4x4_16b_bf16 v[96:99], v[140:141], v[64:65], 0 cbsz:4 abid:12
    v_readlane_b32 s55, v164, 55
    v_mfma_f32_4x4x4_16b_bf16 v[120:123], v[172:173], v[178:179], v[120:123] cbsz:4 abid:13
    v_exp_f32 v136, v116
    v_exp_f32 v137, v117
    s_and_b32 s33, s55, s34
    v_pk_add_f32 v[136:137], v[136:137], 1.0 op_sel_hi:[1,0]
    v_mfma_f32_4x4x4_16b_bf16 v[100:103], v[140:141], v[66:67], 0 cbsz:4 abid:12
    v_rcp_f32 v136, v136
    v_rcp_f32 v137, v137
    buffer_load_dwordx4 v[92:95], v1, s[12:15], s33 offen
    v_pk_mul_f32 v[130:131], v[136:137], v[116:117]
    s_set_gpr_idx_on s63, 0xc
    v_pk_fma_f32 v[16:17], v[132:133], v[104:105], v[16:17] op_sel:[1,0,0] op_sel_hi:[1,1,1]
    v_pk_fma_f32 v[18:19], v[132:133], v[106:107], v[18:19] op_sel:[1,0,0] op_sel_hi:[1,1,1]
    v_pk_fma_f32 v[20:21], v[134:135], v[108:109], v[20:21] op_sel:[1,0,0] op_sel_hi:[1,1,1]
    v_pk_fma_f32 v[22:23], v[134:135], v[110:111], v[22:23] op_sel:[1,0,0] op_sel_hi:[1,1,1]
    s_set_gpr_idx_off
A_48:
    s_sub_u32 s31, s31, 4
    s_cbranch_scc1 B_48
    s_waitcnt vmcnt(6)
    v_mfma_f32_4x4x4_16b_bf16 v[104:107], v[142:143], v[68:69], 0 cbsz:4 abid:12
    v_readlane_b32 s56, v164, 56
    v_mfma_f32_4x4x4_16b_bf16 v[124:127], v[172:173], v[180:181], 0 cbsz:4 abid:13
    v_exp_f32 v136, v114
    v_exp_f32 v137, v115
    s_and_b32 s33, s56, s34
    v_pk_add_f32 v[136:137], v[136:137], 1.0 op_sel_hi:[1,0]
    v_mfma_f32_4x4x4_16b_bf16 v[108:111], v[142:143], v[70:71], 0 cbsz:4 abid:12
    v_rcp_f32 v136, v136
    v_rcp_f32 v137, v137
    buffer_load_dwordx4 v[64:67], v1, s[12:15], s33 offen
    v_pk_mul_f32 v[132:133], v[136:137], v[114:115]
    s_set_gpr_idx_on s48, 0xc
    v_pk_fma_f32 v[16:17], v[128:129], v[96:97], v[16:17] op_sel:[0,0,0] op_sel_hi:[0,1,1]
    v_pk_fma_f32 v[18:19], v[128:129], v[98:99], v[18:19] op_sel:[0,0,0] op_sel_hi:[0,1,1]
    v_pk_fma_f32 v[20:21], v[130:131], v[100:101], v[20:21] op_sel:[0,0,0] op_sel_hi:[0,1,1]
    v_pk_fma_f32 v[22:23], v[130:131], v[102:103], v[22:23] op_sel:[0,0,0] op_sel_hi:[0,1,1]
    s_set_gpr_idx_off
    s_waitcnt vmcnt(6)
    v_mfma_f32_4x4x4_16b_bf16 v[96:99], v[144:145], v[72:73], 0 cbsz:4 abid:12
    v_readlane_b32 s57, v164, 57
    v_mfma_f32_4x4x4_16b_bf16 v[124:127], v[172:173], v[182:183], v[124:127] cbsz:4 abid:13
    v_exp_f32 v136, v118
    v_exp_f32 v137, v119
    s_and_b32 s33, s57, s34
    v_pk_add_f32 v[136:137], v[136:137], 1.0 op_sel_hi:[1,0]
    v_mfma_f32_4x4x4_16b_bf16 v[100:103], v[144:145], v[74:75], 0 cbsz:4 abid:12
    v_rcp_f32 v136, v136
    v_rcp_f32 v137, v137
    buffer_load_dwordx4 v[68:71], v1, s[12:15], s33 offen
    v_pk_mul_f32 v[134:135], v[136:137], v[118:119]
    s_set_gpr_idx_on s49, 0xc
    v_pk_fma_f32 v[16:17], v[128:129], v[104:105], v[16:17] op_sel:[1,0,0] op_sel_hi:[1,1,1]
    v_pk_fma_f32 v[18:19], v[128:129], v[106:107], v[18:19] op_sel:[1,0,0] op_sel_hi:[1,1,1]
    v_pk_fma_f32 v[20:21], v[130:131], v[108:109], v[20:21] op_sel:[1,0,0] op_sel_hi:[1,1,1]
    v_pk_fma_f32 v[22:23], v[130:131], v[110:111], v[22:23] op_sel:[1,0,0] op_sel_hi:[1,1,1]
    s_set_gpr_idx_off
    s_waitcnt vmcnt(6)
    v_mfma_f32_4x4x4_16b_bf16 v[104:107], v[146:147], v[76:77], 0 cbsz:4 abid:12
    v_readlane_b32 s58, v164, 58
    v_mfma_f32_4x4x4_16b_bf16 v[112:115], v[172:173], v[176:177], 0 cbsz:4 abid:14
    v_exp_f32 v136, v120
    v_exp_f32 v137, v121
    s_and_b32 s33, s58, s34
    v_pk_add_f32 v[136:137], v[136:137], 1.0 op_sel_hi:[1,0]
    v_mfma_f32_4x4x4_16b_bf16 v[108:111], v[146:147], v[78:79], 0 cbsz:4 abid:12
    v_rcp_f32 v136, v136
    v_rcp_f32 v137, v137
    buffer_load_dwordx4 v[72:75], v1, s[12:15], s33 offen
    v_pk_mul_f32 v[128:129], v[136:137], v[120:121]
    s_set_gpr_idx_on s50, 0xc
    v_pk_fma_f32 v[16:17], v[132:133], v[96:97], v[16:17] op_sel:[0,0,0] op_sel_hi:[0,1,1]
    v_pk_fma_f32 v[18:19], v[132:133], v[98:99], v[18:19] op_sel:[0,0,0] op_sel_hi:[0,1,1]
    v_pk_fma_f32 v[20:21], v[134:135], v[100:101], v[20:21] op_sel:[0,0,0] op_sel_hi:[0,1,1]
    v_pk_fma_f32 v[22:23], v[134:135], v[102:103], v[22:23] op_sel:[0,0,0] op_sel_hi:[0,1,1]
    s_set_gpr_idx_off
    s_waitcnt vmcnt(6)
    v_mfma_f32_4x4x4_16b_bf16 v[96:99], v[140:141], v[80:81], 0 cbsz:4 abid:13
    v_readlane_b32 s59, v164, 59
    v_mfma_f32_4x4x4_16b_bf16 v[112:115], v[172:173], v[178:179], v[112:115] cbsz:4 abid:14
    v_exp_f32 v136, v124
    v_exp_f32 v137, v125
    s_and_b32 s33, s59, s34
    v_pk_add_f32 v[136:137], v[136:137], 1.0 op_sel_hi:[1,0]
    v_mfma_f32_4x4x4_16b_bf16 v[100:103], v[140:141], v[82:83], 0 cbsz:4 abid:13
    v_rcp_f32 v136, v136
    v_rcp_f32 v137, v137
    buffer_load_dwordx4 v[76:79], v1, s[12:15], s33 offen
    v_pk_mul_f32 v[130:131], v[136:137], v[124:125]
    s_set_gpr_idx_on s51, 0xc
    v_pk_fma_f32 v[16:17], v[132:133], v[104:105], v[16:17] op_sel:[1,0,0] op_sel_hi:[1,1,1]
    v_pk_fma_f32 v[18:19], v[132:133], v[106:107], v[18:19] op_sel:[1,0,0] op_sel_hi:[1,1,1]
    v_pk_fma_f32 v[20:21], v[134:135], v[108:109], v[20:21] op_sel:[1,0,0] op_sel_hi:[1,1,1]
    v_pk_fma_f32 v[22:23], v[134:135], v[110:111], v[22:23] op_sel:[1,0,0] op_sel_hi:[1,1,1]
    s_set_gpr_idx_off
A_52:
    s_sub_u32 s31, s31, 4
    s_cbranch_scc1 B_52
    s_waitcnt vmcnt(6)
    v_mfma_f32_4x4x4_16b_bf16 v[104:107], v[142:143], v[84:85], 0 cbsz:4 abid:13
    v_readlane_b32 s60, v164, 60
    v_mfma_f32_4x4x4_16b_bf16 v[116:119], v[172:173], v[180:181], 0 cbsz:4 abid:14
    v_exp_f32 v136, v122
    v_exp_f32 v137, v123
    s_and_b32 s33, s60, s34
    v_pk_add_f32 v[136:137], v[136:137], 1.0 op_sel_hi:[1,0]
    v_mfma_f32_4x4x4_16b_bf16 v[108:111], v[142:143], v[86:87], 0 cbsz:4 abid:13
    v_rcp_f32 v136, v136
    v_rcp_f32 v137, v137
    buffer_load_dwordx4 v[80:83], v1, s[12:15], s33 offen
    v_pk_mul_f32 v[132:133], v[136:137], v[122:123]
    s_set_gpr_idx_on s52, 0xc
    v_pk_fma_f32 v[16:17], v[128:129], v[96:97], v[16:17] op_sel:[0,0,0] op_sel_hi:[0,1,1]
    v_pk_fma_f32 v[18:19], v[128:129], v[98:99], v[18:19] op_sel:[0,0,0] op_sel_hi:[0,1,1]
    v_pk_fma_f32 v[20:21], v[130:131], v[100:101], v[20:21] op_sel:[0,0,0] op_sel_hi:[0,1,1]
    v_pk_fma_f32 v[22:23], v[130:131], v[102:103], v[22:23] op_sel:[0,0,0] op_sel_hi:[0,1,1]
    s_set_gpr_idx_off
    s_waitcnt vmcnt(6)
    v_mfma_f32_4x4x4_16b_bf16 v[96:99], v[144:145], v[88:89], 0 cbsz:4 abid:13
    v_readlane_b32 s61, v164, 61
    v_mfma_f32_4x4x4_16b_bf16 v[116:119], v[172:173], v[182:183], v[116:119] cbsz:4 abid:14
    v_exp_f32 v136, v126
    v_exp_f32 v137, v127
    s_and_b32 s33, s61, s34
    v_pk_add_f32 v[136:137], v[136:137], 1.0 op_sel_hi:[1,0]
    v_mfma_f32_4x4x4_16b_bf16 v[100:103], v[144:145], v[90:91], 0 cbsz:4 abid:13
    v_rcp_f32 v136, v136
    v_rcp_f32 v137, v137
    buffer_load_dwordx4 v[84:87], v1, s[12:15], s33 offen
    v_pk_mul_f32 v[134:135], v[136:137], v[126:127]
    s_set_gpr_idx_on s53, 0xc
    v_pk_fma_f32 v[16:17], v[128:129], v[104:105], v[16:17] op_sel:[1,0,0] op_sel_hi:[1,1,1]
    v_pk_fma_f32 v[18:19], v[128:129], v[106:107], v[18:19] op_sel:[1,0,0] op_sel_hi:[1,1,1]
    v_pk_fma_f32 v[20:21], v[130:131], v[108:109], v[20:21] op_sel:[1,0,0] op_sel_hi:[1,1,1]
    v_pk_fma_f32 v[22:23], v[130:131], v[110:111], v[22:23] op_sel:[1,0,0] op_sel_hi:[1,1,1]
    s_set_gpr_idx_off
    s_waitcnt vmcnt(6)
    v_mfma_f32_4x4x4_16b_bf16 v[104:107], v[146:147], v[92:93], 0 cbsz:4 abid:13
    v_readlane_b32 s62, v164, 62
    v_mfma_f32_4x4x4_16b_bf16 v[120:123], v[172:173], v[176:177], 0 cbsz:4 abid:15
    v_exp_f32 v136, v112
    v_exp_f32 v137, v113
    s_and_b32 s33, s62, s34
    v_pk_add_f32 v[136:137], v[136:137], 1.0 op_sel_hi:[1,0]
    v_mfma_f32_4x4x4_16b_bf16 v[108:111], v[146:147], v[94:95], 0 cbsz:4 abid:13
    v_rcp_f32 v136, v136
    v_rcp_f32 v137, v137
    buffer_load_dwordx4 v[88:91], v1, s[12:15], s33 offen
    v_pk_mul_f32 v[128:129], v[136:137], v[112:113]
    s_set_gpr_idx_on s54, 0xc
    v_pk_fma_f32 v[16:17], v[132:133], v[96:97], v[16:17] op_sel:[0,0,0] op_sel_hi:[0,1,1]
    v_pk_fma_f32 v[18:19], v[132:133], v[98:99], v[18:19] op_sel:[0,0,0] op_sel_hi:[0,1,1]
    v_pk_fma_f32 v[20:21], v[134:135], v[100:101], v[20:21] op_sel:[0,0,0] op_sel_hi:[0,1,1]
    v_pk_fma_f32 v[22:23], v[134:135], v[102:103], v[22:23] op_sel:[0,0,0] op_sel_hi:[0,1,1]
    s_set_gpr_idx_off
    s_waitcnt vmcnt(6)
    v_mfma_f32_4x4x4_16b_bf16 v[96:99], v[140:141], v[64:65], 0 cbsz:4 abid:14
    v_readlane_b32 s63, v164, 63
    v_mfma_f32_4x4x4_16b_bf16 v[120:123], v[172:173], v[178:179], v[120:123] cbsz:4 abid:15
    v_exp_f32 v136, v116
    v_exp_f32 v137, v117
    s_and_b32 s33, s63, s34
    v_pk_add_f32 v[136:137], v[136:137], 1.0 op_sel_hi:[1,0]
    v_mfma_f32_4x4x4_16b_bf16 v[100:103], v[140:141], v[66:67], 0 cbsz:4 abid:14
    v_rcp_f32 v136, v136
    v_rcp_f32 v137, v137
    buffer_load_dwordx4 v[92:95], v1, s[12:15], s33 offen
    v_pk_mul_f32 v[130:131], v[136:137], v[116:117]
    s_set_gpr_idx_on s55, 0xc
    v_pk_fma_f32 v[16:17], v[132:133], v[104:105], v[16:17] op_sel:[1,0,0] op_sel_hi:[1,1,1]
    v_pk_fma_f32 v[18:19], v[132:133], v[106:107], v[18:19] op_sel:[1,0,0] op_sel_hi:[1,1,1]
    v_pk_fma_f32 v[20:21], v[134:135], v[108:109], v[20:21] op_sel:[1,0,0] op_sel_hi:[1,1,1]
    v_pk_fma_f32 v[22:23], v[134:135], v[110:111], v[22:23] op_sel:[1,0,0] op_sel_hi:[1,1,1]
    s_set_gpr_idx_off
A_56:
    s_sub_u32 s31, s31, 4
    s_cbranch_scc1 B_56
    s_waitcnt vmcnt(6)
    v_mfma_f32_4x4x4_16b_bf16 v[104:107], v[142:143], v[68:69], 0 cbsz:4 abid:14
    v_readlane_b32 s48, v166, 0
    v_mfma_f32_4x4x4_16b_bf16 v[124:127], v[172:173], v[180:181], 0 cbsz:4 abid:15
    v_exp_f32 v136, v114
    v_exp_f32 v137, v115
    s_and_b32 s33, s48, s34
    v_pk_add_f32 v[136:137], v[136:137], 1.0 op_sel_hi:[1,0]
    v_mfma_f32_4x4x4_16b_bf16 v[108:111], v[142:143], v[70:71], 0 cbsz:4 abid:14
    v_rcp_f32 v136, v136
    v_rcp_f32 v137, v137
    buffer_load_dwordx4 v[64:67], v1, s[12:15], s33 offen
    v_pk_mul_f32 v[132:133], v[136:137], v[114:115]
    s_set_gpr_idx_on s56, 0xc
    v_pk_fma_f32 v[16:17], v[128:129], v[96:97], v[16:17] op_sel:[0,0,0] op_sel_hi:[0,1,1]
    v_pk_fma_f32 v[18:19], v[128:129], v[98:99], v[18:19] op_sel:[0,0,0] op_sel_hi:[0,1,1]
    v_pk_fma_f32 v[20:21], v[130:131], v[100:101], v[20:21] op_sel:[0,0,0] op_sel_hi:[0,1,1]
    v_pk_fma_f32 v[22:23], v[130:131], v[102:103], v[22:23] op_sel:[0,0,0] op_sel_hi:[0,1,1]
    s_set_gpr_idx_off
    s_waitcnt vmcnt(6)
    v_mfma_f32_4x4x4_16b_bf16 v[96:99], v[144:145], v[72:73], 0 cbsz:4 abid:14
    v_readlane_b32 s49, v166, 1
    v_mfma_f32_4x4x4_16b_bf16 v[124:127], v[172:173], v[182:183], v[124:127] cbsz:4 abid:15
    v_exp_f32 v136, v118
    v_exp_f32 v137, v119
    s_and_b32 s33, s49, s34
    v_pk_add_f32 v[136:137], v[136:137], 1.0 op_sel_hi:[1,0]
    v_mfma_f32_4x4x4_16b_bf16 v[100:103], v[144:145], v[74:75], 0 cbsz:4 abid:14
    v_rcp_f32 v136, v136
    v_rcp_f32 v137, v137
    buffer_load_dwordx4 v[68:71], v1, s[12:15], s33 offen
    v_pk_mul_f32 v[134:135], v[136:137], v[118:119]
    s_set_gpr_idx_on s57, 0xc
    v_pk_fma_f32 v[16:17], v[128:129], v[104:105], v[16:17] op_sel:[1,0,0] op_sel_hi:[1,1,1]
    v_pk_fma_f32 v[18:19], v[128:129], v[106:107], v[18:19] op_sel:[1,0,0] op_sel_hi:[1,1,1]
    v_pk_fma_f32 v[20:21], v[130:131], v[108:109], v[20:21] op_sel:[1,0,0] op_sel_hi:[1,1,1]
    v_pk_fma_f32 v[22:23], v[130:131], v[110:111], v[22:23] op_sel:[1,0,0] op_sel_hi:[1,1,1]
    s_set_gpr_idx_off
    v_mov_b32 v172, v170
    v_mov_b32 v173, v171
    s_waitcnt vmcnt(6)
    v_mfma_f32_4x4x4_16b_bf16 v[104:107], v[146:147], v[76:77], 0 cbsz:4 abid:14
    v_readlane_b32 s50, v166, 2
    v_mfma_f32_4x4x4_16b_bf16 v[112:115], v[172:173], v[176:177], 0 cbsz:4 abid:0
    v_exp_f32 v136, v120
    v_exp_f32 v137, v121
    s_and_b32 s33, s50, s34
    v_pk_add_f32 v[136:137], v[136:137], 1.0 op_sel_hi:[1,0]
    v_mfma_f32_4x4x4_16b_bf16 v[108:111], v[146:147], v[78:79], 0 cbsz:4 abid:14
    v_rcp_f32 v136, v136
    v_rcp_f32 v137, v137
    buffer_load_dwordx4 v[72:75], v1, s[12:15], s33 offen
    v_pk_mul_f32 v[128:129], v[136:137], v[120:121]
    s_set_gpr_idx_on s58, 0xc
    v_pk_fma_f32 v[16:17], v[132:133], v[96:97], v[16:17] op_sel:[0,0,0] op_sel_hi:[0,1,1]
    v_pk_fma_f32 v[18:19], v[132:133], v[98:99], v[18:19] op_sel:[0,0,0] op_sel_hi:[0,1,1]
    v_pk_fma_f32 v[20:21], v[134:135], v[100:101], v[20:21] op_sel:[0,0,0] op_sel_hi:[0,1,1]
    v_pk_fma_f32 v[22:23], v[134:135], v[102:103], v[22:23] op_sel:[0,0,0] op_sel_hi:[0,1,1]
    s_set_gpr_idx_off
    s_waitcnt vmcnt(6)
    v_mfma_f32_4x4x4_16b_bf16 v[96:99], v[140:141], v[80:81], 0 cbsz:4 abid:15
    v_readlane_b32 s51, v166, 3
    v_mfma_f32_4x4x4_16b_bf16 v[112:115], v[172:173], v[178:179], v[112:115] cbsz:4 abid:0
    v_exp_f32 v136, v124
    v_exp_f32 v137, v125
    s_and_b32 s33, s51, s34
    v_pk_add_f32 v[136:137], v[136:137], 1.0 op_sel_hi:[1,0]
    v_mfma_f32_4x4x4_16b_bf16 v[100:103], v[140:141], v[82:83], 0 cbsz:4 abid:15
    v_rcp_f32 v136, v136
    v_rcp_f32 v137, v137
    buffer_load_dwordx4 v[76:79], v1, s[12:15], s33 offen
    v_pk_mul_f32 v[130:131], v[136:137], v[124:125]
    s_set_gpr_idx_on s59, 0xc
    v_pk_fma_f32 v[16:17], v[132:133], v[104:105], v[16:17] op_sel:[1,0,0] op_sel_hi:[1,1,1]
    v_pk_fma_f32 v[18:19], v[132:133], v[106:107], v[18:19] op_sel:[1,0,0] op_sel_hi:[1,1,1]
    v_pk_fma_f32 v[20:21], v[134:135], v[108:109], v[20:21] op_sel:[1,0,0] op_sel_hi:[1,1,1]
    v_pk_fma_f32 v[22:23], v[134:135], v[110:111], v[22:23] op_sel:[1,0,0] op_sel_hi:[1,1,1]
    s_set_gpr_idx_off
A_60:
    s_sub_u32 s31, s31, 4
    s_cbranch_scc1 B_60
    s_waitcnt vmcnt(6)
    v_mfma_f32_4x4x4_16b_bf16 v[104:107], v[142:143], v[84:85], 0 cbsz:4 abid:15
    v_readlane_b32 s52, v166, 4
    v_mfma_f32_4x4x4_16b_bf16 v[116:119], v[172:173], v[180:181], 0 cbsz:4 abid:0
    v_exp_f32 v136, v122
    v_exp_f32 v137, v123
    s_and_b32 s33, s52, s34
    v_pk_add_f32 v[136:137], v[136:137], 1.0 op_sel_hi:[1,0]
    v_mfma_f32_4x4x4_16b_bf16 v[108:111], v[142:143], v[86:87], 0 cbsz:4 abid:15
    v_rcp_f32 v136, v136
    v_rcp_f32 v137, v137
    buffer_load_dwordx4 v[80:83], v1, s[12:15], s33 offen
    v_pk_mul_f32 v[132:133], v[136:137], v[122:123]
    s_set_gpr_idx_on s60, 0xc
    v_pk_fma_f32 v[16:17], v[128:129], v[96:97], v[16:17] op_sel:[0,0,0] op_sel_hi:[0,1,1]
    v_pk_fma_f32 v[18:19], v[128:129], v[98:99], v[18:19] op_sel:[0,0,0] op_sel_hi:[0,1,1]
    v_pk_fma_f32 v[20:21], v[130:131], v[100:101], v[20:21] op_sel:[0,0,0] op_sel_hi:[0,1,1]
    v_pk_fma_f32 v[22:23], v[130:131], v[102:103], v[22:23] op_sel:[0,0,0] op_sel_hi:[0,1,1]
    s_set_gpr_idx_off
    v_cvt_pk_bf16_f32 v140, v148, v152
    v_cvt_pk_bf16_f32 v141, v156, v160
    s_waitcnt vmcnt(6)
    v_mfma_f32_4x4x4_16b_bf16 v[96:99], v[144:145], v[88:89], 0 cbsz:4 abid:15
    v_readlane_b32 s53, v166, 5
    v_mfma_f32_4x4x4_16b_bf16 v[116:119], v[172:173], v[182:183], v[116:119] cbsz:4 abid:0
    v_exp_f32 v136, v126
    v_exp_f32 v137, v127
    s_and_b32 s33, s53, s34
    v_pk_add_f32 v[136:137], v[136:137], 1.0 op_sel_hi:[1,0]
    v_mfma_f32_4x4x4_16b_bf16 v[100:103], v[144:145], v[90:91], 0 cbsz:4 abid:15
    v_rcp_f32 v136, v136
    v_rcp_f32 v137, v137
    buffer_load_dwordx4 v[84:87], v1, s[12:15], s33 offen
    v_pk_mul_f32 v[134:135], v[136:137], v[126:127]
    s_set_gpr_idx_on s61, 0xc
    v_pk_fma_f32 v[16:17], v[128:129], v[104:105], v[16:17] op_sel:[1,0,0] op_sel_hi:[1,1,1]
    v_pk_fma_f32 v[18:19], v[128:129], v[106:107], v[18:19] op_sel:[1,0,0] op_sel_hi:[1,1,1]
    v_pk_fma_f32 v[20:21], v[130:131], v[108:109], v[20:21] op_sel:[1,0,0] op_sel_hi:[1,1,1]
    v_pk_fma_f32 v[22:23], v[130:131], v[110:111], v[22:23] op_sel:[1,0,0] op_sel_hi:[1,1,1]
    s_set_gpr_idx_off
    v_cvt_pk_bf16_f32 v142, v149, v153
    v_cvt_pk_bf16_f32 v143, v157, v161
    s_waitcnt vmcnt(6)
    v_mfma_f32_4x4x4_16b_bf16 v[104:107], v[146:147], v[92:93], 0 cbsz:4 abid:15
    v_readlane_b32 s54, v166, 6
    v_mfma_f32_4x4x4_16b_bf16 v[120:123], v[172:173], v[176:177], 0 cbsz:4 abid:1
    v_exp_f32 v136, v112
    v_exp_f32 v137, v113
    s_and_b32 s33, s54, s34
    v_pk_add_f32 v[136:137], v[136:137], 1.0 op_sel_hi:[1,0]
    v_mfma_f32_4x4x4_16b_bf16 v[108:111], v[146:147], v[94:95], 0 cbsz:4 abid:15
    v_rcp_f32 v136, v136
    v_rcp_f32 v137, v137
    buffer_load_dwordx4 v[88:91], v1, s[12:15], s33 offen
    v_pk_mul_f32 v[128:129], v[136:137], v[112:113]
    s_set_gpr_idx_on s62, 0xc
    v_pk_fma_f32 v[16:17], v[132:133], v[96:97], v[16:17] op_sel:[0,0,0] op_sel_hi:[0,1,1]
    v_pk_fma_f32 v[18:19], v[132:133], v[98:99], v[18:19] op_sel:[0,0,0] op_sel_hi:[0,1,1]
    v_pk_fma_f32 v[20:21], v[134:135], v[100:101], v[20:21] op_sel:[0,0,0] op_sel_hi:[0,1,1]
    v_pk_fma_f32 v[22:23], v[134:135], v[102:103], v[22:23] op_sel:[0,0,0] op_sel_hi:[0,1,1]
    s_set_gpr_idx_off
    v_cvt_pk_bf16_f32 v144, v150, v154
    v_cvt_pk_bf16_f32 v145, v158, v162
    s_waitcnt vmcnt(6)
    v_mfma_f32_4x4x4_16b_bf16 v[96:99], v[140:141], v[64:65], 0 cbsz:4 abid:0
    v_readlane_b32 s55, v166, 7
    v_mfma_f32_4x4x4_16b_bf16 v[120:123], v[172:173], v[178:179], v[120:123] cbsz:4 abid:1
    v_exp_f32 v136, v116
    v_exp_f32 v137, v117
    s_and_b32 s33, s55, s34
    v_pk_add_f32 v[136:137], v[136:137], 1.0 op_sel_hi:[1,0]
    v_mfma_f32_4x4x4_16b_bf16 v[100:103], v[140:141], v[66:67], 0 cbsz:4 abid:0
    v_rcp_f32 v136, v136
    v_rcp_f32 v137, v137
    buffer_load_dwordx4 v[92:95], v1, s[12:15], s33 offen
    v_pk_mul_f32 v[130:131], v[136:137], v[116:117]
    s_set_gpr_idx_on s63, 0xc
    v_pk_fma_f32 v[16:17], v[132:133], v[104:105], v[16:17] op_sel:[1,0,0] op_sel_hi:[1,1,1]
    v_pk_fma_f32 v[18:19], v[132:133], v[106:107], v[18:19] op_sel:[1,0,0] op_sel_hi:[1,1,1]
    v_pk_fma_f32 v[20:21], v[134:135], v[108:109], v[20:21] op_sel:[1,0,0] op_sel_hi:[1,1,1]
    v_pk_fma_f32 v[22:23], v[134:135], v[110:111], v[22:23] op_sel:[1,0,0] op_sel_hi:[1,1,1]
    s_set_gpr_idx_off
    v_mov_b32 v164, v166
    v_cvt_pk_bf16_f32 v146, v151, v155
    v_cvt_pk_bf16_f32 v147, v159, v163
    s_branch A_0
B_0:
    s_sub_u32 s32, s32, 4
    s_cbranch_scc1 MAIN_DONE
    s_waitcnt vmcnt(2)
    v_mfma_f32_4x4x4_16b_bf16 v[104:107], v[142:143], v[68:69], 0 cbsz:4 abid:0
    v_mfma_f32_4x4x4_16b_bf16 v[124:127], v[172:173], v[180:181], 0 cbsz:4 abid:1
    v_exp_f32 v136, v114
    v_exp_f32 v137, v115
    s_nop 0
    v_pk_add_f32 v[136:137], v[136:137], 1.0 op_sel_hi:[1,0]
    v_mfma_f32_4x4x4_16b_bf16 v[108:111], v[142:143], v[70:71], 0 cbsz:4 abid:0
    v_rcp_f32 v136, v136
    v_rcp_f32 v137, v137
    s_nop 0
    v_pk_mul_f32 v[132:133], v[136:137], v[114:115]
    s_set_gpr_idx_on s48, 0xc
    v_pk_fma_f32 v[16:17], v[128:129], v[96:97], v[16:17] op_sel:[0,0,0] op_sel_hi:[0,1,1]
    v_pk_fma_f32 v[18:19], v[128:129], v[98:99], v[18:19] op_sel:[0,0,0] op_sel_hi:[0,1,1]
    v_pk_fma_f32 v[20:21], v[130:131], v[100:101], v[20:21] op_sel:[0,0,0] op_sel_hi:[0,1,1]
    v_pk_fma_f32 v[22:23], v[130:131], v[102:103], v[22:23] op_sel:[0,0,0] op_sel_hi:[0,1,1]
    s_set_gpr_idx_off
    s_waitcnt vmcnt(1)
    v_mfma_f32_4x4x4_16b_bf16 v[96:99], v[144:145], v[72:73], 0 cbsz:4 abid:0
    v_mfma_f32_4x4x4_16b_bf16 v[124:127], v[172:173], v[182:183], v[124:127] cbsz:4 abid:1
    v_exp_f32 v136, v118
    v_exp_f32 v137, v119
    s_nop 0
    v_pk_add_f32 v[136:137], v[136:137], 1.0 op_sel_hi:[1,0]
    v_mfma_f32_4x4x4_16b_bf16 v[100:103], v[144:145], v[74:75], 0 cbsz:4 abid:0
    v_rcp_f32 v136, v136
    v_rcp_f32 v137, v137
    s_nop 0
    v_pk_mul_f32 v[134:135], v[136:137], v[118:119]
    s_set_gpr_idx_on s49, 0xc
    v_pk_fma_f32 v[16:17], v[128:129], v[104:105], v[16:17] op_sel:[1,0,0] op_sel_hi:[1,1,1]
    v_pk_fma_f32 v[18:19], v[128:129], v[106:107], v[18:19] op_sel:[1,0,0] op_sel_hi:[1,1,1]
    v_pk_fma_f32 v[20:21], v[130:131], v[108:109], v[20:21] op_sel:[1,0,0] op_sel_hi:[1,1,1]
    v_pk_fma_f32 v[22:23], v[130:131], v[110:111], v[22:23] op_sel:[1,0,0] op_sel_hi:[1,1,1]
    s_set_gpr_idx_off
    s_waitcnt vmcnt(0)
    v_mfma_f32_4x4x4_16b_bf16 v[104:107], v[146:147], v[76:77], 0 cbsz:4 abid:0
    v_mfma_f32_4x4x4_16b_bf16 v[112:115], v[172:173], v[176:177], 0 cbsz:4 abid:2
    v_exp_f32 v136, v120
    v_exp_f32 v137, v121
    s_nop 0
    v_pk_add_f32 v[136:137], v[136:137], 1.0 op_sel_hi:[1,0]
    v_mfma_f32_4x4x4_16b_bf16 v[108:111], v[146:147], v[78:79], 0 cbsz:4 abid:0
    v_rcp_f32 v136, v136
    v_rcp_f32 v137, v137
    s_nop 0
    v_pk_mul_f32 v[128:129], v[136:137], v[120:121]
    s_set_gpr_idx_on s50, 0xc
    v_pk_fma_f32 v[16:17], v[132:133], v[96:97], v[16:17] op_sel:[0,0,0] op_sel_hi:[0,1,1]
    v_pk_fma_f32 v[18:19], v[132:133], v[98:99], v[18:19] op_sel:[0,0,0] op_sel_hi:[0,1,1]
    v_pk_fma_f32 v[20:21], v[134:135], v[100:101], v[20:21] op_sel:[0,0,0] op_sel_hi:[0,1,1]
    v_pk_fma_f32 v[22:23], v[134:135], v[102:103], v[22:23] op_sel:[0,0,0] op_sel_hi:[0,1,1]
    s_set_gpr_idx_off
    s_waitcnt vmcnt(0)
    v_mfma_f32_4x4x4_16b_bf16 v[96:99], v[140:141], v[80:81], 0 cbsz:4 abid:1
    v_mfma_f32_4x4x4_16b_bf16 v[112:115], v[172:173], v[178:179], v[112:115] cbsz:4 abid:2
    v_exp_f32 v136, v124
    v_exp_f32 v137, v125
    s_nop 0
    v_pk_add_f32 v[136:137], v[136:137], 1.0 op_sel_hi:[1,0]
    v_mfma_f32_4x4x4_16b_bf16 v[100:103], v[140:141], v[82:83], 0 cbsz:4 abid:1
    v_rcp_f32 v136, v136
    v_rcp_f32 v137, v137
    s_nop 0
    v_pk_mul_f32 v[130:131], v[136:137], v[124:125]
    s_set_gpr_idx_on s51, 0xc
    v_pk_fma_f32 v[16:17], v[132:133], v[104:105], v[16:17] op_sel:[1,0,0] op_sel_hi:[1,1,1]
    v_pk_fma_f32 v[18:19], v[132:133], v[106:107], v[18:19] op_sel:[1,0,0] op_sel_hi:[1,1,1]
    v_pk_fma_f32 v[20:21], v[134:135], v[108:109], v[20:21] op_sel:[1,0,0] op_sel_hi:[1,1,1]
    v_pk_fma_f32 v[22:23], v[134:135], v[110:111], v[22:23] op_sel:[1,0,0] op_sel_hi:[1,1,1]
    s_set_gpr_idx_off
B_4:
    s_sub_u32 s32, s32, 4
    s_cbranch_scc1 MAIN_DONE
    s_waitcnt vmcnt(2)
    v_mfma_f32_4x4x4_16b_bf16 v[104:107], v[142:143], v[84:85], 0 cbsz:4 abid:1
    v_mfma_f32_4x4x4_16b_bf16 v[116:119], v[172:173], v[180:181], 0 cbsz:4 abid:2
    v_exp_f32 v136, v122
    v_exp_f32 v137, v123
    s_nop 0
    v_pk_add_f32 v[136:137], v[136:137], 1.0 op_sel_hi:[1,0]
    v_mfma_f32_4x4x4_16b_bf16 v[108:111], v[142:143], v[86:87], 0 cbsz:4 abid:1
    v_rcp_f32 v136, v136
    v_rcp_f32 v137, v137
    s_nop 0
    v_pk_mul_f32 v[132:133], v[136:137], v[122:123]
    s_set_gpr_idx_on s52, 0xc
    v_pk_fma_f32 v[16:17], v[128:129], v[96:97], v[16:17] op_sel:[0,0,0] op_sel_hi:[0,1,1]
    v_pk_fma_f32 v[18:19], v[128:129], v[98:99], v[18:19] op_sel:[0,0,0] op_sel_hi:[0,1,1]
    v_pk_fma_f32 v[20:21], v[130:131], v[100:101], v[20:21] op_sel:[0,0,0] op_sel_hi:[0,1,1]
    v_pk_fma_f32 v[22:23], v[130:131], v[102:103], v[22:23] op_sel:[0,0,0] op_sel_hi:[0,1,1]
    s_set_gpr_idx_off
    s_waitcnt vmcnt(1)
    v_mfma_f32_4x4x4_16b_bf16 v[96:99], v[144:145], v[88:89], 0 cbsz:4 abid:1
    v_mfma_f32_4x4x4_16b_bf16 v[116:119], v[172:173], v[182:183], v[116:119] cbsz:4 abid:2
    v_exp_f32 v136, v126
    v_exp_f32 v137, v127
    s_nop 0
    v_pk_add_f32 v[136:137], v[136:137], 1.0 op_sel_hi:[1,0]
    v_mfma_f32_4x4x4_16b_bf16 v[100:103], v[144:145], v[90:91], 0 cbsz:4 abid:1
    v_rcp_f32 v136, v136
    v_rcp_f32 v137, v137
    s_nop 0
    v_pk_mul_f32 v[134:135], v[136:137], v[126:127]
    s_set_gpr_idx_on s53, 0xc
    v_pk_fma_f32 v[16:17], v[128:129], v[104:105], v[16:17] op_sel:[1,0,0] op_sel_hi:[1,1,1]
    v_pk_fma_f32 v[18:19], v[128:129], v[106:107], v[18:19] op_sel:[1,0,0] op_sel_hi:[1,1,1]
    v_pk_fma_f32 v[20:21], v[130:131], v[108:109], v[20:21] op_sel:[1,0,0] op_sel_hi:[1,1,1]
    v_pk_fma_f32 v[22:23], v[130:131], v[110:111], v[22:23] op_sel:[1,0,0] op_sel_hi:[1,1,1]
    s_set_gpr_idx_off
    s_waitcnt vmcnt(0)
    v_mfma_f32_4x4x4_16b_bf16 v[104:107], v[146:147], v[92:93], 0 cbsz:4 abid:1
    v_mfma_f32_4x4x4_16b_bf16 v[120:123], v[172:173], v[176:177], 0 cbsz:4 abid:3
    v_exp_f32 v136, v112
    v_exp_f32 v137, v113
    s_nop 0
    v_pk_add_f32 v[136:137], v[136:137], 1.0 op_sel_hi:[1,0]
    v_mfma_f32_4x4x4_16b_bf16 v[108:111], v[146:147], v[94:95], 0 cbsz:4 abid:1
    v_rcp_f32 v136, v136
    v_rcp_f32 v137, v137
    s_nop 0
    v_pk_mul_f32 v[128:129], v[136:137], v[112:113]
    s_set_gpr_idx_on s54, 0xc
    v_pk_fma_f32 v[16:17], v[132:133], v[96:97], v[16:17] op_sel:[0,0,0] op_sel_hi:[0,1,1]
    v_pk_fma_f32 v[18:19], v[132:133], v[98:99], v[18:19] op_sel:[0,0,0] op_sel_hi:[0,1,1]
    v_pk_fma_f32 v[20:21], v[134:135], v[100:101], v[20:21] op_sel:[0,0,0] op_sel_hi:[0,1,1]
    v_pk_fma_f32 v[22:23], v[134:135], v[102:103], v[22:23] op_sel:[0,0,0] op_sel_hi:[0,1,1]
    s_set_gpr_idx_off
    s_waitcnt vmcnt(0)
    v_mfma_f32_4x4x4_16b_bf16 v[96:99], v[140:141], v[64:65], 0 cbsz:4 abid:2
    v_mfma_f32_4x4x4_16b_bf16 v[120:123], v[172:173], v[178:179], v[120:123] cbsz:4 abid:3
    v_exp_f32 v136, v116
    v_exp_f32 v137, v117
    s_nop 0
    v_pk_add_f32 v[136:137], v[136:137], 1.0 op_sel_hi:[1,0]
    v_mfma_f32_4x4x4_16b_bf16 v[100:103], v[140:141], v[66:67], 0 cbsz:4 abid:2
    v_rcp_f32 v136, v136
    v_rcp_f32 v137, v137
    s_nop 0
    v_pk_mul_f32 v[130:131], v[136:137], v[116:117]
    s_set_gpr_idx_on s55, 0xc
    v_pk_fma_f32 v[16:17], v[132:133], v[104:105], v[16:17] op_sel:[1,0,0] op_sel_hi:[1,1,1]
    v_pk_fma_f32 v[18:19], v[132:133], v[106:107], v[18:19] op_sel:[1,0,0] op_sel_hi:[1,1,1]
    v_pk_fma_f32 v[20:21], v[134:135], v[108:109], v[20:21] op_sel:[1,0,0] op_sel_hi:[1,1,1]
    v_pk_fma_f32 v[22:23], v[134:135], v[110:111], v[22:23] op_sel:[1,0,0] op_sel_hi:[1,1,1]
    s_set_gpr_idx_off
B_8:
    s_sub_u32 s32, s32, 4
    s_cbranch_scc1 MAIN_DONE
    s_waitcnt vmcnt(2)
    v_mfma_f32_4x4x4_16b_bf16 v[104:107], v[142:143], v[68:69], 0 cbsz:4 abid:2
    v_mfma_f32_4x4x4_16b_bf16 v[124:127], v[172:173], v[180:181], 0 cbsz:4 abid:3
    v_exp_f32 v136, v114
    v_exp_f32 v137, v115
    s_nop 0
    v_pk_add_f32 v[136:137], v[136:137], 1.0 op_sel_hi:[1,0]
    v_mfma_f32_4x4x4_16b_bf16 v[108:111], v[142:143], v[70:71], 0 cbsz:4 abid:2
    v_rcp_f32 v136, v136
    v_rcp_f32 v137, v137
    s_nop 0
    v_pk_mul_f32 v[132:133], v[136:137], v[114:115]
    s_set_gpr_idx_on s56, 0xc
    v_pk_fma_f32 v[16:17], v[128:129], v[96:97], v[16:17] op_sel:[0,0,0] op_sel_hi:[0,1,1]
    v_pk_fma_f32 v[18:19], v[128:129], v[98:99], v[18:19] op_sel:[0,0,0] op_sel_hi:[0,1,1]
    v_pk_fma_f32 v[20:21], v[130:131], v[100:101], v[20:21] op_sel:[0,0,0] op_sel_hi:[0,1,1]
    v_pk_fma_f32 v[22:23], v[130:131], v[102:103], v[22:23] op_sel:[0,0,0] op_sel_hi:[0,1,1]
    s_set_gpr_idx_off
    ds_read_b64 v[166:167], v5
    s_waitcnt vmcnt(1)
    v_mfma_f32_4x4x4_16b_bf16 v[96:99], v[144:145], v[72:73], 0 cbsz:4 abid:2
    v_mfma_f32_4x4x4_16b_bf16 v[124:127], v[172:173], v[182:183], v[124:127] cbsz:4 abid:3
    v_exp_f32 v136, v118
    v_exp_f32 v137, v119
    s_nop 0
    v_pk_add_f32 v[136:137], v[136:137], 1.0 op_sel_hi:[1,0]
    v_mfma_f32_4x4x4_16b_bf16 v[100:103], v[144:145], v[74:75], 0 cbsz:4 abid:2
    v_rcp_f32 v136, v136
    v_rcp_f32 v137, v137
    s_nop 0
    v_pk_mul_f32 v[134:135], v[136:137], v[118:119]
    s_set_gpr_idx_on s57, 0xc
    v_pk_fma_f32 v[16:17], v[128:129], v[104:105], v[16:17] op_sel:[1,0,0] op_sel_hi:[1,1,1]
    v_pk_fma_f32 v[18:19], v[128:129], v[106:107], v[18:19] op_sel:[1,0,0] op_sel_hi:[1,1,1]
    v_pk_fma_f32 v[20:21], v[130:131], v[108:109], v[20:21] op_sel:[1,0,0] op_sel_hi:[1,1,1]
    v_pk_fma_f32 v[22:23], v[130:131], v[110:111], v[22:23] op_sel:[1,0,0] op_sel_hi:[1,1,1]
    s_set_gpr_idx_off
    s_waitcnt vmcnt(0)
    v_mfma_f32_4x4x4_16b_bf16 v[104:107], v[146:147], v[76:77], 0 cbsz:4 abid:2
    v_mfma_f32_4x4x4_16b_bf16 v[112:115], v[172:173], v[176:177], 0 cbsz:4 abid:4
    v_exp_f32 v136, v120
    v_exp_f32 v137, v121
    s_nop 0
    v_pk_add_f32 v[136:137], v[136:137], 1.0 op_sel_hi:[1,0]
    v_mfma_f32_4x4x4_16b_bf16 v[108:111], v[146:147], v[78:79], 0 cbsz:4 abid:2
    v_rcp_f32 v136, v136
    v_rcp_f32 v137, v137
    s_nop 0
    v_pk_mul_f32 v[128:129], v[136:137], v[120:121]
    s_set_gpr_idx_on s58, 0xc
    v_pk_fma_f32 v[16:17], v[132:133], v[96:97], v[16:17] op_sel:[0,0,0] op_sel_hi:[0,1,1]
    v_pk_fma_f32 v[18:19], v[132:133], v[98:99], v[18:19] op_sel:[0,0,0] op_sel_hi:[0,1,1]
    v_pk_fma_f32 v[20:21], v[134:135], v[100:101], v[20:21] op_sel:[0,0,0] op_sel_hi:[0,1,1]
    v_pk_fma_f32 v[22:23], v[134:135], v[102:103], v[22:23] op_sel:[0,0,0] op_sel_hi:[0,1,1]
    s_set_gpr_idx_off
    s_waitcnt vmcnt(0)
    v_mfma_f32_4x4x4_16b_bf16 v[96:99], v[140:141], v[80:81], 0 cbsz:4 abid:3
    v_mfma_f32_4x4x4_16b_bf16 v[112:115], v[172:173], v[178:179], v[112:115] cbsz:4 abid:4
    v_exp_f32 v136, v124
    v_exp_f32 v137, v125
    s_nop 0
    v_pk_add_f32 v[136:137], v[136:137], 1.0 op_sel_hi:[1,0]
    v_mfma_f32_4x4x4_16b_bf16 v[100:103], v[140:141], v[82:83], 0 cbsz:4 abid:3
    v_rcp_f32 v136, v136
    v_rcp_f32 v137, v137
    s_nop 0
    v_pk_mul_f32 v[130:131], v[136:137], v[124:125]
    s_set_gpr_idx_on s59, 0xc
    v_pk_fma_f32 v[16:17], v[132:133], v[104:105], v[16:17] op_sel:[1,0,0] op_sel_hi:[1,1,1]
    v_pk_fma_f32 v[18:19], v[132:133], v[106:107], v[18:19] op_sel:[1,0,0] op_sel_hi:[1,1,1]
    v_pk_fma_f32 v[20:21], v[134:135], v[108:109], v[20:21] op_sel:[1,0,0] op_sel_hi:[1,1,1]
    v_pk_fma_f32 v[22:23], v[134:135], v[110:111], v[22:23] op_sel:[1,0,0] op_sel_hi:[1,1,1]
    s_set_gpr_idx_off
B_12:
    s_sub_u32 s32, s32, 4
    s_cbranch_scc1 MAIN_DONE
    s_waitcnt vmcnt(2)
    v_mfma_f32_4x4x4_16b_bf16 v[104:107], v[142:143], v[84:85], 0 cbsz:4 abid:3
    v_mfma_f32_4x4x4_16b_bf16 v[116:119], v[172:173], v[180:181], 0 cbsz:4 abid:4
    v_exp_f32 v136, v122
    v_exp_f32 v137, v123
    s_nop 0
    v_pk_add_f32 v[136:137], v[136:137], 1.0 op_sel_hi:[1,0]
    v_mfma_f32_4x4x4_16b_bf16 v[108:111], v[142:143], v[86:87], 0 cbsz:4 abid:3
    v_rcp_f32 v136, v136
    v_rcp_f32 v137, v137
    s_nop 0
    v_pk_mul_f32 v[132:133], v[136:137], v[122:123]
    s_set_gpr_idx_on s60, 0xc
    v_pk_fma_f32 v[16:17], v[128:129], v[96:97], v[16:17] op_sel:[0,0,0] op_sel_hi:[0,1,1]
    v_pk_fma_f32 v[18:19], v[128:129], v[98:99], v[18:19] op_sel:[0,0,0] op_sel_hi:[0,1,1]
    v_pk_fma_f32 v[20:21], v[130:131], v[100:101], v[20:21] op_sel:[0,0,0] op_sel_hi:[0,1,1]
    v_pk_fma_f32 v[22:23], v[130:131], v[102:103], v[22:23] op_sel:[0,0,0] op_sel_hi:[0,1,1]
    s_set_gpr_idx_off
    s_waitcnt lgkmcnt(0)
    v_cmp_gt_u32 vcc, s30, v6
    v_add_u32 v6, 64, v6
    v_add_u32 v5, 512, v5
    v_mov_b32 v8, 39808
    v_cndmask_b32 v166, 40, v166, vcc
    v_cndmask_b32 v167, v8, v167, vcc
    ds_read_b128 v[168:171], v167
    s_waitcnt vmcnt(1)
    v_mfma_f32_4x4x4_16b_bf16 v[96:99], v[144:145], v[88:89], 0 cbsz:4 abid:3
    v_mfma_f32_4x4x4_16b_bf16 v[116:119], v[172:173], v[182:183], v[116:119] cbsz:4 abid:4
    v_exp_f32 v136, v126
    v_exp_f32 v137, v127
    s_nop 0
    v_pk_add_f32 v[136:137], v[136:137], 1.0 op_sel_hi:[1,0]
    v_mfma_f32_4x4x4_16b_bf16 v[100:103], v[144:145], v[90:91], 0 cbsz:4 abid:3
    v_rcp_f32 v136, v136
    v_rcp_f32 v137, v137
    s_nop 0
    v_pk_mul_f32 v[134:135], v[136:137], v[126:127]
    s_set_gpr_idx_on s61, 0xc
    v_pk_fma_f32 v[16:17], v[128:129], v[104:105], v[16:17] op_sel:[1,0,0] op_sel_hi:[1,1,1]
    v_pk_fma_f32 v[18:19], v[128:129], v[106:107], v[18:19] op_sel:[1,0,0] op_sel_hi:[1,1,1]
    v_pk_fma_f32 v[20:21], v[130:131], v[108:109], v[20:21] op_sel:[1,0,0] op_sel_hi:[1,1,1]
    v_pk_fma_f32 v[22:23], v[130:131], v[110:111], v[22:23] op_sel:[1,0,0] op_sel_hi:[1,1,1]
    s_set_gpr_idx_off
    s_waitcnt vmcnt(0)
    v_mfma_f32_4x4x4_16b_bf16 v[104:107], v[146:147], v[92:93], 0 cbsz:4 abid:3
    v_mfma_f32_4x4x4_16b_bf16 v[120:123], v[172:173], v[176:177], 0 cbsz:4 abid:5
    v_exp_f32 v136, v112
    v_exp_f32 v137, v113
    s_nop 0
    v_pk_add_f32 v[136:137], v[136:137], 1.0 op_sel_hi:[1,0]
    v_mfma_f32_4x4x4_16b_bf16 v[108:111], v[146:147], v[94:95], 0 cbsz:4 abid:3
    v_rcp_f32 v136, v136
    v_rcp_f32 v137, v137
    s_nop 0
    v_pk_mul_f32 v[128:129], v[136:137], v[112:113]
    s_set_gpr_idx_on s62, 0xc
    v_pk_fma_f32 v[16:17], v[132:133], v[96:97], v[16:17] op_sel:[0,0,0] op_sel_hi:[0,1,1]
    v_pk_fma_f32 v[18:19], v[132:133], v[98:99], v[18:19] op_sel:[0,0,0] op_sel_hi:[0,1,1]
    v_pk_fma_f32 v[20:21], v[134:135], v[100:101], v[20:21] op_sel:[0,0,0] op_sel_hi:[0,1,1]
    v_pk_fma_f32 v[22:23], v[134:135], v[102:103], v[22:23] op_sel:[0,0,0] op_sel_hi:[0,1,1]
    s_set_gpr_idx_off
    s_waitcnt vmcnt(0)
    v_mfma_f32_4x4x4_16b_bf16 v[96:99], v[140:141], v[64:65], 0 cbsz:4 abid:4
    v_mfma_f32_4x4x4_16b_bf16 v[120:123], v[172:173], v[178:179], v[120:123] cbsz:4 abid:5
    v_exp_f32 v136, v116
    v_exp_f32 v137, v117
    s_nop 0
    v_pk_add_f32 v[136:137], v[136:137], 1.0 op_sel_hi:[1,0]
    v_mfma_f32_4x4x4_16b_bf16 v[100:103], v[140:141], v[66:67], 0 cbsz:4 abid:4
    v_rcp_f32 v136, v136
    v_rcp_f32 v137, v137
    s_nop 0
    v_pk_mul_f32 v[130:131], v[136:137], v[116:117]
    s_set_gpr_idx_on s63, 0xc
    v_pk_fma_f32 v[16:17], v[132:133], v[104:105], v[16:17] op_sel:[1,0,0] op_sel_hi:[1,1,1]
    v_pk_fma_f32 v[18:19], v[132:133], v[106:107], v[18:19] op_sel:[1,0,0] op_sel_hi:[1,1,1]
    v_pk_fma_f32 v[20:21], v[134:135], v[108:109], v[20:21] op_sel:[1,0,0] op_sel_hi:[1,1,1]
    v_pk_fma_f32 v[22:23], v[134:135], v[110:111], v[22:23] op_sel:[1,0,0] op_sel_hi:[1,1,1]
    s_set_gpr_idx_off
B_16:
    s_sub_u32 s32, s32, 4
    s_cbranch_scc1 MAIN_DONE
    s_waitcnt vmcnt(2)
    v_mfma_f32_4x4x4_16b_bf16 v[104:107], v[142:143], v[68:69], 0 cbsz:4 abid:4
    v_mfma_f32_4x4x4_16b_bf16 v[124:127], v[172:173], v[180:181], 0 cbsz:4 abid:5
    v_exp_f32 v136, v114
    v_exp_f32 v137, v115
    s_nop 0
    v_pk_add_f32 v[136:137], v[136:137], 1.0 op_sel_hi:[1,0]
    v_mfma_f32_4x4x4_16b_bf16 v[108:111], v[142:143], v[70:71], 0 cbsz:4 abid:4
    v_rcp_f32 v136, v136
    v_rcp_f32 v137, v137
    s_nop 0
    v_pk_mul_f32 v[132:133], v[136:137], v[114:115]
    s_set_gpr_idx_on s48, 0xc
    v_pk_fma_f32 v[16:17], v[128:129], v[96:97], v[16:17] op_sel:[0,0,0] op_sel_hi:[0,1,1]
    v_pk_fma_f32 v[18:19], v[128:129], v[98:99], v[18:19] op_sel:[0,0,0] op_sel_hi:[0,1,1]
    v_pk_fma_f32 v[20:21], v[130:131], v[100:101], v[20:21] op_sel:[0,0,0] op_sel_hi:[0,1,1]
    v_pk_fma_f32 v[22:23], v[130:131], v[102:103], v[22:23] op_sel:[0,0,0] op_sel_hi:[0,1,1]
    s_set_gpr_idx_off
    s_waitcnt vmcnt(1)
    v_mfma_f32_4x4x4_16b_bf16 v[96:99], v[144:145], v[72:73], 0 cbsz:4 abid:4
    v_mfma_f32_4x4x4_16b_bf16 v[124:127], v[172:173], v[182:183], v[124:127] cbsz:4 abid:5
    v_exp_f32 v136, v118
    v_exp_f32 v137, v119
    s_nop 0
    v_pk_add_f32 v[136:137], v[136:137], 1.0 op_sel_hi:[1,0]
    v_mfma_f32_4x4x4_16b_bf16 v[100:103], v[144:145], v[74:75], 0 cbsz:4 abid:4
    v_rcp_f32 v136, v136
    v_rcp_f32 v137, v137
    s_nop 0
    v_pk_mul_f32 v[134:135], v[136:137], v[118:119]
    s_set_gpr_idx_on s49, 0xc
    v_pk_fma_f32 v[16:17], v[128:129], v[104:105], v[16:17] op_sel:[1,0,0] op_sel_hi:[1,1,1]
    v_pk_fma_f32 v[18:19], v[128:129], v[106:107], v[18:19] op_sel:[1,0,0] op_sel_hi:[1,1,1]
    v_pk_fma_f32 v[20:21], v[130:131], v[108:109], v[20:21] op_sel:[1,0,0] op_sel_hi:[1,1,1]
    v_pk_fma_f32 v[22:23], v[130:131], v[110:111], v[22:23] op_sel:[1,0,0] op_sel_hi:[1,1,1]
    s_set_gpr_idx_off
    s_waitcnt vmcnt(0)
    v_mfma_f32_4x4x4_16b_bf16 v[104:107], v[146:147], v[76:77], 0 cbsz:4 abid:4
    v_mfma_f32_4x4x4_16b_bf16 v[112:115], v[172:173], v[176:177], 0 cbsz:4 abid:6
    v_exp_f32 v136, v120
    v_exp_f32 v137, v121
    s_nop 0
    v_pk_add_f32 v[136:137], v[136:137], 1.0 op_sel_hi:[1,0]
    v_mfma_f32_4x4x4_16b_bf16 v[108:111], v[146:147], v[78:79], 0 cbsz:4 abid:4
    v_rcp_f32 v136, v136
    v_rcp_f32 v137, v137
    s_nop 0
    v_pk_mul_f32 v[128:129], v[136:137], v[120:121]
    s_set_gpr_idx_on s50, 0xc
    v_pk_fma_f32 v[16:17], v[132:133], v[96:97], v[16:17] op_sel:[0,0,0] op_sel_hi:[0,1,1]
    v_pk_fma_f32 v[18:19], v[132:133], v[98:99], v[18:19] op_sel:[0,0,0] op_sel_hi:[0,1,1]
    v_pk_fma_f32 v[20:21], v[134:135], v[100:101], v[20:21] op_sel:[0,0,0] op_sel_hi:[0,1,1]
    v_pk_fma_f32 v[22:23], v[134:135], v[102:103], v[22:23] op_sel:[0,0,0] op_sel_hi:[0,1,1]
    s_set_gpr_idx_off
    s_waitcnt vmcnt(0)
    v_mfma_f32_4x4x4_16b_bf16 v[96:99], v[140:141], v[80:81], 0 cbsz:4 abid:5
    v_mfma_f32_4x4x4_16b_bf16 v[112:115], v[172:173], v[178:179], v[112:115] cbsz:4 abid:6
    v_exp_f32 v136, v124
    v_exp_f32 v137, v125
    s_nop 0
    v_pk_add_f32 v[136:137], v[136:137], 1.0 op_sel_hi:[1,0]
    v_mfma_f32_4x4x4_16b_bf16 v[100:103], v[140:141], v[82:83], 0 cbsz:4 abid:5
    v_rcp_f32 v136, v136
    v_rcp_f32 v137, v137
    s_nop 0
    v_pk_mul_f32 v[130:131], v[136:137], v[124:125]
    s_set_gpr_idx_on s51, 0xc
    v_pk_fma_f32 v[16:17], v[132:133], v[104:105], v[16:17] op_sel:[1,0,0] op_sel_hi:[1,1,1]
    v_pk_fma_f32 v[18:19], v[132:133], v[106:107], v[18:19] op_sel:[1,0,0] op_sel_hi:[1,1,1]
    v_pk_fma_f32 v[20:21], v[134:135], v[108:109], v[20:21] op_sel:[1,0,0] op_sel_hi:[1,1,1]
    v_pk_fma_f32 v[22:23], v[134:135], v[110:111], v[22:23] op_sel:[1,0,0] op_sel_hi:[1,1,1]
    s_set_gpr_idx_off
B_20:
    s_sub_u32 s32, s32, 4
    s_cbranch_scc1 MAIN_DONE
    s_waitcnt vmcnt(2)
    v_mfma_f32_4x4x4_16b_bf16 v[104:107], v[142:143], v[84:85], 0 cbsz:4 abid:5
    v_mfma_f32_4x4x4_16b_bf16 v[116:119], v[172:173], v[180:181], 0 cbsz:4 abid:6
    v_exp_f32 v136, v122
    v_exp_f32 v137, v123
    s_nop 0
    v_pk_add_f32 v[136:137], v[136:137], 1.0 op_sel_hi:[1,0]
    v_mfma_f32_4x4x4_16b_bf16 v[108:111], v[142:143], v[86:87], 0 cbsz:4 abid:5
    v_rcp_f32 v136, v136
    v_rcp_f32 v137, v137
    s_nop 0
    v_pk_mul_f32 v[132:133], v[136:137], v[122:123]
    s_set_gpr_idx_on s52, 0xc
    v_pk_fma_f32 v[16:17], v[128:129], v[96:97], v[16:17] op_sel:[0,0,0] op_sel_hi:[0,1,1]
    v_pk_fma_f32 v[18:19], v[128:129], v[98:99], v[18:19] op_sel:[0,0,0] op_sel_hi:[0,1,1]
    v_pk_fma_f32 v[20:21], v[130:131], v[100:101], v[20:21] op_sel:[0,0,0] op_sel_hi:[0,1,1]
    v_pk_fma_f32 v[22:23], v[130:131], v[102:103], v[22:23] op_sel:[0,0,0] op_sel_hi:[0,1,1]
    s_set_gpr_idx_off
    s_waitcnt lgkmcnt(0)
    s_waitcnt vmcnt(1)
    v_mfma_f32_4x4x4_16b_bf16 v[96:99], v[144:145], v[88:89], 0 cbsz:4 abid:5
    v_mfma_f32_4x4x4_16b_bf16 v[116:119], v[172:173], v[182:183], v[116:119] cbsz:4 abid:6
    v_exp_f32 v136, v126
    v_exp_f32 v137, v127
    s_nop 0
    v_pk_add_f32 v[136:137], v[136:137], 1.0 op_sel_hi:[1,0]
    v_mfma_f32_4x4x4_16b_bf16 v[100:103], v[144:145], v[90:91], 0 cbsz:4 abid:5
    v_rcp_f32 v136, v136
    v_rcp_f32 v137, v137
    s_nop 0
    v_pk_mul_f32 v[134:135], v[136:137], v[126:127]
    s_set_gpr_idx_on s53, 0xc
    v_pk_fma_f32 v[16:17], v[128:129], v[104:105], v[16:17] op_sel:[1,0,0] op_sel_hi:[1,1,1]
    v_pk_fma_f32 v[18:19], v[128:129], v[106:107], v[18:19] op_sel:[1,0,0] op_sel_hi:[1,1,1]
    v_pk_fma_f32 v[20:21], v[130:131], v[108:109], v[20:21] op_sel:[1,0,0] op_sel_hi:[1,1,1]
    v_pk_fma_f32 v[22:23], v[130:131], v[110:111], v[22:23] op_sel:[1,0,0] op_sel_hi:[1,1,1]
    s_set_gpr_idx_off
    s_waitcnt vmcnt(0)
    v_mfma_f32_4x4x4_16b_bf16 v[104:107], v[146:147], v[92:93], 0 cbsz:4 abid:5
    v_mfma_f32_4x4x4_16b_bf16 v[120:123], v[172:173], v[176:177], 0 cbsz:4 abid:7
    v_exp_f32 v136, v112
    v_exp_f32 v137, v113
    s_nop 0
    v_pk_add_f32 v[136:137], v[136:137], 1.0 op_sel_hi:[1,0]
    v_mfma_f32_4x4x4_16b_bf16 v[108:111], v[146:147], v[94:95], 0 cbsz:4 abid:5
    v_rcp_f32 v136, v136
    v_rcp_f32 v137, v137
    s_nop 0
    v_pk_mul_f32 v[128:129], v[136:137], v[112:113]
    s_set_gpr_idx_on s54, 0xc
    v_pk_fma_f32 v[16:17], v[132:133], v[96:97], v[16:17] op_sel:[0,0,0] op_sel_hi:[0,1,1]
    v_pk_fma_f32 v[18:19], v[132:133], v[98:99], v[18:19] op_sel:[0,0,0] op_sel_hi:[0,1,1]
    v_pk_fma_f32 v[20:21], v[134:135], v[100:101], v[20:21] op_sel:[0,0,0] op_sel_hi:[0,1,1]
    v_pk_fma_f32 v[22:23], v[134:135], v[102:103], v[22:23] op_sel:[0,0,0] op_sel_hi:[0,1,1]
    s_set_gpr_idx_off
    s_waitcnt vmcnt(0)
    v_mfma_f32_4x4x4_16b_bf16 v[96:99], v[140:141], v[64:65], 0 cbsz:4 abid:6
    v_mfma_f32_4x4x4_16b_bf16 v[120:123], v[172:173], v[178:179], v[120:123] cbsz:4 abid:7
    v_exp_f32 v136, v116
    v_exp_f32 v137, v117
    s_nop 0
    v_pk_add_f32 v[136:137], v[136:137], 1.0 op_sel_hi:[1,0]
    v_mfma_f32_4x4x4_16b_bf16 v[100:103], v[140:141], v[66:67], 0 cbsz:4 abid:6
    v_rcp_f32 v136, v136
    v_rcp_f32 v137, v137
    s_nop 0
    v_pk_mul_f32 v[130:131], v[136:137], v[116:117]
    s_set_gpr_idx_on s55, 0xc
    v_pk_fma_f32 v[16:17], v[132:133], v[104:105], v[16:17] op_sel:[1,0,0] op_sel_hi:[1,1,1]
    v_pk_fma_f32 v[18:19], v[132:133], v[106:107], v[18:19] op_sel:[1,0,0] op_sel_hi:[1,1,1]
    v_pk_fma_f32 v[20:21], v[134:135], v[108:109], v[20:21] op_sel:[1,0,0] op_sel_hi:[1,1,1]
    v_pk_fma_f32 v[22:23], v[134:135], v[110:111], v[22:23] op_sel:[1,0,0] op_sel_hi:[1,1,1]
    s_set_gpr_idx_off
B_24:
    s_sub_u32 s32, s32, 4
    s_cbranch_scc1 MAIN_DONE
    s_waitcnt vmcnt(2)
    v_mfma_f32_4x4x4_16b_bf16 v[104:107], v[142:143], v[68:69], 0 cbsz:4 abid:6
    v_mfma_f32_4x4x4_16b_bf16 v[124:127], v[172:173], v[180:181], 0 cbsz:4 abid:7
    v_exp_f32 v136, v114
    v_exp_f32 v137, v115
    s_nop 0
    v_pk_add_f32 v[136:137], v[136:137], 1.0 op_sel_hi:[1,0]
    v_mfma_f32_4x4x4_16b_bf16 v[108:111], v[142:143], v[70:71], 0 cbsz:4 abid:6
    v_rcp_f32 v136, v136
    v_rcp_f32 v137, v137
    s_nop 0
    v_pk_mul_f32 v[132:133], v[136:137], v[114:115]
    s_set_gpr_idx_on s56, 0xc
    v_pk_fma_f32 v[16:17], v[128:129], v[96:97], v[16:17] op_sel:[0,0,0] op_sel_hi:[0,1,1]
    v_pk_fma_f32 v[18:19], v[128:129], v[98:99], v[18:19] op_sel:[0,0,0] op_sel_hi:[0,1,1]
    v_pk_fma_f32 v[20:21], v[130:131], v[100:101], v[20:21] op_sel:[0,0,0] op_sel_hi:[0,1,1]
    v_pk_fma_f32 v[22:23], v[130:131], v[102:103], v[22:23] op_sel:[0,0,0] op_sel_hi:[0,1,1]
    s_set_gpr_idx_off
    s_waitcnt vmcnt(1)
    v_mfma_f32_4x4x4_16b_bf16 v[96:99], v[144:145], v[72:73], 0 cbsz:4 abid:6
    v_mfma_f32_4x4x4_16b_bf16 v[124:127], v[172:173], v[182:183], v[124:127] cbsz:4 abid:7
    v_exp_f32 v136, v118
    v_exp_f32 v137, v119
    s_nop 0
    v_pk_add_f32 v[136:137], v[136:137], 1.0 op_sel_hi:[1,0]
    v_mfma_f32_4x4x4_16b_bf16 v[100:103], v[144:145], v[74:75], 0 cbsz:4 abid:6
    v_rcp_f32 v136, v136
    v_rcp_f32 v137, v137
    s_nop 0
    v_pk_mul_f32 v[134:135], v[136:137], v[118:119]
    s_set_gpr_idx_on s57, 0xc
    v_pk_fma_f32 v[16:17], v[128:129], v[104:105], v[16:17] op_sel:[1,0,0] op_sel_hi:[1,1,1]
    v_pk_fma_f32 v[18:19], v[128:129], v[106:107], v[18:19] op_sel:[1,0,0] op_sel_hi:[1,1,1]
    v_pk_fma_f32 v[20:21], v[130:131], v[108:109], v[20:21] op_sel:[1,0,0] op_sel_hi:[1,1,1]
    v_pk_fma_f32 v[22:23], v[130:131], v[110:111], v[22:23] op_sel:[1,0,0] op_sel_hi:[1,1,1]
    s_set_gpr_idx_off
    s_waitcnt vmcnt(0)
    v_mfma_f32_4x4x4_16b_bf16 v[104:107], v[146:147], v[76:77], 0 cbsz:4 abid:6
    v_mfma_f32_4x4x4_16b_bf16 v[112:115], v[172:173], v[176:177], 0 cbsz:4 abid:8
    v_exp_f32 v136, v120
    v_exp_f32 v137, v121
    s_nop 0
    v_pk_add_f32 v[136:137], v[136:137], 1.0 op_sel_hi:[1,0]
    v_mfma_f32_4x4x4_16b_bf16 v[108:111], v[146:147], v[78:79], 0 cbsz:4 abid:6
    v_rcp_f32 v136, v136
    v_rcp_f32 v137, v137
    s_nop 0
    v_pk_mul_f32 v[128:129], v[136:137], v[120:121]
    s_set_gpr_idx_on s58, 0xc
    v_pk_fma_f32 v[16:17], v[132:133], v[96:97], v[16:17] op_sel:[0,0,0] op_sel_hi:[0,1,1]
    v_pk_fma_f32 v[18:19], v[132:133], v[98:99], v[18:19] op_sel:[0,0,0] op_sel_hi:[0,1,1]
    v_pk_fma_f32 v[20:21], v[134:135], v[100:101], v[20:21] op_sel:[0,0,0] op_sel_hi:[0,1,1]
    v_pk_fma_f32 v[22:23], v[134:135], v[102:103], v[22:23] op_sel:[0,0,0] op_sel_hi:[0,1,1]
    s_set_gpr_idx_off
    s_waitcnt vmcnt(0)
    v_mfma_f32_4x4x4_16b_bf16 v[96:99], v[140:141], v[80:81], 0 cbsz:4 abid:7
    v_mfma_f32_4x4x4_16b_bf16 v[112:115], v[172:173], v[178:179], v[112:115] cbsz:4 abid:8
    v_exp_f32 v136, v124
    v_exp_f32 v137, v125
    s_nop 0
    v_pk_add_f32 v[136:137], v[136:137], 1.0 op_sel_hi:[1,0]
    v_mfma_f32_4x4x4_16b_bf16 v[100:103], v[140:141], v[82:83], 0 cbsz:4 abid:7
    v_rcp_f32 v136, v136
    v_rcp_f32 v137, v137
    s_nop 0
    v_pk_mul_f32 v[130:131], v[136:137], v[124:125]
    s_set_gpr_idx_on s59, 0xc
    v_pk_fma_f32 v[16:17], v[132:133], v[104:105], v[16:17] op_sel:[1,0,0] op_sel_hi:[1,1,1]
    v_pk_fma_f32 v[18:19], v[132:133], v[106:107], v[18:19] op_sel:[1,0,0] op_sel_hi:[1,1,1]
    v_pk_fma_f32 v[20:21], v[134:135], v[108:109], v[20:21] op_sel:[1,0,0] op_sel_hi:[1,1,1]
    v_pk_fma_f32 v[22:23], v[134:135], v[110:111], v[22:23] op_sel:[1,0,0] op_sel_hi:[1,1,1]
    s_set_gpr_idx_off
B_28:
    s_sub_u32 s32, s32, 4
    s_cbranch_scc1 MAIN_DONE
    s_waitcnt vmcnt(2)
    v_mfma_f32_4x4x4_16b_bf16 v[104:107], v[142:143], v[84:85], 0 cbsz:4 abid:7
    v_mfma_f32_4x4x4_16b_bf16 v[116:119], v[172:173], v[180:181], 0 cbsz:4 abid:8
    v_exp_f32 v136, v122
    v_exp_f32 v137, v123
    s_nop 0
    v_pk_add_f32 v[136:137], v[136:137], 1.0 op_sel_hi:[1,0]
    v_mfma_f32_4x4x4_16b_bf16 v[108:111], v[142:143], v[86:87], 0 cbsz:4 abid:7
    v_rcp_f32 v136, v136
    v_rcp_f32 v137, v137
    s_nop 0
    v_pk_mul_f32 v[132:133], v[136:137], v[122:123]
    s_set_gpr_idx_on s60, 0xc
    v_pk_fma_f32 v[16:17], v[128:129], v[96:97], v[16:17] op_sel:[0,0,0] op_sel_hi:[0,1,1]
    v_pk_fma_f32 v[18:19], v[128:129], v[98:99], v[18:19] op_sel:[0,0,0] op_sel_hi:[0,1,1]
    v_pk_fma_f32 v[20:21], v[130:131], v[100:101], v[20:21] op_sel:[0,0,0] op_sel_hi:[0,1,1]
    v_pk_fma_f32 v[22:23], v[130:131], v[102:103], v[22:23] op_sel:[0,0,0] op_sel_hi:[0,1,1]
    s_set_gpr_idx_off
    s_waitcnt vmcnt(1)
    v_mfma_f32_4x4x4_16b_bf16 v[96:99], v[144:145], v[88:89], 0 cbsz:4 abid:7
    v_mfma_f32_4x4x4_16b_bf16 v[116:119], v[172:173], v[182:183], v[116:119] cbsz:4 abid:8
    v_exp_f32 v136, v126
    v_exp_f32 v137, v127
    s_nop 0
    v_pk_add_f32 v[136:137], v[136:137], 1.0 op_sel_hi:[1,0]
    v_mfma_f32_4x4x4_16b_bf16 v[100:103], v[144:145], v[90:91], 0 cbsz:4 abid:7
    v_rcp_f32 v136, v136
    v_rcp_f32 v137, v137
    s_nop 0
    v_pk_mul_f32 v[134:135], v[136:137], v[126:127]
    s_set_gpr_idx_on s61, 0xc
    v_pk_fma_f32 v[16:17], v[128:129], v[104:105], v[16:17] op_sel:[1,0,0] op_sel_hi:[1,1,1]
    v_pk_fma_f32 v[18:19], v[128:129], v[106:107], v[18:19] op_sel:[1,0,0] op_sel_hi:[1,1,1]
    v_pk_fma_f32 v[20:21], v[130:131], v[108:109], v[20:21] op_sel:[1,0,0] op_sel_hi:[1,1,1]
    v_pk_fma_f32 v[22:23], v[130:131], v[110:111], v[22:23] op_sel:[1,0,0] op_sel_hi:[1,1,1]
    s_set_gpr_idx_off
    s_waitcnt vmcnt(0)
    v_mfma_f32_4x4x4_16b_bf16 v[104:107], v[146:147], v[92:93], 0 cbsz:4 abid:7
    v_mfma_f32_4x4x4_16b_bf16 v[120:123], v[172:173], v[176:177], 0 cbsz:4 abid:9
    v_exp_f32 v136, v112
    v_exp_f32 v137, v113
    s_nop 0
    v_pk_add_f32 v[136:137], v[136:137], 1.0 op_sel_hi:[1,0]
    v_mfma_f32_4x4x4_16b_bf16 v[108:111], v[146:147], v[94:95], 0 cbsz:4 abid:7
    v_rcp_f32 v136, v136
    v_rcp_f32 v137, v137
    s_nop 0
    v_pk_mul_f32 v[128:129], v[136:137], v[112:113]
    s_set_gpr_idx_on s62, 0xc
    v_pk_fma_f32 v[16:17], v[132:133], v[96:97], v[16:17] op_sel:[0,0,0] op_sel_hi:[0,1,1]
    v_pk_fma_f32 v[18:19], v[132:133], v[98:99], v[18:19] op_sel:[0,0,0] op_sel_hi:[0,1,1]
    v_pk_fma_f32 v[20:21], v[134:135], v[100:101], v[20:21] op_sel:[0,0,0] op_sel_hi:[0,1,1]
    v_pk_fma_f32 v[22:23], v[134:135], v[102:103], v[22:23] op_sel:[0,0,0] op_sel_hi:[0,1,1]
    s_set_gpr_idx_off
    s_waitcnt vmcnt(0)
    v_mfma_f32_4x4x4_16b_bf16 v[96:99], v[140:141], v[64:65], 0 cbsz:4 abid:8
    v_mfma_f32_4x4x4_16b_bf16 v[120:123], v[172:173], v[178:179], v[120:123] cbsz:4 abid:9
    v_exp_f32 v136, v116
    v_exp_f32 v137, v117
    s_nop 0
    v_pk_add_f32 v[136:137], v[136:137], 1.0 op_sel_hi:[1,0]
    v_mfma_f32_4x4x4_16b_bf16 v[100:103], v[140:141], v[66:67], 0 cbsz:4 abid:8
    v_rcp_f32 v136, v136
    v_rcp_f32 v137, v137
    s_nop 0
    v_pk_mul_f32 v[130:131], v[136:137], v[116:117]
    s_set_gpr_idx_on s63, 0xc
    v_pk_fma_f32 v[16:17], v[132:133], v[104:105], v[16:17] op_sel:[1,0,0] op_sel_hi:[1,1,1]
    v_pk_fma_f32 v[18:19], v[132:133], v[106:107], v[18:19] op_sel:[1,0,0] op_sel_hi:[1,1,1]
    v_pk_fma_f32 v[20:21], v[134:135], v[108:109], v[20:21] op_sel:[1,0,0] op_sel_hi:[1,1,1]
    v_pk_fma_f32 v[22:23], v[134:135], v[110:111], v[22:23] op_sel:[1,0,0] op_sel_hi:[1,1,1]
    s_set_gpr_idx_off
B_32:
    s_sub_u32 s32, s32, 4
    s_cbranch_scc1 MAIN_DONE
    s_waitcnt vmcnt(2)
    v_mfma_f32_4x4x4_16b_bf16 v[104:107], v[142:143], v[68:69], 0 cbsz:4 abid:8
    v_mfma_f32_4x4x4_16b_bf16 v[124:127], v[172:173], v[180:181], 0 cbsz:4 abid:9
    v_exp_f32 v136, v114
    v_exp_f32 v137, v115
    s_nop 0
    v_pk_add_f32 v[136:137], v[136:137], 1.0 op_sel_hi:[1,0]
    v_mfma_f32_4x4x4_16b_bf16 v[108:111], v[142:143], v[70:71], 0 cbsz:4 abid:8
    v_rcp_f32 v136, v136
    v_rcp_f32 v137, v137
    s_nop 0
    v_pk_mul_f32 v[132:133], v[136:137], v[114:115]
    s_set_gpr_idx_on s48, 0xc
    v_pk_fma_f32 v[16:17], v[128:129], v[96:97], v[16:17] op_sel:[0,0,0] op_sel_hi:[0,1,1]
    v_pk_fma_f32 v[18:19], v[128:129], v[98:99], v[18:19] op_sel:[0,0,0] op_sel_hi:[0,1,1]
    v_pk_fma_f32 v[20:21], v[130:131], v[100:101], v[20:21] op_sel:[0,0,0] op_sel_hi:[0,1,1]
    v_pk_fma_f32 v[22:23], v[130:131], v[102:103], v[22:23] op_sel:[0,0,0] op_sel_hi:[0,1,1]
    s_set_gpr_idx_off
    s_waitcnt vmcnt(1)
    v_mfma_f32_4x4x4_16b_bf16 v[96:99], v[144:145], v[72:73], 0 cbsz:4 abid:8
    v_mfma_f32_4x4x4_16b_bf16 v[124:127], v[172:173], v[182:183], v[124:127] cbsz:4 abid:9
    v_exp_f32 v136, v118
    v_exp_f32 v137, v119
    s_nop 0
    v_pk_add_f32 v[136:137], v[136:137], 1.0 op_sel_hi:[1,0]
    v_mfma_f32_4x4x4_16b_bf16 v[100:103], v[144:145], v[74:75], 0 cbsz:4 abid:8
    v_rcp_f32 v136, v136
    v_rcp_f32 v137, v137
    s_nop 0
    v_pk_mul_f32 v[134:135], v[136:137], v[118:119]
    s_set_gpr_idx_on s49, 0xc
    v_pk_fma_f32 v[16:17], v[128:129], v[104:105], v[16:17] op_sel:[1,0,0] op_sel_hi:[1,1,1]
    v_pk_fma_f32 v[18:19], v[128:129], v[106:107], v[18:19] op_sel:[1,0,0] op_sel_hi:[1,1,1]
    v_pk_fma_f32 v[20:21], v[130:131], v[108:109], v[20:21] op_sel:[1,0,0] op_sel_hi:[1,1,1]
    v_pk_fma_f32 v[22:23], v[130:131], v[110:111], v[22:23] op_sel:[1,0,0] op_sel_hi:[1,1,1]
    s_set_gpr_idx_off
    s_waitcnt vmcnt(0)
    v_mfma_f32_4x4x4_16b_bf16 v[104:107], v[146:147], v[76:77], 0 cbsz:4 abid:8
    v_mfma_f32_4x4x4_16b_bf16 v[112:115], v[172:173], v[176:177], 0 cbsz:4 abid:10
    v_exp_f32 v136, v120
    v_exp_f32 v137, v121
    s_nop 0
    v_pk_add_f32 v[136:137], v[136:137], 1.0 op_sel_hi:[1,0]
    v_mfma_f32_4x4x4_16b_bf16 v[108:111], v[146:147], v[78:79], 0 cbsz:4 abid:8
    v_rcp_f32 v136, v136
    v_rcp_f32 v137, v137
    s_nop 0
    v_pk_mul_f32 v[128:129], v[136:137], v[120:121]
    s_set_gpr_idx_on s50, 0xc
    v_pk_fma_f32 v[16:17], v[132:133], v[96:97], v[16:17] op_sel:[0,0,0] op_sel_hi:[0,1,1]
    v_pk_fma_f32 v[18:19], v[132:133], v[98:99], v[18:19] op_sel:[0,0,0] op_sel_hi:[0,1,1]
    v_pk_fma_f32 v[20:21], v[134:135], v[100:101], v[20:21] op_sel:[0,0,0] op_sel_hi:[0,1,1]
    v_pk_fma_f32 v[22:23], v[134:135], v[102:103], v[22:23] op_sel:[0,0,0] op_sel_hi:[0,1,1]
    s_set_gpr_idx_off
    s_waitcnt vmcnt(0)
    v_mfma_f32_4x4x4_16b_bf16 v[96:99], v[140:141], v[80:81], 0 cbsz:4 abid:9
    v_mfma_f32_4x4x4_16b_bf16 v[112:115], v[172:173], v[178:179], v[112:115] cbsz:4 abid:10
    v_exp_f32 v136, v124
    v_exp_f32 v137, v125
    s_nop 0
    v_pk_add_f32 v[136:137], v[136:137], 1.0 op_sel_hi:[1,0]
    v_mfma_f32_4x4x4_16b_bf16 v[100:103], v[140:141], v[82:83], 0 cbsz:4 abid:9
    v_rcp_f32 v136, v136
    v_rcp_f32 v137, v137
    s_nop 0
    v_pk_mul_f32 v[130:131], v[136:137], v[124:125]
    s_set_gpr_idx_on s51, 0xc
    v_pk_fma_f32 v[16:17], v[132:133], v[104:105], v[16:17] op_sel:[1,0,0] op_sel_hi:[1,1,1]
    v_pk_fma_f32 v[18:19], v[132:133], v[106:107], v[18:19] op_sel:[1,0,0] op_sel_hi:[1,1,1]
    v_pk_fma_f32 v[20:21], v[134:135], v[108:109], v[20:21] op_sel:[1,0,0] op_sel_hi:[1,1,1]
    v_pk_fma_f32 v[22:23], v[134:135], v[110:111], v[22:23] op_sel:[1,0,0] op_sel_hi:[1,1,1]
    s_set_gpr_idx_off
B_36:
    s_sub_u32 s32, s32, 4
    s_cbranch_scc1 MAIN_DONE
    s_waitcnt vmcnt(2)
    v_mfma_f32_4x4x4_16b_bf16 v[104:107], v[142:143], v[84:85], 0 cbsz:4 abid:9
    v_mfma_f32_4x4x4_16b_bf16 v[116:119], v[172:173], v[180:181], 0 cbsz:4 abid:10
    v_exp_f32 v136, v122
    v_exp_f32 v137, v123
    s_nop 0
    v_pk_add_f32 v[136:137], v[136:137], 1.0 op_sel_hi:[1,0]
    v_mfma_f32_4x4x4_16b_bf16 v[108:111], v[142:143], v[86:87], 0 cbsz:4 abid:9
    v_rcp_f32 v136, v136
    v_rcp_f32 v137, v137
    s_nop 0
    v_pk_mul_f32 v[132:133], v[136:137], v[122:123]
    s_set_gpr_idx_on s52, 0xc
    v_pk_fma_f32 v[16:17], v[128:129], v[96:97], v[16:17] op_sel:[0,0,0] op_sel_hi:[0,1,1]
    v_pk_fma_f32 v[18:19], v[128:129], v[98:99], v[18:19] op_sel:[0,0,0] op_sel_hi:[0,1,1]
    v_pk_fma_f32 v[20:21], v[130:131], v[100:101], v[20:21] op_sel:[0,0,0] op_sel_hi:[0,1,1]
    v_pk_fma_f32 v[22:23], v[130:131], v[102:103], v[22:23] op_sel:[0,0,0] op_sel_hi:[0,1,1]
    s_set_gpr_idx_off
    s_waitcnt vmcnt(1)
    v_mfma_f32_4x4x4_16b_bf16 v[96:99], v[144:145], v[88:89], 0 cbsz:4 abid:9
    v_mfma_f32_4x4x4_16b_bf16 v[116:119], v[172:173], v[182:183], v[116:119] cbsz:4 abid:10
    v_exp_f32 v136, v126
    v_exp_f32 v137, v127
    s_nop 0
    v_pk_add_f32 v[136:137], v[136:137], 1.0 op_sel_hi:[1,0]
    v_mfma_f32_4x4x4_16b_bf16 v[100:103], v[144:145], v[90:91], 0 cbsz:4 abid:9
    v_rcp_f32 v136, v136
    v_rcp_f32 v137, v137
    s_nop 0
    v_pk_mul_f32 v[134:135], v[136:137], v[126:127]
    s_set_gpr_idx_on s53, 0xc
    v_pk_fma_f32 v[16:17], v[128:129], v[104:105], v[16:17] op_sel:[1,0,0] op_sel_hi:[1,1,1]
    v_pk_fma_f32 v[18:19], v[128:129], v[106:107], v[18:19] op_sel:[1,0,0] op_sel_hi:[1,1,1]
    v_pk_fma_f32 v[20:21], v[130:131], v[108:109], v[20:21] op_sel:[1,0,0] op_sel_hi:[1,1,1]
    v_pk_fma_f32 v[22:23], v[130:131], v[110:111], v[22:23] op_sel:[1,0,0] op_sel_hi:[1,1,1]
    s_set_gpr_idx_off
    s_waitcnt vmcnt(0)
    v_mfma_f32_4x4x4_16b_bf16 v[104:107], v[146:147], v[92:93], 0 cbsz:4 abid:9
    v_mfma_f32_4x4x4_16b_bf16 v[120:123], v[172:173], v[176:177], 0 cbsz:4 abid:11
    v_exp_f32 v136, v112
    v_exp_f32 v137, v113
    s_nop 0
    v_pk_add_f32 v[136:137], v[136:137], 1.0 op_sel_hi:[1,0]
    v_mfma_f32_4x4x4_16b_bf16 v[108:111], v[146:147], v[94:95], 0 cbsz:4 abid:9
    v_rcp_f32 v136, v136
    v_rcp_f32 v137, v137
    s_nop 0
    v_pk_mul_f32 v[128:129], v[136:137], v[112:113]
    s_set_gpr_idx_on s54, 0xc
    v_pk_fma_f32 v[16:17], v[132:133], v[96:97], v[16:17] op_sel:[0,0,0] op_sel_hi:[0,1,1]
    v_pk_fma_f32 v[18:19], v[132:133], v[98:99], v[18:19] op_sel:[0,0,0] op_sel_hi:[0,1,1]
    v_pk_fma_f32 v[20:21], v[134:135], v[100:101], v[20:21] op_sel:[0,0,0] op_sel_hi:[0,1,1]
    v_pk_fma_f32 v[22:23], v[134:135], v[102:103], v[22:23] op_sel:[0,0,0] op_sel_hi:[0,1,1]
    s_set_gpr_idx_off
    s_waitcnt vmcnt(0)
    v_mfma_f32_4x4x4_16b_bf16 v[96:99], v[140:141], v[64:65], 0 cbsz:4 abid:10
    v_mfma_f32_4x4x4_16b_bf16 v[120:123], v[172:173], v[178:179], v[120:123] cbsz:4 abid:11
    v_exp_f32 v136, v116
    v_exp_f32 v137, v117
    s_nop 0
    v_pk_add_f32 v[136:137], v[136:137], 1.0 op_sel_hi:[1,0]
    v_mfma_f32_4x4x4_16b_bf16 v[100:103], v[140:141], v[66:67], 0 cbsz:4 abid:10
    v_rcp_f32 v136, v136
    v_rcp_f32 v137, v137
    s_nop 0
    v_pk_mul_f32 v[130:131], v[136:137], v[116:117]
    s_set_gpr_idx_on s55, 0xc
    v_pk_fma_f32 v[16:17], v[132:133], v[104:105], v[16:17] op_sel:[1,0,0] op_sel_hi:[1,1,1]
    v_pk_fma_f32 v[18:19], v[132:133], v[106:107], v[18:19] op_sel:[1,0,0] op_sel_hi:[1,1,1]
    v_pk_fma_f32 v[20:21], v[134:135], v[108:109], v[20:21] op_sel:[1,0,0] op_sel_hi:[1,1,1]
    v_pk_fma_f32 v[22:23], v[134:135], v[110:111], v[22:23] op_sel:[1,0,0] op_sel_hi:[1,1,1]
    s_set_gpr_idx_off
B_40:
    s_sub_u32 s32, s32, 4
    s_cbranch_scc1 MAIN_DONE
    s_waitcnt vmcnt(2)
    v_mfma_f32_4x4x4_16b_bf16 v[104:107], v[142:143], v[68:69], 0 cbsz:4 abid:10
    v_mfma_f32_4x4x4_16b_bf16 v[124:127], v[172:173], v[180:181], 0 cbsz:4 abid:11
    v_exp_f32 v136, v114
    v_exp_f32 v137, v115
    s_nop 0
    v_pk_add_f32 v[136:137], v[136:137], 1.0 op_sel_hi:[1,0]
    v_mfma_f32_4x4x4_16b_bf16 v[108:111], v[142:143], v[70:71], 0 cbsz:4 abid:10
    v_mfma_f32_4x4x4_16b_bf16 v[148:151], v[168:169], v[184:185], 0
    v_rcp_f32 v136, v136
    v_rcp_f32 v137, v137
    s_nop 0
    v_pk_mul_f32 v[132:133], v[136:137], v[114:115]
    s_set_gpr_idx_on s56, 0xc
    v_pk_fma_f32 v[16:17], v[128:129], v[96:97], v[16:17] op_sel:[0,0,0] op_sel_hi:[0,1,1]
    v_pk_fma_f32 v[18:19], v[128:129], v[98:99], v[18:19] op_sel:[0,0,0] op_sel_hi:[0,1,1]
    v_pk_fma_f32 v[20:21], v[130:131], v[100:101], v[20:21] op_sel:[0,0,0] op_sel_hi:[0,1,1]
    v_pk_fma_f32 v[22:23], v[130:131], v[102:103], v[22:23] op_sel:[0,0,0] op_sel_hi:[0,1,1]
    s_set_gpr_idx_off
    s_waitcnt vmcnt(1)
    v_mfma_f32_4x4x4_16b_bf16 v[96:99], v[144:145], v[72:73], 0 cbsz:4 abid:10
    v_mfma_f32_4x4x4_16b_bf16 v[124:127], v[172:173], v[182:183], v[124:127] cbsz:4 abid:11
    v_exp_f32 v136, v118
    v_exp_f32 v137, v119
    s_nop 0
    v_pk_add_f32 v[136:137], v[136:137], 1.0 op_sel_hi:[1,0]
    v_mfma_f32_4x4x4_16b_bf16 v[100:103], v[144:145], v[74:75], 0 cbsz:4 abid:10
    v_mfma_f32_4x4x4_16b_bf16 v[152:155], v[168:169], v[186:187], 0
    v_rcp_f32 v136, v136
    v_rcp_f32 v137, v137
    s_nop 0
    v_pk_mul_f32 v[134:135], v[136:137], v[118:119]
    s_set_gpr_idx_on s57, 0xc
    v_pk_fma_f32 v[16:17], v[128:129], v[104:105], v[16:17] op_sel:[1,0,0] op_sel_hi:[1,1,1]
    v_pk_fma_f32 v[18:19], v[128:129], v[106:107], v[18:19] op_sel:[1,0,0] op_sel_hi:[1,1,1]
    v_pk_fma_f32 v[20:21], v[130:131], v[108:109], v[20:21] op_sel:[1,0,0] op_sel_hi:[1,1,1]
    v_pk_fma_f32 v[22:23], v[130:131], v[110:111], v[22:23] op_sel:[1,0,0] op_sel_hi:[1,1,1]
    s_set_gpr_idx_off
    s_waitcnt vmcnt(0)
    v_mfma_f32_4x4x4_16b_bf16 v[104:107], v[146:147], v[76:77], 0 cbsz:4 abid:10
    v_mfma_f32_4x4x4_16b_bf16 v[112:115], v[172:173], v[176:177], 0 cbsz:4 abid:12
    v_exp_f32 v136, v120
    v_exp_f32 v137, v121
    s_nop 0
    v_pk_add_f32 v[136:137], v[136:137], 1.0 op_sel_hi:[1,0]
    v_mfma_f32_4x4x4_16b_bf16 v[108:111], v[146:147], v[78:79], 0 cbsz:4 abid:10
    v_mfma_f32_4x4x4_16b_bf16 v[156:159], v[168:169], v[188:189], 0
    v_rcp_f32 v136, v136
    v_rcp_f32 v137, v137
    s_nop 0
    v_pk_mul_f32 v[128:129], v[136:137], v[120:121]
    s_set_gpr_idx_on s58, 0xc
    v_pk_fma_f32 v[16:17], v[132:133], v[96:97], v[16:17] op_sel:[0,0,0] op_sel_hi:[0,1,1]
    v_pk_fma_f32 v[18:19], v[132:133], v[98:99], v[18:19] op_sel:[0,0,0] op_sel_hi:[0,1,1]
    v_pk_fma_f32 v[20:21], v[134:135], v[100:101], v[20:21] op_sel:[0,0,0] op_sel_hi:[0,1,1]
    v_pk_fma_f32 v[22:23], v[134:135], v[102:103], v[22:23] op_sel:[0,0,0] op_sel_hi:[0,1,1]
    s_set_gpr_idx_off
    s_waitcnt vmcnt(0)
    v_mfma_f32_4x4x4_16b_bf16 v[96:99], v[140:141], v[80:81], 0 cbsz:4 abid:11
    v_mfma_f32_4x4x4_16b_bf16 v[112:115], v[172:173], v[178:179], v[112:115] cbsz:4 abid:12
    v_exp_f32 v136, v124
    v_exp_f32 v137, v125
    s_nop 0
    v_pk_add_f32 v[136:137], v[136:137], 1.0 op_sel_hi:[1,0]
    v_mfma_f32_4x4x4_16b_bf16 v[100:103], v[140:141], v[82:83], 0 cbsz:4 abid:11
    v_mfma_f32_4x4x4_16b_bf16 v[160:163], v[168:169], v[190:191], 0
    v_rcp_f32 v136, v136
    v_rcp_f32 v137, v137
    s_nop 0
    v_pk_mul_f32 v[130:131], v[136:137], v[124:125]
    s_set_gpr_idx_on s59, 0xc
    v_pk_fma_f32 v[16:17], v[132:133], v[104:105], v[16:17] op_sel:[1,0,0] op_sel_hi:[1,1,1]
    v_pk_fma_f32 v[18:19], v[132:133], v[106:107], v[18:19] op_sel:[1,0,0] op_sel_hi:[1,1,1]
    v_pk_fma_f32 v[20:21], v[134:135], v[108:109], v[20:21] op_sel:[1,0,0] op_sel_hi:[1,1,1]
    v_pk_fma_f32 v[22:23], v[134:135], v[110:111], v[22:23] op_sel:[1,0,0] op_sel_hi:[1,1,1]
    s_set_gpr_idx_off
B_44:
    s_sub_u32 s32, s32, 4
    s_cbranch_scc1 MAIN_DONE
    s_waitcnt vmcnt(2)
    v_mfma_f32_4x4x4_16b_bf16 v[104:107], v[142:143], v[84:85], 0 cbsz:4 abid:11
    v_mfma_f32_4x4x4_16b_bf16 v[116:119], v[172:173], v[180:181], 0 cbsz:4 abid:12
    v_exp_f32 v136, v122
    v_exp_f32 v137, v123
    s_nop 0
    v_pk_add_f32 v[136:137], v[136:137], 1.0 op_sel_hi:[1,0]
    v_mfma_f32_4x4x4_16b_bf16 v[108:111], v[142:143], v[86:87], 0 cbsz:4 abid:11
    v_rcp_f32 v136, v136
    v_rcp_f32 v137, v137
    s_nop 0
    v_pk_mul_f32 v[132:133], v[136:137], v[122:123]
    s_set_gpr_idx_on s60, 0xc
    v_pk_fma_f32 v[16:17], v[128:129], v[96:97], v[16:17] op_sel:[0,0,0] op_sel_hi:[0,1,1]
    v_pk_fma_f32 v[18:19], v[128:129], v[98:99], v[18:19] op_sel:[0,0,0] op_sel_hi:[0,1,1]
    v_pk_fma_f32 v[20:21], v[130:131], v[100:101], v[20:21] op_sel:[0,0,0] op_sel_hi:[0,1,1]
    v_pk_fma_f32 v[22:23], v[130:131], v[102:103], v[22:23] op_sel:[0,0,0] op_sel_hi:[0,1,1]
    s_set_gpr_idx_off
    s_waitcnt vmcnt(1)
    v_mfma_f32_4x4x4_16b_bf16 v[96:99], v[144:145], v[88:89], 0 cbsz:4 abid:11
    v_mfma_f32_4x4x4_16b_bf16 v[116:119], v[172:173], v[182:183], v[116:119] cbsz:4 abid:12
    v_exp_f32 v136, v126
    v_exp_f32 v137, v127
    s_nop 0
    v_pk_add_f32 v[136:137], v[136:137], 1.0 op_sel_hi:[1,0]
    v_mfma_f32_4x4x4_16b_bf16 v[100:103], v[144:145], v[90:91], 0 cbsz:4 abid:11
    v_rcp_f32 v136, v136
    v_rcp_f32 v137, v137
    s_nop 0
    v_pk_mul_f32 v[134:135], v[136:137], v[126:127]
    s_set_gpr_idx_on s61, 0xc
    v_pk_fma_f32 v[16:17], v[128:129], v[104:105], v[16:17] op_sel:[1,0,0] op_sel_hi:[1,1,1]
    v_pk_fma_f32 v[18:19], v[128:129], v[106:107], v[18:19] op_sel:[1,0,0] op_sel_hi:[1,1,1]
    v_pk_fma_f32 v[20:21], v[130:131], v[108:109], v[20:21] op_sel:[1,0,0] op_sel_hi:[1,1,1]
    v_pk_fma_f32 v[22:23], v[130:131], v[110:111], v[22:23] op_sel:[1,0,0] op_sel_hi:[1,1,1]
    s_set_gpr_idx_off
    s_waitcnt vmcnt(0)
    v_mfma_f32_4x4x4_16b_bf16 v[104:107], v[146:147], v[92:93], 0 cbsz:4 abid:11
    v_mfma_f32_4x4x4_16b_bf16 v[120:123], v[172:173], v[176:177], 0 cbsz:4 abid:13
    v_exp_f32 v136, v112
    v_exp_f32 v137, v113
    s_nop 0
    v_pk_add_f32 v[136:137], v[136:137], 1.0 op_sel_hi:[1,0]
    v_mfma_f32_4x4x4_16b_bf16 v[108:111], v[146:147], v[94:95], 0 cbsz:4 abid:11
    v_rcp_f32 v136, v136
    v_rcp_f32 v137, v137
    s_nop 0
    v_pk_mul_f32 v[128:129], v[136:137], v[112:113]
    s_set_gpr_idx_on s62, 0xc
    v_pk_fma_f32 v[16:17], v[132:133], v[96:97], v[16:17] op_sel:[0,0,0] op_sel_hi:[0,1,1]
    v_pk_fma_f32 v[18:19], v[132:133], v[98:99], v[18:19] op_sel:[0,0,0] op_sel_hi:[0,1,1]
    v_pk_fma_f32 v[20:21], v[134:135], v[100:101], v[20:21] op_sel:[0,0,0] op_sel_hi:[0,1,1]
    v_pk_fma_f32 v[22:23], v[134:135], v[102:103], v[22:23] op_sel:[0,0,0] op_sel_hi:[0,1,1]
    s_set_gpr_idx_off
    s_waitcnt vmcnt(0)
    v_mfma_f32_4x4x4_16b_bf16 v[96:99], v[140:141], v[64:65], 0 cbsz:4 abid:12
    v_mfma_f32_4x4x4_16b_bf16 v[120:123], v[172:173], v[178:179], v[120:123] cbsz:4 abid:13
    v_exp_f32 v136, v116
    v_exp_f32 v137, v117
    s_nop 0
    v_pk_add_f32 v[136:137], v[136:137], 1.0 op_sel_hi:[1,0]
    v_mfma_f32_4x4x4_16b_bf16 v[100:103], v[140:141], v[66:67], 0 cbsz:4 abid:12
    v_rcp_f32 v136, v136
    v_rcp_f32 v137, v137
    s_nop 0
    v_pk_mul_f32 v[130:131], v[136:137], v[116:117]
    s_set_gpr_idx_on s63, 0xc
    v_pk_fma_f32 v[16:17], v[132:133], v[104:105], v[16:17] op_sel:[1,0,0] op_sel_hi:[1,1,1]
    v_pk_fma_f32 v[18:19], v[132:133], v[106:107], v[18:19] op_sel:[1,0,0] op_sel_hi:[1,1,1]
    v_pk_fma_f32 v[20:21], v[134:135], v[108:109], v[20:21] op_sel:[1,0,0] op_sel_hi:[1,1,1]
    v_pk_fma_f32 v[22:23], v[134:135], v[110:111], v[22:23] op_sel:[1,0,0] op_sel_hi:[1,1,1]
    s_set_gpr_idx_off
B_48:
    s_sub_u32 s32, s32, 4
    s_cbranch_scc1 MAIN_DONE
    s_waitcnt vmcnt(2)
    v_mfma_f32_4x4x4_16b_bf16 v[104:107], v[142:143], v[68:69], 0 cbsz:4 abid:12
    v_mfma_f32_4x4x4_16b_bf16 v[124:127], v[172:173], v[180:181], 0 cbsz:4 abid:13
    v_exp_f32 v136, v114
    v_exp_f32 v137, v115
    s_nop 0
    v_pk_add_f32 v[136:137], v[136:137], 1.0 op_sel_hi:[1,0]
    v_mfma_f32_4x4x4_16b_bf16 v[108:111], v[142:143], v[70:71], 0 cbsz:4 abid:12
    v_rcp_f32 v136, v136
    v_rcp_f32 v137, v137
    s_nop 0
    v_pk_mul_f32 v[132:133], v[136:137], v[114:115]
    s_set_gpr_idx_on s48, 0xc
    v_pk_fma_f32 v[16:17], v[128:129], v[96:97], v[16:17] op_sel:[0,0,0] op_sel_hi:[0,1,1]
    v_pk_fma_f32 v[18:19], v[128:129], v[98:99], v[18:19] op_sel:[0,0,0] op_sel_hi:[0,1,1]
    v_pk_fma_f32 v[20:21], v[130:131], v[100:101], v[20:21] op_sel:[0,0,0] op_sel_hi:[0,1,1]
    v_pk_fma_f32 v[22:23], v[130:131], v[102:103], v[22:23] op_sel:[0,0,0] op_sel_hi:[0,1,1]
    s_set_gpr_idx_off
    s_waitcnt vmcnt(1)
    v_mfma_f32_4x4x4_16b_bf16 v[96:99], v[144:145], v[72:73], 0 cbsz:4 abid:12
    v_mfma_f32_4x4x4_16b_bf16 v[124:127], v[172:173], v[182:183], v[124:127] cbsz:4 abid:13
    v_exp_f32 v136, v118
    v_exp_f32 v137, v119
    s_nop 0
    v_pk_add_f32 v[136:137], v[136:137], 1.0 op_sel_hi:[1,0]
    v_mfma_f32_4x4x4_16b_bf16 v[100:103], v[144:145], v[74:75], 0 cbsz:4 abid:12
    v_rcp_f32 v136, v136
    v_rcp_f32 v137, v137
    s_nop 0
    v_pk_mul_f32 v[134:135], v[136:137], v[118:119]
    s_set_gpr_idx_on s49, 0xc
    v_pk_fma_f32 v[16:17], v[128:129], v[104:105], v[16:17] op_sel:[1,0,0] op_sel_hi:[1,1,1]
    v_pk_fma_f32 v[18:19], v[128:129], v[106:107], v[18:19] op_sel:[1,0,0] op_sel_hi:[1,1,1]
    v_pk_fma_f32 v[20:21], v[130:131], v[108:109], v[20:21] op_sel:[1,0,0] op_sel_hi:[1,1,1]
    v_pk_fma_f32 v[22:23], v[130:131], v[110:111], v[22:23] op_sel:[1,0,0] op_sel_hi:[1,1,1]
    s_set_gpr_idx_off
    s_waitcnt vmcnt(0)
    v_mfma_f32_4x4x4_16b_bf16 v[104:107], v[146:147], v[76:77], 0 cbsz:4 abid:12
    v_mfma_f32_4x4x4_16b_bf16 v[112:115], v[172:173], v[176:177], 0 cbsz:4 abid:14
    v_exp_f32 v136, v120
    v_exp_f32 v137, v121
    s_nop 0
    v_pk_add_f32 v[136:137], v[136:137], 1.0 op_sel_hi:[1,0]
    v_mfma_f32_4x4x4_16b_bf16 v[108:111], v[146:147], v[78:79], 0 cbsz:4 abid:12
    v_rcp_f32 v136, v136
    v_rcp_f32 v137, v137
    s_nop 0
    v_pk_mul_f32 v[128:129], v[136:137], v[120:121]
    s_set_gpr_idx_on s50, 0xc
    v_pk_fma_f32 v[16:17], v[132:133], v[96:97], v[16:17] op_sel:[0,0,0] op_sel_hi:[0,1,1]
    v_pk_fma_f32 v[18:19], v[132:133], v[98:99], v[18:19] op_sel:[0,0,0] op_sel_hi:[0,1,1]
    v_pk_fma_f32 v[20:21], v[134:135], v[100:101], v[20:21] op_sel:[0,0,0] op_sel_hi:[0,1,1]
    v_pk_fma_f32 v[22:23], v[134:135], v[102:103], v[22:23] op_sel:[0,0,0] op_sel_hi:[0,1,1]
    s_set_gpr_idx_off
    s_waitcnt vmcnt(0)
    v_mfma_f32_4x4x4_16b_bf16 v[96:99], v[140:141], v[80:81], 0 cbsz:4 abid:13
    v_mfma_f32_4x4x4_16b_bf16 v[112:115], v[172:173], v[178:179], v[112:115] cbsz:4 abid:14
    v_exp_f32 v136, v124
    v_exp_f32 v137, v125
    s_nop 0
    v_pk_add_f32 v[136:137], v[136:137], 1.0 op_sel_hi:[1,0]
    v_mfma_f32_4x4x4_16b_bf16 v[100:103], v[140:141], v[82:83], 0 cbsz:4 abid:13
    v_rcp_f32 v136, v136
    v_rcp_f32 v137, v137
    s_nop 0
    v_pk_mul_f32 v[130:131], v[136:137], v[124:125]
    s_set_gpr_idx_on s51, 0xc
    v_pk_fma_f32 v[16:17], v[132:133], v[104:105], v[16:17] op_sel:[1,0,0] op_sel_hi:[1,1,1]
    v_pk_fma_f32 v[18:19], v[132:133], v[106:107], v[18:19] op_sel:[1,0,0] op_sel_hi:[1,1,1]
    v_pk_fma_f32 v[20:21], v[134:135], v[108:109], v[20:21] op_sel:[1,0,0] op_sel_hi:[1,1,1]
    v_pk_fma_f32 v[22:23], v[134:135], v[110:111], v[22:23] op_sel:[1,0,0] op_sel_hi:[1,1,1]
    s_set_gpr_idx_off
B_52:
    s_sub_u32 s32, s32, 4
    s_cbranch_scc1 MAIN_DONE
    s_waitcnt vmcnt(2)
    v_mfma_f32_4x4x4_16b_bf16 v[104:107], v[142:143], v[84:85], 0 cbsz:4 abid:13
    v_mfma_f32_4x4x4_16b_bf16 v[116:119], v[172:173], v[180:181], 0 cbsz:4 abid:14
    v_exp_f32 v136, v122
    v_exp_f32 v137, v123
    s_nop 0
    v_pk_add_f32 v[136:137], v[136:137], 1.0 op_sel_hi:[1,0]
    v_mfma_f32_4x4x4_16b_bf16 v[108:111], v[142:143], v[86:87], 0 cbsz:4 abid:13
    v_rcp_f32 v136, v136
    v_rcp_f32 v137, v137
    s_nop 0
    v_pk_mul_f32 v[132:133], v[136:137], v[122:123]
    s_set_gpr_idx_on s52, 0xc
    v_pk_fma_f32 v[16:17], v[128:129], v[96:97], v[16:17] op_sel:[0,0,0] op_sel_hi:[0,1,1]
    v_pk_fma_f32 v[18:19], v[128:129], v[98:99], v[18:19] op_sel:[0,0,0] op_sel_hi:[0,1,1]
    v_pk_fma_f32 v[20:21], v[130:131], v[100:101], v[20:21] op_sel:[0,0,0] op_sel_hi:[0,1,1]
    v_pk_fma_f32 v[22:23], v[130:131], v[102:103], v[22:23] op_sel:[0,0,0] op_sel_hi:[0,1,1]
    s_set_gpr_idx_off
    s_waitcnt vmcnt(1)
    v_mfma_f32_4x4x4_16b_bf16 v[96:99], v[144:145], v[88:89], 0 cbsz:4 abid:13
    v_mfma_f32_4x4x4_16b_bf16 v[116:119], v[172:173], v[182:183], v[116:119] cbsz:4 abid:14
    v_exp_f32 v136, v126
    v_exp_f32 v137, v127
    s_nop 0
    v_pk_add_f32 v[136:137], v[136:137], 1.0 op_sel_hi:[1,0]
    v_mfma_f32_4x4x4_16b_bf16 v[100:103], v[144:145], v[90:91], 0 cbsz:4 abid:13
    v_rcp_f32 v136, v136
    v_rcp_f32 v137, v137
    s_nop 0
    v_pk_mul_f32 v[134:135], v[136:137], v[126:127]
    s_set_gpr_idx_on s53, 0xc
    v_pk_fma_f32 v[16:17], v[128:129], v[104:105], v[16:17] op_sel:[1,0,0] op_sel_hi:[1,1,1]
    v_pk_fma_f32 v[18:19], v[128:129], v[106:107], v[18:19] op_sel:[1,0,0] op_sel_hi:[1,1,1]
    v_pk_fma_f32 v[20:21], v[130:131], v[108:109], v[20:21] op_sel:[1,0,0] op_sel_hi:[1,1,1]
    v_pk_fma_f32 v[22:23], v[130:131], v[110:111], v[22:23] op_sel:[1,0,0] op_sel_hi:[1,1,1]
    s_set_gpr_idx_off
    s_waitcnt vmcnt(0)
    v_mfma_f32_4x4x4_16b_bf16 v[104:107], v[146:147], v[92:93], 0 cbsz:4 abid:13
    v_mfma_f32_4x4x4_16b_bf16 v[120:123], v[172:173], v[176:177], 0 cbsz:4 abid:15
    v_exp_f32 v136, v112
    v_exp_f32 v137, v113
    s_nop 0
    v_pk_add_f32 v[136:137], v[136:137], 1.0 op_sel_hi:[1,0]
    v_mfma_f32_4x4x4_16b_bf16 v[108:111], v[146:147], v[94:95], 0 cbsz:4 abid:13
    v_rcp_f32 v136, v136
    v_rcp_f32 v137, v137
    s_nop 0
    v_pk_mul_f32 v[128:129], v[136:137], v[112:113]
    s_set_gpr_idx_on s54, 0xc
    v_pk_fma_f32 v[16:17], v[132:133], v[96:97], v[16:17] op_sel:[0,0,0] op_sel_hi:[0,1,1]
    v_pk_fma_f32 v[18:19], v[132:133], v[98:99], v[18:19] op_sel:[0,0,0] op_sel_hi:[0,1,1]
    v_pk_fma_f32 v[20:21], v[134:135], v[100:101], v[20:21] op_sel:[0,0,0] op_sel_hi:[0,1,1]
    v_pk_fma_f32 v[22:23], v[134:135], v[102:103], v[22:23] op_sel:[0,0,0] op_sel_hi:[0,1,1]
    s_set_gpr_idx_off
    s_waitcnt vmcnt(0)
    v_mfma_f32_4x4x4_16b_bf16 v[96:99], v[140:141], v[64:65], 0 cbsz:4 abid:14
    v_mfma_f32_4x4x4_16b_bf16 v[120:123], v[172:173], v[178:179], v[120:123] cbsz:4 abid:15
    v_exp_f32 v136, v116
    v_exp_f32 v137, v117
    s_nop 0
    v_pk_add_f32 v[136:137], v[136:137], 1.0 op_sel_hi:[1,0]
    v_mfma_f32_4x4x4_16b_bf16 v[100:103], v[140:141], v[66:67], 0 cbsz:4 abid:14
    v_rcp_f32 v136, v136
    v_rcp_f32 v137, v137
    s_nop 0
    v_pk_mul_f32 v[130:131], v[136:137], v[116:117]
    s_set_gpr_idx_on s55, 0xc
    v_pk_fma_f32 v[16:17], v[132:133], v[104:105], v[16:17] op_sel:[1,0,0] op_sel_hi:[1,1,1]
    v_pk_fma_f32 v[18:19], v[132:133], v[106:107], v[18:19] op_sel:[1,0,0] op_sel_hi:[1,1,1]
    v_pk_fma_f32 v[20:21], v[134:135], v[108:109], v[20:21] op_sel:[1,0,0] op_sel_hi:[1,1,1]
    v_pk_fma_f32 v[22:23], v[134:135], v[110:111], v[22:23] op_sel:[1,0,0] op_sel_hi:[1,1,1]
    s_set_gpr_idx_off
B_56:
    s_sub_u32 s32, s32, 4
    s_cbranch_scc1 MAIN_DONE
    s_waitcnt vmcnt(2)
    v_mfma_f32_4x4x4_16b_bf16 v[104:107], v[142:143], v[68:69], 0 cbsz:4 abid:14
    v_mfma_f32_4x4x4_16b_bf16 v[124:127], v[172:173], v[180:181], 0 cbsz:4 abid:15
    v_exp_f32 v136, v114
    v_exp_f32 v137, v115
    s_nop 0
    v_pk_add_f32 v[136:137], v[136:137], 1.0 op_sel_hi:[1,0]
    v_mfma_f32_4x4x4_16b_bf16 v[108:111], v[142:143], v[70:71], 0 cbsz:4 abid:14
    v_rcp_f32 v136, v136
    v_rcp_f32 v137, v137
    s_nop 0
    v_pk_mul_f32 v[132:133], v[136:137], v[114:115]
    s_set_gpr_idx_on s56, 0xc
    v_pk_fma_f32 v[16:17], v[128:129], v[96:97], v[16:17] op_sel:[0,0,0] op_sel_hi:[0,1,1]
    v_pk_fma_f32 v[18:19], v[128:129], v[98:99], v[18:19] op_sel:[0,0,0] op_sel_hi:[0,1,1]
    v_pk_fma_f32 v[20:21], v[130:131], v[100:101], v[20:21] op_sel:[0,0,0] op_sel_hi:[0,1,1]
    v_pk_fma_f32 v[22:23], v[130:131], v[102:103], v[22:23] op_sel:[0,0,0] op_sel_hi:[0,1,1]
    s_set_gpr_idx_off
    s_waitcnt vmcnt(1)
    v_mfma_f32_4x4x4_16b_bf16 v[96:99], v[144:145], v[72:73], 0 cbsz:4 abid:14
    v_mfma_f32_4x4x4_16b_bf16 v[124:127], v[172:173], v[182:183], v[124:127] cbsz:4 abid:15
    v_exp_f32 v136, v118
    v_exp_f32 v137, v119
    s_nop 0
    v_pk_add_f32 v[136:137], v[136:137], 1.0 op_sel_hi:[1,0]
    v_mfma_f32_4x4x4_16b_bf16 v[100:103], v[144:145], v[74:75], 0 cbsz:4 abid:14
    v_rcp_f32 v136, v136
    v_rcp_f32 v137, v137
    s_nop 0
    v_pk_mul_f32 v[134:135], v[136:137], v[118:119]
    s_set_gpr_idx_on s57, 0xc
    v_pk_fma_f32 v[16:17], v[128:129], v[104:105], v[16:17] op_sel:[1,0,0] op_sel_hi:[1,1,1]
    v_pk_fma_f32 v[18:19], v[128:129], v[106:107], v[18:19] op_sel:[1,0,0] op_sel_hi:[1,1,1]
    v_pk_fma_f32 v[20:21], v[130:131], v[108:109], v[20:21] op_sel:[1,0,0] op_sel_hi:[1,1,1]
    v_pk_fma_f32 v[22:23], v[130:131], v[110:111], v[22:23] op_sel:[1,0,0] op_sel_hi:[1,1,1]
    s_set_gpr_idx_off
    v_mov_b32 v172, v170
    v_mov_b32 v173, v171
    s_waitcnt vmcnt(0)
    v_mfma_f32_4x4x4_16b_bf16 v[104:107], v[146:147], v[76:77], 0 cbsz:4 abid:14
    v_mfma_f32_4x4x4_16b_bf16 v[112:115], v[172:173], v[176:177], 0 cbsz:4 abid:0
    v_exp_f32 v136, v120
    v_exp_f32 v137, v121
    s_nop 0
    v_pk_add_f32 v[136:137], v[136:137], 1.0 op_sel_hi:[1,0]
    v_mfma_f32_4x4x4_16b_bf16 v[108:111], v[146:147], v[78:79], 0 cbsz:4 abid:14
    v_rcp_f32 v136, v136
    v_rcp_f32 v137, v137
    s_nop 0
    v_pk_mul_f32 v[128:129], v[136:137], v[120:121]
    s_set_gpr_idx_on s58, 0xc
    v_pk_fma_f32 v[16:17], v[132:133], v[96:97], v[16:17] op_sel:[0,0,0] op_sel_hi:[0,1,1]
    v_pk_fma_f32 v[18:19], v[132:133], v[98:99], v[18:19] op_sel:[0,0,0] op_sel_hi:[0,1,1]
    v_pk_fma_f32 v[20:21], v[134:135], v[100:101], v[20:21] op_sel:[0,0,0] op_sel_hi:[0,1,1]
    v_pk_fma_f32 v[22:23], v[134:135], v[102:103], v[22:23] op_sel:[0,0,0] op_sel_hi:[0,1,1]
    s_set_gpr_idx_off
    s_waitcnt vmcnt(0)
    v_mfma_f32_4x4x4_16b_bf16 v[96:99], v[140:141], v[80:81], 0 cbsz:4 abid:15
    v_mfma_f32_4x4x4_16b_bf16 v[112:115], v[172:173], v[178:179], v[112:115] cbsz:4 abid:0
    v_exp_f32 v136, v124
    v_exp_f32 v137, v125
    s_nop 0
    v_pk_add_f32 v[136:137], v[136:137], 1.0 op_sel_hi:[1,0]
    v_mfma_f32_4x4x4_16b_bf16 v[100:103], v[140:141], v[82:83], 0 cbsz:4 abid:15
    v_rcp_f32 v136, v136
    v_rcp_f32 v137, v137
    s_nop 0
    v_pk_mul_f32 v[130:131], v[136:137], v[124:125]
    s_set_gpr_idx_on s59, 0xc
    v_pk_fma_f32 v[16:17], v[132:133], v[104:105], v[16:17] op_sel:[1,0,0] op_sel_hi:[1,1,1]
    v_pk_fma_f32 v[18:19], v[132:133], v[106:107], v[18:19] op_sel:[1,0,0] op_sel_hi:[1,1,1]
    v_pk_fma_f32 v[20:21], v[134:135], v[108:109], v[20:21] op_sel:[1,0,0] op_sel_hi:[1,1,1]
    v_pk_fma_f32 v[22:23], v[134:135], v[110:111], v[22:23] op_sel:[1,0,0] op_sel_hi:[1,1,1]
    s_set_gpr_idx_off
B_60:
    s_sub_u32 s32, s32, 4
    s_cbranch_scc1 MAIN_DONE
    s_waitcnt vmcnt(2)
    v_mfma_f32_4x4x4_16b_bf16 v[104:107], v[142:143], v[84:85], 0 cbsz:4 abid:15
    v_mfma_f32_4x4x4_16b_bf16 v[116:119], v[172:173], v[180:181], 0 cbsz:4 abid:0
    v_exp_f32 v136, v122
    v_exp_f32 v137, v123
    s_nop 0
    v_pk_add_f32 v[136:137], v[136:137], 1.0 op_sel_hi:[1,0]
    v_mfma_f32_4x4x4_16b_bf16 v[108:111], v[142:143], v[86:87], 0 cbsz:4 abid:15
    v_rcp_f32 v136, v136
    v_rcp_f32 v137, v137
    s_nop 0
    v_pk_mul_f32 v[132:133], v[136:137], v[122:123]
    s_set_gpr_idx_on s60, 0xc
    v_pk_fma_f32 v[16:17], v[128:129], v[96:97], v[16:17] op_sel:[0,0,0] op_sel_hi:[0,1,1]
    v_pk_fma_f32 v[18:19], v[128:129], v[98:99], v[18:19] op_sel:[0,0,0] op_sel_hi:[0,1,1]
    v_pk_fma_f32 v[20:21], v[130:131], v[100:101], v[20:21] op_sel:[0,0,0] op_sel_hi:[0,1,1]
    v_pk_fma_f32 v[22:23], v[130:131], v[102:103], v[22:23] op_sel:[0,0,0] op_sel_hi:[0,1,1]
    s_set_gpr_idx_off
    v_cvt_pk_bf16_f32 v140, v148, v152
    v_cvt_pk_bf16_f32 v141, v156, v160
    s_waitcnt vmcnt(1)
    v_mfma_f32_4x4x4_16b_bf16 v[96:99], v[144:145], v[88:89], 0 cbsz:4 abid:15
    v_mfma_f32_4x4x4_16b_bf16 v[116:119], v[172:173], v[182:183], v[116:119] cbsz:4 abid:0
    v_exp_f32 v136, v126
    v_exp_f32 v137, v127
    s_nop 0
    v_pk_add_f32 v[136:137], v[136:137], 1.0 op_sel_hi:[1,0]
    v_mfma_f32_4x4x4_16b_bf16 v[100:103], v[144:145], v[90:91], 0 cbsz:4 abid:15
    v_rcp_f32 v136, v136
    v_rcp_f32 v137, v137
    s_nop 0
    v_pk_mul_f32 v[134:135], v[136:137], v[126:127]
    s_set_gpr_idx_on s61, 0xc
    v_pk_fma_f32 v[16:17], v[128:129], v[104:105], v[16:17] op_sel:[1,0,0] op_sel_hi:[1,1,1]
    v_pk_fma_f32 v[18:19], v[128:129], v[106:107], v[18:19] op_sel:[1,0,0] op_sel_hi:[1,1,1]
    v_pk_fma_f32 v[20:21], v[130:131], v[108:109], v[20:21] op_sel:[1,0,0] op_sel_hi:[1,1,1]
    v_pk_fma_f32 v[22:23], v[130:131], v[110:111], v[22:23] op_sel:[1,0,0] op_sel_hi:[1,1,1]
    s_set_gpr_idx_off
    v_cvt_pk_bf16_f32 v142, v149, v153
    v_cvt_pk_bf16_f32 v143, v157, v161
    s_waitcnt vmcnt(0)
    v_mfma_f32_4x4x4_16b_bf16 v[104:107], v[146:147], v[92:93], 0 cbsz:4 abid:15
    v_mfma_f32_4x4x4_16b_bf16 v[120:123], v[172:173], v[176:177], 0 cbsz:4 abid:1
    v_exp_f32 v136, v112
    v_exp_f32 v137, v113
    s_nop 0
    v_pk_add_f32 v[136:137], v[136:137], 1.0 op_sel_hi:[1,0]
    v_mfma_f32_4x4x4_16b_bf16 v[108:111], v[146:147], v[94:95], 0 cbsz:4 abid:15
    v_rcp_f32 v136, v136
    v_rcp_f32 v137, v137
    s_nop 0
    v_pk_mul_f32 v[128:129], v[136:137], v[112:113]
    s_set_gpr_idx_on s62, 0xc
    v_pk_fma_f32 v[16:17], v[132:133], v[96:97], v[16:17] op_sel:[0,0,0] op_sel_hi:[0,1,1]
    v_pk_fma_f32 v[18:19], v[132:133], v[98:99], v[18:19] op_sel:[0,0,0] op_sel_hi:[0,1,1]
    v_pk_fma_f32 v[20:21], v[134:135], v[100:101], v[20:21] op_sel:[0,0,0] op_sel_hi:[0,1,1]
    v_pk_fma_f32 v[22:23], v[134:135], v[102:103], v[22:23] op_sel:[0,0,0] op_sel_hi:[0,1,1]
    s_set_gpr_idx_off
    v_cvt_pk_bf16_f32 v144, v150, v154
    v_cvt_pk_bf16_f32 v145, v158, v162
    s_waitcnt vmcnt(0)
    v_mfma_f32_4x4x4_16b_bf16 v[96:99], v[140:141], v[64:65], 0 cbsz:4 abid:0
    v_mfma_f32_4x4x4_16b_bf16 v[120:123], v[172:173], v[178:179], v[120:123] cbsz:4 abid:1
    v_exp_f32 v136, v116
    v_exp_f32 v137, v117
    s_nop 0
    v_pk_add_f32 v[136:137], v[136:137], 1.0 op_sel_hi:[1,0]
    v_mfma_f32_4x4x4_16b_bf16 v[100:103], v[140:141], v[66:67], 0 cbsz:4 abid:0
    v_rcp_f32 v136, v136
    v_rcp_f32 v137, v137
    s_nop 0
    v_pk_mul_f32 v[130:131], v[136:137], v[116:117]
    s_set_gpr_idx_on s63, 0xc
    v_pk_fma_f32 v[16:17], v[132:133], v[104:105], v[16:17] op_sel:[1,0,0] op_sel_hi:[1,1,1]
    v_pk_fma_f32 v[18:19], v[132:133], v[106:107], v[18:19] op_sel:[1,0,0] op_sel_hi:[1,1,1]
    v_pk_fma_f32 v[20:21], v[134:135], v[108:109], v[20:21] op_sel:[1,0,0] op_sel_hi:[1,1,1]
    v_pk_fma_f32 v[22:23], v[134:135], v[110:111], v[22:23] op_sel:[1,0,0] op_sel_hi:[1,1,1]
    s_set_gpr_idx_off
    v_mov_b32 v164, v166
    v_cvt_pk_bf16_f32 v146, v151, v155
    v_cvt_pk_bf16_f32 v147, v159, v163
    s_branch B_0
MAIN_DONE:
    s_waitcnt vmcnt(0) lgkmcnt(0)
    s_add_u32 s27, s27, s35
    s_cmp_ge_u32 s27, s26
    s_cbranch_scc1 ALL_DONE
    v_lshlrev_b32 v11, 3, v0
    v_mov_b32 v12, 0
    v_mov_b32 v13, 0
    v_cmp_gt_u32 vcc, 400, v0
    s_and_saveexec_b64 s[42:43], vcc
    ds_write_b64 v11, v[12:13] offset:0
    s_mov_b64 exec, s[42:43]
    s_branch ROUND
ALL_DONE:
    s_mov_b32 s10, 0xbf317218
    s_mov_b32 s11, 0xbf317218
    s_and_b32 s42, s25, 3
    s_lshl_b32 s42, s42, 13
    s_add_u32 s42, s42, 68480
    v_add_u32 v9, s42, v1
    v_lshrrev_b32 v8, 2, v1
    v_add_u32 v8, 101248, v8
    ds_read_b128 v[96:99], v9 offset:0
    ds_read_b128 v[100:103], v9 offset:1024
    ds_read_b128 v[104:107], v9 offset:2048
    ds_read_b128 v[108:111], v9 offset:3072
    ds_read_b128 v[112:115], v9 offset:4096
    ds_read_b128 v[116:119], v9 offset:5120
    ds_read_b128 v[120:123], v9 offset:6144
    ds_read_b128 v[124:127], v9 offset:7168
    s_mul_i32 s42, s4, 1152
    v_add_u32 v10, s42, v8
    v_pk_mul_f32 v[16:17], v[16:17], s[10:11]
    v_pk_mul_f32 v[18:19], v[18:19], s[10:11]
    v_pk_mul_f32 v[20:21], v[20:21], s[10:11]
    v_pk_mul_f32 v[22:23], v[22:23], s[10:11]
    v_cvt_pk_bf16_f32 v64, v16, v20
    ds_write_b32 v10, v64 offset:0
    v_cvt_pk_bf16_f32 v65, v17, v21
    ds_write_b32 v10, v65 offset:288
    v_cvt_pk_bf16_f32 v66, v18, v22
    ds_write_b32 v10, v66 offset:576
    v_cvt_pk_bf16_f32 v67, v19, v23
    ds_write_b32 v10, v67 offset:864
    s_mul_i32 s42, s5, 1152
    v_add_u32 v10, s42, v8
    v_pk_mul_f32 v[24:25], v[24:25], s[10:11]
    v_pk_mul_f32 v[26:27], v[26:27], s[10:11]
    v_pk_mul_f32 v[28:29], v[28:29], s[10:11]
    v_pk_mul_f32 v[30:31], v[30:31], s[10:11]
    v_cvt_pk_bf16_f32 v68, v24, v28
    ds_write_b32 v10, v68 offset:0
    v_cvt_pk_bf16_f32 v69, v25, v29
    ds_write_b32 v10, v69 offset:288
    v_cvt_pk_bf16_f32 v70, v26, v30
    ds_write_b32 v10, v70 offset:576
    v_cvt_pk_bf16_f32 v71, v27, v31
    ds_write_b32 v10, v71 offset:864
    s_mul_i32 s42, s6, 1152
    v_add_u32 v10, s42, v8
    v_pk_mul_f32 v[32:33], v[32:33], s[10:11]
    v_pk_mul_f32 v[34:35], v[34:35], s[10:11]
    v_pk_mul_f32 v[36:37], v[36:37], s[10:11]
    v_pk_mul_f32 v[38:39], v[38:39], s[10:11]
    v_cvt_pk_bf16_f32 v64, v32, v36
    ds_write_b32 v10, v64 offset:0
    v_cvt_pk_bf16_f32 v65, v33, v37
    ds_write_b32 v10, v65 offset:288
    v_cvt_pk_bf16_f32 v66, v34, v38
    ds_write_b32 v10, v66 offset:576
    v_cvt_pk_bf16_f32 v67, v35, v39
    ds_write_b32 v10, v67 offset:864
    s_mul_i32 s42, s7, 1152
    v_add_u32 v10, s42, v8
    v_pk_mul_f32 v[40:41], v[40:41], s[10:11]
    v_pk_mul_f32 v[42:43], v[42:43], s[10:11]
    v_pk_mul_f32 v[44:45], v[44:45], s[10:11]
    v_pk_mul_f32 v[46:47], v[46:47], s[10:11]
    v_cvt_pk_bf16_f32 v68, v40, v44
    ds_write_b32 v10, v68 offset:0
    v_cvt_pk_bf16_f32 v69, v41, v45
    ds_write_b32 v10, v69 offset:288
    v_cvt_pk_bf16_f32 v70, v42, v46
    ds_write_b32 v10, v70 offset:576
    v_cvt_pk_bf16_f32 v71, v43, v47
    ds_write_b32 v10, v71 offset:864
    s_mul_i32 s42, s8, 1152
    v_add_u32 v10, s42, v8
    v_pk_mul_f32 v[48:49], v[48:49], s[10:11]
    v_pk_mul_f32 v[50:51], v[50:51], s[10:11]
    v_pk_mul_f32 v[52:53], v[52:53], s[10:11]
    v_pk_mul_f32 v[54:55], v[54:55], s[10:11]
    v_cvt_pk_bf16_f32 v64, v48, v52
    ds_write_b32 v10, v64 offset:0
    v_cvt_pk_bf16_f32 v65, v49, v53
    ds_write_b32 v10, v65 offset:288
    v_cvt_pk_bf16_f32 v66, v50, v54
    ds_write_b32 v10, v66 offset:576
    v_cvt_pk_bf16_f32 v67, v51, v55
    ds_write_b32 v10, v67 offset:864
    v_lshrrev_b32 v9, 4, v1
    v_and_b32 v10, 15, v9
    v_lshrrev_b32 v11, 4, v9
    s_lshr_b32 s42, s25, 2
    s_mul_i32 s43, s42, 23040
    s_add_u32 s43, s43, 101248
    v_mul_u32_u24 v8, 288, v10
    v_lshl_add_u32 v8, v11, 4, v8
    v_add_u32 v8, s43, v8
    s_mul_i32 s42, s42, 5242880
    s_lshl_b32 s43, s24, 10
    s_add_u32 s42, s42, s43
    s_and_b32 s43, s25, 3
    s_lshl_b32 s43, s43, 8
    s_add_u32 s42, s42, s43
    v_lshlrev_b32 v11, 18, v11
    v_lshl_add_u32 v11, v10, 4, v11
    v_add_u32 v11, s42, v11
    s_waitcnt lgkmcnt(0)
    s_barrier
    ds_read_b128 v[64:67], v8 offset:0
    ds_read_b128 v[68:71], v8 offset:64
    ds_read_b128 v[72:75], v8 offset:128
    ds_read_b128 v[76:79], v8 offset:192
    ds_read_b128 v[80:83], v8 offset:4608
    ds_read_b128 v[84:87], v8 offset:4672
    ds_read_b128 v[88:91], v8 offset:4736
    ds_read_b128 v[92:95], v8 offset:4800
    s_waitcnt lgkmcnt(7)
    v_mfma_f32_16x16x32_bf16 v[16:19], v[64:67], v[96:99], 0
    v_mfma_f32_16x16x32_bf16 v[20:23], v[64:67], v[112:115], 0
    s_waitcnt lgkmcnt(6)
    v_mfma_f32_16x16x32_bf16 v[16:19], v[68:71], v[100:103], v[16:19]
    v_mfma_f32_16x16x32_bf16 v[20:23], v[68:71], v[116:119], v[20:23]
    s_waitcnt lgkmcnt(5)
    v_mfma_f32_16x16x32_bf16 v[16:19], v[72:75], v[104:107], v[16:19]
    v_mfma_f32_16x16x32_bf16 v[20:23], v[72:75], v[120:123], v[20:23]
    s_waitcnt lgkmcnt(4)
    v_mfma_f32_16x16x32_bf16 v[16:19], v[76:79], v[108:111], v[16:19]
    v_mfma_f32_16x16x32_bf16 v[20:23], v[76:79], v[124:127], v[20:23]
    ds_read_b128 v[64:67], v8 offset:9216
    ds_read_b128 v[68:71], v8 offset:9280
    ds_read_b128 v[72:75], v8 offset:9344
    ds_read_b128 v[76:79], v8 offset:9408
    s_waitcnt lgkmcnt(7)
    v_mfma_f32_16x16x32_bf16 v[24:27], v[80:83], v[96:99], 0
    v_mfma_f32_16x16x32_bf16 v[28:31], v[80:83], v[112:115], 0
    s_waitcnt lgkmcnt(6)
    v_mfma_f32_16x16x32_bf16 v[24:27], v[84:87], v[100:103], v[24:27]
    v_mfma_f32_16x16x32_bf16 v[28:31], v[84:87], v[116:119], v[28:31]
    s_waitcnt lgkmcnt(5)
    v_mfma_f32_16x16x32_bf16 v[24:27], v[88:91], v[104:107], v[24:27]
    v_mfma_f32_16x16x32_bf16 v[28:31], v[88:91], v[120:123], v[28:31]
    s_waitcnt lgkmcnt(4)
    v_mfma_f32_16x16x32_bf16 v[24:27], v[92:95], v[108:111], v[24:27]
    v_mfma_f32_16x16x32_bf16 v[28:31], v[92:95], v[124:127], v[28:31]
    v_cvt_pk_bf16_f32 v128, v16, v17
    v_cvt_pk_bf16_f32 v129, v18, v19
    v_cvt_pk_bf16_f32 v130, v20, v21
    v_cvt_pk_bf16_f32 v131, v22, v23
    buffer_store_dwordx4 v[128:131], v11, s[20:23], 0 offen sc0 sc1
    v_add_u32 v11, 1048576, v11
    ds_read_b128 v[80:83], v8 offset:13824
    ds_read_b128 v[84:87], v8 offset:13888
    ds_read_b128 v[88:91], v8 offset:13952
    ds_read_b128 v[92:95], v8 offset:14016
    s_waitcnt lgkmcnt(7)
    v_mfma_f32_16x16x32_bf16 v[32:35], v[64:67], v[96:99], 0
    v_mfma_f32_16x16x32_bf16 v[36:39], v[64:67], v[112:115], 0
    s_waitcnt lgkmcnt(6)
    v_mfma_f32_16x16x32_bf16 v[32:35], v[68:71], v[100:103], v[32:35]
    v_mfma_f32_16x16x32_bf16 v[36:39], v[68:71], v[116:119], v[36:39]
    s_waitcnt lgkmcnt(5)
    v_mfma_f32_16x16x32_bf16 v[32:35], v[72:75], v[104:107], v[32:35]
    v_mfma_f32_16x16x32_bf16 v[36:39], v[72:75], v[120:123], v[36:39]
    s_waitcnt lgkmcnt(4)
    v_mfma_f32_16x16x32_bf16 v[32:35], v[76:79], v[108:111], v[32:35]
    v_mfma_f32_16x16x32_bf16 v[36:39], v[76:79], v[124:127], v[36:39]
    v_cvt_pk_bf16_f32 v132, v24, v25
    v_cvt_pk_bf16_f32 v133, v26, v27
    v_cvt_pk_bf16_f32 v134, v28, v29
    v_cvt_pk_bf16_f32 v135, v30, v31
    buffer_store_dwordx4 v[132:135], v11, s[20:23], 0 offen sc0 sc1
    v_add_u32 v11, 1048576, v11
    ds_read_b128 v[64:67], v8 offset:18432
    ds_read_b128 v[68:71], v8 offset:18496
    ds_read_b128 v[72:75], v8 offset:18560
    ds_read_b128 v[76:79], v8 offset:18624
    s_waitcnt lgkmcnt(7)
    v_mfma_f32_16x16x32_bf16 v[40:43], v[80:83], v[96:99], 0
    v_mfma_f32_16x16x32_bf16 v[44:47], v[80:83], v[112:115], 0
    s_waitcnt lgkmcnt(6)
    v_mfma_f32_16x16x32_bf16 v[40:43], v[84:87], v[100:103], v[40:43]
    v_mfma_f32_16x16x32_bf16 v[44:47], v[84:87], v[116:119], v[44:47]
    s_waitcnt lgkmcnt(5)
    v_mfma_f32_16x16x32_bf16 v[40:43], v[88:91], v[104:107], v[40:43]
    v_mfma_f32_16x16x32_bf16 v[44:47], v[88:91], v[120:123], v[44:47]
    s_waitcnt lgkmcnt(4)
    v_mfma_f32_16x16x32_bf16 v[40:43], v[92:95], v[108:111], v[40:43]
    v_mfma_f32_16x16x32_bf16 v[44:47], v[92:95], v[124:127], v[44:47]
    v_cvt_pk_bf16_f32 v128, v32, v33
    v_cvt_pk_bf16_f32 v129, v34, v35
    v_cvt_pk_bf16_f32 v130, v36, v37
    v_cvt_pk_bf16_f32 v131, v38, v39
    buffer_store_dwordx4 v[128:131], v11, s[20:23], 0 offen sc0 sc1
    v_add_u32 v11, 1048576, v11
    s_waitcnt lgkmcnt(3)
    v_mfma_f32_16x16x32_bf16 v[48:51], v[64:67], v[96:99], 0
    v_mfma_f32_16x16x32_bf16 v[52:55], v[64:67], v[112:115], 0
    s_waitcnt lgkmcnt(2)
    v_mfma_f32_16x16x32_bf16 v[48:51], v[68:71], v[100:103], v[48:51]
    v_mfma_f32_16x16x32_bf16 v[52:55], v[68:71], v[116:119], v[52:55]
    s_waitcnt lgkmcnt(1)
    v_mfma_f32_16x16x32_bf16 v[48:51], v[72:75], v[104:107], v[48:51]
    v_mfma_f32_16x16x32_bf16 v[52:55], v[72:75], v[120:123], v[52:55]
    s_waitcnt lgkmcnt(0)
    v_mfma_f32_16x16x32_bf16 v[48:51], v[76:79], v[108:111], v[48:51]
    v_mfma_f32_16x16x32_bf16 v[52:55], v[76:79], v[124:127], v[52:55]
    v_cvt_pk_bf16_f32 v132, v40, v41
    v_cvt_pk_bf16_f32 v133, v42, v43
    v_cvt_pk_bf16_f32 v134, v44, v45
    v_cvt_pk_bf16_f32 v135, v46, v47
    buffer_store_dwordx4 v[132:135], v11, s[20:23], 0 offen sc0 sc1
    v_add_u32 v11, 1048576, v11
    s_nop 7
    v_cvt_pk_bf16_f32 v128, v48, v49
    v_cvt_pk_bf16_f32 v129, v50, v51
    v_cvt_pk_bf16_f32 v130, v52, v53
    v_cvt_pk_bf16_f32 v131, v54, v55
    buffer_store_dwordx4 v[128:131], v11, s[20:23], 0 offen sc0 sc1
K2_END:
    s_endpgm
.section .rodata,"a"
.p2align 6
.amdhsa_kernel bin_kernel
  .amdhsa_next_free_vgpr 64
  .amdhsa_next_free_sgpr 48
  .amdhsa_accum_offset 64
  .amdhsa_group_segment_fixed_size 0
  .amdhsa_kernarg_size 88
  .amdhsa_user_sgpr_count 2
  .amdhsa_user_sgpr_kernarg_segment_ptr 1
  .amdhsa_system_sgpr_workgroup_id_x 1
  .amdhsa_float_denorm_mode_32 3
.end_amdhsa_kernel
.section .rodata,"a"
.p2align 6
.amdhsa_kernel main_kernel
  .amdhsa_next_free_vgpr 192
  .amdhsa_next_free_sgpr 100
  .amdhsa_accum_offset 192
  .amdhsa_group_segment_fixed_size 0
  .amdhsa_kernarg_size 88
  .amdhsa_user_sgpr_count 2
  .amdhsa_user_sgpr_kernarg_segment_ptr 1
  .amdhsa_system_sgpr_workgroup_id_x 1
  .amdhsa_float_denorm_mode_32 3
.end_amdhsa_kernel
```

```asm
; @launch grid=(256,1,1) block=(512,1,1) lds=163840
.amdgcn_target "amdgcn-amd-amdhsa--gfx950"
.text
.globl gather_scatter__tensor_product_equiv_tfn__graph_kernel
.p2align 8
.type gather_scatter__tensor_product_equiv_tfn__graph_kernel,@function
gather_scatter__tensor_product_equiv_tfn__graph_kernel:
    s_cmp_ge_u32 s2, 256
    s_cbranch_scc1 END
    s_load_dwordx16 s[40:55], s[0:1], 0
    s_load_dwordx4 s[56:59], s[0:1], 64
    s_load_dwordx2 s[16:17], s[0:1], 80
    s_load_dwordx2 s[12:13], s[0:1], 0
    s_load_dwordx2 s[20:21], s[0:1], 64
    s_and_b32 s4, s2, 7
    s_lshl_b32 s4, s4, 5
    s_lshr_b32 s5, s2, 3
    s_or_b32 s24, s4, s5
    v_lshrrev_b32 v8, 6, v0
    v_and_b32 v9, 63, v0
    v_lshlrev_b32 v1, 4, v9
    v_readfirstlane_b32 s25, v8
    v_lshlrev_b32 v11, 3, v0
    v_mov_b32 v12, 0
    v_mov_b32 v13, 0
    ds_write_b64 v11, v[12:13]
    v_mov_b32 v15, 1
    s_mov_b32 s14, 10240000
    s_mov_b32 s15, 0x20000
    s_mov_b32 s18, 7077888
    s_mov_b32 s19, 0x20000
    s_mov_b32 s22, 10240000
    s_mov_b32 s23, 0x20000
    s_mov_b32 s34, 0xfffffc00
    s_mov_b32 s27, 0
    s_mov_b32 s10, 0xbfb8aa3b
    s_mov_b32 s11, 0xbfb8aa3b
    v_mul_u32_u24 v14, 52, v9
    v_lshrrev_b32 v14, 8, v14
    v_mul_u32_u24 v7, 5, v14
    v_sub_u32 v7, v9, v7
    v_lshlrev_b32 v14, 2, v14
    v_lshlrev_b32 v7, 2, v7
    s_mov_b32 s35, 2097152
    v_mov_b32 v16, 0
    v_mov_b32 v17, 0
    v_mov_b32 v18, 0
    v_mov_b32 v19, 0
    v_mov_b32 v20, 0
    v_mov_b32 v21, 0
    v_mov_b32 v22, 0
    v_mov_b32 v23, 0
    v_mov_b32 v24, 0
    v_mov_b32 v25, 0
    v_mov_b32 v26, 0
    v_mov_b32 v27, 0
    v_mov_b32 v28, 0
    v_mov_b32 v29, 0
    v_mov_b32 v30, 0
    v_mov_b32 v31, 0
    v_mov_b32 v32, 0
    v_mov_b32 v33, 0
    v_mov_b32 v34, 0
    v_mov_b32 v35, 0
    v_mov_b32 v36, 0
    v_mov_b32 v37, 0
    v_mov_b32 v38, 0
    v_mov_b32 v39, 0
    v_mov_b32 v40, 0
    v_mov_b32 v41, 0
    v_mov_b32 v42, 0
    v_mov_b32 v43, 0
    v_mov_b32 v44, 0
    v_mov_b32 v45, 0
    v_mov_b32 v46, 0
    v_mov_b32 v47, 0
    v_mov_b32 v48, 0
    v_mov_b32 v49, 0
    v_mov_b32 v50, 0
    v_mov_b32 v51, 0
    v_mov_b32 v52, 0
    v_mov_b32 v53, 0
    v_mov_b32 v54, 0
    v_mov_b32 v55, 0
    v_mov_b32 v56, 0
    v_mov_b32 v57, 0
    v_mov_b32 v58, 0
    v_mov_b32 v59, 0
    v_mov_b32 v60, 0
    v_mov_b32 v61, 0
    v_mov_b32 v62, 0
    v_mov_b32 v63, 0
    s_cmp_ge_u32 s2, 250
    s_cbranch_scc1 AUX
    s_cmp_ge_u32 s25, 5
    s_cbranch_scc1 HELP
    s_mul_i32 s3, s2, 5120
    v_lshl_add_u32 v8, v0, 4, s3
    v_lshlrev_b32 v9, 1, v8
    s_waitcnt lgkmcnt(0)
    global_load_dwordx4 v[64:67], v8, s[44:45]
    global_load_dwordx4 v[68:71], v8, s[42:43]
    global_load_dwordx4 v[72:75], v9, s[46:47]
    global_load_dwordx4 v[76:79], v9, s[46:47] offset:16
    global_load_dwordx4 v[80:83], v9, s[48:49]
    global_load_dwordx4 v[84:87], v9, s[48:49] offset:16
    s_barrier
    s_mul_i32 s62, s25, 3
    s_mov_b32 s63, 3
LUT_W:
    s_lshl_b32 s3, s62, 25
    s_add_u32 s3, s3, 0x8000
    v_lshl_add_u32 v128, v1, 15, s3
    v_add_u32 v129, 65536, v128
    v_add_u32 v130, 131072, v128
    v_add_u32 v131, 196608, v128
    v_add_u32 v132, 262144, v128
    v_add_u32 v133, 327680, v128
    v_add_u32 v134, 393216, v128
    v_add_u32 v135, 458752, v128
    v_pk_mul_f32 v[136:137], v[128:129], s[10:11]
    v_pk_mul_f32 v[138:139], v[130:131], s[10:11]
    v_pk_mul_f32 v[140:141], v[132:133], s[10:11]
    v_pk_mul_f32 v[142:143], v[134:135], s[10:11]
    v_exp_f32 v136, v136
    v_exp_f32 v137, v137
    v_exp_f32 v138, v138
    v_exp_f32 v139, v139
    v_exp_f32 v140, v140
    v_exp_f32 v141, v141
    v_exp_f32 v142, v142
    v_exp_f32 v143, v143
    s_lshl_b32 s3, s62, 10
    v_pk_add_f32 v[144:145], v[136:137], 1.0 op_sel_hi:[1,0]
    v_pk_add_f32 v[146:147], v[138:139], 1.0 op_sel_hi:[1,0]
    v_pk_add_f32 v[148:149], v[140:141], 1.0 op_sel_hi:[1,0]
    v_pk_add_f32 v[150:151], v[142:143], 1.0 op_sel_hi:[1,0]
    v_rcp_f32 v144, v144
    v_rcp_f32 v145, v145
    v_rcp_f32 v146, v146
    v_rcp_f32 v147, v147
    v_rcp_f32 v148, v148
    v_rcp_f32 v149, v149
    v_rcp_f32 v150, v150
    v_rcp_f32 v151, v151
    v_add_u32 v160, s3, v1
    v_pk_mul_f32 v[128:129], v[128:129], v[144:145]
    v_pk_mul_f32 v[130:131], v[130:131], v[146:147]
    v_pk_mul_f32 v[132:133], v[132:133], v[148:149]
    v_pk_mul_f32 v[134:135], v[134:135], v[150:151]
    v_add_u32 v161, 0x10000, v160
    v_pk_mul_f32 v[136:137], v[128:129], v[136:137] neg_lo:[1,0] neg_hi:[1,0]
    v_pk_mul_f32 v[138:139], v[130:131], v[138:139] neg_lo:[1,0] neg_hi:[1,0]
    v_pk_mul_f32 v[140:141], v[132:133], v[140:141] neg_lo:[1,0] neg_hi:[1,0]
    v_pk_mul_f32 v[142:143], v[134:135], v[142:143] neg_lo:[1,0] neg_hi:[1,0]
    v_cvt_pk_bf16_f32 v152, v128, v129
    v_cvt_pk_bf16_f32 v153, v130, v131
    v_cvt_pk_bf16_f32 v154, v132, v133
    v_cvt_pk_bf16_f32 v155, v134, v135
    v_cvt_pk_bf16_f32 v156, v136, v137
    v_cvt_pk_bf16_f32 v157, v138, v139
    v_cvt_pk_bf16_f32 v158, v140, v141
    v_cvt_pk_bf16_f32 v159, v142, v143
    ds_write_b128 v160, v[152:155] offset:32768
    ds_write_b128 v161, v[156:159] offset:32768
    s_add_u32 s62, s62, 1
    s_sub_u32 s63, s63, 1
    s_cmp_lg_u32 s63, 0
    s_cbranch_scc1 LUT_W
    s_waitcnt vmcnt(5)
    v_and_b32 v88, 0xff, v64
    v_lshlrev_b32 v88, 2, v88
    ds_add_rtn_u32 v92, v88, v15 offset:2304
    v_and_b32 v89, 0xff, v65
    v_lshlrev_b32 v89, 2, v89
    ds_add_rtn_u32 v93, v89, v15 offset:2304
    v_and_b32 v90, 0xff, v66
    v_lshlrev_b32 v90, 2, v90
    ds_add_rtn_u32 v94, v90, v15 offset:2304
    v_and_b32 v91, 0xff, v67
    v_lshlrev_b32 v91, 2, v91
    ds_add_rtn_u32 v95, v91, v15 offset:2304
    s_waitcnt vmcnt(4)
    v_lshrrev_b32 v64, 8, v64
    v_lshl_or_b32 v64, v68, 10, v64
    v_lshrrev_b32 v65, 8, v65
    v_lshl_or_b32 v65, v69, 10, v65
    v_lshrrev_b32 v66, 8, v66
    v_lshl_or_b32 v66, v70, 10, v66
    v_lshrrev_b32 v67, 8, v67
    v_lshl_or_b32 v67, v71, 10, v67
    s_waitcnt lgkmcnt(0)
    s_barrier
    ds_read_b128 v[96:99], v1 offset:2304
    s_waitcnt lgkmcnt(0)
    v_add_u32 v10, v96, v97
    v_add3_u32 v10, v10, v98, v99
    v_mov_b32 v11, v10
    s_nop 1
    v_add_u32_dpp v11, v11, v11 row_shr:1 row_mask:0xf bank_mask:0xf bound_ctrl:0
    s_nop 1
    v_add_u32_dpp v11, v11, v11 row_shr:2 row_mask:0xf bank_mask:0xf bound_ctrl:0
    s_nop 1
    v_add_u32_dpp v11, v11, v11 row_shr:4 row_mask:0xf bank_mask:0xf bound_ctrl:0
    s_nop 1
    v_add_u32_dpp v11, v11, v11 row_shr:8 row_mask:0xf bank_mask:0xf bound_ctrl:0
    s_nop 1
    v_add_u32_dpp v11, v11, v11 row_bcast:15 row_mask:0xa bank_mask:0xf
    s_nop 1
    v_add_u32_dpp v11, v11, v11 row_bcast:31 row_mask:0xc bank_mask:0xf
    v_sub_u32 v100, v11, v10
    v_add_u32 v101, v100, v96
    v_add_u32 v102, v101, v97
    v_add_u32 v103, v102, v98
    ds_write_b128 v1, v[100:103] offset:3328
    v_lshl_or_b32 v108, v96, 11, v100
    v_lshl_or_b32 v110, v97, 11, v101
    v_lshl_or_b32 v112, v98, 11, v102
    v_lshl_or_b32 v114, v99, 11, v103
    ds_read_b32 v96, v88 offset:3328
    ds_read_b32 v97, v89 offset:3328
    ds_read_b32 v98, v90 offset:3328
    ds_read_b32 v99, v91 offset:3328
    s_waitcnt lgkmcnt(3)
    v_add_u32 v92, v92, v96
    v_lshlrev_b32 v88, 2, v92
    v_lshlrev_b32 v92, 4, v92
    s_waitcnt lgkmcnt(2)
    v_add_u32 v93, v93, v97
    v_lshlrev_b32 v89, 2, v93
    v_lshlrev_b32 v93, 4, v93
    s_waitcnt lgkmcnt(1)
    v_add_u32 v94, v94, v98
    v_lshlrev_b32 v90, 2, v94
    v_lshlrev_b32 v94, 4, v94
    s_waitcnt lgkmcnt(0)
    v_add_u32 v95, v95, v99
    v_lshlrev_b32 v91, 2, v95
    v_lshlrev_b32 v95, 4, v95
    ds_write_b32 v88, v64 offset:4352
    ds_write_b32 v89, v65 offset:4352
    ds_write_b32 v90, v66 offset:4352
    ds_write_b32 v91, v67 offset:4352
    s_waitcnt vmcnt(0)
    v_add_u32 v92, 9472, v92
    ds_write2_b64 v92, v[72:73], v[80:81] offset0:0 offset1:1
    v_add_u32 v93, 9472, v93
    ds_write2_b64 v93, v[74:75], v[82:83] offset0:0 offset1:1
    v_add_u32 v94, 9472, v94
    ds_write2_b64 v94, v[76:77], v[84:85] offset0:0 offset1:1
    v_add_u32 v95, 9472, v95
    ds_write2_b64 v95, v[78:79], v[86:87] offset0:0 offset1:1
    v_lshlrev_b32 v10, 4, v0
    s_mul_i32 s3, s2, 20480
    s_add_u32 s3, s3, 1310720
    v_add_u32 v9, s3, v10
    s_waitcnt lgkmcnt(0)
    s_barrier
    ds_read_b128 v[64:67], v10 offset:4352
    ds_read_b128 v[68:71], v10 offset:9472
    ds_read_b128 v[72:75], v10 offset:14592
    ds_read_b128 v[76:79], v10 offset:19712
    ds_read_b128 v[80:83], v10 offset:24832
    s_waitcnt lgkmcnt(4)
    global_store_dwordx4 v8, v[64:67], s[16:17] sc0 sc1
    s_waitcnt lgkmcnt(3)
    global_store_dwordx4 v9, v[68:71], s[16:17] sc0 sc1
    v_add_u32 v9, 5120, v9
    s_waitcnt lgkmcnt(2)
    global_store_dwordx4 v9, v[72:75], s[16:17] sc0 sc1
    v_add_u32 v9, 5120, v9
    s_waitcnt lgkmcnt(1)
    global_store_dwordx4 v9, v[76:79], s[16:17] sc0 sc1
    v_add_u32 v9, 5120, v9
    s_waitcnt lgkmcnt(0)
    global_store_dwordx4 v9, v[80:83], s[16:17] sc0 sc1
    s_branch PUBLISH
HELP:
    s_waitcnt lgkmcnt(0)
    s_cmp_lg_u32 s2, 0
    s_cbranch_scc1 NO_NONCE
    s_cmp_lg_u32 s25, 7
    s_cbranch_scc1 NO_NONCE
    s_memrealtime s[4:5]
    v_mov_b32 v8, 0
    s_waitcnt lgkmcnt(0)
    s_and_b32 s5, s5, 0x3ff
    s_bitset1_b32 s5, 31
    v_mov_b32 v10, s4
    v_mov_b32 v11, s5
    s_mov_b64 exec, 1
    global_store_dwordx2 v8, v[10:11], s[58:59] sc0 sc1
    s_mov_b64 exec, -1
NO_NONCE:
    s_barrier
    s_mul_i32 s62, s25, 11
    s_sub_u32 s62, s62, 40
    s_mov_b32 s63, 5
LUT_A:
    s_lshl_b32 s3, s62, 25
    s_add_u32 s3, s3, 0x8000
    v_lshl_add_u32 v128, v1, 15, s3
    v_add_u32 v129, 65536, v128
    v_add_u32 v130, 131072, v128
    v_add_u32 v131, 196608, v128
    v_add_u32 v132, 262144, v128
    v_add_u32 v133, 327680, v128
    v_add_u32 v134, 393216, v128
    v_add_u32 v135, 458752, v128
    v_pk_mul_f32 v[136:137], v[128:129], s[10:11]
    v_pk_mul_f32 v[138:139], v[130:131], s[10:11]
    v_pk_mul_f32 v[140:141], v[132:133], s[10:11]
    v_pk_mul_f32 v[142:143], v[134:135], s[10:11]
    v_exp_f32 v136, v136
    v_exp_f32 v137, v137
    v_exp_f32 v138, v138
    v_exp_f32 v139, v139
    v_exp_f32 v140, v140
    v_exp_f32 v141, v141
    v_exp_f32 v142, v142
    v_exp_f32 v143, v143
    s_lshl_b32 s3, s62, 10
    v_pk_add_f32 v[144:145], v[136:137], 1.0 op_sel_hi:[1,0]
    v_pk_add_f32 v[146:147], v[138:139], 1.0 op_sel_hi:[1,0]
    v_pk_add_f32 v[148:149], v[140:141], 1.0 op_sel_hi:[1,0]
    v_pk_add_f32 v[150:151], v[142:143], 1.0 op_sel_hi:[1,0]
    v_rcp_f32 v144, v144
    v_rcp_f32 v145, v145
    v_rcp_f32 v146, v146
    v_rcp_f32 v147, v147
    v_rcp_f32 v148, v148
    v_rcp_f32 v149, v149
    v_rcp_f32 v150, v150
    v_rcp_f32 v151, v151
    v_add_u32 v160, s3, v1
    v_pk_mul_f32 v[128:129], v[128:129], v[144:145]
    v_pk_mul_f32 v[130:131], v[130:131], v[146:147]
    v_pk_mul_f32 v[132:133], v[132:133], v[148:149]
    v_pk_mul_f32 v[134:135], v[134:135], v[150:151]
    v_add_u32 v161, 0x10000, v160
    v_pk_mul_f32 v[136:137], v[128:129], v[136:137] neg_lo:[1,0] neg_hi:[1,0]
    v_pk_mul_f32 v[138:139], v[130:131], v[138:139] neg_lo:[1,0] neg_hi:[1,0]
    v_pk_mul_f32 v[140:141], v[132:133], v[140:141] neg_lo:[1,0] neg_hi:[1,0]
    v_pk_mul_f32 v[142:143], v[134:135], v[142:143] neg_lo:[1,0] neg_hi:[1,0]
    v_cvt_pk_bf16_f32 v152, v128, v129
    v_cvt_pk_bf16_f32 v153, v130, v131
    v_cvt_pk_bf16_f32 v154, v132, v133
    v_cvt_pk_bf16_f32 v155, v134, v135
    v_cvt_pk_bf16_f32 v156, v136, v137
    v_cvt_pk_bf16_f32 v157, v138, v139
    v_cvt_pk_bf16_f32 v158, v140, v141
    v_cvt_pk_bf16_f32 v159, v142, v143
    ds_write_b128 v160, v[152:155] offset:32768
    ds_write_b128 v161, v[156:159] offset:32768
    s_add_u32 s62, s62, 1
    s_sub_u32 s63, s63, 1
    s_cmp_lg_u32 s63, 0
    s_cbranch_scc1 LUT_A
    s_barrier
    s_mov_b32 s63, 2
LUT_B:
    s_lshl_b32 s3, s62, 25
    s_add_u32 s3, s3, 0x8000
    v_lshl_add_u32 v128, v1, 15, s3
    v_add_u32 v129, 65536, v128
    v_add_u32 v130, 131072, v128
    v_add_u32 v131, 196608, v128
    v_add_u32 v132, 262144, v128
    v_add_u32 v133, 327680, v128
    v_add_u32 v134, 393216, v128
    v_add_u32 v135, 458752, v128
    v_pk_mul_f32 v[136:137], v[128:129], s[10:11]
    v_pk_mul_f32 v[138:139], v[130:131], s[10:11]
    v_pk_mul_f32 v[140:141], v[132:133], s[10:11]
    v_pk_mul_f32 v[142:143], v[134:135], s[10:11]
    v_exp_f32 v136, v136
    v_exp_f32 v137, v137
    v_exp_f32 v138, v138
    v_exp_f32 v139, v139
    v_exp_f32 v140, v140
    v_exp_f32 v141, v141
    v_exp_f32 v142, v142
    v_exp_f32 v143, v143
    s_lshl_b32 s3, s62, 10
    v_pk_add_f32 v[144:145], v[136:137], 1.0 op_sel_hi:[1,0]
    v_pk_add_f32 v[146:147], v[138:139], 1.0 op_sel_hi:[1,0]
    v_pk_add_f32 v[148:149], v[140:141], 1.0 op_sel_hi:[1,0]
    v_pk_add_f32 v[150:151], v[142:143], 1.0 op_sel_hi:[1,0]
    v_rcp_f32 v144, v144
    v_rcp_f32 v145, v145
    v_rcp_f32 v146, v146
    v_rcp_f32 v147, v147
    v_rcp_f32 v148, v148
    v_rcp_f32 v149, v149
    v_rcp_f32 v150, v150
    v_rcp_f32 v151, v151
    v_add_u32 v160, s3, v1
    v_pk_mul_f32 v[128:129], v[128:129], v[144:145]
    v_pk_mul_f32 v[130:131], v[130:131], v[146:147]
    v_pk_mul_f32 v[132:133], v[132:133], v[148:149]
    v_pk_mul_f32 v[134:135], v[134:135], v[150:151]
    v_add_u32 v161, 0x10000, v160
    v_pk_mul_f32 v[136:137], v[128:129], v[136:137] neg_lo:[1,0] neg_hi:[1,0]
    v_pk_mul_f32 v[138:139], v[130:131], v[138:139] neg_lo:[1,0] neg_hi:[1,0]
    v_pk_mul_f32 v[140:141], v[132:133], v[140:141] neg_lo:[1,0] neg_hi:[1,0]
    v_pk_mul_f32 v[142:143], v[134:135], v[142:143] neg_lo:[1,0] neg_hi:[1,0]
    v_cvt_pk_bf16_f32 v152, v128, v129
    v_cvt_pk_bf16_f32 v153, v130, v131
    v_cvt_pk_bf16_f32 v154, v132, v133
    v_cvt_pk_bf16_f32 v155, v134, v135
    v_cvt_pk_bf16_f32 v156, v136, v137
    v_cvt_pk_bf16_f32 v157, v138, v139
    v_cvt_pk_bf16_f32 v158, v140, v141
    v_cvt_pk_bf16_f32 v159, v142, v143
    ds_write_b128 v160, v[152:155] offset:32768
    ds_write_b128 v161, v[156:159] offset:32768
    s_add_u32 s62, s62, 1
    s_sub_u32 s63, s63, 1
    s_cmp_lg_u32 s63, 0
    s_cbranch_scc1 LUT_B
    s_barrier
    s_mov_b32 s63, 4
LUT_C:
    s_lshl_b32 s3, s62, 25
    s_add_u32 s3, s3, 0x8000
    v_lshl_add_u32 v128, v1, 15, s3
    v_add_u32 v129, 65536, v128
    v_add_u32 v130, 131072, v128
    v_add_u32 v131, 196608, v128
    v_add_u32 v132, 262144, v128
    v_add_u32 v133, 327680, v128
    v_add_u32 v134, 393216, v128
    v_add_u32 v135, 458752, v128
    v_pk_mul_f32 v[136:137], v[128:129], s[10:11]
    v_pk_mul_f32 v[138:139], v[130:131], s[10:11]
    v_pk_mul_f32 v[140:141], v[132:133], s[10:11]
    v_pk_mul_f32 v[142:143], v[134:135], s[10:11]
    v_exp_f32 v136, v136
    v_exp_f32 v137, v137
    v_exp_f32 v138, v138
    v_exp_f32 v139, v139
    v_exp_f32 v140, v140
    v_exp_f32 v141, v141
    v_exp_f32 v142, v142
    v_exp_f32 v143, v143
    s_lshl_b32 s3, s62, 10
    v_pk_add_f32 v[144:145], v[136:137], 1.0 op_sel_hi:[1,0]
    v_pk_add_f32 v[146:147], v[138:139], 1.0 op_sel_hi:[1,0]
    v_pk_add_f32 v[148:149], v[140:141], 1.0 op_sel_hi:[1,0]
    v_pk_add_f32 v[150:151], v[142:143], 1.0 op_sel_hi:[1,0]
    v_rcp_f32 v144, v144
    v_rcp_f32 v145, v145
    v_rcp_f32 v146, v146
    v_rcp_f32 v147, v147
    v_rcp_f32 v148, v148
    v_rcp_f32 v149, v149
    v_rcp_f32 v150, v150
    v_rcp_f32 v151, v151
    v_add_u32 v160, s3, v1
    v_pk_mul_f32 v[128:129], v[128:129], v[144:145]
    v_pk_mul_f32 v[130:131], v[130:131], v[146:147]
    v_pk_mul_f32 v[132:133], v[132:133], v[148:149]
    v_pk_mul_f32 v[134:135], v[134:135], v[150:151]
    v_add_u32 v161, 0x10000, v160
    v_pk_mul_f32 v[136:137], v[128:129], v[136:137] neg_lo:[1,0] neg_hi:[1,0]
    v_pk_mul_f32 v[138:139], v[130:131], v[138:139] neg_lo:[1,0] neg_hi:[1,0]
    v_pk_mul_f32 v[140:141], v[132:133], v[140:141] neg_lo:[1,0] neg_hi:[1,0]
    v_pk_mul_f32 v[142:143], v[134:135], v[142:143] neg_lo:[1,0] neg_hi:[1,0]
    v_cvt_pk_bf16_f32 v152, v128, v129
    v_cvt_pk_bf16_f32 v153, v130, v131
    v_cvt_pk_bf16_f32 v154, v132, v133
    v_cvt_pk_bf16_f32 v155, v134, v135
    v_cvt_pk_bf16_f32 v156, v136, v137
    v_cvt_pk_bf16_f32 v157, v138, v139
    v_cvt_pk_bf16_f32 v158, v140, v141
    v_cvt_pk_bf16_f32 v159, v142, v143
    ds_write_b128 v160, v[152:155] offset:32768
    ds_write_b128 v161, v[156:159] offset:32768
    s_add_u32 s62, s62, 1
    s_sub_u32 s63, s63, 1
    s_cmp_lg_u32 s63, 0
    s_cbranch_scc1 LUT_C
    s_branch PUBLISH
AUX:
    v_lshrrev_b32 v8, 4, v1
    s_waitcnt lgkmcnt(0)
    s_cmp_ge_u32 s2, 254
    s_cbranch_scc1 AUX_CONST
    s_cmp_ge_u32 s25, 4
    s_cbranch_scc1 AUX_DONE
    s_sub_u32 s4, s2, 250
    s_lshl_b32 s5, s25, 13
    s_lshl_b32 s6, s4, 6
    s_add_u32 s5, s5, s6
    v_lshrrev_b32 v9, 4, v8
    v_lshlrev_b32 v9, 11, v9
    v_and_b32 v10, 15, v8
    v_lshl_add_u32 v9, v10, 2, v9
    v_add_u32 v9, s5, v9
    s_lshl_b32 s5, s4, 13
    s_lshl_b32 s6, s25, 10
    s_add_u32 s5, s5, s6
    s_add_u32 s5, s5, 6492160
    v_add_u32 v10, s5, v1
    s_mov_b32 s4, 0x05040100
    s_mov_b32 s5, 0x07060302
    global_load_dword v64, v9, s[54:55] offset:0
    global_load_dword v65, v9, s[54:55] offset:256
    global_load_dword v66, v9, s[54:55] offset:512
    global_load_dword v67, v9, s[54:55] offset:768
    global_load_dword v68, v9, s[54:55] offset:1024
    global_load_dword v69, v9, s[54:55] offset:1280
    global_load_dword v70, v9, s[54:55] offset:1536
    global_load_dword v71, v9, s[54:55] offset:1792
    s_waitcnt vmcnt(0)
    v_perm_b32 v72, v65, v64, s4
    v_perm_b32 v76, v65, v64, s5
    v_perm_b32 v73, v67, v66, s4
    v_perm_b32 v77, v67, v66, s5
    v_perm_b32 v74, v69, v68, s4
    v_perm_b32 v78, v69, v68, s5
    v_perm_b32 v75, v71, v70, s4
    v_perm_b32 v79, v71, v70, s5
    global_store_dwordx4 v10, v[72:75], s[16:17] sc0 sc1
    v_add_u32 v10, 4096, v10
    global_store_dwordx4 v10, v[76:79], s[16:17] sc0 sc1
    s_branch AUX_DONE
AUX_CONST:
    s_cmp_lg_u32 s2, 254
    s_cbranch_scc1 AUX_DONE
    s_cmp_lg_u32 s25, 0
    s_cbranch_scc1 AUX_DONE
    v_lshlrev_b32 v9, 2, v8
    v_and_b32 v10, 3, v8
    v_lshlrev_b32 v10, 1, v10
    v_add_u32 v11, 6488064, v1
    s_mov_b32 s4, 0x05040100
    s_mov_b32 s5, 0x07060302
    global_load_dword v64, v9, s[50:51] offset:0
    global_load_dword v65, v9, s[50:51] offset:256
    global_load_dword v66, v9, s[50:51] offset:512
    global_load_dword v67, v9, s[50:51] offset:768
    global_load_ushort v72, v10, s[52:53] offset:0
    global_load_ushort v73, v10, s[52:53] offset:8
    global_load_ushort v74, v10, s[52:53] offset:16
    global_load_ushort v75, v10, s[52:53] offset:24
    global_load_ushort v76, v10, s[52:53] offset:32
    global_load_ushort v77, v10, s[52:53] offset:40
    global_load_ushort v78, v10, s[52:53] offset:48
    global_load_ushort v79, v10, s[52:53] offset:56
    global_load_ushort v80, v10, s[52:53] offset:64
    global_load_ushort v81, v10, s[52:53] offset:72
    global_load_ushort v82, v10, s[52:53] offset:80
    global_load_ushort v83, v10, s[52:53] offset:88
    global_load_ushort v84, v10, s[52:53] offset:96
    global_load_ushort v85, v10, s[52:53] offset:104
    global_load_ushort v86, v10, s[52:53] offset:112
    global_load_ushort v87, v10, s[52:53] offset:120
    s_waitcnt vmcnt(0)
    v_perm_b32 v68, v65, v64, s4
    v_perm_b32 v70, v65, v64, s5
    v_perm_b32 v69, v67, v66, s4
    v_perm_b32 v71, v67, v66, s5
    v_lshl_or_b32 v88, v73, 16, v72
    v_lshl_or_b32 v89, v75, 16, v74
    v_lshl_or_b32 v90, v77, 16, v76
    v_lshl_or_b32 v91, v79, 16, v78
    v_lshl_or_b32 v92, v81, 16, v80
    v_lshl_or_b32 v93, v83, 16, v82
    v_lshl_or_b32 v94, v85, 16, v84
    v_lshl_or_b32 v95, v87, 16, v86
    global_store_dwordx4 v11, v[68:71], s[16:17] sc0 sc1
    global_store_dwordx4 v11, v[88:91], s[16:17] offset:1024 sc0 sc1
    global_store_dwordx4 v11, v[92:95], s[16:17] offset:2048 sc0 sc1
AUX_DONE:
    v_mov_b32 v108, 0
    v_mov_b32 v110, 0
    v_mov_b32 v112, 0
    v_mov_b32 v114, 0
    s_mul_i32 s62, s25, 6
    s_mov_b32 s63, 6
LUT_X:
    s_lshl_b32 s3, s62, 25
    s_add_u32 s3, s3, 0x8000
    v_lshl_add_u32 v128, v1, 15, s3
    v_add_u32 v129, 65536, v128
    v_add_u32 v130, 131072, v128
    v_add_u32 v131, 196608, v128
    v_add_u32 v132, 262144, v128
    v_add_u32 v133, 327680, v128
    v_add_u32 v134, 393216, v128
    v_add_u32 v135, 458752, v128
    v_pk_mul_f32 v[136:137], v[128:129], s[10:11]
    v_pk_mul_f32 v[138:139], v[130:131], s[10:11]
    v_pk_mul_f32 v[140:141], v[132:133], s[10:11]
    v_pk_mul_f32 v[142:143], v[134:135], s[10:11]
    v_exp_f32 v136, v136
    v_exp_f32 v137, v137
    v_exp_f32 v138, v138
    v_exp_f32 v139, v139
    v_exp_f32 v140, v140
    v_exp_f32 v141, v141
    v_exp_f32 v142, v142
    v_exp_f32 v143, v143
    s_lshl_b32 s3, s62, 10
    v_pk_add_f32 v[144:145], v[136:137], 1.0 op_sel_hi:[1,0]
    v_pk_add_f32 v[146:147], v[138:139], 1.0 op_sel_hi:[1,0]
    v_pk_add_f32 v[148:149], v[140:141], 1.0 op_sel_hi:[1,0]
    v_pk_add_f32 v[150:151], v[142:143], 1.0 op_sel_hi:[1,0]
    v_rcp_f32 v144, v144
    v_rcp_f32 v145, v145
    v_rcp_f32 v146, v146
    v_rcp_f32 v147, v147
    v_rcp_f32 v148, v148
    v_rcp_f32 v149, v149
    v_rcp_f32 v150, v150
    v_rcp_f32 v151, v151
    v_add_u32 v160, s3, v1
    v_pk_mul_f32 v[128:129], v[128:129], v[144:145]
    v_pk_mul_f32 v[130:131], v[130:131], v[146:147]
    v_pk_mul_f32 v[132:133], v[132:133], v[148:149]
    v_pk_mul_f32 v[134:135], v[134:135], v[150:151]
    v_add_u32 v161, 0x10000, v160
    v_pk_mul_f32 v[136:137], v[128:129], v[136:137] neg_lo:[1,0] neg_hi:[1,0]
    v_pk_mul_f32 v[138:139], v[130:131], v[138:139] neg_lo:[1,0] neg_hi:[1,0]
    v_pk_mul_f32 v[140:141], v[132:133], v[140:141] neg_lo:[1,0] neg_hi:[1,0]
    v_pk_mul_f32 v[142:143], v[134:135], v[142:143] neg_lo:[1,0] neg_hi:[1,0]
    v_cvt_pk_bf16_f32 v152, v128, v129
    v_cvt_pk_bf16_f32 v153, v130, v131
    v_cvt_pk_bf16_f32 v154, v132, v133
    v_cvt_pk_bf16_f32 v155, v134, v135
    v_cvt_pk_bf16_f32 v156, v136, v137
    v_cvt_pk_bf16_f32 v157, v138, v139
    v_cvt_pk_bf16_f32 v158, v140, v141
    v_cvt_pk_bf16_f32 v159, v142, v143
    ds_write_b128 v160, v[152:155] offset:32768
    ds_write_b128 v161, v[156:159] offset:32768
    s_add_u32 s62, s62, 1
    s_sub_u32 s63, s63, 1
    s_cmp_lg_u32 s63, 0
    s_cbranch_scc1 LUT_X
PUBLISH:
    v_mov_b32 v10, 0
NONCE_POLL:
    s_sub_u32 s35, s35, 1
    s_cbranch_scc1 END
    global_load_dwordx2 v[12:13], v10, s[58:59] sc1
    s_waitcnt vmcnt(0)
    v_readfirstlane_b32 s61, v13
    v_readfirstlane_b32 s60, v12
    s_bitcmp1_b32 s61, 31
    s_cbranch_scc0 NONCE_POLL
    s_lshl_b32 s61, s61, 22
    s_waitcnt lgkmcnt(0)
    s_barrier
    s_cmp_lg_u32 s25, 0
    s_cbranch_scc1 PUBLISHED
    v_or_b32 v108, s61, v108
    v_mov_b32 v109, s60
    v_or_b32 v110, s61, v110
    v_mov_b32 v111, s60
    v_or_b32 v112, s61, v112
    v_mov_b32 v113, s60
    v_or_b32 v114, s61, v114
    v_mov_b32 v115, s60
    s_lshl_b32 s3, s2, 11
    s_add_u32 s3, s3, 6553600
    v_lshl_add_u32 v10, v1, 1, s3
    global_store_dwordx4 v10, v[108:111], s[16:17] sc0 sc1
    global_store_dwordx4 v10, v[112:115], s[16:17] offset:16 sc0 sc1
PUBLISHED:
    s_lshl_b32 s62, s25, 1
    s_add_u32 s62, s62, 48
    s_mov_b32 s63, 2
LUT_D:
    s_lshl_b32 s3, s62, 25
    s_add_u32 s3, s3, 0x8000
    v_lshl_add_u32 v128, v1, 15, s3
    v_add_u32 v129, 65536, v128
    v_add_u32 v130, 131072, v128
    v_add_u32 v131, 196608, v128
    v_add_u32 v132, 262144, v128
    v_add_u32 v133, 327680, v128
    v_add_u32 v134, 393216, v128
    v_add_u32 v135, 458752, v128
    v_pk_mul_f32 v[136:137], v[128:129], s[10:11]
    v_pk_mul_f32 v[138:139], v[130:131], s[10:11]
    v_pk_mul_f32 v[140:141], v[132:133], s[10:11]
    v_pk_mul_f32 v[142:143], v[134:135], s[10:11]
    v_exp_f32 v136, v136
    v_exp_f32 v137, v137
    v_exp_f32 v138, v138
    v_exp_f32 v139, v139
    v_exp_f32 v140, v140
    v_exp_f32 v141, v141
    v_exp_f32 v142, v142
    v_exp_f32 v143, v143
    s_lshl_b32 s3, s62, 10
    v_pk_add_f32 v[144:145], v[136:137], 1.0 op_sel_hi:[1,0]
    v_pk_add_f32 v[146:147], v[138:139], 1.0 op_sel_hi:[1,0]
    v_pk_add_f32 v[148:149], v[140:141], 1.0 op_sel_hi:[1,0]
    v_pk_add_f32 v[150:151], v[142:143], 1.0 op_sel_hi:[1,0]
    v_rcp_f32 v144, v144
    v_rcp_f32 v145, v145
    v_rcp_f32 v146, v146
    v_rcp_f32 v147, v147
    v_rcp_f32 v148, v148
    v_rcp_f32 v149, v149
    v_rcp_f32 v150, v150
    v_rcp_f32 v151, v151
    v_add_u32 v160, s3, v1
    v_pk_mul_f32 v[128:129], v[128:129], v[144:145]
    v_pk_mul_f32 v[130:131], v[130:131], v[146:147]
    v_pk_mul_f32 v[132:133], v[132:133], v[148:149]
    v_pk_mul_f32 v[134:135], v[134:135], v[150:151]
    v_add_u32 v161, 0x10000, v160
    v_pk_mul_f32 v[136:137], v[128:129], v[136:137] neg_lo:[1,0] neg_hi:[1,0]
    v_pk_mul_f32 v[138:139], v[130:131], v[138:139] neg_lo:[1,0] neg_hi:[1,0]
    v_pk_mul_f32 v[140:141], v[132:133], v[140:141] neg_lo:[1,0] neg_hi:[1,0]
    v_pk_mul_f32 v[142:143], v[134:135], v[142:143] neg_lo:[1,0] neg_hi:[1,0]
    v_cvt_pk_bf16_f32 v152, v128, v129
    v_cvt_pk_bf16_f32 v153, v130, v131
    v_cvt_pk_bf16_f32 v154, v132, v133
    v_cvt_pk_bf16_f32 v155, v134, v135
    v_cvt_pk_bf16_f32 v156, v136, v137
    v_cvt_pk_bf16_f32 v157, v138, v139
    v_cvt_pk_bf16_f32 v158, v140, v141
    v_cvt_pk_bf16_f32 v159, v142, v143
    ds_write_b128 v160, v[152:155] offset:32768
    ds_write_b128 v161, v[156:159] offset:32768
    s_add_u32 s62, s62, 1
    s_sub_u32 s63, s63, 1
    s_cmp_lg_u32 s63, 0
    s_cbranch_scc1 LUT_D
    s_cmp_lg_u32 s25, 7
    s_cbranch_scc1 LUT_DONE
    v_mov_b32 v10, 65280
    v_mov_b32 v11, 0x7f80
    ds_write_b16 v10, v11 offset:32768
LUT_DONE:
    v_lshrrev_b32 v4, 1, v0
    s_lshl_b32 s3, s24, 3
    s_add_u32 s3, s3, 6553600
    v_lshl_add_u32 v10, v4, 11, s3
    s_lshr_b32 s61, s61, 22
TAB_POLL:
    s_sub_u32 s35, s35, 1
    s_cbranch_scc1 END
    buffer_load_dwordx2 v[2:3], v10, s[16:19], 0 offen sc1
    s_waitcnt vmcnt(0)
    v_lshrrev_b32 v11, 22, v2
    v_cmp_ne_u32 vcc, s60, v3
    v_cmp_ne_u32 s[42:43], s61, v11
    s_or_b64 vcc, vcc, s[42:43]
    s_and_b64 exec, exec, vcc
    s_cbranch_execnz TAB_POLL
    s_mov_b64 exec, -1
    v_mul_u32_u24 v4, 1280, v4
    v_and_b32 v12, 1, v0
    v_cmp_eq_u32 s[42:43], 1, v12
    v_and_b32 v13, 0x7ff, v2
    v_bfe_u32 v2, v2, 11, 11
    v_lshrrev_b32 v9, 4, v1
    v_add_u32 v4, v4, v13
    v_cndmask_b32 v13, 0, v2, s[42:43]
    v_mov_b32 v3, v13
    s_nop 1
    v_add_u32_dpp v3, v3, v3 row_shr:1 row_mask:0xf bank_mask:0xf bound_ctrl:0
    s_nop 1
    v_add_u32_dpp v3, v3, v3 row_shr:2 row_mask:0xf bank_mask:0xf bound_ctrl:0
    s_nop 1
    v_add_u32_dpp v3, v3, v3 row_shr:4 row_mask:0xf bank_mask:0xf bound_ctrl:0
    s_nop 1
    v_add_u32_dpp v3, v3, v3 row_shr:8 row_mask:0xf bank_mask:0xf bound_ctrl:0
    s_nop 1
    v_add_u32_dpp v3, v3, v3 row_bcast:15 row_mask:0xa bank_mask:0xf
    s_nop 1
    v_add_u32_dpp v3, v3, v3 row_bcast:31 row_mask:0xc bank_mask:0xf
    s_nop 0
    v_readlane_b32 s44, v3, 63
    v_sub_u32 v3, v3, v13
    v_cmp_lt_u32 vcc, s25, v9
    v_cmp_gt_u32 s[42:43], 9, v9
    v_lshlrev_b32 v10, 2, v9
    v_mov_b32 v11, s44
    s_and_b64 vcc, vcc, s[42:43]
    s_and_saveexec_b64 s[42:43], vcc
    ds_add_u32 v10, v11 offset:2176
    s_mov_b64 exec, s[42:43]
    s_lshl_b32 s3, s25, 2
    v_mov_b32 v10, s3
    v_mov_b32 v11, 32
    s_waitcnt lgkmcnt(0)
    s_barrier
    ds_read_b32 v10, v10 offset:2176
    ds_read_b32 v11, v11 offset:2176
    s_waitcnt lgkmcnt(0)
    v_add_u32 v3, v3, v10
    v_readfirstlane_b32 s26, v11
ROUND:
    v_and_b32 v8, 1, v0
    v_subrev_u32 v9, s27, v3
    v_add_u32 v9, v9, v8
    v_add_u32 v10, v4, v8
    s_mov_b32 s3, 1472
EXPAND:
    v_cmp_lt_u32 vcc, v8, v2
    s_and_b64 exec, exec, vcc
    s_cbranch_execz EXPAND_DONE
    v_cmp_gt_u32 vcc, s3, v9
    v_lshlrev_b32 v11, 2, v9
    s_and_saveexec_b64 s[42:43], vcc
    ds_write_b32 v11, v10 offset:2304
    s_mov_b64 exec, s[42:43]
    v_add_u32 v8, 2, v8
    v_add_u32 v9, 2, v9
    v_add_u32 v10, 2, v10
    s_branch EXPAND
EXPAND_DONE:
    s_mov_b64 exec, -1
    s_sub_u32 s28, s26, s27
    s_min_u32 s28, s28, 1472
    v_lshlrev_b32 v8, 2, v0
    v_add_u32 v9, 0, v0
    v_cmp_gt_u32 s[36:37], s28, v9
    v_add_u32 v9, 512, v0
    v_cmp_gt_u32 s[38:39], s28, v9
    v_add_u32 v9, 1024, v0
    v_cmp_gt_u32 s[40:41], s28, v9
    s_waitcnt lgkmcnt(0)
    s_barrier
    ds_read_b32 v64, v8 offset:2304
    ds_read_b32 v65, v8 offset:4352
    ds_read_b32 v66, v8 offset:6400
    s_lshl_b32 s10, s25, 10
    s_add_u32 s10, s10, 8192
    s_mov_b32 s11, 1310720
    s_and_b32 s3, s25, 3
    s_lshl_b32 s3, s3, 13
    s_add_u32 s3, s3, 6492160
    s_mov_b32 s45, 6488064
    s_mov_b32 s44, 5033
    s_waitcnt lgkmcnt(0)
    v_lshlrev_b32 v68, 2, v64
    v_lshlrev_b32 v64, 4, v64
    v_lshlrev_b32 v69, 2, v65
    v_lshlrev_b32 v65, 4, v65
    v_lshlrev_b32 v70, 2, v66
    v_lshlrev_b32 v66, 4, v66
    s_mov_b64 exec, s[40:41]
    s_cbranch_execz SKIP3
    buffer_load_dword v70, v70, s[16:19], 0 offen sc1
SKIP3:
    s_mov_b64 exec, s[36:37]
    buffer_load_dword v68, v68, s[16:19], 0 offen sc1
    s_mov_b64 exec, s[38:39]
    buffer_load_dword v69, v69, s[16:19], 0 offen sc1
    s_mov_b64 exec, -1
    buffer_load_dwordx4 v[176:179], v1, s[16:19], s45 offen offset:0 sc1
    buffer_load_dwordx4 v[180:183], v1, s[16:19], s45 offen offset:1024 sc1
    buffer_load_dwordx4 v[184:187], v1, s[16:19], s45 offen offset:2048 sc1
    buffer_load_dwordx4 v[188:191], v1, s[16:19], s3 offen offset:0 sc1
    buffer_load_dwordx4 v[192:195], v1, s[16:19], s3 offen offset:1024 sc1
    s_waitcnt vmcnt(5)
    s_add_u32 m0, s10, 0
    s_mov_b64 exec, s[36:37]
    buffer_load_dwordx4 v64, s[16:19], s11 offen sc1 lds
    s_add_u32 m0, s10, 8192
    s_mov_b64 exec, s[38:39]
    buffer_load_dwordx4 v65, s[16:19], s11 offen sc1 lds
    s_add_u32 m0, s10, 16384
    s_mov_b64 exec, s[40:41]
    s_cbranch_execz SKIP3R
    buffer_load_dwordx4 v66, s[16:19], s11 offen sc1 lds
SKIP3R:
    s_mov_b64 exec, -1
    v_mul_hi_u32 v9, s44, v68
    v_and_b32 v72, 63, v68
    v_mul_u32_u24 v72, 48, v72
    v_lshl_add_u32 v72, v9, 2, v72
    v_mul_hi_u32 v9, s44, v69
    v_and_b32 v73, 63, v69
    v_mul_u32_u24 v73, 48, v73
    v_lshl_add_u32 v73, v9, 2, v73
    v_mul_hi_u32 v9, s44, v70
    v_and_b32 v74, 63, v70
    v_mul_u32_u24 v74, 48, v74
    v_lshl_add_u32 v74, v9, 2, v74
    s_mov_b64 exec, s[36:37]
    ds_add_rtn_u32 v76, v72, v15 offset:0
    s_mov_b64 exec, s[38:39]
    ds_add_rtn_u32 v77, v73, v15 offset:0
    s_mov_b64 exec, s[40:41]
    ds_add_rtn_u32 v78, v74, v15 offset:0
    s_mov_b64 exec, -1
    v_add_u32 v9, 0, v0
    v_lshlrev_b32 v9, 21, v9
    v_lshrrev_b32 v80, 10, v68
    v_lshl_or_b32 v80, v80, 7, v9
    v_add_u32 v9, 512, v0
    v_lshlrev_b32 v9, 21, v9
    v_lshrrev_b32 v81, 10, v69
    v_lshl_or_b32 v81, v81, 7, v9
    v_add_u32 v9, 1024, v0
    v_lshlrev_b32 v9, 21, v9
    v_lshrrev_b32 v82, 10, v70
    v_lshl_or_b32 v82, v82, 7, v9
    v_lshrrev_b32 v8, 4, v1
    v_min_u32 v9, 39, v8
    v_mul_u32_u24 v9, 48, v9
    v_cmp_gt_u32 s[46:47], 40, v8
    v_sub_u32 v10, 63, v8
    s_mul_i32 s10, s25, 5
    s_waitcnt lgkmcnt(0)
    s_barrier
    ds_read_b128 v[84:87], v9 offset:0
    ds_read_b128 v[88:91], v9 offset:16
    ds_read_b128 v[92:95], v9 offset:32
    s_waitcnt lgkmcnt(1)
    v_add3_u32 v84, v84, v85, v86
    v_add3_u32 v87, v87, v88, v89
    v_add3_u32 v84, v84, v90, v91
    s_waitcnt lgkmcnt(0)
    v_add3_u32 v87, v87, v92, v93
    v_add3_u32 v84, v84, v94, v95
    v_add_u32 v84, v84, v87
    v_lshl_or_b32 v85, v84, 6, v10
    v_cndmask_b32 v85, 0, v85, s[46:47]
    s_cmp_lg_u32 s27, 0
    s_cbranch_scc1 DEALT
    v_readlane_b32 s4, v85, s10
    s_add_u32 s10, s10, 1
    v_readlane_b32 s5, v85, s10
    s_add_u32 s10, s10, 1
    v_readlane_b32 s6, v85, s10
    s_add_u32 s10, s10, 1
    v_readlane_b32 s7, v85, s10
    s_add_u32 s10, s10, 1
    v_readlane_b32 s8, v85, s10
    v_cmp_lt_u32 s[48:49], s4, v85
    v_cmp_lt_u32 s[50:51], s5, v85
    v_cmp_lt_u32 s[52:53], s6, v85
    v_cmp_lt_u32 s[54:55], s7, v85
    v_cmp_lt_u32 s[56:57], s8, v85
    s_bcnt1_i32_b64 s4, s[48:49]
    s_bcnt1_i32_b64 s5, s[50:51]
    s_bcnt1_i32_b64 s6, s[52:53]
    s_bcnt1_i32_b64 s7, s[54:55]
    s_bcnt1_i32_b64 s8, s[56:57]
    v_writelane_b32 v9, s4, 0
    v_writelane_b32 v9, s5, 1
    v_writelane_b32 v9, s6, 2
    v_writelane_b32 v9, s7, 3
    v_writelane_b32 v9, s8, 4
    s_sub_u32 s10, s10, 4
    v_add_u32 v10, s10, v8
    v_lshrrev_b32 v11, 3, v9
    v_and_b32 v9, 7, v9
    v_lshrrev_b32 v12, v11, 18
    v_and_b32 v12, 1, v12
    v_mul_u32_u24 v12, 7, v12
    v_xor_b32 v9, v9, v12
    v_mad_u32_u24 v9, v9, 5, v11
    v_lshlrev_b32 v9, 2, v9
    s_mov_b64 exec, 0x1f
    ds_write_b32 v9, v10 offset:1920
    s_mov_b64 exec, -1
DEALT:
    s_lshl_b32 s11, s10, 2
    v_add_u32 v9, s11, v7
    v_lshlrev_b32 v13, 2, v8
    v_cmp_gt_u32 s[42:43], 60, v8
    s_waitcnt lgkmcnt(0)
    s_barrier
    ds_read_b32 v9, v9 offset:1920
    ds_read_b32 v13, v13 offset:1920
    v_lshlrev_b32 v12, 17, v7
    s_waitcnt lgkmcnt(1)
    v_mul_u32_u24 v10, 48, v9
    v_add_u32 v10, v10, v14
    ds_read_b32 v11, v10 offset:0
    s_waitcnt lgkmcnt(1)
    v_lshlrev_b32 v13, 2, v13
    ds_bpermute_b32 v86, v13, v84
    v_readlane_b32 s4, v9, 0
    v_readlane_b32 s5, v9, 1
    v_readlane_b32 s6, v9, 2
    v_readlane_b32 s7, v9, 3
    v_readlane_b32 s8, v9, 4
    s_waitcnt lgkmcnt(0)
    v_cndmask_b32 v11, 0, v11, s[42:43]
    v_cndmask_b32 v86, 0, v86, s[46:47]
    v_sub_u32 v12, v12, v11
    v_mov_b32 v87, v86
    s_nop 0
    v_add_u32_dpp v11, v11, v11 row_shr:1 row_mask:0xf bank_mask:0xf bound_ctrl:0
    v_add_u32_dpp v87, v87, v87 row_shr:1 row_mask:0xf bank_mask:0xf bound_ctrl:0
    s_nop 0
    v_add_u32_dpp v11, v11, v11 row_shr:2 row_mask:0xf bank_mask:0xf bound_ctrl:0
    v_add_u32_dpp v87, v87, v87 row_shr:2 row_mask:0xf bank_mask:0xf bound_ctrl:0
    s_nop 0
    v_add_u32_dpp v11, v11, v11 row_shr:4 row_mask:0xf bank_mask:0xf bound_ctrl:0
    v_add_u32_dpp v87, v87, v87 row_shr:4 row_mask:0xf bank_mask:0xf bound_ctrl:0
    s_nop 0
    v_add_u32_dpp v11, v11, v11 row_shr:8 row_mask:0xf bank_mask:0xf bound_ctrl:0
    v_add_u32_dpp v87, v87, v87 row_shr:8 row_mask:0xf bank_mask:0xf bound_ctrl:0
    s_nop 0
    v_add_u32_dpp v11, v11, v11 row_bcast:15 row_mask:0xa bank_mask:0xf
    v_add_u32_dpp v87, v87, v87 row_bcast:15 row_mask:0xa bank_mask:0xf
    s_nop 0
    v_add_u32_dpp v11, v11, v11 row_bcast:31 row_mask:0xc bank_mask:0xf
    v_add_u32_dpp v87, v87, v87 row_bcast:31 row_mask:0xc bank_mask:0xf
    v_sub_u32 v87, v87, v86
    v_add_u32 v12, v12, v11
    v_readlane_b32 s29, v87, s10
    v_readlane_b32 s30, v11, 63
    s_nop 0
    v_add_u32 v12, s29, v12
    s_mov_b64 exec, s[42:43]
    ds_write_b32 v10, v12 offset:0
    s_mov_b64 exec, -1
    v_add_u32 v6, s29, v8
    v_lshlrev_b32 v5, 2, v6
    v_add_u32 v5, 2304, v5
    s_add_u32 s10, s30, 3
    s_and_b32 s10, s10, -4
    s_min_u32 s32, s10, 4
    s_sub_u32 s31, s10, s32
    s_add_u32 s30, s30, s29
    s_waitcnt lgkmcnt(0)
    s_barrier
    ds_read_b32 v72, v72 offset:0
    ds_read_b32 v73, v73 offset:0
    ds_read_b32 v74, v74 offset:0
    buffer_load_dwordx4 v[196:199], v1, s[16:19], s3 offen offset:2048 sc1
    buffer_load_dwordx4 v[200:203], v1, s[16:19], s3 offen offset:3072 sc1
    s_add_u32 s3, s3, 4096
    buffer_load_dwordx4 v[204:207], v1, s[16:19], s3 offen offset:0 sc1
    buffer_load_dwordx4 v[208:211], v1, s[16:19], s3 offen offset:1024 sc1
    buffer_load_dwordx4 v[212:215], v1, s[16:19], s3 offen offset:2048 sc1
    buffer_load_dwordx4 v[216:219], v1, s[16:19], s3 offen offset:3072 sc1
    s_waitcnt lgkmcnt(2)
    v_lshrrev_b32 v9, 16, v72
    v_and_b32 v72, 0xffff, v72
    v_or_b32 v80, v80, v9
    v_add_lshl_u32 v72, v72, v76, 2
    s_waitcnt lgkmcnt(1)
    v_lshrrev_b32 v9, 16, v73
    v_and_b32 v73, 0xffff, v73
    v_or_b32 v81, v81, v9
    v_add_lshl_u32 v73, v73, v77, 2
    s_waitcnt lgkmcnt(0)
    v_lshrrev_b32 v9, 16, v74
    v_and_b32 v74, 0xffff, v74
    v_or_b32 v82, v82, v9
    v_add_lshl_u32 v74, v74, v78, 2
    s_mov_b64 exec, s[36:37]
    ds_write_b32 v72, v80 offset:2304
    s_mov_b64 exec, s[38:39]
    ds_write_b32 v73, v81 offset:2304
    s_mov_b64 exec, s[40:41]
    ds_write_b32 v74, v82 offset:2304
    s_mov_b64 exec, -1
    s_waitcnt lgkmcnt(0)
    s_waitcnt vmcnt(6)
    s_barrier
    ds_read_b32 v165, v5
    v_mov_b32 v128, 0
    v_mov_b32 v129, 0
    v_mov_b32 v130, 0
    v_mov_b32 v131, 0
    v_mov_b32 v132, 0
    v_mov_b32 v133, 0
    v_mov_b32 v134, 0
    v_mov_b32 v135, 0
    s_waitcnt lgkmcnt(0)
    v_cmp_gt_u32 vcc, s30, v6
    v_add_u32 v6, 64, v6
    v_add_u32 v5, 256, v5
    v_cndmask_b32 v165, 40, v165, vcc
    v_lshrrev_b32 v8, 21, v165
    v_lshlrev_b32 v8, 4, v8
    v_lshlrev_b32 v9, 3, v165
    ds_read_b128 v[168:171], v8 offset:8192
    v_and_b32 v9, 0xfffc00, v9
    v_and_or_b32 v165, v165, 56, v9
    s_nop 0
    v_readlane_b32 s48, v165, 0
    s_and_b32 s33, s48, s34
    buffer_load_dwordx4 v[64:67], v1, s[12:15], s33 offen
    v_readlane_b32 s49, v165, 1
    s_and_b32 s33, s49, s34
    buffer_load_dwordx4 v[68:71], v1, s[12:15], s33 offen
    v_readlane_b32 s50, v165, 2
    s_and_b32 s33, s50, s34
    buffer_load_dwordx4 v[72:75], v1, s[12:15], s33 offen
    v_readlane_b32 s51, v165, 3
    s_and_b32 s33, s51, s34
    buffer_load_dwordx4 v[76:79], v1, s[12:15], s33 offen
    v_readlane_b32 s52, v165, 4
    s_and_b32 s33, s52, s34
    buffer_load_dwordx4 v[80:83], v1, s[12:15], s33 offen
    v_readlane_b32 s53, v165, 5
    s_and_b32 s33, s53, s34
    buffer_load_dwordx4 v[84:87], v1, s[12:15], s33 offen
    v_readlane_b32 s54, v165, 6
    s_and_b32 s33, s54, s34
    buffer_load_dwordx4 v[88:91], v1, s[12:15], s33 offen
    v_mov_b32 v164, v165
    s_waitcnt lgkmcnt(0) vmcnt(7)
    v_mov_b32 v172, v170
    v_mov_b32 v173, v171
    v_mfma_f32_4x4x4_16b_bf16 v[148:151], v[168:169], v[180:181], 0
    v_mfma_f32_4x4x4_16b_bf16 v[152:155], v[168:169], v[182:183], 0
    v_mfma_f32_4x4x4_16b_bf16 v[156:159], v[168:169], v[184:185], 0
    v_mfma_f32_4x4x4_16b_bf16 v[160:163], v[168:169], v[186:187], 0
    v_mfma_f32_4x4x4_16b_bf16 v[112:115], v[172:173], v[176:177], 0 cbsz:4 abid:0
    v_mfma_f32_4x4x4_16b_bf16 v[116:119], v[172:173], v[178:179], 0 cbsz:4 abid:0
    v_mfma_f32_4x4x4_16b_bf16 v[120:123], v[172:173], v[176:177], 0 cbsz:4 abid:1
    s_nop 1
    v_cvt_pk_bf16_f32 v140, v148, v152
    v_cvt_pk_bf16_f32 v141, v156, v160
    v_cvt_pk_bf16_f32 v142, v149, v153
    v_cvt_pk_bf16_f32 v143, v157, v161
    v_cvt_pk_bf16_f32 v144, v150, v154
    v_cvt_pk_bf16_f32 v145, v158, v162
    v_cvt_pk_bf16_f32 v146, v151, v155
    v_cvt_pk_bf16_f32 v147, v159, v163
    v_lshlrev_b32_sdwa v136, v15, v112 dst_sel:DWORD dst_unused:UNUSED_PAD src0_sel:DWORD src1_sel:WORD_1
    v_lshlrev_b32_sdwa v137, v15, v113 dst_sel:DWORD dst_unused:UNUSED_PAD src0_sel:DWORD src1_sel:WORD_1
    ds_read_u16_d16_hi v128, v136 offset:32768
    ds_read_u16_d16_hi v129, v137 offset:32768
    v_lshlrev_b32_sdwa v138, v15, v116 dst_sel:DWORD dst_unused:UNUSED_PAD src0_sel:DWORD src1_sel:WORD_1
    v_lshlrev_b32_sdwa v139, v15, v117 dst_sel:DWORD dst_unused:UNUSED_PAD src0_sel:DWORD src1_sel:WORD_1
    ds_read_u16_d16_hi v130, v138 offset:32768
    ds_read_u16_d16_hi v131, v139 offset:32768
    s_waitcnt vmcnt(6)
    v_mfma_f32_4x4x4_16b_bf16 v[96:99], v[140:141], v[64:65], 0 cbsz:4 abid:0
    v_mfma_f32_4x4x4_16b_bf16 v[100:103], v[140:141], v[66:67], 0 cbsz:4 abid:0
A_0:
    s_sub_u32 s31, s31, 4
    s_cbranch_scc1 B_0
    v_mfma_f32_4x4x4_16b_bf16 v[124:127], v[172:173], v[178:179], 0 cbsz:4 abid:1
    v_lshlrev_b32_sdwa v136, v15, v114 dst_sel:DWORD dst_unused:UNUSED_PAD src0_sel:DWORD src1_sel:WORD_1
    s_waitcnt vmcnt(5)
    v_mfma_f32_4x4x4_16b_bf16 v[104:107], v[142:143], v[68:69], 0 cbsz:4 abid:0
    v_readlane_b32 s55, v164, 7
    v_mfma_f32_4x4x4_16b_bf16 v[108:111], v[142:143], v[70:71], 0 cbsz:4 abid:0
    v_lshlrev_b32_sdwa v137, v15, v115 dst_sel:DWORD dst_unused:UNUSED_PAD src0_sel:DWORD src1_sel:WORD_1
    ds_read_u16_d16_hi v132, v136 offset:32768
    ds_read_u16_d16_hi v133, v137 offset:32768
    s_and_b32 s33, s55, s34
    buffer_load_dwordx4 v[92:95], v1, s[12:15], s33 offen
    s_waitcnt lgkmcnt(2)
    s_set_gpr_idx_on s48, 0xc
    v_pk_fma_f32 v[16:17], v[128:129], v[96:97], v[16:17] op_sel:[0,0,0] op_sel_hi:[0,1,1]
    v_pk_fma_f32 v[18:19], v[128:129], v[98:99], v[18:19] op_sel:[0,0,0] op_sel_hi:[0,1,1]
    v_pk_fma_f32 v[20:21], v[130:131], v[100:101], v[20:21] op_sel:[0,0,0] op_sel_hi:[0,1,1]
    v_pk_fma_f32 v[22:23], v[130:131], v[102:103], v[22:23] op_sel:[0,0,0] op_sel_hi:[0,1,1]
    s_set_gpr_idx_off
    v_lshlrev_b32_sdwa v138, v15, v118 dst_sel:DWORD dst_unused:UNUSED_PAD src0_sel:DWORD src1_sel:WORD_1
    s_waitcnt vmcnt(5)
    v_mfma_f32_4x4x4_16b_bf16 v[96:99], v[144:145], v[72:73], 0 cbsz:4 abid:0
    v_readlane_b32 s56, v164, 8
    v_mfma_f32_4x4x4_16b_bf16 v[100:103], v[144:145], v[74:75], 0 cbsz:4 abid:0
    v_lshlrev_b32_sdwa v139, v15, v119 dst_sel:DWORD dst_unused:UNUSED_PAD src0_sel:DWORD src1_sel:WORD_1
    ds_read_u16_d16_hi v134, v138 offset:32768
    ds_read_u16_d16_hi v135, v139 offset:32768
    s_and_b32 s33, s56, s34
    buffer_load_dwordx4 v[64:67], v1, s[12:15], s33 offen
    s_set_gpr_idx_on s49, 0xc
    v_pk_fma_f32 v[16:17], v[128:129], v[104:105], v[16:17] op_sel:[1,0,0] op_sel_hi:[1,1,1]
    v_pk_fma_f32 v[18:19], v[128:129], v[106:107], v[18:19] op_sel:[1,0,0] op_sel_hi:[1,1,1]
    v_pk_fma_f32 v[20:21], v[130:131], v[108:109], v[20:21] op_sel:[1,0,0] op_sel_hi:[1,1,1]
    v_pk_fma_f32 v[22:23], v[130:131], v[110:111], v[22:23] op_sel:[1,0,0] op_sel_hi:[1,1,1]
    s_set_gpr_idx_off
    v_mfma_f32_4x4x4_16b_bf16 v[112:115], v[172:173], v[176:177], 0 cbsz:4 abid:2
    v_lshlrev_b32_sdwa v136, v15, v120 dst_sel:DWORD dst_unused:UNUSED_PAD src0_sel:DWORD src1_sel:WORD_1
    s_waitcnt vmcnt(5)
    v_mfma_f32_4x4x4_16b_bf16 v[104:107], v[146:147], v[76:77], 0 cbsz:4 abid:0
    v_readlane_b32 s57, v164, 9
    v_mfma_f32_4x4x4_16b_bf16 v[108:111], v[146:147], v[78:79], 0 cbsz:4 abid:0
    v_lshlrev_b32_sdwa v137, v15, v121 dst_sel:DWORD dst_unused:UNUSED_PAD src0_sel:DWORD src1_sel:WORD_1
    ds_read_u16_d16_hi v128, v136 offset:32768
    ds_read_u16_d16_hi v129, v137 offset:32768
    s_and_b32 s33, s57, s34
    buffer_load_dwordx4 v[68:71], v1, s[12:15], s33 offen
    s_waitcnt lgkmcnt(2)
    s_set_gpr_idx_on s50, 0xc
    v_pk_fma_f32 v[16:17], v[132:133], v[96:97], v[16:17] op_sel:[0,0,0] op_sel_hi:[0,1,1]
    v_pk_fma_f32 v[18:19], v[132:133], v[98:99], v[18:19] op_sel:[0,0,0] op_sel_hi:[0,1,1]
    v_pk_fma_f32 v[20:21], v[134:135], v[100:101], v[20:21] op_sel:[0,0,0] op_sel_hi:[0,1,1]
    v_pk_fma_f32 v[22:23], v[134:135], v[102:103], v[22:23] op_sel:[0,0,0] op_sel_hi:[0,1,1]
    s_set_gpr_idx_off
    v_lshlrev_b32_sdwa v138, v15, v124 dst_sel:DWORD dst_unused:UNUSED_PAD src0_sel:DWORD src1_sel:WORD_1
    s_waitcnt vmcnt(5)
    v_mfma_f32_4x4x4_16b_bf16 v[96:99], v[140:141], v[80:81], 0 cbsz:4 abid:1
    v_readlane_b32 s58, v164, 10
    v_mfma_f32_4x4x4_16b_bf16 v[100:103], v[140:141], v[82:83], 0 cbsz:4 abid:1
    v_lshlrev_b32_sdwa v139, v15, v125 dst_sel:DWORD dst_unused:UNUSED_PAD src0_sel:DWORD src1_sel:WORD_1
    ds_read_u16_d16_hi v130, v138 offset:32768
    ds_read_u16_d16_hi v131, v139 offset:32768
    s_and_b32 s33, s58, s34
    buffer_load_dwordx4 v[72:75], v1, s[12:15], s33 offen
    s_set_gpr_idx_on s51, 0xc
    v_pk_fma_f32 v[16:17], v[132:133], v[104:105], v[16:17] op_sel:[1,0,0] op_sel_hi:[1,1,1]
    v_pk_fma_f32 v[18:19], v[132:133], v[106:107], v[18:19] op_sel:[1,0,0] op_sel_hi:[1,1,1]
    v_pk_fma_f32 v[20:21], v[134:135], v[108:109], v[20:21] op_sel:[1,0,0] op_sel_hi:[1,1,1]
    v_pk_fma_f32 v[22:23], v[134:135], v[110:111], v[22:23] op_sel:[1,0,0] op_sel_hi:[1,1,1]
    s_set_gpr_idx_off
A_4:
    s_sub_u32 s31, s31, 4
    s_cbranch_scc1 B_4
    v_mfma_f32_4x4x4_16b_bf16 v[116:119], v[172:173], v[178:179], 0 cbsz:4 abid:2
    v_lshlrev_b32_sdwa v136, v15, v122 dst_sel:DWORD dst_unused:UNUSED_PAD src0_sel:DWORD src1_sel:WORD_1
    s_waitcnt vmcnt(5)
    v_mfma_f32_4x4x4_16b_bf16 v[104:107], v[142:143], v[84:85], 0 cbsz:4 abid:1
    v_readlane_b32 s59, v164, 11
    v_mfma_f32_4x4x4_16b_bf16 v[108:111], v[142:143], v[86:87], 0 cbsz:4 abid:1
    v_lshlrev_b32_sdwa v137, v15, v123 dst_sel:DWORD dst_unused:UNUSED_PAD src0_sel:DWORD src1_sel:WORD_1
    ds_read_u16_d16_hi v132, v136 offset:32768
    ds_read_u16_d16_hi v133, v137 offset:32768
    s_and_b32 s33, s59, s34
    buffer_load_dwordx4 v[76:79], v1, s[12:15], s33 offen
    s_waitcnt lgkmcnt(2)
    s_set_gpr_idx_on s52, 0xc
    v_pk_fma_f32 v[16:17], v[128:129], v[96:97], v[16:17] op_sel:[0,0,0] op_sel_hi:[0,1,1]
    v_pk_fma_f32 v[18:19], v[128:129], v[98:99], v[18:19] op_sel:[0,0,0] op_sel_hi:[0,1,1]
    v_pk_fma_f32 v[20:21], v[130:131], v[100:101], v[20:21] op_sel:[0,0,0] op_sel_hi:[0,1,1]
    v_pk_fma_f32 v[22:23], v[130:131], v[102:103], v[22:23] op_sel:[0,0,0] op_sel_hi:[0,1,1]
    s_set_gpr_idx_off
    v_lshlrev_b32_sdwa v138, v15, v126 dst_sel:DWORD dst_unused:UNUSED_PAD src0_sel:DWORD src1_sel:WORD_1
    s_waitcnt vmcnt(5)
    v_mfma_f32_4x4x4_16b_bf16 v[96:99], v[144:145], v[88:89], 0 cbsz:4 abid:1
    v_readlane_b32 s60, v164, 12
    v_mfma_f32_4x4x4_16b_bf16 v[100:103], v[144:145], v[90:91], 0 cbsz:4 abid:1
    v_lshlrev_b32_sdwa v139, v15, v127 dst_sel:DWORD dst_unused:UNUSED_PAD src0_sel:DWORD src1_sel:WORD_1
    ds_read_u16_d16_hi v134, v138 offset:32768
    ds_read_u16_d16_hi v135, v139 offset:32768
    s_and_b32 s33, s60, s34
    buffer_load_dwordx4 v[80:83], v1, s[12:15], s33 offen
    s_set_gpr_idx_on s53, 0xc
    v_pk_fma_f32 v[16:17], v[128:129], v[104:105], v[16:17] op_sel:[1,0,0] op_sel_hi:[1,1,1]
    v_pk_fma_f32 v[18:19], v[128:129], v[106:107], v[18:19] op_sel:[1,0,0] op_sel_hi:[1,1,1]
    v_pk_fma_f32 v[20:21], v[130:131], v[108:109], v[20:21] op_sel:[1,0,0] op_sel_hi:[1,1,1]
    v_pk_fma_f32 v[22:23], v[130:131], v[110:111], v[22:23] op_sel:[1,0,0] op_sel_hi:[1,1,1]
    s_set_gpr_idx_off
    v_mfma_f32_4x4x4_16b_bf16 v[120:123], v[172:173], v[176:177], 0 cbsz:4 abid:3
    v_lshlrev_b32_sdwa v136, v15, v112 dst_sel:DWORD dst_unused:UNUSED_PAD src0_sel:DWORD src1_sel:WORD_1
    s_waitcnt vmcnt(5)
    v_mfma_f32_4x4x4_16b_bf16 v[104:107], v[146:147], v[92:93], 0 cbsz:4 abid:1
    v_readlane_b32 s61, v164, 13
    v_mfma_f32_4x4x4_16b_bf16 v[108:111], v[146:147], v[94:95], 0 cbsz:4 abid:1
    v_lshlrev_b32_sdwa v137, v15, v113 dst_sel:DWORD dst_unused:UNUSED_PAD src0_sel:DWORD src1_sel:WORD_1
    ds_read_u16_d16_hi v128, v136 offset:32768
    ds_read_u16_d16_hi v129, v137 offset:32768
    s_and_b32 s33, s61, s34
    buffer_load_dwordx4 v[84:87], v1, s[12:15], s33 offen
    s_waitcnt lgkmcnt(2)
    s_set_gpr_idx_on s54, 0xc
    v_pk_fma_f32 v[16:17], v[132:133], v[96:97], v[16:17] op_sel:[0,0,0] op_sel_hi:[0,1,1]
    v_pk_fma_f32 v[18:19], v[132:133], v[98:99], v[18:19] op_sel:[0,0,0] op_sel_hi:[0,1,1]
    v_pk_fma_f32 v[20:21], v[134:135], v[100:101], v[20:21] op_sel:[0,0,0] op_sel_hi:[0,1,1]
    v_pk_fma_f32 v[22:23], v[134:135], v[102:103], v[22:23] op_sel:[0,0,0] op_sel_hi:[0,1,1]
    s_set_gpr_idx_off
    v_lshlrev_b32_sdwa v138, v15, v116 dst_sel:DWORD dst_unused:UNUSED_PAD src0_sel:DWORD src1_sel:WORD_1
    s_waitcnt vmcnt(5)
    v_mfma_f32_4x4x4_16b_bf16 v[96:99], v[140:141], v[64:65], 0 cbsz:4 abid:2
    v_readlane_b32 s62, v164, 14
    v_mfma_f32_4x4x4_16b_bf16 v[100:103], v[140:141], v[66:67], 0 cbsz:4 abid:2
    v_lshlrev_b32_sdwa v139, v15, v117 dst_sel:DWORD dst_unused:UNUSED_PAD src0_sel:DWORD src1_sel:WORD_1
    ds_read_u16_d16_hi v130, v138 offset:32768
    ds_read_u16_d16_hi v131, v139 offset:32768
    s_and_b32 s33, s62, s34
    buffer_load_dwordx4 v[88:91], v1, s[12:15], s33 offen
    s_set_gpr_idx_on s55, 0xc
    v_pk_fma_f32 v[16:17], v[132:133], v[104:105], v[16:17] op_sel:[1,0,0] op_sel_hi:[1,1,1]
    v_pk_fma_f32 v[18:19], v[132:133], v[106:107], v[18:19] op_sel:[1,0,0] op_sel_hi:[1,1,1]
    v_pk_fma_f32 v[20:21], v[134:135], v[108:109], v[20:21] op_sel:[1,0,0] op_sel_hi:[1,1,1]
    v_pk_fma_f32 v[22:23], v[134:135], v[110:111], v[22:23] op_sel:[1,0,0] op_sel_hi:[1,1,1]
    s_set_gpr_idx_off
A_8:
    s_sub_u32 s31, s31, 4
    s_cbranch_scc1 B_8
    v_mfma_f32_4x4x4_16b_bf16 v[124:127], v[172:173], v[178:179], 0 cbsz:4 abid:3
    v_lshlrev_b32_sdwa v136, v15, v114 dst_sel:DWORD dst_unused:UNUSED_PAD src0_sel:DWORD src1_sel:WORD_1
    s_waitcnt vmcnt(5)
    v_mfma_f32_4x4x4_16b_bf16 v[104:107], v[142:143], v[68:69], 0 cbsz:4 abid:2
    v_readlane_b32 s63, v164, 15
    v_mfma_f32_4x4x4_16b_bf16 v[108:111], v[142:143], v[70:71], 0 cbsz:4 abid:2
    v_lshlrev_b32_sdwa v137, v15, v115 dst_sel:DWORD dst_unused:UNUSED_PAD src0_sel:DWORD src1_sel:WORD_1
    ds_read_u16_d16_hi v132, v136 offset:32768
    ds_read_u16_d16_hi v133, v137 offset:32768
    s_and_b32 s33, s63, s34
    buffer_load_dwordx4 v[92:95], v1, s[12:15], s33 offen
    s_waitcnt lgkmcnt(2)
    s_set_gpr_idx_on s56, 0xc
    v_pk_fma_f32 v[16:17], v[128:129], v[96:97], v[16:17] op_sel:[0,0,0] op_sel_hi:[0,1,1]
    v_pk_fma_f32 v[18:19], v[128:129], v[98:99], v[18:19] op_sel:[0,0,0] op_sel_hi:[0,1,1]
    v_pk_fma_f32 v[20:21], v[130:131], v[100:101], v[20:21] op_sel:[0,0,0] op_sel_hi:[0,1,1]
    v_pk_fma_f32 v[22:23], v[130:131], v[102:103], v[22:23] op_sel:[0,0,0] op_sel_hi:[0,1,1]
    s_set_gpr_idx_off
    ds_read_b32 v165, v5
    v_lshlrev_b32_sdwa v138, v15, v118 dst_sel:DWORD dst_unused:UNUSED_PAD src0_sel:DWORD src1_sel:WORD_1
    s_waitcnt vmcnt(5)
    v_mfma_f32_4x4x4_16b_bf16 v[96:99], v[144:145], v[72:73], 0 cbsz:4 abid:2
    v_readlane_b32 s48, v164, 16
    v_mfma_f32_4x4x4_16b_bf16 v[100:103], v[144:145], v[74:75], 0 cbsz:4 abid:2
    v_lshlrev_b32_sdwa v139, v15, v119 dst_sel:DWORD dst_unused:UNUSED_PAD src0_sel:DWORD src1_sel:WORD_1
    ds_read_u16_d16_hi v134, v138 offset:32768
    ds_read_u16_d16_hi v135, v139 offset:32768
    s_and_b32 s33, s48, s34
    buffer_load_dwordx4 v[64:67], v1, s[12:15], s33 offen
    s_set_gpr_idx_on s57, 0xc
    v_pk_fma_f32 v[16:17], v[128:129], v[104:105], v[16:17] op_sel:[1,0,0] op_sel_hi:[1,1,1]
    v_pk_fma_f32 v[18:19], v[128:129], v[106:107], v[18:19] op_sel:[1,0,0] op_sel_hi:[1,1,1]
    v_pk_fma_f32 v[20:21], v[130:131], v[108:109], v[20:21] op_sel:[1,0,0] op_sel_hi:[1,1,1]
    v_pk_fma_f32 v[22:23], v[130:131], v[110:111], v[22:23] op_sel:[1,0,0] op_sel_hi:[1,1,1]
    s_set_gpr_idx_off
    v_mfma_f32_4x4x4_16b_bf16 v[112:115], v[172:173], v[176:177], 0 cbsz:4 abid:4
    v_lshlrev_b32_sdwa v136, v15, v120 dst_sel:DWORD dst_unused:UNUSED_PAD src0_sel:DWORD src1_sel:WORD_1
    s_waitcnt vmcnt(5)
    v_mfma_f32_4x4x4_16b_bf16 v[104:107], v[146:147], v[76:77], 0 cbsz:4 abid:2
    v_readlane_b32 s49, v164, 17
    v_mfma_f32_4x4x4_16b_bf16 v[108:111], v[146:147], v[78:79], 0 cbsz:4 abid:2
    v_lshlrev_b32_sdwa v137, v15, v121 dst_sel:DWORD dst_unused:UNUSED_PAD src0_sel:DWORD src1_sel:WORD_1
    ds_read_u16_d16_hi v128, v136 offset:32768
    ds_read_u16_d16_hi v129, v137 offset:32768
    s_and_b32 s33, s49, s34
    buffer_load_dwordx4 v[68:71], v1, s[12:15], s33 offen
    s_waitcnt lgkmcnt(2)
    s_set_gpr_idx_on s58, 0xc
    v_pk_fma_f32 v[16:17], v[132:133], v[96:97], v[16:17] op_sel:[0,0,0] op_sel_hi:[0,1,1]
    v_pk_fma_f32 v[18:19], v[132:133], v[98:99], v[18:19] op_sel:[0,0,0] op_sel_hi:[0,1,1]
    v_pk_fma_f32 v[20:21], v[134:135], v[100:101], v[20:21] op_sel:[0,0,0] op_sel_hi:[0,1,1]
    v_pk_fma_f32 v[22:23], v[134:135], v[102:103], v[22:23] op_sel:[0,0,0] op_sel_hi:[0,1,1]
    s_set_gpr_idx_off
    v_lshlrev_b32_sdwa v138, v15, v124 dst_sel:DWORD dst_unused:UNUSED_PAD src0_sel:DWORD src1_sel:WORD_1
    s_waitcnt vmcnt(5)
    v_mfma_f32_4x4x4_16b_bf16 v[96:99], v[140:141], v[80:81], 0 cbsz:4 abid:3
    v_readlane_b32 s50, v164, 18
    v_mfma_f32_4x4x4_16b_bf16 v[100:103], v[140:141], v[82:83], 0 cbsz:4 abid:3
    v_lshlrev_b32_sdwa v139, v15, v125 dst_sel:DWORD dst_unused:UNUSED_PAD src0_sel:DWORD src1_sel:WORD_1
    ds_read_u16_d16_hi v130, v138 offset:32768
    ds_read_u16_d16_hi v131, v139 offset:32768
    s_and_b32 s33, s50, s34
    buffer_load_dwordx4 v[72:75], v1, s[12:15], s33 offen
    s_set_gpr_idx_on s59, 0xc
    v_pk_fma_f32 v[16:17], v[132:133], v[104:105], v[16:17] op_sel:[1,0,0] op_sel_hi:[1,1,1]
    v_pk_fma_f32 v[18:19], v[132:133], v[106:107], v[18:19] op_sel:[1,0,0] op_sel_hi:[1,1,1]
    v_pk_fma_f32 v[20:21], v[134:135], v[108:109], v[20:21] op_sel:[1,0,0] op_sel_hi:[1,1,1]
    v_pk_fma_f32 v[22:23], v[134:135], v[110:111], v[22:23] op_sel:[1,0,0] op_sel_hi:[1,1,1]
    s_set_gpr_idx_off
A_12:
    s_sub_u32 s31, s31, 4
    s_cbranch_scc1 B_12
    v_mfma_f32_4x4x4_16b_bf16 v[116:119], v[172:173], v[178:179], 0 cbsz:4 abid:4
    v_lshlrev_b32_sdwa v136, v15, v122 dst_sel:DWORD dst_unused:UNUSED_PAD src0_sel:DWORD src1_sel:WORD_1
    s_waitcnt vmcnt(5)
    v_mfma_f32_4x4x4_16b_bf16 v[104:107], v[142:143], v[84:85], 0 cbsz:4 abid:3
    v_readlane_b32 s51, v164, 19
    v_mfma_f32_4x4x4_16b_bf16 v[108:111], v[142:143], v[86:87], 0 cbsz:4 abid:3
    v_lshlrev_b32_sdwa v137, v15, v123 dst_sel:DWORD dst_unused:UNUSED_PAD src0_sel:DWORD src1_sel:WORD_1
    ds_read_u16_d16_hi v132, v136 offset:32768
    ds_read_u16_d16_hi v133, v137 offset:32768
    s_and_b32 s33, s51, s34
    buffer_load_dwordx4 v[76:79], v1, s[12:15], s33 offen
    s_waitcnt lgkmcnt(2)
    s_set_gpr_idx_on s60, 0xc
    v_pk_fma_f32 v[16:17], v[128:129], v[96:97], v[16:17] op_sel:[0,0,0] op_sel_hi:[0,1,1]
    v_pk_fma_f32 v[18:19], v[128:129], v[98:99], v[18:19] op_sel:[0,0,0] op_sel_hi:[0,1,1]
    v_pk_fma_f32 v[20:21], v[130:131], v[100:101], v[20:21] op_sel:[0,0,0] op_sel_hi:[0,1,1]
    v_pk_fma_f32 v[22:23], v[130:131], v[102:103], v[22:23] op_sel:[0,0,0] op_sel_hi:[0,1,1]
    s_set_gpr_idx_off
    v_cmp_gt_u32 vcc, s30, v6
    v_add_u32 v6, 64, v6
    v_add_u32 v5, 256, v5
    v_cndmask_b32 v165, 40, v165, vcc
    v_lshrrev_b32 v8, 21, v165
    v_lshlrev_b32 v8, 4, v8
    v_lshlrev_b32 v9, 3, v165
    ds_read_b128 v[168:171], v8 offset:8192
    v_and_b32 v9, 0xfffc00, v9
    v_and_or_b32 v165, v165, 56, v9
    v_lshlrev_b32_sdwa v138, v15, v126 dst_sel:DWORD dst_unused:UNUSED_PAD src0_sel:DWORD src1_sel:WORD_1
    s_waitcnt vmcnt(5)
    v_mfma_f32_4x4x4_16b_bf16 v[96:99], v[144:145], v[88:89], 0 cbsz:4 abid:3
    v_readlane_b32 s52, v164, 20
    v_mfma_f32_4x4x4_16b_bf16 v[100:103], v[144:145], v[90:91], 0 cbsz:4 abid:3
    v_lshlrev_b32_sdwa v139, v15, v127 dst_sel:DWORD dst_unused:UNUSED_PAD src0_sel:DWORD src1_sel:WORD_1
    ds_read_u16_d16_hi v134, v138 offset:32768
    ds_read_u16_d16_hi v135, v139 offset:32768
    s_and_b32 s33, s52, s34
    buffer_load_dwordx4 v[80:83], v1, s[12:15], s33 offen
    s_set_gpr_idx_on s61, 0xc
    v_pk_fma_f32 v[16:17], v[128:129], v[104:105], v[16:17] op_sel:[1,0,0] op_sel_hi:[1,1,1]
    v_pk_fma_f32 v[18:19], v[128:129], v[106:107], v[18:19] op_sel:[1,0,0] op_sel_hi:[1,1,1]
    v_pk_fma_f32 v[20:21], v[130:131], v[108:109], v[20:21] op_sel:[1,0,0] op_sel_hi:[1,1,1]
    v_pk_fma_f32 v[22:23], v[130:131], v[110:111], v[22:23] op_sel:[1,0,0] op_sel_hi:[1,1,1]
    s_set_gpr_idx_off
    v_mfma_f32_4x4x4_16b_bf16 v[120:123], v[172:173], v[176:177], 0 cbsz:4 abid:5
    v_lshlrev_b32_sdwa v136, v15, v112 dst_sel:DWORD dst_unused:UNUSED_PAD src0_sel:DWORD src1_sel:WORD_1
    s_waitcnt vmcnt(5)
    v_mfma_f32_4x4x4_16b_bf16 v[104:107], v[146:147], v[92:93], 0 cbsz:4 abid:3
    v_readlane_b32 s53, v164, 21
    v_mfma_f32_4x4x4_16b_bf16 v[108:111], v[146:147], v[94:95], 0 cbsz:4 abid:3
    v_lshlrev_b32_sdwa v137, v15, v113 dst_sel:DWORD dst_unused:UNUSED_PAD src0_sel:DWORD src1_sel:WORD_1
    ds_read_u16_d16_hi v128, v136 offset:32768
    ds_read_u16_d16_hi v129, v137 offset:32768
    s_and_b32 s33, s53, s34
    buffer_load_dwordx4 v[84:87], v1, s[12:15], s33 offen
    s_waitcnt lgkmcnt(2)
    s_set_gpr_idx_on s62, 0xc
    v_pk_fma_f32 v[16:17], v[132:133], v[96:97], v[16:17] op_sel:[0,0,0] op_sel_hi:[0,1,1]
    v_pk_fma_f32 v[18:19], v[132:133], v[98:99], v[18:19] op_sel:[0,0,0] op_sel_hi:[0,1,1]
    v_pk_fma_f32 v[20:21], v[134:135], v[100:101], v[20:21] op_sel:[0,0,0] op_sel_hi:[0,1,1]
    v_pk_fma_f32 v[22:23], v[134:135], v[102:103], v[22:23] op_sel:[0,0,0] op_sel_hi:[0,1,1]
    s_set_gpr_idx_off
    v_lshlrev_b32_sdwa v138, v15, v116 dst_sel:DWORD dst_unused:UNUSED_PAD src0_sel:DWORD src1_sel:WORD_1
    s_waitcnt vmcnt(5)
    v_mfma_f32_4x4x4_16b_bf16 v[96:99], v[140:141], v[64:65], 0 cbsz:4 abid:4
    v_readlane_b32 s54, v164, 22
    v_mfma_f32_4x4x4_16b_bf16 v[100:103], v[140:141], v[66:67], 0 cbsz:4 abid:4
    v_lshlrev_b32_sdwa v139, v15, v117 dst_sel:DWORD dst_unused:UNUSED_PAD src0_sel:DWORD src1_sel:WORD_1
    ds_read_u16_d16_hi v130, v138 offset:32768
    ds_read_u16_d16_hi v131, v139 offset:32768
    s_and_b32 s33, s54, s34
    buffer_load_dwordx4 v[88:91], v1, s[12:15], s33 offen
    s_set_gpr_idx_on s63, 0xc
    v_pk_fma_f32 v[16:17], v[132:133], v[104:105], v[16:17] op_sel:[1,0,0] op_sel_hi:[1,1,1]
    v_pk_fma_f32 v[18:19], v[132:133], v[106:107], v[18:19] op_sel:[1,0,0] op_sel_hi:[1,1,1]
    v_pk_fma_f32 v[20:21], v[134:135], v[108:109], v[20:21] op_sel:[1,0,0] op_sel_hi:[1,1,1]
    v_pk_fma_f32 v[22:23], v[134:135], v[110:111], v[22:23] op_sel:[1,0,0] op_sel_hi:[1,1,1]
    s_set_gpr_idx_off
A_16:
    s_sub_u32 s31, s31, 4
    s_cbranch_scc1 B_16
    v_mfma_f32_4x4x4_16b_bf16 v[124:127], v[172:173], v[178:179], 0 cbsz:4 abid:5
    v_lshlrev_b32_sdwa v136, v15, v114 dst_sel:DWORD dst_unused:UNUSED_PAD src0_sel:DWORD src1_sel:WORD_1
    s_waitcnt vmcnt(5)
    v_mfma_f32_4x4x4_16b_bf16 v[104:107], v[142:143], v[68:69], 0 cbsz:4 abid:4
    v_readlane_b32 s55, v164, 23
    v_mfma_f32_4x4x4_16b_bf16 v[108:111], v[142:143], v[70:71], 0 cbsz:4 abid:4
    v_lshlrev_b32_sdwa v137, v15, v115 dst_sel:DWORD dst_unused:UNUSED_PAD src0_sel:DWORD src1_sel:WORD_1
    ds_read_u16_d16_hi v132, v136 offset:32768
    ds_read_u16_d16_hi v133, v137 offset:32768
    s_and_b32 s33, s55, s34
    buffer_load_dwordx4 v[92:95], v1, s[12:15], s33 offen
    s_waitcnt lgkmcnt(2)
    s_set_gpr_idx_on s48, 0xc
    v_pk_fma_f32 v[16:17], v[128:129], v[96:97], v[16:17] op_sel:[0,0,0] op_sel_hi:[0,1,1]
    v_pk_fma_f32 v[18:19], v[128:129], v[98:99], v[18:19] op_sel:[0,0,0] op_sel_hi:[0,1,1]
    v_pk_fma_f32 v[20:21], v[130:131], v[100:101], v[20:21] op_sel:[0,0,0] op_sel_hi:[0,1,1]
    v_pk_fma_f32 v[22:23], v[130:131], v[102:103], v[22:23] op_sel:[0,0,0] op_sel_hi:[0,1,1]
    s_set_gpr_idx_off
    v_lshlrev_b32_sdwa v138, v15, v118 dst_sel:DWORD dst_unused:UNUSED_PAD src0_sel:DWORD src1_sel:WORD_1
    s_waitcnt vmcnt(5)
    v_mfma_f32_4x4x4_16b_bf16 v[96:99], v[144:145], v[72:73], 0 cbsz:4 abid:4
    v_readlane_b32 s56, v164, 24
    v_mfma_f32_4x4x4_16b_bf16 v[100:103], v[144:145], v[74:75], 0 cbsz:4 abid:4
    v_lshlrev_b32_sdwa v139, v15, v119 dst_sel:DWORD dst_unused:UNUSED_PAD src0_sel:DWORD src1_sel:WORD_1
    ds_read_u16_d16_hi v134, v138 offset:32768
    ds_read_u16_d16_hi v135, v139 offset:32768
    s_and_b32 s33, s56, s34
    buffer_load_dwordx4 v[64:67], v1, s[12:15], s33 offen
    s_set_gpr_idx_on s49, 0xc
    v_pk_fma_f32 v[16:17], v[128:129], v[104:105], v[16:17] op_sel:[1,0,0] op_sel_hi:[1,1,1]
    v_pk_fma_f32 v[18:19], v[128:129], v[106:107], v[18:19] op_sel:[1,0,0] op_sel_hi:[1,1,1]
    v_pk_fma_f32 v[20:21], v[130:131], v[108:109], v[20:21] op_sel:[1,0,0] op_sel_hi:[1,1,1]
    v_pk_fma_f32 v[22:23], v[130:131], v[110:111], v[22:23] op_sel:[1,0,0] op_sel_hi:[1,1,1]
    s_set_gpr_idx_off
    v_mfma_f32_4x4x4_16b_bf16 v[112:115], v[172:173], v[176:177], 0 cbsz:4 abid:6
    v_lshlrev_b32_sdwa v136, v15, v120 dst_sel:DWORD dst_unused:UNUSED_PAD src0_sel:DWORD src1_sel:WORD_1
    s_waitcnt vmcnt(5)
    v_mfma_f32_4x4x4_16b_bf16 v[104:107], v[146:147], v[76:77], 0 cbsz:4 abid:4
    v_readlane_b32 s57, v164, 25
    v_mfma_f32_4x4x4_16b_bf16 v[108:111], v[146:147], v[78:79], 0 cbsz:4 abid:4
    v_lshlrev_b32_sdwa v137, v15, v121 dst_sel:DWORD dst_unused:UNUSED_PAD src0_sel:DWORD src1_sel:WORD_1
    ds_read_u16_d16_hi v128, v136 offset:32768
    ds_read_u16_d16_hi v129, v137 offset:32768
    s_and_b32 s33, s57, s34
    buffer_load_dwordx4 v[68:71], v1, s[12:15], s33 offen
    s_waitcnt lgkmcnt(2)
    s_set_gpr_idx_on s50, 0xc
    v_pk_fma_f32 v[16:17], v[132:133], v[96:97], v[16:17] op_sel:[0,0,0] op_sel_hi:[0,1,1]
    v_pk_fma_f32 v[18:19], v[132:133], v[98:99], v[18:19] op_sel:[0,0,0] op_sel_hi:[0,1,1]
    v_pk_fma_f32 v[20:21], v[134:135], v[100:101], v[20:21] op_sel:[0,0,0] op_sel_hi:[0,1,1]
    v_pk_fma_f32 v[22:23], v[134:135], v[102:103], v[22:23] op_sel:[0,0,0] op_sel_hi:[0,1,1]
    s_set_gpr_idx_off
    v_lshlrev_b32_sdwa v138, v15, v124 dst_sel:DWORD dst_unused:UNUSED_PAD src0_sel:DWORD src1_sel:WORD_1
    s_waitcnt vmcnt(5)
    v_mfma_f32_4x4x4_16b_bf16 v[96:99], v[140:141], v[80:81], 0 cbsz:4 abid:5
    v_readlane_b32 s58, v164, 26
    v_mfma_f32_4x4x4_16b_bf16 v[100:103], v[140:141], v[82:83], 0 cbsz:4 abid:5
    v_lshlrev_b32_sdwa v139, v15, v125 dst_sel:DWORD dst_unused:UNUSED_PAD src0_sel:DWORD src1_sel:WORD_1
    ds_read_u16_d16_hi v130, v138 offset:32768
    ds_read_u16_d16_hi v131, v139 offset:32768
    s_and_b32 s33, s58, s34
    buffer_load_dwordx4 v[72:75], v1, s[12:15], s33 offen
    s_set_gpr_idx_on s51, 0xc
    v_pk_fma_f32 v[16:17], v[132:133], v[104:105], v[16:17] op_sel:[1,0,0] op_sel_hi:[1,1,1]
    v_pk_fma_f32 v[18:19], v[132:133], v[106:107], v[18:19] op_sel:[1,0,0] op_sel_hi:[1,1,1]
    v_pk_fma_f32 v[20:21], v[134:135], v[108:109], v[20:21] op_sel:[1,0,0] op_sel_hi:[1,1,1]
    v_pk_fma_f32 v[22:23], v[134:135], v[110:111], v[22:23] op_sel:[1,0,0] op_sel_hi:[1,1,1]
    s_set_gpr_idx_off
A_20:
    s_sub_u32 s31, s31, 4
    s_cbranch_scc1 B_20
    v_mfma_f32_4x4x4_16b_bf16 v[116:119], v[172:173], v[178:179], 0 cbsz:4 abid:6
    v_lshlrev_b32_sdwa v136, v15, v122 dst_sel:DWORD dst_unused:UNUSED_PAD src0_sel:DWORD src1_sel:WORD_1
    s_waitcnt vmcnt(5)
    v_mfma_f32_4x4x4_16b_bf16 v[104:107], v[142:143], v[84:85], 0 cbsz:4 abid:5
    v_readlane_b32 s59, v164, 27
    v_mfma_f32_4x4x4_16b_bf16 v[108:111], v[142:143], v[86:87], 0 cbsz:4 abid:5
    v_lshlrev_b32_sdwa v137, v15, v123 dst_sel:DWORD dst_unused:UNUSED_PAD src0_sel:DWORD src1_sel:WORD_1
    ds_read_u16_d16_hi v132, v136 offset:32768
    ds_read_u16_d16_hi v133, v137 offset:32768
    s_and_b32 s33, s59, s34
    buffer_load_dwordx4 v[76:79], v1, s[12:15], s33 offen
    s_waitcnt lgkmcnt(2)
    s_set_gpr_idx_on s52, 0xc
    v_pk_fma_f32 v[16:17], v[128:129], v[96:97], v[16:17] op_sel:[0,0,0] op_sel_hi:[0,1,1]
    v_pk_fma_f32 v[18:19], v[128:129], v[98:99], v[18:19] op_sel:[0,0,0] op_sel_hi:[0,1,1]
    v_pk_fma_f32 v[20:21], v[130:131], v[100:101], v[20:21] op_sel:[0,0,0] op_sel_hi:[0,1,1]
    v_pk_fma_f32 v[22:23], v[130:131], v[102:103], v[22:23] op_sel:[0,0,0] op_sel_hi:[0,1,1]
    s_set_gpr_idx_off
    v_lshlrev_b32_sdwa v138, v15, v126 dst_sel:DWORD dst_unused:UNUSED_PAD src0_sel:DWORD src1_sel:WORD_1
    s_waitcnt vmcnt(5)
    v_mfma_f32_4x4x4_16b_bf16 v[96:99], v[144:145], v[88:89], 0 cbsz:4 abid:5
    v_readlane_b32 s60, v164, 28
    v_mfma_f32_4x4x4_16b_bf16 v[100:103], v[144:145], v[90:91], 0 cbsz:4 abid:5
    v_lshlrev_b32_sdwa v139, v15, v127 dst_sel:DWORD dst_unused:UNUSED_PAD src0_sel:DWORD src1_sel:WORD_1
    ds_read_u16_d16_hi v134, v138 offset:32768
    ds_read_u16_d16_hi v135, v139 offset:32768
    s_and_b32 s33, s60, s34
    buffer_load_dwordx4 v[80:83], v1, s[12:15], s33 offen
    s_set_gpr_idx_on s53, 0xc
    v_pk_fma_f32 v[16:17], v[128:129], v[104:105], v[16:17] op_sel:[1,0,0] op_sel_hi:[1,1,1]
    v_pk_fma_f32 v[18:19], v[128:129], v[106:107], v[18:19] op_sel:[1,0,0] op_sel_hi:[1,1,1]
    v_pk_fma_f32 v[20:21], v[130:131], v[108:109], v[20:21] op_sel:[1,0,0] op_sel_hi:[1,1,1]
    v_pk_fma_f32 v[22:23], v[130:131], v[110:111], v[22:23] op_sel:[1,0,0] op_sel_hi:[1,1,1]
    s_set_gpr_idx_off
    v_mfma_f32_4x4x4_16b_bf16 v[120:123], v[172:173], v[176:177], 0 cbsz:4 abid:7
    v_lshlrev_b32_sdwa v136, v15, v112 dst_sel:DWORD dst_unused:UNUSED_PAD src0_sel:DWORD src1_sel:WORD_1
    s_waitcnt vmcnt(5)
    v_mfma_f32_4x4x4_16b_bf16 v[104:107], v[146:147], v[92:93], 0 cbsz:4 abid:5
    v_readlane_b32 s61, v164, 29
    v_mfma_f32_4x4x4_16b_bf16 v[108:111], v[146:147], v[94:95], 0 cbsz:4 abid:5
    v_lshlrev_b32_sdwa v137, v15, v113 dst_sel:DWORD dst_unused:UNUSED_PAD src0_sel:DWORD src1_sel:WORD_1
    ds_read_u16_d16_hi v128, v136 offset:32768
    ds_read_u16_d16_hi v129, v137 offset:32768
    s_and_b32 s33, s61, s34
    buffer_load_dwordx4 v[84:87], v1, s[12:15], s33 offen
    s_waitcnt lgkmcnt(2)
    s_set_gpr_idx_on s54, 0xc
    v_pk_fma_f32 v[16:17], v[132:133], v[96:97], v[16:17] op_sel:[0,0,0] op_sel_hi:[0,1,1]
    v_pk_fma_f32 v[18:19], v[132:133], v[98:99], v[18:19] op_sel:[0,0,0] op_sel_hi:[0,1,1]
    v_pk_fma_f32 v[20:21], v[134:135], v[100:101], v[20:21] op_sel:[0,0,0] op_sel_hi:[0,1,1]
    v_pk_fma_f32 v[22:23], v[134:135], v[102:103], v[22:23] op_sel:[0,0,0] op_sel_hi:[0,1,1]
    s_set_gpr_idx_off
    v_lshlrev_b32_sdwa v138, v15, v116 dst_sel:DWORD dst_unused:UNUSED_PAD src0_sel:DWORD src1_sel:WORD_1
    s_waitcnt vmcnt(5)
    v_mfma_f32_4x4x4_16b_bf16 v[96:99], v[140:141], v[64:65], 0 cbsz:4 abid:6
    v_readlane_b32 s62, v164, 30
    v_mfma_f32_4x4x4_16b_bf16 v[100:103], v[140:141], v[66:67], 0 cbsz:4 abid:6
    v_lshlrev_b32_sdwa v139, v15, v117 dst_sel:DWORD dst_unused:UNUSED_PAD src0_sel:DWORD src1_sel:WORD_1
    ds_read_u16_d16_hi v130, v138 offset:32768
    ds_read_u16_d16_hi v131, v139 offset:32768
    s_and_b32 s33, s62, s34
    buffer_load_dwordx4 v[88:91], v1, s[12:15], s33 offen
    s_set_gpr_idx_on s55, 0xc
    v_pk_fma_f32 v[16:17], v[132:133], v[104:105], v[16:17] op_sel:[1,0,0] op_sel_hi:[1,1,1]
    v_pk_fma_f32 v[18:19], v[132:133], v[106:107], v[18:19] op_sel:[1,0,0] op_sel_hi:[1,1,1]
    v_pk_fma_f32 v[20:21], v[134:135], v[108:109], v[20:21] op_sel:[1,0,0] op_sel_hi:[1,1,1]
    v_pk_fma_f32 v[22:23], v[134:135], v[110:111], v[22:23] op_sel:[1,0,0] op_sel_hi:[1,1,1]
    s_set_gpr_idx_off
A_24:
    s_sub_u32 s31, s31, 4
    s_cbranch_scc1 B_24
    v_mfma_f32_4x4x4_16b_bf16 v[124:127], v[172:173], v[178:179], 0 cbsz:4 abid:7
    v_lshlrev_b32_sdwa v136, v15, v114 dst_sel:DWORD dst_unused:UNUSED_PAD src0_sel:DWORD src1_sel:WORD_1
    s_waitcnt vmcnt(5)
    v_mfma_f32_4x4x4_16b_bf16 v[104:107], v[142:143], v[68:69], 0 cbsz:4 abid:6
    v_readlane_b32 s63, v164, 31
    v_mfma_f32_4x4x4_16b_bf16 v[108:111], v[142:143], v[70:71], 0 cbsz:4 abid:6
    v_lshlrev_b32_sdwa v137, v15, v115 dst_sel:DWORD dst_unused:UNUSED_PAD src0_sel:DWORD src1_sel:WORD_1
    ds_read_u16_d16_hi v132, v136 offset:32768
    ds_read_u16_d16_hi v133, v137 offset:32768
    s_and_b32 s33, s63, s34
    buffer_load_dwordx4 v[92:95], v1, s[12:15], s33 offen
    s_waitcnt lgkmcnt(2)
    s_set_gpr_idx_on s56, 0xc
    v_pk_fma_f32 v[16:17], v[128:129], v[96:97], v[16:17] op_sel:[0,0,0] op_sel_hi:[0,1,1]
    v_pk_fma_f32 v[18:19], v[128:129], v[98:99], v[18:19] op_sel:[0,0,0] op_sel_hi:[0,1,1]
    v_pk_fma_f32 v[20:21], v[130:131], v[100:101], v[20:21] op_sel:[0,0,0] op_sel_hi:[0,1,1]
    v_pk_fma_f32 v[22:23], v[130:131], v[102:103], v[22:23] op_sel:[0,0,0] op_sel_hi:[0,1,1]
    s_set_gpr_idx_off
    v_lshlrev_b32_sdwa v138, v15, v118 dst_sel:DWORD dst_unused:UNUSED_PAD src0_sel:DWORD src1_sel:WORD_1
    s_waitcnt vmcnt(5)
    v_mfma_f32_4x4x4_16b_bf16 v[96:99], v[144:145], v[72:73], 0 cbsz:4 abid:6
    v_readlane_b32 s48, v164, 32
    v_mfma_f32_4x4x4_16b_bf16 v[100:103], v[144:145], v[74:75], 0 cbsz:4 abid:6
    v_lshlrev_b32_sdwa v139, v15, v119 dst_sel:DWORD dst_unused:UNUSED_PAD src0_sel:DWORD src1_sel:WORD_1
    ds_read_u16_d16_hi v134, v138 offset:32768
    ds_read_u16_d16_hi v135, v139 offset:32768
    s_and_b32 s33, s48, s34
    buffer_load_dwordx4 v[64:67], v1, s[12:15], s33 offen
    s_set_gpr_idx_on s57, 0xc
    v_pk_fma_f32 v[16:17], v[128:129], v[104:105], v[16:17] op_sel:[1,0,0] op_sel_hi:[1,1,1]
    v_pk_fma_f32 v[18:19], v[128:129], v[106:107], v[18:19] op_sel:[1,0,0] op_sel_hi:[1,1,1]
    v_pk_fma_f32 v[20:21], v[130:131], v[108:109], v[20:21] op_sel:[1,0,0] op_sel_hi:[1,1,1]
    v_pk_fma_f32 v[22:23], v[130:131], v[110:111], v[22:23] op_sel:[1,0,0] op_sel_hi:[1,1,1]
    s_set_gpr_idx_off
    v_mfma_f32_4x4x4_16b_bf16 v[112:115], v[172:173], v[176:177], 0 cbsz:4 abid:8
    v_lshlrev_b32_sdwa v136, v15, v120 dst_sel:DWORD dst_unused:UNUSED_PAD src0_sel:DWORD src1_sel:WORD_1
    s_waitcnt vmcnt(5)
    v_mfma_f32_4x4x4_16b_bf16 v[104:107], v[146:147], v[76:77], 0 cbsz:4 abid:6
    v_readlane_b32 s49, v164, 33
    v_mfma_f32_4x4x4_16b_bf16 v[108:111], v[146:147], v[78:79], 0 cbsz:4 abid:6
    v_lshlrev_b32_sdwa v137, v15, v121 dst_sel:DWORD dst_unused:UNUSED_PAD src0_sel:DWORD src1_sel:WORD_1
    ds_read_u16_d16_hi v128, v136 offset:32768
    ds_read_u16_d16_hi v129, v137 offset:32768
    s_and_b32 s33, s49, s34
    buffer_load_dwordx4 v[68:71], v1, s[12:15], s33 offen
    s_waitcnt lgkmcnt(2)
    s_set_gpr_idx_on s58, 0xc
    v_pk_fma_f32 v[16:17], v[132:133], v[96:97], v[16:17] op_sel:[0,0,0] op_sel_hi:[0,1,1]
    v_pk_fma_f32 v[18:19], v[132:133], v[98:99], v[18:19] op_sel:[0,0,0] op_sel_hi:[0,1,1]
    v_pk_fma_f32 v[20:21], v[134:135], v[100:101], v[20:21] op_sel:[0,0,0] op_sel_hi:[0,1,1]
    v_pk_fma_f32 v[22:23], v[134:135], v[102:103], v[22:23] op_sel:[0,0,0] op_sel_hi:[0,1,1]
    s_set_gpr_idx_off
    v_lshlrev_b32_sdwa v138, v15, v124 dst_sel:DWORD dst_unused:UNUSED_PAD src0_sel:DWORD src1_sel:WORD_1
    s_waitcnt vmcnt(5)
    v_mfma_f32_4x4x4_16b_bf16 v[96:99], v[140:141], v[80:81], 0 cbsz:4 abid:7
    v_readlane_b32 s50, v164, 34
    v_mfma_f32_4x4x4_16b_bf16 v[100:103], v[140:141], v[82:83], 0 cbsz:4 abid:7
    v_lshlrev_b32_sdwa v139, v15, v125 dst_sel:DWORD dst_unused:UNUSED_PAD src0_sel:DWORD src1_sel:WORD_1
    ds_read_u16_d16_hi v130, v138 offset:32768
    ds_read_u16_d16_hi v131, v139 offset:32768
    s_and_b32 s33, s50, s34
    buffer_load_dwordx4 v[72:75], v1, s[12:15], s33 offen
    s_set_gpr_idx_on s59, 0xc
    v_pk_fma_f32 v[16:17], v[132:133], v[104:105], v[16:17] op_sel:[1,0,0] op_sel_hi:[1,1,1]
    v_pk_fma_f32 v[18:19], v[132:133], v[106:107], v[18:19] op_sel:[1,0,0] op_sel_hi:[1,1,1]
    v_pk_fma_f32 v[20:21], v[134:135], v[108:109], v[20:21] op_sel:[1,0,0] op_sel_hi:[1,1,1]
    v_pk_fma_f32 v[22:23], v[134:135], v[110:111], v[22:23] op_sel:[1,0,0] op_sel_hi:[1,1,1]
    s_set_gpr_idx_off
A_28:
    s_sub_u32 s31, s31, 4
    s_cbranch_scc1 B_28
    v_mfma_f32_4x4x4_16b_bf16 v[116:119], v[172:173], v[178:179], 0 cbsz:4 abid:8
    v_lshlrev_b32_sdwa v136, v15, v122 dst_sel:DWORD dst_unused:UNUSED_PAD src0_sel:DWORD src1_sel:WORD_1
    s_waitcnt vmcnt(5)
    v_mfma_f32_4x4x4_16b_bf16 v[104:107], v[142:143], v[84:85], 0 cbsz:4 abid:7
    v_readlane_b32 s51, v164, 35
    v_mfma_f32_4x4x4_16b_bf16 v[108:111], v[142:143], v[86:87], 0 cbsz:4 abid:7
    v_lshlrev_b32_sdwa v137, v15, v123 dst_sel:DWORD dst_unused:UNUSED_PAD src0_sel:DWORD src1_sel:WORD_1
    ds_read_u16_d16_hi v132, v136 offset:32768
    ds_read_u16_d16_hi v133, v137 offset:32768
    s_and_b32 s33, s51, s34
    buffer_load_dwordx4 v[76:79], v1, s[12:15], s33 offen
    s_waitcnt lgkmcnt(2)
    s_set_gpr_idx_on s60, 0xc
    v_pk_fma_f32 v[16:17], v[128:129], v[96:97], v[16:17] op_sel:[0,0,0] op_sel_hi:[0,1,1]
    v_pk_fma_f32 v[18:19], v[128:129], v[98:99], v[18:19] op_sel:[0,0,0] op_sel_hi:[0,1,1]
    v_pk_fma_f32 v[20:21], v[130:131], v[100:101], v[20:21] op_sel:[0,0,0] op_sel_hi:[0,1,1]
    v_pk_fma_f32 v[22:23], v[130:131], v[102:103], v[22:23] op_sel:[0,0,0] op_sel_hi:[0,1,1]
    s_set_gpr_idx_off
    v_lshlrev_b32_sdwa v138, v15, v126 dst_sel:DWORD dst_unused:UNUSED_PAD src0_sel:DWORD src1_sel:WORD_1
    s_waitcnt vmcnt(5)
    v_mfma_f32_4x4x4_16b_bf16 v[96:99], v[144:145], v[88:89], 0 cbsz:4 abid:7
    v_readlane_b32 s52, v164, 36
    v_mfma_f32_4x4x4_16b_bf16 v[100:103], v[144:145], v[90:91], 0 cbsz:4 abid:7
    v_lshlrev_b32_sdwa v139, v15, v127 dst_sel:DWORD dst_unused:UNUSED_PAD src0_sel:DWORD src1_sel:WORD_1
    ds_read_u16_d16_hi v134, v138 offset:32768
    ds_read_u16_d16_hi v135, v139 offset:32768
    s_and_b32 s33, s52, s34
    buffer_load_dwordx4 v[80:83], v1, s[12:15], s33 offen
    s_set_gpr_idx_on s61, 0xc
    v_pk_fma_f32 v[16:17], v[128:129], v[104:105], v[16:17] op_sel:[1,0,0] op_sel_hi:[1,1,1]
    v_pk_fma_f32 v[18:19], v[128:129], v[106:107], v[18:19] op_sel:[1,0,0] op_sel_hi:[1,1,1]
    v_pk_fma_f32 v[20:21], v[130:131], v[108:109], v[20:21] op_sel:[1,0,0] op_sel_hi:[1,1,1]
    v_pk_fma_f32 v[22:23], v[130:131], v[110:111], v[22:23] op_sel:[1,0,0] op_sel_hi:[1,1,1]
    s_set_gpr_idx_off
    v_mfma_f32_4x4x4_16b_bf16 v[120:123], v[172:173], v[176:177], 0 cbsz:4 abid:9
    v_lshlrev_b32_sdwa v136, v15, v112 dst_sel:DWORD dst_unused:UNUSED_PAD src0_sel:DWORD src1_sel:WORD_1
    s_waitcnt vmcnt(5)
    v_mfma_f32_4x4x4_16b_bf16 v[104:107], v[146:147], v[92:93], 0 cbsz:4 abid:7
    v_readlane_b32 s53, v164, 37
    v_mfma_f32_4x4x4_16b_bf16 v[108:111], v[146:147], v[94:95], 0 cbsz:4 abid:7
    v_lshlrev_b32_sdwa v137, v15, v113 dst_sel:DWORD dst_unused:UNUSED_PAD src0_sel:DWORD src1_sel:WORD_1
    ds_read_u16_d16_hi v128, v136 offset:32768
    ds_read_u16_d16_hi v129, v137 offset:32768
    s_and_b32 s33, s53, s34
    buffer_load_dwordx4 v[84:87], v1, s[12:15], s33 offen
    s_waitcnt lgkmcnt(2)
    s_set_gpr_idx_on s62, 0xc
    v_pk_fma_f32 v[16:17], v[132:133], v[96:97], v[16:17] op_sel:[0,0,0] op_sel_hi:[0,1,1]
    v_pk_fma_f32 v[18:19], v[132:133], v[98:99], v[18:19] op_sel:[0,0,0] op_sel_hi:[0,1,1]
    v_pk_fma_f32 v[20:21], v[134:135], v[100:101], v[20:21] op_sel:[0,0,0] op_sel_hi:[0,1,1]
    v_pk_fma_f32 v[22:23], v[134:135], v[102:103], v[22:23] op_sel:[0,0,0] op_sel_hi:[0,1,1]
    s_set_gpr_idx_off
    v_lshlrev_b32_sdwa v138, v15, v116 dst_sel:DWORD dst_unused:UNUSED_PAD src0_sel:DWORD src1_sel:WORD_1
    s_waitcnt vmcnt(5)
    v_mfma_f32_4x4x4_16b_bf16 v[96:99], v[140:141], v[64:65], 0 cbsz:4 abid:8
    v_readlane_b32 s54, v164, 38
    v_mfma_f32_4x4x4_16b_bf16 v[100:103], v[140:141], v[66:67], 0 cbsz:4 abid:8
    v_lshlrev_b32_sdwa v139, v15, v117 dst_sel:DWORD dst_unused:UNUSED_PAD src0_sel:DWORD src1_sel:WORD_1
    ds_read_u16_d16_hi v130, v138 offset:32768
    ds_read_u16_d16_hi v131, v139 offset:32768
    s_and_b32 s33, s54, s34
    buffer_load_dwordx4 v[88:91], v1, s[12:15], s33 offen
    s_set_gpr_idx_on s63, 0xc
    v_pk_fma_f32 v[16:17], v[132:133], v[104:105], v[16:17] op_sel:[1,0,0] op_sel_hi:[1,1,1]
    v_pk_fma_f32 v[18:19], v[132:133], v[106:107], v[18:19] op_sel:[1,0,0] op_sel_hi:[1,1,1]
    v_pk_fma_f32 v[20:21], v[134:135], v[108:109], v[20:21] op_sel:[1,0,0] op_sel_hi:[1,1,1]
    v_pk_fma_f32 v[22:23], v[134:135], v[110:111], v[22:23] op_sel:[1,0,0] op_sel_hi:[1,1,1]
    s_set_gpr_idx_off
A_32:
    s_sub_u32 s31, s31, 4
    s_cbranch_scc1 B_32
    v_mfma_f32_4x4x4_16b_bf16 v[124:127], v[172:173], v[178:179], 0 cbsz:4 abid:9
    v_lshlrev_b32_sdwa v136, v15, v114 dst_sel:DWORD dst_unused:UNUSED_PAD src0_sel:DWORD src1_sel:WORD_1
    s_waitcnt vmcnt(5)
    v_mfma_f32_4x4x4_16b_bf16 v[104:107], v[142:143], v[68:69], 0 cbsz:4 abid:8
    v_readlane_b32 s55, v164, 39
    v_mfma_f32_4x4x4_16b_bf16 v[108:111], v[142:143], v[70:71], 0 cbsz:4 abid:8
    v_lshlrev_b32_sdwa v137, v15, v115 dst_sel:DWORD dst_unused:UNUSED_PAD src0_sel:DWORD src1_sel:WORD_1
    ds_read_u16_d16_hi v132, v136 offset:32768
    ds_read_u16_d16_hi v133, v137 offset:32768
    s_and_b32 s33, s55, s34
    buffer_load_dwordx4 v[92:95], v1, s[12:15], s33 offen
    s_waitcnt lgkmcnt(2)
    s_set_gpr_idx_on s48, 0xc
    v_pk_fma_f32 v[16:17], v[128:129], v[96:97], v[16:17] op_sel:[0,0,0] op_sel_hi:[0,1,1]
    v_pk_fma_f32 v[18:19], v[128:129], v[98:99], v[18:19] op_sel:[0,0,0] op_sel_hi:[0,1,1]
    v_pk_fma_f32 v[20:21], v[130:131], v[100:101], v[20:21] op_sel:[0,0,0] op_sel_hi:[0,1,1]
    v_pk_fma_f32 v[22:23], v[130:131], v[102:103], v[22:23] op_sel:[0,0,0] op_sel_hi:[0,1,1]
    s_set_gpr_idx_off
    v_lshlrev_b32_sdwa v138, v15, v118 dst_sel:DWORD dst_unused:UNUSED_PAD src0_sel:DWORD src1_sel:WORD_1
    s_waitcnt vmcnt(5)
    v_mfma_f32_4x4x4_16b_bf16 v[96:99], v[144:145], v[72:73], 0 cbsz:4 abid:8
    v_readlane_b32 s56, v164, 40
    v_mfma_f32_4x4x4_16b_bf16 v[100:103], v[144:145], v[74:75], 0 cbsz:4 abid:8
    v_lshlrev_b32_sdwa v139, v15, v119 dst_sel:DWORD dst_unused:UNUSED_PAD src0_sel:DWORD src1_sel:WORD_1
    ds_read_u16_d16_hi v134, v138 offset:32768
    ds_read_u16_d16_hi v135, v139 offset:32768
    s_and_b32 s33, s56, s34
    buffer_load_dwordx4 v[64:67], v1, s[12:15], s33 offen
    s_set_gpr_idx_on s49, 0xc
    v_pk_fma_f32 v[16:17], v[128:129], v[104:105], v[16:17] op_sel:[1,0,0] op_sel_hi:[1,1,1]
    v_pk_fma_f32 v[18:19], v[128:129], v[106:107], v[18:19] op_sel:[1,0,0] op_sel_hi:[1,1,1]
    v_pk_fma_f32 v[20:21], v[130:131], v[108:109], v[20:21] op_sel:[1,0,0] op_sel_hi:[1,1,1]
    v_pk_fma_f32 v[22:23], v[130:131], v[110:111], v[22:23] op_sel:[1,0,0] op_sel_hi:[1,1,1]
    s_set_gpr_idx_off
    v_mfma_f32_4x4x4_16b_bf16 v[112:115], v[172:173], v[176:177], 0 cbsz:4 abid:10
    v_lshlrev_b32_sdwa v136, v15, v120 dst_sel:DWORD dst_unused:UNUSED_PAD src0_sel:DWORD src1_sel:WORD_1
    s_waitcnt vmcnt(5)
    v_mfma_f32_4x4x4_16b_bf16 v[104:107], v[146:147], v[76:77], 0 cbsz:4 abid:8
    v_readlane_b32 s57, v164, 41
    v_mfma_f32_4x4x4_16b_bf16 v[108:111], v[146:147], v[78:79], 0 cbsz:4 abid:8
    v_lshlrev_b32_sdwa v137, v15, v121 dst_sel:DWORD dst_unused:UNUSED_PAD src0_sel:DWORD src1_sel:WORD_1
    ds_read_u16_d16_hi v128, v136 offset:32768
    ds_read_u16_d16_hi v129, v137 offset:32768
    s_and_b32 s33, s57, s34
    buffer_load_dwordx4 v[68:71], v1, s[12:15], s33 offen
    s_waitcnt lgkmcnt(2)
    s_set_gpr_idx_on s50, 0xc
    v_pk_fma_f32 v[16:17], v[132:133], v[96:97], v[16:17] op_sel:[0,0,0] op_sel_hi:[0,1,1]
    v_pk_fma_f32 v[18:19], v[132:133], v[98:99], v[18:19] op_sel:[0,0,0] op_sel_hi:[0,1,1]
    v_pk_fma_f32 v[20:21], v[134:135], v[100:101], v[20:21] op_sel:[0,0,0] op_sel_hi:[0,1,1]
    v_pk_fma_f32 v[22:23], v[134:135], v[102:103], v[22:23] op_sel:[0,0,0] op_sel_hi:[0,1,1]
    s_set_gpr_idx_off
    v_lshlrev_b32_sdwa v138, v15, v124 dst_sel:DWORD dst_unused:UNUSED_PAD src0_sel:DWORD src1_sel:WORD_1
    s_waitcnt vmcnt(5)
    v_mfma_f32_4x4x4_16b_bf16 v[96:99], v[140:141], v[80:81], 0 cbsz:4 abid:9
    v_readlane_b32 s58, v164, 42
    v_mfma_f32_4x4x4_16b_bf16 v[100:103], v[140:141], v[82:83], 0 cbsz:4 abid:9
    v_lshlrev_b32_sdwa v139, v15, v125 dst_sel:DWORD dst_unused:UNUSED_PAD src0_sel:DWORD src1_sel:WORD_1
    ds_read_u16_d16_hi v130, v138 offset:32768
    ds_read_u16_d16_hi v131, v139 offset:32768
    s_and_b32 s33, s58, s34
    buffer_load_dwordx4 v[72:75], v1, s[12:15], s33 offen
    s_set_gpr_idx_on s51, 0xc
    v_pk_fma_f32 v[16:17], v[132:133], v[104:105], v[16:17] op_sel:[1,0,0] op_sel_hi:[1,1,1]
    v_pk_fma_f32 v[18:19], v[132:133], v[106:107], v[18:19] op_sel:[1,0,0] op_sel_hi:[1,1,1]
    v_pk_fma_f32 v[20:21], v[134:135], v[108:109], v[20:21] op_sel:[1,0,0] op_sel_hi:[1,1,1]
    v_pk_fma_f32 v[22:23], v[134:135], v[110:111], v[22:23] op_sel:[1,0,0] op_sel_hi:[1,1,1]
    s_set_gpr_idx_off
A_36:
    s_sub_u32 s31, s31, 4
    s_cbranch_scc1 B_36
    v_mfma_f32_4x4x4_16b_bf16 v[116:119], v[172:173], v[178:179], 0 cbsz:4 abid:10
    v_lshlrev_b32_sdwa v136, v15, v122 dst_sel:DWORD dst_unused:UNUSED_PAD src0_sel:DWORD src1_sel:WORD_1
    s_waitcnt vmcnt(5)
    v_mfma_f32_4x4x4_16b_bf16 v[104:107], v[142:143], v[84:85], 0 cbsz:4 abid:9
    v_readlane_b32 s59, v164, 43
    v_mfma_f32_4x4x4_16b_bf16 v[108:111], v[142:143], v[86:87], 0 cbsz:4 abid:9
    v_lshlrev_b32_sdwa v137, v15, v123 dst_sel:DWORD dst_unused:UNUSED_PAD src0_sel:DWORD src1_sel:WORD_1
    ds_read_u16_d16_hi v132, v136 offset:32768
    ds_read_u16_d16_hi v133, v137 offset:32768
    s_and_b32 s33, s59, s34
    buffer_load_dwordx4 v[76:79], v1, s[12:15], s33 offen
    s_waitcnt lgkmcnt(2)
    s_set_gpr_idx_on s52, 0xc
    v_pk_fma_f32 v[16:17], v[128:129], v[96:97], v[16:17] op_sel:[0,0,0] op_sel_hi:[0,1,1]
    v_pk_fma_f32 v[18:19], v[128:129], v[98:99], v[18:19] op_sel:[0,0,0] op_sel_hi:[0,1,1]
    v_pk_fma_f32 v[20:21], v[130:131], v[100:101], v[20:21] op_sel:[0,0,0] op_sel_hi:[0,1,1]
    v_pk_fma_f32 v[22:23], v[130:131], v[102:103], v[22:23] op_sel:[0,0,0] op_sel_hi:[0,1,1]
    s_set_gpr_idx_off
    v_lshlrev_b32_sdwa v138, v15, v126 dst_sel:DWORD dst_unused:UNUSED_PAD src0_sel:DWORD src1_sel:WORD_1
    s_waitcnt vmcnt(5)
    v_mfma_f32_4x4x4_16b_bf16 v[96:99], v[144:145], v[88:89], 0 cbsz:4 abid:9
    v_readlane_b32 s60, v164, 44
    v_mfma_f32_4x4x4_16b_bf16 v[100:103], v[144:145], v[90:91], 0 cbsz:4 abid:9
    v_lshlrev_b32_sdwa v139, v15, v127 dst_sel:DWORD dst_unused:UNUSED_PAD src0_sel:DWORD src1_sel:WORD_1
    ds_read_u16_d16_hi v134, v138 offset:32768
    ds_read_u16_d16_hi v135, v139 offset:32768
    s_and_b32 s33, s60, s34
    buffer_load_dwordx4 v[80:83], v1, s[12:15], s33 offen
    s_set_gpr_idx_on s53, 0xc
    v_pk_fma_f32 v[16:17], v[128:129], v[104:105], v[16:17] op_sel:[1,0,0] op_sel_hi:[1,1,1]
    v_pk_fma_f32 v[18:19], v[128:129], v[106:107], v[18:19] op_sel:[1,0,0] op_sel_hi:[1,1,1]
    v_pk_fma_f32 v[20:21], v[130:131], v[108:109], v[20:21] op_sel:[1,0,0] op_sel_hi:[1,1,1]
    v_pk_fma_f32 v[22:23], v[130:131], v[110:111], v[22:23] op_sel:[1,0,0] op_sel_hi:[1,1,1]
    s_set_gpr_idx_off
    v_mfma_f32_4x4x4_16b_bf16 v[120:123], v[172:173], v[176:177], 0 cbsz:4 abid:11
    v_lshlrev_b32_sdwa v136, v15, v112 dst_sel:DWORD dst_unused:UNUSED_PAD src0_sel:DWORD src1_sel:WORD_1
    s_waitcnt vmcnt(5)
    v_mfma_f32_4x4x4_16b_bf16 v[104:107], v[146:147], v[92:93], 0 cbsz:4 abid:9
    v_readlane_b32 s61, v164, 45
    v_mfma_f32_4x4x4_16b_bf16 v[108:111], v[146:147], v[94:95], 0 cbsz:4 abid:9
    v_lshlrev_b32_sdwa v137, v15, v113 dst_sel:DWORD dst_unused:UNUSED_PAD src0_sel:DWORD src1_sel:WORD_1
    ds_read_u16_d16_hi v128, v136 offset:32768
    ds_read_u16_d16_hi v129, v137 offset:32768
    s_and_b32 s33, s61, s34
    buffer_load_dwordx4 v[84:87], v1, s[12:15], s33 offen
    s_waitcnt lgkmcnt(2)
    s_set_gpr_idx_on s54, 0xc
    v_pk_fma_f32 v[16:17], v[132:133], v[96:97], v[16:17] op_sel:[0,0,0] op_sel_hi:[0,1,1]
    v_pk_fma_f32 v[18:19], v[132:133], v[98:99], v[18:19] op_sel:[0,0,0] op_sel_hi:[0,1,1]
    v_pk_fma_f32 v[20:21], v[134:135], v[100:101], v[20:21] op_sel:[0,0,0] op_sel_hi:[0,1,1]
    v_pk_fma_f32 v[22:23], v[134:135], v[102:103], v[22:23] op_sel:[0,0,0] op_sel_hi:[0,1,1]
    s_set_gpr_idx_off
    v_lshlrev_b32_sdwa v138, v15, v116 dst_sel:DWORD dst_unused:UNUSED_PAD src0_sel:DWORD src1_sel:WORD_1
    s_waitcnt vmcnt(5)
    v_mfma_f32_4x4x4_16b_bf16 v[96:99], v[140:141], v[64:65], 0 cbsz:4 abid:10
    v_readlane_b32 s62, v164, 46
    v_mfma_f32_4x4x4_16b_bf16 v[100:103], v[140:141], v[66:67], 0 cbsz:4 abid:10
    v_lshlrev_b32_sdwa v139, v15, v117 dst_sel:DWORD dst_unused:UNUSED_PAD src0_sel:DWORD src1_sel:WORD_1
    ds_read_u16_d16_hi v130, v138 offset:32768
    ds_read_u16_d16_hi v131, v139 offset:32768
    s_and_b32 s33, s62, s34
    buffer_load_dwordx4 v[88:91], v1, s[12:15], s33 offen
    s_set_gpr_idx_on s55, 0xc
    v_pk_fma_f32 v[16:17], v[132:133], v[104:105], v[16:17] op_sel:[1,0,0] op_sel_hi:[1,1,1]
    v_pk_fma_f32 v[18:19], v[132:133], v[106:107], v[18:19] op_sel:[1,0,0] op_sel_hi:[1,1,1]
    v_pk_fma_f32 v[20:21], v[134:135], v[108:109], v[20:21] op_sel:[1,0,0] op_sel_hi:[1,1,1]
    v_pk_fma_f32 v[22:23], v[134:135], v[110:111], v[22:23] op_sel:[1,0,0] op_sel_hi:[1,1,1]
    s_set_gpr_idx_off
A_40:
    s_sub_u32 s31, s31, 4
    s_cbranch_scc1 B_40
    v_mfma_f32_4x4x4_16b_bf16 v[124:127], v[172:173], v[178:179], 0 cbsz:4 abid:11
    v_lshlrev_b32_sdwa v136, v15, v114 dst_sel:DWORD dst_unused:UNUSED_PAD src0_sel:DWORD src1_sel:WORD_1
    s_waitcnt vmcnt(5)
    v_mfma_f32_4x4x4_16b_bf16 v[104:107], v[142:143], v[68:69], 0 cbsz:4 abid:10
    v_readlane_b32 s63, v164, 47
    v_mfma_f32_4x4x4_16b_bf16 v[108:111], v[142:143], v[70:71], 0 cbsz:4 abid:10
    v_lshlrev_b32_sdwa v137, v15, v115 dst_sel:DWORD dst_unused:UNUSED_PAD src0_sel:DWORD src1_sel:WORD_1
    ds_read_u16_d16_hi v132, v136 offset:32768
    ds_read_u16_d16_hi v133, v137 offset:32768
    s_and_b32 s33, s63, s34
    buffer_load_dwordx4 v[92:95], v1, s[12:15], s33 offen
    s_waitcnt lgkmcnt(2)
    s_set_gpr_idx_on s56, 0xc
    v_pk_fma_f32 v[16:17], v[128:129], v[96:97], v[16:17] op_sel:[0,0,0] op_sel_hi:[0,1,1]
    v_pk_fma_f32 v[18:19], v[128:129], v[98:99], v[18:19] op_sel:[0,0,0] op_sel_hi:[0,1,1]
    v_pk_fma_f32 v[20:21], v[130:131], v[100:101], v[20:21] op_sel:[0,0,0] op_sel_hi:[0,1,1]
    v_pk_fma_f32 v[22:23], v[130:131], v[102:103], v[22:23] op_sel:[0,0,0] op_sel_hi:[0,1,1]
    s_set_gpr_idx_off
    v_mfma_f32_4x4x4_16b_bf16 v[148:151], v[168:169], v[180:181], 0
    v_lshlrev_b32_sdwa v138, v15, v118 dst_sel:DWORD dst_unused:UNUSED_PAD src0_sel:DWORD src1_sel:WORD_1
    s_waitcnt vmcnt(5)
    v_mfma_f32_4x4x4_16b_bf16 v[96:99], v[144:145], v[72:73], 0 cbsz:4 abid:10
    v_readlane_b32 s48, v164, 48
    v_mfma_f32_4x4x4_16b_bf16 v[100:103], v[144:145], v[74:75], 0 cbsz:4 abid:10
    v_lshlrev_b32_sdwa v139, v15, v119 dst_sel:DWORD dst_unused:UNUSED_PAD src0_sel:DWORD src1_sel:WORD_1
    ds_read_u16_d16_hi v134, v138 offset:32768
    ds_read_u16_d16_hi v135, v139 offset:32768
    s_and_b32 s33, s48, s34
    buffer_load_dwordx4 v[64:67], v1, s[12:15], s33 offen
    s_set_gpr_idx_on s57, 0xc
    v_pk_fma_f32 v[16:17], v[128:129], v[104:105], v[16:17] op_sel:[1,0,0] op_sel_hi:[1,1,1]
    v_pk_fma_f32 v[18:19], v[128:129], v[106:107], v[18:19] op_sel:[1,0,0] op_sel_hi:[1,1,1]
    v_pk_fma_f32 v[20:21], v[130:131], v[108:109], v[20:21] op_sel:[1,0,0] op_sel_hi:[1,1,1]
    v_pk_fma_f32 v[22:23], v[130:131], v[110:111], v[22:23] op_sel:[1,0,0] op_sel_hi:[1,1,1]
    s_set_gpr_idx_off
    v_mfma_f32_4x4x4_16b_bf16 v[112:115], v[172:173], v[176:177], 0 cbsz:4 abid:12
    v_lshlrev_b32_sdwa v136, v15, v120 dst_sel:DWORD dst_unused:UNUSED_PAD src0_sel:DWORD src1_sel:WORD_1
    s_waitcnt vmcnt(5)
    v_mfma_f32_4x4x4_16b_bf16 v[104:107], v[146:147], v[76:77], 0 cbsz:4 abid:10
    v_readlane_b32 s49, v164, 49
    v_mfma_f32_4x4x4_16b_bf16 v[108:111], v[146:147], v[78:79], 0 cbsz:4 abid:10
    v_lshlrev_b32_sdwa v137, v15, v121 dst_sel:DWORD dst_unused:UNUSED_PAD src0_sel:DWORD src1_sel:WORD_1
    ds_read_u16_d16_hi v128, v136 offset:32768
    ds_read_u16_d16_hi v129, v137 offset:32768
    s_and_b32 s33, s49, s34
    buffer_load_dwordx4 v[68:71], v1, s[12:15], s33 offen
    s_waitcnt lgkmcnt(2)
    s_set_gpr_idx_on s58, 0xc
    v_pk_fma_f32 v[16:17], v[132:133], v[96:97], v[16:17] op_sel:[0,0,0] op_sel_hi:[0,1,1]
    v_pk_fma_f32 v[18:19], v[132:133], v[98:99], v[18:19] op_sel:[0,0,0] op_sel_hi:[0,1,1]
    v_pk_fma_f32 v[20:21], v[134:135], v[100:101], v[20:21] op_sel:[0,0,0] op_sel_hi:[0,1,1]
    v_pk_fma_f32 v[22:23], v[134:135], v[102:103], v[22:23] op_sel:[0,0,0] op_sel_hi:[0,1,1]
    s_set_gpr_idx_off
    v_mfma_f32_4x4x4_16b_bf16 v[152:155], v[168:169], v[182:183], 0
    v_lshlrev_b32_sdwa v138, v15, v124 dst_sel:DWORD dst_unused:UNUSED_PAD src0_sel:DWORD src1_sel:WORD_1
    s_waitcnt vmcnt(5)
    v_mfma_f32_4x4x4_16b_bf16 v[96:99], v[140:141], v[80:81], 0 cbsz:4 abid:11
    v_readlane_b32 s50, v164, 50
    v_mfma_f32_4x4x4_16b_bf16 v[100:103], v[140:141], v[82:83], 0 cbsz:4 abid:11
    v_lshlrev_b32_sdwa v139, v15, v125 dst_sel:DWORD dst_unused:UNUSED_PAD src0_sel:DWORD src1_sel:WORD_1
    ds_read_u16_d16_hi v130, v138 offset:32768
    ds_read_u16_d16_hi v131, v139 offset:32768
    s_and_b32 s33, s50, s34
    buffer_load_dwordx4 v[72:75], v1, s[12:15], s33 offen
    s_set_gpr_idx_on s59, 0xc
    v_pk_fma_f32 v[16:17], v[132:133], v[104:105], v[16:17] op_sel:[1,0,0] op_sel_hi:[1,1,1]
    v_pk_fma_f32 v[18:19], v[132:133], v[106:107], v[18:19] op_sel:[1,0,0] op_sel_hi:[1,1,1]
    v_pk_fma_f32 v[20:21], v[134:135], v[108:109], v[20:21] op_sel:[1,0,0] op_sel_hi:[1,1,1]
    v_pk_fma_f32 v[22:23], v[134:135], v[110:111], v[22:23] op_sel:[1,0,0] op_sel_hi:[1,1,1]
    s_set_gpr_idx_off
A_44:
    s_sub_u32 s31, s31, 4
    s_cbranch_scc1 B_44
    v_mfma_f32_4x4x4_16b_bf16 v[116:119], v[172:173], v[178:179], 0 cbsz:4 abid:12
    v_lshlrev_b32_sdwa v136, v15, v122 dst_sel:DWORD dst_unused:UNUSED_PAD src0_sel:DWORD src1_sel:WORD_1
    s_waitcnt vmcnt(5)
    v_mfma_f32_4x4x4_16b_bf16 v[104:107], v[142:143], v[84:85], 0 cbsz:4 abid:11
    v_readlane_b32 s51, v164, 51
    v_mfma_f32_4x4x4_16b_bf16 v[108:111], v[142:143], v[86:87], 0 cbsz:4 abid:11
    v_lshlrev_b32_sdwa v137, v15, v123 dst_sel:DWORD dst_unused:UNUSED_PAD src0_sel:DWORD src1_sel:WORD_1
    ds_read_u16_d16_hi v132, v136 offset:32768
    ds_read_u16_d16_hi v133, v137 offset:32768
    s_and_b32 s33, s51, s34
    buffer_load_dwordx4 v[76:79], v1, s[12:15], s33 offen
    s_waitcnt lgkmcnt(2)
    s_set_gpr_idx_on s60, 0xc
    v_pk_fma_f32 v[16:17], v[128:129], v[96:97], v[16:17] op_sel:[0,0,0] op_sel_hi:[0,1,1]
    v_pk_fma_f32 v[18:19], v[128:129], v[98:99], v[18:19] op_sel:[0,0,0] op_sel_hi:[0,1,1]
    v_pk_fma_f32 v[20:21], v[130:131], v[100:101], v[20:21] op_sel:[0,0,0] op_sel_hi:[0,1,1]
    v_pk_fma_f32 v[22:23], v[130:131], v[102:103], v[22:23] op_sel:[0,0,0] op_sel_hi:[0,1,1]
    s_set_gpr_idx_off
    v_mfma_f32_4x4x4_16b_bf16 v[156:159], v[168:169], v[184:185], 0
    v_lshlrev_b32_sdwa v138, v15, v126 dst_sel:DWORD dst_unused:UNUSED_PAD src0_sel:DWORD src1_sel:WORD_1
    s_waitcnt vmcnt(5)
    v_mfma_f32_4x4x4_16b_bf16 v[96:99], v[144:145], v[88:89], 0 cbsz:4 abid:11
    v_readlane_b32 s52, v164, 52
    v_mfma_f32_4x4x4_16b_bf16 v[100:103], v[144:145], v[90:91], 0 cbsz:4 abid:11
    v_lshlrev_b32_sdwa v139, v15, v127 dst_sel:DWORD dst_unused:UNUSED_PAD src0_sel:DWORD src1_sel:WORD_1
    ds_read_u16_d16_hi v134, v138 offset:32768
    ds_read_u16_d16_hi v135, v139 offset:32768
    s_and_b32 s33, s52, s34
    buffer_load_dwordx4 v[80:83], v1, s[12:15], s33 offen
    s_set_gpr_idx_on s61, 0xc
    v_pk_fma_f32 v[16:17], v[128:129], v[104:105], v[16:17] op_sel:[1,0,0] op_sel_hi:[1,1,1]
    v_pk_fma_f32 v[18:19], v[128:129], v[106:107], v[18:19] op_sel:[1,0,0] op_sel_hi:[1,1,1]
    v_pk_fma_f32 v[20:21], v[130:131], v[108:109], v[20:21] op_sel:[1,0,0] op_sel_hi:[1,1,1]
    v_pk_fma_f32 v[22:23], v[130:131], v[110:111], v[22:23] op_sel:[1,0,0] op_sel_hi:[1,1,1]
    s_set_gpr_idx_off
    v_mfma_f32_4x4x4_16b_bf16 v[120:123], v[172:173], v[176:177], 0 cbsz:4 abid:13
    v_lshlrev_b32_sdwa v136, v15, v112 dst_sel:DWORD dst_unused:UNUSED_PAD src0_sel:DWORD src1_sel:WORD_1
    s_waitcnt vmcnt(5)
    v_mfma_f32_4x4x4_16b_bf16 v[104:107], v[146:147], v[92:93], 0 cbsz:4 abid:11
    v_readlane_b32 s53, v164, 53
    v_mfma_f32_4x4x4_16b_bf16 v[108:111], v[146:147], v[94:95], 0 cbsz:4 abid:11
    v_lshlrev_b32_sdwa v137, v15, v113 dst_sel:DWORD dst_unused:UNUSED_PAD src0_sel:DWORD src1_sel:WORD_1
    ds_read_u16_d16_hi v128, v136 offset:32768
    ds_read_u16_d16_hi v129, v137 offset:32768
    s_and_b32 s33, s53, s34
    buffer_load_dwordx4 v[84:87], v1, s[12:15], s33 offen
    s_waitcnt lgkmcnt(2)
    s_set_gpr_idx_on s62, 0xc
    v_pk_fma_f32 v[16:17], v[132:133], v[96:97], v[16:17] op_sel:[0,0,0] op_sel_hi:[0,1,1]
    v_pk_fma_f32 v[18:19], v[132:133], v[98:99], v[18:19] op_sel:[0,0,0] op_sel_hi:[0,1,1]
    v_pk_fma_f32 v[20:21], v[134:135], v[100:101], v[20:21] op_sel:[0,0,0] op_sel_hi:[0,1,1]
    v_pk_fma_f32 v[22:23], v[134:135], v[102:103], v[22:23] op_sel:[0,0,0] op_sel_hi:[0,1,1]
    s_set_gpr_idx_off
    v_mfma_f32_4x4x4_16b_bf16 v[160:163], v[168:169], v[186:187], 0
    v_lshlrev_b32_sdwa v138, v15, v116 dst_sel:DWORD dst_unused:UNUSED_PAD src0_sel:DWORD src1_sel:WORD_1
    s_waitcnt vmcnt(5)
    v_mfma_f32_4x4x4_16b_bf16 v[96:99], v[140:141], v[64:65], 0 cbsz:4 abid:12
    v_readlane_b32 s54, v164, 54
    v_mfma_f32_4x4x4_16b_bf16 v[100:103], v[140:141], v[66:67], 0 cbsz:4 abid:12
    v_lshlrev_b32_sdwa v139, v15, v117 dst_sel:DWORD dst_unused:UNUSED_PAD src0_sel:DWORD src1_sel:WORD_1
    ds_read_u16_d16_hi v130, v138 offset:32768
    ds_read_u16_d16_hi v131, v139 offset:32768
    s_and_b32 s33, s54, s34
    buffer_load_dwordx4 v[88:91], v1, s[12:15], s33 offen
    s_set_gpr_idx_on s63, 0xc
    v_pk_fma_f32 v[16:17], v[132:133], v[104:105], v[16:17] op_sel:[1,0,0] op_sel_hi:[1,1,1]
    v_pk_fma_f32 v[18:19], v[132:133], v[106:107], v[18:19] op_sel:[1,0,0] op_sel_hi:[1,1,1]
    v_pk_fma_f32 v[20:21], v[134:135], v[108:109], v[20:21] op_sel:[1,0,0] op_sel_hi:[1,1,1]
    v_pk_fma_f32 v[22:23], v[134:135], v[110:111], v[22:23] op_sel:[1,0,0] op_sel_hi:[1,1,1]
    s_set_gpr_idx_off
A_48:
    s_sub_u32 s31, s31, 4
    s_cbranch_scc1 B_48
    v_mfma_f32_4x4x4_16b_bf16 v[124:127], v[172:173], v[178:179], 0 cbsz:4 abid:13
    v_lshlrev_b32_sdwa v136, v15, v114 dst_sel:DWORD dst_unused:UNUSED_PAD src0_sel:DWORD src1_sel:WORD_1
    s_waitcnt vmcnt(5)
    v_mfma_f32_4x4x4_16b_bf16 v[104:107], v[142:143], v[68:69], 0 cbsz:4 abid:12
    v_readlane_b32 s55, v164, 55
    v_mfma_f32_4x4x4_16b_bf16 v[108:111], v[142:143], v[70:71], 0 cbsz:4 abid:12
    v_lshlrev_b32_sdwa v137, v15, v115 dst_sel:DWORD dst_unused:UNUSED_PAD src0_sel:DWORD src1_sel:WORD_1
    ds_read_u16_d16_hi v132, v136 offset:32768
    ds_read_u16_d16_hi v133, v137 offset:32768
    s_and_b32 s33, s55, s34
    buffer_load_dwordx4 v[92:95], v1, s[12:15], s33 offen
    s_waitcnt lgkmcnt(2)
    s_set_gpr_idx_on s48, 0xc
    v_pk_fma_f32 v[16:17], v[128:129], v[96:97], v[16:17] op_sel:[0,0,0] op_sel_hi:[0,1,1]
    v_pk_fma_f32 v[18:19], v[128:129], v[98:99], v[18:19] op_sel:[0,0,0] op_sel_hi:[0,1,1]
    v_pk_fma_f32 v[20:21], v[130:131], v[100:101], v[20:21] op_sel:[0,0,0] op_sel_hi:[0,1,1]
    v_pk_fma_f32 v[22:23], v[130:131], v[102:103], v[22:23] op_sel:[0,0,0] op_sel_hi:[0,1,1]
    s_set_gpr_idx_off
    v_lshlrev_b32_sdwa v138, v15, v118 dst_sel:DWORD dst_unused:UNUSED_PAD src0_sel:DWORD src1_sel:WORD_1
    s_waitcnt vmcnt(5)
    v_mfma_f32_4x4x4_16b_bf16 v[96:99], v[144:145], v[72:73], 0 cbsz:4 abid:12
    v_readlane_b32 s56, v164, 56
    v_mfma_f32_4x4x4_16b_bf16 v[100:103], v[144:145], v[74:75], 0 cbsz:4 abid:12
    v_lshlrev_b32_sdwa v139, v15, v119 dst_sel:DWORD dst_unused:UNUSED_PAD src0_sel:DWORD src1_sel:WORD_1
    ds_read_u16_d16_hi v134, v138 offset:32768
    ds_read_u16_d16_hi v135, v139 offset:32768
    s_and_b32 s33, s56, s34
    buffer_load_dwordx4 v[64:67], v1, s[12:15], s33 offen
    s_set_gpr_idx_on s49, 0xc
    v_pk_fma_f32 v[16:17], v[128:129], v[104:105], v[16:17] op_sel:[1,0,0] op_sel_hi:[1,1,1]
    v_pk_fma_f32 v[18:19], v[128:129], v[106:107], v[18:19] op_sel:[1,0,0] op_sel_hi:[1,1,1]
    v_pk_fma_f32 v[20:21], v[130:131], v[108:109], v[20:21] op_sel:[1,0,0] op_sel_hi:[1,1,1]
    v_pk_fma_f32 v[22:23], v[130:131], v[110:111], v[22:23] op_sel:[1,0,0] op_sel_hi:[1,1,1]
    s_set_gpr_idx_off
    v_mfma_f32_4x4x4_16b_bf16 v[112:115], v[172:173], v[176:177], 0 cbsz:4 abid:14
    v_lshlrev_b32_sdwa v136, v15, v120 dst_sel:DWORD dst_unused:UNUSED_PAD src0_sel:DWORD src1_sel:WORD_1
    s_waitcnt vmcnt(5)
    v_mfma_f32_4x4x4_16b_bf16 v[104:107], v[146:147], v[76:77], 0 cbsz:4 abid:12
    v_readlane_b32 s57, v164, 57
    v_mfma_f32_4x4x4_16b_bf16 v[108:111], v[146:147], v[78:79], 0 cbsz:4 abid:12
    v_lshlrev_b32_sdwa v137, v15, v121 dst_sel:DWORD dst_unused:UNUSED_PAD src0_sel:DWORD src1_sel:WORD_1
    ds_read_u16_d16_hi v128, v136 offset:32768
    ds_read_u16_d16_hi v129, v137 offset:32768
    s_and_b32 s33, s57, s34
    buffer_load_dwordx4 v[68:71], v1, s[12:15], s33 offen
    s_waitcnt lgkmcnt(2)
    s_set_gpr_idx_on s50, 0xc
    v_pk_fma_f32 v[16:17], v[132:133], v[96:97], v[16:17] op_sel:[0,0,0] op_sel_hi:[0,1,1]
    v_pk_fma_f32 v[18:19], v[132:133], v[98:99], v[18:19] op_sel:[0,0,0] op_sel_hi:[0,1,1]
    v_pk_fma_f32 v[20:21], v[134:135], v[100:101], v[20:21] op_sel:[0,0,0] op_sel_hi:[0,1,1]
    v_pk_fma_f32 v[22:23], v[134:135], v[102:103], v[22:23] op_sel:[0,0,0] op_sel_hi:[0,1,1]
    s_set_gpr_idx_off
    v_lshlrev_b32_sdwa v138, v15, v124 dst_sel:DWORD dst_unused:UNUSED_PAD src0_sel:DWORD src1_sel:WORD_1
    s_waitcnt vmcnt(5)
    v_mfma_f32_4x4x4_16b_bf16 v[96:99], v[140:141], v[80:81], 0 cbsz:4 abid:13
    v_readlane_b32 s58, v164, 58
    v_mfma_f32_4x4x4_16b_bf16 v[100:103], v[140:141], v[82:83], 0 cbsz:4 abid:13
    v_lshlrev_b32_sdwa v139, v15, v125 dst_sel:DWORD dst_unused:UNUSED_PAD src0_sel:DWORD src1_sel:WORD_1
    ds_read_u16_d16_hi v130, v138 offset:32768
    ds_read_u16_d16_hi v131, v139 offset:32768
    s_and_b32 s33, s58, s34
    buffer_load_dwordx4 v[72:75], v1, s[12:15], s33 offen
    s_set_gpr_idx_on s51, 0xc
    v_pk_fma_f32 v[16:17], v[132:133], v[104:105], v[16:17] op_sel:[1,0,0] op_sel_hi:[1,1,1]
    v_pk_fma_f32 v[18:19], v[132:133], v[106:107], v[18:19] op_sel:[1,0,0] op_sel_hi:[1,1,1]
    v_pk_fma_f32 v[20:21], v[134:135], v[108:109], v[20:21] op_sel:[1,0,0] op_sel_hi:[1,1,1]
    v_pk_fma_f32 v[22:23], v[134:135], v[110:111], v[22:23] op_sel:[1,0,0] op_sel_hi:[1,1,1]
    s_set_gpr_idx_off
A_52:
    s_sub_u32 s31, s31, 4
    s_cbranch_scc1 B_52
    v_mfma_f32_4x4x4_16b_bf16 v[116:119], v[172:173], v[178:179], 0 cbsz:4 abid:14
    v_lshlrev_b32_sdwa v136, v15, v122 dst_sel:DWORD dst_unused:UNUSED_PAD src0_sel:DWORD src1_sel:WORD_1
    s_waitcnt vmcnt(5)
    v_mfma_f32_4x4x4_16b_bf16 v[104:107], v[142:143], v[84:85], 0 cbsz:4 abid:13
    v_readlane_b32 s59, v164, 59
    v_mfma_f32_4x4x4_16b_bf16 v[108:111], v[142:143], v[86:87], 0 cbsz:4 abid:13
    v_lshlrev_b32_sdwa v137, v15, v123 dst_sel:DWORD dst_unused:UNUSED_PAD src0_sel:DWORD src1_sel:WORD_1
    ds_read_u16_d16_hi v132, v136 offset:32768
    ds_read_u16_d16_hi v133, v137 offset:32768
    s_and_b32 s33, s59, s34
    buffer_load_dwordx4 v[76:79], v1, s[12:15], s33 offen
    s_waitcnt lgkmcnt(2)
    s_set_gpr_idx_on s52, 0xc
    v_pk_fma_f32 v[16:17], v[128:129], v[96:97], v[16:17] op_sel:[0,0,0] op_sel_hi:[0,1,1]
    v_pk_fma_f32 v[18:19], v[128:129], v[98:99], v[18:19] op_sel:[0,0,0] op_sel_hi:[0,1,1]
    v_pk_fma_f32 v[20:21], v[130:131], v[100:101], v[20:21] op_sel:[0,0,0] op_sel_hi:[0,1,1]
    v_pk_fma_f32 v[22:23], v[130:131], v[102:103], v[22:23] op_sel:[0,0,0] op_sel_hi:[0,1,1]
    s_set_gpr_idx_off
    v_lshlrev_b32_sdwa v138, v15, v126 dst_sel:DWORD dst_unused:UNUSED_PAD src0_sel:DWORD src1_sel:WORD_1
    s_waitcnt vmcnt(5)
    v_mfma_f32_4x4x4_16b_bf16 v[96:99], v[144:145], v[88:89], 0 cbsz:4 abid:13
    v_readlane_b32 s60, v164, 60
    v_mfma_f32_4x4x4_16b_bf16 v[100:103], v[144:145], v[90:91], 0 cbsz:4 abid:13
    v_lshlrev_b32_sdwa v139, v15, v127 dst_sel:DWORD dst_unused:UNUSED_PAD src0_sel:DWORD src1_sel:WORD_1
    ds_read_u16_d16_hi v134, v138 offset:32768
    ds_read_u16_d16_hi v135, v139 offset:32768
    s_and_b32 s33, s60, s34
    buffer_load_dwordx4 v[80:83], v1, s[12:15], s33 offen
    s_set_gpr_idx_on s53, 0xc
    v_pk_fma_f32 v[16:17], v[128:129], v[104:105], v[16:17] op_sel:[1,0,0] op_sel_hi:[1,1,1]
    v_pk_fma_f32 v[18:19], v[128:129], v[106:107], v[18:19] op_sel:[1,0,0] op_sel_hi:[1,1,1]
    v_pk_fma_f32 v[20:21], v[130:131], v[108:109], v[20:21] op_sel:[1,0,0] op_sel_hi:[1,1,1]
    v_pk_fma_f32 v[22:23], v[130:131], v[110:111], v[22:23] op_sel:[1,0,0] op_sel_hi:[1,1,1]
    s_set_gpr_idx_off
    v_mfma_f32_4x4x4_16b_bf16 v[120:123], v[172:173], v[176:177], 0 cbsz:4 abid:15
    v_lshlrev_b32_sdwa v136, v15, v112 dst_sel:DWORD dst_unused:UNUSED_PAD src0_sel:DWORD src1_sel:WORD_1
    s_waitcnt vmcnt(5)
    v_mfma_f32_4x4x4_16b_bf16 v[104:107], v[146:147], v[92:93], 0 cbsz:4 abid:13
    v_readlane_b32 s61, v164, 61
    v_mfma_f32_4x4x4_16b_bf16 v[108:111], v[146:147], v[94:95], 0 cbsz:4 abid:13
    v_lshlrev_b32_sdwa v137, v15, v113 dst_sel:DWORD dst_unused:UNUSED_PAD src0_sel:DWORD src1_sel:WORD_1
    ds_read_u16_d16_hi v128, v136 offset:32768
    ds_read_u16_d16_hi v129, v137 offset:32768
    s_and_b32 s33, s61, s34
    buffer_load_dwordx4 v[84:87], v1, s[12:15], s33 offen
    s_waitcnt lgkmcnt(2)
    s_set_gpr_idx_on s54, 0xc
    v_pk_fma_f32 v[16:17], v[132:133], v[96:97], v[16:17] op_sel:[0,0,0] op_sel_hi:[0,1,1]
    v_pk_fma_f32 v[18:19], v[132:133], v[98:99], v[18:19] op_sel:[0,0,0] op_sel_hi:[0,1,1]
    v_pk_fma_f32 v[20:21], v[134:135], v[100:101], v[20:21] op_sel:[0,0,0] op_sel_hi:[0,1,1]
    v_pk_fma_f32 v[22:23], v[134:135], v[102:103], v[22:23] op_sel:[0,0,0] op_sel_hi:[0,1,1]
    s_set_gpr_idx_off
    v_lshlrev_b32_sdwa v138, v15, v116 dst_sel:DWORD dst_unused:UNUSED_PAD src0_sel:DWORD src1_sel:WORD_1
    s_waitcnt vmcnt(5)
    v_mfma_f32_4x4x4_16b_bf16 v[96:99], v[140:141], v[64:65], 0 cbsz:4 abid:14
    v_readlane_b32 s62, v164, 62
    v_mfma_f32_4x4x4_16b_bf16 v[100:103], v[140:141], v[66:67], 0 cbsz:4 abid:14
    v_lshlrev_b32_sdwa v139, v15, v117 dst_sel:DWORD dst_unused:UNUSED_PAD src0_sel:DWORD src1_sel:WORD_1
    ds_read_u16_d16_hi v130, v138 offset:32768
    ds_read_u16_d16_hi v131, v139 offset:32768
    s_and_b32 s33, s62, s34
    buffer_load_dwordx4 v[88:91], v1, s[12:15], s33 offen
    s_set_gpr_idx_on s55, 0xc
    v_pk_fma_f32 v[16:17], v[132:133], v[104:105], v[16:17] op_sel:[1,0,0] op_sel_hi:[1,1,1]
    v_pk_fma_f32 v[18:19], v[132:133], v[106:107], v[18:19] op_sel:[1,0,0] op_sel_hi:[1,1,1]
    v_pk_fma_f32 v[20:21], v[134:135], v[108:109], v[20:21] op_sel:[1,0,0] op_sel_hi:[1,1,1]
    v_pk_fma_f32 v[22:23], v[134:135], v[110:111], v[22:23] op_sel:[1,0,0] op_sel_hi:[1,1,1]
    s_set_gpr_idx_off
A_56:
    s_sub_u32 s31, s31, 4
    s_cbranch_scc1 B_56
    v_mfma_f32_4x4x4_16b_bf16 v[124:127], v[172:173], v[178:179], 0 cbsz:4 abid:15
    v_lshlrev_b32_sdwa v136, v15, v114 dst_sel:DWORD dst_unused:UNUSED_PAD src0_sel:DWORD src1_sel:WORD_1
    s_waitcnt vmcnt(5)
    v_mfma_f32_4x4x4_16b_bf16 v[104:107], v[142:143], v[68:69], 0 cbsz:4 abid:14
    v_readlane_b32 s63, v164, 63
    v_mfma_f32_4x4x4_16b_bf16 v[108:111], v[142:143], v[70:71], 0 cbsz:4 abid:14
    v_lshlrev_b32_sdwa v137, v15, v115 dst_sel:DWORD dst_unused:UNUSED_PAD src0_sel:DWORD src1_sel:WORD_1
    ds_read_u16_d16_hi v132, v136 offset:32768
    ds_read_u16_d16_hi v133, v137 offset:32768
    s_and_b32 s33, s63, s34
    buffer_load_dwordx4 v[92:95], v1, s[12:15], s33 offen
    s_waitcnt lgkmcnt(2)
    s_set_gpr_idx_on s56, 0xc
    v_pk_fma_f32 v[16:17], v[128:129], v[96:97], v[16:17] op_sel:[0,0,0] op_sel_hi:[0,1,1]
    v_pk_fma_f32 v[18:19], v[128:129], v[98:99], v[18:19] op_sel:[0,0,0] op_sel_hi:[0,1,1]
    v_pk_fma_f32 v[20:21], v[130:131], v[100:101], v[20:21] op_sel:[0,0,0] op_sel_hi:[0,1,1]
    v_pk_fma_f32 v[22:23], v[130:131], v[102:103], v[22:23] op_sel:[0,0,0] op_sel_hi:[0,1,1]
    s_set_gpr_idx_off
    v_lshlrev_b32_sdwa v138, v15, v118 dst_sel:DWORD dst_unused:UNUSED_PAD src0_sel:DWORD src1_sel:WORD_1
    s_waitcnt vmcnt(5)
    v_mfma_f32_4x4x4_16b_bf16 v[96:99], v[144:145], v[72:73], 0 cbsz:4 abid:14
    v_readlane_b32 s48, v165, 0
    v_mfma_f32_4x4x4_16b_bf16 v[100:103], v[144:145], v[74:75], 0 cbsz:4 abid:14
    v_lshlrev_b32_sdwa v139, v15, v119 dst_sel:DWORD dst_unused:UNUSED_PAD src0_sel:DWORD src1_sel:WORD_1
    ds_read_u16_d16_hi v134, v138 offset:32768
    ds_read_u16_d16_hi v135, v139 offset:32768
    s_and_b32 s33, s48, s34
    buffer_load_dwordx4 v[64:67], v1, s[12:15], s33 offen
    s_set_gpr_idx_on s57, 0xc
    v_pk_fma_f32 v[16:17], v[128:129], v[104:105], v[16:17] op_sel:[1,0,0] op_sel_hi:[1,1,1]
    v_pk_fma_f32 v[18:19], v[128:129], v[106:107], v[18:19] op_sel:[1,0,0] op_sel_hi:[1,1,1]
    v_pk_fma_f32 v[20:21], v[130:131], v[108:109], v[20:21] op_sel:[1,0,0] op_sel_hi:[1,1,1]
    v_pk_fma_f32 v[22:23], v[130:131], v[110:111], v[22:23] op_sel:[1,0,0] op_sel_hi:[1,1,1]
    s_set_gpr_idx_off
    v_mov_b32 v172, v170
    v_mov_b32 v173, v171
    s_nop 1
    v_mfma_f32_4x4x4_16b_bf16 v[112:115], v[172:173], v[176:177], 0 cbsz:4 abid:0
    v_lshlrev_b32_sdwa v136, v15, v120 dst_sel:DWORD dst_unused:UNUSED_PAD src0_sel:DWORD src1_sel:WORD_1
    s_waitcnt vmcnt(5)
    v_mfma_f32_4x4x4_16b_bf16 v[104:107], v[146:147], v[76:77], 0 cbsz:4 abid:14
    v_readlane_b32 s49, v165, 1
    v_mfma_f32_4x4x4_16b_bf16 v[108:111], v[146:147], v[78:79], 0 cbsz:4 abid:14
    v_lshlrev_b32_sdwa v137, v15, v121 dst_sel:DWORD dst_unused:UNUSED_PAD src0_sel:DWORD src1_sel:WORD_1
    ds_read_u16_d16_hi v128, v136 offset:32768
    ds_read_u16_d16_hi v129, v137 offset:32768
    s_and_b32 s33, s49, s34
    buffer_load_dwordx4 v[68:71], v1, s[12:15], s33 offen
    s_waitcnt lgkmcnt(2)
    s_set_gpr_idx_on s58, 0xc
    v_pk_fma_f32 v[16:17], v[132:133], v[96:97], v[16:17] op_sel:[0,0,0] op_sel_hi:[0,1,1]
    v_pk_fma_f32 v[18:19], v[132:133], v[98:99], v[18:19] op_sel:[0,0,0] op_sel_hi:[0,1,1]
    v_pk_fma_f32 v[20:21], v[134:135], v[100:101], v[20:21] op_sel:[0,0,0] op_sel_hi:[0,1,1]
    v_pk_fma_f32 v[22:23], v[134:135], v[102:103], v[22:23] op_sel:[0,0,0] op_sel_hi:[0,1,1]
    s_set_gpr_idx_off
    v_lshlrev_b32_sdwa v138, v15, v124 dst_sel:DWORD dst_unused:UNUSED_PAD src0_sel:DWORD src1_sel:WORD_1
    s_waitcnt vmcnt(5)
    v_mfma_f32_4x4x4_16b_bf16 v[96:99], v[140:141], v[80:81], 0 cbsz:4 abid:15
    v_readlane_b32 s50, v165, 2
    v_mfma_f32_4x4x4_16b_bf16 v[100:103], v[140:141], v[82:83], 0 cbsz:4 abid:15
    v_lshlrev_b32_sdwa v139, v15, v125 dst_sel:DWORD dst_unused:UNUSED_PAD src0_sel:DWORD src1_sel:WORD_1
    ds_read_u16_d16_hi v130, v138 offset:32768
    ds_read_u16_d16_hi v131, v139 offset:32768
    s_and_b32 s33, s50, s34
    buffer_load_dwordx4 v[72:75], v1, s[12:15], s33 offen
    s_set_gpr_idx_on s59, 0xc
    v_pk_fma_f32 v[16:17], v[132:133], v[104:105], v[16:17] op_sel:[1,0,0] op_sel_hi:[1,1,1]
    v_pk_fma_f32 v[18:19], v[132:133], v[106:107], v[18:19] op_sel:[1,0,0] op_sel_hi:[1,1,1]
    v_pk_fma_f32 v[20:21], v[134:135], v[108:109], v[20:21] op_sel:[1,0,0] op_sel_hi:[1,1,1]
    v_pk_fma_f32 v[22:23], v[134:135], v[110:111], v[22:23] op_sel:[1,0,0] op_sel_hi:[1,1,1]
    s_set_gpr_idx_off
A_60:
    s_sub_u32 s31, s31, 4
    s_cbranch_scc1 B_60
    v_mfma_f32_4x4x4_16b_bf16 v[116:119], v[172:173], v[178:179], 0 cbsz:4 abid:0
    v_lshlrev_b32_sdwa v136, v15, v122 dst_sel:DWORD dst_unused:UNUSED_PAD src0_sel:DWORD src1_sel:WORD_1
    s_waitcnt vmcnt(5)
    v_mfma_f32_4x4x4_16b_bf16 v[104:107], v[142:143], v[84:85], 0 cbsz:4 abid:15
    v_readlane_b32 s51, v165, 3
    v_mfma_f32_4x4x4_16b_bf16 v[108:111], v[142:143], v[86:87], 0 cbsz:4 abid:15
    v_lshlrev_b32_sdwa v137, v15, v123 dst_sel:DWORD dst_unused:UNUSED_PAD src0_sel:DWORD src1_sel:WORD_1
    ds_read_u16_d16_hi v132, v136 offset:32768
    ds_read_u16_d16_hi v133, v137 offset:32768
    v_cvt_pk_bf16_f32 v140, v148, v152
    v_cvt_pk_bf16_f32 v141, v156, v160
    s_and_b32 s33, s51, s34
    buffer_load_dwordx4 v[76:79], v1, s[12:15], s33 offen
    s_waitcnt lgkmcnt(2)
    s_set_gpr_idx_on s60, 0xc
    v_pk_fma_f32 v[16:17], v[128:129], v[96:97], v[16:17] op_sel:[0,0,0] op_sel_hi:[0,1,1]
    v_pk_fma_f32 v[18:19], v[128:129], v[98:99], v[18:19] op_sel:[0,0,0] op_sel_hi:[0,1,1]
    v_pk_fma_f32 v[20:21], v[130:131], v[100:101], v[20:21] op_sel:[0,0,0] op_sel_hi:[0,1,1]
    v_pk_fma_f32 v[22:23], v[130:131], v[102:103], v[22:23] op_sel:[0,0,0] op_sel_hi:[0,1,1]
    s_set_gpr_idx_off
    v_lshlrev_b32_sdwa v138, v15, v126 dst_sel:DWORD dst_unused:UNUSED_PAD src0_sel:DWORD src1_sel:WORD_1
    s_waitcnt vmcnt(5)
    v_mfma_f32_4x4x4_16b_bf16 v[96:99], v[144:145], v[88:89], 0 cbsz:4 abid:15
    v_readlane_b32 s52, v165, 4
    v_mfma_f32_4x4x4_16b_bf16 v[100:103], v[144:145], v[90:91], 0 cbsz:4 abid:15
    v_lshlrev_b32_sdwa v139, v15, v127 dst_sel:DWORD dst_unused:UNUSED_PAD src0_sel:DWORD src1_sel:WORD_1
    ds_read_u16_d16_hi v134, v138 offset:32768
    ds_read_u16_d16_hi v135, v139 offset:32768
    v_cvt_pk_bf16_f32 v142, v149, v153
    v_cvt_pk_bf16_f32 v143, v157, v161
    s_and_b32 s33, s52, s34
    buffer_load_dwordx4 v[80:83], v1, s[12:15], s33 offen
    s_set_gpr_idx_on s61, 0xc
    v_pk_fma_f32 v[16:17], v[128:129], v[104:105], v[16:17] op_sel:[1,0,0] op_sel_hi:[1,1,1]
    v_pk_fma_f32 v[18:19], v[128:129], v[106:107], v[18:19] op_sel:[1,0,0] op_sel_hi:[1,1,1]
    v_pk_fma_f32 v[20:21], v[130:131], v[108:109], v[20:21] op_sel:[1,0,0] op_sel_hi:[1,1,1]
    v_pk_fma_f32 v[22:23], v[130:131], v[110:111], v[22:23] op_sel:[1,0,0] op_sel_hi:[1,1,1]
    s_set_gpr_idx_off
    v_mfma_f32_4x4x4_16b_bf16 v[120:123], v[172:173], v[176:177], 0 cbsz:4 abid:1
    v_lshlrev_b32_sdwa v136, v15, v112 dst_sel:DWORD dst_unused:UNUSED_PAD src0_sel:DWORD src1_sel:WORD_1
    s_waitcnt vmcnt(5)
    v_mfma_f32_4x4x4_16b_bf16 v[104:107], v[146:147], v[92:93], 0 cbsz:4 abid:15
    v_readlane_b32 s53, v165, 5
    v_mfma_f32_4x4x4_16b_bf16 v[108:111], v[146:147], v[94:95], 0 cbsz:4 abid:15
    v_lshlrev_b32_sdwa v137, v15, v113 dst_sel:DWORD dst_unused:UNUSED_PAD src0_sel:DWORD src1_sel:WORD_1
    ds_read_u16_d16_hi v128, v136 offset:32768
    ds_read_u16_d16_hi v129, v137 offset:32768
    v_cvt_pk_bf16_f32 v144, v150, v154
    v_cvt_pk_bf16_f32 v145, v158, v162
    s_and_b32 s33, s53, s34
    buffer_load_dwordx4 v[84:87], v1, s[12:15], s33 offen
    s_waitcnt lgkmcnt(2)
    s_set_gpr_idx_on s62, 0xc
    v_pk_fma_f32 v[16:17], v[132:133], v[96:97], v[16:17] op_sel:[0,0,0] op_sel_hi:[0,1,1]
    v_pk_fma_f32 v[18:19], v[132:133], v[98:99], v[18:19] op_sel:[0,0,0] op_sel_hi:[0,1,1]
    v_pk_fma_f32 v[20:21], v[134:135], v[100:101], v[20:21] op_sel:[0,0,0] op_sel_hi:[0,1,1]
    v_pk_fma_f32 v[22:23], v[134:135], v[102:103], v[22:23] op_sel:[0,0,0] op_sel_hi:[0,1,1]
    s_set_gpr_idx_off
    v_lshlrev_b32_sdwa v138, v15, v116 dst_sel:DWORD dst_unused:UNUSED_PAD src0_sel:DWORD src1_sel:WORD_1
    s_waitcnt vmcnt(5)
    v_mfma_f32_4x4x4_16b_bf16 v[96:99], v[140:141], v[64:65], 0 cbsz:4 abid:0
    v_readlane_b32 s54, v165, 6
    v_mfma_f32_4x4x4_16b_bf16 v[100:103], v[140:141], v[66:67], 0 cbsz:4 abid:0
    v_lshlrev_b32_sdwa v139, v15, v117 dst_sel:DWORD dst_unused:UNUSED_PAD src0_sel:DWORD src1_sel:WORD_1
    ds_read_u16_d16_hi v130, v138 offset:32768
    ds_read_u16_d16_hi v131, v139 offset:32768
    v_cvt_pk_bf16_f32 v146, v151, v155
    v_cvt_pk_bf16_f32 v147, v159, v163
    s_and_b32 s33, s54, s34
    buffer_load_dwordx4 v[88:91], v1, s[12:15], s33 offen
    s_set_gpr_idx_on s63, 0xc
    v_pk_fma_f32 v[16:17], v[132:133], v[104:105], v[16:17] op_sel:[1,0,0] op_sel_hi:[1,1,1]
    v_pk_fma_f32 v[18:19], v[132:133], v[106:107], v[18:19] op_sel:[1,0,0] op_sel_hi:[1,1,1]
    v_pk_fma_f32 v[20:21], v[134:135], v[108:109], v[20:21] op_sel:[1,0,0] op_sel_hi:[1,1,1]
    v_pk_fma_f32 v[22:23], v[134:135], v[110:111], v[22:23] op_sel:[1,0,0] op_sel_hi:[1,1,1]
    s_set_gpr_idx_off
    v_mov_b32 v164, v165
    s_branch A_0
B_0:
    s_sub_u32 s32, s32, 4
    s_cbranch_scc1 MAIN_DONE
    v_mfma_f32_4x4x4_16b_bf16 v[124:127], v[172:173], v[178:179], 0 cbsz:4 abid:1
    v_lshlrev_b32_sdwa v136, v15, v114 dst_sel:DWORD dst_unused:UNUSED_PAD src0_sel:DWORD src1_sel:WORD_1
    s_waitcnt vmcnt(5)
    v_mfma_f32_4x4x4_16b_bf16 v[104:107], v[142:143], v[68:69], 0 cbsz:4 abid:0
    s_nop 0
    v_mfma_f32_4x4x4_16b_bf16 v[108:111], v[142:143], v[70:71], 0 cbsz:4 abid:0
    v_lshlrev_b32_sdwa v137, v15, v115 dst_sel:DWORD dst_unused:UNUSED_PAD src0_sel:DWORD src1_sel:WORD_1
    ds_read_u16_d16_hi v132, v136 offset:32768
    ds_read_u16_d16_hi v133, v137 offset:32768
    s_waitcnt lgkmcnt(2)
    s_set_gpr_idx_on s48, 0xc
    v_pk_fma_f32 v[16:17], v[128:129], v[96:97], v[16:17] op_sel:[0,0,0] op_sel_hi:[0,1,1]
    v_pk_fma_f32 v[18:19], v[128:129], v[98:99], v[18:19] op_sel:[0,0,0] op_sel_hi:[0,1,1]
    v_pk_fma_f32 v[20:21], v[130:131], v[100:101], v[20:21] op_sel:[0,0,0] op_sel_hi:[0,1,1]
    v_pk_fma_f32 v[22:23], v[130:131], v[102:103], v[22:23] op_sel:[0,0,0] op_sel_hi:[0,1,1]
    s_set_gpr_idx_off
    v_lshlrev_b32_sdwa v138, v15, v118 dst_sel:DWORD dst_unused:UNUSED_PAD src0_sel:DWORD src1_sel:WORD_1
    s_waitcnt vmcnt(4)
    v_mfma_f32_4x4x4_16b_bf16 v[96:99], v[144:145], v[72:73], 0 cbsz:4 abid:0
    s_nop 0
    v_mfma_f32_4x4x4_16b_bf16 v[100:103], v[144:145], v[74:75], 0 cbsz:4 abid:0
    v_lshlrev_b32_sdwa v139, v15, v119 dst_sel:DWORD dst_unused:UNUSED_PAD src0_sel:DWORD src1_sel:WORD_1
    ds_read_u16_d16_hi v134, v138 offset:32768
    ds_read_u16_d16_hi v135, v139 offset:32768
    s_set_gpr_idx_on s49, 0xc
    v_pk_fma_f32 v[16:17], v[128:129], v[104:105], v[16:17] op_sel:[1,0,0] op_sel_hi:[1,1,1]
    v_pk_fma_f32 v[18:19], v[128:129], v[106:107], v[18:19] op_sel:[1,0,0] op_sel_hi:[1,1,1]
    v_pk_fma_f32 v[20:21], v[130:131], v[108:109], v[20:21] op_sel:[1,0,0] op_sel_hi:[1,1,1]
    v_pk_fma_f32 v[22:23], v[130:131], v[110:111], v[22:23] op_sel:[1,0,0] op_sel_hi:[1,1,1]
    s_set_gpr_idx_off
    v_mfma_f32_4x4x4_16b_bf16 v[112:115], v[172:173], v[176:177], 0 cbsz:4 abid:2
    v_lshlrev_b32_sdwa v136, v15, v120 dst_sel:DWORD dst_unused:UNUSED_PAD src0_sel:DWORD src1_sel:WORD_1
    s_waitcnt vmcnt(3)
    v_mfma_f32_4x4x4_16b_bf16 v[104:107], v[146:147], v[76:77], 0 cbsz:4 abid:0
    s_nop 0
    v_mfma_f32_4x4x4_16b_bf16 v[108:111], v[146:147], v[78:79], 0 cbsz:4 abid:0
    v_lshlrev_b32_sdwa v137, v15, v121 dst_sel:DWORD dst_unused:UNUSED_PAD src0_sel:DWORD src1_sel:WORD_1
    ds_read_u16_d16_hi v128, v136 offset:32768
    ds_read_u16_d16_hi v129, v137 offset:32768
    s_waitcnt lgkmcnt(2)
    s_set_gpr_idx_on s50, 0xc
    v_pk_fma_f32 v[16:17], v[132:133], v[96:97], v[16:17] op_sel:[0,0,0] op_sel_hi:[0,1,1]
    v_pk_fma_f32 v[18:19], v[132:133], v[98:99], v[18:19] op_sel:[0,0,0] op_sel_hi:[0,1,1]
    v_pk_fma_f32 v[20:21], v[134:135], v[100:101], v[20:21] op_sel:[0,0,0] op_sel_hi:[0,1,1]
    v_pk_fma_f32 v[22:23], v[134:135], v[102:103], v[22:23] op_sel:[0,0,0] op_sel_hi:[0,1,1]
    s_set_gpr_idx_off
    v_lshlrev_b32_sdwa v138, v15, v124 dst_sel:DWORD dst_unused:UNUSED_PAD src0_sel:DWORD src1_sel:WORD_1
    s_waitcnt vmcnt(2)
    v_mfma_f32_4x4x4_16b_bf16 v[96:99], v[140:141], v[80:81], 0 cbsz:4 abid:1
    s_nop 0
    v_mfma_f32_4x4x4_16b_bf16 v[100:103], v[140:141], v[82:83], 0 cbsz:4 abid:1
    v_lshlrev_b32_sdwa v139, v15, v125 dst_sel:DWORD dst_unused:UNUSED_PAD src0_sel:DWORD src1_sel:WORD_1
    ds_read_u16_d16_hi v130, v138 offset:32768
    ds_read_u16_d16_hi v131, v139 offset:32768
    s_set_gpr_idx_on s51, 0xc
    v_pk_fma_f32 v[16:17], v[132:133], v[104:105], v[16:17] op_sel:[1,0,0] op_sel_hi:[1,1,1]
    v_pk_fma_f32 v[18:19], v[132:133], v[106:107], v[18:19] op_sel:[1,0,0] op_sel_hi:[1,1,1]
    v_pk_fma_f32 v[20:21], v[134:135], v[108:109], v[20:21] op_sel:[1,0,0] op_sel_hi:[1,1,1]
    v_pk_fma_f32 v[22:23], v[134:135], v[110:111], v[22:23] op_sel:[1,0,0] op_sel_hi:[1,1,1]
    s_set_gpr_idx_off
B_4:
    s_sub_u32 s32, s32, 4
    s_cbranch_scc1 MAIN_DONE
    v_mfma_f32_4x4x4_16b_bf16 v[116:119], v[172:173], v[178:179], 0 cbsz:4 abid:2
    v_lshlrev_b32_sdwa v136, v15, v122 dst_sel:DWORD dst_unused:UNUSED_PAD src0_sel:DWORD src1_sel:WORD_1
    s_waitcnt vmcnt(5)
    v_mfma_f32_4x4x4_16b_bf16 v[104:107], v[142:143], v[84:85], 0 cbsz:4 abid:1
    s_nop 0
    v_mfma_f32_4x4x4_16b_bf16 v[108:111], v[142:143], v[86:87], 0 cbsz:4 abid:1
    v_lshlrev_b32_sdwa v137, v15, v123 dst_sel:DWORD dst_unused:UNUSED_PAD src0_sel:DWORD src1_sel:WORD_1
    ds_read_u16_d16_hi v132, v136 offset:32768
    ds_read_u16_d16_hi v133, v137 offset:32768
    s_waitcnt lgkmcnt(2)
    s_set_gpr_idx_on s52, 0xc
    v_pk_fma_f32 v[16:17], v[128:129], v[96:97], v[16:17] op_sel:[0,0,0] op_sel_hi:[0,1,1]
    v_pk_fma_f32 v[18:19], v[128:129], v[98:99], v[18:19] op_sel:[0,0,0] op_sel_hi:[0,1,1]
    v_pk_fma_f32 v[20:21], v[130:131], v[100:101], v[20:21] op_sel:[0,0,0] op_sel_hi:[0,1,1]
    v_pk_fma_f32 v[22:23], v[130:131], v[102:103], v[22:23] op_sel:[0,0,0] op_sel_hi:[0,1,1]
    s_set_gpr_idx_off
    v_lshlrev_b32_sdwa v138, v15, v126 dst_sel:DWORD dst_unused:UNUSED_PAD src0_sel:DWORD src1_sel:WORD_1
    s_waitcnt vmcnt(4)
    v_mfma_f32_4x4x4_16b_bf16 v[96:99], v[144:145], v[88:89], 0 cbsz:4 abid:1
    s_nop 0
    v_mfma_f32_4x4x4_16b_bf16 v[100:103], v[144:145], v[90:91], 0 cbsz:4 abid:1
    v_lshlrev_b32_sdwa v139, v15, v127 dst_sel:DWORD dst_unused:UNUSED_PAD src0_sel:DWORD src1_sel:WORD_1
    ds_read_u16_d16_hi v134, v138 offset:32768
    ds_read_u16_d16_hi v135, v139 offset:32768
    s_set_gpr_idx_on s53, 0xc
    v_pk_fma_f32 v[16:17], v[128:129], v[104:105], v[16:17] op_sel:[1,0,0] op_sel_hi:[1,1,1]
    v_pk_fma_f32 v[18:19], v[128:129], v[106:107], v[18:19] op_sel:[1,0,0] op_sel_hi:[1,1,1]
    v_pk_fma_f32 v[20:21], v[130:131], v[108:109], v[20:21] op_sel:[1,0,0] op_sel_hi:[1,1,1]
    v_pk_fma_f32 v[22:23], v[130:131], v[110:111], v[22:23] op_sel:[1,0,0] op_sel_hi:[1,1,1]
    s_set_gpr_idx_off
    v_mfma_f32_4x4x4_16b_bf16 v[120:123], v[172:173], v[176:177], 0 cbsz:4 abid:3
    v_lshlrev_b32_sdwa v136, v15, v112 dst_sel:DWORD dst_unused:UNUSED_PAD src0_sel:DWORD src1_sel:WORD_1
    s_waitcnt vmcnt(3)
    v_mfma_f32_4x4x4_16b_bf16 v[104:107], v[146:147], v[92:93], 0 cbsz:4 abid:1
    s_nop 0
    v_mfma_f32_4x4x4_16b_bf16 v[108:111], v[146:147], v[94:95], 0 cbsz:4 abid:1
    v_lshlrev_b32_sdwa v137, v15, v113 dst_sel:DWORD dst_unused:UNUSED_PAD src0_sel:DWORD src1_sel:WORD_1
    ds_read_u16_d16_hi v128, v136 offset:32768
    ds_read_u16_d16_hi v129, v137 offset:32768
    s_waitcnt lgkmcnt(2)
    s_set_gpr_idx_on s54, 0xc
    v_pk_fma_f32 v[16:17], v[132:133], v[96:97], v[16:17] op_sel:[0,0,0] op_sel_hi:[0,1,1]
    v_pk_fma_f32 v[18:19], v[132:133], v[98:99], v[18:19] op_sel:[0,0,0] op_sel_hi:[0,1,1]
    v_pk_fma_f32 v[20:21], v[134:135], v[100:101], v[20:21] op_sel:[0,0,0] op_sel_hi:[0,1,1]
    v_pk_fma_f32 v[22:23], v[134:135], v[102:103], v[22:23] op_sel:[0,0,0] op_sel_hi:[0,1,1]
    s_set_gpr_idx_off
    v_lshlrev_b32_sdwa v138, v15, v116 dst_sel:DWORD dst_unused:UNUSED_PAD src0_sel:DWORD src1_sel:WORD_1
    s_waitcnt vmcnt(2)
    v_mfma_f32_4x4x4_16b_bf16 v[96:99], v[140:141], v[64:65], 0 cbsz:4 abid:2
    s_nop 0
    v_mfma_f32_4x4x4_16b_bf16 v[100:103], v[140:141], v[66:67], 0 cbsz:4 abid:2
    v_lshlrev_b32_sdwa v139, v15, v117 dst_sel:DWORD dst_unused:UNUSED_PAD src0_sel:DWORD src1_sel:WORD_1
    ds_read_u16_d16_hi v130, v138 offset:32768
    ds_read_u16_d16_hi v131, v139 offset:32768
    s_set_gpr_idx_on s55, 0xc
    v_pk_fma_f32 v[16:17], v[132:133], v[104:105], v[16:17] op_sel:[1,0,0] op_sel_hi:[1,1,1]
    v_pk_fma_f32 v[18:19], v[132:133], v[106:107], v[18:19] op_sel:[1,0,0] op_sel_hi:[1,1,1]
    v_pk_fma_f32 v[20:21], v[134:135], v[108:109], v[20:21] op_sel:[1,0,0] op_sel_hi:[1,1,1]
    v_pk_fma_f32 v[22:23], v[134:135], v[110:111], v[22:23] op_sel:[1,0,0] op_sel_hi:[1,1,1]
    s_set_gpr_idx_off
B_8:
    s_sub_u32 s32, s32, 4
    s_cbranch_scc1 MAIN_DONE
    v_mfma_f32_4x4x4_16b_bf16 v[124:127], v[172:173], v[178:179], 0 cbsz:4 abid:3
    v_lshlrev_b32_sdwa v136, v15, v114 dst_sel:DWORD dst_unused:UNUSED_PAD src0_sel:DWORD src1_sel:WORD_1
    s_waitcnt vmcnt(5)
    v_mfma_f32_4x4x4_16b_bf16 v[104:107], v[142:143], v[68:69], 0 cbsz:4 abid:2
    s_nop 0
    v_mfma_f32_4x4x4_16b_bf16 v[108:111], v[142:143], v[70:71], 0 cbsz:4 abid:2
    v_lshlrev_b32_sdwa v137, v15, v115 dst_sel:DWORD dst_unused:UNUSED_PAD src0_sel:DWORD src1_sel:WORD_1
    ds_read_u16_d16_hi v132, v136 offset:32768
    ds_read_u16_d16_hi v133, v137 offset:32768
    s_waitcnt lgkmcnt(2)
    s_set_gpr_idx_on s56, 0xc
    v_pk_fma_f32 v[16:17], v[128:129], v[96:97], v[16:17] op_sel:[0,0,0] op_sel_hi:[0,1,1]
    v_pk_fma_f32 v[18:19], v[128:129], v[98:99], v[18:19] op_sel:[0,0,0] op_sel_hi:[0,1,1]
    v_pk_fma_f32 v[20:21], v[130:131], v[100:101], v[20:21] op_sel:[0,0,0] op_sel_hi:[0,1,1]
    v_pk_fma_f32 v[22:23], v[130:131], v[102:103], v[22:23] op_sel:[0,0,0] op_sel_hi:[0,1,1]
    s_set_gpr_idx_off
    ds_read_b32 v165, v5
    v_lshlrev_b32_sdwa v138, v15, v118 dst_sel:DWORD dst_unused:UNUSED_PAD src0_sel:DWORD src1_sel:WORD_1
    s_waitcnt vmcnt(4)
    v_mfma_f32_4x4x4_16b_bf16 v[96:99], v[144:145], v[72:73], 0 cbsz:4 abid:2
    s_nop 0
    v_mfma_f32_4x4x4_16b_bf16 v[100:103], v[144:145], v[74:75], 0 cbsz:4 abid:2
    v_lshlrev_b32_sdwa v139, v15, v119 dst_sel:DWORD dst_unused:UNUSED_PAD src0_sel:DWORD src1_sel:WORD_1
    ds_read_u16_d16_hi v134, v138 offset:32768
    ds_read_u16_d16_hi v135, v139 offset:32768
    s_set_gpr_idx_on s57, 0xc
    v_pk_fma_f32 v[16:17], v[128:129], v[104:105], v[16:17] op_sel:[1,0,0] op_sel_hi:[1,1,1]
    v_pk_fma_f32 v[18:19], v[128:129], v[106:107], v[18:19] op_sel:[1,0,0] op_sel_hi:[1,1,1]
    v_pk_fma_f32 v[20:21], v[130:131], v[108:109], v[20:21] op_sel:[1,0,0] op_sel_hi:[1,1,1]
    v_pk_fma_f32 v[22:23], v[130:131], v[110:111], v[22:23] op_sel:[1,0,0] op_sel_hi:[1,1,1]
    s_set_gpr_idx_off
    v_mfma_f32_4x4x4_16b_bf16 v[112:115], v[172:173], v[176:177], 0 cbsz:4 abid:4
    v_lshlrev_b32_sdwa v136, v15, v120 dst_sel:DWORD dst_unused:UNUSED_PAD src0_sel:DWORD src1_sel:WORD_1
    s_waitcnt vmcnt(3)
    v_mfma_f32_4x4x4_16b_bf16 v[104:107], v[146:147], v[76:77], 0 cbsz:4 abid:2
    s_nop 0
    v_mfma_f32_4x4x4_16b_bf16 v[108:111], v[146:147], v[78:79], 0 cbsz:4 abid:2
    v_lshlrev_b32_sdwa v137, v15, v121 dst_sel:DWORD dst_unused:UNUSED_PAD src0_sel:DWORD src1_sel:WORD_1
    ds_read_u16_d16_hi v128, v136 offset:32768
    ds_read_u16_d16_hi v129, v137 offset:32768
    s_waitcnt lgkmcnt(2)
    s_set_gpr_idx_on s58, 0xc
    v_pk_fma_f32 v[16:17], v[132:133], v[96:97], v[16:17] op_sel:[0,0,0] op_sel_hi:[0,1,1]
    v_pk_fma_f32 v[18:19], v[132:133], v[98:99], v[18:19] op_sel:[0,0,0] op_sel_hi:[0,1,1]
    v_pk_fma_f32 v[20:21], v[134:135], v[100:101], v[20:21] op_sel:[0,0,0] op_sel_hi:[0,1,1]
    v_pk_fma_f32 v[22:23], v[134:135], v[102:103], v[22:23] op_sel:[0,0,0] op_sel_hi:[0,1,1]
    s_set_gpr_idx_off
    v_lshlrev_b32_sdwa v138, v15, v124 dst_sel:DWORD dst_unused:UNUSED_PAD src0_sel:DWORD src1_sel:WORD_1
    s_waitcnt vmcnt(2)
    v_mfma_f32_4x4x4_16b_bf16 v[96:99], v[140:141], v[80:81], 0 cbsz:4 abid:3
    s_nop 0
    v_mfma_f32_4x4x4_16b_bf16 v[100:103], v[140:141], v[82:83], 0 cbsz:4 abid:3
    v_lshlrev_b32_sdwa v139, v15, v125 dst_sel:DWORD dst_unused:UNUSED_PAD src0_sel:DWORD src1_sel:WORD_1
    ds_read_u16_d16_hi v130, v138 offset:32768
    ds_read_u16_d16_hi v131, v139 offset:32768
    s_set_gpr_idx_on s59, 0xc
    v_pk_fma_f32 v[16:17], v[132:133], v[104:105], v[16:17] op_sel:[1,0,0] op_sel_hi:[1,1,1]
    v_pk_fma_f32 v[18:19], v[132:133], v[106:107], v[18:19] op_sel:[1,0,0] op_sel_hi:[1,1,1]
    v_pk_fma_f32 v[20:21], v[134:135], v[108:109], v[20:21] op_sel:[1,0,0] op_sel_hi:[1,1,1]
    v_pk_fma_f32 v[22:23], v[134:135], v[110:111], v[22:23] op_sel:[1,0,0] op_sel_hi:[1,1,1]
    s_set_gpr_idx_off
B_12:
    s_sub_u32 s32, s32, 4
    s_cbranch_scc1 MAIN_DONE
    v_mfma_f32_4x4x4_16b_bf16 v[116:119], v[172:173], v[178:179], 0 cbsz:4 abid:4
    v_lshlrev_b32_sdwa v136, v15, v122 dst_sel:DWORD dst_unused:UNUSED_PAD src0_sel:DWORD src1_sel:WORD_1
    s_waitcnt vmcnt(5)
    v_mfma_f32_4x4x4_16b_bf16 v[104:107], v[142:143], v[84:85], 0 cbsz:4 abid:3
    s_nop 0
    v_mfma_f32_4x4x4_16b_bf16 v[108:111], v[142:143], v[86:87], 0 cbsz:4 abid:3
    v_lshlrev_b32_sdwa v137, v15, v123 dst_sel:DWORD dst_unused:UNUSED_PAD src0_sel:DWORD src1_sel:WORD_1
    ds_read_u16_d16_hi v132, v136 offset:32768
    ds_read_u16_d16_hi v133, v137 offset:32768
    s_waitcnt lgkmcnt(2)
    s_set_gpr_idx_on s60, 0xc
    v_pk_fma_f32 v[16:17], v[128:129], v[96:97], v[16:17] op_sel:[0,0,0] op_sel_hi:[0,1,1]
    v_pk_fma_f32 v[18:19], v[128:129], v[98:99], v[18:19] op_sel:[0,0,0] op_sel_hi:[0,1,1]
    v_pk_fma_f32 v[20:21], v[130:131], v[100:101], v[20:21] op_sel:[0,0,0] op_sel_hi:[0,1,1]
    v_pk_fma_f32 v[22:23], v[130:131], v[102:103], v[22:23] op_sel:[0,0,0] op_sel_hi:[0,1,1]
    s_set_gpr_idx_off
    v_cmp_gt_u32 vcc, s30, v6
    v_add_u32 v6, 64, v6
    v_add_u32 v5, 256, v5
    v_cndmask_b32 v165, 40, v165, vcc
    v_lshrrev_b32 v8, 21, v165
    v_lshlrev_b32 v8, 4, v8
    v_lshlrev_b32 v9, 3, v165
    ds_read_b128 v[168:171], v8 offset:8192
    v_and_b32 v9, 0xfffc00, v9
    v_and_or_b32 v165, v165, 56, v9
    v_lshlrev_b32_sdwa v138, v15, v126 dst_sel:DWORD dst_unused:UNUSED_PAD src0_sel:DWORD src1_sel:WORD_1
    s_waitcnt vmcnt(4)
    v_mfma_f32_4x4x4_16b_bf16 v[96:99], v[144:145], v[88:89], 0 cbsz:4 abid:3
    s_nop 0
    v_mfma_f32_4x4x4_16b_bf16 v[100:103], v[144:145], v[90:91], 0 cbsz:4 abid:3
    v_lshlrev_b32_sdwa v139, v15, v127 dst_sel:DWORD dst_unused:UNUSED_PAD src0_sel:DWORD src1_sel:WORD_1
    ds_read_u16_d16_hi v134, v138 offset:32768
    ds_read_u16_d16_hi v135, v139 offset:32768
    s_set_gpr_idx_on s61, 0xc
    v_pk_fma_f32 v[16:17], v[128:129], v[104:105], v[16:17] op_sel:[1,0,0] op_sel_hi:[1,1,1]
    v_pk_fma_f32 v[18:19], v[128:129], v[106:107], v[18:19] op_sel:[1,0,0] op_sel_hi:[1,1,1]
    v_pk_fma_f32 v[20:21], v[130:131], v[108:109], v[20:21] op_sel:[1,0,0] op_sel_hi:[1,1,1]
    v_pk_fma_f32 v[22:23], v[130:131], v[110:111], v[22:23] op_sel:[1,0,0] op_sel_hi:[1,1,1]
    s_set_gpr_idx_off
    v_mfma_f32_4x4x4_16b_bf16 v[120:123], v[172:173], v[176:177], 0 cbsz:4 abid:5
    v_lshlrev_b32_sdwa v136, v15, v112 dst_sel:DWORD dst_unused:UNUSED_PAD src0_sel:DWORD src1_sel:WORD_1
    s_waitcnt vmcnt(3)
    v_mfma_f32_4x4x4_16b_bf16 v[104:107], v[146:147], v[92:93], 0 cbsz:4 abid:3
    s_nop 0
    v_mfma_f32_4x4x4_16b_bf16 v[108:111], v[146:147], v[94:95], 0 cbsz:4 abid:3
    v_lshlrev_b32_sdwa v137, v15, v113 dst_sel:DWORD dst_unused:UNUSED_PAD src0_sel:DWORD src1_sel:WORD_1
    ds_read_u16_d16_hi v128, v136 offset:32768
    ds_read_u16_d16_hi v129, v137 offset:32768
    s_waitcnt lgkmcnt(2)
    s_set_gpr_idx_on s62, 0xc
    v_pk_fma_f32 v[16:17], v[132:133], v[96:97], v[16:17] op_sel:[0,0,0] op_sel_hi:[0,1,1]
    v_pk_fma_f32 v[18:19], v[132:133], v[98:99], v[18:19] op_sel:[0,0,0] op_sel_hi:[0,1,1]
    v_pk_fma_f32 v[20:21], v[134:135], v[100:101], v[20:21] op_sel:[0,0,0] op_sel_hi:[0,1,1]
    v_pk_fma_f32 v[22:23], v[134:135], v[102:103], v[22:23] op_sel:[0,0,0] op_sel_hi:[0,1,1]
    s_set_gpr_idx_off
    v_lshlrev_b32_sdwa v138, v15, v116 dst_sel:DWORD dst_unused:UNUSED_PAD src0_sel:DWORD src1_sel:WORD_1
    s_waitcnt vmcnt(2)
    v_mfma_f32_4x4x4_16b_bf16 v[96:99], v[140:141], v[64:65], 0 cbsz:4 abid:4
    s_nop 0
    v_mfma_f32_4x4x4_16b_bf16 v[100:103], v[140:141], v[66:67], 0 cbsz:4 abid:4
    v_lshlrev_b32_sdwa v139, v15, v117 dst_sel:DWORD dst_unused:UNUSED_PAD src0_sel:DWORD src1_sel:WORD_1
    ds_read_u16_d16_hi v130, v138 offset:32768
    ds_read_u16_d16_hi v131, v139 offset:32768
    s_set_gpr_idx_on s63, 0xc
    v_pk_fma_f32 v[16:17], v[132:133], v[104:105], v[16:17] op_sel:[1,0,0] op_sel_hi:[1,1,1]
    v_pk_fma_f32 v[18:19], v[132:133], v[106:107], v[18:19] op_sel:[1,0,0] op_sel_hi:[1,1,1]
    v_pk_fma_f32 v[20:21], v[134:135], v[108:109], v[20:21] op_sel:[1,0,0] op_sel_hi:[1,1,1]
    v_pk_fma_f32 v[22:23], v[134:135], v[110:111], v[22:23] op_sel:[1,0,0] op_sel_hi:[1,1,1]
    s_set_gpr_idx_off
B_16:
    s_sub_u32 s32, s32, 4
    s_cbranch_scc1 MAIN_DONE
    v_mfma_f32_4x4x4_16b_bf16 v[124:127], v[172:173], v[178:179], 0 cbsz:4 abid:5
    v_lshlrev_b32_sdwa v136, v15, v114 dst_sel:DWORD dst_unused:UNUSED_PAD src0_sel:DWORD src1_sel:WORD_1
    s_waitcnt vmcnt(5)
    v_mfma_f32_4x4x4_16b_bf16 v[104:107], v[142:143], v[68:69], 0 cbsz:4 abid:4
    s_nop 0
    v_mfma_f32_4x4x4_16b_bf16 v[108:111], v[142:143], v[70:71], 0 cbsz:4 abid:4
    v_lshlrev_b32_sdwa v137, v15, v115 dst_sel:DWORD dst_unused:UNUSED_PAD src0_sel:DWORD src1_sel:WORD_1
    ds_read_u16_d16_hi v132, v136 offset:32768
    ds_read_u16_d16_hi v133, v137 offset:32768
    s_waitcnt lgkmcnt(2)
    s_set_gpr_idx_on s48, 0xc
    v_pk_fma_f32 v[16:17], v[128:129], v[96:97], v[16:17] op_sel:[0,0,0] op_sel_hi:[0,1,1]
    v_pk_fma_f32 v[18:19], v[128:129], v[98:99], v[18:19] op_sel:[0,0,0] op_sel_hi:[0,1,1]
    v_pk_fma_f32 v[20:21], v[130:131], v[100:101], v[20:21] op_sel:[0,0,0] op_sel_hi:[0,1,1]
    v_pk_fma_f32 v[22:23], v[130:131], v[102:103], v[22:23] op_sel:[0,0,0] op_sel_hi:[0,1,1]
    s_set_gpr_idx_off
    v_lshlrev_b32_sdwa v138, v15, v118 dst_sel:DWORD dst_unused:UNUSED_PAD src0_sel:DWORD src1_sel:WORD_1
    s_waitcnt vmcnt(4)
    v_mfma_f32_4x4x4_16b_bf16 v[96:99], v[144:145], v[72:73], 0 cbsz:4 abid:4
    s_nop 0
    v_mfma_f32_4x4x4_16b_bf16 v[100:103], v[144:145], v[74:75], 0 cbsz:4 abid:4
    v_lshlrev_b32_sdwa v139, v15, v119 dst_sel:DWORD dst_unused:UNUSED_PAD src0_sel:DWORD src1_sel:WORD_1
    ds_read_u16_d16_hi v134, v138 offset:32768
    ds_read_u16_d16_hi v135, v139 offset:32768
    s_set_gpr_idx_on s49, 0xc
    v_pk_fma_f32 v[16:17], v[128:129], v[104:105], v[16:17] op_sel:[1,0,0] op_sel_hi:[1,1,1]
    v_pk_fma_f32 v[18:19], v[128:129], v[106:107], v[18:19] op_sel:[1,0,0] op_sel_hi:[1,1,1]
    v_pk_fma_f32 v[20:21], v[130:131], v[108:109], v[20:21] op_sel:[1,0,0] op_sel_hi:[1,1,1]
    v_pk_fma_f32 v[22:23], v[130:131], v[110:111], v[22:23] op_sel:[1,0,0] op_sel_hi:[1,1,1]
    s_set_gpr_idx_off
    v_mfma_f32_4x4x4_16b_bf16 v[112:115], v[172:173], v[176:177], 0 cbsz:4 abid:6
    v_lshlrev_b32_sdwa v136, v15, v120 dst_sel:DWORD dst_unused:UNUSED_PAD src0_sel:DWORD src1_sel:WORD_1
    s_waitcnt vmcnt(3)
    v_mfma_f32_4x4x4_16b_bf16 v[104:107], v[146:147], v[76:77], 0 cbsz:4 abid:4
    s_nop 0
    v_mfma_f32_4x4x4_16b_bf16 v[108:111], v[146:147], v[78:79], 0 cbsz:4 abid:4
    v_lshlrev_b32_sdwa v137, v15, v121 dst_sel:DWORD dst_unused:UNUSED_PAD src0_sel:DWORD src1_sel:WORD_1
    ds_read_u16_d16_hi v128, v136 offset:32768
    ds_read_u16_d16_hi v129, v137 offset:32768
    s_waitcnt lgkmcnt(2)
    s_set_gpr_idx_on s50, 0xc
    v_pk_fma_f32 v[16:17], v[132:133], v[96:97], v[16:17] op_sel:[0,0,0] op_sel_hi:[0,1,1]
    v_pk_fma_f32 v[18:19], v[132:133], v[98:99], v[18:19] op_sel:[0,0,0] op_sel_hi:[0,1,1]
    v_pk_fma_f32 v[20:21], v[134:135], v[100:101], v[20:21] op_sel:[0,0,0] op_sel_hi:[0,1,1]
    v_pk_fma_f32 v[22:23], v[134:135], v[102:103], v[22:23] op_sel:[0,0,0] op_sel_hi:[0,1,1]
    s_set_gpr_idx_off
    v_lshlrev_b32_sdwa v138, v15, v124 dst_sel:DWORD dst_unused:UNUSED_PAD src0_sel:DWORD src1_sel:WORD_1
    s_waitcnt vmcnt(2)
    v_mfma_f32_4x4x4_16b_bf16 v[96:99], v[140:141], v[80:81], 0 cbsz:4 abid:5
    s_nop 0
    v_mfma_f32_4x4x4_16b_bf16 v[100:103], v[140:141], v[82:83], 0 cbsz:4 abid:5
    v_lshlrev_b32_sdwa v139, v15, v125 dst_sel:DWORD dst_unused:UNUSED_PAD src0_sel:DWORD src1_sel:WORD_1
    ds_read_u16_d16_hi v130, v138 offset:32768
    ds_read_u16_d16_hi v131, v139 offset:32768
    s_set_gpr_idx_on s51, 0xc
    v_pk_fma_f32 v[16:17], v[132:133], v[104:105], v[16:17] op_sel:[1,0,0] op_sel_hi:[1,1,1]
    v_pk_fma_f32 v[18:19], v[132:133], v[106:107], v[18:19] op_sel:[1,0,0] op_sel_hi:[1,1,1]
    v_pk_fma_f32 v[20:21], v[134:135], v[108:109], v[20:21] op_sel:[1,0,0] op_sel_hi:[1,1,1]
    v_pk_fma_f32 v[22:23], v[134:135], v[110:111], v[22:23] op_sel:[1,0,0] op_sel_hi:[1,1,1]
    s_set_gpr_idx_off
B_20:
    s_sub_u32 s32, s32, 4
    s_cbranch_scc1 MAIN_DONE
    v_mfma_f32_4x4x4_16b_bf16 v[116:119], v[172:173], v[178:179], 0 cbsz:4 abid:6
    v_lshlrev_b32_sdwa v136, v15, v122 dst_sel:DWORD dst_unused:UNUSED_PAD src0_sel:DWORD src1_sel:WORD_1
    s_waitcnt vmcnt(5)
    v_mfma_f32_4x4x4_16b_bf16 v[104:107], v[142:143], v[84:85], 0 cbsz:4 abid:5
    s_nop 0
    v_mfma_f32_4x4x4_16b_bf16 v[108:111], v[142:143], v[86:87], 0 cbsz:4 abid:5
    v_lshlrev_b32_sdwa v137, v15, v123 dst_sel:DWORD dst_unused:UNUSED_PAD src0_sel:DWORD src1_sel:WORD_1
    ds_read_u16_d16_hi v132, v136 offset:32768
    ds_read_u16_d16_hi v133, v137 offset:32768
    s_waitcnt lgkmcnt(2)
    s_set_gpr_idx_on s52, 0xc
    v_pk_fma_f32 v[16:17], v[128:129], v[96:97], v[16:17] op_sel:[0,0,0] op_sel_hi:[0,1,1]
    v_pk_fma_f32 v[18:19], v[128:129], v[98:99], v[18:19] op_sel:[0,0,0] op_sel_hi:[0,1,1]
    v_pk_fma_f32 v[20:21], v[130:131], v[100:101], v[20:21] op_sel:[0,0,0] op_sel_hi:[0,1,1]
    v_pk_fma_f32 v[22:23], v[130:131], v[102:103], v[22:23] op_sel:[0,0,0] op_sel_hi:[0,1,1]
    s_set_gpr_idx_off
    v_lshlrev_b32_sdwa v138, v15, v126 dst_sel:DWORD dst_unused:UNUSED_PAD src0_sel:DWORD src1_sel:WORD_1
    s_waitcnt vmcnt(4)
    v_mfma_f32_4x4x4_16b_bf16 v[96:99], v[144:145], v[88:89], 0 cbsz:4 abid:5
    s_nop 0
    v_mfma_f32_4x4x4_16b_bf16 v[100:103], v[144:145], v[90:91], 0 cbsz:4 abid:5
    v_lshlrev_b32_sdwa v139, v15, v127 dst_sel:DWORD dst_unused:UNUSED_PAD src0_sel:DWORD src1_sel:WORD_1
    ds_read_u16_d16_hi v134, v138 offset:32768
    ds_read_u16_d16_hi v135, v139 offset:32768
    s_set_gpr_idx_on s53, 0xc
    v_pk_fma_f32 v[16:17], v[128:129], v[104:105], v[16:17] op_sel:[1,0,0] op_sel_hi:[1,1,1]
    v_pk_fma_f32 v[18:19], v[128:129], v[106:107], v[18:19] op_sel:[1,0,0] op_sel_hi:[1,1,1]
    v_pk_fma_f32 v[20:21], v[130:131], v[108:109], v[20:21] op_sel:[1,0,0] op_sel_hi:[1,1,1]
    v_pk_fma_f32 v[22:23], v[130:131], v[110:111], v[22:23] op_sel:[1,0,0] op_sel_hi:[1,1,1]
    s_set_gpr_idx_off
    v_mfma_f32_4x4x4_16b_bf16 v[120:123], v[172:173], v[176:177], 0 cbsz:4 abid:7
    v_lshlrev_b32_sdwa v136, v15, v112 dst_sel:DWORD dst_unused:UNUSED_PAD src0_sel:DWORD src1_sel:WORD_1
    s_waitcnt vmcnt(3)
    v_mfma_f32_4x4x4_16b_bf16 v[104:107], v[146:147], v[92:93], 0 cbsz:4 abid:5
    s_nop 0
    v_mfma_f32_4x4x4_16b_bf16 v[108:111], v[146:147], v[94:95], 0 cbsz:4 abid:5
    v_lshlrev_b32_sdwa v137, v15, v113 dst_sel:DWORD dst_unused:UNUSED_PAD src0_sel:DWORD src1_sel:WORD_1
    ds_read_u16_d16_hi v128, v136 offset:32768
    ds_read_u16_d16_hi v129, v137 offset:32768
    s_waitcnt lgkmcnt(2)
    s_set_gpr_idx_on s54, 0xc
    v_pk_fma_f32 v[16:17], v[132:133], v[96:97], v[16:17] op_sel:[0,0,0] op_sel_hi:[0,1,1]
    v_pk_fma_f32 v[18:19], v[132:133], v[98:99], v[18:19] op_sel:[0,0,0] op_sel_hi:[0,1,1]
    v_pk_fma_f32 v[20:21], v[134:135], v[100:101], v[20:21] op_sel:[0,0,0] op_sel_hi:[0,1,1]
    v_pk_fma_f32 v[22:23], v[134:135], v[102:103], v[22:23] op_sel:[0,0,0] op_sel_hi:[0,1,1]
    s_set_gpr_idx_off
    v_lshlrev_b32_sdwa v138, v15, v116 dst_sel:DWORD dst_unused:UNUSED_PAD src0_sel:DWORD src1_sel:WORD_1
    s_waitcnt vmcnt(2)
    v_mfma_f32_4x4x4_16b_bf16 v[96:99], v[140:141], v[64:65], 0 cbsz:4 abid:6
    s_nop 0
    v_mfma_f32_4x4x4_16b_bf16 v[100:103], v[140:141], v[66:67], 0 cbsz:4 abid:6
    v_lshlrev_b32_sdwa v139, v15, v117 dst_sel:DWORD dst_unused:UNUSED_PAD src0_sel:DWORD src1_sel:WORD_1
    ds_read_u16_d16_hi v130, v138 offset:32768
    ds_read_u16_d16_hi v131, v139 offset:32768
    s_set_gpr_idx_on s55, 0xc
    v_pk_fma_f32 v[16:17], v[132:133], v[104:105], v[16:17] op_sel:[1,0,0] op_sel_hi:[1,1,1]
    v_pk_fma_f32 v[18:19], v[132:133], v[106:107], v[18:19] op_sel:[1,0,0] op_sel_hi:[1,1,1]
    v_pk_fma_f32 v[20:21], v[134:135], v[108:109], v[20:21] op_sel:[1,0,0] op_sel_hi:[1,1,1]
    v_pk_fma_f32 v[22:23], v[134:135], v[110:111], v[22:23] op_sel:[1,0,0] op_sel_hi:[1,1,1]
    s_set_gpr_idx_off
B_24:
    s_sub_u32 s32, s32, 4
    s_cbranch_scc1 MAIN_DONE
    v_mfma_f32_4x4x4_16b_bf16 v[124:127], v[172:173], v[178:179], 0 cbsz:4 abid:7
    v_lshlrev_b32_sdwa v136, v15, v114 dst_sel:DWORD dst_unused:UNUSED_PAD src0_sel:DWORD src1_sel:WORD_1
    s_waitcnt vmcnt(5)
    v_mfma_f32_4x4x4_16b_bf16 v[104:107], v[142:143], v[68:69], 0 cbsz:4 abid:6
    s_nop 0
    v_mfma_f32_4x4x4_16b_bf16 v[108:111], v[142:143], v[70:71], 0 cbsz:4 abid:6
    v_lshlrev_b32_sdwa v137, v15, v115 dst_sel:DWORD dst_unused:UNUSED_PAD src0_sel:DWORD src1_sel:WORD_1
    ds_read_u16_d16_hi v132, v136 offset:32768
    ds_read_u16_d16_hi v133, v137 offset:32768
    s_waitcnt lgkmcnt(2)
    s_set_gpr_idx_on s56, 0xc
    v_pk_fma_f32 v[16:17], v[128:129], v[96:97], v[16:17] op_sel:[0,0,0] op_sel_hi:[0,1,1]
    v_pk_fma_f32 v[18:19], v[128:129], v[98:99], v[18:19] op_sel:[0,0,0] op_sel_hi:[0,1,1]
    v_pk_fma_f32 v[20:21], v[130:131], v[100:101], v[20:21] op_sel:[0,0,0] op_sel_hi:[0,1,1]
    v_pk_fma_f32 v[22:23], v[130:131], v[102:103], v[22:23] op_sel:[0,0,0] op_sel_hi:[0,1,1]
    s_set_gpr_idx_off
    v_lshlrev_b32_sdwa v138, v15, v118 dst_sel:DWORD dst_unused:UNUSED_PAD src0_sel:DWORD src1_sel:WORD_1
    s_waitcnt vmcnt(4)
    v_mfma_f32_4x4x4_16b_bf16 v[96:99], v[144:145], v[72:73], 0 cbsz:4 abid:6
    s_nop 0
    v_mfma_f32_4x4x4_16b_bf16 v[100:103], v[144:145], v[74:75], 0 cbsz:4 abid:6
    v_lshlrev_b32_sdwa v139, v15, v119 dst_sel:DWORD dst_unused:UNUSED_PAD src0_sel:DWORD src1_sel:WORD_1
    ds_read_u16_d16_hi v134, v138 offset:32768
    ds_read_u16_d16_hi v135, v139 offset:32768
    s_set_gpr_idx_on s57, 0xc
    v_pk_fma_f32 v[16:17], v[128:129], v[104:105], v[16:17] op_sel:[1,0,0] op_sel_hi:[1,1,1]
    v_pk_fma_f32 v[18:19], v[128:129], v[106:107], v[18:19] op_sel:[1,0,0] op_sel_hi:[1,1,1]
    v_pk_fma_f32 v[20:21], v[130:131], v[108:109], v[20:21] op_sel:[1,0,0] op_sel_hi:[1,1,1]
    v_pk_fma_f32 v[22:23], v[130:131], v[110:111], v[22:23] op_sel:[1,0,0] op_sel_hi:[1,1,1]
    s_set_gpr_idx_off
    v_mfma_f32_4x4x4_16b_bf16 v[112:115], v[172:173], v[176:177], 0 cbsz:4 abid:8
    v_lshlrev_b32_sdwa v136, v15, v120 dst_sel:DWORD dst_unused:UNUSED_PAD src0_sel:DWORD src1_sel:WORD_1
    s_waitcnt vmcnt(3)
    v_mfma_f32_4x4x4_16b_bf16 v[104:107], v[146:147], v[76:77], 0 cbsz:4 abid:6
    s_nop 0
    v_mfma_f32_4x4x4_16b_bf16 v[108:111], v[146:147], v[78:79], 0 cbsz:4 abid:6
    v_lshlrev_b32_sdwa v137, v15, v121 dst_sel:DWORD dst_unused:UNUSED_PAD src0_sel:DWORD src1_sel:WORD_1
    ds_read_u16_d16_hi v128, v136 offset:32768
    ds_read_u16_d16_hi v129, v137 offset:32768
    s_waitcnt lgkmcnt(2)
    s_set_gpr_idx_on s58, 0xc
    v_pk_fma_f32 v[16:17], v[132:133], v[96:97], v[16:17] op_sel:[0,0,0] op_sel_hi:[0,1,1]
    v_pk_fma_f32 v[18:19], v[132:133], v[98:99], v[18:19] op_sel:[0,0,0] op_sel_hi:[0,1,1]
    v_pk_fma_f32 v[20:21], v[134:135], v[100:101], v[20:21] op_sel:[0,0,0] op_sel_hi:[0,1,1]
    v_pk_fma_f32 v[22:23], v[134:135], v[102:103], v[22:23] op_sel:[0,0,0] op_sel_hi:[0,1,1]
    s_set_gpr_idx_off
    v_lshlrev_b32_sdwa v138, v15, v124 dst_sel:DWORD dst_unused:UNUSED_PAD src0_sel:DWORD src1_sel:WORD_1
    s_waitcnt vmcnt(2)
    v_mfma_f32_4x4x4_16b_bf16 v[96:99], v[140:141], v[80:81], 0 cbsz:4 abid:7
    s_nop 0
    v_mfma_f32_4x4x4_16b_bf16 v[100:103], v[140:141], v[82:83], 0 cbsz:4 abid:7
    v_lshlrev_b32_sdwa v139, v15, v125 dst_sel:DWORD dst_unused:UNUSED_PAD src0_sel:DWORD src1_sel:WORD_1
    ds_read_u16_d16_hi v130, v138 offset:32768
    ds_read_u16_d16_hi v131, v139 offset:32768
    s_set_gpr_idx_on s59, 0xc
    v_pk_fma_f32 v[16:17], v[132:133], v[104:105], v[16:17] op_sel:[1,0,0] op_sel_hi:[1,1,1]
    v_pk_fma_f32 v[18:19], v[132:133], v[106:107], v[18:19] op_sel:[1,0,0] op_sel_hi:[1,1,1]
    v_pk_fma_f32 v[20:21], v[134:135], v[108:109], v[20:21] op_sel:[1,0,0] op_sel_hi:[1,1,1]
    v_pk_fma_f32 v[22:23], v[134:135], v[110:111], v[22:23] op_sel:[1,0,0] op_sel_hi:[1,1,1]
    s_set_gpr_idx_off
B_28:
    s_sub_u32 s32, s32, 4
    s_cbranch_scc1 MAIN_DONE
    v_mfma_f32_4x4x4_16b_bf16 v[116:119], v[172:173], v[178:179], 0 cbsz:4 abid:8
    v_lshlrev_b32_sdwa v136, v15, v122 dst_sel:DWORD dst_unused:UNUSED_PAD src0_sel:DWORD src1_sel:WORD_1
    s_waitcnt vmcnt(5)
    v_mfma_f32_4x4x4_16b_bf16 v[104:107], v[142:143], v[84:85], 0 cbsz:4 abid:7
    s_nop 0
    v_mfma_f32_4x4x4_16b_bf16 v[108:111], v[142:143], v[86:87], 0 cbsz:4 abid:7
    v_lshlrev_b32_sdwa v137, v15, v123 dst_sel:DWORD dst_unused:UNUSED_PAD src0_sel:DWORD src1_sel:WORD_1
    ds_read_u16_d16_hi v132, v136 offset:32768
    ds_read_u16_d16_hi v133, v137 offset:32768
    s_waitcnt lgkmcnt(2)
    s_set_gpr_idx_on s60, 0xc
    v_pk_fma_f32 v[16:17], v[128:129], v[96:97], v[16:17] op_sel:[0,0,0] op_sel_hi:[0,1,1]
    v_pk_fma_f32 v[18:19], v[128:129], v[98:99], v[18:19] op_sel:[0,0,0] op_sel_hi:[0,1,1]
    v_pk_fma_f32 v[20:21], v[130:131], v[100:101], v[20:21] op_sel:[0,0,0] op_sel_hi:[0,1,1]
    v_pk_fma_f32 v[22:23], v[130:131], v[102:103], v[22:23] op_sel:[0,0,0] op_sel_hi:[0,1,1]
    s_set_gpr_idx_off
    v_lshlrev_b32_sdwa v138, v15, v126 dst_sel:DWORD dst_unused:UNUSED_PAD src0_sel:DWORD src1_sel:WORD_1
    s_waitcnt vmcnt(4)
    v_mfma_f32_4x4x4_16b_bf16 v[96:99], v[144:145], v[88:89], 0 cbsz:4 abid:7
    s_nop 0
    v_mfma_f32_4x4x4_16b_bf16 v[100:103], v[144:145], v[90:91], 0 cbsz:4 abid:7
    v_lshlrev_b32_sdwa v139, v15, v127 dst_sel:DWORD dst_unused:UNUSED_PAD src0_sel:DWORD src1_sel:WORD_1
    ds_read_u16_d16_hi v134, v138 offset:32768
    ds_read_u16_d16_hi v135, v139 offset:32768
    s_set_gpr_idx_on s61, 0xc
    v_pk_fma_f32 v[16:17], v[128:129], v[104:105], v[16:17] op_sel:[1,0,0] op_sel_hi:[1,1,1]
    v_pk_fma_f32 v[18:19], v[128:129], v[106:107], v[18:19] op_sel:[1,0,0] op_sel_hi:[1,1,1]
    v_pk_fma_f32 v[20:21], v[130:131], v[108:109], v[20:21] op_sel:[1,0,0] op_sel_hi:[1,1,1]
    v_pk_fma_f32 v[22:23], v[130:131], v[110:111], v[22:23] op_sel:[1,0,0] op_sel_hi:[1,1,1]
    s_set_gpr_idx_off
    v_mfma_f32_4x4x4_16b_bf16 v[120:123], v[172:173], v[176:177], 0 cbsz:4 abid:9
    v_lshlrev_b32_sdwa v136, v15, v112 dst_sel:DWORD dst_unused:UNUSED_PAD src0_sel:DWORD src1_sel:WORD_1
    s_waitcnt vmcnt(3)
    v_mfma_f32_4x4x4_16b_bf16 v[104:107], v[146:147], v[92:93], 0 cbsz:4 abid:7
    s_nop 0
    v_mfma_f32_4x4x4_16b_bf16 v[108:111], v[146:147], v[94:95], 0 cbsz:4 abid:7
    v_lshlrev_b32_sdwa v137, v15, v113 dst_sel:DWORD dst_unused:UNUSED_PAD src0_sel:DWORD src1_sel:WORD_1
    ds_read_u16_d16_hi v128, v136 offset:32768
    ds_read_u16_d16_hi v129, v137 offset:32768
    s_waitcnt lgkmcnt(2)
    s_set_gpr_idx_on s62, 0xc
    v_pk_fma_f32 v[16:17], v[132:133], v[96:97], v[16:17] op_sel:[0,0,0] op_sel_hi:[0,1,1]
    v_pk_fma_f32 v[18:19], v[132:133], v[98:99], v[18:19] op_sel:[0,0,0] op_sel_hi:[0,1,1]
    v_pk_fma_f32 v[20:21], v[134:135], v[100:101], v[20:21] op_sel:[0,0,0] op_sel_hi:[0,1,1]
    v_pk_fma_f32 v[22:23], v[134:135], v[102:103], v[22:23] op_sel:[0,0,0] op_sel_hi:[0,1,1]
    s_set_gpr_idx_off
    v_lshlrev_b32_sdwa v138, v15, v116 dst_sel:DWORD dst_unused:UNUSED_PAD src0_sel:DWORD src1_sel:WORD_1
    s_waitcnt vmcnt(2)
    v_mfma_f32_4x4x4_16b_bf16 v[96:99], v[140:141], v[64:65], 0 cbsz:4 abid:8
    s_nop 0
    v_mfma_f32_4x4x4_16b_bf16 v[100:103], v[140:141], v[66:67], 0 cbsz:4 abid:8
    v_lshlrev_b32_sdwa v139, v15, v117 dst_sel:DWORD dst_unused:UNUSED_PAD src0_sel:DWORD src1_sel:WORD_1
    ds_read_u16_d16_hi v130, v138 offset:32768
    ds_read_u16_d16_hi v131, v139 offset:32768
    s_set_gpr_idx_on s63, 0xc
    v_pk_fma_f32 v[16:17], v[132:133], v[104:105], v[16:17] op_sel:[1,0,0] op_sel_hi:[1,1,1]
    v_pk_fma_f32 v[18:19], v[132:133], v[106:107], v[18:19] op_sel:[1,0,0] op_sel_hi:[1,1,1]
    v_pk_fma_f32 v[20:21], v[134:135], v[108:109], v[20:21] op_sel:[1,0,0] op_sel_hi:[1,1,1]
    v_pk_fma_f32 v[22:23], v[134:135], v[110:111], v[22:23] op_sel:[1,0,0] op_sel_hi:[1,1,1]
    s_set_gpr_idx_off
B_32:
    s_sub_u32 s32, s32, 4
    s_cbranch_scc1 MAIN_DONE
    v_mfma_f32_4x4x4_16b_bf16 v[124:127], v[172:173], v[178:179], 0 cbsz:4 abid:9
    v_lshlrev_b32_sdwa v136, v15, v114 dst_sel:DWORD dst_unused:UNUSED_PAD src0_sel:DWORD src1_sel:WORD_1
    s_waitcnt vmcnt(5)
    v_mfma_f32_4x4x4_16b_bf16 v[104:107], v[142:143], v[68:69], 0 cbsz:4 abid:8
    s_nop 0
    v_mfma_f32_4x4x4_16b_bf16 v[108:111], v[142:143], v[70:71], 0 cbsz:4 abid:8
    v_lshlrev_b32_sdwa v137, v15, v115 dst_sel:DWORD dst_unused:UNUSED_PAD src0_sel:DWORD src1_sel:WORD_1
    ds_read_u16_d16_hi v132, v136 offset:32768
    ds_read_u16_d16_hi v133, v137 offset:32768
    s_waitcnt lgkmcnt(2)
    s_set_gpr_idx_on s48, 0xc
    v_pk_fma_f32 v[16:17], v[128:129], v[96:97], v[16:17] op_sel:[0,0,0] op_sel_hi:[0,1,1]
    v_pk_fma_f32 v[18:19], v[128:129], v[98:99], v[18:19] op_sel:[0,0,0] op_sel_hi:[0,1,1]
    v_pk_fma_f32 v[20:21], v[130:131], v[100:101], v[20:21] op_sel:[0,0,0] op_sel_hi:[0,1,1]
    v_pk_fma_f32 v[22:23], v[130:131], v[102:103], v[22:23] op_sel:[0,0,0] op_sel_hi:[0,1,1]
    s_set_gpr_idx_off
    v_lshlrev_b32_sdwa v138, v15, v118 dst_sel:DWORD dst_unused:UNUSED_PAD src0_sel:DWORD src1_sel:WORD_1
    s_waitcnt vmcnt(4)
    v_mfma_f32_4x4x4_16b_bf16 v[96:99], v[144:145], v[72:73], 0 cbsz:4 abid:8
    s_nop 0
    v_mfma_f32_4x4x4_16b_bf16 v[100:103], v[144:145], v[74:75], 0 cbsz:4 abid:8
    v_lshlrev_b32_sdwa v139, v15, v119 dst_sel:DWORD dst_unused:UNUSED_PAD src0_sel:DWORD src1_sel:WORD_1
    ds_read_u16_d16_hi v134, v138 offset:32768
    ds_read_u16_d16_hi v135, v139 offset:32768
    s_set_gpr_idx_on s49, 0xc
    v_pk_fma_f32 v[16:17], v[128:129], v[104:105], v[16:17] op_sel:[1,0,0] op_sel_hi:[1,1,1]
    v_pk_fma_f32 v[18:19], v[128:129], v[106:107], v[18:19] op_sel:[1,0,0] op_sel_hi:[1,1,1]
    v_pk_fma_f32 v[20:21], v[130:131], v[108:109], v[20:21] op_sel:[1,0,0] op_sel_hi:[1,1,1]
    v_pk_fma_f32 v[22:23], v[130:131], v[110:111], v[22:23] op_sel:[1,0,0] op_sel_hi:[1,1,1]
    s_set_gpr_idx_off
    v_mfma_f32_4x4x4_16b_bf16 v[112:115], v[172:173], v[176:177], 0 cbsz:4 abid:10
    v_lshlrev_b32_sdwa v136, v15, v120 dst_sel:DWORD dst_unused:UNUSED_PAD src0_sel:DWORD src1_sel:WORD_1
    s_waitcnt vmcnt(3)
    v_mfma_f32_4x4x4_16b_bf16 v[104:107], v[146:147], v[76:77], 0 cbsz:4 abid:8
    s_nop 0
    v_mfma_f32_4x4x4_16b_bf16 v[108:111], v[146:147], v[78:79], 0 cbsz:4 abid:8
    v_lshlrev_b32_sdwa v137, v15, v121 dst_sel:DWORD dst_unused:UNUSED_PAD src0_sel:DWORD src1_sel:WORD_1
    ds_read_u16_d16_hi v128, v136 offset:32768
    ds_read_u16_d16_hi v129, v137 offset:32768
    s_waitcnt lgkmcnt(2)
    s_set_gpr_idx_on s50, 0xc
    v_pk_fma_f32 v[16:17], v[132:133], v[96:97], v[16:17] op_sel:[0,0,0] op_sel_hi:[0,1,1]
    v_pk_fma_f32 v[18:19], v[132:133], v[98:99], v[18:19] op_sel:[0,0,0] op_sel_hi:[0,1,1]
    v_pk_fma_f32 v[20:21], v[134:135], v[100:101], v[20:21] op_sel:[0,0,0] op_sel_hi:[0,1,1]
    v_pk_fma_f32 v[22:23], v[134:135], v[102:103], v[22:23] op_sel:[0,0,0] op_sel_hi:[0,1,1]
    s_set_gpr_idx_off
    v_lshlrev_b32_sdwa v138, v15, v124 dst_sel:DWORD dst_unused:UNUSED_PAD src0_sel:DWORD src1_sel:WORD_1
    s_waitcnt vmcnt(2)
    v_mfma_f32_4x4x4_16b_bf16 v[96:99], v[140:141], v[80:81], 0 cbsz:4 abid:9
    s_nop 0
    v_mfma_f32_4x4x4_16b_bf16 v[100:103], v[140:141], v[82:83], 0 cbsz:4 abid:9
    v_lshlrev_b32_sdwa v139, v15, v125 dst_sel:DWORD dst_unused:UNUSED_PAD src0_sel:DWORD src1_sel:WORD_1
    ds_read_u16_d16_hi v130, v138 offset:32768
    ds_read_u16_d16_hi v131, v139 offset:32768
    s_set_gpr_idx_on s51, 0xc
    v_pk_fma_f32 v[16:17], v[132:133], v[104:105], v[16:17] op_sel:[1,0,0] op_sel_hi:[1,1,1]
    v_pk_fma_f32 v[18:19], v[132:133], v[106:107], v[18:19] op_sel:[1,0,0] op_sel_hi:[1,1,1]
    v_pk_fma_f32 v[20:21], v[134:135], v[108:109], v[20:21] op_sel:[1,0,0] op_sel_hi:[1,1,1]
    v_pk_fma_f32 v[22:23], v[134:135], v[110:111], v[22:23] op_sel:[1,0,0] op_sel_hi:[1,1,1]
    s_set_gpr_idx_off
B_36:
    s_sub_u32 s32, s32, 4
    s_cbranch_scc1 MAIN_DONE
    v_mfma_f32_4x4x4_16b_bf16 v[116:119], v[172:173], v[178:179], 0 cbsz:4 abid:10
    v_lshlrev_b32_sdwa v136, v15, v122 dst_sel:DWORD dst_unused:UNUSED_PAD src0_sel:DWORD src1_sel:WORD_1
    s_waitcnt vmcnt(5)
    v_mfma_f32_4x4x4_16b_bf16 v[104:107], v[142:143], v[84:85], 0 cbsz:4 abid:9
    s_nop 0
    v_mfma_f32_4x4x4_16b_bf16 v[108:111], v[142:143], v[86:87], 0 cbsz:4 abid:9
    v_lshlrev_b32_sdwa v137, v15, v123 dst_sel:DWORD dst_unused:UNUSED_PAD src0_sel:DWORD src1_sel:WORD_1
    ds_read_u16_d16_hi v132, v136 offset:32768
    ds_read_u16_d16_hi v133, v137 offset:32768
    s_waitcnt lgkmcnt(2)
    s_set_gpr_idx_on s52, 0xc
    v_pk_fma_f32 v[16:17], v[128:129], v[96:97], v[16:17] op_sel:[0,0,0] op_sel_hi:[0,1,1]
    v_pk_fma_f32 v[18:19], v[128:129], v[98:99], v[18:19] op_sel:[0,0,0] op_sel_hi:[0,1,1]
    v_pk_fma_f32 v[20:21], v[130:131], v[100:101], v[20:21] op_sel:[0,0,0] op_sel_hi:[0,1,1]
    v_pk_fma_f32 v[22:23], v[130:131], v[102:103], v[22:23] op_sel:[0,0,0] op_sel_hi:[0,1,1]
    s_set_gpr_idx_off
    v_lshlrev_b32_sdwa v138, v15, v126 dst_sel:DWORD dst_unused:UNUSED_PAD src0_sel:DWORD src1_sel:WORD_1
    s_waitcnt vmcnt(4)
    v_mfma_f32_4x4x4_16b_bf16 v[96:99], v[144:145], v[88:89], 0 cbsz:4 abid:9
    s_nop 0
    v_mfma_f32_4x4x4_16b_bf16 v[100:103], v[144:145], v[90:91], 0 cbsz:4 abid:9
    v_lshlrev_b32_sdwa v139, v15, v127 dst_sel:DWORD dst_unused:UNUSED_PAD src0_sel:DWORD src1_sel:WORD_1
    ds_read_u16_d16_hi v134, v138 offset:32768
    ds_read_u16_d16_hi v135, v139 offset:32768
    s_set_gpr_idx_on s53, 0xc
    v_pk_fma_f32 v[16:17], v[128:129], v[104:105], v[16:17] op_sel:[1,0,0] op_sel_hi:[1,1,1]
    v_pk_fma_f32 v[18:19], v[128:129], v[106:107], v[18:19] op_sel:[1,0,0] op_sel_hi:[1,1,1]
    v_pk_fma_f32 v[20:21], v[130:131], v[108:109], v[20:21] op_sel:[1,0,0] op_sel_hi:[1,1,1]
    v_pk_fma_f32 v[22:23], v[130:131], v[110:111], v[22:23] op_sel:[1,0,0] op_sel_hi:[1,1,1]
    s_set_gpr_idx_off
    v_mfma_f32_4x4x4_16b_bf16 v[120:123], v[172:173], v[176:177], 0 cbsz:4 abid:11
    v_lshlrev_b32_sdwa v136, v15, v112 dst_sel:DWORD dst_unused:UNUSED_PAD src0_sel:DWORD src1_sel:WORD_1
    s_waitcnt vmcnt(3)
    v_mfma_f32_4x4x4_16b_bf16 v[104:107], v[146:147], v[92:93], 0 cbsz:4 abid:9
    s_nop 0
    v_mfma_f32_4x4x4_16b_bf16 v[108:111], v[146:147], v[94:95], 0 cbsz:4 abid:9
    v_lshlrev_b32_sdwa v137, v15, v113 dst_sel:DWORD dst_unused:UNUSED_PAD src0_sel:DWORD src1_sel:WORD_1
    ds_read_u16_d16_hi v128, v136 offset:32768
    ds_read_u16_d16_hi v129, v137 offset:32768
    s_waitcnt lgkmcnt(2)
    s_set_gpr_idx_on s54, 0xc
    v_pk_fma_f32 v[16:17], v[132:133], v[96:97], v[16:17] op_sel:[0,0,0] op_sel_hi:[0,1,1]
    v_pk_fma_f32 v[18:19], v[132:133], v[98:99], v[18:19] op_sel:[0,0,0] op_sel_hi:[0,1,1]
    v_pk_fma_f32 v[20:21], v[134:135], v[100:101], v[20:21] op_sel:[0,0,0] op_sel_hi:[0,1,1]
    v_pk_fma_f32 v[22:23], v[134:135], v[102:103], v[22:23] op_sel:[0,0,0] op_sel_hi:[0,1,1]
    s_set_gpr_idx_off
    v_lshlrev_b32_sdwa v138, v15, v116 dst_sel:DWORD dst_unused:UNUSED_PAD src0_sel:DWORD src1_sel:WORD_1
    s_waitcnt vmcnt(2)
    v_mfma_f32_4x4x4_16b_bf16 v[96:99], v[140:141], v[64:65], 0 cbsz:4 abid:10
    s_nop 0
    v_mfma_f32_4x4x4_16b_bf16 v[100:103], v[140:141], v[66:67], 0 cbsz:4 abid:10
    v_lshlrev_b32_sdwa v139, v15, v117 dst_sel:DWORD dst_unused:UNUSED_PAD src0_sel:DWORD src1_sel:WORD_1
    ds_read_u16_d16_hi v130, v138 offset:32768
    ds_read_u16_d16_hi v131, v139 offset:32768
    s_set_gpr_idx_on s55, 0xc
    v_pk_fma_f32 v[16:17], v[132:133], v[104:105], v[16:17] op_sel:[1,0,0] op_sel_hi:[1,1,1]
    v_pk_fma_f32 v[18:19], v[132:133], v[106:107], v[18:19] op_sel:[1,0,0] op_sel_hi:[1,1,1]
    v_pk_fma_f32 v[20:21], v[134:135], v[108:109], v[20:21] op_sel:[1,0,0] op_sel_hi:[1,1,1]
    v_pk_fma_f32 v[22:23], v[134:135], v[110:111], v[22:23] op_sel:[1,0,0] op_sel_hi:[1,1,1]
    s_set_gpr_idx_off
B_40:
    s_sub_u32 s32, s32, 4
    s_cbranch_scc1 MAIN_DONE
    v_mfma_f32_4x4x4_16b_bf16 v[124:127], v[172:173], v[178:179], 0 cbsz:4 abid:11
    v_lshlrev_b32_sdwa v136, v15, v114 dst_sel:DWORD dst_unused:UNUSED_PAD src0_sel:DWORD src1_sel:WORD_1
    s_waitcnt vmcnt(5)
    v_mfma_f32_4x4x4_16b_bf16 v[104:107], v[142:143], v[68:69], 0 cbsz:4 abid:10
    s_nop 0
    v_mfma_f32_4x4x4_16b_bf16 v[108:111], v[142:143], v[70:71], 0 cbsz:4 abid:10
    v_lshlrev_b32_sdwa v137, v15, v115 dst_sel:DWORD dst_unused:UNUSED_PAD src0_sel:DWORD src1_sel:WORD_1
    ds_read_u16_d16_hi v132, v136 offset:32768
    ds_read_u16_d16_hi v133, v137 offset:32768
    s_waitcnt lgkmcnt(2)
    s_set_gpr_idx_on s56, 0xc
    v_pk_fma_f32 v[16:17], v[128:129], v[96:97], v[16:17] op_sel:[0,0,0] op_sel_hi:[0,1,1]
    v_pk_fma_f32 v[18:19], v[128:129], v[98:99], v[18:19] op_sel:[0,0,0] op_sel_hi:[0,1,1]
    v_pk_fma_f32 v[20:21], v[130:131], v[100:101], v[20:21] op_sel:[0,0,0] op_sel_hi:[0,1,1]
    v_pk_fma_f32 v[22:23], v[130:131], v[102:103], v[22:23] op_sel:[0,0,0] op_sel_hi:[0,1,1]
    s_set_gpr_idx_off
    v_mfma_f32_4x4x4_16b_bf16 v[148:151], v[168:169], v[180:181], 0
    v_lshlrev_b32_sdwa v138, v15, v118 dst_sel:DWORD dst_unused:UNUSED_PAD src0_sel:DWORD src1_sel:WORD_1
    s_waitcnt vmcnt(4)
    v_mfma_f32_4x4x4_16b_bf16 v[96:99], v[144:145], v[72:73], 0 cbsz:4 abid:10
    s_nop 0
    v_mfma_f32_4x4x4_16b_bf16 v[100:103], v[144:145], v[74:75], 0 cbsz:4 abid:10
    v_lshlrev_b32_sdwa v139, v15, v119 dst_sel:DWORD dst_unused:UNUSED_PAD src0_sel:DWORD src1_sel:WORD_1
    ds_read_u16_d16_hi v134, v138 offset:32768
    ds_read_u16_d16_hi v135, v139 offset:32768
    s_set_gpr_idx_on s57, 0xc
    v_pk_fma_f32 v[16:17], v[128:129], v[104:105], v[16:17] op_sel:[1,0,0] op_sel_hi:[1,1,1]
    v_pk_fma_f32 v[18:19], v[128:129], v[106:107], v[18:19] op_sel:[1,0,0] op_sel_hi:[1,1,1]
    v_pk_fma_f32 v[20:21], v[130:131], v[108:109], v[20:21] op_sel:[1,0,0] op_sel_hi:[1,1,1]
    v_pk_fma_f32 v[22:23], v[130:131], v[110:111], v[22:23] op_sel:[1,0,0] op_sel_hi:[1,1,1]
    s_set_gpr_idx_off
    v_mfma_f32_4x4x4_16b_bf16 v[112:115], v[172:173], v[176:177], 0 cbsz:4 abid:12
    v_lshlrev_b32_sdwa v136, v15, v120 dst_sel:DWORD dst_unused:UNUSED_PAD src0_sel:DWORD src1_sel:WORD_1
    s_waitcnt vmcnt(3)
    v_mfma_f32_4x4x4_16b_bf16 v[104:107], v[146:147], v[76:77], 0 cbsz:4 abid:10
    s_nop 0
    v_mfma_f32_4x4x4_16b_bf16 v[108:111], v[146:147], v[78:79], 0 cbsz:4 abid:10
    v_lshlrev_b32_sdwa v137, v15, v121 dst_sel:DWORD dst_unused:UNUSED_PAD src0_sel:DWORD src1_sel:WORD_1
    ds_read_u16_d16_hi v128, v136 offset:32768
    ds_read_u16_d16_hi v129, v137 offset:32768
    s_waitcnt lgkmcnt(2)
    s_set_gpr_idx_on s58, 0xc
    v_pk_fma_f32 v[16:17], v[132:133], v[96:97], v[16:17] op_sel:[0,0,0] op_sel_hi:[0,1,1]
    v_pk_fma_f32 v[18:19], v[132:133], v[98:99], v[18:19] op_sel:[0,0,0] op_sel_hi:[0,1,1]
    v_pk_fma_f32 v[20:21], v[134:135], v[100:101], v[20:21] op_sel:[0,0,0] op_sel_hi:[0,1,1]
    v_pk_fma_f32 v[22:23], v[134:135], v[102:103], v[22:23] op_sel:[0,0,0] op_sel_hi:[0,1,1]
    s_set_gpr_idx_off
    v_mfma_f32_4x4x4_16b_bf16 v[152:155], v[168:169], v[182:183], 0
    v_lshlrev_b32_sdwa v138, v15, v124 dst_sel:DWORD dst_unused:UNUSED_PAD src0_sel:DWORD src1_sel:WORD_1
    s_waitcnt vmcnt(2)
    v_mfma_f32_4x4x4_16b_bf16 v[96:99], v[140:141], v[80:81], 0 cbsz:4 abid:11
    s_nop 0
    v_mfma_f32_4x4x4_16b_bf16 v[100:103], v[140:141], v[82:83], 0 cbsz:4 abid:11
    v_lshlrev_b32_sdwa v139, v15, v125 dst_sel:DWORD dst_unused:UNUSED_PAD src0_sel:DWORD src1_sel:WORD_1
    ds_read_u16_d16_hi v130, v138 offset:32768
    ds_read_u16_d16_hi v131, v139 offset:32768
    s_set_gpr_idx_on s59, 0xc
    v_pk_fma_f32 v[16:17], v[132:133], v[104:105], v[16:17] op_sel:[1,0,0] op_sel_hi:[1,1,1]
    v_pk_fma_f32 v[18:19], v[132:133], v[106:107], v[18:19] op_sel:[1,0,0] op_sel_hi:[1,1,1]
    v_pk_fma_f32 v[20:21], v[134:135], v[108:109], v[20:21] op_sel:[1,0,0] op_sel_hi:[1,1,1]
    v_pk_fma_f32 v[22:23], v[134:135], v[110:111], v[22:23] op_sel:[1,0,0] op_sel_hi:[1,1,1]
    s_set_gpr_idx_off
B_44:
    s_sub_u32 s32, s32, 4
    s_cbranch_scc1 MAIN_DONE
    v_mfma_f32_4x4x4_16b_bf16 v[116:119], v[172:173], v[178:179], 0 cbsz:4 abid:12
    v_lshlrev_b32_sdwa v136, v15, v122 dst_sel:DWORD dst_unused:UNUSED_PAD src0_sel:DWORD src1_sel:WORD_1
    s_waitcnt vmcnt(5)
    v_mfma_f32_4x4x4_16b_bf16 v[104:107], v[142:143], v[84:85], 0 cbsz:4 abid:11
    s_nop 0
    v_mfma_f32_4x4x4_16b_bf16 v[108:111], v[142:143], v[86:87], 0 cbsz:4 abid:11
    v_lshlrev_b32_sdwa v137, v15, v123 dst_sel:DWORD dst_unused:UNUSED_PAD src0_sel:DWORD src1_sel:WORD_1
    ds_read_u16_d16_hi v132, v136 offset:32768
    ds_read_u16_d16_hi v133, v137 offset:32768
    s_waitcnt lgkmcnt(2)
    s_set_gpr_idx_on s60, 0xc
    v_pk_fma_f32 v[16:17], v[128:129], v[96:97], v[16:17] op_sel:[0,0,0] op_sel_hi:[0,1,1]
    v_pk_fma_f32 v[18:19], v[128:129], v[98:99], v[18:19] op_sel:[0,0,0] op_sel_hi:[0,1,1]
    v_pk_fma_f32 v[20:21], v[130:131], v[100:101], v[20:21] op_sel:[0,0,0] op_sel_hi:[0,1,1]
    v_pk_fma_f32 v[22:23], v[130:131], v[102:103], v[22:23] op_sel:[0,0,0] op_sel_hi:[0,1,1]
    s_set_gpr_idx_off
    v_mfma_f32_4x4x4_16b_bf16 v[156:159], v[168:169], v[184:185], 0
    v_lshlrev_b32_sdwa v138, v15, v126 dst_sel:DWORD dst_unused:UNUSED_PAD src0_sel:DWORD src1_sel:WORD_1
    s_waitcnt vmcnt(4)
    v_mfma_f32_4x4x4_16b_bf16 v[96:99], v[144:145], v[88:89], 0 cbsz:4 abid:11
    s_nop 0
    v_mfma_f32_4x4x4_16b_bf16 v[100:103], v[144:145], v[90:91], 0 cbsz:4 abid:11
    v_lshlrev_b32_sdwa v139, v15, v127 dst_sel:DWORD dst_unused:UNUSED_PAD src0_sel:DWORD src1_sel:WORD_1
    ds_read_u16_d16_hi v134, v138 offset:32768
    ds_read_u16_d16_hi v135, v139 offset:32768
    s_set_gpr_idx_on s61, 0xc
    v_pk_fma_f32 v[16:17], v[128:129], v[104:105], v[16:17] op_sel:[1,0,0] op_sel_hi:[1,1,1]
    v_pk_fma_f32 v[18:19], v[128:129], v[106:107], v[18:19] op_sel:[1,0,0] op_sel_hi:[1,1,1]
    v_pk_fma_f32 v[20:21], v[130:131], v[108:109], v[20:21] op_sel:[1,0,0] op_sel_hi:[1,1,1]
    v_pk_fma_f32 v[22:23], v[130:131], v[110:111], v[22:23] op_sel:[1,0,0] op_sel_hi:[1,1,1]
    s_set_gpr_idx_off
    v_mfma_f32_4x4x4_16b_bf16 v[120:123], v[172:173], v[176:177], 0 cbsz:4 abid:13
    v_lshlrev_b32_sdwa v136, v15, v112 dst_sel:DWORD dst_unused:UNUSED_PAD src0_sel:DWORD src1_sel:WORD_1
    s_waitcnt vmcnt(3)
    v_mfma_f32_4x4x4_16b_bf16 v[104:107], v[146:147], v[92:93], 0 cbsz:4 abid:11
    s_nop 0
    v_mfma_f32_4x4x4_16b_bf16 v[108:111], v[146:147], v[94:95], 0 cbsz:4 abid:11
    v_lshlrev_b32_sdwa v137, v15, v113 dst_sel:DWORD dst_unused:UNUSED_PAD src0_sel:DWORD src1_sel:WORD_1
    ds_read_u16_d16_hi v128, v136 offset:32768
    ds_read_u16_d16_hi v129, v137 offset:32768
    s_waitcnt lgkmcnt(2)
    s_set_gpr_idx_on s62, 0xc
    v_pk_fma_f32 v[16:17], v[132:133], v[96:97], v[16:17] op_sel:[0,0,0] op_sel_hi:[0,1,1]
    v_pk_fma_f32 v[18:19], v[132:133], v[98:99], v[18:19] op_sel:[0,0,0] op_sel_hi:[0,1,1]
    v_pk_fma_f32 v[20:21], v[134:135], v[100:101], v[20:21] op_sel:[0,0,0] op_sel_hi:[0,1,1]
    v_pk_fma_f32 v[22:23], v[134:135], v[102:103], v[22:23] op_sel:[0,0,0] op_sel_hi:[0,1,1]
    s_set_gpr_idx_off
    v_mfma_f32_4x4x4_16b_bf16 v[160:163], v[168:169], v[186:187], 0
    v_lshlrev_b32_sdwa v138, v15, v116 dst_sel:DWORD dst_unused:UNUSED_PAD src0_sel:DWORD src1_sel:WORD_1
    s_waitcnt vmcnt(2)
    v_mfma_f32_4x4x4_16b_bf16 v[96:99], v[140:141], v[64:65], 0 cbsz:4 abid:12
    s_nop 0
    v_mfma_f32_4x4x4_16b_bf16 v[100:103], v[140:141], v[66:67], 0 cbsz:4 abid:12
    v_lshlrev_b32_sdwa v139, v15, v117 dst_sel:DWORD dst_unused:UNUSED_PAD src0_sel:DWORD src1_sel:WORD_1
    ds_read_u16_d16_hi v130, v138 offset:32768
    ds_read_u16_d16_hi v131, v139 offset:32768
    s_set_gpr_idx_on s63, 0xc
    v_pk_fma_f32 v[16:17], v[132:133], v[104:105], v[16:17] op_sel:[1,0,0] op_sel_hi:[1,1,1]
    v_pk_fma_f32 v[18:19], v[132:133], v[106:107], v[18:19] op_sel:[1,0,0] op_sel_hi:[1,1,1]
    v_pk_fma_f32 v[20:21], v[134:135], v[108:109], v[20:21] op_sel:[1,0,0] op_sel_hi:[1,1,1]
    v_pk_fma_f32 v[22:23], v[134:135], v[110:111], v[22:23] op_sel:[1,0,0] op_sel_hi:[1,1,1]
    s_set_gpr_idx_off
B_48:
    s_sub_u32 s32, s32, 4
    s_cbranch_scc1 MAIN_DONE
    v_mfma_f32_4x4x4_16b_bf16 v[124:127], v[172:173], v[178:179], 0 cbsz:4 abid:13
    v_lshlrev_b32_sdwa v136, v15, v114 dst_sel:DWORD dst_unused:UNUSED_PAD src0_sel:DWORD src1_sel:WORD_1
    s_waitcnt vmcnt(5)
    v_mfma_f32_4x4x4_16b_bf16 v[104:107], v[142:143], v[68:69], 0 cbsz:4 abid:12
    s_nop 0
    v_mfma_f32_4x4x4_16b_bf16 v[108:111], v[142:143], v[70:71], 0 cbsz:4 abid:12
    v_lshlrev_b32_sdwa v137, v15, v115 dst_sel:DWORD dst_unused:UNUSED_PAD src0_sel:DWORD src1_sel:WORD_1
    ds_read_u16_d16_hi v132, v136 offset:32768
    ds_read_u16_d16_hi v133, v137 offset:32768
    s_waitcnt lgkmcnt(2)
    s_set_gpr_idx_on s48, 0xc
    v_pk_fma_f32 v[16:17], v[128:129], v[96:97], v[16:17] op_sel:[0,0,0] op_sel_hi:[0,1,1]
    v_pk_fma_f32 v[18:19], v[128:129], v[98:99], v[18:19] op_sel:[0,0,0] op_sel_hi:[0,1,1]
    v_pk_fma_f32 v[20:21], v[130:131], v[100:101], v[20:21] op_sel:[0,0,0] op_sel_hi:[0,1,1]
    v_pk_fma_f32 v[22:23], v[130:131], v[102:103], v[22:23] op_sel:[0,0,0] op_sel_hi:[0,1,1]
    s_set_gpr_idx_off
    v_lshlrev_b32_sdwa v138, v15, v118 dst_sel:DWORD dst_unused:UNUSED_PAD src0_sel:DWORD src1_sel:WORD_1
    s_waitcnt vmcnt(4)
    v_mfma_f32_4x4x4_16b_bf16 v[96:99], v[144:145], v[72:73], 0 cbsz:4 abid:12
    s_nop 0
    v_mfma_f32_4x4x4_16b_bf16 v[100:103], v[144:145], v[74:75], 0 cbsz:4 abid:12
    v_lshlrev_b32_sdwa v139, v15, v119 dst_sel:DWORD dst_unused:UNUSED_PAD src0_sel:DWORD src1_sel:WORD_1
    ds_read_u16_d16_hi v134, v138 offset:32768
    ds_read_u16_d16_hi v135, v139 offset:32768
    s_set_gpr_idx_on s49, 0xc
    v_pk_fma_f32 v[16:17], v[128:129], v[104:105], v[16:17] op_sel:[1,0,0] op_sel_hi:[1,1,1]
    v_pk_fma_f32 v[18:19], v[128:129], v[106:107], v[18:19] op_sel:[1,0,0] op_sel_hi:[1,1,1]
    v_pk_fma_f32 v[20:21], v[130:131], v[108:109], v[20:21] op_sel:[1,0,0] op_sel_hi:[1,1,1]
    v_pk_fma_f32 v[22:23], v[130:131], v[110:111], v[22:23] op_sel:[1,0,0] op_sel_hi:[1,1,1]
    s_set_gpr_idx_off
    v_mfma_f32_4x4x4_16b_bf16 v[112:115], v[172:173], v[176:177], 0 cbsz:4 abid:14
    v_lshlrev_b32_sdwa v136, v15, v120 dst_sel:DWORD dst_unused:UNUSED_PAD src0_sel:DWORD src1_sel:WORD_1
    s_waitcnt vmcnt(3)
    v_mfma_f32_4x4x4_16b_bf16 v[104:107], v[146:147], v[76:77], 0 cbsz:4 abid:12
    s_nop 0
    v_mfma_f32_4x4x4_16b_bf16 v[108:111], v[146:147], v[78:79], 0 cbsz:4 abid:12
    v_lshlrev_b32_sdwa v137, v15, v121 dst_sel:DWORD dst_unused:UNUSED_PAD src0_sel:DWORD src1_sel:WORD_1
    ds_read_u16_d16_hi v128, v136 offset:32768
    ds_read_u16_d16_hi v129, v137 offset:32768
    s_waitcnt lgkmcnt(2)
    s_set_gpr_idx_on s50, 0xc
    v_pk_fma_f32 v[16:17], v[132:133], v[96:97], v[16:17] op_sel:[0,0,0] op_sel_hi:[0,1,1]
    v_pk_fma_f32 v[18:19], v[132:133], v[98:99], v[18:19] op_sel:[0,0,0] op_sel_hi:[0,1,1]
    v_pk_fma_f32 v[20:21], v[134:135], v[100:101], v[20:21] op_sel:[0,0,0] op_sel_hi:[0,1,1]
    v_pk_fma_f32 v[22:23], v[134:135], v[102:103], v[22:23] op_sel:[0,0,0] op_sel_hi:[0,1,1]
    s_set_gpr_idx_off
    v_lshlrev_b32_sdwa v138, v15, v124 dst_sel:DWORD dst_unused:UNUSED_PAD src0_sel:DWORD src1_sel:WORD_1
    s_waitcnt vmcnt(2)
    v_mfma_f32_4x4x4_16b_bf16 v[96:99], v[140:141], v[80:81], 0 cbsz:4 abid:13
    s_nop 0
    v_mfma_f32_4x4x4_16b_bf16 v[100:103], v[140:141], v[82:83], 0 cbsz:4 abid:13
    v_lshlrev_b32_sdwa v139, v15, v125 dst_sel:DWORD dst_unused:UNUSED_PAD src0_sel:DWORD src1_sel:WORD_1
    ds_read_u16_d16_hi v130, v138 offset:32768
    ds_read_u16_d16_hi v131, v139 offset:32768
    s_set_gpr_idx_on s51, 0xc
    v_pk_fma_f32 v[16:17], v[132:133], v[104:105], v[16:17] op_sel:[1,0,0] op_sel_hi:[1,1,1]
    v_pk_fma_f32 v[18:19], v[132:133], v[106:107], v[18:19] op_sel:[1,0,0] op_sel_hi:[1,1,1]
    v_pk_fma_f32 v[20:21], v[134:135], v[108:109], v[20:21] op_sel:[1,0,0] op_sel_hi:[1,1,1]
    v_pk_fma_f32 v[22:23], v[134:135], v[110:111], v[22:23] op_sel:[1,0,0] op_sel_hi:[1,1,1]
    s_set_gpr_idx_off
B_52:
    s_sub_u32 s32, s32, 4
    s_cbranch_scc1 MAIN_DONE
    v_mfma_f32_4x4x4_16b_bf16 v[116:119], v[172:173], v[178:179], 0 cbsz:4 abid:14
    v_lshlrev_b32_sdwa v136, v15, v122 dst_sel:DWORD dst_unused:UNUSED_PAD src0_sel:DWORD src1_sel:WORD_1
    s_waitcnt vmcnt(5)
    v_mfma_f32_4x4x4_16b_bf16 v[104:107], v[142:143], v[84:85], 0 cbsz:4 abid:13
    s_nop 0
    v_mfma_f32_4x4x4_16b_bf16 v[108:111], v[142:143], v[86:87], 0 cbsz:4 abid:13
    v_lshlrev_b32_sdwa v137, v15, v123 dst_sel:DWORD dst_unused:UNUSED_PAD src0_sel:DWORD src1_sel:WORD_1
    ds_read_u16_d16_hi v132, v136 offset:32768
    ds_read_u16_d16_hi v133, v137 offset:32768
    s_waitcnt lgkmcnt(2)
    s_set_gpr_idx_on s52, 0xc
    v_pk_fma_f32 v[16:17], v[128:129], v[96:97], v[16:17] op_sel:[0,0,0] op_sel_hi:[0,1,1]
    v_pk_fma_f32 v[18:19], v[128:129], v[98:99], v[18:19] op_sel:[0,0,0] op_sel_hi:[0,1,1]
    v_pk_fma_f32 v[20:21], v[130:131], v[100:101], v[20:21] op_sel:[0,0,0] op_sel_hi:[0,1,1]
    v_pk_fma_f32 v[22:23], v[130:131], v[102:103], v[22:23] op_sel:[0,0,0] op_sel_hi:[0,1,1]
    s_set_gpr_idx_off
    v_lshlrev_b32_sdwa v138, v15, v126 dst_sel:DWORD dst_unused:UNUSED_PAD src0_sel:DWORD src1_sel:WORD_1
    s_waitcnt vmcnt(4)
    v_mfma_f32_4x4x4_16b_bf16 v[96:99], v[144:145], v[88:89], 0 cbsz:4 abid:13
    s_nop 0
    v_mfma_f32_4x4x4_16b_bf16 v[100:103], v[144:145], v[90:91], 0 cbsz:4 abid:13
    v_lshlrev_b32_sdwa v139, v15, v127 dst_sel:DWORD dst_unused:UNUSED_PAD src0_sel:DWORD src1_sel:WORD_1
    ds_read_u16_d16_hi v134, v138 offset:32768
    ds_read_u16_d16_hi v135, v139 offset:32768
    s_set_gpr_idx_on s53, 0xc
    v_pk_fma_f32 v[16:17], v[128:129], v[104:105], v[16:17] op_sel:[1,0,0] op_sel_hi:[1,1,1]
    v_pk_fma_f32 v[18:19], v[128:129], v[106:107], v[18:19] op_sel:[1,0,0] op_sel_hi:[1,1,1]
    v_pk_fma_f32 v[20:21], v[130:131], v[108:109], v[20:21] op_sel:[1,0,0] op_sel_hi:[1,1,1]
    v_pk_fma_f32 v[22:23], v[130:131], v[110:111], v[22:23] op_sel:[1,0,0] op_sel_hi:[1,1,1]
    s_set_gpr_idx_off
    v_mfma_f32_4x4x4_16b_bf16 v[120:123], v[172:173], v[176:177], 0 cbsz:4 abid:15
    v_lshlrev_b32_sdwa v136, v15, v112 dst_sel:DWORD dst_unused:UNUSED_PAD src0_sel:DWORD src1_sel:WORD_1
    s_waitcnt vmcnt(3)
    v_mfma_f32_4x4x4_16b_bf16 v[104:107], v[146:147], v[92:93], 0 cbsz:4 abid:13
    s_nop 0
    v_mfma_f32_4x4x4_16b_bf16 v[108:111], v[146:147], v[94:95], 0 cbsz:4 abid:13
    v_lshlrev_b32_sdwa v137, v15, v113 dst_sel:DWORD dst_unused:UNUSED_PAD src0_sel:DWORD src1_sel:WORD_1
    ds_read_u16_d16_hi v128, v136 offset:32768
    ds_read_u16_d16_hi v129, v137 offset:32768
    s_waitcnt lgkmcnt(2)
    s_set_gpr_idx_on s54, 0xc
    v_pk_fma_f32 v[16:17], v[132:133], v[96:97], v[16:17] op_sel:[0,0,0] op_sel_hi:[0,1,1]
    v_pk_fma_f32 v[18:19], v[132:133], v[98:99], v[18:19] op_sel:[0,0,0] op_sel_hi:[0,1,1]
    v_pk_fma_f32 v[20:21], v[134:135], v[100:101], v[20:21] op_sel:[0,0,0] op_sel_hi:[0,1,1]
    v_pk_fma_f32 v[22:23], v[134:135], v[102:103], v[22:23] op_sel:[0,0,0] op_sel_hi:[0,1,1]
    s_set_gpr_idx_off
    v_lshlrev_b32_sdwa v138, v15, v116 dst_sel:DWORD dst_unused:UNUSED_PAD src0_sel:DWORD src1_sel:WORD_1
    s_waitcnt vmcnt(2)
    v_mfma_f32_4x4x4_16b_bf16 v[96:99], v[140:141], v[64:65], 0 cbsz:4 abid:14
    s_nop 0
    v_mfma_f32_4x4x4_16b_bf16 v[100:103], v[140:141], v[66:67], 0 cbsz:4 abid:14
    v_lshlrev_b32_sdwa v139, v15, v117 dst_sel:DWORD dst_unused:UNUSED_PAD src0_sel:DWORD src1_sel:WORD_1
    ds_read_u16_d16_hi v130, v138 offset:32768
    ds_read_u16_d16_hi v131, v139 offset:32768
    s_set_gpr_idx_on s55, 0xc
    v_pk_fma_f32 v[16:17], v[132:133], v[104:105], v[16:17] op_sel:[1,0,0] op_sel_hi:[1,1,1]
    v_pk_fma_f32 v[18:19], v[132:133], v[106:107], v[18:19] op_sel:[1,0,0] op_sel_hi:[1,1,1]
    v_pk_fma_f32 v[20:21], v[134:135], v[108:109], v[20:21] op_sel:[1,0,0] op_sel_hi:[1,1,1]
    v_pk_fma_f32 v[22:23], v[134:135], v[110:111], v[22:23] op_sel:[1,0,0] op_sel_hi:[1,1,1]
    s_set_gpr_idx_off
B_56:
    s_sub_u32 s32, s32, 4
    s_cbranch_scc1 MAIN_DONE
    v_mfma_f32_4x4x4_16b_bf16 v[124:127], v[172:173], v[178:179], 0 cbsz:4 abid:15
    v_lshlrev_b32_sdwa v136, v15, v114 dst_sel:DWORD dst_unused:UNUSED_PAD src0_sel:DWORD src1_sel:WORD_1
    s_waitcnt vmcnt(5)
    v_mfma_f32_4x4x4_16b_bf16 v[104:107], v[142:143], v[68:69], 0 cbsz:4 abid:14
    s_nop 0
    v_mfma_f32_4x4x4_16b_bf16 v[108:111], v[142:143], v[70:71], 0 cbsz:4 abid:14
    v_lshlrev_b32_sdwa v137, v15, v115 dst_sel:DWORD dst_unused:UNUSED_PAD src0_sel:DWORD src1_sel:WORD_1
    ds_read_u16_d16_hi v132, v136 offset:32768
    ds_read_u16_d16_hi v133, v137 offset:32768
    s_waitcnt lgkmcnt(2)
    s_set_gpr_idx_on s56, 0xc
    v_pk_fma_f32 v[16:17], v[128:129], v[96:97], v[16:17] op_sel:[0,0,0] op_sel_hi:[0,1,1]
    v_pk_fma_f32 v[18:19], v[128:129], v[98:99], v[18:19] op_sel:[0,0,0] op_sel_hi:[0,1,1]
    v_pk_fma_f32 v[20:21], v[130:131], v[100:101], v[20:21] op_sel:[0,0,0] op_sel_hi:[0,1,1]
    v_pk_fma_f32 v[22:23], v[130:131], v[102:103], v[22:23] op_sel:[0,0,0] op_sel_hi:[0,1,1]
    s_set_gpr_idx_off
    v_lshlrev_b32_sdwa v138, v15, v118 dst_sel:DWORD dst_unused:UNUSED_PAD src0_sel:DWORD src1_sel:WORD_1
    s_waitcnt vmcnt(4)
    v_mfma_f32_4x4x4_16b_bf16 v[96:99], v[144:145], v[72:73], 0 cbsz:4 abid:14
    s_nop 0
    v_mfma_f32_4x4x4_16b_bf16 v[100:103], v[144:145], v[74:75], 0 cbsz:4 abid:14
    v_lshlrev_b32_sdwa v139, v15, v119 dst_sel:DWORD dst_unused:UNUSED_PAD src0_sel:DWORD src1_sel:WORD_1
    ds_read_u16_d16_hi v134, v138 offset:32768
    ds_read_u16_d16_hi v135, v139 offset:32768
    s_set_gpr_idx_on s57, 0xc
    v_pk_fma_f32 v[16:17], v[128:129], v[104:105], v[16:17] op_sel:[1,0,0] op_sel_hi:[1,1,1]
    v_pk_fma_f32 v[18:19], v[128:129], v[106:107], v[18:19] op_sel:[1,0,0] op_sel_hi:[1,1,1]
    v_pk_fma_f32 v[20:21], v[130:131], v[108:109], v[20:21] op_sel:[1,0,0] op_sel_hi:[1,1,1]
    v_pk_fma_f32 v[22:23], v[130:131], v[110:111], v[22:23] op_sel:[1,0,0] op_sel_hi:[1,1,1]
    s_set_gpr_idx_off
    v_mov_b32 v172, v170
    v_mov_b32 v173, v171
    s_nop 1
    v_mfma_f32_4x4x4_16b_bf16 v[112:115], v[172:173], v[176:177], 0 cbsz:4 abid:0
    v_lshlrev_b32_sdwa v136, v15, v120 dst_sel:DWORD dst_unused:UNUSED_PAD src0_sel:DWORD src1_sel:WORD_1
    s_waitcnt vmcnt(3)
    v_mfma_f32_4x4x4_16b_bf16 v[104:107], v[146:147], v[76:77], 0 cbsz:4 abid:14
    s_nop 0
    v_mfma_f32_4x4x4_16b_bf16 v[108:111], v[146:147], v[78:79], 0 cbsz:4 abid:14
    v_lshlrev_b32_sdwa v137, v15, v121 dst_sel:DWORD dst_unused:UNUSED_PAD src0_sel:DWORD src1_sel:WORD_1
    ds_read_u16_d16_hi v128, v136 offset:32768
    ds_read_u16_d16_hi v129, v137 offset:32768
    s_waitcnt lgkmcnt(2)
    s_set_gpr_idx_on s58, 0xc
    v_pk_fma_f32 v[16:17], v[132:133], v[96:97], v[16:17] op_sel:[0,0,0] op_sel_hi:[0,1,1]
    v_pk_fma_f32 v[18:19], v[132:133], v[98:99], v[18:19] op_sel:[0,0,0] op_sel_hi:[0,1,1]
    v_pk_fma_f32 v[20:21], v[134:135], v[100:101], v[20:21] op_sel:[0,0,0] op_sel_hi:[0,1,1]
    v_pk_fma_f32 v[22:23], v[134:135], v[102:103], v[22:23] op_sel:[0,0,0] op_sel_hi:[0,1,1]
    s_set_gpr_idx_off
    v_lshlrev_b32_sdwa v138, v15, v124 dst_sel:DWORD dst_unused:UNUSED_PAD src0_sel:DWORD src1_sel:WORD_1
    s_waitcnt vmcnt(2)
    v_mfma_f32_4x4x4_16b_bf16 v[96:99], v[140:141], v[80:81], 0 cbsz:4 abid:15
    s_nop 0
    v_mfma_f32_4x4x4_16b_bf16 v[100:103], v[140:141], v[82:83], 0 cbsz:4 abid:15
    v_lshlrev_b32_sdwa v139, v15, v125 dst_sel:DWORD dst_unused:UNUSED_PAD src0_sel:DWORD src1_sel:WORD_1
    ds_read_u16_d16_hi v130, v138 offset:32768
    ds_read_u16_d16_hi v131, v139 offset:32768
    s_set_gpr_idx_on s59, 0xc
    v_pk_fma_f32 v[16:17], v[132:133], v[104:105], v[16:17] op_sel:[1,0,0] op_sel_hi:[1,1,1]
    v_pk_fma_f32 v[18:19], v[132:133], v[106:107], v[18:19] op_sel:[1,0,0] op_sel_hi:[1,1,1]
    v_pk_fma_f32 v[20:21], v[134:135], v[108:109], v[20:21] op_sel:[1,0,0] op_sel_hi:[1,1,1]
    v_pk_fma_f32 v[22:23], v[134:135], v[110:111], v[22:23] op_sel:[1,0,0] op_sel_hi:[1,1,1]
    s_set_gpr_idx_off
B_60:
    s_sub_u32 s32, s32, 4
    s_cbranch_scc1 MAIN_DONE
    v_mfma_f32_4x4x4_16b_bf16 v[116:119], v[172:173], v[178:179], 0 cbsz:4 abid:0
    v_lshlrev_b32_sdwa v136, v15, v122 dst_sel:DWORD dst_unused:UNUSED_PAD src0_sel:DWORD src1_sel:WORD_1
    s_waitcnt vmcnt(5)
    v_mfma_f32_4x4x4_16b_bf16 v[104:107], v[142:143], v[84:85], 0 cbsz:4 abid:15
    s_nop 0
    v_mfma_f32_4x4x4_16b_bf16 v[108:111], v[142:143], v[86:87], 0 cbsz:4 abid:15
    v_lshlrev_b32_sdwa v137, v15, v123 dst_sel:DWORD dst_unused:UNUSED_PAD src0_sel:DWORD src1_sel:WORD_1
    ds_read_u16_d16_hi v132, v136 offset:32768
    ds_read_u16_d16_hi v133, v137 offset:32768
    v_cvt_pk_bf16_f32 v140, v148, v152
    v_cvt_pk_bf16_f32 v141, v156, v160
    s_waitcnt lgkmcnt(2)
    s_set_gpr_idx_on s60, 0xc
    v_pk_fma_f32 v[16:17], v[128:129], v[96:97], v[16:17] op_sel:[0,0,0] op_sel_hi:[0,1,1]
    v_pk_fma_f32 v[18:19], v[128:129], v[98:99], v[18:19] op_sel:[0,0,0] op_sel_hi:[0,1,1]
    v_pk_fma_f32 v[20:21], v[130:131], v[100:101], v[20:21] op_sel:[0,0,0] op_sel_hi:[0,1,1]
    v_pk_fma_f32 v[22:23], v[130:131], v[102:103], v[22:23] op_sel:[0,0,0] op_sel_hi:[0,1,1]
    s_set_gpr_idx_off
    v_lshlrev_b32_sdwa v138, v15, v126 dst_sel:DWORD dst_unused:UNUSED_PAD src0_sel:DWORD src1_sel:WORD_1
    s_waitcnt vmcnt(4)
    v_mfma_f32_4x4x4_16b_bf16 v[96:99], v[144:145], v[88:89], 0 cbsz:4 abid:15
    s_nop 0
    v_mfma_f32_4x4x4_16b_bf16 v[100:103], v[144:145], v[90:91], 0 cbsz:4 abid:15
    v_lshlrev_b32_sdwa v139, v15, v127 dst_sel:DWORD dst_unused:UNUSED_PAD src0_sel:DWORD src1_sel:WORD_1
    ds_read_u16_d16_hi v134, v138 offset:32768
    ds_read_u16_d16_hi v135, v139 offset:32768
    v_cvt_pk_bf16_f32 v142, v149, v153
    v_cvt_pk_bf16_f32 v143, v157, v161
    s_set_gpr_idx_on s61, 0xc
    v_pk_fma_f32 v[16:17], v[128:129], v[104:105], v[16:17] op_sel:[1,0,0] op_sel_hi:[1,1,1]
    v_pk_fma_f32 v[18:19], v[128:129], v[106:107], v[18:19] op_sel:[1,0,0] op_sel_hi:[1,1,1]
    v_pk_fma_f32 v[20:21], v[130:131], v[108:109], v[20:21] op_sel:[1,0,0] op_sel_hi:[1,1,1]
    v_pk_fma_f32 v[22:23], v[130:131], v[110:111], v[22:23] op_sel:[1,0,0] op_sel_hi:[1,1,1]
    s_set_gpr_idx_off
    v_mfma_f32_4x4x4_16b_bf16 v[120:123], v[172:173], v[176:177], 0 cbsz:4 abid:1
    v_lshlrev_b32_sdwa v136, v15, v112 dst_sel:DWORD dst_unused:UNUSED_PAD src0_sel:DWORD src1_sel:WORD_1
    s_waitcnt vmcnt(3)
    v_mfma_f32_4x4x4_16b_bf16 v[104:107], v[146:147], v[92:93], 0 cbsz:4 abid:15
    s_nop 0
    v_mfma_f32_4x4x4_16b_bf16 v[108:111], v[146:147], v[94:95], 0 cbsz:4 abid:15
    v_lshlrev_b32_sdwa v137, v15, v113 dst_sel:DWORD dst_unused:UNUSED_PAD src0_sel:DWORD src1_sel:WORD_1
    ds_read_u16_d16_hi v128, v136 offset:32768
    ds_read_u16_d16_hi v129, v137 offset:32768
    v_cvt_pk_bf16_f32 v144, v150, v154
    v_cvt_pk_bf16_f32 v145, v158, v162
    s_waitcnt lgkmcnt(2)
    s_set_gpr_idx_on s62, 0xc
    v_pk_fma_f32 v[16:17], v[132:133], v[96:97], v[16:17] op_sel:[0,0,0] op_sel_hi:[0,1,1]
    v_pk_fma_f32 v[18:19], v[132:133], v[98:99], v[18:19] op_sel:[0,0,0] op_sel_hi:[0,1,1]
    v_pk_fma_f32 v[20:21], v[134:135], v[100:101], v[20:21] op_sel:[0,0,0] op_sel_hi:[0,1,1]
    v_pk_fma_f32 v[22:23], v[134:135], v[102:103], v[22:23] op_sel:[0,0,0] op_sel_hi:[0,1,1]
    s_set_gpr_idx_off
    v_lshlrev_b32_sdwa v138, v15, v116 dst_sel:DWORD dst_unused:UNUSED_PAD src0_sel:DWORD src1_sel:WORD_1
    s_waitcnt vmcnt(2)
    v_mfma_f32_4x4x4_16b_bf16 v[96:99], v[140:141], v[64:65], 0 cbsz:4 abid:0
    s_nop 0
    v_mfma_f32_4x4x4_16b_bf16 v[100:103], v[140:141], v[66:67], 0 cbsz:4 abid:0
    v_lshlrev_b32_sdwa v139, v15, v117 dst_sel:DWORD dst_unused:UNUSED_PAD src0_sel:DWORD src1_sel:WORD_1
    ds_read_u16_d16_hi v130, v138 offset:32768
    ds_read_u16_d16_hi v131, v139 offset:32768
    v_cvt_pk_bf16_f32 v146, v151, v155
    v_cvt_pk_bf16_f32 v147, v159, v163
    s_set_gpr_idx_on s63, 0xc
    v_pk_fma_f32 v[16:17], v[132:133], v[104:105], v[16:17] op_sel:[1,0,0] op_sel_hi:[1,1,1]
    v_pk_fma_f32 v[18:19], v[132:133], v[106:107], v[18:19] op_sel:[1,0,0] op_sel_hi:[1,1,1]
    v_pk_fma_f32 v[20:21], v[134:135], v[108:109], v[20:21] op_sel:[1,0,0] op_sel_hi:[1,1,1]
    v_pk_fma_f32 v[22:23], v[134:135], v[110:111], v[22:23] op_sel:[1,0,0] op_sel_hi:[1,1,1]
    s_set_gpr_idx_off
    v_mov_b32 v164, v165
    s_branch B_0
MAIN_DONE:
    s_waitcnt vmcnt(0) lgkmcnt(0)
    s_add_u32 s27, s27, 1472
    s_cmp_ge_u32 s27, s26
    s_cbranch_scc1 ALL_DONE
    v_lshlrev_b32 v11, 2, v0
    v_mov_b32 v12, 0
    v_cmp_gt_u32 vcc, 480, v0
    s_and_saveexec_b64 s[42:43], vcc
    ds_write_b32 v11, v12 offset:0
    s_mov_b64 exec, s[42:43]
    s_waitcnt lgkmcnt(0)
    s_barrier
    s_branch ROUND
ALL_DONE:
    v_cvt_pk_bf16_f32 v64, v16, v20
    v_cvt_pk_bf16_f32 v65, v17, v21
    v_cvt_pk_bf16_f32 v66, v18, v22
    v_cvt_pk_bf16_f32 v67, v19, v23
    v_cvt_pk_bf16_f32 v68, v24, v28
    v_cvt_pk_bf16_f32 v69, v25, v29
    v_cvt_pk_bf16_f32 v70, v26, v30
    v_cvt_pk_bf16_f32 v71, v27, v31
    v_cvt_pk_bf16_f32 v72, v32, v36
    v_cvt_pk_bf16_f32 v73, v33, v37
    v_cvt_pk_bf16_f32 v74, v34, v38
    v_cvt_pk_bf16_f32 v75, v35, v39
    v_cvt_pk_bf16_f32 v76, v40, v44
    v_cvt_pk_bf16_f32 v77, v41, v45
    v_cvt_pk_bf16_f32 v78, v42, v46
    v_cvt_pk_bf16_f32 v79, v43, v47
    v_cvt_pk_bf16_f32 v80, v48, v52
    v_cvt_pk_bf16_f32 v81, v49, v53
    v_cvt_pk_bf16_f32 v82, v50, v54
    v_cvt_pk_bf16_f32 v83, v51, v55
    v_lshrrev_b32 v8, 2, v1
    v_add_u32 v8, 32768, v8
    s_mul_i32 s42, s4, 1152
    v_add_u32 v96, s42, v8
    s_mul_i32 s42, s5, 1152
    v_add_u32 v97, s42, v8
    s_mul_i32 s42, s6, 1152
    v_add_u32 v98, s42, v8
    s_mul_i32 s42, s7, 1152
    v_add_u32 v99, s42, v8
    s_mul_i32 s42, s8, 1152
    v_add_u32 v100, s42, v8
    v_lshrrev_b32 v9, 4, v1
    v_and_b32 v10, 15, v9
    v_lshrrev_b32 v11, 4, v9
    s_lshr_b32 s42, s25, 2
    s_mul_i32 s43, s42, 23040
    s_add_u32 s43, s43, 32768
    v_mul_u32_u24 v8, 288, v10
    v_lshl_add_u32 v8, v11, 4, v8
    v_add_u32 v8, s43, v8
    s_mul_i32 s42, s42, 5242880
    s_lshl_b32 s43, s24, 10
    s_add_u32 s42, s42, s43
    s_and_b32 s43, s25, 3
    s_lshl_b32 s43, s43, 8
    s_add_u32 s42, s42, s43
    v_lshlrev_b32 v11, 18, v11
    v_lshl_add_u32 v11, v10, 4, v11
    v_add_u32 v11, s42, v11
    s_barrier
    ds_write_b32 v96, v64 offset:0
    ds_write_b32 v96, v65 offset:288
    ds_write_b32 v96, v66 offset:576
    ds_write_b32 v96, v67 offset:864
    ds_write_b32 v97, v68 offset:0
    ds_write_b32 v97, v69 offset:288
    ds_write_b32 v97, v70 offset:576
    ds_write_b32 v97, v71 offset:864
    ds_write_b32 v98, v72 offset:0
    ds_write_b32 v98, v73 offset:288
    ds_write_b32 v98, v74 offset:576
    ds_write_b32 v98, v75 offset:864
    ds_write_b32 v99, v76 offset:0
    ds_write_b32 v99, v77 offset:288
    ds_write_b32 v99, v78 offset:576
    ds_write_b32 v99, v79 offset:864
    ds_write_b32 v100, v80 offset:0
    ds_write_b32 v100, v81 offset:288
    ds_write_b32 v100, v82 offset:576
    ds_write_b32 v100, v83 offset:864
    s_waitcnt lgkmcnt(0)
    s_barrier
    ds_read_b128 v[64:67], v8 offset:0
    ds_read_b128 v[68:71], v8 offset:64
    ds_read_b128 v[72:75], v8 offset:128
    ds_read_b128 v[76:79], v8 offset:192
    ds_read_b128 v[80:83], v8 offset:4608
    ds_read_b128 v[84:87], v8 offset:4672
    ds_read_b128 v[88:91], v8 offset:4736
    ds_read_b128 v[92:95], v8 offset:4800
    s_waitcnt lgkmcnt(7)
    v_mfma_f32_16x16x32_bf16 v[16:19], v[64:67], v[188:191], 0
    v_mfma_f32_16x16x32_bf16 v[20:23], v[64:67], v[204:207], 0
    s_waitcnt lgkmcnt(6)
    v_mfma_f32_16x16x32_bf16 v[16:19], v[68:71], v[192:195], v[16:19]
    v_mfma_f32_16x16x32_bf16 v[20:23], v[68:71], v[208:211], v[20:23]
    s_waitcnt lgkmcnt(5)
    v_mfma_f32_16x16x32_bf16 v[16:19], v[72:75], v[196:199], v[16:19]
    v_mfma_f32_16x16x32_bf16 v[20:23], v[72:75], v[212:215], v[20:23]
    s_waitcnt lgkmcnt(4)
    v_mfma_f32_16x16x32_bf16 v[16:19], v[76:79], v[200:203], v[16:19]
    v_mfma_f32_16x16x32_bf16 v[20:23], v[76:79], v[216:219], v[20:23]
    ds_read_b128 v[64:67], v8 offset:9216
    ds_read_b128 v[68:71], v8 offset:9280
    ds_read_b128 v[72:75], v8 offset:9344
    ds_read_b128 v[76:79], v8 offset:9408
    s_waitcnt lgkmcnt(7)
    v_mfma_f32_16x16x32_bf16 v[24:27], v[80:83], v[188:191], 0
    v_mfma_f32_16x16x32_bf16 v[28:31], v[80:83], v[204:207], 0
    s_waitcnt lgkmcnt(6)
    v_mfma_f32_16x16x32_bf16 v[24:27], v[84:87], v[192:195], v[24:27]
    v_mfma_f32_16x16x32_bf16 v[28:31], v[84:87], v[208:211], v[28:31]
    s_waitcnt lgkmcnt(5)
    v_mfma_f32_16x16x32_bf16 v[24:27], v[88:91], v[196:199], v[24:27]
    v_mfma_f32_16x16x32_bf16 v[28:31], v[88:91], v[212:215], v[28:31]
    s_waitcnt lgkmcnt(4)
    v_mfma_f32_16x16x32_bf16 v[24:27], v[92:95], v[200:203], v[24:27]
    v_mfma_f32_16x16x32_bf16 v[28:31], v[92:95], v[216:219], v[28:31]
    v_cvt_pk_bf16_f32 v128, v16, v17
    v_cvt_pk_bf16_f32 v129, v18, v19
    v_cvt_pk_bf16_f32 v130, v20, v21
    v_cvt_pk_bf16_f32 v131, v22, v23
    buffer_store_dwordx4 v[128:131], v11, s[20:23], 0 offen sc0 sc1
    v_add_u32 v11, 1048576, v11
    ds_read_b128 v[80:83], v8 offset:13824
    ds_read_b128 v[84:87], v8 offset:13888
    ds_read_b128 v[88:91], v8 offset:13952
    ds_read_b128 v[92:95], v8 offset:14016
    s_waitcnt lgkmcnt(7)
    v_mfma_f32_16x16x32_bf16 v[32:35], v[64:67], v[188:191], 0
    v_mfma_f32_16x16x32_bf16 v[36:39], v[64:67], v[204:207], 0
    s_waitcnt lgkmcnt(6)
    v_mfma_f32_16x16x32_bf16 v[32:35], v[68:71], v[192:195], v[32:35]
    v_mfma_f32_16x16x32_bf16 v[36:39], v[68:71], v[208:211], v[36:39]
    s_waitcnt lgkmcnt(5)
    v_mfma_f32_16x16x32_bf16 v[32:35], v[72:75], v[196:199], v[32:35]
    v_mfma_f32_16x16x32_bf16 v[36:39], v[72:75], v[212:215], v[36:39]
    s_waitcnt lgkmcnt(4)
    v_mfma_f32_16x16x32_bf16 v[32:35], v[76:79], v[200:203], v[32:35]
    v_mfma_f32_16x16x32_bf16 v[36:39], v[76:79], v[216:219], v[36:39]
    v_cvt_pk_bf16_f32 v132, v24, v25
    v_cvt_pk_bf16_f32 v133, v26, v27
    v_cvt_pk_bf16_f32 v134, v28, v29
    v_cvt_pk_bf16_f32 v135, v30, v31
    buffer_store_dwordx4 v[132:135], v11, s[20:23], 0 offen sc0 sc1
    v_add_u32 v11, 1048576, v11
    ds_read_b128 v[64:67], v8 offset:18432
    ds_read_b128 v[68:71], v8 offset:18496
    ds_read_b128 v[72:75], v8 offset:18560
    ds_read_b128 v[76:79], v8 offset:18624
    s_waitcnt lgkmcnt(7)
    v_mfma_f32_16x16x32_bf16 v[40:43], v[80:83], v[188:191], 0
    v_mfma_f32_16x16x32_bf16 v[44:47], v[80:83], v[204:207], 0
    s_waitcnt lgkmcnt(6)
    v_mfma_f32_16x16x32_bf16 v[40:43], v[84:87], v[192:195], v[40:43]
    v_mfma_f32_16x16x32_bf16 v[44:47], v[84:87], v[208:211], v[44:47]
    s_waitcnt lgkmcnt(5)
    v_mfma_f32_16x16x32_bf16 v[40:43], v[88:91], v[196:199], v[40:43]
    v_mfma_f32_16x16x32_bf16 v[44:47], v[88:91], v[212:215], v[44:47]
    s_waitcnt lgkmcnt(4)
    v_mfma_f32_16x16x32_bf16 v[40:43], v[92:95], v[200:203], v[40:43]
    v_mfma_f32_16x16x32_bf16 v[44:47], v[92:95], v[216:219], v[44:47]
    v_cvt_pk_bf16_f32 v128, v32, v33
    v_cvt_pk_bf16_f32 v129, v34, v35
    v_cvt_pk_bf16_f32 v130, v36, v37
    v_cvt_pk_bf16_f32 v131, v38, v39
    buffer_store_dwordx4 v[128:131], v11, s[20:23], 0 offen sc0 sc1
    v_add_u32 v11, 1048576, v11
    s_waitcnt lgkmcnt(3)
    v_mfma_f32_16x16x32_bf16 v[48:51], v[64:67], v[188:191], 0
    v_mfma_f32_16x16x32_bf16 v[52:55], v[64:67], v[204:207], 0
    s_waitcnt lgkmcnt(2)
    v_mfma_f32_16x16x32_bf16 v[48:51], v[68:71], v[192:195], v[48:51]
    v_mfma_f32_16x16x32_bf16 v[52:55], v[68:71], v[208:211], v[52:55]
    s_waitcnt lgkmcnt(1)
    v_mfma_f32_16x16x32_bf16 v[48:51], v[72:75], v[196:199], v[48:51]
    v_mfma_f32_16x16x32_bf16 v[52:55], v[72:75], v[212:215], v[52:55]
    s_waitcnt lgkmcnt(0)
    v_mfma_f32_16x16x32_bf16 v[48:51], v[76:79], v[200:203], v[48:51]
    v_mfma_f32_16x16x32_bf16 v[52:55], v[76:79], v[216:219], v[52:55]
    v_cvt_pk_bf16_f32 v132, v40, v41
    v_cvt_pk_bf16_f32 v133, v42, v43
    v_cvt_pk_bf16_f32 v134, v44, v45
    v_cvt_pk_bf16_f32 v135, v46, v47
    buffer_store_dwordx4 v[132:135], v11, s[20:23], 0 offen sc0 sc1
    v_add_u32 v11, 1048576, v11
    s_nop 7
    v_cvt_pk_bf16_f32 v128, v48, v49
    v_cvt_pk_bf16_f32 v129, v50, v51
    v_cvt_pk_bf16_f32 v130, v52, v53
    v_cvt_pk_bf16_f32 v131, v54, v55
    buffer_store_dwordx4 v[128:131], v11, s[20:23], 0 offen sc0 sc1
END:
    s_endpgm
.section .rodata,"a"
.p2align 6
.amdhsa_kernel gather_scatter__tensor_product_equiv_tfn__graph_kernel
  .amdhsa_next_free_vgpr 220
  .amdhsa_next_free_sgpr 64
  .amdhsa_accum_offset 220
  .amdhsa_group_segment_fixed_size 0
  .amdhsa_kernarg_size 88
  .amdhsa_user_sgpr_count 2
  .amdhsa_user_sgpr_kernarg_segment_ptr 1
  .amdhsa_system_sgpr_workgroup_id_x 1
  .amdhsa_float_denorm_mode_32 3
.end_amdhsa_kernel
```

```asm
; @launch grid=(256,1,1) block=(512,1,1) lds=163840
.amdgcn_target "amdgcn-amd-amdhsa--gfx950"
.text
.globl gather_scatter__tensor_product_equiv_tfn__graph_kernel
.p2align 8
.type gather_scatter__tensor_product_equiv_tfn__graph_kernel,@function
gather_scatter__tensor_product_equiv_tfn__graph_kernel:
    s_cmp_ge_u32 s2, 256
    s_cbranch_scc1 END
    s_load_dwordx16 s[40:55], s[0:1], 0
    s_load_dwordx4 s[56:59], s[0:1], 64
    s_load_dwordx2 s[16:17], s[0:1], 80
    s_load_dwordx2 s[12:13], s[0:1], 0
    s_load_dwordx2 s[20:21], s[0:1], 64
    s_and_b32 s4, s2, 7
    s_lshl_b32 s4, s4, 5
    s_lshr_b32 s5, s2, 3
    s_or_b32 s24, s4, s5
    v_lshrrev_b32 v8, 6, v0
    v_and_b32 v9, 63, v0
    v_lshlrev_b32 v1, 4, v9
    v_readfirstlane_b32 s25, v8
    v_lshlrev_b32 v11, 3, v0
    v_mov_b32 v12, 0
    v_mov_b32 v13, 0
    ds_write_b64 v11, v[12:13]
    v_mov_b32 v15, 1
    s_mov_b32 s14, 10240000
    s_mov_b32 s15, 0x20000
    s_mov_b32 s18, 8650880
    s_mov_b32 s19, 0x20000
    s_mov_b32 s22, 10240000
    s_mov_b32 s23, 0x20000
    s_mov_b32 s34, 0xfffffc00
    s_mov_b32 s27, 0
    s_mov_b32 s10, 0xbfb8aa3b
    s_mov_b32 s11, 0xbfb8aa3b
    v_mul_u32_u24 v14, 52, v9
    v_lshrrev_b32 v14, 8, v14
    v_mul_u32_u24 v7, 5, v14
    v_sub_u32 v7, v9, v7
    v_lshlrev_b32 v14, 2, v14
    v_lshlrev_b32 v7, 2, v7
    s_mov_b32 s35, 2097152
    v_and_b32 v4, 0xff, v0
    s_lshl_b32 s3, s24, 3
    s_add_u32 s3, s3, 7864320
    v_lshl_add_u32 v6, v4, 11, s3
    s_and_b32 s3, s2, 7
    s_lshl_b32 s3, s3, 7
    s_add_u32 s3, s3, 8388608
    s_lshl_b32 s4, s25, 15
    s_add_u32 s3, s3, s4
    v_and_b32 v166, 31, v0
    v_lshl_add_u32 v166, v166, 10, s3
    v_mul_u32_u24 v4, 1280, v4
    v_mov_b32 v16, 0
    v_mov_b32 v17, 0
    v_mov_b32 v18, 0
    v_mov_b32 v19, 0
    v_mov_b32 v20, 0
    v_mov_b32 v21, 0
    v_mov_b32 v22, 0
    v_mov_b32 v23, 0
    v_mov_b32 v24, 0
    v_mov_b32 v25, 0
    v_mov_b32 v26, 0
    v_mov_b32 v27, 0
    v_mov_b32 v28, 0
    v_mov_b32 v29, 0
    v_mov_b32 v30, 0
    v_mov_b32 v31, 0
    v_mov_b32 v32, 0
    v_mov_b32 v33, 0
    v_mov_b32 v34, 0
    v_mov_b32 v35, 0
    v_mov_b32 v36, 0
    v_mov_b32 v37, 0
    v_mov_b32 v38, 0
    v_mov_b32 v39, 0
    v_mov_b32 v40, 0
    v_mov_b32 v41, 0
    v_mov_b32 v42, 0
    v_mov_b32 v43, 0
    v_mov_b32 v44, 0
    v_mov_b32 v45, 0
    v_mov_b32 v46, 0
    v_mov_b32 v47, 0
    v_mov_b32 v48, 0
    v_mov_b32 v49, 0
    v_mov_b32 v50, 0
    v_mov_b32 v51, 0
    v_mov_b32 v52, 0
    v_mov_b32 v53, 0
    v_mov_b32 v54, 0
    v_mov_b32 v55, 0
    v_mov_b32 v56, 0
    v_mov_b32 v57, 0
    v_mov_b32 v58, 0
    v_mov_b32 v59, 0
    v_mov_b32 v60, 0
    v_mov_b32 v61, 0
    v_mov_b32 v62, 0
    v_mov_b32 v63, 0
    s_cmp_ge_u32 s25, 5
    s_cbranch_scc1 HELP
    v_mul_u32_u24 v138, 0x8000, v1
    v_lshrrev_b32 v10, 1, v1
    v_add_u32 v138, v138, v10
    s_cmp_ge_u32 s2, 250
    s_cbranch_scc1 AUX
    s_mul_i32 s3, s2, 5120
    v_lshl_add_u32 v8, v0, 4, s3
    v_lshlrev_b32 v9, 1, v8
    s_mov_b32 s9, 87040
    s_setprio 1
    s_waitcnt lgkmcnt(0)
    global_load_dwordx4 v[64:67], v8, s[44:45]
    global_load_dwordx4 v[68:71], v8, s[42:43]
    v_lshrrev_b32 v193, 2, v1
    global_load_dword v188, v193, s[50:51] offset:0
    global_load_dword v189, v193, s[50:51] offset:256
    global_load_dword v190, v193, s[50:51] offset:512
    global_load_dword v191, v193, s[50:51] offset:768
    v_and_b32 v193, 0x7f, v193
    global_load_dword v192, v193, s[52:53]
    s_add_u32 s4, s16, 8650752
    s_addc_u32 s5, s17, 0
    s_load_dwordx2 s[64:65], s[4:5], 0
    s_barrier
    s_add_u32 s62, s25, 1
LUTP_W0L:
    s_mul_i32 s3, s62, 33554944
    s_add_u32 s3, s3, 4286709632
    v_add_u32 v128, s3, v138
    s_lshl_b32 s3, s62, 10
    v_add_u32 v136, s3, v1
    v_add_u32 v129, 131074, v128
    v_add_u32 v130, 262148, v128
    v_add_u32 v131, 393222, v128
    v_add_u32 v137, 0x10000, v136
    v_or_b32 v132, 0x80008000, v128
    v_or_b32 v133, 0x80008000, v129
    v_or_b32 v134, 0x80008000, v130
    v_or_b32 v135, 0x80008000, v131
    ds_write_b128 v136, v[128:131] offset:32768
    ds_write_b128 v137, v[132:135] offset:32768
    s_add_u32 s62, s62, 5
    s_cmp_le_u32 s62, 15
    s_cbranch_scc1 LUTP_W0L
LUTP_END_W0:
    global_load_dwordx4 v[72:75], v9, s[46:47]
    global_load_dwordx4 v[76:79], v9, s[46:47] offset:16
    global_load_dwordx4 v[80:83], v9, s[48:49]
    global_load_dwordx4 v[84:87], v9, s[48:49] offset:16
    s_cmp_gt_u32 s62, 24
    s_cbranch_scc1 LUTP_END_W
LUTP_WL:
    s_mul_i32 s3, s62, 33554944
    s_add_u32 s3, s3, 4286709632
    v_add_u32 v128, s3, v138
    s_lshl_b32 s3, s62, 10
    v_add_u32 v136, s3, v1
    v_add_u32 v129, 131074, v128
    v_add_u32 v130, 262148, v128
    v_add_u32 v131, 393222, v128
    v_add_u32 v137, 0x10000, v136
    v_or_b32 v132, 0x80008000, v128
    v_or_b32 v133, 0x80008000, v129
    v_or_b32 v134, 0x80008000, v130
    v_or_b32 v135, 0x80008000, v131
    ds_write_b128 v136, v[128:131] offset:32768
    ds_write_b128 v137, v[132:135] offset:32768
    s_add_u32 s62, s62, 5
    s_cmp_le_u32 s62, 24
    s_cbranch_scc1 LUTP_WL
LUTP_END_W:
    s_waitcnt lgkmcnt(0)
    s_add_u32 s64, s64, 1
    s_and_b32 s65, s65, 0x3ff
    v_mov_b32 v109, s64
    v_mov_b32 v111, s64
    v_mov_b32 v113, s64
    v_mov_b32 v115, s64
    s_waitcnt vmcnt(10)
    v_and_b32 v88, 0xff, v64
    v_lshlrev_b32 v88, 2, v88
    ds_add_rtn_u32 v92, v88, v15 offset:2304
    v_and_b32 v89, 0xff, v65
    v_lshlrev_b32 v89, 2, v89
    ds_add_rtn_u32 v93, v89, v15 offset:2304
    v_and_b32 v90, 0xff, v66
    v_lshlrev_b32 v90, 2, v90
    ds_add_rtn_u32 v94, v90, v15 offset:2304
    v_and_b32 v91, 0xff, v67
    v_lshlrev_b32 v91, 2, v91
    ds_add_rtn_u32 v95, v91, v15 offset:2304
    s_waitcnt vmcnt(9)
    v_lshrrev_b32 v64, 8, v64
    v_lshl_or_b32 v108, v68, 10, v64
    v_lshrrev_b32 v65, 8, v65
    v_lshl_or_b32 v110, v69, 10, v65
    v_lshrrev_b32 v66, 8, v66
    v_lshl_or_b32 v112, v70, 10, v66
    v_lshrrev_b32 v67, 8, v67
    v_lshl_or_b32 v114, v71, 10, v67
    s_waitcnt lgkmcnt(0)
    s_barrier
    ds_read_b128 v[96:99], v1 offset:2304
    s_waitcnt lgkmcnt(0)
    v_add_u32 v10, v96, v97
    v_add3_u32 v10, v10, v98, v99
    v_mov_b32 v11, v10
    s_nop 1
    v_add_u32_dpp v11, v11, v11 row_shr:1 row_mask:0xf bank_mask:0xf bound_ctrl:0
    s_nop 1
    v_add_u32_dpp v11, v11, v11 row_shr:2 row_mask:0xf bank_mask:0xf bound_ctrl:0
    s_nop 1
    v_add_u32_dpp v11, v11, v11 row_shr:4 row_mask:0xf bank_mask:0xf bound_ctrl:0
    s_nop 1
    v_add_u32_dpp v11, v11, v11 row_shr:8 row_mask:0xf bank_mask:0xf bound_ctrl:0
    s_nop 1
    v_add_u32_dpp v11, v11, v11 row_bcast:15 row_mask:0xa bank_mask:0xf
    s_nop 1
    v_add_u32_dpp v11, v11, v11 row_bcast:31 row_mask:0xc bank_mask:0xf
    v_sub_u32 v100, v11, v10
    v_add_u32 v101, v100, v96
    v_add_u32 v102, v101, v97
    v_add_u32 v103, v102, v98
    ds_write_b128 v1, v[100:103] offset:3328
    ds_read_b32 v96, v88 offset:3328
    ds_read_b32 v97, v89 offset:3328
    ds_read_b32 v98, v90 offset:3328
    ds_read_b32 v99, v91 offset:3328
    s_waitcnt lgkmcnt(3)
    v_add_u32 v92, v92, v96
    v_lshl_add_u32 v88, v92, 3, s9
    ds_write_b64 v88, v[108:109]
    s_waitcnt lgkmcnt(3)
    v_add_u32 v93, v93, v97
    v_lshl_add_u32 v89, v93, 3, s9
    ds_write_b64 v89, v[110:111]
    s_waitcnt lgkmcnt(3)
    v_add_u32 v94, v94, v98
    v_lshl_add_u32 v90, v94, 3, s9
    ds_write_b64 v90, v[112:113]
    s_waitcnt lgkmcnt(3)
    v_add_u32 v95, v95, v99
    v_lshl_add_u32 v91, v95, 3, s9
    ds_write_b64 v91, v[114:115]
    v_lshlrev_b32 v92, 4, v92
    v_add_u32 v92, 4352, v92
    v_lshlrev_b32 v93, 4, v93
    v_add_u32 v93, 4352, v93
    v_lshlrev_b32 v94, 4, v94
    v_add_u32 v94, 4352, v94
    v_lshlrev_b32 v95, 4, v95
    v_add_u32 v95, 4352, v95
    s_waitcnt lgkmcnt(0)
    s_barrier
    s_waitcnt vmcnt(0)
    ds_write2_b64 v92, v[72:73], v[80:81] offset0:0 offset1:1
    ds_write2_b64 v93, v[74:75], v[82:83] offset0:0 offset1:1
    ds_write2_b64 v94, v[76:77], v[84:85] offset0:0 offset1:1
    ds_write2_b64 v95, v[78:79], v[86:87] offset0:0 offset1:1
    ds_write_b32 v193, v192 offset:31744
    v_lshrrev_b32 v193, 3, v1
    v_and_b32 v193, 24, v193
    s_mov_b32 s4, 0x05040100
    s_mov_b32 s5, 0x07060302
    ds_read_b64_tr_b16 v[180:181], v193 offset:31744
    ds_read_b64_tr_b16 v[182:183], v193 offset:31776
    ds_read_b64_tr_b16 v[184:185], v193 offset:31808
    ds_read_b64_tr_b16 v[186:187], v193 offset:31840
    v_perm_b32 v176, v189, v188, s4
    v_perm_b32 v178, v189, v188, s5
    v_perm_b32 v177, v191, v190, s4
    v_perm_b32 v179, v191, v190, s5
    s_setprio 0
    s_branch BINNED
AUX:
    v_lshrrev_b32 v8, 4, v1
    s_waitcnt lgkmcnt(0)
    s_add_u32 s4, s16, 8650752
    s_addc_u32 s5, s17, 0
    s_load_dwordx2 s[64:65], s[4:5], 0
    v_lshrrev_b32 v193, 2, v1
    global_load_dword v188, v193, s[50:51] offset:0
    global_load_dword v189, v193, s[50:51] offset:256
    global_load_dword v190, v193, s[50:51] offset:512
    global_load_dword v191, v193, s[50:51] offset:768
    v_and_b32 v193, 0x7f, v193
    global_load_dword v192, v193, s[52:53]
    s_waitcnt lgkmcnt(0)
    s_cmp_ge_u32 s2, 254
    s_cbranch_scc1 AUX_IDLE
    s_cmp_ge_u32 s25, 4
    s_cbranch_scc1 AUX_IDLE
    s_sub_u32 s4, s2, 250
    s_lshl_b32 s5, s25, 13
    s_lshl_b32 s6, s4, 6
    s_add_u32 s5, s5, s6
    v_lshrrev_b32 v9, 4, v8
    v_lshlrev_b32 v9, 11, v9
    v_and_b32 v10, 15, v8
    v_lshl_add_u32 v9, v10, 2, v9
    v_add_u32 v9, s5, v9
    s_lshl_b32 s5, s4, 13
    s_lshl_b32 s6, s25, 10
    s_add_u32 s5, s5, s6
    s_add_u32 s5, s5, 7802880
    v_add_u32 v10, s5, v1
    s_mov_b32 s4, 0x05040100
    s_mov_b32 s5, 0x07060302
    global_load_dword v64, v9, s[54:55] offset:0
    global_load_dword v65, v9, s[54:55] offset:256
    global_load_dword v66, v9, s[54:55] offset:512
    global_load_dword v67, v9, s[54:55] offset:768
    global_load_dword v68, v9, s[54:55] offset:1024
    global_load_dword v69, v9, s[54:55] offset:1280
    global_load_dword v70, v9, s[54:55] offset:1536
    global_load_dword v71, v9, s[54:55] offset:1792
    s_barrier
    s_add_u32 s62, s25, 1
LUTP_XL:
    s_mul_i32 s3, s62, 33554944
    s_add_u32 s3, s3, 4286709632
    v_add_u32 v128, s3, v138
    s_lshl_b32 s3, s62, 10
    v_add_u32 v136, s3, v1
    v_add_u32 v129, 131074, v128
    v_add_u32 v130, 262148, v128
    v_add_u32 v131, 393222, v128
    v_add_u32 v137, 0x10000, v136
    v_or_b32 v132, 0x80008000, v128
    v_or_b32 v133, 0x80008000, v129
    v_or_b32 v134, 0x80008000, v130
    v_or_b32 v135, 0x80008000, v131
    ds_write_b128 v136, v[128:131] offset:32768
    ds_write_b128 v137, v[132:135] offset:32768
    s_add_u32 s62, s62, 5
    s_cmp_le_u32 s62, 24
    s_cbranch_scc1 LUTP_XL
LUTP_END_X:
    s_waitcnt vmcnt(0)
    v_perm_b32 v72, v65, v64, s4
    v_perm_b32 v76, v65, v64, s5
    v_perm_b32 v73, v67, v66, s4
    v_perm_b32 v77, v67, v66, s5
    v_perm_b32 v74, v69, v68, s4
    v_perm_b32 v78, v69, v68, s5
    v_perm_b32 v75, v71, v70, s4
    v_perm_b32 v79, v71, v70, s5
    global_store_dwordx4 v10, v[72:75], s[16:17] sc0 sc1
    v_add_u32 v10, 4096, v10
    global_store_dwordx4 v10, v[76:79], s[16:17] sc0 sc1
    s_branch AUX_DONE
AUX_IDLE:
    s_barrier
    s_add_u32 s62, s25, 1
LUTP_ZL:
    s_mul_i32 s3, s62, 33554944
    s_add_u32 s3, s3, 4286709632
    v_add_u32 v128, s3, v138
    s_lshl_b32 s3, s62, 10
    v_add_u32 v136, s3, v1
    v_add_u32 v129, 131074, v128
    v_add_u32 v130, 262148, v128
    v_add_u32 v131, 393222, v128
    v_add_u32 v137, 0x10000, v136
    v_or_b32 v132, 0x80008000, v128
    v_or_b32 v133, 0x80008000, v129
    v_or_b32 v134, 0x80008000, v130
    v_or_b32 v135, 0x80008000, v131
    ds_write_b128 v136, v[128:131] offset:32768
    ds_write_b128 v137, v[132:135] offset:32768
    s_add_u32 s62, s62, 5
    s_cmp_le_u32 s62, 24
    s_cbranch_scc1 LUTP_ZL
LUTP_END_Z:
AUX_DONE:
    s_add_u32 s64, s64, 1
    s_and_b32 s65, s65, 0x3ff
    s_waitcnt lgkmcnt(0)
    s_barrier
    s_barrier
    s_waitcnt vmcnt(0)
    ds_write_b32 v193, v192 offset:31744
    v_lshrrev_b32 v193, 3, v1
    v_and_b32 v193, 24, v193
    s_mov_b32 s4, 0x05040100
    s_mov_b32 s5, 0x07060302
    ds_read_b64_tr_b16 v[180:181], v193 offset:31744
    ds_read_b64_tr_b16 v[182:183], v193 offset:31776
    ds_read_b64_tr_b16 v[184:185], v193 offset:31808
    ds_read_b64_tr_b16 v[186:187], v193 offset:31840
    v_perm_b32 v176, v189, v188, s4
    v_perm_b32 v178, v189, v188, s5
    v_perm_b32 v177, v191, v190, s4
    v_perm_b32 v179, v191, v190, s5
    s_branch BINNED
HELP:
    s_waitcnt lgkmcnt(0)
    s_add_u32 s4, s16, 8650752
    s_addc_u32 s5, s17, 0
    s_load_dwordx2 s[64:65], s[4:5], 0
    v_lshrrev_b32 v193, 2, v1
    global_load_dword v188, v193, s[50:51] offset:0
    global_load_dword v189, v193, s[50:51] offset:256
    global_load_dword v190, v193, s[50:51] offset:512
    global_load_dword v191, v193, s[50:51] offset:768
    v_and_b32 v193, 0x7f, v193
    global_load_dword v192, v193, s[52:53]
    s_barrier
    s_cmp_lg_u32 s25, 7
    s_cbranch_scc1 HELP56
    s_mov_b32 s62, 63
    s_mov_b32 s63, 1
LUT_7a:
    s_lshl_b32 s3, s62, 25
    s_add_u32 s3, s3, 0x8000
    v_lshl_add_u32 v128, v1, 15, s3
    v_add_u32 v129, 65536, v128
    v_add_u32 v130, 131072, v128
    v_add_u32 v131, 196608, v128
    v_add_u32 v132, 262144, v128
    v_add_u32 v133, 327680, v128
    v_add_u32 v134, 393216, v128
    v_add_u32 v135, 458752, v128
    v_pk_mul_f32 v[136:137], v[128:129], s[10:11]
    v_pk_mul_f32 v[138:139], v[130:131], s[10:11]
    v_pk_mul_f32 v[140:141], v[132:133], s[10:11]
    v_pk_mul_f32 v[142:143], v[134:135], s[10:11]
    v_exp_f32 v136, v136
    v_exp_f32 v137, v137
    v_exp_f32 v138, v138
    v_exp_f32 v139, v139
    v_exp_f32 v140, v140
    v_exp_f32 v141, v141
    v_exp_f32 v142, v142
    v_exp_f32 v143, v143
    s_lshl_b32 s3, s62, 10
    v_pk_add_f32 v[144:145], v[136:137], 1.0 op_sel_hi:[1,0]
    v_pk_add_f32 v[146:147], v[138:139], 1.0 op_sel_hi:[1,0]
    v_pk_add_f32 v[148:149], v[140:141], 1.0 op_sel_hi:[1,0]
    v_pk_add_f32 v[150:151], v[142:143], 1.0 op_sel_hi:[1,0]
    v_rcp_f32 v144, v144
    v_rcp_f32 v145, v145
    v_rcp_f32 v146, v146
    v_rcp_f32 v147, v147
    v_rcp_f32 v148, v148
    v_rcp_f32 v149, v149
    v_rcp_f32 v150, v150
    v_rcp_f32 v151, v151
    v_add_u32 v160, s3, v1
    v_pk_mul_f32 v[128:129], v[128:129], v[144:145]
    v_pk_mul_f32 v[130:131], v[130:131], v[146:147]
    v_pk_mul_f32 v[132:133], v[132:133], v[148:149]
    v_pk_mul_f32 v[134:135], v[134:135], v[150:151]
    v_add_u32 v161, 0x10000, v160
    v_pk_mul_f32 v[136:137], v[128:129], v[136:137] neg_lo:[1,0] neg_hi:[1,0]
    v_pk_mul_f32 v[138:139], v[130:131], v[138:139] neg_lo:[1,0] neg_hi:[1,0]
    v_pk_mul_f32 v[140:141], v[132:133], v[140:141] neg_lo:[1,0] neg_hi:[1,0]
    v_pk_mul_f32 v[142:143], v[134:135], v[142:143] neg_lo:[1,0] neg_hi:[1,0]
    v_cvt_pk_bf16_f32 v152, v128, v129
    v_cvt_pk_bf16_f32 v153, v130, v131
    v_cvt_pk_bf16_f32 v154, v132, v133
    v_cvt_pk_bf16_f32 v155, v134, v135
    v_cvt_pk_bf16_f32 v156, v136, v137
    v_cvt_pk_bf16_f32 v157, v138, v139
    v_cvt_pk_bf16_f32 v158, v140, v141
    v_cvt_pk_bf16_f32 v159, v142, v143
    ds_write_b128 v160, v[152:155] offset:32768
    ds_write_b128 v161, v[156:159] offset:32768
    s_add_u32 s62, s62, 1
    s_sub_u32 s63, s63, 1
    s_cmp_lg_u32 s63, 0
    s_cbranch_scc1 LUT_7a
    v_mov_b32 v10, 65280
    v_mov_b32 v11, 0x7f80
    ds_write_b16 v10, v11 offset:32768
    s_mov_b32 s62, 33
    s_mov_b32 s63, 1
LUT_7b:
    s_lshl_b32 s3, s62, 25
    s_add_u32 s3, s3, 0x8000
    v_lshl_add_u32 v128, v1, 15, s3
    v_add_u32 v129, 65536, v128
    v_add_u32 v130, 131072, v128
    v_add_u32 v131, 196608, v128
    v_add_u32 v132, 262144, v128
    v_add_u32 v133, 327680, v128
    v_add_u32 v134, 393216, v128
    v_add_u32 v135, 458752, v128
    v_pk_mul_f32 v[136:137], v[128:129], s[10:11]
    v_pk_mul_f32 v[138:139], v[130:131], s[10:11]
    v_pk_mul_f32 v[140:141], v[132:133], s[10:11]
    v_pk_mul_f32 v[142:143], v[134:135], s[10:11]
    v_exp_f32 v136, v136
    v_exp_f32 v137, v137
    v_exp_f32 v138, v138
    v_exp_f32 v139, v139
    v_exp_f32 v140, v140
    v_exp_f32 v141, v141
    v_exp_f32 v142, v142
    v_exp_f32 v143, v143
    s_lshl_b32 s3, s62, 10
    v_pk_add_f32 v[144:145], v[136:137], 1.0 op_sel_hi:[1,0]
    v_pk_add_f32 v[146:147], v[138:139], 1.0 op_sel_hi:[1,0]
    v_pk_add_f32 v[148:149], v[140:141], 1.0 op_sel_hi:[1,0]
    v_pk_add_f32 v[150:151], v[142:143], 1.0 op_sel_hi:[1,0]
    v_rcp_f32 v144, v144
    v_rcp_f32 v145, v145
    v_rcp_f32 v146, v146
    v_rcp_f32 v147, v147
    v_rcp_f32 v148, v148
    v_rcp_f32 v149, v149
    v_rcp_f32 v150, v150
    v_rcp_f32 v151, v151
    v_add_u32 v160, s3, v1
    v_pk_mul_f32 v[128:129], v[128:129], v[144:145]
    v_pk_mul_f32 v[130:131], v[130:131], v[146:147]
    v_pk_mul_f32 v[132:133], v[132:133], v[148:149]
    v_pk_mul_f32 v[134:135], v[134:135], v[150:151]
    v_add_u32 v161, 0x10000, v160
    v_pk_mul_f32 v[136:137], v[128:129], v[136:137] neg_lo:[1,0] neg_hi:[1,0]
    v_pk_mul_f32 v[138:139], v[130:131], v[138:139] neg_lo:[1,0] neg_hi:[1,0]
    v_pk_mul_f32 v[140:141], v[132:133], v[140:141] neg_lo:[1,0] neg_hi:[1,0]
    v_pk_mul_f32 v[142:143], v[134:135], v[142:143] neg_lo:[1,0] neg_hi:[1,0]
    v_cvt_pk_bf16_f32 v152, v128, v129
    v_cvt_pk_bf16_f32 v153, v130, v131
    v_cvt_pk_bf16_f32 v154, v132, v133
    v_cvt_pk_bf16_f32 v155, v134, v135
    v_cvt_pk_bf16_f32 v156, v136, v137
    v_cvt_pk_bf16_f32 v157, v138, v139
    v_cvt_pk_bf16_f32 v158, v140, v141
    v_cvt_pk_bf16_f32 v159, v142, v143
    ds_write_b128 v160, v[152:155] offset:32768
    ds_write_b128 v161, v[156:159] offset:32768
    s_add_u32 s62, s62, 1
    s_sub_u32 s63, s63, 1
    s_cmp_lg_u32 s63, 0
    s_cbranch_scc1 LUT_7b
    s_waitcnt vmcnt(0)
    ds_write_b32 v193, v192 offset:31744
    v_lshrrev_b32 v193, 3, v1
    v_and_b32 v193, 24, v193
    s_mov_b32 s4, 0x05040100
    s_mov_b32 s5, 0x07060302
    ds_read_b64_tr_b16 v[180:181], v193 offset:31744
    ds_read_b64_tr_b16 v[182:183], v193 offset:31776
    ds_read_b64_tr_b16 v[184:185], v193 offset:31808
    ds_read_b64_tr_b16 v[186:187], v193 offset:31840
    v_perm_b32 v176, v189, v188, s4
    v_perm_b32 v178, v189, v188, s5
    v_perm_b32 v177, v191, v190, s4
    v_perm_b32 v179, v191, v190, s5
    s_waitcnt lgkmcnt(0)
    s_add_u32 s64, s64, 1
    s_and_b32 s65, s65, 0x3ff
    s_barrier
    s_mul_i32 s3, s2, 10240
    s_add_u32 s3, s3, 0
    v_add_u32 v9, s3, v1
    v_add_u32 v10, 87040, v1
    s_barrier
    ds_read_b128 v[64:67], v10 offset:0
    ds_read_b128 v[68:71], v10 offset:1024
    ds_read_b128 v[72:75], v10 offset:2048
    ds_read_b128 v[76:79], v10 offset:3072
    s_waitcnt lgkmcnt(3)
    global_store_dwordx4 v9, v[64:67], s[16:17] offset:0 sc0 sc1
    s_waitcnt lgkmcnt(2)
    global_store_dwordx4 v9, v[68:71], s[16:17] offset:1024 sc0 sc1
    s_waitcnt lgkmcnt(1)
    global_store_dwordx4 v9, v[72:75], s[16:17] offset:2048 sc0 sc1
    s_waitcnt lgkmcnt(0)
    global_store_dwordx4 v9, v[76:79], s[16:17] offset:3072 sc0 sc1
    s_barrier
    s_cmp_ge_u32 s2, 250
    s_cbranch_scc1 NO_RECS_7
    s_mul_i32 s3, s2, 20480
    s_add_u32 s3, s3, 2621440
    v_add_u32 v9, s3, v1
    ds_read_b128 v[84:87], v1 offset:4352
    ds_read_b128 v[88:91], v1 offset:5376
    ds_read_b128 v[92:95], v1 offset:6400
    ds_read_b128 v[96:99], v1 offset:7424
    ds_read_b128 v[100:103], v1 offset:8448
    ds_read_b128 v[104:107], v1 offset:9472
    s_waitcnt lgkmcnt(5)
    global_store_dwordx4 v9, v[84:87], s[16:17] offset:0 sc0 sc1
    s_waitcnt lgkmcnt(4)
    global_store_dwordx4 v9, v[88:91], s[16:17] offset:1024 sc0 sc1
    s_waitcnt lgkmcnt(3)
    global_store_dwordx4 v9, v[92:95], s[16:17] offset:2048 sc0 sc1
    s_waitcnt lgkmcnt(2)
    global_store_dwordx4 v9, v[96:99], s[16:17] offset:3072 sc0 sc1
    v_add_u32 v9, 4096, v9
    s_waitcnt lgkmcnt(1)
    global_store_dwordx4 v9, v[100:103], s[16:17] offset:0 sc0 sc1
    s_waitcnt lgkmcnt(0)
    global_store_dwordx4 v9, v[104:107], s[16:17] offset:1024 sc0 sc1
NO_RECS_7:
    s_branch STORED
HELP56:
    s_cmp_eq_u32 s25, 6
    s_cbranch_scc1 HELP6
    s_mov_b32 s62, 0
    s_mov_b32 s63, 1
LUT_5a:
    s_lshl_b32 s3, s62, 25
    s_add_u32 s3, s3, 0x8000
    v_lshl_add_u32 v128, v1, 15, s3
    v_add_u32 v129, 65536, v128
    v_add_u32 v130, 131072, v128
    v_add_u32 v131, 196608, v128
    v_add_u32 v132, 262144, v128
    v_add_u32 v133, 327680, v128
    v_add_u32 v134, 393216, v128
    v_add_u32 v135, 458752, v128
    v_pk_mul_f32 v[136:137], v[128:129], s[10:11]
    v_pk_mul_f32 v[138:139], v[130:131], s[10:11]
    v_pk_mul_f32 v[140:141], v[132:133], s[10:11]
    v_pk_mul_f32 v[142:143], v[134:135], s[10:11]
    v_exp_f32 v136, v136
    v_exp_f32 v137, v137
    v_exp_f32 v138, v138
    v_exp_f32 v139, v139
    v_exp_f32 v140, v140
    v_exp_f32 v141, v141
    v_exp_f32 v142, v142
    v_exp_f32 v143, v143
    s_lshl_b32 s3, s62, 10
    v_pk_add_f32 v[144:145], v[136:137], 1.0 op_sel_hi:[1,0]
    v_pk_add_f32 v[146:147], v[138:139], 1.0 op_sel_hi:[1,0]
    v_pk_add_f32 v[148:149], v[140:141], 1.0 op_sel_hi:[1,0]
    v_pk_add_f32 v[150:151], v[142:143], 1.0 op_sel_hi:[1,0]
    v_rcp_f32 v144, v144
    v_rcp_f32 v145, v145
    v_rcp_f32 v146, v146
    v_rcp_f32 v147, v147
    v_rcp_f32 v148, v148
    v_rcp_f32 v149, v149
    v_rcp_f32 v150, v150
    v_rcp_f32 v151, v151
    v_add_u32 v160, s3, v1
    v_pk_mul_f32 v[128:129], v[128:129], v[144:145]
    v_pk_mul_f32 v[130:131], v[130:131], v[146:147]
    v_pk_mul_f32 v[132:133], v[132:133], v[148:149]
    v_pk_mul_f32 v[134:135], v[134:135], v[150:151]
    v_add_u32 v161, 0x10000, v160
    v_pk_mul_f32 v[136:137], v[128:129], v[136:137] neg_lo:[1,0] neg_hi:[1,0]
    v_pk_mul_f32 v[138:139], v[130:131], v[138:139] neg_lo:[1,0] neg_hi:[1,0]
    v_pk_mul_f32 v[140:141], v[132:133], v[140:141] neg_lo:[1,0] neg_hi:[1,0]
    v_pk_mul_f32 v[142:143], v[134:135], v[142:143] neg_lo:[1,0] neg_hi:[1,0]
    v_cvt_pk_bf16_f32 v152, v128, v129
    v_cvt_pk_bf16_f32 v153, v130, v131
    v_cvt_pk_bf16_f32 v154, v132, v133
    v_cvt_pk_bf16_f32 v155, v134, v135
    v_cvt_pk_bf16_f32 v156, v136, v137
    v_cvt_pk_bf16_f32 v157, v138, v139
    v_cvt_pk_bf16_f32 v158, v140, v141
    v_cvt_pk_bf16_f32 v159, v142, v143
    ds_write_b128 v160, v[152:155] offset:32768
    ds_write_b128 v161, v[156:159] offset:32768
    s_add_u32 s62, s62, 1
    s_sub_u32 s63, s63, 1
    s_cmp_lg_u32 s63, 0
    s_cbranch_scc1 LUT_5a
    s_mov_b32 s62, 25
    s_mov_b32 s63, 1
LUT_5b:
    s_lshl_b32 s3, s62, 25
    s_add_u32 s3, s3, 0x8000
    v_lshl_add_u32 v128, v1, 15, s3
    v_add_u32 v129, 65536, v128
    v_add_u32 v130, 131072, v128
    v_add_u32 v131, 196608, v128
    v_add_u32 v132, 262144, v128
    v_add_u32 v133, 327680, v128
    v_add_u32 v134, 393216, v128
    v_add_u32 v135, 458752, v128
    v_pk_mul_f32 v[136:137], v[128:129], s[10:11]
    v_pk_mul_f32 v[138:139], v[130:131], s[10:11]
    v_pk_mul_f32 v[140:141], v[132:133], s[10:11]
    v_pk_mul_f32 v[142:143], v[134:135], s[10:11]
    v_exp_f32 v136, v136
    v_exp_f32 v137, v137
    v_exp_f32 v138, v138
    v_exp_f32 v139, v139
    v_exp_f32 v140, v140
    v_exp_f32 v141, v141
    v_exp_f32 v142, v142
    v_exp_f32 v143, v143
    s_lshl_b32 s3, s62, 10
    v_pk_add_f32 v[144:145], v[136:137], 1.0 op_sel_hi:[1,0]
    v_pk_add_f32 v[146:147], v[138:139], 1.0 op_sel_hi:[1,0]
    v_pk_add_f32 v[148:149], v[140:141], 1.0 op_sel_hi:[1,0]
    v_pk_add_f32 v[150:151], v[142:143], 1.0 op_sel_hi:[1,0]
    v_rcp_f32 v144, v144
    v_rcp_f32 v145, v145
    v_rcp_f32 v146, v146
    v_rcp_f32 v147, v147
    v_rcp_f32 v148, v148
    v_rcp_f32 v149, v149
    v_rcp_f32 v150, v150
    v_rcp_f32 v151, v151
    v_add_u32 v160, s3, v1
    v_pk_mul_f32 v[128:129], v[128:129], v[144:145]
    v_pk_mul_f32 v[130:131], v[130:131], v[146:147]
    v_pk_mul_f32 v[132:133], v[132:133], v[148:149]
    v_pk_mul_f32 v[134:135], v[134:135], v[150:151]
    v_add_u32 v161, 0x10000, v160
    v_pk_mul_f32 v[136:137], v[128:129], v[136:137] neg_lo:[1,0] neg_hi:[1,0]
    v_pk_mul_f32 v[138:139], v[130:131], v[138:139] neg_lo:[1,0] neg_hi:[1,0]
    v_pk_mul_f32 v[140:141], v[132:133], v[140:141] neg_lo:[1,0] neg_hi:[1,0]
    v_pk_mul_f32 v[142:143], v[134:135], v[142:143] neg_lo:[1,0] neg_hi:[1,0]
    v_cvt_pk_bf16_f32 v152, v128, v129
    v_cvt_pk_bf16_f32 v153, v130, v131
    v_cvt_pk_bf16_f32 v154, v132, v133
    v_cvt_pk_bf16_f32 v155, v134, v135
    v_cvt_pk_bf16_f32 v156, v136, v137
    v_cvt_pk_bf16_f32 v157, v138, v139
    v_cvt_pk_bf16_f32 v158, v140, v141
    v_cvt_pk_bf16_f32 v159, v142, v143
    ds_write_b128 v160, v[152:155] offset:32768
    ds_write_b128 v161, v[156:159] offset:32768
    s_add_u32 s62, s62, 1
    s_sub_u32 s63, s63, 1
    s_cmp_lg_u32 s63, 0
    s_cbranch_scc1 LUT_5b
    s_waitcnt vmcnt(0)
    ds_write_b32 v193, v192 offset:31744
    v_lshrrev_b32 v193, 3, v1
    v_and_b32 v193, 24, v193
    s_mov_b32 s4, 0x05040100
    s_mov_b32 s5, 0x07060302
    ds_read_b64_tr_b16 v[180:181], v193 offset:31744
    ds_read_b64_tr_b16 v[182:183], v193 offset:31776
    ds_read_b64_tr_b16 v[184:185], v193 offset:31808
    ds_read_b64_tr_b16 v[186:187], v193 offset:31840
    v_perm_b32 v176, v189, v188, s4
    v_perm_b32 v178, v189, v188, s5
    v_perm_b32 v177, v191, v190, s4
    v_perm_b32 v179, v191, v190, s5
    s_waitcnt lgkmcnt(0)
    s_add_u32 s64, s64, 1
    s_and_b32 s65, s65, 0x3ff
    s_barrier
    s_mul_i32 s3, s2, 10240
    s_add_u32 s3, s3, 4096
    v_add_u32 v9, s3, v1
    v_add_u32 v10, 91136, v1
    s_barrier
    ds_read_b128 v[64:67], v10 offset:0
    ds_read_b128 v[68:71], v10 offset:1024
    ds_read_b128 v[72:75], v10 offset:2048
    s_waitcnt lgkmcnt(2)
    global_store_dwordx4 v9, v[64:67], s[16:17] offset:0 sc0 sc1
    s_waitcnt lgkmcnt(1)
    global_store_dwordx4 v9, v[68:71], s[16:17] offset:1024 sc0 sc1
    s_waitcnt lgkmcnt(0)
    global_store_dwordx4 v9, v[72:75], s[16:17] offset:2048 sc0 sc1
    s_barrier
    s_cmp_ge_u32 s2, 250
    s_cbranch_scc1 NO_RECS_5
    s_mul_i32 s3, s2, 20480
    s_add_u32 s3, s3, 2627584
    v_add_u32 v9, s3, v1
    ds_read_b128 v[84:87], v1 offset:10496
    ds_read_b128 v[88:91], v1 offset:11520
    ds_read_b128 v[92:95], v1 offset:12544
    ds_read_b128 v[96:99], v1 offset:13568
    ds_read_b128 v[100:103], v1 offset:14592
    ds_read_b128 v[104:107], v1 offset:15616
    ds_read_b128 v[108:111], v1 offset:16640
    s_waitcnt lgkmcnt(6)
    global_store_dwordx4 v9, v[84:87], s[16:17] offset:0 sc0 sc1
    s_waitcnt lgkmcnt(5)
    global_store_dwordx4 v9, v[88:91], s[16:17] offset:1024 sc0 sc1
    s_waitcnt lgkmcnt(4)
    global_store_dwordx4 v9, v[92:95], s[16:17] offset:2048 sc0 sc1
    s_waitcnt lgkmcnt(3)
    global_store_dwordx4 v9, v[96:99], s[16:17] offset:3072 sc0 sc1
    v_add_u32 v9, 4096, v9
    s_waitcnt lgkmcnt(2)
    global_store_dwordx4 v9, v[100:103], s[16:17] offset:0 sc0 sc1
    s_waitcnt lgkmcnt(1)
    global_store_dwordx4 v9, v[104:107], s[16:17] offset:1024 sc0 sc1
    s_waitcnt lgkmcnt(0)
    global_store_dwordx4 v9, v[108:111], s[16:17] offset:2048 sc0 sc1
NO_RECS_5:
    s_branch STORED
HELP6:
    s_mov_b32 s62, 26
    s_mov_b32 s63, 2
LUT_6:
    s_lshl_b32 s3, s62, 25
    s_add_u32 s3, s3, 0x8000
    v_lshl_add_u32 v128, v1, 15, s3
    v_add_u32 v129, 65536, v128
    v_add_u32 v130, 131072, v128
    v_add_u32 v131, 196608, v128
    v_add_u32 v132, 262144, v128
    v_add_u32 v133, 327680, v128
    v_add_u32 v134, 393216, v128
    v_add_u32 v135, 458752, v128
    v_pk_mul_f32 v[136:137], v[128:129], s[10:11]
    v_pk_mul_f32 v[138:139], v[130:131], s[10:11]
    v_pk_mul_f32 v[140:141], v[132:133], s[10:11]
    v_pk_mul_f32 v[142:143], v[134:135], s[10:11]
    v_exp_f32 v136, v136
    v_exp_f32 v137, v137
    v_exp_f32 v138, v138
    v_exp_f32 v139, v139
    v_exp_f32 v140, v140
    v_exp_f32 v141, v141
    v_exp_f32 v142, v142
    v_exp_f32 v143, v143
    s_lshl_b32 s3, s62, 10
    v_pk_add_f32 v[144:145], v[136:137], 1.0 op_sel_hi:[1,0]
    v_pk_add_f32 v[146:147], v[138:139], 1.0 op_sel_hi:[1,0]
    v_pk_add_f32 v[148:149], v[140:141], 1.0 op_sel_hi:[1,0]
    v_pk_add_f32 v[150:151], v[142:143], 1.0 op_sel_hi:[1,0]
    v_rcp_f32 v144, v144
    v_rcp_f32 v145, v145
    v_rcp_f32 v146, v146
    v_rcp_f32 v147, v147
    v_rcp_f32 v148, v148
    v_rcp_f32 v149, v149
    v_rcp_f32 v150, v150
    v_rcp_f32 v151, v151
    v_add_u32 v160, s3, v1
    v_pk_mul_f32 v[128:129], v[128:129], v[144:145]
    v_pk_mul_f32 v[130:131], v[130:131], v[146:147]
    v_pk_mul_f32 v[132:133], v[132:133], v[148:149]
    v_pk_mul_f32 v[134:135], v[134:135], v[150:151]
    v_add_u32 v161, 0x10000, v160
    v_pk_mul_f32 v[136:137], v[128:129], v[136:137] neg_lo:[1,0] neg_hi:[1,0]
    v_pk_mul_f32 v[138:139], v[130:131], v[138:139] neg_lo:[1,0] neg_hi:[1,0]
    v_pk_mul_f32 v[140:141], v[132:133], v[140:141] neg_lo:[1,0] neg_hi:[1,0]
    v_pk_mul_f32 v[142:143], v[134:135], v[142:143] neg_lo:[1,0] neg_hi:[1,0]
    v_cvt_pk_bf16_f32 v152, v128, v129
    v_cvt_pk_bf16_f32 v153, v130, v131
    v_cvt_pk_bf16_f32 v154, v132, v133
    v_cvt_pk_bf16_f32 v155, v134, v135
    v_cvt_pk_bf16_f32 v156, v136, v137
    v_cvt_pk_bf16_f32 v157, v138, v139
    v_cvt_pk_bf16_f32 v158, v140, v141
    v_cvt_pk_bf16_f32 v159, v142, v143
    ds_write_b128 v160, v[152:155] offset:32768
    ds_write_b128 v161, v[156:159] offset:32768
    s_add_u32 s62, s62, 1
    s_sub_u32 s63, s63, 1
    s_cmp_lg_u32 s63, 0
    s_cbranch_scc1 LUT_6
    s_waitcnt vmcnt(0)
    ds_write_b32 v193, v192 offset:31744
    v_lshrrev_b32 v193, 3, v1
    v_and_b32 v193, 24, v193
    s_mov_b32 s4, 0x05040100
    s_mov_b32 s5, 0x07060302
    ds_read_b64_tr_b16 v[180:181], v193 offset:31744
    ds_read_b64_tr_b16 v[182:183], v193 offset:31776
    ds_read_b64_tr_b16 v[184:185], v193 offset:31808
    ds_read_b64_tr_b16 v[186:187], v193 offset:31840
    v_perm_b32 v176, v189, v188, s4
    v_perm_b32 v178, v189, v188, s5
    v_perm_b32 v177, v191, v190, s4
    v_perm_b32 v179, v191, v190, s5
    s_lshl_b32 s3, s2, 11
    s_add_u32 s3, s3, 7864320
    v_lshl_add_u32 v8, v1, 1, s3
    s_waitcnt lgkmcnt(0)
    s_add_u32 s64, s64, 1
    s_and_b32 s65, s65, 0x3ff
    s_barrier
    ds_read_b128 v[96:99], v1 offset:2304
    s_waitcnt lgkmcnt(0)
    v_add_u32 v10, v96, v97
    v_add3_u32 v10, v10, v98, v99
    v_mov_b32 v11, v10
    s_nop 1
    v_add_u32_dpp v11, v11, v11 row_shr:1 row_mask:0xf bank_mask:0xf bound_ctrl:0
    s_nop 1
    v_add_u32_dpp v11, v11, v11 row_shr:2 row_mask:0xf bank_mask:0xf bound_ctrl:0
    s_nop 1
    v_add_u32_dpp v11, v11, v11 row_shr:4 row_mask:0xf bank_mask:0xf bound_ctrl:0
    s_nop 1
    v_add_u32_dpp v11, v11, v11 row_shr:8 row_mask:0xf bank_mask:0xf bound_ctrl:0
    s_nop 1
    v_add_u32_dpp v11, v11, v11 row_bcast:15 row_mask:0xa bank_mask:0xf
    s_nop 1
    v_add_u32_dpp v11, v11, v11 row_bcast:31 row_mask:0xc bank_mask:0xf
    v_sub_u32 v100, v11, v10
    v_add_u32 v101, v100, v96
    v_add_u32 v102, v101, v97
    v_add_u32 v103, v102, v98
    s_lshl_b32 s3, s65, 22
    v_lshl_or_b32 v108, v96, 11, v100
    v_or_b32 v108, s3, v108
    v_mov_b32 v109, s64
    v_lshl_or_b32 v110, v97, 11, v101
    v_or_b32 v110, s3, v110
    v_mov_b32 v111, s64
    v_lshl_or_b32 v112, v98, 11, v102
    v_or_b32 v112, s3, v112
    v_mov_b32 v113, s64
    v_lshl_or_b32 v114, v99, 11, v103
    v_or_b32 v114, s3, v114
    v_mov_b32 v115, s64
    global_store_dwordx4 v8, v[108:111], s[16:17] sc0 sc1
    global_store_dwordx4 v8, v[112:115], s[16:17] offset:16 sc0 sc1
    s_mul_i32 s3, s2, 10240
    s_add_u32 s3, s3, 7168
    v_add_u32 v9, s3, v1
    v_add_u32 v10, 94208, v1
    s_barrier
    ds_read_b128 v[64:67], v10 offset:0
    ds_read_b128 v[68:71], v10 offset:1024
    ds_read_b128 v[72:75], v10 offset:2048
    s_waitcnt lgkmcnt(2)
    global_store_dwordx4 v9, v[64:67], s[16:17] offset:0 sc0 sc1
    s_waitcnt lgkmcnt(1)
    global_store_dwordx4 v9, v[68:71], s[16:17] offset:1024 sc0 sc1
    s_waitcnt lgkmcnt(0)
    global_store_dwordx4 v9, v[72:75], s[16:17] offset:2048 sc0 sc1
    s_barrier
    s_cmp_ge_u32 s2, 250
    s_cbranch_scc1 NO_RECS_6
    s_mul_i32 s3, s2, 20480
    s_add_u32 s3, s3, 2634752
    v_add_u32 v9, s3, v1
    ds_read_b128 v[84:87], v1 offset:17664
    ds_read_b128 v[88:91], v1 offset:18688
    ds_read_b128 v[92:95], v1 offset:19712
    ds_read_b128 v[96:99], v1 offset:20736
    ds_read_b128 v[100:103], v1 offset:21760
    ds_read_b128 v[104:107], v1 offset:22784
    ds_read_b128 v[108:111], v1 offset:23808
    s_waitcnt lgkmcnt(6)
    global_store_dwordx4 v9, v[84:87], s[16:17] offset:0 sc0 sc1
    s_waitcnt lgkmcnt(5)
    global_store_dwordx4 v9, v[88:91], s[16:17] offset:1024 sc0 sc1
    s_waitcnt lgkmcnt(4)
    global_store_dwordx4 v9, v[92:95], s[16:17] offset:2048 sc0 sc1
    s_waitcnt lgkmcnt(3)
    global_store_dwordx4 v9, v[96:99], s[16:17] offset:3072 sc0 sc1
    v_add_u32 v9, 4096, v9
    s_waitcnt lgkmcnt(2)
    global_store_dwordx4 v9, v[100:103], s[16:17] offset:0 sc0 sc1
    s_waitcnt lgkmcnt(1)
    global_store_dwordx4 v9, v[104:107], s[16:17] offset:1024 sc0 sc1
    s_waitcnt lgkmcnt(0)
    global_store_dwordx4 v9, v[108:111], s[16:17] offset:2048 sc0 sc1
NO_RECS_6:
STORED:
    v_mov_b32 v2, 0
    s_branch TAB_DONE
BINNED:
    v_mov_b32 v2, 0
    s_cmp_eq_u32 s25, 4
    s_cbranch_scc0 POLLER
    s_waitcnt lgkmcnt(0)
    s_barrier
    s_mov_b32 s62, 31
    s_mov_b32 s63, 2
LUT_4:
    s_lshl_b32 s3, s62, 25
    s_add_u32 s3, s3, 0x8000
    v_lshl_add_u32 v128, v1, 15, s3
    v_add_u32 v129, 65536, v128
    v_add_u32 v130, 131072, v128
    v_add_u32 v131, 196608, v128
    v_add_u32 v132, 262144, v128
    v_add_u32 v133, 327680, v128
    v_add_u32 v134, 393216, v128
    v_add_u32 v135, 458752, v128
    v_pk_mul_f32 v[136:137], v[128:129], s[10:11]
    v_pk_mul_f32 v[138:139], v[130:131], s[10:11]
    v_pk_mul_f32 v[140:141], v[132:133], s[10:11]
    v_pk_mul_f32 v[142:143], v[134:135], s[10:11]
    v_exp_f32 v136, v136
    v_exp_f32 v137, v137
    v_exp_f32 v138, v138
    v_exp_f32 v139, v139
    v_exp_f32 v140, v140
    v_exp_f32 v141, v141
    v_exp_f32 v142, v142
    v_exp_f32 v143, v143
    s_lshl_b32 s3, s62, 10
    v_pk_add_f32 v[144:145], v[136:137], 1.0 op_sel_hi:[1,0]
    v_pk_add_f32 v[146:147], v[138:139], 1.0 op_sel_hi:[1,0]
    v_pk_add_f32 v[148:149], v[140:141], 1.0 op_sel_hi:[1,0]
    v_pk_add_f32 v[150:151], v[142:143], 1.0 op_sel_hi:[1,0]
    v_rcp_f32 v144, v144
    v_rcp_f32 v145, v145
    v_rcp_f32 v146, v146
    v_rcp_f32 v147, v147
    v_rcp_f32 v148, v148
    v_rcp_f32 v149, v149
    v_rcp_f32 v150, v150
    v_rcp_f32 v151, v151
    v_add_u32 v160, s3, v1
    v_pk_mul_f32 v[128:129], v[128:129], v[144:145]
    v_pk_mul_f32 v[130:131], v[130:131], v[146:147]
    v_pk_mul_f32 v[132:133], v[132:133], v[148:149]
    v_pk_mul_f32 v[134:135], v[134:135], v[150:151]
    v_add_u32 v161, 0x10000, v160
    v_pk_mul_f32 v[136:137], v[128:129], v[136:137] neg_lo:[1,0] neg_hi:[1,0]
    v_pk_mul_f32 v[138:139], v[130:131], v[138:139] neg_lo:[1,0] neg_hi:[1,0]
    v_pk_mul_f32 v[140:141], v[132:133], v[140:141] neg_lo:[1,0] neg_hi:[1,0]
    v_pk_mul_f32 v[142:143], v[134:135], v[142:143] neg_lo:[1,0] neg_hi:[1,0]
    v_cvt_pk_bf16_f32 v152, v128, v129
    v_cvt_pk_bf16_f32 v153, v130, v131
    v_cvt_pk_bf16_f32 v154, v132, v133
    v_cvt_pk_bf16_f32 v155, v134, v135
    v_cvt_pk_bf16_f32 v156, v136, v137
    v_cvt_pk_bf16_f32 v157, v138, v139
    v_cvt_pk_bf16_f32 v158, v140, v141
    v_cvt_pk_bf16_f32 v159, v142, v143
    ds_write_b128 v160, v[152:155] offset:32768
    ds_write_b128 v161, v[156:159] offset:32768
    s_add_u32 s62, s62, 1
    s_sub_u32 s63, s63, 1
    s_cmp_lg_u32 s63, 0
    s_cbranch_scc1 LUT_4
    s_branch TAB_DONE
POLLER:
    s_add_u32 s62, s25, 34
    v_mov_b32 v132, 0x80008000
    v_mov_b32 v133, 0x80008000
    v_mov_b32 v134, 0x80008000
    v_mov_b32 v135, 0x80008000
LUTP_UH:
    s_mul_i32 s3, s62, 33554944
    s_add_u32 s3, s3, 131072
    v_add_u32 v128, s3, v138
    s_lshl_b32 s3, s62, 10
    v_add_u32 v136, s3, v1
    v_add_u32 v129, 131074, v128
    v_add_u32 v130, 262148, v128
    v_add_u32 v131, 393222, v128
    v_add_u32 v137, 0x10000, v136
    ds_write_b128 v136, v[128:131] offset:32768
    ds_write_b128 v137, v[132:135] offset:32768
    s_add_u32 s62, s62, 4
    s_cmp_le_u32 s62, 52
    s_cbranch_scc1 LUTP_UH
LUTP_END_U:
    buffer_load_dwordx2 v[2:3], v6, s[16:19], 0 offen sc1
    s_waitcnt lgkmcnt(0)
    s_barrier
    s_cmp_gt_u32 s62, 62
    s_cbranch_scc1 LUTP_END_V
LUTP_VH:
    s_mul_i32 s3, s62, 33554944
    s_add_u32 s3, s3, 131072
    v_add_u32 v128, s3, v138
    s_lshl_b32 s3, s62, 10
    v_add_u32 v136, s3, v1
    v_add_u32 v129, 131074, v128
    v_add_u32 v130, 262148, v128
    v_add_u32 v131, 393222, v128
    v_add_u32 v137, 0x10000, v136
    ds_write_b128 v136, v[128:131] offset:32768
    ds_write_b128 v137, v[132:135] offset:32768
    s_add_u32 s62, s62, 4
    s_cmp_le_u32 s62, 62
    s_cbranch_scc1 LUTP_VH
LUTP_END_V:
POLL_TAB:
    s_waitcnt vmcnt(0)
    v_lshrrev_b32 v11, 22, v2
    v_cmp_ne_u32 vcc, s64, v3
    v_cmp_ne_u32 s[42:43], s65, v11
    s_or_b64 vcc, vcc, s[42:43]
    s_and_b64 exec, exec, vcc
    s_cbranch_execz POLLED_TAB
    s_sub_u32 s35, s35, 1
    s_cbranch_scc1 END
    buffer_load_dwordx2 v[2:3], v6, s[16:19], 0 offen sc1
    s_branch POLL_TAB
POLLED_TAB:
    s_mov_b64 exec, -1
TAB_DONE:
    v_and_b32 v13, 0x7ff, v2
    v_bfe_u32 v2, v2, 11, 11
    v_lshrrev_b32 v9, 4, v1
    v_add_u32 v4, v4, v13
    v_mov_b32 v3, v2
    s_cmp_ge_u32 s25, 4
    s_cbranch_scc1 NO_KEY_TOUCH
    v_lshlrev_b32 v10, 3, v4
    buffer_load_dword v167, v10, s[16:19], 0 offen sc1
NO_KEY_TOUCH:
    s_nop 1
    v_add_u32_dpp v3, v3, v3 row_shr:1 row_mask:0xf bank_mask:0xf bound_ctrl:0
    s_nop 1
    v_add_u32_dpp v3, v3, v3 row_shr:2 row_mask:0xf bank_mask:0xf bound_ctrl:0
    s_nop 1
    v_add_u32_dpp v3, v3, v3 row_shr:4 row_mask:0xf bank_mask:0xf bound_ctrl:0
    s_nop 1
    v_add_u32_dpp v3, v3, v3 row_shr:8 row_mask:0xf bank_mask:0xf bound_ctrl:0
    s_nop 1
    v_add_u32_dpp v3, v3, v3 row_bcast:15 row_mask:0xa bank_mask:0xf
    s_nop 1
    v_add_u32_dpp v3, v3, v3 row_bcast:31 row_mask:0xc bank_mask:0xf
    s_nop 0
    v_readlane_b32 s44, v3, 63
    v_sub_u32 v3, v3, v2
    v_cmp_lt_u32 vcc, s25, v9
    v_cmp_gt_u32 s[42:43], 9, v9
    v_lshlrev_b32 v10, 2, v9
    v_mov_b32 v11, s44
    s_and_b64 vcc, vcc, s[42:43]
    s_and_saveexec_b64 s[42:43], vcc
    ds_add_u32 v10, v11 offset:2176
    s_mov_b64 exec, s[42:43]
    s_lshl_b32 s3, s25, 2
    v_mov_b32 v10, s3
    v_mov_b32 v11, 32
    s_waitcnt lgkmcnt(0)
    s_barrier
    ds_read_b32 v8, v10 offset:2176
    ds_read_b32 v11, v11 offset:2176
    s_cmp_lg_u32 s25, 4
    s_cbranch_scc1 EPOCH_DONE
    s_cmp_lg_u32 s2, 0
    s_cbranch_scc1 EPOCH_DONE
    v_mov_b32 v12, s64
    v_mov_b32 v10, 8650752
    s_mov_b64 exec, 1
    global_store_dword v10, v12, s[16:17] sc0 sc1
    s_mov_b64 exec, -1
EPOCH_DONE:
    s_waitcnt lgkmcnt(0)
    v_add_u32 v3, v3, v8
    v_readfirstlane_b32 s26, v11
    s_cmp_lt_u32 s25, 5
    s_cbranch_scc1 RECS_FLAGGED
    v_mov_b32 v10, 2240
    s_waitcnt vmcnt(0)
    s_mov_b64 exec, 1
    ds_add_rtn_u32 v10, v10, v15
    s_mov_b64 exec, -1
    s_waitcnt lgkmcnt(0)
    v_readfirstlane_b32 s3, v10
    s_cmp_lg_u32 s3, 2
    s_cbranch_scc1 RECS_FLAGGED
    s_lshl_b32 s3, s2, 10
    s_add_u32 s3, s3, 8388608
    v_lshl_add_u32 v10, v1, 3, s3
    v_mov_b32 v12, s64
    v_mov_b32 v13, s65
    s_mov_b64 exec, 0xff
    global_store_dwordx2 v10, v[12:13], s[16:17] sc0 sc1
    s_mov_b64 exec, -1
RECS_FLAGGED:
ROUND:
    v_mov_b32 v8, 0
    v_subrev_u32 v9, s27, v3
    v_mov_b32 v10, v4
    s_mov_b32 s3, 1472
    s_cmp_gt_u32 s26, 1472
    s_cbranch_scc1 EXPAND
    v_lshlrev_b32 v11, 2, v3
    v_cmpx_lt_u32 vcc, 0, v2
    ds_write_b32 v11, v10 offset:2304
    v_add_u32 v10, 1, v10
    v_cmpx_lt_u32 vcc, 1, v2
    ds_write_b32 v11, v10 offset:2308
    v_add_u32 v10, 1, v10
    v_cmpx_lt_u32 vcc, 2, v2
    ds_write_b32 v11, v10 offset:2312
    v_add_u32 v10, 1, v10
    v_cmpx_lt_u32 vcc, 3, v2
    ds_write_b32 v11, v10 offset:2316
    v_add_u32 v10, 1, v10
    v_cmpx_lt_u32 vcc, 4, v2
    ds_write_b32 v11, v10 offset:2320
    v_add_u32 v10, 1, v10
    v_cmpx_lt_u32 vcc, 5, v2
    ds_write_b32 v11, v10 offset:2324
    v_add_u32 v10, 1, v10
    v_cmpx_lt_u32 vcc, 6, v2
    s_cbranch_execz EXPAND_DONE
    ds_write_b32 v11, v10 offset:2328
    v_add_u32 v10, 1, v10
    v_cmpx_lt_u32 vcc, 7, v2
    ds_write_b32 v11, v10 offset:2332
    v_add_u32 v10, 1, v10
    v_cmpx_lt_u32 vcc, 8, v2
    s_cbranch_execz EXPAND_DONE
    ds_write_b32 v11, v10 offset:2336
    v_add_u32 v10, 1, v10
    v_cmpx_lt_u32 vcc, 9, v2
    ds_write_b32 v11, v10 offset:2340
    v_add_u32 v10, 1, v10
    v_cmpx_lt_u32 vcc, 10, v2
    s_cbranch_execz EXPAND_DONE
    ds_write_b32 v11, v10 offset:2344
    v_add_u32 v10, 1, v10
    v_cmpx_lt_u32 vcc, 11, v2
    ds_write_b32 v11, v10 offset:2348
    v_add_u32 v10, 1, v10
    v_cmpx_lt_u32 vcc, 12, v2
    s_cbranch_execz EXPAND_DONE
    ds_write_b32 v11, v10 offset:2352
    v_add_u32 v10, 1, v10
    v_cmpx_lt_u32 vcc, 13, v2
    ds_write_b32 v11, v10 offset:2356
    v_add_u32 v10, 1, v10
    v_cmpx_lt_u32 vcc, 14, v2
    s_cbranch_execz EXPAND_DONE
    ds_write_b32 v11, v10 offset:2360
    v_add_u32 v10, 1, v10
    v_cmpx_lt_u32 vcc, 15, v2
    ds_write_b32 v11, v10 offset:2364
    v_add_u32 v10, 1, v10
    v_mov_b32 v8, 16
    v_add_u32 v9, 16, v9
EXPAND:
    v_cmp_lt_u32 vcc, v8, v2
    s_and_b64 exec, exec, vcc
    s_cbranch_execz EXPAND_DONE
    v_cmp_gt_u32 vcc, s3, v9
    v_lshlrev_b32 v11, 2, v9
    s_and_saveexec_b64 s[42:43], vcc
    ds_write_b32 v11, v10 offset:2304
    s_mov_b64 exec, s[42:43]
    v_add_u32 v8, 1, v8
    v_add_u32 v9, 1, v9
    v_add_u32 v10, 1, v10
    s_branch EXPAND
EXPAND_DONE:
    s_mov_b64 exec, -1
    s_sub_u32 s28, s26, s27
    s_min_u32 s28, s28, 1472
    v_lshlrev_b32 v8, 2, v0
    v_add_u32 v9, 0, v0
    v_cmp_gt_u32 s[36:37], s28, v9
    v_add_u32 v9, 512, v0
    v_cmp_gt_u32 s[38:39], s28, v9
    v_add_u32 v9, 1024, v0
    v_cmp_gt_u32 s[40:41], s28, v9
    s_waitcnt lgkmcnt(0)
    s_barrier
    ds_read_b32 v64, v8 offset:2304
    ds_read_b32 v65, v8 offset:4352
    ds_read_b32 v66, v8 offset:6400
    s_mov_b32 s44, 5033
    s_waitcnt lgkmcnt(0)
    v_lshlrev_b32 v68, 3, v64
    v_lshlrev_b32 v64, 4, v64
    v_lshlrev_b32 v69, 3, v65
    v_lshlrev_b32 v65, 4, v65
    v_lshlrev_b32 v70, 3, v66
    v_lshlrev_b32 v66, 4, v66
KEY_LOAD:
    s_mov_b64 exec, s[40:41]
    s_cbranch_execz SKIP3
    buffer_load_dwordx2 v[100:101], v70, s[16:19], 0 offen sc1
SKIP3:
    s_mov_b64 exec, s[36:37]
    buffer_load_dwordx2 v[96:97], v68, s[16:19], 0 offen sc1
    s_mov_b64 exec, s[38:39]
    buffer_load_dwordx2 v[98:99], v69, s[16:19], 0 offen sc1
    s_mov_b64 exec, -1
    s_sub_u32 s62, s25, 4
    s_cmp_ge_u32 s62, 3
    s_cbranch_scc1 NO_LAST_JOB
    s_mov_b32 s10, 0xbfb8aa3b
    s_mov_b32 s11, 0xbfb8aa3b
    s_add_u32 s62, s62, 28
    s_mov_b32 s63, 1
LUT_k:
    s_lshl_b32 s3, s62, 25
    s_add_u32 s3, s3, 0x8000
    v_lshl_add_u32 v128, v1, 15, s3
    v_add_u32 v129, 65536, v128
    v_add_u32 v130, 131072, v128
    v_add_u32 v131, 196608, v128
    v_add_u32 v132, 262144, v128
    v_add_u32 v133, 327680, v128
    v_add_u32 v134, 393216, v128
    v_add_u32 v135, 458752, v128
    v_pk_mul_f32 v[136:137], v[128:129], s[10:11]
    v_pk_mul_f32 v[138:139], v[130:131], s[10:11]
    v_pk_mul_f32 v[140:141], v[132:133], s[10:11]
    v_pk_mul_f32 v[142:143], v[134:135], s[10:11]
    v_exp_f32 v136, v136
    v_exp_f32 v137, v137
    v_exp_f32 v138, v138
    v_exp_f32 v139, v139
    v_exp_f32 v140, v140
    v_exp_f32 v141, v141
    v_exp_f32 v142, v142
    v_exp_f32 v143, v143
    s_lshl_b32 s3, s62, 10
    v_pk_add_f32 v[144:145], v[136:137], 1.0 op_sel_hi:[1,0]
    v_pk_add_f32 v[146:147], v[138:139], 1.0 op_sel_hi:[1,0]
    v_pk_add_f32 v[148:149], v[140:141], 1.0 op_sel_hi:[1,0]
    v_pk_add_f32 v[150:151], v[142:143], 1.0 op_sel_hi:[1,0]
    v_rcp_f32 v144, v144
    v_rcp_f32 v145, v145
    v_rcp_f32 v146, v146
    v_rcp_f32 v147, v147
    v_rcp_f32 v148, v148
    v_rcp_f32 v149, v149
    v_rcp_f32 v150, v150
    v_rcp_f32 v151, v151
    v_add_u32 v160, s3, v1
    v_pk_mul_f32 v[128:129], v[128:129], v[144:145]
    v_pk_mul_f32 v[130:131], v[130:131], v[146:147]
    v_pk_mul_f32 v[132:133], v[132:133], v[148:149]
    v_pk_mul_f32 v[134:135], v[134:135], v[150:151]
    v_add_u32 v161, 0x10000, v160
    v_pk_mul_f32 v[136:137], v[128:129], v[136:137] neg_lo:[1,0] neg_hi:[1,0]
    v_pk_mul_f32 v[138:139], v[130:131], v[138:139] neg_lo:[1,0] neg_hi:[1,0]
    v_pk_mul_f32 v[140:141], v[132:133], v[140:141] neg_lo:[1,0] neg_hi:[1,0]
    v_pk_mul_f32 v[142:143], v[134:135], v[142:143] neg_lo:[1,0] neg_hi:[1,0]
    v_cvt_pk_bf16_f32 v152, v128, v129
    v_cvt_pk_bf16_f32 v153, v130, v131
    v_cvt_pk_bf16_f32 v154, v132, v133
    v_cvt_pk_bf16_f32 v155, v134, v135
    v_cvt_pk_bf16_f32 v156, v136, v137
    v_cvt_pk_bf16_f32 v157, v138, v139
    v_cvt_pk_bf16_f32 v158, v140, v141
    v_cvt_pk_bf16_f32 v159, v142, v143
    ds_write_b128 v160, v[152:155] offset:32768
    ds_write_b128 v161, v[156:159] offset:32768
    s_add_u32 s62, s62, 1
    s_sub_u32 s63, s63, 1
    s_cmp_lg_u32 s63, 0
    s_cbranch_scc1 LUT_k
NO_LAST_JOB:
    s_waitcnt vmcnt(0)
    v_cmp_ne_u32 s[48:49], s64, v97
    v_cmp_ne_u32 s[50:51], s64, v99
    v_cmp_ne_u32 s[52:53], s64, v101
    s_and_b64 s[48:49], s[48:49], s[36:37]
    s_and_b64 s[50:51], s[50:51], s[38:39]
    s_and_b64 s[52:53], s[52:53], s[40:41]
    s_or_b64 s[48:49], s[48:49], s[50:51]
    s_or_b64 s[48:49], s[48:49], s[52:53]
    s_cbranch_scc0 KEYS_OK
    s_sub_u32 s35, s35, 1
    s_cbranch_scc0 KEY_LOAD
    s_endpgm
KEYS_OK:
    buffer_load_dwordx2 v[136:137], v166, s[16:19], 0 offen sc1
    v_mul_hi_u32 v9, s44, v96
    v_and_b32 v72, 63, v96
    v_mul_u32_u24 v72, 48, v72
    v_lshl_add_u32 v72, v9, 2, v72
    v_mul_hi_u32 v9, s44, v98
    v_and_b32 v73, 63, v98
    v_mul_u32_u24 v73, 48, v73
    v_lshl_add_u32 v73, v9, 2, v73
    v_mul_hi_u32 v9, s44, v100
    v_and_b32 v74, 63, v100
    v_mul_u32_u24 v74, 48, v74
    v_lshl_add_u32 v74, v9, 2, v74
    s_mov_b64 exec, s[36:37]
    ds_add_rtn_u32 v76, v72, v15 offset:0
    s_mov_b64 exec, s[38:39]
    ds_add_rtn_u32 v77, v73, v15 offset:0
    s_mov_b64 exec, s[40:41]
    ds_add_rtn_u32 v78, v74, v15 offset:0
    s_mov_b64 exec, -1
    v_add_u32 v9, 0, v0
    v_lshlrev_b32 v9, 21, v9
    v_lshrrev_b32 v80, 10, v96
    v_lshl_or_b32 v80, v80, 7, v9
    v_add_u32 v9, 512, v0
    v_lshlrev_b32 v9, 21, v9
    v_lshrrev_b32 v81, 10, v98
    v_lshl_or_b32 v81, v81, 7, v9
    v_add_u32 v9, 1024, v0
    v_lshlrev_b32 v9, 21, v9
    v_lshrrev_b32 v82, 10, v100
    v_lshl_or_b32 v82, v82, 7, v9
    v_lshrrev_b32 v8, 4, v1
    v_min_u32 v9, 39, v8
    v_mul_u32_u24 v9, 48, v9
    v_cmp_gt_u32 s[46:47], 40, v8
    v_sub_u32 v10, 63, v8
    s_mul_i32 s10, s25, 5
    s_lshl_b32 s3, s25, 10
    s_add_u32 s3, s3, 8192
    s_mov_b32 s9, 2621440
    s_waitcnt lgkmcnt(0)
    s_barrier
    ds_read_b128 v[84:87], v9 offset:0
    ds_read_b128 v[88:91], v9 offset:16
    ds_read_b128 v[92:95], v9 offset:32
    s_waitcnt lgkmcnt(1)
    v_add3_u32 v84, v84, v85, v86
    v_add3_u32 v87, v87, v88, v89
    v_add3_u32 v84, v84, v90, v91
    s_waitcnt lgkmcnt(0)
    v_add3_u32 v87, v87, v92, v93
    v_add3_u32 v84, v84, v94, v95
    v_add_u32 v84, v84, v87
    v_lshl_or_b32 v85, v84, 6, v10
    v_cndmask_b32 v85, 0, v85, s[46:47]
    s_cmp_lg_u32 s27, 0
    s_cbranch_scc1 DEALT
    v_readlane_b32 s4, v85, s10
    s_add_u32 s10, s10, 1
    v_readlane_b32 s5, v85, s10
    s_add_u32 s10, s10, 1
    v_readlane_b32 s6, v85, s10
    s_add_u32 s10, s10, 1
    v_readlane_b32 s7, v85, s10
    s_add_u32 s10, s10, 1
    v_readlane_b32 s8, v85, s10
    v_cmp_lt_u32 s[48:49], s4, v85
    v_cmp_lt_u32 s[50:51], s5, v85
    v_cmp_lt_u32 s[52:53], s6, v85
    v_cmp_lt_u32 s[54:55], s7, v85
    v_cmp_lt_u32 s[56:57], s8, v85
    s_bcnt1_i32_b64 s4, s[48:49]
    s_bcnt1_i32_b64 s5, s[50:51]
    s_bcnt1_i32_b64 s6, s[52:53]
    s_bcnt1_i32_b64 s7, s[54:55]
    s_bcnt1_i32_b64 s8, s[56:57]
    v_writelane_b32 v9, s4, 0
    v_writelane_b32 v9, s5, 1
    v_writelane_b32 v9, s6, 2
    v_writelane_b32 v9, s7, 3
    v_writelane_b32 v9, s8, 4
    s_sub_u32 s10, s10, 4
    v_add_u32 v10, s10, v8
    v_lshrrev_b32 v11, 3, v9
    v_and_b32 v9, 7, v9
    v_lshrrev_b32 v12, v11, 18
    v_and_b32 v12, 1, v12
    v_mul_u32_u24 v12, 7, v12
    v_xor_b32 v9, v9, v12
    v_mad_u32_u24 v9, v9, 5, v11
    v_lshlrev_b32 v9, 2, v9
    s_mov_b64 exec, 0x1f
    ds_write_b32 v9, v10 offset:1920
    s_mov_b64 exec, -1
DEALT:
    s_lshl_b32 s11, s10, 2
    v_add_u32 v9, s11, v7
    v_lshlrev_b32 v13, 2, v8
POLL_REC:
    s_waitcnt vmcnt(0)
    v_cmp_ne_u32 vcc, s64, v136
    v_cmp_ne_u32 s[42:43], s65, v137
    s_or_b64 vcc, vcc, s[42:43]
    s_and_b64 exec, exec, vcc
    s_cbranch_execz POLLED_REC
    s_sub_u32 s35, s35, 1
    s_cbranch_scc1 END
    buffer_load_dwordx2 v[136:137], v166, s[16:19], 0 offen sc1
    s_branch POLL_REC
POLLED_REC:
    s_mov_b64 exec, -1
    v_cmp_gt_u32 s[42:43], 60, v8
    s_waitcnt lgkmcnt(0)
    s_barrier
    ds_read_b32 v9, v9 offset:1920
    ds_read_b32 v13, v13 offset:1920
    v_lshlrev_b32 v12, 17, v7
    s_add_u32 m0, s3, 0
    s_mov_b64 exec, s[36:37]
    buffer_load_dwordx4 v64, s[16:19], s9 offen sc1 lds
    s_add_u32 m0, s3, 8192
    s_mov_b64 exec, s[38:39]
    buffer_load_dwordx4 v65, s[16:19], s9 offen sc1 lds
    s_add_u32 m0, s3, 16384
    s_mov_b64 exec, s[40:41]
    s_cbranch_execz SKIP3R
    buffer_load_dwordx4 v66, s[16:19], s9 offen sc1 lds
SKIP3R:
    s_mov_b64 exec, -1
    s_waitcnt lgkmcnt(1)
    v_mul_u32_u24 v10, 48, v9
    v_add_u32 v10, v10, v14
    ds_read_b32 v11, v10 offset:0
    s_waitcnt lgkmcnt(1)
    v_lshlrev_b32 v13, 2, v13
    ds_bpermute_b32 v86, v13, v84
    v_readlane_b32 s4, v9, 0
    v_readlane_b32 s5, v9, 1
    v_readlane_b32 s6, v9, 2
    v_readlane_b32 s7, v9, 3
    v_readlane_b32 s8, v9, 4
    s_waitcnt lgkmcnt(0)
    v_cndmask_b32 v11, 0, v11, s[42:43]
    v_cndmask_b32 v86, 0, v86, s[46:47]
    v_sub_u32 v12, v12, v11
    v_mov_b32 v87, v86
    s_nop 0
    v_add_u32_dpp v11, v11, v11 row_shr:1 row_mask:0xf bank_mask:0xf bound_ctrl:0
    v_add_u32_dpp v87, v87, v87 row_shr:1 row_mask:0xf bank_mask:0xf bound_ctrl:0
    s_nop 0
    v_add_u32_dpp v11, v11, v11 row_shr:2 row_mask:0xf bank_mask:0xf bound_ctrl:0
    v_add_u32_dpp v87, v87, v87 row_shr:2 row_mask:0xf bank_mask:0xf bound_ctrl:0
    s_nop 0
    v_add_u32_dpp v11, v11, v11 row_shr:4 row_mask:0xf bank_mask:0xf bound_ctrl:0
    v_add_u32_dpp v87, v87, v87 row_shr:4 row_mask:0xf bank_mask:0xf bound_ctrl:0
    s_nop 0
    v_add_u32_dpp v11, v11, v11 row_shr:8 row_mask:0xf bank_mask:0xf bound_ctrl:0
    v_add_u32_dpp v87, v87, v87 row_shr:8 row_mask:0xf bank_mask:0xf bound_ctrl:0
    s_nop 0
    v_add_u32_dpp v11, v11, v11 row_bcast:15 row_mask:0xa bank_mask:0xf
    v_add_u32_dpp v87, v87, v87 row_bcast:15 row_mask:0xa bank_mask:0xf
    s_nop 0
    v_add_u32_dpp v11, v11, v11 row_bcast:31 row_mask:0xc bank_mask:0xf
    v_add_u32_dpp v87, v87, v87 row_bcast:31 row_mask:0xc bank_mask:0xf
    v_sub_u32 v87, v87, v86
    v_add_u32 v12, v12, v11
    v_readlane_b32 s29, v87, s10
    v_readlane_b32 s30, v11, 63
    s_nop 0
    v_add_u32 v12, s29, v12
    s_mov_b64 exec, s[42:43]
    ds_write_b32 v10, v12 offset:0
    s_mov_b64 exec, -1
    v_add_u32 v6, s29, v8
    v_lshlrev_b32 v5, 2, v6
    v_add_u32 v5, 2304, v5
    s_add_u32 s10, s30, 3
    s_and_b32 s10, s10, -4
    s_min_u32 s32, s10, 4
    s_sub_u32 s31, s10, s32
    s_add_u32 s30, s30, s29
    s_waitcnt lgkmcnt(0)
    s_barrier
    ds_read_b32 v72, v72 offset:0
    ds_read_b32 v73, v73 offset:0
    ds_read_b32 v74, v74 offset:0
    s_waitcnt lgkmcnt(2)
    v_lshrrev_b32 v9, 16, v72
    v_and_b32 v72, 0xffff, v72
    v_or_b32 v80, v80, v9
    v_add_lshl_u32 v72, v72, v76, 2
    s_waitcnt lgkmcnt(1)
    v_lshrrev_b32 v9, 16, v73
    v_and_b32 v73, 0xffff, v73
    v_or_b32 v81, v81, v9
    v_add_lshl_u32 v73, v73, v77, 2
    s_waitcnt lgkmcnt(0)
    v_lshrrev_b32 v9, 16, v74
    v_and_b32 v74, 0xffff, v74
    v_or_b32 v82, v82, v9
    v_add_lshl_u32 v74, v74, v78, 2
    s_mov_b64 exec, s[36:37]
    ds_write_b32 v72, v80 offset:2304
    s_mov_b64 exec, s[38:39]
    ds_write_b32 v73, v81 offset:2304
    s_mov_b64 exec, s[40:41]
    ds_write_b32 v74, v82 offset:2304
    s_mov_b64 exec, -1
    s_waitcnt lgkmcnt(0)
    s_barrier
    ds_read_b32 v165, v5
    s_and_b32 s10, s25, 3
    s_lshl_b32 s10, s10, 13
    s_add_u32 s10, s10, 7802880
    s_add_u32 s11, s10, 4096
    v_mov_b32 v128, 0
    v_mov_b32 v129, 0
    v_mov_b32 v130, 0
    v_mov_b32 v131, 0
    v_mov_b32 v132, 0
    v_mov_b32 v133, 0
    v_mov_b32 v134, 0
    v_mov_b32 v135, 0
    s_waitcnt lgkmcnt(0)
    v_cmp_gt_u32 vcc, s30, v6
    v_add_u32 v6, 64, v6
    v_add_u32 v5, 256, v5
    v_cndmask_b32 v165, 40, v165, vcc
    v_lshrrev_b32 v8, 21, v165
    v_lshlrev_b32 v8, 4, v8
    v_lshlrev_b32 v9, 3, v165
    v_and_b32 v9, 0xfffc00, v9
    v_and_or_b32 v165, v165, 56, v9
    s_nop 0
    v_readlane_b32 s48, v165, 0
    s_and_b32 s33, s48, s34
    buffer_load_dwordx4 v[64:67], v1, s[12:15], s33 offen
    v_readlane_b32 s49, v165, 1
    s_and_b32 s33, s49, s34
    buffer_load_dwordx4 v[68:71], v1, s[12:15], s33 offen
    v_readlane_b32 s50, v165, 2
    s_and_b32 s33, s50, s34
    buffer_load_dwordx4 v[72:75], v1, s[12:15], s33 offen
    v_readlane_b32 s51, v165, 3
    s_and_b32 s33, s51, s34
    buffer_load_dwordx4 v[76:79], v1, s[12:15], s33 offen
    v_readlane_b32 s52, v165, 4
    s_and_b32 s33, s52, s34
    buffer_load_dwordx4 v[80:83], v1, s[12:15], s33 offen
    v_readlane_b32 s53, v165, 5
    s_and_b32 s33, s53, s34
    buffer_load_dwordx4 v[84:87], v1, s[12:15], s33 offen
    v_readlane_b32 s54, v165, 6
    s_and_b32 s33, s54, s34
    buffer_load_dwordx4 v[88:91], v1, s[12:15], s33 offen
    v_mov_b32 v164, v165
    s_waitcnt vmcnt(7)
    s_barrier
    ds_read_b128 v[168:171], v8 offset:8192
    s_waitcnt lgkmcnt(0)
    v_mov_b32 v172, v170
    v_mov_b32 v173, v171
    v_mfma_f32_4x4x4_16b_bf16 v[148:151], v[168:169], v[180:181], 0
    v_mfma_f32_4x4x4_16b_bf16 v[152:155], v[168:169], v[182:183], 0
    v_mfma_f32_4x4x4_16b_bf16 v[156:159], v[168:169], v[184:185], 0
    v_mfma_f32_4x4x4_16b_bf16 v[160:163], v[168:169], v[186:187], 0
    v_mfma_f32_4x4x4_16b_bf16 v[112:115], v[172:173], v[176:177], 0 cbsz:4 abid:0
    v_mfma_f32_4x4x4_16b_bf16 v[116:119], v[172:173], v[178:179], 0 cbsz:4 abid:0
    v_mfma_f32_4x4x4_16b_bf16 v[120:123], v[172:173], v[176:177], 0 cbsz:4 abid:1
    s_nop 1
    v_cvt_pk_bf16_f32 v140, v148, v152
    v_cvt_pk_bf16_f32 v141, v156, v160
    v_cvt_pk_bf16_f32 v142, v149, v153
    v_cvt_pk_bf16_f32 v143, v157, v161
    v_cvt_pk_bf16_f32 v144, v150, v154
    v_cvt_pk_bf16_f32 v145, v158, v162
    v_cvt_pk_bf16_f32 v146, v151, v155
    v_cvt_pk_bf16_f32 v147, v159, v163
    v_lshlrev_b32_sdwa v136, v15, v112 dst_sel:DWORD dst_unused:UNUSED_PAD src0_sel:DWORD src1_sel:WORD_1
    v_lshlrev_b32_sdwa v137, v15, v113 dst_sel:DWORD dst_unused:UNUSED_PAD src0_sel:DWORD src1_sel:WORD_1
    ds_read_u16_d16_hi v128, v136 offset:32768
    ds_read_u16_d16_hi v129, v137 offset:32768
    v_lshlrev_b32_sdwa v138, v15, v116 dst_sel:DWORD dst_unused:UNUSED_PAD src0_sel:DWORD src1_sel:WORD_1
    v_lshlrev_b32_sdwa v139, v15, v117 dst_sel:DWORD dst_unused:UNUSED_PAD src0_sel:DWORD src1_sel:WORD_1
    ds_read_u16_d16_hi v130, v138 offset:32768
    ds_read_u16_d16_hi v131, v139 offset:32768
    s_waitcnt vmcnt(6)
    v_mfma_f32_4x4x4_16b_bf16 v[96:99], v[140:141], v[64:65], 0 cbsz:4 abid:0
    v_mfma_f32_4x4x4_16b_bf16 v[100:103], v[140:141], v[66:67], 0 cbsz:4 abid:0
A_0:
    s_sub_u32 s31, s31, 4
    s_cbranch_scc1 TO_B_0
    v_mfma_f32_4x4x4_16b_bf16 v[124:127], v[172:173], v[178:179], 0 cbsz:4 abid:1
    v_lshlrev_b32_sdwa v136, v15, v114 dst_sel:DWORD dst_unused:UNUSED_PAD src0_sel:DWORD src1_sel:WORD_1
    s_waitcnt vmcnt(5)
    v_mfma_f32_4x4x4_16b_bf16 v[104:107], v[142:143], v[68:69], 0 cbsz:4 abid:0
    v_readlane_b32 s55, v164, 7
    v_mfma_f32_4x4x4_16b_bf16 v[108:111], v[142:143], v[70:71], 0 cbsz:4 abid:0
    v_lshlrev_b32_sdwa v137, v15, v115 dst_sel:DWORD dst_unused:UNUSED_PAD src0_sel:DWORD src1_sel:WORD_1
    ds_read_u16_d16_hi v132, v136 offset:32768
    ds_read_u16_d16_hi v133, v137 offset:32768
    s_and_b32 s33, s55, s34
    buffer_load_dwordx4 v[92:95], v1, s[12:15], s33 offen
    s_waitcnt lgkmcnt(2)
    s_set_gpr_idx_on s48, 0xc
    v_pk_fma_f32 v[16:17], v[128:129], v[96:97], v[16:17] op_sel:[0,0,0] op_sel_hi:[0,1,1]
    v_pk_fma_f32 v[18:19], v[128:129], v[98:99], v[18:19] op_sel:[0,0,0] op_sel_hi:[0,1,1]
    v_pk_fma_f32 v[20:21], v[130:131], v[100:101], v[20:21] op_sel:[0,0,0] op_sel_hi:[0,1,1]
    v_pk_fma_f32 v[22:23], v[130:131], v[102:103], v[22:23] op_sel:[0,0,0] op_sel_hi:[0,1,1]
    s_set_gpr_idx_off
    v_lshlrev_b32_sdwa v138, v15, v118 dst_sel:DWORD dst_unused:UNUSED_PAD src0_sel:DWORD src1_sel:WORD_1
    s_waitcnt vmcnt(5)
    v_mfma_f32_4x4x4_16b_bf16 v[96:99], v[144:145], v[72:73], 0 cbsz:4 abid:0
    v_readlane_b32 s56, v164, 8
    v_mfma_f32_4x4x4_16b_bf16 v[100:103], v[144:145], v[74:75], 0 cbsz:4 abid:0
    v_lshlrev_b32_sdwa v139, v15, v119 dst_sel:DWORD dst_unused:UNUSED_PAD src0_sel:DWORD src1_sel:WORD_1
    ds_read_u16_d16_hi v134, v138 offset:32768
    ds_read_u16_d16_hi v135, v139 offset:32768
    s_and_b32 s33, s56, s34
    buffer_load_dwordx4 v[64:67], v1, s[12:15], s33 offen
    s_set_gpr_idx_on s49, 0xc
    v_pk_fma_f32 v[16:17], v[128:129], v[104:105], v[16:17] op_sel:[1,0,0] op_sel_hi:[1,1,1]
    v_pk_fma_f32 v[18:19], v[128:129], v[106:107], v[18:19] op_sel:[1,0,0] op_sel_hi:[1,1,1]
    v_pk_fma_f32 v[20:21], v[130:131], v[108:109], v[20:21] op_sel:[1,0,0] op_sel_hi:[1,1,1]
    v_pk_fma_f32 v[22:23], v[130:131], v[110:111], v[22:23] op_sel:[1,0,0] op_sel_hi:[1,1,1]
    s_set_gpr_idx_off
    v_mfma_f32_4x4x4_16b_bf16 v[112:115], v[172:173], v[176:177], 0 cbsz:4 abid:2
    v_lshlrev_b32_sdwa v136, v15, v120 dst_sel:DWORD dst_unused:UNUSED_PAD src0_sel:DWORD src1_sel:WORD_1
    s_waitcnt vmcnt(5)
    v_mfma_f32_4x4x4_16b_bf16 v[104:107], v[146:147], v[76:77], 0 cbsz:4 abid:0
    v_readlane_b32 s57, v164, 9
    v_mfma_f32_4x4x4_16b_bf16 v[108:111], v[146:147], v[78:79], 0 cbsz:4 abid:0
    v_lshlrev_b32_sdwa v137, v15, v121 dst_sel:DWORD dst_unused:UNUSED_PAD src0_sel:DWORD src1_sel:WORD_1
    ds_read_u16_d16_hi v128, v136 offset:32768
    ds_read_u16_d16_hi v129, v137 offset:32768
    s_and_b32 s33, s57, s34
    buffer_load_dwordx4 v[68:71], v1, s[12:15], s33 offen
    s_waitcnt lgkmcnt(2)
    s_set_gpr_idx_on s50, 0xc
    v_pk_fma_f32 v[16:17], v[132:133], v[96:97], v[16:17] op_sel:[0,0,0] op_sel_hi:[0,1,1]
    v_pk_fma_f32 v[18:19], v[132:133], v[98:99], v[18:19] op_sel:[0,0,0] op_sel_hi:[0,1,1]
    v_pk_fma_f32 v[20:21], v[134:135], v[100:101], v[20:21] op_sel:[0,0,0] op_sel_hi:[0,1,1]
    v_pk_fma_f32 v[22:23], v[134:135], v[102:103], v[22:23] op_sel:[0,0,0] op_sel_hi:[0,1,1]
    s_set_gpr_idx_off
    v_lshlrev_b32_sdwa v138, v15, v124 dst_sel:DWORD dst_unused:UNUSED_PAD src0_sel:DWORD src1_sel:WORD_1
    s_waitcnt vmcnt(5)
    v_mfma_f32_4x4x4_16b_bf16 v[96:99], v[140:141], v[80:81], 0 cbsz:4 abid:1
    v_readlane_b32 s58, v164, 10
    v_mfma_f32_4x4x4_16b_bf16 v[100:103], v[140:141], v[82:83], 0 cbsz:4 abid:1
    v_lshlrev_b32_sdwa v139, v15, v125 dst_sel:DWORD dst_unused:UNUSED_PAD src0_sel:DWORD src1_sel:WORD_1
    ds_read_u16_d16_hi v130, v138 offset:32768
    ds_read_u16_d16_hi v131, v139 offset:32768
    s_and_b32 s33, s58, s34
    buffer_load_dwordx4 v[72:75], v1, s[12:15], s33 offen
    s_set_gpr_idx_on s51, 0xc
    v_pk_fma_f32 v[16:17], v[132:133], v[104:105], v[16:17] op_sel:[1,0,0] op_sel_hi:[1,1,1]
    v_pk_fma_f32 v[18:19], v[132:133], v[106:107], v[18:19] op_sel:[1,0,0] op_sel_hi:[1,1,1]
    v_pk_fma_f32 v[20:21], v[134:135], v[108:109], v[20:21] op_sel:[1,0,0] op_sel_hi:[1,1,1]
    v_pk_fma_f32 v[22:23], v[134:135], v[110:111], v[22:23] op_sel:[1,0,0] op_sel_hi:[1,1,1]
    s_set_gpr_idx_off
A_4:
    s_sub_u32 s31, s31, 4
    s_cbranch_scc1 TO_B_4
    v_mfma_f32_4x4x4_16b_bf16 v[116:119], v[172:173], v[178:179], 0 cbsz:4 abid:2
    v_lshlrev_b32_sdwa v136, v15, v122 dst_sel:DWORD dst_unused:UNUSED_PAD src0_sel:DWORD src1_sel:WORD_1
    s_waitcnt vmcnt(5)
    v_mfma_f32_4x4x4_16b_bf16 v[104:107], v[142:143], v[84:85], 0 cbsz:4 abid:1
    v_readlane_b32 s59, v164, 11
    v_mfma_f32_4x4x4_16b_bf16 v[108:111], v[142:143], v[86:87], 0 cbsz:4 abid:1
    v_lshlrev_b32_sdwa v137, v15, v123 dst_sel:DWORD dst_unused:UNUSED_PAD src0_sel:DWORD src1_sel:WORD_1
    ds_read_u16_d16_hi v132, v136 offset:32768
    ds_read_u16_d16_hi v133, v137 offset:32768
    s_and_b32 s33, s59, s34
    buffer_load_dwordx4 v[76:79], v1, s[12:15], s33 offen
    s_waitcnt lgkmcnt(2)
    s_set_gpr_idx_on s52, 0xc
    v_pk_fma_f32 v[16:17], v[128:129], v[96:97], v[16:17] op_sel:[0,0,0] op_sel_hi:[0,1,1]
    v_pk_fma_f32 v[18:19], v[128:129], v[98:99], v[18:19] op_sel:[0,0,0] op_sel_hi:[0,1,1]
    v_pk_fma_f32 v[20:21], v[130:131], v[100:101], v[20:21] op_sel:[0,0,0] op_sel_hi:[0,1,1]
    v_pk_fma_f32 v[22:23], v[130:131], v[102:103], v[22:23] op_sel:[0,0,0] op_sel_hi:[0,1,1]
    s_set_gpr_idx_off
    v_lshlrev_b32_sdwa v138, v15, v126 dst_sel:DWORD dst_unused:UNUSED_PAD src0_sel:DWORD src1_sel:WORD_1
    s_waitcnt vmcnt(5)
    v_mfma_f32_4x4x4_16b_bf16 v[96:99], v[144:145], v[88:89], 0 cbsz:4 abid:1
    v_readlane_b32 s60, v164, 12
    v_mfma_f32_4x4x4_16b_bf16 v[100:103], v[144:145], v[90:91], 0 cbsz:4 abid:1
    v_lshlrev_b32_sdwa v139, v15, v127 dst_sel:DWORD dst_unused:UNUSED_PAD src0_sel:DWORD src1_sel:WORD_1
    ds_read_u16_d16_hi v134, v138 offset:32768
    ds_read_u16_d16_hi v135, v139 offset:32768
    s_and_b32 s33, s60, s34
    buffer_load_dwordx4 v[80:83], v1, s[12:15], s33 offen
    s_set_gpr_idx_on s53, 0xc
    v_pk_fma_f32 v[16:17], v[128:129], v[104:105], v[16:17] op_sel:[1,0,0] op_sel_hi:[1,1,1]
    v_pk_fma_f32 v[18:19], v[128:129], v[106:107], v[18:19] op_sel:[1,0,0] op_sel_hi:[1,1,1]
    v_pk_fma_f32 v[20:21], v[130:131], v[108:109], v[20:21] op_sel:[1,0,0] op_sel_hi:[1,1,1]
    v_pk_fma_f32 v[22:23], v[130:131], v[110:111], v[22:23] op_sel:[1,0,0] op_sel_hi:[1,1,1]
    s_set_gpr_idx_off
    v_mfma_f32_4x4x4_16b_bf16 v[120:123], v[172:173], v[176:177], 0 cbsz:4 abid:3
    v_lshlrev_b32_sdwa v136, v15, v112 dst_sel:DWORD dst_unused:UNUSED_PAD src0_sel:DWORD src1_sel:WORD_1
    s_waitcnt vmcnt(5)
    v_mfma_f32_4x4x4_16b_bf16 v[104:107], v[146:147], v[92:93], 0 cbsz:4 abid:1
    v_readlane_b32 s61, v164, 13
    v_mfma_f32_4x4x4_16b_bf16 v[108:111], v[146:147], v[94:95], 0 cbsz:4 abid:1
    v_lshlrev_b32_sdwa v137, v15, v113 dst_sel:DWORD dst_unused:UNUSED_PAD src0_sel:DWORD src1_sel:WORD_1
    ds_read_u16_d16_hi v128, v136 offset:32768
    ds_read_u16_d16_hi v129, v137 offset:32768
    s_and_b32 s33, s61, s34
    buffer_load_dwordx4 v[84:87], v1, s[12:15], s33 offen
    s_waitcnt lgkmcnt(2)
    s_set_gpr_idx_on s54, 0xc
    v_pk_fma_f32 v[16:17], v[132:133], v[96:97], v[16:17] op_sel:[0,0,0] op_sel_hi:[0,1,1]
    v_pk_fma_f32 v[18:19], v[132:133], v[98:99], v[18:19] op_sel:[0,0,0] op_sel_hi:[0,1,1]
    v_pk_fma_f32 v[20:21], v[134:135], v[100:101], v[20:21] op_sel:[0,0,0] op_sel_hi:[0,1,1]
    v_pk_fma_f32 v[22:23], v[134:135], v[102:103], v[22:23] op_sel:[0,0,0] op_sel_hi:[0,1,1]
    s_set_gpr_idx_off
    v_lshlrev_b32_sdwa v138, v15, v116 dst_sel:DWORD dst_unused:UNUSED_PAD src0_sel:DWORD src1_sel:WORD_1
    s_waitcnt vmcnt(5)
    v_mfma_f32_4x4x4_16b_bf16 v[96:99], v[140:141], v[64:65], 0 cbsz:4 abid:2
    v_readlane_b32 s62, v164, 14
    v_mfma_f32_4x4x4_16b_bf16 v[100:103], v[140:141], v[66:67], 0 cbsz:4 abid:2
    v_lshlrev_b32_sdwa v139, v15, v117 dst_sel:DWORD dst_unused:UNUSED_PAD src0_sel:DWORD src1_sel:WORD_1
    ds_read_u16_d16_hi v130, v138 offset:32768
    ds_read_u16_d16_hi v131, v139 offset:32768
    s_and_b32 s33, s62, s34
    buffer_load_dwordx4 v[88:91], v1, s[12:15], s33 offen
    s_set_gpr_idx_on s55, 0xc
    v_pk_fma_f32 v[16:17], v[132:133], v[104:105], v[16:17] op_sel:[1,0,0] op_sel_hi:[1,1,1]
    v_pk_fma_f32 v[18:19], v[132:133], v[106:107], v[18:19] op_sel:[1,0,0] op_sel_hi:[1,1,1]
    v_pk_fma_f32 v[20:21], v[134:135], v[108:109], v[20:21] op_sel:[1,0,0] op_sel_hi:[1,1,1]
    v_pk_fma_f32 v[22:23], v[134:135], v[110:111], v[22:23] op_sel:[1,0,0] op_sel_hi:[1,1,1]
    s_set_gpr_idx_off
A_8:
    s_sub_u32 s31, s31, 4
    s_cbranch_scc1 TO_B_8
    v_mfma_f32_4x4x4_16b_bf16 v[124:127], v[172:173], v[178:179], 0 cbsz:4 abid:3
    v_lshlrev_b32_sdwa v136, v15, v114 dst_sel:DWORD dst_unused:UNUSED_PAD src0_sel:DWORD src1_sel:WORD_1
    s_waitcnt vmcnt(5)
    v_mfma_f32_4x4x4_16b_bf16 v[104:107], v[142:143], v[68:69], 0 cbsz:4 abid:2
    v_readlane_b32 s63, v164, 15
    v_mfma_f32_4x4x4_16b_bf16 v[108:111], v[142:143], v[70:71], 0 cbsz:4 abid:2
    v_lshlrev_b32_sdwa v137, v15, v115 dst_sel:DWORD dst_unused:UNUSED_PAD src0_sel:DWORD src1_sel:WORD_1
    ds_read_u16_d16_hi v132, v136 offset:32768
    ds_read_u16_d16_hi v133, v137 offset:32768
    s_and_b32 s33, s63, s34
    buffer_load_dwordx4 v[92:95], v1, s[12:15], s33 offen
    s_waitcnt lgkmcnt(2)
    s_set_gpr_idx_on s56, 0xc
    v_pk_fma_f32 v[16:17], v[128:129], v[96:97], v[16:17] op_sel:[0,0,0] op_sel_hi:[0,1,1]
    v_pk_fma_f32 v[18:19], v[128:129], v[98:99], v[18:19] op_sel:[0,0,0] op_sel_hi:[0,1,1]
    v_pk_fma_f32 v[20:21], v[130:131], v[100:101], v[20:21] op_sel:[0,0,0] op_sel_hi:[0,1,1]
    v_pk_fma_f32 v[22:23], v[130:131], v[102:103], v[22:23] op_sel:[0,0,0] op_sel_hi:[0,1,1]
    s_set_gpr_idx_off
    ds_read_b32 v165, v5
    v_lshlrev_b32_sdwa v138, v15, v118 dst_sel:DWORD dst_unused:UNUSED_PAD src0_sel:DWORD src1_sel:WORD_1
    s_waitcnt vmcnt(5)
    v_mfma_f32_4x4x4_16b_bf16 v[96:99], v[144:145], v[72:73], 0 cbsz:4 abid:2
    v_readlane_b32 s48, v164, 16
    v_mfma_f32_4x4x4_16b_bf16 v[100:103], v[144:145], v[74:75], 0 cbsz:4 abid:2
    v_lshlrev_b32_sdwa v139, v15, v119 dst_sel:DWORD dst_unused:UNUSED_PAD src0_sel:DWORD src1_sel:WORD_1
    ds_read_u16_d16_hi v134, v138 offset:32768
    ds_read_u16_d16_hi v135, v139 offset:32768
    s_and_b32 s33, s48, s34
    buffer_load_dwordx4 v[64:67], v1, s[12:15], s33 offen
    s_set_gpr_idx_on s57, 0xc
    v_pk_fma_f32 v[16:17], v[128:129], v[104:105], v[16:17] op_sel:[1,0,0] op_sel_hi:[1,1,1]
    v_pk_fma_f32 v[18:19], v[128:129], v[106:107], v[18:19] op_sel:[1,0,0] op_sel_hi:[1,1,1]
    v_pk_fma_f32 v[20:21], v[130:131], v[108:109], v[20:21] op_sel:[1,0,0] op_sel_hi:[1,1,1]
    v_pk_fma_f32 v[22:23], v[130:131], v[110:111], v[22:23] op_sel:[1,0,0] op_sel_hi:[1,1,1]
    s_set_gpr_idx_off
    v_mfma_f32_4x4x4_16b_bf16 v[112:115], v[172:173], v[176:177], 0 cbsz:4 abid:4
    v_lshlrev_b32_sdwa v136, v15, v120 dst_sel:DWORD dst_unused:UNUSED_PAD src0_sel:DWORD src1_sel:WORD_1
    s_waitcnt vmcnt(5)
    v_mfma_f32_4x4x4_16b_bf16 v[104:107], v[146:147], v[76:77], 0 cbsz:4 abid:2
    v_readlane_b32 s49, v164, 17
    v_mfma_f32_4x4x4_16b_bf16 v[108:111], v[146:147], v[78:79], 0 cbsz:4 abid:2
    v_lshlrev_b32_sdwa v137, v15, v121 dst_sel:DWORD dst_unused:UNUSED_PAD src0_sel:DWORD src1_sel:WORD_1
    ds_read_u16_d16_hi v128, v136 offset:32768
    ds_read_u16_d16_hi v129, v137 offset:32768
    s_and_b32 s33, s49, s34
    buffer_load_dwordx4 v[68:71], v1, s[12:15], s33 offen
    s_waitcnt lgkmcnt(2)
    s_set_gpr_idx_on s58, 0xc
    v_pk_fma_f32 v[16:17], v[132:133], v[96:97], v[16:17] op_sel:[0,0,0] op_sel_hi:[0,1,1]
    v_pk_fma_f32 v[18:19], v[132:133], v[98:99], v[18:19] op_sel:[0,0,0] op_sel_hi:[0,1,1]
    v_pk_fma_f32 v[20:21], v[134:135], v[100:101], v[20:21] op_sel:[0,0,0] op_sel_hi:[0,1,1]
    v_pk_fma_f32 v[22:23], v[134:135], v[102:103], v[22:23] op_sel:[0,0,0] op_sel_hi:[0,1,1]
    s_set_gpr_idx_off
    v_lshlrev_b32_sdwa v138, v15, v124 dst_sel:DWORD dst_unused:UNUSED_PAD src0_sel:DWORD src1_sel:WORD_1
    s_waitcnt vmcnt(5)
    v_mfma_f32_4x4x4_16b_bf16 v[96:99], v[140:141], v[80:81], 0 cbsz:4 abid:3
    v_readlane_b32 s50, v164, 18
    v_mfma_f32_4x4x4_16b_bf16 v[100:103], v[140:141], v[82:83], 0 cbsz:4 abid:3
    v_lshlrev_b32_sdwa v139, v15, v125 dst_sel:DWORD dst_unused:UNUSED_PAD src0_sel:DWORD src1_sel:WORD_1
    ds_read_u16_d16_hi v130, v138 offset:32768
    ds_read_u16_d16_hi v131, v139 offset:32768
    s_and_b32 s33, s50, s34
    buffer_load_dwordx4 v[72:75], v1, s[12:15], s33 offen
    s_set_gpr_idx_on s59, 0xc
    v_pk_fma_f32 v[16:17], v[132:133], v[104:105], v[16:17] op_sel:[1,0,0] op_sel_hi:[1,1,1]
    v_pk_fma_f32 v[18:19], v[132:133], v[106:107], v[18:19] op_sel:[1,0,0] op_sel_hi:[1,1,1]
    v_pk_fma_f32 v[20:21], v[134:135], v[108:109], v[20:21] op_sel:[1,0,0] op_sel_hi:[1,1,1]
    v_pk_fma_f32 v[22:23], v[134:135], v[110:111], v[22:23] op_sel:[1,0,0] op_sel_hi:[1,1,1]
    s_set_gpr_idx_off
A_12:
    s_sub_u32 s31, s31, 4
    s_cbranch_scc1 TO_B_12
    v_mfma_f32_4x4x4_16b_bf16 v[116:119], v[172:173], v[178:179], 0 cbsz:4 abid:4
    v_lshlrev_b32_sdwa v136, v15, v122 dst_sel:DWORD dst_unused:UNUSED_PAD src0_sel:DWORD src1_sel:WORD_1
    s_waitcnt vmcnt(5)
    v_mfma_f32_4x4x4_16b_bf16 v[104:107], v[142:143], v[84:85], 0 cbsz:4 abid:3
    v_readlane_b32 s51, v164, 19
    v_mfma_f32_4x4x4_16b_bf16 v[108:111], v[142:143], v[86:87], 0 cbsz:4 abid:3
    v_lshlrev_b32_sdwa v137, v15, v123 dst_sel:DWORD dst_unused:UNUSED_PAD src0_sel:DWORD src1_sel:WORD_1
    ds_read_u16_d16_hi v132, v136 offset:32768
    ds_read_u16_d16_hi v133, v137 offset:32768
    s_and_b32 s33, s51, s34
    buffer_load_dwordx4 v[76:79], v1, s[12:15], s33 offen
    s_waitcnt lgkmcnt(2)
    s_set_gpr_idx_on s60, 0xc
    v_pk_fma_f32 v[16:17], v[128:129], v[96:97], v[16:17] op_sel:[0,0,0] op_sel_hi:[0,1,1]
    v_pk_fma_f32 v[18:19], v[128:129], v[98:99], v[18:19] op_sel:[0,0,0] op_sel_hi:[0,1,1]
    v_pk_fma_f32 v[20:21], v[130:131], v[100:101], v[20:21] op_sel:[0,0,0] op_sel_hi:[0,1,1]
    v_pk_fma_f32 v[22:23], v[130:131], v[102:103], v[22:23] op_sel:[0,0,0] op_sel_hi:[0,1,1]
    s_set_gpr_idx_off
    v_cmp_gt_u32 vcc, s30, v6
    v_add_u32 v6, 64, v6
    v_add_u32 v5, 256, v5
    v_cndmask_b32 v165, 40, v165, vcc
    v_lshrrev_b32 v8, 21, v165
    v_lshlrev_b32 v8, 4, v8
    v_lshlrev_b32 v9, 3, v165
    ds_read_b128 v[168:171], v8 offset:8192
    v_and_b32 v9, 0xfffc00, v9
    v_and_or_b32 v165, v165, 56, v9
    v_lshlrev_b32_sdwa v138, v15, v126 dst_sel:DWORD dst_unused:UNUSED_PAD src0_sel:DWORD src1_sel:WORD_1
    s_waitcnt vmcnt(5)
    v_mfma_f32_4x4x4_16b_bf16 v[96:99], v[144:145], v[88:89], 0 cbsz:4 abid:3
    v_readlane_b32 s52, v164, 20
    v_mfma_f32_4x4x4_16b_bf16 v[100:103], v[144:145], v[90:91], 0 cbsz:4 abid:3
    v_lshlrev_b32_sdwa v139, v15, v127 dst_sel:DWORD dst_unused:UNUSED_PAD src0_sel:DWORD src1_sel:WORD_1
    ds_read_u16_d16_hi v134, v138 offset:32768
    ds_read_u16_d16_hi v135, v139 offset:32768
    s_and_b32 s33, s52, s34
    buffer_load_dwordx4 v[80:83], v1, s[12:15], s33 offen
    s_set_gpr_idx_on s61, 0xc
    v_pk_fma_f32 v[16:17], v[128:129], v[104:105], v[16:17] op_sel:[1,0,0] op_sel_hi:[1,1,1]
    v_pk_fma_f32 v[18:19], v[128:129], v[106:107], v[18:19] op_sel:[1,0,0] op_sel_hi:[1,1,1]
    v_pk_fma_f32 v[20:21], v[130:131], v[108:109], v[20:21] op_sel:[1,0,0] op_sel_hi:[1,1,1]
    v_pk_fma_f32 v[22:23], v[130:131], v[110:111], v[22:23] op_sel:[1,0,0] op_sel_hi:[1,1,1]
    s_set_gpr_idx_off
    v_mfma_f32_4x4x4_16b_bf16 v[120:123], v[172:173], v[176:177], 0 cbsz:4 abid:5
    v_lshlrev_b32_sdwa v136, v15, v112 dst_sel:DWORD dst_unused:UNUSED_PAD src0_sel:DWORD src1_sel:WORD_1
    s_waitcnt vmcnt(5)
    v_mfma_f32_4x4x4_16b_bf16 v[104:107], v[146:147], v[92:93], 0 cbsz:4 abid:3
    v_readlane_b32 s53, v164, 21
    v_mfma_f32_4x4x4_16b_bf16 v[108:111], v[146:147], v[94:95], 0 cbsz:4 abid:3
    v_lshlrev_b32_sdwa v137, v15, v113 dst_sel:DWORD dst_unused:UNUSED_PAD src0_sel:DWORD src1_sel:WORD_1
    ds_read_u16_d16_hi v128, v136 offset:32768
    ds_read_u16_d16_hi v129, v137 offset:32768
    s_and_b32 s33, s53, s34
    buffer_load_dwordx4 v[84:87], v1, s[12:15], s33 offen
    s_waitcnt lgkmcnt(2)
    s_set_gpr_idx_on s62, 0xc
    v_pk_fma_f32 v[16:17], v[132:133], v[96:97], v[16:17] op_sel:[0,0,0] op_sel_hi:[0,1,1]
    v_pk_fma_f32 v[18:19], v[132:133], v[98:99], v[18:19] op_sel:[0,0,0] op_sel_hi:[0,1,1]
    v_pk_fma_f32 v[20:21], v[134:135], v[100:101], v[20:21] op_sel:[0,0,0] op_sel_hi:[0,1,1]
    v_pk_fma_f32 v[22:23], v[134:135], v[102:103], v[22:23] op_sel:[0,0,0] op_sel_hi:[0,1,1]
    s_set_gpr_idx_off
    v_lshlrev_b32_sdwa v138, v15, v116 dst_sel:DWORD dst_unused:UNUSED_PAD src0_sel:DWORD src1_sel:WORD_1
    s_waitcnt vmcnt(5)
    v_mfma_f32_4x4x4_16b_bf16 v[96:99], v[140:141], v[64:65], 0 cbsz:4 abid:4
    v_readlane_b32 s54, v164, 22
    v_mfma_f32_4x4x4_16b_bf16 v[100:103], v[140:141], v[66:67], 0 cbsz:4 abid:4
    v_lshlrev_b32_sdwa v139, v15, v117 dst_sel:DWORD dst_unused:UNUSED_PAD src0_sel:DWORD src1_sel:WORD_1
    ds_read_u16_d16_hi v130, v138 offset:32768
    ds_read_u16_d16_hi v131, v139 offset:32768
    s_and_b32 s33, s54, s34
    buffer_load_dwordx4 v[88:91], v1, s[12:15], s33 offen
    s_set_gpr_idx_on s63, 0xc
    v_pk_fma_f32 v[16:17], v[132:133], v[104:105], v[16:17] op_sel:[1,0,0] op_sel_hi:[1,1,1]
    v_pk_fma_f32 v[18:19], v[132:133], v[106:107], v[18:19] op_sel:[1,0,0] op_sel_hi:[1,1,1]
    v_pk_fma_f32 v[20:21], v[134:135], v[108:109], v[20:21] op_sel:[1,0,0] op_sel_hi:[1,1,1]
    v_pk_fma_f32 v[22:23], v[134:135], v[110:111], v[22:23] op_sel:[1,0,0] op_sel_hi:[1,1,1]
    s_set_gpr_idx_off
A_16:
    s_sub_u32 s31, s31, 4
    s_cbranch_scc1 TO_B_16
    v_mfma_f32_4x4x4_16b_bf16 v[124:127], v[172:173], v[178:179], 0 cbsz:4 abid:5
    v_lshlrev_b32_sdwa v136, v15, v114 dst_sel:DWORD dst_unused:UNUSED_PAD src0_sel:DWORD src1_sel:WORD_1
    s_waitcnt vmcnt(5)
    v_mfma_f32_4x4x4_16b_bf16 v[104:107], v[142:143], v[68:69], 0 cbsz:4 abid:4
    v_readlane_b32 s55, v164, 23
    v_mfma_f32_4x4x4_16b_bf16 v[108:111], v[142:143], v[70:71], 0 cbsz:4 abid:4
    v_lshlrev_b32_sdwa v137, v15, v115 dst_sel:DWORD dst_unused:UNUSED_PAD src0_sel:DWORD src1_sel:WORD_1
    ds_read_u16_d16_hi v132, v136 offset:32768
    ds_read_u16_d16_hi v133, v137 offset:32768
    s_and_b32 s33, s55, s34
    buffer_load_dwordx4 v[92:95], v1, s[12:15], s33 offen
    s_waitcnt lgkmcnt(2)
    s_set_gpr_idx_on s48, 0xc
    v_pk_fma_f32 v[16:17], v[128:129], v[96:97], v[16:17] op_sel:[0,0,0] op_sel_hi:[0,1,1]
    v_pk_fma_f32 v[18:19], v[128:129], v[98:99], v[18:19] op_sel:[0,0,0] op_sel_hi:[0,1,1]
    v_pk_fma_f32 v[20:21], v[130:131], v[100:101], v[20:21] op_sel:[0,0,0] op_sel_hi:[0,1,1]
    v_pk_fma_f32 v[22:23], v[130:131], v[102:103], v[22:23] op_sel:[0,0,0] op_sel_hi:[0,1,1]
    s_set_gpr_idx_off
    v_lshlrev_b32_sdwa v138, v15, v118 dst_sel:DWORD dst_unused:UNUSED_PAD src0_sel:DWORD src1_sel:WORD_1
    s_waitcnt vmcnt(5)
    v_mfma_f32_4x4x4_16b_bf16 v[96:99], v[144:145], v[72:73], 0 cbsz:4 abid:4
    v_readlane_b32 s56, v164, 24
    v_mfma_f32_4x4x4_16b_bf16 v[100:103], v[144:145], v[74:75], 0 cbsz:4 abid:4
    v_lshlrev_b32_sdwa v139, v15, v119 dst_sel:DWORD dst_unused:UNUSED_PAD src0_sel:DWORD src1_sel:WORD_1
    ds_read_u16_d16_hi v134, v138 offset:32768
    ds_read_u16_d16_hi v135, v139 offset:32768
    s_and_b32 s33, s56, s34
    buffer_load_dwordx4 v[64:67], v1, s[12:15], s33 offen
    s_set_gpr_idx_on s49, 0xc
    v_pk_fma_f32 v[16:17], v[128:129], v[104:105], v[16:17] op_sel:[1,0,0] op_sel_hi:[1,1,1]
    v_pk_fma_f32 v[18:19], v[128:129], v[106:107], v[18:19] op_sel:[1,0,0] op_sel_hi:[1,1,1]
    v_pk_fma_f32 v[20:21], v[130:131], v[108:109], v[20:21] op_sel:[1,0,0] op_sel_hi:[1,1,1]
    v_pk_fma_f32 v[22:23], v[130:131], v[110:111], v[22:23] op_sel:[1,0,0] op_sel_hi:[1,1,1]
    s_set_gpr_idx_off
    v_mfma_f32_4x4x4_16b_bf16 v[112:115], v[172:173], v[176:177], 0 cbsz:4 abid:6
    v_lshlrev_b32_sdwa v136, v15, v120 dst_sel:DWORD dst_unused:UNUSED_PAD src0_sel:DWORD src1_sel:WORD_1
    s_waitcnt vmcnt(5)
    v_mfma_f32_4x4x4_16b_bf16 v[104:107], v[146:147], v[76:77], 0 cbsz:4 abid:4
    v_readlane_b32 s57, v164, 25
    v_mfma_f32_4x4x4_16b_bf16 v[108:111], v[146:147], v[78:79], 0 cbsz:4 abid:4
    v_lshlrev_b32_sdwa v137, v15, v121 dst_sel:DWORD dst_unused:UNUSED_PAD src0_sel:DWORD src1_sel:WORD_1
    ds_read_u16_d16_hi v128, v136 offset:32768
    ds_read_u16_d16_hi v129, v137 offset:32768
    s_and_b32 s33, s57, s34
    buffer_load_dwordx4 v[68:71], v1, s[12:15], s33 offen
    s_waitcnt lgkmcnt(2)
    s_set_gpr_idx_on s50, 0xc
    v_pk_fma_f32 v[16:17], v[132:133], v[96:97], v[16:17] op_sel:[0,0,0] op_sel_hi:[0,1,1]
    v_pk_fma_f32 v[18:19], v[132:133], v[98:99], v[18:19] op_sel:[0,0,0] op_sel_hi:[0,1,1]
    v_pk_fma_f32 v[20:21], v[134:135], v[100:101], v[20:21] op_sel:[0,0,0] op_sel_hi:[0,1,1]
    v_pk_fma_f32 v[22:23], v[134:135], v[102:103], v[22:23] op_sel:[0,0,0] op_sel_hi:[0,1,1]
    s_set_gpr_idx_off
    v_lshlrev_b32_sdwa v138, v15, v124 dst_sel:DWORD dst_unused:UNUSED_PAD src0_sel:DWORD src1_sel:WORD_1
    s_waitcnt vmcnt(5)
    v_mfma_f32_4x4x4_16b_bf16 v[96:99], v[140:141], v[80:81], 0 cbsz:4 abid:5
    v_readlane_b32 s58, v164, 26
    v_mfma_f32_4x4x4_16b_bf16 v[100:103], v[140:141], v[82:83], 0 cbsz:4 abid:5
    v_lshlrev_b32_sdwa v139, v15, v125 dst_sel:DWORD dst_unused:UNUSED_PAD src0_sel:DWORD src1_sel:WORD_1
    ds_read_u16_d16_hi v130, v138 offset:32768
    ds_read_u16_d16_hi v131, v139 offset:32768
    s_and_b32 s33, s58, s34
    buffer_load_dwordx4 v[72:75], v1, s[12:15], s33 offen
    s_set_gpr_idx_on s51, 0xc
    v_pk_fma_f32 v[16:17], v[132:133], v[104:105], v[16:17] op_sel:[1,0,0] op_sel_hi:[1,1,1]
    v_pk_fma_f32 v[18:19], v[132:133], v[106:107], v[18:19] op_sel:[1,0,0] op_sel_hi:[1,1,1]
    v_pk_fma_f32 v[20:21], v[134:135], v[108:109], v[20:21] op_sel:[1,0,0] op_sel_hi:[1,1,1]
    v_pk_fma_f32 v[22:23], v[134:135], v[110:111], v[22:23] op_sel:[1,0,0] op_sel_hi:[1,1,1]
    s_set_gpr_idx_off
A_20:
    s_sub_u32 s31, s31, 4
    s_cbranch_scc1 TO_B_20
    v_mfma_f32_4x4x4_16b_bf16 v[116:119], v[172:173], v[178:179], 0 cbsz:4 abid:6
    v_lshlrev_b32_sdwa v136, v15, v122 dst_sel:DWORD dst_unused:UNUSED_PAD src0_sel:DWORD src1_sel:WORD_1
    s_waitcnt vmcnt(5)
    v_mfma_f32_4x4x4_16b_bf16 v[104:107], v[142:143], v[84:85], 0 cbsz:4 abid:5
    v_readlane_b32 s59, v164, 27
    v_mfma_f32_4x4x4_16b_bf16 v[108:111], v[142:143], v[86:87], 0 cbsz:4 abid:5
    v_lshlrev_b32_sdwa v137, v15, v123 dst_sel:DWORD dst_unused:UNUSED_PAD src0_sel:DWORD src1_sel:WORD_1
    ds_read_u16_d16_hi v132, v136 offset:32768
    ds_read_u16_d16_hi v133, v137 offset:32768
    s_and_b32 s33, s59, s34
    buffer_load_dwordx4 v[76:79], v1, s[12:15], s33 offen
    s_waitcnt lgkmcnt(2)
    s_set_gpr_idx_on s52, 0xc
    v_pk_fma_f32 v[16:17], v[128:129], v[96:97], v[16:17] op_sel:[0,0,0] op_sel_hi:[0,1,1]
    v_pk_fma_f32 v[18:19], v[128:129], v[98:99], v[18:19] op_sel:[0,0,0] op_sel_hi:[0,1,1]
    v_pk_fma_f32 v[20:21], v[130:131], v[100:101], v[20:21] op_sel:[0,0,0] op_sel_hi:[0,1,1]
    v_pk_fma_f32 v[22:23], v[130:131], v[102:103], v[22:23] op_sel:[0,0,0] op_sel_hi:[0,1,1]
    s_set_gpr_idx_off
    v_lshlrev_b32_sdwa v138, v15, v126 dst_sel:DWORD dst_unused:UNUSED_PAD src0_sel:DWORD src1_sel:WORD_1
    s_waitcnt vmcnt(5)
    v_mfma_f32_4x4x4_16b_bf16 v[96:99], v[144:145], v[88:89], 0 cbsz:4 abid:5
    v_readlane_b32 s60, v164, 28
    v_mfma_f32_4x4x4_16b_bf16 v[100:103], v[144:145], v[90:91], 0 cbsz:4 abid:5
    v_lshlrev_b32_sdwa v139, v15, v127 dst_sel:DWORD dst_unused:UNUSED_PAD src0_sel:DWORD src1_sel:WORD_1
    ds_read_u16_d16_hi v134, v138 offset:32768
    ds_read_u16_d16_hi v135, v139 offset:32768
    s_and_b32 s33, s60, s34
    buffer_load_dwordx4 v[80:83], v1, s[12:15], s33 offen
    s_set_gpr_idx_on s53, 0xc
    v_pk_fma_f32 v[16:17], v[128:129], v[104:105], v[16:17] op_sel:[1,0,0] op_sel_hi:[1,1,1]
    v_pk_fma_f32 v[18:19], v[128:129], v[106:107], v[18:19] op_sel:[1,0,0] op_sel_hi:[1,1,1]
    v_pk_fma_f32 v[20:21], v[130:131], v[108:109], v[20:21] op_sel:[1,0,0] op_sel_hi:[1,1,1]
    v_pk_fma_f32 v[22:23], v[130:131], v[110:111], v[22:23] op_sel:[1,0,0] op_sel_hi:[1,1,1]
    s_set_gpr_idx_off
    v_mfma_f32_4x4x4_16b_bf16 v[120:123], v[172:173], v[176:177], 0 cbsz:4 abid:7
    v_lshlrev_b32_sdwa v136, v15, v112 dst_sel:DWORD dst_unused:UNUSED_PAD src0_sel:DWORD src1_sel:WORD_1
    s_waitcnt vmcnt(5)
    v_mfma_f32_4x4x4_16b_bf16 v[104:107], v[146:147], v[92:93], 0 cbsz:4 abid:5
    v_readlane_b32 s61, v164, 29
    v_mfma_f32_4x4x4_16b_bf16 v[108:111], v[146:147], v[94:95], 0 cbsz:4 abid:5
    v_lshlrev_b32_sdwa v137, v15, v113 dst_sel:DWORD dst_unused:UNUSED_PAD src0_sel:DWORD src1_sel:WORD_1
    ds_read_u16_d16_hi v128, v136 offset:32768
    ds_read_u16_d16_hi v129, v137 offset:32768
    s_and_b32 s33, s61, s34
    buffer_load_dwordx4 v[84:87], v1, s[12:15], s33 offen
    s_waitcnt lgkmcnt(2)
    s_set_gpr_idx_on s54, 0xc
    v_pk_fma_f32 v[16:17], v[132:133], v[96:97], v[16:17] op_sel:[0,0,0] op_sel_hi:[0,1,1]
    v_pk_fma_f32 v[18:19], v[132:133], v[98:99], v[18:19] op_sel:[0,0,0] op_sel_hi:[0,1,1]
    v_pk_fma_f32 v[20:21], v[134:135], v[100:101], v[20:21] op_sel:[0,0,0] op_sel_hi:[0,1,1]
    v_pk_fma_f32 v[22:23], v[134:135], v[102:103], v[22:23] op_sel:[0,0,0] op_sel_hi:[0,1,1]
    s_set_gpr_idx_off
    v_lshlrev_b32_sdwa v138, v15, v116 dst_sel:DWORD dst_unused:UNUSED_PAD src0_sel:DWORD src1_sel:WORD_1
    s_waitcnt vmcnt(5)
    v_mfma_f32_4x4x4_16b_bf16 v[96:99], v[140:141], v[64:65], 0 cbsz:4 abid:6
    v_readlane_b32 s62, v164, 30
    v_mfma_f32_4x4x4_16b_bf16 v[100:103], v[140:141], v[66:67], 0 cbsz:4 abid:6
    v_lshlrev_b32_sdwa v139, v15, v117 dst_sel:DWORD dst_unused:UNUSED_PAD src0_sel:DWORD src1_sel:WORD_1
    ds_read_u16_d16_hi v130, v138 offset:32768
    ds_read_u16_d16_hi v131, v139 offset:32768
    s_and_b32 s33, s62, s34
    buffer_load_dwordx4 v[88:91], v1, s[12:15], s33 offen
    s_set_gpr_idx_on s55, 0xc
    v_pk_fma_f32 v[16:17], v[132:133], v[104:105], v[16:17] op_sel:[1,0,0] op_sel_hi:[1,1,1]
    v_pk_fma_f32 v[18:19], v[132:133], v[106:107], v[18:19] op_sel:[1,0,0] op_sel_hi:[1,1,1]
    v_pk_fma_f32 v[20:21], v[134:135], v[108:109], v[20:21] op_sel:[1,0,0] op_sel_hi:[1,1,1]
    v_pk_fma_f32 v[22:23], v[134:135], v[110:111], v[22:23] op_sel:[1,0,0] op_sel_hi:[1,1,1]
    s_set_gpr_idx_off
A_24:
    s_sub_u32 s31, s31, 4
    s_cbranch_scc1 TO_B_24
    v_mfma_f32_4x4x4_16b_bf16 v[124:127], v[172:173], v[178:179], 0 cbsz:4 abid:7
    v_lshlrev_b32_sdwa v136, v15, v114 dst_sel:DWORD dst_unused:UNUSED_PAD src0_sel:DWORD src1_sel:WORD_1
    s_waitcnt vmcnt(5)
    v_mfma_f32_4x4x4_16b_bf16 v[104:107], v[142:143], v[68:69], 0 cbsz:4 abid:6
    v_readlane_b32 s63, v164, 31
    v_mfma_f32_4x4x4_16b_bf16 v[108:111], v[142:143], v[70:71], 0 cbsz:4 abid:6
    v_lshlrev_b32_sdwa v137, v15, v115 dst_sel:DWORD dst_unused:UNUSED_PAD src0_sel:DWORD src1_sel:WORD_1
    ds_read_u16_d16_hi v132, v136 offset:32768
    ds_read_u16_d16_hi v133, v137 offset:32768
    s_and_b32 s33, s63, s34
    buffer_load_dwordx4 v[92:95], v1, s[12:15], s33 offen
    s_waitcnt lgkmcnt(2)
    s_set_gpr_idx_on s56, 0xc
    v_pk_fma_f32 v[16:17], v[128:129], v[96:97], v[16:17] op_sel:[0,0,0] op_sel_hi:[0,1,1]
    v_pk_fma_f32 v[18:19], v[128:129], v[98:99], v[18:19] op_sel:[0,0,0] op_sel_hi:[0,1,1]
    v_pk_fma_f32 v[20:21], v[130:131], v[100:101], v[20:21] op_sel:[0,0,0] op_sel_hi:[0,1,1]
    v_pk_fma_f32 v[22:23], v[130:131], v[102:103], v[22:23] op_sel:[0,0,0] op_sel_hi:[0,1,1]
    s_set_gpr_idx_off
    v_lshlrev_b32_sdwa v138, v15, v118 dst_sel:DWORD dst_unused:UNUSED_PAD src0_sel:DWORD src1_sel:WORD_1
    s_waitcnt vmcnt(5)
    v_mfma_f32_4x4x4_16b_bf16 v[96:99], v[144:145], v[72:73], 0 cbsz:4 abid:6
    v_readlane_b32 s48, v164, 32
    v_mfma_f32_4x4x4_16b_bf16 v[100:103], v[144:145], v[74:75], 0 cbsz:4 abid:6
    v_lshlrev_b32_sdwa v139, v15, v119 dst_sel:DWORD dst_unused:UNUSED_PAD src0_sel:DWORD src1_sel:WORD_1
    ds_read_u16_d16_hi v134, v138 offset:32768
    ds_read_u16_d16_hi v135, v139 offset:32768
    s_and_b32 s33, s48, s34
    buffer_load_dwordx4 v[64:67], v1, s[12:15], s33 offen
    s_set_gpr_idx_on s57, 0xc
    v_pk_fma_f32 v[16:17], v[128:129], v[104:105], v[16:17] op_sel:[1,0,0] op_sel_hi:[1,1,1]
    v_pk_fma_f32 v[18:19], v[128:129], v[106:107], v[18:19] op_sel:[1,0,0] op_sel_hi:[1,1,1]
    v_pk_fma_f32 v[20:21], v[130:131], v[108:109], v[20:21] op_sel:[1,0,0] op_sel_hi:[1,1,1]
    v_pk_fma_f32 v[22:23], v[130:131], v[110:111], v[22:23] op_sel:[1,0,0] op_sel_hi:[1,1,1]
    s_set_gpr_idx_off
    v_mfma_f32_4x4x4_16b_bf16 v[112:115], v[172:173], v[176:177], 0 cbsz:4 abid:8
    v_lshlrev_b32_sdwa v136, v15, v120 dst_sel:DWORD dst_unused:UNUSED_PAD src0_sel:DWORD src1_sel:WORD_1
    s_waitcnt vmcnt(5)
    v_mfma_f32_4x4x4_16b_bf16 v[104:107], v[146:147], v[76:77], 0 cbsz:4 abid:6
    v_readlane_b32 s49, v164, 33
    v_mfma_f32_4x4x4_16b_bf16 v[108:111], v[146:147], v[78:79], 0 cbsz:4 abid:6
    v_lshlrev_b32_sdwa v137, v15, v121 dst_sel:DWORD dst_unused:UNUSED_PAD src0_sel:DWORD src1_sel:WORD_1
    ds_read_u16_d16_hi v128, v136 offset:32768
    ds_read_u16_d16_hi v129, v137 offset:32768
    s_and_b32 s33, s49, s34
    buffer_load_dwordx4 v[68:71], v1, s[12:15], s33 offen
    s_waitcnt lgkmcnt(2)
    s_set_gpr_idx_on s58, 0xc
    v_pk_fma_f32 v[16:17], v[132:133], v[96:97], v[16:17] op_sel:[0,0,0] op_sel_hi:[0,1,1]
    v_pk_fma_f32 v[18:19], v[132:133], v[98:99], v[18:19] op_sel:[0,0,0] op_sel_hi:[0,1,1]
    v_pk_fma_f32 v[20:21], v[134:135], v[100:101], v[20:21] op_sel:[0,0,0] op_sel_hi:[0,1,1]
    v_pk_fma_f32 v[22:23], v[134:135], v[102:103], v[22:23] op_sel:[0,0,0] op_sel_hi:[0,1,1]
    s_set_gpr_idx_off
    v_lshlrev_b32_sdwa v138, v15, v124 dst_sel:DWORD dst_unused:UNUSED_PAD src0_sel:DWORD src1_sel:WORD_1
    s_waitcnt vmcnt(5)
    v_mfma_f32_4x4x4_16b_bf16 v[96:99], v[140:141], v[80:81], 0 cbsz:4 abid:7
    v_readlane_b32 s50, v164, 34
    v_mfma_f32_4x4x4_16b_bf16 v[100:103], v[140:141], v[82:83], 0 cbsz:4 abid:7
    v_lshlrev_b32_sdwa v139, v15, v125 dst_sel:DWORD dst_unused:UNUSED_PAD src0_sel:DWORD src1_sel:WORD_1
    ds_read_u16_d16_hi v130, v138 offset:32768
    ds_read_u16_d16_hi v131, v139 offset:32768
    s_and_b32 s33, s50, s34
    buffer_load_dwordx4 v[72:75], v1, s[12:15], s33 offen
    s_set_gpr_idx_on s59, 0xc
    v_pk_fma_f32 v[16:17], v[132:133], v[104:105], v[16:17] op_sel:[1,0,0] op_sel_hi:[1,1,1]
    v_pk_fma_f32 v[18:19], v[132:133], v[106:107], v[18:19] op_sel:[1,0,0] op_sel_hi:[1,1,1]
    v_pk_fma_f32 v[20:21], v[134:135], v[108:109], v[20:21] op_sel:[1,0,0] op_sel_hi:[1,1,1]
    v_pk_fma_f32 v[22:23], v[134:135], v[110:111], v[22:23] op_sel:[1,0,0] op_sel_hi:[1,1,1]
    s_set_gpr_idx_off
A_28:
    s_sub_u32 s31, s31, 4
    s_cbranch_scc1 TO_B_28
    v_mfma_f32_4x4x4_16b_bf16 v[116:119], v[172:173], v[178:179], 0 cbsz:4 abid:8
    v_lshlrev_b32_sdwa v136, v15, v122 dst_sel:DWORD dst_unused:UNUSED_PAD src0_sel:DWORD src1_sel:WORD_1
    s_waitcnt vmcnt(5)
    v_mfma_f32_4x4x4_16b_bf16 v[104:107], v[142:143], v[84:85], 0 cbsz:4 abid:7
    v_readlane_b32 s51, v164, 35
    v_mfma_f32_4x4x4_16b_bf16 v[108:111], v[142:143], v[86:87], 0 cbsz:4 abid:7
    v_lshlrev_b32_sdwa v137, v15, v123 dst_sel:DWORD dst_unused:UNUSED_PAD src0_sel:DWORD src1_sel:WORD_1
    ds_read_u16_d16_hi v132, v136 offset:32768
    ds_read_u16_d16_hi v133, v137 offset:32768
    s_and_b32 s33, s51, s34
    buffer_load_dwordx4 v[76:79], v1, s[12:15], s33 offen
    s_waitcnt lgkmcnt(2)
    s_set_gpr_idx_on s60, 0xc
    v_pk_fma_f32 v[16:17], v[128:129], v[96:97], v[16:17] op_sel:[0,0,0] op_sel_hi:[0,1,1]
    v_pk_fma_f32 v[18:19], v[128:129], v[98:99], v[18:19] op_sel:[0,0,0] op_sel_hi:[0,1,1]
    v_pk_fma_f32 v[20:21], v[130:131], v[100:101], v[20:21] op_sel:[0,0,0] op_sel_hi:[0,1,1]
    v_pk_fma_f32 v[22:23], v[130:131], v[102:103], v[22:23] op_sel:[0,0,0] op_sel_hi:[0,1,1]
    s_set_gpr_idx_off
    v_lshlrev_b32_sdwa v138, v15, v126 dst_sel:DWORD dst_unused:UNUSED_PAD src0_sel:DWORD src1_sel:WORD_1
    s_waitcnt vmcnt(5)
    v_mfma_f32_4x4x4_16b_bf16 v[96:99], v[144:145], v[88:89], 0 cbsz:4 abid:7
    v_readlane_b32 s52, v164, 36
    v_mfma_f32_4x4x4_16b_bf16 v[100:103], v[144:145], v[90:91], 0 cbsz:4 abid:7
    v_lshlrev_b32_sdwa v139, v15, v127 dst_sel:DWORD dst_unused:UNUSED_PAD src0_sel:DWORD src1_sel:WORD_1
    ds_read_u16_d16_hi v134, v138 offset:32768
    ds_read_u16_d16_hi v135, v139 offset:32768
    s_and_b32 s33, s52, s34
    buffer_load_dwordx4 v[80:83], v1, s[12:15], s33 offen
    s_set_gpr_idx_on s61, 0xc
    v_pk_fma_f32 v[16:17], v[128:129], v[104:105], v[16:17] op_sel:[1,0,0] op_sel_hi:[1,1,1]
    v_pk_fma_f32 v[18:19], v[128:129], v[106:107], v[18:19] op_sel:[1,0,0] op_sel_hi:[1,1,1]
    v_pk_fma_f32 v[20:21], v[130:131], v[108:109], v[20:21] op_sel:[1,0,0] op_sel_hi:[1,1,1]
    v_pk_fma_f32 v[22:23], v[130:131], v[110:111], v[22:23] op_sel:[1,0,0] op_sel_hi:[1,1,1]
    s_set_gpr_idx_off
    v_mfma_f32_4x4x4_16b_bf16 v[120:123], v[172:173], v[176:177], 0 cbsz:4 abid:9
    v_lshlrev_b32_sdwa v136, v15, v112 dst_sel:DWORD dst_unused:UNUSED_PAD src0_sel:DWORD src1_sel:WORD_1
    s_waitcnt vmcnt(5)
    v_mfma_f32_4x4x4_16b_bf16 v[104:107], v[146:147], v[92:93], 0 cbsz:4 abid:7
    v_readlane_b32 s53, v164, 37
    v_mfma_f32_4x4x4_16b_bf16 v[108:111], v[146:147], v[94:95], 0 cbsz:4 abid:7
    v_lshlrev_b32_sdwa v137, v15, v113 dst_sel:DWORD dst_unused:UNUSED_PAD src0_sel:DWORD src1_sel:WORD_1
    ds_read_u16_d16_hi v128, v136 offset:32768
    ds_read_u16_d16_hi v129, v137 offset:32768
    s_and_b32 s33, s53, s34
    buffer_load_dwordx4 v[84:87], v1, s[12:15], s33 offen
    s_waitcnt lgkmcnt(2)
    s_set_gpr_idx_on s62, 0xc
    v_pk_fma_f32 v[16:17], v[132:133], v[96:97], v[16:17] op_sel:[0,0,0] op_sel_hi:[0,1,1]
    v_pk_fma_f32 v[18:19], v[132:133], v[98:99], v[18:19] op_sel:[0,0,0] op_sel_hi:[0,1,1]
    v_pk_fma_f32 v[20:21], v[134:135], v[100:101], v[20:21] op_sel:[0,0,0] op_sel_hi:[0,1,1]
    v_pk_fma_f32 v[22:23], v[134:135], v[102:103], v[22:23] op_sel:[0,0,0] op_sel_hi:[0,1,1]
    s_set_gpr_idx_off
    v_lshlrev_b32_sdwa v138, v15, v116 dst_sel:DWORD dst_unused:UNUSED_PAD src0_sel:DWORD src1_sel:WORD_1
    s_waitcnt vmcnt(5)
    v_mfma_f32_4x4x4_16b_bf16 v[96:99], v[140:141], v[64:65], 0 cbsz:4 abid:8
    v_readlane_b32 s54, v164, 38
    v_mfma_f32_4x4x4_16b_bf16 v[100:103], v[140:141], v[66:67], 0 cbsz:4 abid:8
    v_lshlrev_b32_sdwa v139, v15, v117 dst_sel:DWORD dst_unused:UNUSED_PAD src0_sel:DWORD src1_sel:WORD_1
    ds_read_u16_d16_hi v130, v138 offset:32768
    ds_read_u16_d16_hi v131, v139 offset:32768
    s_and_b32 s33, s54, s34
    buffer_load_dwordx4 v[88:91], v1, s[12:15], s33 offen
    s_set_gpr_idx_on s63, 0xc
    v_pk_fma_f32 v[16:17], v[132:133], v[104:105], v[16:17] op_sel:[1,0,0] op_sel_hi:[1,1,1]
    v_pk_fma_f32 v[18:19], v[132:133], v[106:107], v[18:19] op_sel:[1,0,0] op_sel_hi:[1,1,1]
    v_pk_fma_f32 v[20:21], v[134:135], v[108:109], v[20:21] op_sel:[1,0,0] op_sel_hi:[1,1,1]
    v_pk_fma_f32 v[22:23], v[134:135], v[110:111], v[22:23] op_sel:[1,0,0] op_sel_hi:[1,1,1]
    s_set_gpr_idx_off
A_32:
    s_sub_u32 s31, s31, 4
    s_cbranch_scc1 TO_B_32
    v_mfma_f32_4x4x4_16b_bf16 v[124:127], v[172:173], v[178:179], 0 cbsz:4 abid:9
    v_lshlrev_b32_sdwa v136, v15, v114 dst_sel:DWORD dst_unused:UNUSED_PAD src0_sel:DWORD src1_sel:WORD_1
    s_waitcnt vmcnt(5)
    v_mfma_f32_4x4x4_16b_bf16 v[104:107], v[142:143], v[68:69], 0 cbsz:4 abid:8
    v_readlane_b32 s55, v164, 39
    v_mfma_f32_4x4x4_16b_bf16 v[108:111], v[142:143], v[70:71], 0 cbsz:4 abid:8
    v_lshlrev_b32_sdwa v137, v15, v115 dst_sel:DWORD dst_unused:UNUSED_PAD src0_sel:DWORD src1_sel:WORD_1
    ds_read_u16_d16_hi v132, v136 offset:32768
    ds_read_u16_d16_hi v133, v137 offset:32768
    s_and_b32 s33, s55, s34
    buffer_load_dwordx4 v[92:95], v1, s[12:15], s33 offen
    s_waitcnt lgkmcnt(2)
    s_set_gpr_idx_on s48, 0xc
    v_pk_fma_f32 v[16:17], v[128:129], v[96:97], v[16:17] op_sel:[0,0,0] op_sel_hi:[0,1,1]
    v_pk_fma_f32 v[18:19], v[128:129], v[98:99], v[18:19] op_sel:[0,0,0] op_sel_hi:[0,1,1]
    v_pk_fma_f32 v[20:21], v[130:131], v[100:101], v[20:21] op_sel:[0,0,0] op_sel_hi:[0,1,1]
    v_pk_fma_f32 v[22:23], v[130:131], v[102:103], v[22:23] op_sel:[0,0,0] op_sel_hi:[0,1,1]
    s_set_gpr_idx_off
    v_lshlrev_b32_sdwa v138, v15, v118 dst_sel:DWORD dst_unused:UNUSED_PAD src0_sel:DWORD src1_sel:WORD_1
    s_waitcnt vmcnt(5)
    v_mfma_f32_4x4x4_16b_bf16 v[96:99], v[144:145], v[72:73], 0 cbsz:4 abid:8
    v_readlane_b32 s56, v164, 40
    v_mfma_f32_4x4x4_16b_bf16 v[100:103], v[144:145], v[74:75], 0 cbsz:4 abid:8
    v_lshlrev_b32_sdwa v139, v15, v119 dst_sel:DWORD dst_unused:UNUSED_PAD src0_sel:DWORD src1_sel:WORD_1
    ds_read_u16_d16_hi v134, v138 offset:32768
    ds_read_u16_d16_hi v135, v139 offset:32768
    s_and_b32 s33, s56, s34
    buffer_load_dwordx4 v[64:67], v1, s[12:15], s33 offen
    s_set_gpr_idx_on s49, 0xc
    v_pk_fma_f32 v[16:17], v[128:129], v[104:105], v[16:17] op_sel:[1,0,0] op_sel_hi:[1,1,1]
    v_pk_fma_f32 v[18:19], v[128:129], v[106:107], v[18:19] op_sel:[1,0,0] op_sel_hi:[1,1,1]
    v_pk_fma_f32 v[20:21], v[130:131], v[108:109], v[20:21] op_sel:[1,0,0] op_sel_hi:[1,1,1]
    v_pk_fma_f32 v[22:23], v[130:131], v[110:111], v[22:23] op_sel:[1,0,0] op_sel_hi:[1,1,1]
    s_set_gpr_idx_off
    v_mfma_f32_4x4x4_16b_bf16 v[112:115], v[172:173], v[176:177], 0 cbsz:4 abid:10
    v_lshlrev_b32_sdwa v136, v15, v120 dst_sel:DWORD dst_unused:UNUSED_PAD src0_sel:DWORD src1_sel:WORD_1
    s_waitcnt vmcnt(5)
    v_mfma_f32_4x4x4_16b_bf16 v[104:107], v[146:147], v[76:77], 0 cbsz:4 abid:8
    v_readlane_b32 s57, v164, 41
    v_mfma_f32_4x4x4_16b_bf16 v[108:111], v[146:147], v[78:79], 0 cbsz:4 abid:8
    v_lshlrev_b32_sdwa v137, v15, v121 dst_sel:DWORD dst_unused:UNUSED_PAD src0_sel:DWORD src1_sel:WORD_1
    ds_read_u16_d16_hi v128, v136 offset:32768
    ds_read_u16_d16_hi v129, v137 offset:32768
    s_and_b32 s33, s57, s34
    buffer_load_dwordx4 v[68:71], v1, s[12:15], s33 offen
    s_waitcnt lgkmcnt(2)
    s_set_gpr_idx_on s50, 0xc
    v_pk_fma_f32 v[16:17], v[132:133], v[96:97], v[16:17] op_sel:[0,0,0] op_sel_hi:[0,1,1]
    v_pk_fma_f32 v[18:19], v[132:133], v[98:99], v[18:19] op_sel:[0,0,0] op_sel_hi:[0,1,1]
    v_pk_fma_f32 v[20:21], v[134:135], v[100:101], v[20:21] op_sel:[0,0,0] op_sel_hi:[0,1,1]
    v_pk_fma_f32 v[22:23], v[134:135], v[102:103], v[22:23] op_sel:[0,0,0] op_sel_hi:[0,1,1]
    s_set_gpr_idx_off
    v_lshlrev_b32_sdwa v138, v15, v124 dst_sel:DWORD dst_unused:UNUSED_PAD src0_sel:DWORD src1_sel:WORD_1
    s_waitcnt vmcnt(5)
    v_mfma_f32_4x4x4_16b_bf16 v[96:99], v[140:141], v[80:81], 0 cbsz:4 abid:9
    v_readlane_b32 s58, v164, 42
    v_mfma_f32_4x4x4_16b_bf16 v[100:103], v[140:141], v[82:83], 0 cbsz:4 abid:9
    v_lshlrev_b32_sdwa v139, v15, v125 dst_sel:DWORD dst_unused:UNUSED_PAD src0_sel:DWORD src1_sel:WORD_1
    ds_read_u16_d16_hi v130, v138 offset:32768
    ds_read_u16_d16_hi v131, v139 offset:32768
    s_and_b32 s33, s58, s34
    buffer_load_dwordx4 v[72:75], v1, s[12:15], s33 offen
    s_set_gpr_idx_on s51, 0xc
    v_pk_fma_f32 v[16:17], v[132:133], v[104:105], v[16:17] op_sel:[1,0,0] op_sel_hi:[1,1,1]
    v_pk_fma_f32 v[18:19], v[132:133], v[106:107], v[18:19] op_sel:[1,0,0] op_sel_hi:[1,1,1]
    v_pk_fma_f32 v[20:21], v[134:135], v[108:109], v[20:21] op_sel:[1,0,0] op_sel_hi:[1,1,1]
    v_pk_fma_f32 v[22:23], v[134:135], v[110:111], v[22:23] op_sel:[1,0,0] op_sel_hi:[1,1,1]
    s_set_gpr_idx_off
A_36:
    s_sub_u32 s31, s31, 4
    s_cbranch_scc1 TO_B_36
    v_mfma_f32_4x4x4_16b_bf16 v[116:119], v[172:173], v[178:179], 0 cbsz:4 abid:10
    v_lshlrev_b32_sdwa v136, v15, v122 dst_sel:DWORD dst_unused:UNUSED_PAD src0_sel:DWORD src1_sel:WORD_1
    s_waitcnt vmcnt(5)
    v_mfma_f32_4x4x4_16b_bf16 v[104:107], v[142:143], v[84:85], 0 cbsz:4 abid:9
    v_readlane_b32 s59, v164, 43
    v_mfma_f32_4x4x4_16b_bf16 v[108:111], v[142:143], v[86:87], 0 cbsz:4 abid:9
    v_lshlrev_b32_sdwa v137, v15, v123 dst_sel:DWORD dst_unused:UNUSED_PAD src0_sel:DWORD src1_sel:WORD_1
    ds_read_u16_d16_hi v132, v136 offset:32768
    ds_read_u16_d16_hi v133, v137 offset:32768
    s_and_b32 s33, s59, s34
    buffer_load_dwordx4 v[76:79], v1, s[12:15], s33 offen
    s_waitcnt lgkmcnt(2)
    s_set_gpr_idx_on s52, 0xc
    v_pk_fma_f32 v[16:17], v[128:129], v[96:97], v[16:17] op_sel:[0,0,0] op_sel_hi:[0,1,1]
    v_pk_fma_f32 v[18:19], v[128:129], v[98:99], v[18:19] op_sel:[0,0,0] op_sel_hi:[0,1,1]
    v_pk_fma_f32 v[20:21], v[130:131], v[100:101], v[20:21] op_sel:[0,0,0] op_sel_hi:[0,1,1]
    v_pk_fma_f32 v[22:23], v[130:131], v[102:103], v[22:23] op_sel:[0,0,0] op_sel_hi:[0,1,1]
    s_set_gpr_idx_off
    v_lshlrev_b32_sdwa v138, v15, v126 dst_sel:DWORD dst_unused:UNUSED_PAD src0_sel:DWORD src1_sel:WORD_1
    s_waitcnt vmcnt(5)
    v_mfma_f32_4x4x4_16b_bf16 v[96:99], v[144:145], v[88:89], 0 cbsz:4 abid:9
    v_readlane_b32 s60, v164, 44
    v_mfma_f32_4x4x4_16b_bf16 v[100:103], v[144:145], v[90:91], 0 cbsz:4 abid:9
    v_lshlrev_b32_sdwa v139, v15, v127 dst_sel:DWORD dst_unused:UNUSED_PAD src0_sel:DWORD src1_sel:WORD_1
    ds_read_u16_d16_hi v134, v138 offset:32768
    ds_read_u16_d16_hi v135, v139 offset:32768
    s_and_b32 s33, s60, s34
    buffer_load_dwordx4 v[80:83], v1, s[12:15], s33 offen
    s_set_gpr_idx_on s53, 0xc
    v_pk_fma_f32 v[16:17], v[128:129], v[104:105], v[16:17] op_sel:[1,0,0] op_sel_hi:[1,1,1]
    v_pk_fma_f32 v[18:19], v[128:129], v[106:107], v[18:19] op_sel:[1,0,0] op_sel_hi:[1,1,1]
    v_pk_fma_f32 v[20:21], v[130:131], v[108:109], v[20:21] op_sel:[1,0,0] op_sel_hi:[1,1,1]
    v_pk_fma_f32 v[22:23], v[130:131], v[110:111], v[22:23] op_sel:[1,0,0] op_sel_hi:[1,1,1]
    s_set_gpr_idx_off
    v_mfma_f32_4x4x4_16b_bf16 v[120:123], v[172:173], v[176:177], 0 cbsz:4 abid:11
    v_lshlrev_b32_sdwa v136, v15, v112 dst_sel:DWORD dst_unused:UNUSED_PAD src0_sel:DWORD src1_sel:WORD_1
    s_waitcnt vmcnt(5)
    v_mfma_f32_4x4x4_16b_bf16 v[104:107], v[146:147], v[92:93], 0 cbsz:4 abid:9
    v_readlane_b32 s61, v164, 45
    v_mfma_f32_4x4x4_16b_bf16 v[108:111], v[146:147], v[94:95], 0 cbsz:4 abid:9
    v_lshlrev_b32_sdwa v137, v15, v113 dst_sel:DWORD dst_unused:UNUSED_PAD src0_sel:DWORD src1_sel:WORD_1
    ds_read_u16_d16_hi v128, v136 offset:32768
    ds_read_u16_d16_hi v129, v137 offset:32768
    s_and_b32 s33, s61, s34
    buffer_load_dwordx4 v[84:87], v1, s[12:15], s33 offen
    s_waitcnt lgkmcnt(2)
    s_set_gpr_idx_on s54, 0xc
    v_pk_fma_f32 v[16:17], v[132:133], v[96:97], v[16:17] op_sel:[0,0,0] op_sel_hi:[0,1,1]
    v_pk_fma_f32 v[18:19], v[132:133], v[98:99], v[18:19] op_sel:[0,0,0] op_sel_hi:[0,1,1]
    v_pk_fma_f32 v[20:21], v[134:135], v[100:101], v[20:21] op_sel:[0,0,0] op_sel_hi:[0,1,1]
    v_pk_fma_f32 v[22:23], v[134:135], v[102:103], v[22:23] op_sel:[0,0,0] op_sel_hi:[0,1,1]
    s_set_gpr_idx_off
    v_lshlrev_b32_sdwa v138, v15, v116 dst_sel:DWORD dst_unused:UNUSED_PAD src0_sel:DWORD src1_sel:WORD_1
    s_waitcnt vmcnt(5)
    v_mfma_f32_4x4x4_16b_bf16 v[96:99], v[140:141], v[64:65], 0 cbsz:4 abid:10
    v_readlane_b32 s62, v164, 46
    v_mfma_f32_4x4x4_16b_bf16 v[100:103], v[140:141], v[66:67], 0 cbsz:4 abid:10
    v_lshlrev_b32_sdwa v139, v15, v117 dst_sel:DWORD dst_unused:UNUSED_PAD src0_sel:DWORD src1_sel:WORD_1
    ds_read_u16_d16_hi v130, v138 offset:32768
    ds_read_u16_d16_hi v131, v139 offset:32768
    s_and_b32 s33, s62, s34
    buffer_load_dwordx4 v[88:91], v1, s[12:15], s33 offen
    s_set_gpr_idx_on s55, 0xc
    v_pk_fma_f32 v[16:17], v[132:133], v[104:105], v[16:17] op_sel:[1,0,0] op_sel_hi:[1,1,1]
    v_pk_fma_f32 v[18:19], v[132:133], v[106:107], v[18:19] op_sel:[1,0,0] op_sel_hi:[1,1,1]
    v_pk_fma_f32 v[20:21], v[134:135], v[108:109], v[20:21] op_sel:[1,0,0] op_sel_hi:[1,1,1]
    v_pk_fma_f32 v[22:23], v[134:135], v[110:111], v[22:23] op_sel:[1,0,0] op_sel_hi:[1,1,1]
    s_set_gpr_idx_off
A_40:
    s_sub_u32 s31, s31, 4
    s_cbranch_scc1 TO_B_40
    v_mfma_f32_4x4x4_16b_bf16 v[124:127], v[172:173], v[178:179], 0 cbsz:4 abid:11
    v_lshlrev_b32_sdwa v136, v15, v114 dst_sel:DWORD dst_unused:UNUSED_PAD src0_sel:DWORD src1_sel:WORD_1
    s_waitcnt vmcnt(5)
    v_mfma_f32_4x4x4_16b_bf16 v[104:107], v[142:143], v[68:69], 0 cbsz:4 abid:10
    v_readlane_b32 s63, v164, 47
    v_mfma_f32_4x4x4_16b_bf16 v[108:111], v[142:143], v[70:71], 0 cbsz:4 abid:10
    v_lshlrev_b32_sdwa v137, v15, v115 dst_sel:DWORD dst_unused:UNUSED_PAD src0_sel:DWORD src1_sel:WORD_1
    ds_read_u16_d16_hi v132, v136 offset:32768
    ds_read_u16_d16_hi v133, v137 offset:32768
    s_and_b32 s33, s63, s34
    buffer_load_dwordx4 v[92:95], v1, s[12:15], s33 offen
    s_waitcnt lgkmcnt(2)
    s_set_gpr_idx_on s56, 0xc
    v_pk_fma_f32 v[16:17], v[128:129], v[96:97], v[16:17] op_sel:[0,0,0] op_sel_hi:[0,1,1]
    v_pk_fma_f32 v[18:19], v[128:129], v[98:99], v[18:19] op_sel:[0,0,0] op_sel_hi:[0,1,1]
    v_pk_fma_f32 v[20:21], v[130:131], v[100:101], v[20:21] op_sel:[0,0,0] op_sel_hi:[0,1,1]
    v_pk_fma_f32 v[22:23], v[130:131], v[102:103], v[22:23] op_sel:[0,0,0] op_sel_hi:[0,1,1]
    s_set_gpr_idx_off
    v_mfma_f32_4x4x4_16b_bf16 v[148:151], v[168:169], v[180:181], 0
    v_lshlrev_b32_sdwa v138, v15, v118 dst_sel:DWORD dst_unused:UNUSED_PAD src0_sel:DWORD src1_sel:WORD_1
    s_waitcnt vmcnt(5)
    v_mfma_f32_4x4x4_16b_bf16 v[96:99], v[144:145], v[72:73], 0 cbsz:4 abid:10
    v_readlane_b32 s48, v164, 48
    v_mfma_f32_4x4x4_16b_bf16 v[100:103], v[144:145], v[74:75], 0 cbsz:4 abid:10
    v_lshlrev_b32_sdwa v139, v15, v119 dst_sel:DWORD dst_unused:UNUSED_PAD src0_sel:DWORD src1_sel:WORD_1
    ds_read_u16_d16_hi v134, v138 offset:32768
    ds_read_u16_d16_hi v135, v139 offset:32768
    s_and_b32 s33, s48, s34
    buffer_load_dwordx4 v[64:67], v1, s[12:15], s33 offen
    s_set_gpr_idx_on s57, 0xc
    v_pk_fma_f32 v[16:17], v[128:129], v[104:105], v[16:17] op_sel:[1,0,0] op_sel_hi:[1,1,1]
    v_pk_fma_f32 v[18:19], v[128:129], v[106:107], v[18:19] op_sel:[1,0,0] op_sel_hi:[1,1,1]
    v_pk_fma_f32 v[20:21], v[130:131], v[108:109], v[20:21] op_sel:[1,0,0] op_sel_hi:[1,1,1]
    v_pk_fma_f32 v[22:23], v[130:131], v[110:111], v[22:23] op_sel:[1,0,0] op_sel_hi:[1,1,1]
    s_set_gpr_idx_off
    v_mfma_f32_4x4x4_16b_bf16 v[112:115], v[172:173], v[176:177], 0 cbsz:4 abid:12
    v_lshlrev_b32_sdwa v136, v15, v120 dst_sel:DWORD dst_unused:UNUSED_PAD src0_sel:DWORD src1_sel:WORD_1
    s_waitcnt vmcnt(5)
    v_mfma_f32_4x4x4_16b_bf16 v[104:107], v[146:147], v[76:77], 0 cbsz:4 abid:10
    v_readlane_b32 s49, v164, 49
    v_mfma_f32_4x4x4_16b_bf16 v[108:111], v[146:147], v[78:79], 0 cbsz:4 abid:10
    v_lshlrev_b32_sdwa v137, v15, v121 dst_sel:DWORD dst_unused:UNUSED_PAD src0_sel:DWORD src1_sel:WORD_1
    ds_read_u16_d16_hi v128, v136 offset:32768
    ds_read_u16_d16_hi v129, v137 offset:32768
    s_and_b32 s33, s49, s34
    buffer_load_dwordx4 v[68:71], v1, s[12:15], s33 offen
    s_waitcnt lgkmcnt(2)
    s_set_gpr_idx_on s58, 0xc
    v_pk_fma_f32 v[16:17], v[132:133], v[96:97], v[16:17] op_sel:[0,0,0] op_sel_hi:[0,1,1]
    v_pk_fma_f32 v[18:19], v[132:133], v[98:99], v[18:19] op_sel:[0,0,0] op_sel_hi:[0,1,1]
    v_pk_fma_f32 v[20:21], v[134:135], v[100:101], v[20:21] op_sel:[0,0,0] op_sel_hi:[0,1,1]
    v_pk_fma_f32 v[22:23], v[134:135], v[102:103], v[22:23] op_sel:[0,0,0] op_sel_hi:[0,1,1]
    s_set_gpr_idx_off
    v_mfma_f32_4x4x4_16b_bf16 v[152:155], v[168:169], v[182:183], 0
    v_lshlrev_b32_sdwa v138, v15, v124 dst_sel:DWORD dst_unused:UNUSED_PAD src0_sel:DWORD src1_sel:WORD_1
    s_waitcnt vmcnt(5)
    v_mfma_f32_4x4x4_16b_bf16 v[96:99], v[140:141], v[80:81], 0 cbsz:4 abid:11
    v_readlane_b32 s50, v164, 50
    v_mfma_f32_4x4x4_16b_bf16 v[100:103], v[140:141], v[82:83], 0 cbsz:4 abid:11
    v_lshlrev_b32_sdwa v139, v15, v125 dst_sel:DWORD dst_unused:UNUSED_PAD src0_sel:DWORD src1_sel:WORD_1
    ds_read_u16_d16_hi v130, v138 offset:32768
    ds_read_u16_d16_hi v131, v139 offset:32768
    s_and_b32 s33, s50, s34
    buffer_load_dwordx4 v[72:75], v1, s[12:15], s33 offen
    s_set_gpr_idx_on s59, 0xc
    v_pk_fma_f32 v[16:17], v[132:133], v[104:105], v[16:17] op_sel:[1,0,0] op_sel_hi:[1,1,1]
    v_pk_fma_f32 v[18:19], v[132:133], v[106:107], v[18:19] op_sel:[1,0,0] op_sel_hi:[1,1,1]
    v_pk_fma_f32 v[20:21], v[134:135], v[108:109], v[20:21] op_sel:[1,0,0] op_sel_hi:[1,1,1]
    v_pk_fma_f32 v[22:23], v[134:135], v[110:111], v[22:23] op_sel:[1,0,0] op_sel_hi:[1,1,1]
    s_set_gpr_idx_off
A_44:
    s_sub_u32 s31, s31, 4
    s_cbranch_scc1 TO_B_44
    v_mfma_f32_4x4x4_16b_bf16 v[116:119], v[172:173], v[178:179], 0 cbsz:4 abid:12
    v_lshlrev_b32_sdwa v136, v15, v122 dst_sel:DWORD dst_unused:UNUSED_PAD src0_sel:DWORD src1_sel:WORD_1
    s_waitcnt vmcnt(5)
    v_mfma_f32_4x4x4_16b_bf16 v[104:107], v[142:143], v[84:85], 0 cbsz:4 abid:11
    v_readlane_b32 s51, v164, 51
    v_mfma_f32_4x4x4_16b_bf16 v[108:111], v[142:143], v[86:87], 0 cbsz:4 abid:11
    v_lshlrev_b32_sdwa v137, v15, v123 dst_sel:DWORD dst_unused:UNUSED_PAD src0_sel:DWORD src1_sel:WORD_1
    ds_read_u16_d16_hi v132, v136 offset:32768
    ds_read_u16_d16_hi v133, v137 offset:32768
    s_and_b32 s33, s51, s34
    buffer_load_dwordx4 v[76:79], v1, s[12:15], s33 offen
    s_waitcnt lgkmcnt(2)
    s_set_gpr_idx_on s60, 0xc
    v_pk_fma_f32 v[16:17], v[128:129], v[96:97], v[16:17] op_sel:[0,0,0] op_sel_hi:[0,1,1]
    v_pk_fma_f32 v[18:19], v[128:129], v[98:99], v[18:19] op_sel:[0,0,0] op_sel_hi:[0,1,1]
    v_pk_fma_f32 v[20:21], v[130:131], v[100:101], v[20:21] op_sel:[0,0,0] op_sel_hi:[0,1,1]
    v_pk_fma_f32 v[22:23], v[130:131], v[102:103], v[22:23] op_sel:[0,0,0] op_sel_hi:[0,1,1]
    s_set_gpr_idx_off
    v_mfma_f32_4x4x4_16b_bf16 v[156:159], v[168:169], v[184:185], 0
    v_lshlrev_b32_sdwa v138, v15, v126 dst_sel:DWORD dst_unused:UNUSED_PAD src0_sel:DWORD src1_sel:WORD_1
    s_waitcnt vmcnt(5)
    v_mfma_f32_4x4x4_16b_bf16 v[96:99], v[144:145], v[88:89], 0 cbsz:4 abid:11
    v_readlane_b32 s52, v164, 52
    v_mfma_f32_4x4x4_16b_bf16 v[100:103], v[144:145], v[90:91], 0 cbsz:4 abid:11
    v_lshlrev_b32_sdwa v139, v15, v127 dst_sel:DWORD dst_unused:UNUSED_PAD src0_sel:DWORD src1_sel:WORD_1
    ds_read_u16_d16_hi v134, v138 offset:32768
    ds_read_u16_d16_hi v135, v139 offset:32768
    s_and_b32 s33, s52, s34
    buffer_load_dwordx4 v[80:83], v1, s[12:15], s33 offen
    s_set_gpr_idx_on s61, 0xc
    v_pk_fma_f32 v[16:17], v[128:129], v[104:105], v[16:17] op_sel:[1,0,0] op_sel_hi:[1,1,1]
    v_pk_fma_f32 v[18:19], v[128:129], v[106:107], v[18:19] op_sel:[1,0,0] op_sel_hi:[1,1,1]
    v_pk_fma_f32 v[20:21], v[130:131], v[108:109], v[20:21] op_sel:[1,0,0] op_sel_hi:[1,1,1]
    v_pk_fma_f32 v[22:23], v[130:131], v[110:111], v[22:23] op_sel:[1,0,0] op_sel_hi:[1,1,1]
    s_set_gpr_idx_off
    v_mfma_f32_4x4x4_16b_bf16 v[120:123], v[172:173], v[176:177], 0 cbsz:4 abid:13
    v_lshlrev_b32_sdwa v136, v15, v112 dst_sel:DWORD dst_unused:UNUSED_PAD src0_sel:DWORD src1_sel:WORD_1
    s_waitcnt vmcnt(5)
    v_mfma_f32_4x4x4_16b_bf16 v[104:107], v[146:147], v[92:93], 0 cbsz:4 abid:11
    v_readlane_b32 s53, v164, 53
    v_mfma_f32_4x4x4_16b_bf16 v[108:111], v[146:147], v[94:95], 0 cbsz:4 abid:11
    v_lshlrev_b32_sdwa v137, v15, v113 dst_sel:DWORD dst_unused:UNUSED_PAD src0_sel:DWORD src1_sel:WORD_1
    ds_read_u16_d16_hi v128, v136 offset:32768
    ds_read_u16_d16_hi v129, v137 offset:32768
    s_and_b32 s33, s53, s34
    buffer_load_dwordx4 v[84:87], v1, s[12:15], s33 offen
    s_waitcnt lgkmcnt(2)
    s_set_gpr_idx_on s62, 0xc
    v_pk_fma_f32 v[16:17], v[132:133], v[96:97], v[16:17] op_sel:[0,0,0] op_sel_hi:[0,1,1]
    v_pk_fma_f32 v[18:19], v[132:133], v[98:99], v[18:19] op_sel:[0,0,0] op_sel_hi:[0,1,1]
    v_pk_fma_f32 v[20:21], v[134:135], v[100:101], v[20:21] op_sel:[0,0,0] op_sel_hi:[0,1,1]
    v_pk_fma_f32 v[22:23], v[134:135], v[102:103], v[22:23] op_sel:[0,0,0] op_sel_hi:[0,1,1]
    s_set_gpr_idx_off
    v_mfma_f32_4x4x4_16b_bf16 v[160:163], v[168:169], v[186:187], 0
    v_lshlrev_b32_sdwa v138, v15, v116 dst_sel:DWORD dst_unused:UNUSED_PAD src0_sel:DWORD src1_sel:WORD_1
    s_waitcnt vmcnt(5)
    v_mfma_f32_4x4x4_16b_bf16 v[96:99], v[140:141], v[64:65], 0 cbsz:4 abid:12
    v_readlane_b32 s54, v164, 54
    v_mfma_f32_4x4x4_16b_bf16 v[100:103], v[140:141], v[66:67], 0 cbsz:4 abid:12
    v_lshlrev_b32_sdwa v139, v15, v117 dst_sel:DWORD dst_unused:UNUSED_PAD src0_sel:DWORD src1_sel:WORD_1
    ds_read_u16_d16_hi v130, v138 offset:32768
    ds_read_u16_d16_hi v131, v139 offset:32768
    s_and_b32 s33, s54, s34
    buffer_load_dwordx4 v[88:91], v1, s[12:15], s33 offen
    s_set_gpr_idx_on s63, 0xc
    v_pk_fma_f32 v[16:17], v[132:133], v[104:105], v[16:17] op_sel:[1,0,0] op_sel_hi:[1,1,1]
    v_pk_fma_f32 v[18:19], v[132:133], v[106:107], v[18:19] op_sel:[1,0,0] op_sel_hi:[1,1,1]
    v_pk_fma_f32 v[20:21], v[134:135], v[108:109], v[20:21] op_sel:[1,0,0] op_sel_hi:[1,1,1]
    v_pk_fma_f32 v[22:23], v[134:135], v[110:111], v[22:23] op_sel:[1,0,0] op_sel_hi:[1,1,1]
    s_set_gpr_idx_off
A_48:
    s_sub_u32 s31, s31, 4
    s_cbranch_scc1 TO_B_48
    v_mfma_f32_4x4x4_16b_bf16 v[124:127], v[172:173], v[178:179], 0 cbsz:4 abid:13
    v_lshlrev_b32_sdwa v136, v15, v114 dst_sel:DWORD dst_unused:UNUSED_PAD src0_sel:DWORD src1_sel:WORD_1
    s_waitcnt vmcnt(5)
    v_mfma_f32_4x4x4_16b_bf16 v[104:107], v[142:143], v[68:69], 0 cbsz:4 abid:12
    v_readlane_b32 s55, v164, 55
    v_mfma_f32_4x4x4_16b_bf16 v[108:111], v[142:143], v[70:71], 0 cbsz:4 abid:12
    v_lshlrev_b32_sdwa v137, v15, v115 dst_sel:DWORD dst_unused:UNUSED_PAD src0_sel:DWORD src1_sel:WORD_1
    ds_read_u16_d16_hi v132, v136 offset:32768
    ds_read_u16_d16_hi v133, v137 offset:32768
    s_and_b32 s33, s55, s34
    buffer_load_dwordx4 v[92:95], v1, s[12:15], s33 offen
    s_waitcnt lgkmcnt(2)
    s_set_gpr_idx_on s48, 0xc
    v_pk_fma_f32 v[16:17], v[128:129], v[96:97], v[16:17] op_sel:[0,0,0] op_sel_hi:[0,1,1]
    v_pk_fma_f32 v[18:19], v[128:129], v[98:99], v[18:19] op_sel:[0,0,0] op_sel_hi:[0,1,1]
    v_pk_fma_f32 v[20:21], v[130:131], v[100:101], v[20:21] op_sel:[0,0,0] op_sel_hi:[0,1,1]
    v_pk_fma_f32 v[22:23], v[130:131], v[102:103], v[22:23] op_sel:[0,0,0] op_sel_hi:[0,1,1]
    s_set_gpr_idx_off
    v_lshlrev_b32_sdwa v138, v15, v118 dst_sel:DWORD dst_unused:UNUSED_PAD src0_sel:DWORD src1_sel:WORD_1
    s_waitcnt vmcnt(5)
    v_mfma_f32_4x4x4_16b_bf16 v[96:99], v[144:145], v[72:73], 0 cbsz:4 abid:12
    v_readlane_b32 s56, v164, 56
    v_mfma_f32_4x4x4_16b_bf16 v[100:103], v[144:145], v[74:75], 0 cbsz:4 abid:12
    v_lshlrev_b32_sdwa v139, v15, v119 dst_sel:DWORD dst_unused:UNUSED_PAD src0_sel:DWORD src1_sel:WORD_1
    ds_read_u16_d16_hi v134, v138 offset:32768
    ds_read_u16_d16_hi v135, v139 offset:32768
    s_and_b32 s33, s56, s34
    buffer_load_dwordx4 v[64:67], v1, s[12:15], s33 offen
    s_set_gpr_idx_on s49, 0xc
    v_pk_fma_f32 v[16:17], v[128:129], v[104:105], v[16:17] op_sel:[1,0,0] op_sel_hi:[1,1,1]
    v_pk_fma_f32 v[18:19], v[128:129], v[106:107], v[18:19] op_sel:[1,0,0] op_sel_hi:[1,1,1]
    v_pk_fma_f32 v[20:21], v[130:131], v[108:109], v[20:21] op_sel:[1,0,0] op_sel_hi:[1,1,1]
    v_pk_fma_f32 v[22:23], v[130:131], v[110:111], v[22:23] op_sel:[1,0,0] op_sel_hi:[1,1,1]
    s_set_gpr_idx_off
    v_mfma_f32_4x4x4_16b_bf16 v[112:115], v[172:173], v[176:177], 0 cbsz:4 abid:14
    v_lshlrev_b32_sdwa v136, v15, v120 dst_sel:DWORD dst_unused:UNUSED_PAD src0_sel:DWORD src1_sel:WORD_1
    s_waitcnt vmcnt(5)
    v_mfma_f32_4x4x4_16b_bf16 v[104:107], v[146:147], v[76:77], 0 cbsz:4 abid:12
    v_readlane_b32 s57, v164, 57
    v_mfma_f32_4x4x4_16b_bf16 v[108:111], v[146:147], v[78:79], 0 cbsz:4 abid:12
    v_lshlrev_b32_sdwa v137, v15, v121 dst_sel:DWORD dst_unused:UNUSED_PAD src0_sel:DWORD src1_sel:WORD_1
    ds_read_u16_d16_hi v128, v136 offset:32768
    ds_read_u16_d16_hi v129, v137 offset:32768
    s_and_b32 s33, s57, s34
    buffer_load_dwordx4 v[68:71], v1, s[12:15], s33 offen
    s_waitcnt lgkmcnt(2)
    s_set_gpr_idx_on s50, 0xc
    v_pk_fma_f32 v[16:17], v[132:133], v[96:97], v[16:17] op_sel:[0,0,0] op_sel_hi:[0,1,1]
    v_pk_fma_f32 v[18:19], v[132:133], v[98:99], v[18:19] op_sel:[0,0,0] op_sel_hi:[0,1,1]
    v_pk_fma_f32 v[20:21], v[134:135], v[100:101], v[20:21] op_sel:[0,0,0] op_sel_hi:[0,1,1]
    v_pk_fma_f32 v[22:23], v[134:135], v[102:103], v[22:23] op_sel:[0,0,0] op_sel_hi:[0,1,1]
    s_set_gpr_idx_off
    v_lshlrev_b32_sdwa v138, v15, v124 dst_sel:DWORD dst_unused:UNUSED_PAD src0_sel:DWORD src1_sel:WORD_1
    s_waitcnt vmcnt(5)
    v_mfma_f32_4x4x4_16b_bf16 v[96:99], v[140:141], v[80:81], 0 cbsz:4 abid:13
    v_readlane_b32 s58, v164, 58
    v_mfma_f32_4x4x4_16b_bf16 v[100:103], v[140:141], v[82:83], 0 cbsz:4 abid:13
    v_lshlrev_b32_sdwa v139, v15, v125 dst_sel:DWORD dst_unused:UNUSED_PAD src0_sel:DWORD src1_sel:WORD_1
    ds_read_u16_d16_hi v130, v138 offset:32768
    ds_read_u16_d16_hi v131, v139 offset:32768
    s_and_b32 s33, s58, s34
    buffer_load_dwordx4 v[72:75], v1, s[12:15], s33 offen
    s_set_gpr_idx_on s51, 0xc
    v_pk_fma_f32 v[16:17], v[132:133], v[104:105], v[16:17] op_sel:[1,0,0] op_sel_hi:[1,1,1]
    v_pk_fma_f32 v[18:19], v[132:133], v[106:107], v[18:19] op_sel:[1,0,0] op_sel_hi:[1,1,1]
    v_pk_fma_f32 v[20:21], v[134:135], v[108:109], v[20:21] op_sel:[1,0,0] op_sel_hi:[1,1,1]
    v_pk_fma_f32 v[22:23], v[134:135], v[110:111], v[22:23] op_sel:[1,0,0] op_sel_hi:[1,1,1]
    s_set_gpr_idx_off
A_52:
    s_sub_u32 s31, s31, 4
    s_cbranch_scc1 TO_B_52
    v_mfma_f32_4x4x4_16b_bf16 v[116:119], v[172:173], v[178:179], 0 cbsz:4 abid:14
    v_lshlrev_b32_sdwa v136, v15, v122 dst_sel:DWORD dst_unused:UNUSED_PAD src0_sel:DWORD src1_sel:WORD_1
    s_waitcnt vmcnt(5)
    v_mfma_f32_4x4x4_16b_bf16 v[104:107], v[142:143], v[84:85], 0 cbsz:4 abid:13
    v_readlane_b32 s59, v164, 59
    v_mfma_f32_4x4x4_16b_bf16 v[108:111], v[142:143], v[86:87], 0 cbsz:4 abid:13
    v_lshlrev_b32_sdwa v137, v15, v123 dst_sel:DWORD dst_unused:UNUSED_PAD src0_sel:DWORD src1_sel:WORD_1
    ds_read_u16_d16_hi v132, v136 offset:32768
    ds_read_u16_d16_hi v133, v137 offset:32768
    s_and_b32 s33, s59, s34
    buffer_load_dwordx4 v[76:79], v1, s[12:15], s33 offen
    s_waitcnt lgkmcnt(2)
    s_set_gpr_idx_on s52, 0xc
    v_pk_fma_f32 v[16:17], v[128:129], v[96:97], v[16:17] op_sel:[0,0,0] op_sel_hi:[0,1,1]
    v_pk_fma_f32 v[18:19], v[128:129], v[98:99], v[18:19] op_sel:[0,0,0] op_sel_hi:[0,1,1]
    v_pk_fma_f32 v[20:21], v[130:131], v[100:101], v[20:21] op_sel:[0,0,0] op_sel_hi:[0,1,1]
    v_pk_fma_f32 v[22:23], v[130:131], v[102:103], v[22:23] op_sel:[0,0,0] op_sel_hi:[0,1,1]
    s_set_gpr_idx_off
    v_lshlrev_b32_sdwa v138, v15, v126 dst_sel:DWORD dst_unused:UNUSED_PAD src0_sel:DWORD src1_sel:WORD_1
    s_waitcnt vmcnt(5)
    v_mfma_f32_4x4x4_16b_bf16 v[96:99], v[144:145], v[88:89], 0 cbsz:4 abid:13
    v_readlane_b32 s60, v164, 60
    v_mfma_f32_4x4x4_16b_bf16 v[100:103], v[144:145], v[90:91], 0 cbsz:4 abid:13
    v_lshlrev_b32_sdwa v139, v15, v127 dst_sel:DWORD dst_unused:UNUSED_PAD src0_sel:DWORD src1_sel:WORD_1
    ds_read_u16_d16_hi v134, v138 offset:32768
    ds_read_u16_d16_hi v135, v139 offset:32768
    s_and_b32 s33, s60, s34
    buffer_load_dwordx4 v[80:83], v1, s[12:15], s33 offen
    s_set_gpr_idx_on s53, 0xc
    v_pk_fma_f32 v[16:17], v[128:129], v[104:105], v[16:17] op_sel:[1,0,0] op_sel_hi:[1,1,1]
    v_pk_fma_f32 v[18:19], v[128:129], v[106:107], v[18:19] op_sel:[1,0,0] op_sel_hi:[1,1,1]
    v_pk_fma_f32 v[20:21], v[130:131], v[108:109], v[20:21] op_sel:[1,0,0] op_sel_hi:[1,1,1]
    v_pk_fma_f32 v[22:23], v[130:131], v[110:111], v[22:23] op_sel:[1,0,0] op_sel_hi:[1,1,1]
    s_set_gpr_idx_off
    v_mfma_f32_4x4x4_16b_bf16 v[120:123], v[172:173], v[176:177], 0 cbsz:4 abid:15
    v_lshlrev_b32_sdwa v136, v15, v112 dst_sel:DWORD dst_unused:UNUSED_PAD src0_sel:DWORD src1_sel:WORD_1
    s_waitcnt vmcnt(5)
    v_mfma_f32_4x4x4_16b_bf16 v[104:107], v[146:147], v[92:93], 0 cbsz:4 abid:13
    v_readlane_b32 s61, v164, 61
    v_mfma_f32_4x4x4_16b_bf16 v[108:111], v[146:147], v[94:95], 0 cbsz:4 abid:13
    v_lshlrev_b32_sdwa v137, v15, v113 dst_sel:DWORD dst_unused:UNUSED_PAD src0_sel:DWORD src1_sel:WORD_1
    ds_read_u16_d16_hi v128, v136 offset:32768
    ds_read_u16_d16_hi v129, v137 offset:32768
    s_and_b32 s33, s61, s34
    buffer_load_dwordx4 v[84:87], v1, s[12:15], s33 offen
    s_waitcnt lgkmcnt(2)
    s_set_gpr_idx_on s54, 0xc
    v_pk_fma_f32 v[16:17], v[132:133], v[96:97], v[16:17] op_sel:[0,0,0] op_sel_hi:[0,1,1]
    v_pk_fma_f32 v[18:19], v[132:133], v[98:99], v[18:19] op_sel:[0,0,0] op_sel_hi:[0,1,1]
    v_pk_fma_f32 v[20:21], v[134:135], v[100:101], v[20:21] op_sel:[0,0,0] op_sel_hi:[0,1,1]
    v_pk_fma_f32 v[22:23], v[134:135], v[102:103], v[22:23] op_sel:[0,0,0] op_sel_hi:[0,1,1]
    s_set_gpr_idx_off
    v_lshlrev_b32_sdwa v138, v15, v116 dst_sel:DWORD dst_unused:UNUSED_PAD src0_sel:DWORD src1_sel:WORD_1
    s_waitcnt vmcnt(5)
    v_mfma_f32_4x4x4_16b_bf16 v[96:99], v[140:141], v[64:65], 0 cbsz:4 abid:14
    v_readlane_b32 s62, v164, 62
    v_mfma_f32_4x4x4_16b_bf16 v[100:103], v[140:141], v[66:67], 0 cbsz:4 abid:14
    v_lshlrev_b32_sdwa v139, v15, v117 dst_sel:DWORD dst_unused:UNUSED_PAD src0_sel:DWORD src1_sel:WORD_1
    ds_read_u16_d16_hi v130, v138 offset:32768
    ds_read_u16_d16_hi v131, v139 offset:32768
    s_and_b32 s33, s62, s34
    buffer_load_dwordx4 v[88:91], v1, s[12:15], s33 offen
    s_set_gpr_idx_on s55, 0xc
    v_pk_fma_f32 v[16:17], v[132:133], v[104:105], v[16:17] op_sel:[1,0,0] op_sel_hi:[1,1,1]
    v_pk_fma_f32 v[18:19], v[132:133], v[106:107], v[18:19] op_sel:[1,0,0] op_sel_hi:[1,1,1]
    v_pk_fma_f32 v[20:21], v[134:135], v[108:109], v[20:21] op_sel:[1,0,0] op_sel_hi:[1,1,1]
    v_pk_fma_f32 v[22:23], v[134:135], v[110:111], v[22:23] op_sel:[1,0,0] op_sel_hi:[1,1,1]
    s_set_gpr_idx_off
A_56:
    s_sub_u32 s31, s31, 4
    s_cbranch_scc1 TO_B_56
    v_mfma_f32_4x4x4_16b_bf16 v[124:127], v[172:173], v[178:179], 0 cbsz:4 abid:15
    v_lshlrev_b32_sdwa v136, v15, v114 dst_sel:DWORD dst_unused:UNUSED_PAD src0_sel:DWORD src1_sel:WORD_1
    s_waitcnt vmcnt(5)
    v_mfma_f32_4x4x4_16b_bf16 v[104:107], v[142:143], v[68:69], 0 cbsz:4 abid:14
    v_readlane_b32 s63, v164, 63
    v_mfma_f32_4x4x4_16b_bf16 v[108:111], v[142:143], v[70:71], 0 cbsz:4 abid:14
    v_lshlrev_b32_sdwa v137, v15, v115 dst_sel:DWORD dst_unused:UNUSED_PAD src0_sel:DWORD src1_sel:WORD_1
    ds_read_u16_d16_hi v132, v136 offset:32768
    ds_read_u16_d16_hi v133, v137 offset:32768
    s_and_b32 s33, s63, s34
    buffer_load_dwordx4 v[92:95], v1, s[12:15], s33 offen
    s_waitcnt lgkmcnt(2)
    s_set_gpr_idx_on s56, 0xc
    v_pk_fma_f32 v[16:17], v[128:129], v[96:97], v[16:17] op_sel:[0,0,0] op_sel_hi:[0,1,1]
    v_pk_fma_f32 v[18:19], v[128:129], v[98:99], v[18:19] op_sel:[0,0,0] op_sel_hi:[0,1,1]
    v_pk_fma_f32 v[20:21], v[130:131], v[100:101], v[20:21] op_sel:[0,0,0] op_sel_hi:[0,1,1]
    v_pk_fma_f32 v[22:23], v[130:131], v[102:103], v[22:23] op_sel:[0,0,0] op_sel_hi:[0,1,1]
    s_set_gpr_idx_off
    v_lshlrev_b32_sdwa v138, v15, v118 dst_sel:DWORD dst_unused:UNUSED_PAD src0_sel:DWORD src1_sel:WORD_1
    s_waitcnt vmcnt(5)
    v_mfma_f32_4x4x4_16b_bf16 v[96:99], v[144:145], v[72:73], 0 cbsz:4 abid:14
    v_readlane_b32 s48, v165, 0
    v_mfma_f32_4x4x4_16b_bf16 v[100:103], v[144:145], v[74:75], 0 cbsz:4 abid:14
    v_lshlrev_b32_sdwa v139, v15, v119 dst_sel:DWORD dst_unused:UNUSED_PAD src0_sel:DWORD src1_sel:WORD_1
    ds_read_u16_d16_hi v134, v138 offset:32768
    ds_read_u16_d16_hi v135, v139 offset:32768
    s_and_b32 s33, s48, s34
    buffer_load_dwordx4 v[64:67], v1, s[12:15], s33 offen
    s_set_gpr_idx_on s57, 0xc
    v_pk_fma_f32 v[16:17], v[128:129], v[104:105], v[16:17] op_sel:[1,0,0] op_sel_hi:[1,1,1]
    v_pk_fma_f32 v[18:19], v[128:129], v[106:107], v[18:19] op_sel:[1,0,0] op_sel_hi:[1,1,1]
    v_pk_fma_f32 v[20:21], v[130:131], v[108:109], v[20:21] op_sel:[1,0,0] op_sel_hi:[1,1,1]
    v_pk_fma_f32 v[22:23], v[130:131], v[110:111], v[22:23] op_sel:[1,0,0] op_sel_hi:[1,1,1]
    s_set_gpr_idx_off
    v_mov_b32 v172, v170
    v_mov_b32 v173, v171
    s_nop 1
    v_mfma_f32_4x4x4_16b_bf16 v[112:115], v[172:173], v[176:177], 0 cbsz:4 abid:0
    v_lshlrev_b32_sdwa v136, v15, v120 dst_sel:DWORD dst_unused:UNUSED_PAD src0_sel:DWORD src1_sel:WORD_1
    s_waitcnt vmcnt(5)
    v_mfma_f32_4x4x4_16b_bf16 v[104:107], v[146:147], v[76:77], 0 cbsz:4 abid:14
    v_readlane_b32 s49, v165, 1
    v_mfma_f32_4x4x4_16b_bf16 v[108:111], v[146:147], v[78:79], 0 cbsz:4 abid:14
    v_lshlrev_b32_sdwa v137, v15, v121 dst_sel:DWORD dst_unused:UNUSED_PAD src0_sel:DWORD src1_sel:WORD_1
    ds_read_u16_d16_hi v128, v136 offset:32768
    ds_read_u16_d16_hi v129, v137 offset:32768
    s_and_b32 s33, s49, s34
    buffer_load_dwordx4 v[68:71], v1, s[12:15], s33 offen
    s_waitcnt lgkmcnt(2)
    s_set_gpr_idx_on s58, 0xc
    v_pk_fma_f32 v[16:17], v[132:133], v[96:97], v[16:17] op_sel:[0,0,0] op_sel_hi:[0,1,1]
    v_pk_fma_f32 v[18:19], v[132:133], v[98:99], v[18:19] op_sel:[0,0,0] op_sel_hi:[0,1,1]
    v_pk_fma_f32 v[20:21], v[134:135], v[100:101], v[20:21] op_sel:[0,0,0] op_sel_hi:[0,1,1]
    v_pk_fma_f32 v[22:23], v[134:135], v[102:103], v[22:23] op_sel:[0,0,0] op_sel_hi:[0,1,1]
    s_set_gpr_idx_off
    v_lshlrev_b32_sdwa v138, v15, v124 dst_sel:DWORD dst_unused:UNUSED_PAD src0_sel:DWORD src1_sel:WORD_1
    s_waitcnt vmcnt(5)
    v_mfma_f32_4x4x4_16b_bf16 v[96:99], v[140:141], v[80:81], 0 cbsz:4 abid:15
    v_readlane_b32 s50, v165, 2
    v_mfma_f32_4x4x4_16b_bf16 v[100:103], v[140:141], v[82:83], 0 cbsz:4 abid:15
    v_lshlrev_b32_sdwa v139, v15, v125 dst_sel:DWORD dst_unused:UNUSED_PAD src0_sel:DWORD src1_sel:WORD_1
    ds_read_u16_d16_hi v130, v138 offset:32768
    ds_read_u16_d16_hi v131, v139 offset:32768
    s_and_b32 s33, s50, s34
    buffer_load_dwordx4 v[72:75], v1, s[12:15], s33 offen
    s_set_gpr_idx_on s59, 0xc
    v_pk_fma_f32 v[16:17], v[132:133], v[104:105], v[16:17] op_sel:[1,0,0] op_sel_hi:[1,1,1]
    v_pk_fma_f32 v[18:19], v[132:133], v[106:107], v[18:19] op_sel:[1,0,0] op_sel_hi:[1,1,1]
    v_pk_fma_f32 v[20:21], v[134:135], v[108:109], v[20:21] op_sel:[1,0,0] op_sel_hi:[1,1,1]
    v_pk_fma_f32 v[22:23], v[134:135], v[110:111], v[22:23] op_sel:[1,0,0] op_sel_hi:[1,1,1]
    s_set_gpr_idx_off
A_60:
    s_sub_u32 s31, s31, 4
    s_cbranch_scc1 TO_B_60
    v_mfma_f32_4x4x4_16b_bf16 v[116:119], v[172:173], v[178:179], 0 cbsz:4 abid:0
    v_lshlrev_b32_sdwa v136, v15, v122 dst_sel:DWORD dst_unused:UNUSED_PAD src0_sel:DWORD src1_sel:WORD_1
    s_waitcnt vmcnt(5)
    v_mfma_f32_4x4x4_16b_bf16 v[104:107], v[142:143], v[84:85], 0 cbsz:4 abid:15
    v_readlane_b32 s51, v165, 3
    v_mfma_f32_4x4x4_16b_bf16 v[108:111], v[142:143], v[86:87], 0 cbsz:4 abid:15
    v_lshlrev_b32_sdwa v137, v15, v123 dst_sel:DWORD dst_unused:UNUSED_PAD src0_sel:DWORD src1_sel:WORD_1
    ds_read_u16_d16_hi v132, v136 offset:32768
    ds_read_u16_d16_hi v133, v137 offset:32768
    v_cvt_pk_bf16_f32 v140, v148, v152
    v_cvt_pk_bf16_f32 v141, v156, v160
    s_and_b32 s33, s51, s34
    buffer_load_dwordx4 v[76:79], v1, s[12:15], s33 offen
    s_waitcnt lgkmcnt(2)
    s_set_gpr_idx_on s60, 0xc
    v_pk_fma_f32 v[16:17], v[128:129], v[96:97], v[16:17] op_sel:[0,0,0] op_sel_hi:[0,1,1]
    v_pk_fma_f32 v[18:19], v[128:129], v[98:99], v[18:19] op_sel:[0,0,0] op_sel_hi:[0,1,1]
    v_pk_fma_f32 v[20:21], v[130:131], v[100:101], v[20:21] op_sel:[0,0,0] op_sel_hi:[0,1,1]
    v_pk_fma_f32 v[22:23], v[130:131], v[102:103], v[22:23] op_sel:[0,0,0] op_sel_hi:[0,1,1]
    s_set_gpr_idx_off
    v_lshlrev_b32_sdwa v138, v15, v126 dst_sel:DWORD dst_unused:UNUSED_PAD src0_sel:DWORD src1_sel:WORD_1
    s_waitcnt vmcnt(5)
    v_mfma_f32_4x4x4_16b_bf16 v[96:99], v[144:145], v[88:89], 0 cbsz:4 abid:15
    v_readlane_b32 s52, v165, 4
    v_mfma_f32_4x4x4_16b_bf16 v[100:103], v[144:145], v[90:91], 0 cbsz:4 abid:15
    v_lshlrev_b32_sdwa v139, v15, v127 dst_sel:DWORD dst_unused:UNUSED_PAD src0_sel:DWORD src1_sel:WORD_1
    ds_read_u16_d16_hi v134, v138 offset:32768
    ds_read_u16_d16_hi v135, v139 offset:32768
    v_cvt_pk_bf16_f32 v142, v149, v153
    v_cvt_pk_bf16_f32 v143, v157, v161
    s_and_b32 s33, s52, s34
    buffer_load_dwordx4 v[80:83], v1, s[12:15], s33 offen
    s_set_gpr_idx_on s61, 0xc
    v_pk_fma_f32 v[16:17], v[128:129], v[104:105], v[16:17] op_sel:[1,0,0] op_sel_hi:[1,1,1]
    v_pk_fma_f32 v[18:19], v[128:129], v[106:107], v[18:19] op_sel:[1,0,0] op_sel_hi:[1,1,1]
    v_pk_fma_f32 v[20:21], v[130:131], v[108:109], v[20:21] op_sel:[1,0,0] op_sel_hi:[1,1,1]
    v_pk_fma_f32 v[22:23], v[130:131], v[110:111], v[22:23] op_sel:[1,0,0] op_sel_hi:[1,1,1]
    s_set_gpr_idx_off
    v_mfma_f32_4x4x4_16b_bf16 v[120:123], v[172:173], v[176:177], 0 cbsz:4 abid:1
    v_lshlrev_b32_sdwa v136, v15, v112 dst_sel:DWORD dst_unused:UNUSED_PAD src0_sel:DWORD src1_sel:WORD_1
    s_waitcnt vmcnt(5)
    v_mfma_f32_4x4x4_16b_bf16 v[104:107], v[146:147], v[92:93], 0 cbsz:4 abid:15
    v_readlane_b32 s53, v165, 5
    v_mfma_f32_4x4x4_16b_bf16 v[108:111], v[146:147], v[94:95], 0 cbsz:4 abid:15
    v_lshlrev_b32_sdwa v137, v15, v113 dst_sel:DWORD dst_unused:UNUSED_PAD src0_sel:DWORD src1_sel:WORD_1
    ds_read_u16_d16_hi v128, v136 offset:32768
    ds_read_u16_d16_hi v129, v137 offset:32768
    v_cvt_pk_bf16_f32 v144, v150, v154
    v_cvt_pk_bf16_f32 v145, v158, v162
    s_and_b32 s33, s53, s34
    buffer_load_dwordx4 v[84:87], v1, s[12:15], s33 offen
    s_waitcnt lgkmcnt(2)
    s_set_gpr_idx_on s62, 0xc
    v_pk_fma_f32 v[16:17], v[132:133], v[96:97], v[16:17] op_sel:[0,0,0] op_sel_hi:[0,1,1]
    v_pk_fma_f32 v[18:19], v[132:133], v[98:99], v[18:19] op_sel:[0,0,0] op_sel_hi:[0,1,1]
    v_pk_fma_f32 v[20:21], v[134:135], v[100:101], v[20:21] op_sel:[0,0,0] op_sel_hi:[0,1,1]
    v_pk_fma_f32 v[22:23], v[134:135], v[102:103], v[22:23] op_sel:[0,0,0] op_sel_hi:[0,1,1]
    s_set_gpr_idx_off
    v_lshlrev_b32_sdwa v138, v15, v116 dst_sel:DWORD dst_unused:UNUSED_PAD src0_sel:DWORD src1_sel:WORD_1
    s_waitcnt vmcnt(5)
    v_mfma_f32_4x4x4_16b_bf16 v[96:99], v[140:141], v[64:65], 0 cbsz:4 abid:0
    v_readlane_b32 s54, v165, 6
    v_mfma_f32_4x4x4_16b_bf16 v[100:103], v[140:141], v[66:67], 0 cbsz:4 abid:0
    v_lshlrev_b32_sdwa v139, v15, v117 dst_sel:DWORD dst_unused:UNUSED_PAD src0_sel:DWORD src1_sel:WORD_1
    ds_read_u16_d16_hi v130, v138 offset:32768
    ds_read_u16_d16_hi v131, v139 offset:32768
    v_cvt_pk_bf16_f32 v146, v151, v155
    v_cvt_pk_bf16_f32 v147, v159, v163
    s_and_b32 s33, s54, s34
    buffer_load_dwordx4 v[88:91], v1, s[12:15], s33 offen
    s_set_gpr_idx_on s63, 0xc
    v_pk_fma_f32 v[16:17], v[132:133], v[104:105], v[16:17] op_sel:[1,0,0] op_sel_hi:[1,1,1]
    v_pk_fma_f32 v[18:19], v[132:133], v[106:107], v[18:19] op_sel:[1,0,0] op_sel_hi:[1,1,1]
    v_pk_fma_f32 v[20:21], v[134:135], v[108:109], v[20:21] op_sel:[1,0,0] op_sel_hi:[1,1,1]
    v_pk_fma_f32 v[22:23], v[134:135], v[110:111], v[22:23] op_sel:[1,0,0] op_sel_hi:[1,1,1]
    s_set_gpr_idx_off
    v_mov_b32 v164, v165
    s_branch A_0
TO_B_0:
    buffer_load_dwordx4 v[188:191], v1, s[16:19], s10 offen offset:0 sc1
    buffer_load_dwordx4 v[192:195], v1, s[16:19], s10 offen offset:1024 sc1
    buffer_load_dwordx4 v[196:199], v1, s[16:19], s10 offen offset:2048 sc1
    buffer_load_dwordx4 v[200:203], v1, s[16:19], s10 offen offset:3072 sc1
    buffer_load_dwordx4 v[204:207], v1, s[16:19], s11 offen offset:0 sc1
    buffer_load_dwordx4 v[208:211], v1, s[16:19], s11 offen offset:1024 sc1
    buffer_load_dwordx4 v[212:215], v1, s[16:19], s11 offen offset:2048 sc1
    buffer_load_dwordx4 v[216:219], v1, s[16:19], s11 offen offset:3072 sc1
    s_branch B_0
TO_B_4:
    buffer_load_dwordx4 v[188:191], v1, s[16:19], s10 offen offset:0 sc1
    buffer_load_dwordx4 v[192:195], v1, s[16:19], s10 offen offset:1024 sc1
    buffer_load_dwordx4 v[196:199], v1, s[16:19], s10 offen offset:2048 sc1
    buffer_load_dwordx4 v[200:203], v1, s[16:19], s10 offen offset:3072 sc1
    buffer_load_dwordx4 v[204:207], v1, s[16:19], s11 offen offset:0 sc1
    buffer_load_dwordx4 v[208:211], v1, s[16:19], s11 offen offset:1024 sc1
    buffer_load_dwordx4 v[212:215], v1, s[16:19], s11 offen offset:2048 sc1
    buffer_load_dwordx4 v[216:219], v1, s[16:19], s11 offen offset:3072 sc1
    s_branch B_4
TO_B_8:
    buffer_load_dwordx4 v[188:191], v1, s[16:19], s10 offen offset:0 sc1
    buffer_load_dwordx4 v[192:195], v1, s[16:19], s10 offen offset:1024 sc1
    buffer_load_dwordx4 v[196:199], v1, s[16:19], s10 offen offset:2048 sc1
    buffer_load_dwordx4 v[200:203], v1, s[16:19], s10 offen offset:3072 sc1
    buffer_load_dwordx4 v[204:207], v1, s[16:19], s11 offen offset:0 sc1
    buffer_load_dwordx4 v[208:211], v1, s[16:19], s11 offen offset:1024 sc1
    buffer_load_dwordx4 v[212:215], v1, s[16:19], s11 offen offset:2048 sc1
    buffer_load_dwordx4 v[216:219], v1, s[16:19], s11 offen offset:3072 sc1
    s_branch B_8
TO_B_12:
    buffer_load_dwordx4 v[188:191], v1, s[16:19], s10 offen offset:0 sc1
    buffer_load_dwordx4 v[192:195], v1, s[16:19], s10 offen offset:1024 sc1
    buffer_load_dwordx4 v[196:199], v1, s[16:19], s10 offen offset:2048 sc1
    buffer_load_dwordx4 v[200:203], v1, s[16:19], s10 offen offset:3072 sc1
    buffer_load_dwordx4 v[204:207], v1, s[16:19], s11 offen offset:0 sc1
    buffer_load_dwordx4 v[208:211], v1, s[16:19], s11 offen offset:1024 sc1
    buffer_load_dwordx4 v[212:215], v1, s[16:19], s11 offen offset:2048 sc1
    buffer_load_dwordx4 v[216:219], v1, s[16:19], s11 offen offset:3072 sc1
    s_branch B_12
TO_B_16:
    buffer_load_dwordx4 v[188:191], v1, s[16:19], s10 offen offset:0 sc1
    buffer_load_dwordx4 v[192:195], v1, s[16:19], s10 offen offset:1024 sc1
    buffer_load_dwordx4 v[196:199], v1, s[16:19], s10 offen offset:2048 sc1
    buffer_load_dwordx4 v[200:203], v1, s[16:19], s10 offen offset:3072 sc1
    buffer_load_dwordx4 v[204:207], v1, s[16:19], s11 offen offset:0 sc1
    buffer_load_dwordx4 v[208:211], v1, s[16:19], s11 offen offset:1024 sc1
    buffer_load_dwordx4 v[212:215], v1, s[16:19], s11 offen offset:2048 sc1
    buffer_load_dwordx4 v[216:219], v1, s[16:19], s11 offen offset:3072 sc1
    s_branch B_16
TO_B_20:
    buffer_load_dwordx4 v[188:191], v1, s[16:19], s10 offen offset:0 sc1
    buffer_load_dwordx4 v[192:195], v1, s[16:19], s10 offen offset:1024 sc1
    buffer_load_dwordx4 v[196:199], v1, s[16:19], s10 offen offset:2048 sc1
    buffer_load_dwordx4 v[200:203], v1, s[16:19], s10 offen offset:3072 sc1
    buffer_load_dwordx4 v[204:207], v1, s[16:19], s11 offen offset:0 sc1
    buffer_load_dwordx4 v[208:211], v1, s[16:19], s11 offen offset:1024 sc1
    buffer_load_dwordx4 v[212:215], v1, s[16:19], s11 offen offset:2048 sc1
    buffer_load_dwordx4 v[216:219], v1, s[16:19], s11 offen offset:3072 sc1
    s_branch B_20
TO_B_24:
    buffer_load_dwordx4 v[188:191], v1, s[16:19], s10 offen offset:0 sc1
    buffer_load_dwordx4 v[192:195], v1, s[16:19], s10 offen offset:1024 sc1
    buffer_load_dwordx4 v[196:199], v1, s[16:19], s10 offen offset:2048 sc1
    buffer_load_dwordx4 v[200:203], v1, s[16:19], s10 offen offset:3072 sc1
    buffer_load_dwordx4 v[204:207], v1, s[16:19], s11 offen offset:0 sc1
    buffer_load_dwordx4 v[208:211], v1, s[16:19], s11 offen offset:1024 sc1
    buffer_load_dwordx4 v[212:215], v1, s[16:19], s11 offen offset:2048 sc1
    buffer_load_dwordx4 v[216:219], v1, s[16:19], s11 offen offset:3072 sc1
    s_branch B_24
TO_B_28:
    buffer_load_dwordx4 v[188:191], v1, s[16:19], s10 offen offset:0 sc1
    buffer_load_dwordx4 v[192:195], v1, s[16:19], s10 offen offset:1024 sc1
    buffer_load_dwordx4 v[196:199], v1, s[16:19], s10 offen offset:2048 sc1
    buffer_load_dwordx4 v[200:203], v1, s[16:19], s10 offen offset:3072 sc1
    buffer_load_dwordx4 v[204:207], v1, s[16:19], s11 offen offset:0 sc1
    buffer_load_dwordx4 v[208:211], v1, s[16:19], s11 offen offset:1024 sc1
    buffer_load_dwordx4 v[212:215], v1, s[16:19], s11 offen offset:2048 sc1
    buffer_load_dwordx4 v[216:219], v1, s[16:19], s11 offen offset:3072 sc1
    s_branch B_28
TO_B_32:
    buffer_load_dwordx4 v[188:191], v1, s[16:19], s10 offen offset:0 sc1
    buffer_load_dwordx4 v[192:195], v1, s[16:19], s10 offen offset:1024 sc1
    buffer_load_dwordx4 v[196:199], v1, s[16:19], s10 offen offset:2048 sc1
    buffer_load_dwordx4 v[200:203], v1, s[16:19], s10 offen offset:3072 sc1
    buffer_load_dwordx4 v[204:207], v1, s[16:19], s11 offen offset:0 sc1
    buffer_load_dwordx4 v[208:211], v1, s[16:19], s11 offen offset:1024 sc1
    buffer_load_dwordx4 v[212:215], v1, s[16:19], s11 offen offset:2048 sc1
    buffer_load_dwordx4 v[216:219], v1, s[16:19], s11 offen offset:3072 sc1
    s_branch B_32
TO_B_36:
    buffer_load_dwordx4 v[188:191], v1, s[16:19], s10 offen offset:0 sc1
    buffer_load_dwordx4 v[192:195], v1, s[16:19], s10 offen offset:1024 sc1
    buffer_load_dwordx4 v[196:199], v1, s[16:19], s10 offen offset:2048 sc1
    buffer_load_dwordx4 v[200:203], v1, s[16:19], s10 offen offset:3072 sc1
    buffer_load_dwordx4 v[204:207], v1, s[16:19], s11 offen offset:0 sc1
    buffer_load_dwordx4 v[208:211], v1, s[16:19], s11 offen offset:1024 sc1
    buffer_load_dwordx4 v[212:215], v1, s[16:19], s11 offen offset:2048 sc1
    buffer_load_dwordx4 v[216:219], v1, s[16:19], s11 offen offset:3072 sc1
    s_branch B_36
TO_B_40:
    buffer_load_dwordx4 v[188:191], v1, s[16:19], s10 offen offset:0 sc1
    buffer_load_dwordx4 v[192:195], v1, s[16:19], s10 offen offset:1024 sc1
    buffer_load_dwordx4 v[196:199], v1, s[16:19], s10 offen offset:2048 sc1
    buffer_load_dwordx4 v[200:203], v1, s[16:19], s10 offen offset:3072 sc1
    buffer_load_dwordx4 v[204:207], v1, s[16:19], s11 offen offset:0 sc1
    buffer_load_dwordx4 v[208:211], v1, s[16:19], s11 offen offset:1024 sc1
    buffer_load_dwordx4 v[212:215], v1, s[16:19], s11 offen offset:2048 sc1
    buffer_load_dwordx4 v[216:219], v1, s[16:19], s11 offen offset:3072 sc1
    s_branch B_40
TO_B_44:
    buffer_load_dwordx4 v[188:191], v1, s[16:19], s10 offen offset:0 sc1
    buffer_load_dwordx4 v[192:195], v1, s[16:19], s10 offen offset:1024 sc1
    buffer_load_dwordx4 v[196:199], v1, s[16:19], s10 offen offset:2048 sc1
    buffer_load_dwordx4 v[200:203], v1, s[16:19], s10 offen offset:3072 sc1
    buffer_load_dwordx4 v[204:207], v1, s[16:19], s11 offen offset:0 sc1
    buffer_load_dwordx4 v[208:211], v1, s[16:19], s11 offen offset:1024 sc1
    buffer_load_dwordx4 v[212:215], v1, s[16:19], s11 offen offset:2048 sc1
    buffer_load_dwordx4 v[216:219], v1, s[16:19], s11 offen offset:3072 sc1
    s_branch B_44
TO_B_48:
    buffer_load_dwordx4 v[188:191], v1, s[16:19], s10 offen offset:0 sc1
    buffer_load_dwordx4 v[192:195], v1, s[16:19], s10 offen offset:1024 sc1
    buffer_load_dwordx4 v[196:199], v1, s[16:19], s10 offen offset:2048 sc1
    buffer_load_dwordx4 v[200:203], v1, s[16:19], s10 offen offset:3072 sc1
    buffer_load_dwordx4 v[204:207], v1, s[16:19], s11 offen offset:0 sc1
    buffer_load_dwordx4 v[208:211], v1, s[16:19], s11 offen offset:1024 sc1
    buffer_load_dwordx4 v[212:215], v1, s[16:19], s11 offen offset:2048 sc1
    buffer_load_dwordx4 v[216:219], v1, s[16:19], s11 offen offset:3072 sc1
    s_branch B_48
TO_B_52:
    buffer_load_dwordx4 v[188:191], v1, s[16:19], s10 offen offset:0 sc1
    buffer_load_dwordx4 v[192:195], v1, s[16:19], s10 offen offset:1024 sc1
    buffer_load_dwordx4 v[196:199], v1, s[16:19], s10 offen offset:2048 sc1
    buffer_load_dwordx4 v[200:203], v1, s[16:19], s10 offen offset:3072 sc1
    buffer_load_dwordx4 v[204:207], v1, s[16:19], s11 offen offset:0 sc1
    buffer_load_dwordx4 v[208:211], v1, s[16:19], s11 offen offset:1024 sc1
    buffer_load_dwordx4 v[212:215], v1, s[16:19], s11 offen offset:2048 sc1
    buffer_load_dwordx4 v[216:219], v1, s[16:19], s11 offen offset:3072 sc1
    s_branch B_52
TO_B_56:
    buffer_load_dwordx4 v[188:191], v1, s[16:19], s10 offen offset:0 sc1
    buffer_load_dwordx4 v[192:195], v1, s[16:19], s10 offen offset:1024 sc1
    buffer_load_dwordx4 v[196:199], v1, s[16:19], s10 offen offset:2048 sc1
    buffer_load_dwordx4 v[200:203], v1, s[16:19], s10 offen offset:3072 sc1
    buffer_load_dwordx4 v[204:207], v1, s[16:19], s11 offen offset:0 sc1
    buffer_load_dwordx4 v[208:211], v1, s[16:19], s11 offen offset:1024 sc1
    buffer_load_dwordx4 v[212:215], v1, s[16:19], s11 offen offset:2048 sc1
    buffer_load_dwordx4 v[216:219], v1, s[16:19], s11 offen offset:3072 sc1
    s_branch B_56
TO_B_60:
    buffer_load_dwordx4 v[188:191], v1, s[16:19], s10 offen offset:0 sc1
    buffer_load_dwordx4 v[192:195], v1, s[16:19], s10 offen offset:1024 sc1
    buffer_load_dwordx4 v[196:199], v1, s[16:19], s10 offen offset:2048 sc1
    buffer_load_dwordx4 v[200:203], v1, s[16:19], s10 offen offset:3072 sc1
    buffer_load_dwordx4 v[204:207], v1, s[16:19], s11 offen offset:0 sc1
    buffer_load_dwordx4 v[208:211], v1, s[16:19], s11 offen offset:1024 sc1
    buffer_load_dwordx4 v[212:215], v1, s[16:19], s11 offen offset:2048 sc1
    buffer_load_dwordx4 v[216:219], v1, s[16:19], s11 offen offset:3072 sc1
    s_branch B_60
B_0:
    s_sub_u32 s32, s32, 4
    s_cbranch_scc1 MAIN_DONE
    v_mfma_f32_4x4x4_16b_bf16 v[124:127], v[172:173], v[178:179], 0 cbsz:4 abid:1
    v_lshlrev_b32_sdwa v136, v15, v114 dst_sel:DWORD dst_unused:UNUSED_PAD src0_sel:DWORD src1_sel:WORD_1
    s_waitcnt vmcnt(13)
    v_mfma_f32_4x4x4_16b_bf16 v[104:107], v[142:143], v[68:69], 0 cbsz:4 abid:0
    s_nop 0
    v_mfma_f32_4x4x4_16b_bf16 v[108:111], v[142:143], v[70:71], 0 cbsz:4 abid:0
    v_lshlrev_b32_sdwa v137, v15, v115 dst_sel:DWORD dst_unused:UNUSED_PAD src0_sel:DWORD src1_sel:WORD_1
    ds_read_u16_d16_hi v132, v136 offset:32768
    ds_read_u16_d16_hi v133, v137 offset:32768
    s_waitcnt lgkmcnt(2)
    s_set_gpr_idx_on s48, 0xc
    v_pk_fma_f32 v[16:17], v[128:129], v[96:97], v[16:17] op_sel:[0,0,0] op_sel_hi:[0,1,1]
    v_pk_fma_f32 v[18:19], v[128:129], v[98:99], v[18:19] op_sel:[0,0,0] op_sel_hi:[0,1,1]
    v_pk_fma_f32 v[20:21], v[130:131], v[100:101], v[20:21] op_sel:[0,0,0] op_sel_hi:[0,1,1]
    v_pk_fma_f32 v[22:23], v[130:131], v[102:103], v[22:23] op_sel:[0,0,0] op_sel_hi:[0,1,1]
    s_set_gpr_idx_off
    v_lshlrev_b32_sdwa v138, v15, v118 dst_sel:DWORD dst_unused:UNUSED_PAD src0_sel:DWORD src1_sel:WORD_1
    s_waitcnt vmcnt(12)
    v_mfma_f32_4x4x4_16b_bf16 v[96:99], v[144:145], v[72:73], 0 cbsz:4 abid:0
    s_nop 0
    v_mfma_f32_4x4x4_16b_bf16 v[100:103], v[144:145], v[74:75], 0 cbsz:4 abid:0
    v_lshlrev_b32_sdwa v139, v15, v119 dst_sel:DWORD dst_unused:UNUSED_PAD src0_sel:DWORD src1_sel:WORD_1
    ds_read_u16_d16_hi v134, v138 offset:32768
    ds_read_u16_d16_hi v135, v139 offset:32768
    s_set_gpr_idx_on s49, 0xc
    v_pk_fma_f32 v[16:17], v[128:129], v[104:105], v[16:17] op_sel:[1,0,0] op_sel_hi:[1,1,1]
    v_pk_fma_f32 v[18:19], v[128:129], v[106:107], v[18:19] op_sel:[1,0,0] op_sel_hi:[1,1,1]
    v_pk_fma_f32 v[20:21], v[130:131], v[108:109], v[20:21] op_sel:[1,0,0] op_sel_hi:[1,1,1]
    v_pk_fma_f32 v[22:23], v[130:131], v[110:111], v[22:23] op_sel:[1,0,0] op_sel_hi:[1,1,1]
    s_set_gpr_idx_off
    v_mfma_f32_4x4x4_16b_bf16 v[112:115], v[172:173], v[176:177], 0 cbsz:4 abid:2
    v_lshlrev_b32_sdwa v136, v15, v120 dst_sel:DWORD dst_unused:UNUSED_PAD src0_sel:DWORD src1_sel:WORD_1
    s_waitcnt vmcnt(11)
    v_mfma_f32_4x4x4_16b_bf16 v[104:107], v[146:147], v[76:77], 0 cbsz:4 abid:0
    s_nop 0
    v_mfma_f32_4x4x4_16b_bf16 v[108:111], v[146:147], v[78:79], 0 cbsz:4 abid:0
    v_lshlrev_b32_sdwa v137, v15, v121 dst_sel:DWORD dst_unused:UNUSED_PAD src0_sel:DWORD src1_sel:WORD_1
    ds_read_u16_d16_hi v128, v136 offset:32768
    ds_read_u16_d16_hi v129, v137 offset:32768
    s_waitcnt lgkmcnt(2)
    s_set_gpr_idx_on s50, 0xc
    v_pk_fma_f32 v[16:17], v[132:133], v[96:97], v[16:17] op_sel:[0,0,0] op_sel_hi:[0,1,1]
    v_pk_fma_f32 v[18:19], v[132:133], v[98:99], v[18:19] op_sel:[0,0,0] op_sel_hi:[0,1,1]
    v_pk_fma_f32 v[20:21], v[134:135], v[100:101], v[20:21] op_sel:[0,0,0] op_sel_hi:[0,1,1]
    v_pk_fma_f32 v[22:23], v[134:135], v[102:103], v[22:23] op_sel:[0,0,0] op_sel_hi:[0,1,1]
    s_set_gpr_idx_off
    v_lshlrev_b32_sdwa v138, v15, v124 dst_sel:DWORD dst_unused:UNUSED_PAD src0_sel:DWORD src1_sel:WORD_1
    s_waitcnt vmcnt(10)
    v_mfma_f32_4x4x4_16b_bf16 v[96:99], v[140:141], v[80:81], 0 cbsz:4 abid:1
    s_nop 0
    v_mfma_f32_4x4x4_16b_bf16 v[100:103], v[140:141], v[82:83], 0 cbsz:4 abid:1
    v_lshlrev_b32_sdwa v139, v15, v125 dst_sel:DWORD dst_unused:UNUSED_PAD src0_sel:DWORD src1_sel:WORD_1
    ds_read_u16_d16_hi v130, v138 offset:32768
    ds_read_u16_d16_hi v131, v139 offset:32768
    s_set_gpr_idx_on s51, 0xc
    v_pk_fma_f32 v[16:17], v[132:133], v[104:105], v[16:17] op_sel:[1,0,0] op_sel_hi:[1,1,1]
    v_pk_fma_f32 v[18:19], v[132:133], v[106:107], v[18:19] op_sel:[1,0,0] op_sel_hi:[1,1,1]
    v_pk_fma_f32 v[20:21], v[134:135], v[108:109], v[20:21] op_sel:[1,0,0] op_sel_hi:[1,1,1]
    v_pk_fma_f32 v[22:23], v[134:135], v[110:111], v[22:23] op_sel:[1,0,0] op_sel_hi:[1,1,1]
    s_set_gpr_idx_off
B_4:
    s_sub_u32 s32, s32, 4
    s_cbranch_scc1 MAIN_DONE
    v_mfma_f32_4x4x4_16b_bf16 v[116:119], v[172:173], v[178:179], 0 cbsz:4 abid:2
    v_lshlrev_b32_sdwa v136, v15, v122 dst_sel:DWORD dst_unused:UNUSED_PAD src0_sel:DWORD src1_sel:WORD_1
    s_waitcnt vmcnt(13)
    v_mfma_f32_4x4x4_16b_bf16 v[104:107], v[142:143], v[84:85], 0 cbsz:4 abid:1
    s_nop 0
    v_mfma_f32_4x4x4_16b_bf16 v[108:111], v[142:143], v[86:87], 0 cbsz:4 abid:1
    v_lshlrev_b32_sdwa v137, v15, v123 dst_sel:DWORD dst_unused:UNUSED_PAD src0_sel:DWORD src1_sel:WORD_1
    ds_read_u16_d16_hi v132, v136 offset:32768
    ds_read_u16_d16_hi v133, v137 offset:32768
    s_waitcnt lgkmcnt(2)
    s_set_gpr_idx_on s52, 0xc
    v_pk_fma_f32 v[16:17], v[128:129], v[96:97], v[16:17] op_sel:[0,0,0] op_sel_hi:[0,1,1]
    v_pk_fma_f32 v[18:19], v[128:129], v[98:99], v[18:19] op_sel:[0,0,0] op_sel_hi:[0,1,1]
    v_pk_fma_f32 v[20:21], v[130:131], v[100:101], v[20:21] op_sel:[0,0,0] op_sel_hi:[0,1,1]
    v_pk_fma_f32 v[22:23], v[130:131], v[102:103], v[22:23] op_sel:[0,0,0] op_sel_hi:[0,1,1]
    s_set_gpr_idx_off
    v_lshlrev_b32_sdwa v138, v15, v126 dst_sel:DWORD dst_unused:UNUSED_PAD src0_sel:DWORD src1_sel:WORD_1
    s_waitcnt vmcnt(12)
    v_mfma_f32_4x4x4_16b_bf16 v[96:99], v[144:145], v[88:89], 0 cbsz:4 abid:1
    s_nop 0
    v_mfma_f32_4x4x4_16b_bf16 v[100:103], v[144:145], v[90:91], 0 cbsz:4 abid:1
    v_lshlrev_b32_sdwa v139, v15, v127 dst_sel:DWORD dst_unused:UNUSED_PAD src0_sel:DWORD src1_sel:WORD_1
    ds_read_u16_d16_hi v134, v138 offset:32768
    ds_read_u16_d16_hi v135, v139 offset:32768
    s_set_gpr_idx_on s53, 0xc
    v_pk_fma_f32 v[16:17], v[128:129], v[104:105], v[16:17] op_sel:[1,0,0] op_sel_hi:[1,1,1]
    v_pk_fma_f32 v[18:19], v[128:129], v[106:107], v[18:19] op_sel:[1,0,0] op_sel_hi:[1,1,1]
    v_pk_fma_f32 v[20:21], v[130:131], v[108:109], v[20:21] op_sel:[1,0,0] op_sel_hi:[1,1,1]
    v_pk_fma_f32 v[22:23], v[130:131], v[110:111], v[22:23] op_sel:[1,0,0] op_sel_hi:[1,1,1]
    s_set_gpr_idx_off
    v_mfma_f32_4x4x4_16b_bf16 v[120:123], v[172:173], v[176:177], 0 cbsz:4 abid:3
    v_lshlrev_b32_sdwa v136, v15, v112 dst_sel:DWORD dst_unused:UNUSED_PAD src0_sel:DWORD src1_sel:WORD_1
    s_waitcnt vmcnt(11)
    v_mfma_f32_4x4x4_16b_bf16 v[104:107], v[146:147], v[92:93], 0 cbsz:4 abid:1
    s_nop 0
    v_mfma_f32_4x4x4_16b_bf16 v[108:111], v[146:147], v[94:95], 0 cbsz:4 abid:1
    v_lshlrev_b32_sdwa v137, v15, v113 dst_sel:DWORD dst_unused:UNUSED_PAD src0_sel:DWORD src1_sel:WORD_1
    ds_read_u16_d16_hi v128, v136 offset:32768
    ds_read_u16_d16_hi v129, v137 offset:32768
    s_waitcnt lgkmcnt(2)
    s_set_gpr_idx_on s54, 0xc
    v_pk_fma_f32 v[16:17], v[132:133], v[96:97], v[16:17] op_sel:[0,0,0] op_sel_hi:[0,1,1]
    v_pk_fma_f32 v[18:19], v[132:133], v[98:99], v[18:19] op_sel:[0,0,0] op_sel_hi:[0,1,1]
    v_pk_fma_f32 v[20:21], v[134:135], v[100:101], v[20:21] op_sel:[0,0,0] op_sel_hi:[0,1,1]
    v_pk_fma_f32 v[22:23], v[134:135], v[102:103], v[22:23] op_sel:[0,0,0] op_sel_hi:[0,1,1]
    s_set_gpr_idx_off
    v_lshlrev_b32_sdwa v138, v15, v116 dst_sel:DWORD dst_unused:UNUSED_PAD src0_sel:DWORD src1_sel:WORD_1
    s_waitcnt vmcnt(10)
    v_mfma_f32_4x4x4_16b_bf16 v[96:99], v[140:141], v[64:65], 0 cbsz:4 abid:2
    s_nop 0
    v_mfma_f32_4x4x4_16b_bf16 v[100:103], v[140:141], v[66:67], 0 cbsz:4 abid:2
    v_lshlrev_b32_sdwa v139, v15, v117 dst_sel:DWORD dst_unused:UNUSED_PAD src0_sel:DWORD src1_sel:WORD_1
    ds_read_u16_d16_hi v130, v138 offset:32768
    ds_read_u16_d16_hi v131, v139 offset:32768
    s_set_gpr_idx_on s55, 0xc
    v_pk_fma_f32 v[16:17], v[132:133], v[104:105], v[16:17] op_sel:[1,0,0] op_sel_hi:[1,1,1]
    v_pk_fma_f32 v[18:19], v[132:133], v[106:107], v[18:19] op_sel:[1,0,0] op_sel_hi:[1,1,1]
    v_pk_fma_f32 v[20:21], v[134:135], v[108:109], v[20:21] op_sel:[1,0,0] op_sel_hi:[1,1,1]
    v_pk_fma_f32 v[22:23], v[134:135], v[110:111], v[22:23] op_sel:[1,0,0] op_sel_hi:[1,1,1]
    s_set_gpr_idx_off
B_8:
    s_sub_u32 s32, s32, 4
    s_cbranch_scc1 MAIN_DONE
    v_mfma_f32_4x4x4_16b_bf16 v[124:127], v[172:173], v[178:179], 0 cbsz:4 abid:3
    v_lshlrev_b32_sdwa v136, v15, v114 dst_sel:DWORD dst_unused:UNUSED_PAD src0_sel:DWORD src1_sel:WORD_1
    s_waitcnt vmcnt(13)
    v_mfma_f32_4x4x4_16b_bf16 v[104:107], v[142:143], v[68:69], 0 cbsz:4 abid:2
    s_nop 0
    v_mfma_f32_4x4x4_16b_bf16 v[108:111], v[142:143], v[70:71], 0 cbsz:4 abid:2
    v_lshlrev_b32_sdwa v137, v15, v115 dst_sel:DWORD dst_unused:UNUSED_PAD src0_sel:DWORD src1_sel:WORD_1
    ds_read_u16_d16_hi v132, v136 offset:32768
    ds_read_u16_d16_hi v133, v137 offset:32768
    s_waitcnt lgkmcnt(2)
    s_set_gpr_idx_on s56, 0xc
    v_pk_fma_f32 v[16:17], v[128:129], v[96:97], v[16:17] op_sel:[0,0,0] op_sel_hi:[0,1,1]
    v_pk_fma_f32 v[18:19], v[128:129], v[98:99], v[18:19] op_sel:[0,0,0] op_sel_hi:[0,1,1]
    v_pk_fma_f32 v[20:21], v[130:131], v[100:101], v[20:21] op_sel:[0,0,0] op_sel_hi:[0,1,1]
    v_pk_fma_f32 v[22:23], v[130:131], v[102:103], v[22:23] op_sel:[0,0,0] op_sel_hi:[0,1,1]
    s_set_gpr_idx_off
    ds_read_b32 v165, v5
    v_lshlrev_b32_sdwa v138, v15, v118 dst_sel:DWORD dst_unused:UNUSED_PAD src0_sel:DWORD src1_sel:WORD_1
    s_waitcnt vmcnt(12)
    v_mfma_f32_4x4x4_16b_bf16 v[96:99], v[144:145], v[72:73], 0 cbsz:4 abid:2
    s_nop 0
    v_mfma_f32_4x4x4_16b_bf16 v[100:103], v[144:145], v[74:75], 0 cbsz:4 abid:2
    v_lshlrev_b32_sdwa v139, v15, v119 dst_sel:DWORD dst_unused:UNUSED_PAD src0_sel:DWORD src1_sel:WORD_1
    ds_read_u16_d16_hi v134, v138 offset:32768
    ds_read_u16_d16_hi v135, v139 offset:32768
    s_set_gpr_idx_on s57, 0xc
    v_pk_fma_f32 v[16:17], v[128:129], v[104:105], v[16:17] op_sel:[1,0,0] op_sel_hi:[1,1,1]
    v_pk_fma_f32 v[18:19], v[128:129], v[106:107], v[18:19] op_sel:[1,0,0] op_sel_hi:[1,1,1]
    v_pk_fma_f32 v[20:21], v[130:131], v[108:109], v[20:21] op_sel:[1,0,0] op_sel_hi:[1,1,1]
    v_pk_fma_f32 v[22:23], v[130:131], v[110:111], v[22:23] op_sel:[1,0,0] op_sel_hi:[1,1,1]
    s_set_gpr_idx_off
    v_mfma_f32_4x4x4_16b_bf16 v[112:115], v[172:173], v[176:177], 0 cbsz:4 abid:4
    v_lshlrev_b32_sdwa v136, v15, v120 dst_sel:DWORD dst_unused:UNUSED_PAD src0_sel:DWORD src1_sel:WORD_1
    s_waitcnt vmcnt(11)
    v_mfma_f32_4x4x4_16b_bf16 v[104:107], v[146:147], v[76:77], 0 cbsz:4 abid:2
    s_nop 0
    v_mfma_f32_4x4x4_16b_bf16 v[108:111], v[146:147], v[78:79], 0 cbsz:4 abid:2
    v_lshlrev_b32_sdwa v137, v15, v121 dst_sel:DWORD dst_unused:UNUSED_PAD src0_sel:DWORD src1_sel:WORD_1
    ds_read_u16_d16_hi v128, v136 offset:32768
    ds_read_u16_d16_hi v129, v137 offset:32768
    s_waitcnt lgkmcnt(2)
    s_set_gpr_idx_on s58, 0xc
    v_pk_fma_f32 v[16:17], v[132:133], v[96:97], v[16:17] op_sel:[0,0,0] op_sel_hi:[0,1,1]
    v_pk_fma_f32 v[18:19], v[132:133], v[98:99], v[18:19] op_sel:[0,0,0] op_sel_hi:[0,1,1]
    v_pk_fma_f32 v[20:21], v[134:135], v[100:101], v[20:21] op_sel:[0,0,0] op_sel_hi:[0,1,1]
    v_pk_fma_f32 v[22:23], v[134:135], v[102:103], v[22:23] op_sel:[0,0,0] op_sel_hi:[0,1,1]
    s_set_gpr_idx_off
    v_lshlrev_b32_sdwa v138, v15, v124 dst_sel:DWORD dst_unused:UNUSED_PAD src0_sel:DWORD src1_sel:WORD_1
    s_waitcnt vmcnt(10)
    v_mfma_f32_4x4x4_16b_bf16 v[96:99], v[140:141], v[80:81], 0 cbsz:4 abid:3
    s_nop 0
    v_mfma_f32_4x4x4_16b_bf16 v[100:103], v[140:141], v[82:83], 0 cbsz:4 abid:3
    v_lshlrev_b32_sdwa v139, v15, v125 dst_sel:DWORD dst_unused:UNUSED_PAD src0_sel:DWORD src1_sel:WORD_1
    ds_read_u16_d16_hi v130, v138 offset:32768
    ds_read_u16_d16_hi v131, v139 offset:32768
    s_set_gpr_idx_on s59, 0xc
    v_pk_fma_f32 v[16:17], v[132:133], v[104:105], v[16:17] op_sel:[1,0,0] op_sel_hi:[1,1,1]
    v_pk_fma_f32 v[18:19], v[132:133], v[106:107], v[18:19] op_sel:[1,0,0] op_sel_hi:[1,1,1]
    v_pk_fma_f32 v[20:21], v[134:135], v[108:109], v[20:21] op_sel:[1,0,0] op_sel_hi:[1,1,1]
    v_pk_fma_f32 v[22:23], v[134:135], v[110:111], v[22:23] op_sel:[1,0,0] op_sel_hi:[1,1,1]
    s_set_gpr_idx_off
B_12:
    s_sub_u32 s32, s32, 4
    s_cbranch_scc1 MAIN_DONE
    v_mfma_f32_4x4x4_16b_bf16 v[116:119], v[172:173], v[178:179], 0 cbsz:4 abid:4
    v_lshlrev_b32_sdwa v136, v15, v122 dst_sel:DWORD dst_unused:UNUSED_PAD src0_sel:DWORD src1_sel:WORD_1
    s_waitcnt vmcnt(13)
    v_mfma_f32_4x4x4_16b_bf16 v[104:107], v[142:143], v[84:85], 0 cbsz:4 abid:3
    s_nop 0
    v_mfma_f32_4x4x4_16b_bf16 v[108:111], v[142:143], v[86:87], 0 cbsz:4 abid:3
    v_lshlrev_b32_sdwa v137, v15, v123 dst_sel:DWORD dst_unused:UNUSED_PAD src0_sel:DWORD src1_sel:WORD_1
    ds_read_u16_d16_hi v132, v136 offset:32768
    ds_read_u16_d16_hi v133, v137 offset:32768
    s_waitcnt lgkmcnt(2)
    s_set_gpr_idx_on s60, 0xc
    v_pk_fma_f32 v[16:17], v[128:129], v[96:97], v[16:17] op_sel:[0,0,0] op_sel_hi:[0,1,1]
    v_pk_fma_f32 v[18:19], v[128:129], v[98:99], v[18:19] op_sel:[0,0,0] op_sel_hi:[0,1,1]
    v_pk_fma_f32 v[20:21], v[130:131], v[100:101], v[20:21] op_sel:[0,0,0] op_sel_hi:[0,1,1]
    v_pk_fma_f32 v[22:23], v[130:131], v[102:103], v[22:23] op_sel:[0,0,0] op_sel_hi:[0,1,1]
    s_set_gpr_idx_off
    v_cmp_gt_u32 vcc, s30, v6
    v_add_u32 v6, 64, v6
    v_add_u32 v5, 256, v5
    v_cndmask_b32 v165, 40, v165, vcc
    v_lshrrev_b32 v8, 21, v165
    v_lshlrev_b32 v8, 4, v8
    v_lshlrev_b32 v9, 3, v165
    ds_read_b128 v[168:171], v8 offset:8192
    v_and_b32 v9, 0xfffc00, v9
    v_and_or_b32 v165, v165, 56, v9
    v_lshlrev_b32_sdwa v138, v15, v126 dst_sel:DWORD dst_unused:UNUSED_PAD src0_sel:DWORD src1_sel:WORD_1
    s_waitcnt vmcnt(12)
    v_mfma_f32_4x4x4_16b_bf16 v[96:99], v[144:145], v[88:89], 0 cbsz:4 abid:3
    s_nop 0
    v_mfma_f32_4x4x4_16b_bf16 v[100:103], v[144:145], v[90:91], 0 cbsz:4 abid:3
    v_lshlrev_b32_sdwa v139, v15, v127 dst_sel:DWORD dst_unused:UNUSED_PAD src0_sel:DWORD src1_sel:WORD_1
    ds_read_u16_d16_hi v134, v138 offset:32768
    ds_read_u16_d16_hi v135, v139 offset:32768
    s_set_gpr_idx_on s61, 0xc
    v_pk_fma_f32 v[16:17], v[128:129], v[104:105], v[16:17] op_sel:[1,0,0] op_sel_hi:[1,1,1]
    v_pk_fma_f32 v[18:19], v[128:129], v[106:107], v[18:19] op_sel:[1,0,0] op_sel_hi:[1,1,1]
    v_pk_fma_f32 v[20:21], v[130:131], v[108:109], v[20:21] op_sel:[1,0,0] op_sel_hi:[1,1,1]
    v_pk_fma_f32 v[22:23], v[130:131], v[110:111], v[22:23] op_sel:[1,0,0] op_sel_hi:[1,1,1]
    s_set_gpr_idx_off
    v_mfma_f32_4x4x4_16b_bf16 v[120:123], v[172:173], v[176:177], 0 cbsz:4 abid:5
    v_lshlrev_b32_sdwa v136, v15, v112 dst_sel:DWORD dst_unused:UNUSED_PAD src0_sel:DWORD src1_sel:WORD_1
    s_waitcnt vmcnt(11)
    v_mfma_f32_4x4x4_16b_bf16 v[104:107], v[146:147], v[92:93], 0 cbsz:4 abid:3
    s_nop 0
    v_mfma_f32_4x4x4_16b_bf16 v[108:111], v[146:147], v[94:95], 0 cbsz:4 abid:3
    v_lshlrev_b32_sdwa v137, v15, v113 dst_sel:DWORD dst_unused:UNUSED_PAD src0_sel:DWORD src1_sel:WORD_1
    ds_read_u16_d16_hi v128, v136 offset:32768
    ds_read_u16_d16_hi v129, v137 offset:32768
    s_waitcnt lgkmcnt(2)
    s_set_gpr_idx_on s62, 0xc
    v_pk_fma_f32 v[16:17], v[132:133], v[96:97], v[16:17] op_sel:[0,0,0] op_sel_hi:[0,1,1]
    v_pk_fma_f32 v[18:19], v[132:133], v[98:99], v[18:19] op_sel:[0,0,0] op_sel_hi:[0,1,1]
    v_pk_fma_f32 v[20:21], v[134:135], v[100:101], v[20:21] op_sel:[0,0,0] op_sel_hi:[0,1,1]
    v_pk_fma_f32 v[22:23], v[134:135], v[102:103], v[22:23] op_sel:[0,0,0] op_sel_hi:[0,1,1]
    s_set_gpr_idx_off
    v_lshlrev_b32_sdwa v138, v15, v116 dst_sel:DWORD dst_unused:UNUSED_PAD src0_sel:DWORD src1_sel:WORD_1
    s_waitcnt vmcnt(10)
    v_mfma_f32_4x4x4_16b_bf16 v[96:99], v[140:141], v[64:65], 0 cbsz:4 abid:4
    s_nop 0
    v_mfma_f32_4x4x4_16b_bf16 v[100:103], v[140:141], v[66:67], 0 cbsz:4 abid:4
    v_lshlrev_b32_sdwa v139, v15, v117 dst_sel:DWORD dst_unused:UNUSED_PAD src0_sel:DWORD src1_sel:WORD_1
    ds_read_u16_d16_hi v130, v138 offset:32768
    ds_read_u16_d16_hi v131, v139 offset:32768
    s_set_gpr_idx_on s63, 0xc
    v_pk_fma_f32 v[16:17], v[132:133], v[104:105], v[16:17] op_sel:[1,0,0] op_sel_hi:[1,1,1]
    v_pk_fma_f32 v[18:19], v[132:133], v[106:107], v[18:19] op_sel:[1,0,0] op_sel_hi:[1,1,1]
    v_pk_fma_f32 v[20:21], v[134:135], v[108:109], v[20:21] op_sel:[1,0,0] op_sel_hi:[1,1,1]
    v_pk_fma_f32 v[22:23], v[134:135], v[110:111], v[22:23] op_sel:[1,0,0] op_sel_hi:[1,1,1]
    s_set_gpr_idx_off
B_16:
    s_sub_u32 s32, s32, 4
    s_cbranch_scc1 MAIN_DONE
    v_mfma_f32_4x4x4_16b_bf16 v[124:127], v[172:173], v[178:179], 0 cbsz:4 abid:5
    v_lshlrev_b32_sdwa v136, v15, v114 dst_sel:DWORD dst_unused:UNUSED_PAD src0_sel:DWORD src1_sel:WORD_1
    s_waitcnt vmcnt(13)
    v_mfma_f32_4x4x4_16b_bf16 v[104:107], v[142:143], v[68:69], 0 cbsz:4 abid:4
    s_nop 0
    v_mfma_f32_4x4x4_16b_bf16 v[108:111], v[142:143], v[70:71], 0 cbsz:4 abid:4
    v_lshlrev_b32_sdwa v137, v15, v115 dst_sel:DWORD dst_unused:UNUSED_PAD src0_sel:DWORD src1_sel:WORD_1
    ds_read_u16_d16_hi v132, v136 offset:32768
    ds_read_u16_d16_hi v133, v137 offset:32768
    s_waitcnt lgkmcnt(2)
    s_set_gpr_idx_on s48, 0xc
    v_pk_fma_f32 v[16:17], v[128:129], v[96:97], v[16:17] op_sel:[0,0,0] op_sel_hi:[0,1,1]
    v_pk_fma_f32 v[18:19], v[128:129], v[98:99], v[18:19] op_sel:[0,0,0] op_sel_hi:[0,1,1]
    v_pk_fma_f32 v[20:21], v[130:131], v[100:101], v[20:21] op_sel:[0,0,0] op_sel_hi:[0,1,1]
    v_pk_fma_f32 v[22:23], v[130:131], v[102:103], v[22:23] op_sel:[0,0,0] op_sel_hi:[0,1,1]
    s_set_gpr_idx_off
    v_lshlrev_b32_sdwa v138, v15, v118 dst_sel:DWORD dst_unused:UNUSED_PAD src0_sel:DWORD src1_sel:WORD_1
    s_waitcnt vmcnt(12)
    v_mfma_f32_4x4x4_16b_bf16 v[96:99], v[144:145], v[72:73], 0 cbsz:4 abid:4
    s_nop 0
    v_mfma_f32_4x4x4_16b_bf16 v[100:103], v[144:145], v[74:75], 0 cbsz:4 abid:4
    v_lshlrev_b32_sdwa v139, v15, v119 dst_sel:DWORD dst_unused:UNUSED_PAD src0_sel:DWORD src1_sel:WORD_1
    ds_read_u16_d16_hi v134, v138 offset:32768
    ds_read_u16_d16_hi v135, v139 offset:32768
    s_set_gpr_idx_on s49, 0xc
    v_pk_fma_f32 v[16:17], v[128:129], v[104:105], v[16:17] op_sel:[1,0,0] op_sel_hi:[1,1,1]
    v_pk_fma_f32 v[18:19], v[128:129], v[106:107], v[18:19] op_sel:[1,0,0] op_sel_hi:[1,1,1]
    v_pk_fma_f32 v[20:21], v[130:131], v[108:109], v[20:21] op_sel:[1,0,0] op_sel_hi:[1,1,1]
    v_pk_fma_f32 v[22:23], v[130:131], v[110:111], v[22:23] op_sel:[1,0,0] op_sel_hi:[1,1,1]
    s_set_gpr_idx_off
    v_mfma_f32_4x4x4_16b_bf16 v[112:115], v[172:173], v[176:177], 0 cbsz:4 abid:6
    v_lshlrev_b32_sdwa v136, v15, v120 dst_sel:DWORD dst_unused:UNUSED_PAD src0_sel:DWORD src1_sel:WORD_1
    s_waitcnt vmcnt(11)
    v_mfma_f32_4x4x4_16b_bf16 v[104:107], v[146:147], v[76:77], 0 cbsz:4 abid:4
    s_nop 0
    v_mfma_f32_4x4x4_16b_bf16 v[108:111], v[146:147], v[78:79], 0 cbsz:4 abid:4
    v_lshlrev_b32_sdwa v137, v15, v121 dst_sel:DWORD dst_unused:UNUSED_PAD src0_sel:DWORD src1_sel:WORD_1
    ds_read_u16_d16_hi v128, v136 offset:32768
    ds_read_u16_d16_hi v129, v137 offset:32768
    s_waitcnt lgkmcnt(2)
    s_set_gpr_idx_on s50, 0xc
    v_pk_fma_f32 v[16:17], v[132:133], v[96:97], v[16:17] op_sel:[0,0,0] op_sel_hi:[0,1,1]
    v_pk_fma_f32 v[18:19], v[132:133], v[98:99], v[18:19] op_sel:[0,0,0] op_sel_hi:[0,1,1]
    v_pk_fma_f32 v[20:21], v[134:135], v[100:101], v[20:21] op_sel:[0,0,0] op_sel_hi:[0,1,1]
    v_pk_fma_f32 v[22:23], v[134:135], v[102:103], v[22:23] op_sel:[0,0,0] op_sel_hi:[0,1,1]
    s_set_gpr_idx_off
    v_lshlrev_b32_sdwa v138, v15, v124 dst_sel:DWORD dst_unused:UNUSED_PAD src0_sel:DWORD src1_sel:WORD_1
    s_waitcnt vmcnt(10)
    v_mfma_f32_4x4x4_16b_bf16 v[96:99], v[140:141], v[80:81], 0 cbsz:4 abid:5
    s_nop 0
    v_mfma_f32_4x4x4_16b_bf16 v[100:103], v[140:141], v[82:83], 0 cbsz:4 abid:5
    v_lshlrev_b32_sdwa v139, v15, v125 dst_sel:DWORD dst_unused:UNUSED_PAD src0_sel:DWORD src1_sel:WORD_1
    ds_read_u16_d16_hi v130, v138 offset:32768
    ds_read_u16_d16_hi v131, v139 offset:32768
    s_set_gpr_idx_on s51, 0xc
    v_pk_fma_f32 v[16:17], v[132:133], v[104:105], v[16:17] op_sel:[1,0,0] op_sel_hi:[1,1,1]
    v_pk_fma_f32 v[18:19], v[132:133], v[106:107], v[18:19] op_sel:[1,0,0] op_sel_hi:[1,1,1]
    v_pk_fma_f32 v[20:21], v[134:135], v[108:109], v[20:21] op_sel:[1,0,0] op_sel_hi:[1,1,1]
    v_pk_fma_f32 v[22:23], v[134:135], v[110:111], v[22:23] op_sel:[1,0,0] op_sel_hi:[1,1,1]
    s_set_gpr_idx_off
B_20:
    s_sub_u32 s32, s32, 4
    s_cbranch_scc1 MAIN_DONE
    v_mfma_f32_4x4x4_16b_bf16 v[116:119], v[172:173], v[178:179], 0 cbsz:4 abid:6
    v_lshlrev_b32_sdwa v136, v15, v122 dst_sel:DWORD dst_unused:UNUSED_PAD src0_sel:DWORD src1_sel:WORD_1
    s_waitcnt vmcnt(13)
    v_mfma_f32_4x4x4_16b_bf16 v[104:107], v[142:143], v[84:85], 0 cbsz:4 abid:5
    s_nop 0
    v_mfma_f32_4x4x4_16b_bf16 v[108:111], v[142:143], v[86:87], 0 cbsz:4 abid:5
    v_lshlrev_b32_sdwa v137, v15, v123 dst_sel:DWORD dst_unused:UNUSED_PAD src0_sel:DWORD src1_sel:WORD_1
    ds_read_u16_d16_hi v132, v136 offset:32768
    ds_read_u16_d16_hi v133, v137 offset:32768
    s_waitcnt lgkmcnt(2)
    s_set_gpr_idx_on s52, 0xc
    v_pk_fma_f32 v[16:17], v[128:129], v[96:97], v[16:17] op_sel:[0,0,0] op_sel_hi:[0,1,1]
    v_pk_fma_f32 v[18:19], v[128:129], v[98:99], v[18:19] op_sel:[0,0,0] op_sel_hi:[0,1,1]
    v_pk_fma_f32 v[20:21], v[130:131], v[100:101], v[20:21] op_sel:[0,0,0] op_sel_hi:[0,1,1]
    v_pk_fma_f32 v[22:23], v[130:131], v[102:103], v[22:23] op_sel:[0,0,0] op_sel_hi:[0,1,1]
    s_set_gpr_idx_off
    v_lshlrev_b32_sdwa v138, v15, v126 dst_sel:DWORD dst_unused:UNUSED_PAD src0_sel:DWORD src1_sel:WORD_1
    s_waitcnt vmcnt(12)
    v_mfma_f32_4x4x4_16b_bf16 v[96:99], v[144:145], v[88:89], 0 cbsz:4 abid:5
    s_nop 0
    v_mfma_f32_4x4x4_16b_bf16 v[100:103], v[144:145], v[90:91], 0 cbsz:4 abid:5
    v_lshlrev_b32_sdwa v139, v15, v127 dst_sel:DWORD dst_unused:UNUSED_PAD src0_sel:DWORD src1_sel:WORD_1
    ds_read_u16_d16_hi v134, v138 offset:32768
    ds_read_u16_d16_hi v135, v139 offset:32768
    s_set_gpr_idx_on s53, 0xc
    v_pk_fma_f32 v[16:17], v[128:129], v[104:105], v[16:17] op_sel:[1,0,0] op_sel_hi:[1,1,1]
    v_pk_fma_f32 v[18:19], v[128:129], v[106:107], v[18:19] op_sel:[1,0,0] op_sel_hi:[1,1,1]
    v_pk_fma_f32 v[20:21], v[130:131], v[108:109], v[20:21] op_sel:[1,0,0] op_sel_hi:[1,1,1]
    v_pk_fma_f32 v[22:23], v[130:131], v[110:111], v[22:23] op_sel:[1,0,0] op_sel_hi:[1,1,1]
    s_set_gpr_idx_off
    v_mfma_f32_4x4x4_16b_bf16 v[120:123], v[172:173], v[176:177], 0 cbsz:4 abid:7
    v_lshlrev_b32_sdwa v136, v15, v112 dst_sel:DWORD dst_unused:UNUSED_PAD src0_sel:DWORD src1_sel:WORD_1
    s_waitcnt vmcnt(11)
    v_mfma_f32_4x4x4_16b_bf16 v[104:107], v[146:147], v[92:93], 0 cbsz:4 abid:5
    s_nop 0
    v_mfma_f32_4x4x4_16b_bf16 v[108:111], v[146:147], v[94:95], 0 cbsz:4 abid:5
    v_lshlrev_b32_sdwa v137, v15, v113 dst_sel:DWORD dst_unused:UNUSED_PAD src0_sel:DWORD src1_sel:WORD_1
    ds_read_u16_d16_hi v128, v136 offset:32768
    ds_read_u16_d16_hi v129, v137 offset:32768
    s_waitcnt lgkmcnt(2)
    s_set_gpr_idx_on s54, 0xc
    v_pk_fma_f32 v[16:17], v[132:133], v[96:97], v[16:17] op_sel:[0,0,0] op_sel_hi:[0,1,1]
    v_pk_fma_f32 v[18:19], v[132:133], v[98:99], v[18:19] op_sel:[0,0,0] op_sel_hi:[0,1,1]
    v_pk_fma_f32 v[20:21], v[134:135], v[100:101], v[20:21] op_sel:[0,0,0] op_sel_hi:[0,1,1]
    v_pk_fma_f32 v[22:23], v[134:135], v[102:103], v[22:23] op_sel:[0,0,0] op_sel_hi:[0,1,1]
    s_set_gpr_idx_off
    v_lshlrev_b32_sdwa v138, v15, v116 dst_sel:DWORD dst_unused:UNUSED_PAD src0_sel:DWORD src1_sel:WORD_1
    s_waitcnt vmcnt(10)
    v_mfma_f32_4x4x4_16b_bf16 v[96:99], v[140:141], v[64:65], 0 cbsz:4 abid:6
    s_nop 0
    v_mfma_f32_4x4x4_16b_bf16 v[100:103], v[140:141], v[66:67], 0 cbsz:4 abid:6
    v_lshlrev_b32_sdwa v139, v15, v117 dst_sel:DWORD dst_unused:UNUSED_PAD src0_sel:DWORD src1_sel:WORD_1
    ds_read_u16_d16_hi v130, v138 offset:32768
    ds_read_u16_d16_hi v131, v139 offset:32768
    s_set_gpr_idx_on s55, 0xc
    v_pk_fma_f32 v[16:17], v[132:133], v[104:105], v[16:17] op_sel:[1,0,0] op_sel_hi:[1,1,1]
    v_pk_fma_f32 v[18:19], v[132:133], v[106:107], v[18:19] op_sel:[1,0,0] op_sel_hi:[1,1,1]
    v_pk_fma_f32 v[20:21], v[134:135], v[108:109], v[20:21] op_sel:[1,0,0] op_sel_hi:[1,1,1]
    v_pk_fma_f32 v[22:23], v[134:135], v[110:111], v[22:23] op_sel:[1,0,0] op_sel_hi:[1,1,1]
    s_set_gpr_idx_off
B_24:
    s_sub_u32 s32, s32, 4
    s_cbranch_scc1 MAIN_DONE
    v_mfma_f32_4x4x4_16b_bf16 v[124:127], v[172:173], v[178:179], 0 cbsz:4 abid:7
    v_lshlrev_b32_sdwa v136, v15, v114 dst_sel:DWORD dst_unused:UNUSED_PAD src0_sel:DWORD src1_sel:WORD_1
    s_waitcnt vmcnt(13)
    v_mfma_f32_4x4x4_16b_bf16 v[104:107], v[142:143], v[68:69], 0 cbsz:4 abid:6
    s_nop 0
    v_mfma_f32_4x4x4_16b_bf16 v[108:111], v[142:143], v[70:71], 0 cbsz:4 abid:6
    v_lshlrev_b32_sdwa v137, v15, v115 dst_sel:DWORD dst_unused:UNUSED_PAD src0_sel:DWORD src1_sel:WORD_1
    ds_read_u16_d16_hi v132, v136 offset:32768
    ds_read_u16_d16_hi v133, v137 offset:32768
    s_waitcnt lgkmcnt(2)
    s_set_gpr_idx_on s56, 0xc
    v_pk_fma_f32 v[16:17], v[128:129], v[96:97], v[16:17] op_sel:[0,0,0] op_sel_hi:[0,1,1]
    v_pk_fma_f32 v[18:19], v[128:129], v[98:99], v[18:19] op_sel:[0,0,0] op_sel_hi:[0,1,1]
    v_pk_fma_f32 v[20:21], v[130:131], v[100:101], v[20:21] op_sel:[0,0,0] op_sel_hi:[0,1,1]
    v_pk_fma_f32 v[22:23], v[130:131], v[102:103], v[22:23] op_sel:[0,0,0] op_sel_hi:[0,1,1]
    s_set_gpr_idx_off
    v_lshlrev_b32_sdwa v138, v15, v118 dst_sel:DWORD dst_unused:UNUSED_PAD src0_sel:DWORD src1_sel:WORD_1
    s_waitcnt vmcnt(12)
    v_mfma_f32_4x4x4_16b_bf16 v[96:99], v[144:145], v[72:73], 0 cbsz:4 abid:6
    s_nop 0
    v_mfma_f32_4x4x4_16b_bf16 v[100:103], v[144:145], v[74:75], 0 cbsz:4 abid:6
    v_lshlrev_b32_sdwa v139, v15, v119 dst_sel:DWORD dst_unused:UNUSED_PAD src0_sel:DWORD src1_sel:WORD_1
    ds_read_u16_d16_hi v134, v138 offset:32768
    ds_read_u16_d16_hi v135, v139 offset:32768
    s_set_gpr_idx_on s57, 0xc
    v_pk_fma_f32 v[16:17], v[128:129], v[104:105], v[16:17] op_sel:[1,0,0] op_sel_hi:[1,1,1]
    v_pk_fma_f32 v[18:19], v[128:129], v[106:107], v[18:19] op_sel:[1,0,0] op_sel_hi:[1,1,1]
    v_pk_fma_f32 v[20:21], v[130:131], v[108:109], v[20:21] op_sel:[1,0,0] op_sel_hi:[1,1,1]
    v_pk_fma_f32 v[22:23], v[130:131], v[110:111], v[22:23] op_sel:[1,0,0] op_sel_hi:[1,1,1]
    s_set_gpr_idx_off
    v_mfma_f32_4x4x4_16b_bf16 v[112:115], v[172:173], v[176:177], 0 cbsz:4 abid:8
    v_lshlrev_b32_sdwa v136, v15, v120 dst_sel:DWORD dst_unused:UNUSED_PAD src0_sel:DWORD src1_sel:WORD_1
    s_waitcnt vmcnt(11)
    v_mfma_f32_4x4x4_16b_bf16 v[104:107], v[146:147], v[76:77], 0 cbsz:4 abid:6
    s_nop 0
    v_mfma_f32_4x4x4_16b_bf16 v[108:111], v[146:147], v[78:79], 0 cbsz:4 abid:6
    v_lshlrev_b32_sdwa v137, v15, v121 dst_sel:DWORD dst_unused:UNUSED_PAD src0_sel:DWORD src1_sel:WORD_1
    ds_read_u16_d16_hi v128, v136 offset:32768
    ds_read_u16_d16_hi v129, v137 offset:32768
    s_waitcnt lgkmcnt(2)
    s_set_gpr_idx_on s58, 0xc
    v_pk_fma_f32 v[16:17], v[132:133], v[96:97], v[16:17] op_sel:[0,0,0] op_sel_hi:[0,1,1]
    v_pk_fma_f32 v[18:19], v[132:133], v[98:99], v[18:19] op_sel:[0,0,0] op_sel_hi:[0,1,1]
    v_pk_fma_f32 v[20:21], v[134:135], v[100:101], v[20:21] op_sel:[0,0,0] op_sel_hi:[0,1,1]
    v_pk_fma_f32 v[22:23], v[134:135], v[102:103], v[22:23] op_sel:[0,0,0] op_sel_hi:[0,1,1]
    s_set_gpr_idx_off
    v_lshlrev_b32_sdwa v138, v15, v124 dst_sel:DWORD dst_unused:UNUSED_PAD src0_sel:DWORD src1_sel:WORD_1
    s_waitcnt vmcnt(10)
    v_mfma_f32_4x4x4_16b_bf16 v[96:99], v[140:141], v[80:81], 0 cbsz:4 abid:7
    s_nop 0
    v_mfma_f32_4x4x4_16b_bf16 v[100:103], v[140:141], v[82:83], 0 cbsz:4 abid:7
    v_lshlrev_b32_sdwa v139, v15, v125 dst_sel:DWORD dst_unused:UNUSED_PAD src0_sel:DWORD src1_sel:WORD_1
    ds_read_u16_d16_hi v130, v138 offset:32768
    ds_read_u16_d16_hi v131, v139 offset:32768
    s_set_gpr_idx_on s59, 0xc
    v_pk_fma_f32 v[16:17], v[132:133], v[104:105], v[16:17] op_sel:[1,0,0] op_sel_hi:[1,1,1]
    v_pk_fma_f32 v[18:19], v[132:133], v[106:107], v[18:19] op_sel:[1,0,0] op_sel_hi:[1,1,1]
    v_pk_fma_f32 v[20:21], v[134:135], v[108:109], v[20:21] op_sel:[1,0,0] op_sel_hi:[1,1,1]
    v_pk_fma_f32 v[22:23], v[134:135], v[110:111], v[22:23] op_sel:[1,0,0] op_sel_hi:[1,1,1]
    s_set_gpr_idx_off
B_28:
    s_sub_u32 s32, s32, 4
    s_cbranch_scc1 MAIN_DONE
    v_mfma_f32_4x4x4_16b_bf16 v[116:119], v[172:173], v[178:179], 0 cbsz:4 abid:8
    v_lshlrev_b32_sdwa v136, v15, v122 dst_sel:DWORD dst_unused:UNUSED_PAD src0_sel:DWORD src1_sel:WORD_1
    s_waitcnt vmcnt(13)
    v_mfma_f32_4x4x4_16b_bf16 v[104:107], v[142:143], v[84:85], 0 cbsz:4 abid:7
    s_nop 0
    v_mfma_f32_4x4x4_16b_bf16 v[108:111], v[142:143], v[86:87], 0 cbsz:4 abid:7
    v_lshlrev_b32_sdwa v137, v15, v123 dst_sel:DWORD dst_unused:UNUSED_PAD src0_sel:DWORD src1_sel:WORD_1
    ds_read_u16_d16_hi v132, v136 offset:32768
    ds_read_u16_d16_hi v133, v137 offset:32768
    s_waitcnt lgkmcnt(2)
    s_set_gpr_idx_on s60, 0xc
    v_pk_fma_f32 v[16:17], v[128:129], v[96:97], v[16:17] op_sel:[0,0,0] op_sel_hi:[0,1,1]
    v_pk_fma_f32 v[18:19], v[128:129], v[98:99], v[18:19] op_sel:[0,0,0] op_sel_hi:[0,1,1]
    v_pk_fma_f32 v[20:21], v[130:131], v[100:101], v[20:21] op_sel:[0,0,0] op_sel_hi:[0,1,1]
    v_pk_fma_f32 v[22:23], v[130:131], v[102:103], v[22:23] op_sel:[0,0,0] op_sel_hi:[0,1,1]
    s_set_gpr_idx_off
    v_lshlrev_b32_sdwa v138, v15, v126 dst_sel:DWORD dst_unused:UNUSED_PAD src0_sel:DWORD src1_sel:WORD_1
    s_waitcnt vmcnt(12)
    v_mfma_f32_4x4x4_16b_bf16 v[96:99], v[144:145], v[88:89], 0 cbsz:4 abid:7
    s_nop 0
    v_mfma_f32_4x4x4_16b_bf16 v[100:103], v[144:145], v[90:91], 0 cbsz:4 abid:7
    v_lshlrev_b32_sdwa v139, v15, v127 dst_sel:DWORD dst_unused:UNUSED_PAD src0_sel:DWORD src1_sel:WORD_1
    ds_read_u16_d16_hi v134, v138 offset:32768
    ds_read_u16_d16_hi v135, v139 offset:32768
    s_set_gpr_idx_on s61, 0xc
    v_pk_fma_f32 v[16:17], v[128:129], v[104:105], v[16:17] op_sel:[1,0,0] op_sel_hi:[1,1,1]
    v_pk_fma_f32 v[18:19], v[128:129], v[106:107], v[18:19] op_sel:[1,0,0] op_sel_hi:[1,1,1]
    v_pk_fma_f32 v[20:21], v[130:131], v[108:109], v[20:21] op_sel:[1,0,0] op_sel_hi:[1,1,1]
    v_pk_fma_f32 v[22:23], v[130:131], v[110:111], v[22:23] op_sel:[1,0,0] op_sel_hi:[1,1,1]
    s_set_gpr_idx_off
    v_mfma_f32_4x4x4_16b_bf16 v[120:123], v[172:173], v[176:177], 0 cbsz:4 abid:9
    v_lshlrev_b32_sdwa v136, v15, v112 dst_sel:DWORD dst_unused:UNUSED_PAD src0_sel:DWORD src1_sel:WORD_1
    s_waitcnt vmcnt(11)
    v_mfma_f32_4x4x4_16b_bf16 v[104:107], v[146:147], v[92:93], 0 cbsz:4 abid:7
    s_nop 0
    v_mfma_f32_4x4x4_16b_bf16 v[108:111], v[146:147], v[94:95], 0 cbsz:4 abid:7
    v_lshlrev_b32_sdwa v137, v15, v113 dst_sel:DWORD dst_unused:UNUSED_PAD src0_sel:DWORD src1_sel:WORD_1
    ds_read_u16_d16_hi v128, v136 offset:32768
    ds_read_u16_d16_hi v129, v137 offset:32768
    s_waitcnt lgkmcnt(2)
    s_set_gpr_idx_on s62, 0xc
    v_pk_fma_f32 v[16:17], v[132:133], v[96:97], v[16:17] op_sel:[0,0,0] op_sel_hi:[0,1,1]
    v_pk_fma_f32 v[18:19], v[132:133], v[98:99], v[18:19] op_sel:[0,0,0] op_sel_hi:[0,1,1]
    v_pk_fma_f32 v[20:21], v[134:135], v[100:101], v[20:21] op_sel:[0,0,0] op_sel_hi:[0,1,1]
    v_pk_fma_f32 v[22:23], v[134:135], v[102:103], v[22:23] op_sel:[0,0,0] op_sel_hi:[0,1,1]
    s_set_gpr_idx_off
    v_lshlrev_b32_sdwa v138, v15, v116 dst_sel:DWORD dst_unused:UNUSED_PAD src0_sel:DWORD src1_sel:WORD_1
    s_waitcnt vmcnt(10)
    v_mfma_f32_4x4x4_16b_bf16 v[96:99], v[140:141], v[64:65], 0 cbsz:4 abid:8
    s_nop 0
    v_mfma_f32_4x4x4_16b_bf16 v[100:103], v[140:141], v[66:67], 0 cbsz:4 abid:8
    v_lshlrev_b32_sdwa v139, v15, v117 dst_sel:DWORD dst_unused:UNUSED_PAD src0_sel:DWORD src1_sel:WORD_1
    ds_read_u16_d16_hi v130, v138 offset:32768
    ds_read_u16_d16_hi v131, v139 offset:32768
    s_set_gpr_idx_on s63, 0xc
    v_pk_fma_f32 v[16:17], v[132:133], v[104:105], v[16:17] op_sel:[1,0,0] op_sel_hi:[1,1,1]
    v_pk_fma_f32 v[18:19], v[132:133], v[106:107], v[18:19] op_sel:[1,0,0] op_sel_hi:[1,1,1]
    v_pk_fma_f32 v[20:21], v[134:135], v[108:109], v[20:21] op_sel:[1,0,0] op_sel_hi:[1,1,1]
    v_pk_fma_f32 v[22:23], v[134:135], v[110:111], v[22:23] op_sel:[1,0,0] op_sel_hi:[1,1,1]
    s_set_gpr_idx_off
B_32:
    s_sub_u32 s32, s32, 4
    s_cbranch_scc1 MAIN_DONE
    v_mfma_f32_4x4x4_16b_bf16 v[124:127], v[172:173], v[178:179], 0 cbsz:4 abid:9
    v_lshlrev_b32_sdwa v136, v15, v114 dst_sel:DWORD dst_unused:UNUSED_PAD src0_sel:DWORD src1_sel:WORD_1
    s_waitcnt vmcnt(13)
    v_mfma_f32_4x4x4_16b_bf16 v[104:107], v[142:143], v[68:69], 0 cbsz:4 abid:8
    s_nop 0
    v_mfma_f32_4x4x4_16b_bf16 v[108:111], v[142:143], v[70:71], 0 cbsz:4 abid:8
    v_lshlrev_b32_sdwa v137, v15, v115 dst_sel:DWORD dst_unused:UNUSED_PAD src0_sel:DWORD src1_sel:WORD_1
    ds_read_u16_d16_hi v132, v136 offset:32768
    ds_read_u16_d16_hi v133, v137 offset:32768
    s_waitcnt lgkmcnt(2)
    s_set_gpr_idx_on s48, 0xc
    v_pk_fma_f32 v[16:17], v[128:129], v[96:97], v[16:17] op_sel:[0,0,0] op_sel_hi:[0,1,1]
    v_pk_fma_f32 v[18:19], v[128:129], v[98:99], v[18:19] op_sel:[0,0,0] op_sel_hi:[0,1,1]
    v_pk_fma_f32 v[20:21], v[130:131], v[100:101], v[20:21] op_sel:[0,0,0] op_sel_hi:[0,1,1]
    v_pk_fma_f32 v[22:23], v[130:131], v[102:103], v[22:23] op_sel:[0,0,0] op_sel_hi:[0,1,1]
    s_set_gpr_idx_off
    v_lshlrev_b32_sdwa v138, v15, v118 dst_sel:DWORD dst_unused:UNUSED_PAD src0_sel:DWORD src1_sel:WORD_1
    s_waitcnt vmcnt(12)
    v_mfma_f32_4x4x4_16b_bf16 v[96:99], v[144:145], v[72:73], 0 cbsz:4 abid:8
    s_nop 0
    v_mfma_f32_4x4x4_16b_bf16 v[100:103], v[144:145], v[74:75], 0 cbsz:4 abid:8
    v_lshlrev_b32_sdwa v139, v15, v119 dst_sel:DWORD dst_unused:UNUSED_PAD src0_sel:DWORD src1_sel:WORD_1
    ds_read_u16_d16_hi v134, v138 offset:32768
    ds_read_u16_d16_hi v135, v139 offset:32768
    s_set_gpr_idx_on s49, 0xc
    v_pk_fma_f32 v[16:17], v[128:129], v[104:105], v[16:17] op_sel:[1,0,0] op_sel_hi:[1,1,1]
    v_pk_fma_f32 v[18:19], v[128:129], v[106:107], v[18:19] op_sel:[1,0,0] op_sel_hi:[1,1,1]
    v_pk_fma_f32 v[20:21], v[130:131], v[108:109], v[20:21] op_sel:[1,0,0] op_sel_hi:[1,1,1]
    v_pk_fma_f32 v[22:23], v[130:131], v[110:111], v[22:23] op_sel:[1,0,0] op_sel_hi:[1,1,1]
    s_set_gpr_idx_off
    v_mfma_f32_4x4x4_16b_bf16 v[112:115], v[172:173], v[176:177], 0 cbsz:4 abid:10
    v_lshlrev_b32_sdwa v136, v15, v120 dst_sel:DWORD dst_unused:UNUSED_PAD src0_sel:DWORD src1_sel:WORD_1
    s_waitcnt vmcnt(11)
    v_mfma_f32_4x4x4_16b_bf16 v[104:107], v[146:147], v[76:77], 0 cbsz:4 abid:8
    s_nop 0
    v_mfma_f32_4x4x4_16b_bf16 v[108:111], v[146:147], v[78:79], 0 cbsz:4 abid:8
    v_lshlrev_b32_sdwa v137, v15, v121 dst_sel:DWORD dst_unused:UNUSED_PAD src0_sel:DWORD src1_sel:WORD_1
    ds_read_u16_d16_hi v128, v136 offset:32768
    ds_read_u16_d16_hi v129, v137 offset:32768
    s_waitcnt lgkmcnt(2)
    s_set_gpr_idx_on s50, 0xc
    v_pk_fma_f32 v[16:17], v[132:133], v[96:97], v[16:17] op_sel:[0,0,0] op_sel_hi:[0,1,1]
    v_pk_fma_f32 v[18:19], v[132:133], v[98:99], v[18:19] op_sel:[0,0,0] op_sel_hi:[0,1,1]
    v_pk_fma_f32 v[20:21], v[134:135], v[100:101], v[20:21] op_sel:[0,0,0] op_sel_hi:[0,1,1]
    v_pk_fma_f32 v[22:23], v[134:135], v[102:103], v[22:23] op_sel:[0,0,0] op_sel_hi:[0,1,1]
    s_set_gpr_idx_off
    v_lshlrev_b32_sdwa v138, v15, v124 dst_sel:DWORD dst_unused:UNUSED_PAD src0_sel:DWORD src1_sel:WORD_1
    s_waitcnt vmcnt(10)
    v_mfma_f32_4x4x4_16b_bf16 v[96:99], v[140:141], v[80:81], 0 cbsz:4 abid:9
    s_nop 0
    v_mfma_f32_4x4x4_16b_bf16 v[100:103], v[140:141], v[82:83], 0 cbsz:4 abid:9
    v_lshlrev_b32_sdwa v139, v15, v125 dst_sel:DWORD dst_unused:UNUSED_PAD src0_sel:DWORD src1_sel:WORD_1
    ds_read_u16_d16_hi v130, v138 offset:32768
    ds_read_u16_d16_hi v131, v139 offset:32768
    s_set_gpr_idx_on s51, 0xc
    v_pk_fma_f32 v[16:17], v[132:133], v[104:105], v[16:17] op_sel:[1,0,0] op_sel_hi:[1,1,1]
    v_pk_fma_f32 v[18:19], v[132:133], v[106:107], v[18:19] op_sel:[1,0,0] op_sel_hi:[1,1,1]
    v_pk_fma_f32 v[20:21], v[134:135], v[108:109], v[20:21] op_sel:[1,0,0] op_sel_hi:[1,1,1]
    v_pk_fma_f32 v[22:23], v[134:135], v[110:111], v[22:23] op_sel:[1,0,0] op_sel_hi:[1,1,1]
    s_set_gpr_idx_off
B_36:
    s_sub_u32 s32, s32, 4
    s_cbranch_scc1 MAIN_DONE
    v_mfma_f32_4x4x4_16b_bf16 v[116:119], v[172:173], v[178:179], 0 cbsz:4 abid:10
    v_lshlrev_b32_sdwa v136, v15, v122 dst_sel:DWORD dst_unused:UNUSED_PAD src0_sel:DWORD src1_sel:WORD_1
    s_waitcnt vmcnt(13)
    v_mfma_f32_4x4x4_16b_bf16 v[104:107], v[142:143], v[84:85], 0 cbsz:4 abid:9
    s_nop 0
    v_mfma_f32_4x4x4_16b_bf16 v[108:111], v[142:143], v[86:87], 0 cbsz:4 abid:9
    v_lshlrev_b32_sdwa v137, v15, v123 dst_sel:DWORD dst_unused:UNUSED_PAD src0_sel:DWORD src1_sel:WORD_1
    ds_read_u16_d16_hi v132, v136 offset:32768
    ds_read_u16_d16_hi v133, v137 offset:32768
    s_waitcnt lgkmcnt(2)
    s_set_gpr_idx_on s52, 0xc
    v_pk_fma_f32 v[16:17], v[128:129], v[96:97], v[16:17] op_sel:[0,0,0] op_sel_hi:[0,1,1]
    v_pk_fma_f32 v[18:19], v[128:129], v[98:99], v[18:19] op_sel:[0,0,0] op_sel_hi:[0,1,1]
    v_pk_fma_f32 v[20:21], v[130:131], v[100:101], v[20:21] op_sel:[0,0,0] op_sel_hi:[0,1,1]
    v_pk_fma_f32 v[22:23], v[130:131], v[102:103], v[22:23] op_sel:[0,0,0] op_sel_hi:[0,1,1]
    s_set_gpr_idx_off
    v_lshlrev_b32_sdwa v138, v15, v126 dst_sel:DWORD dst_unused:UNUSED_PAD src0_sel:DWORD src1_sel:WORD_1
    s_waitcnt vmcnt(12)
    v_mfma_f32_4x4x4_16b_bf16 v[96:99], v[144:145], v[88:89], 0 cbsz:4 abid:9
    s_nop 0
    v_mfma_f32_4x4x4_16b_bf16 v[100:103], v[144:145], v[90:91], 0 cbsz:4 abid:9
    v_lshlrev_b32_sdwa v139, v15, v127 dst_sel:DWORD dst_unused:UNUSED_PAD src0_sel:DWORD src1_sel:WORD_1
    ds_read_u16_d16_hi v134, v138 offset:32768
    ds_read_u16_d16_hi v135, v139 offset:32768
    s_set_gpr_idx_on s53, 0xc
    v_pk_fma_f32 v[16:17], v[128:129], v[104:105], v[16:17] op_sel:[1,0,0] op_sel_hi:[1,1,1]
    v_pk_fma_f32 v[18:19], v[128:129], v[106:107], v[18:19] op_sel:[1,0,0] op_sel_hi:[1,1,1]
    v_pk_fma_f32 v[20:21], v[130:131], v[108:109], v[20:21] op_sel:[1,0,0] op_sel_hi:[1,1,1]
    v_pk_fma_f32 v[22:23], v[130:131], v[110:111], v[22:23] op_sel:[1,0,0] op_sel_hi:[1,1,1]
    s_set_gpr_idx_off
    v_mfma_f32_4x4x4_16b_bf16 v[120:123], v[172:173], v[176:177], 0 cbsz:4 abid:11
    v_lshlrev_b32_sdwa v136, v15, v112 dst_sel:DWORD dst_unused:UNUSED_PAD src0_sel:DWORD src1_sel:WORD_1
    s_waitcnt vmcnt(11)
    v_mfma_f32_4x4x4_16b_bf16 v[104:107], v[146:147], v[92:93], 0 cbsz:4 abid:9
    s_nop 0
    v_mfma_f32_4x4x4_16b_bf16 v[108:111], v[146:147], v[94:95], 0 cbsz:4 abid:9
    v_lshlrev_b32_sdwa v137, v15, v113 dst_sel:DWORD dst_unused:UNUSED_PAD src0_sel:DWORD src1_sel:WORD_1
    ds_read_u16_d16_hi v128, v136 offset:32768
    ds_read_u16_d16_hi v129, v137 offset:32768
    s_waitcnt lgkmcnt(2)
    s_set_gpr_idx_on s54, 0xc
    v_pk_fma_f32 v[16:17], v[132:133], v[96:97], v[16:17] op_sel:[0,0,0] op_sel_hi:[0,1,1]
    v_pk_fma_f32 v[18:19], v[132:133], v[98:99], v[18:19] op_sel:[0,0,0] op_sel_hi:[0,1,1]
    v_pk_fma_f32 v[20:21], v[134:135], v[100:101], v[20:21] op_sel:[0,0,0] op_sel_hi:[0,1,1]
    v_pk_fma_f32 v[22:23], v[134:135], v[102:103], v[22:23] op_sel:[0,0,0] op_sel_hi:[0,1,1]
    s_set_gpr_idx_off
    v_lshlrev_b32_sdwa v138, v15, v116 dst_sel:DWORD dst_unused:UNUSED_PAD src0_sel:DWORD src1_sel:WORD_1
    s_waitcnt vmcnt(10)
    v_mfma_f32_4x4x4_16b_bf16 v[96:99], v[140:141], v[64:65], 0 cbsz:4 abid:10
    s_nop 0
    v_mfma_f32_4x4x4_16b_bf16 v[100:103], v[140:141], v[66:67], 0 cbsz:4 abid:10
    v_lshlrev_b32_sdwa v139, v15, v117 dst_sel:DWORD dst_unused:UNUSED_PAD src0_sel:DWORD src1_sel:WORD_1
    ds_read_u16_d16_hi v130, v138 offset:32768
    ds_read_u16_d16_hi v131, v139 offset:32768
    s_set_gpr_idx_on s55, 0xc
    v_pk_fma_f32 v[16:17], v[132:133], v[104:105], v[16:17] op_sel:[1,0,0] op_sel_hi:[1,1,1]
    v_pk_fma_f32 v[18:19], v[132:133], v[106:107], v[18:19] op_sel:[1,0,0] op_sel_hi:[1,1,1]
    v_pk_fma_f32 v[20:21], v[134:135], v[108:109], v[20:21] op_sel:[1,0,0] op_sel_hi:[1,1,1]
    v_pk_fma_f32 v[22:23], v[134:135], v[110:111], v[22:23] op_sel:[1,0,0] op_sel_hi:[1,1,1]
    s_set_gpr_idx_off
B_40:
    s_sub_u32 s32, s32, 4
    s_cbranch_scc1 MAIN_DONE
    v_mfma_f32_4x4x4_16b_bf16 v[124:127], v[172:173], v[178:179], 0 cbsz:4 abid:11
    v_lshlrev_b32_sdwa v136, v15, v114 dst_sel:DWORD dst_unused:UNUSED_PAD src0_sel:DWORD src1_sel:WORD_1
    s_waitcnt vmcnt(13)
    v_mfma_f32_4x4x4_16b_bf16 v[104:107], v[142:143], v[68:69], 0 cbsz:4 abid:10
    s_nop 0
    v_mfma_f32_4x4x4_16b_bf16 v[108:111], v[142:143], v[70:71], 0 cbsz:4 abid:10
    v_lshlrev_b32_sdwa v137, v15, v115 dst_sel:DWORD dst_unused:UNUSED_PAD src0_sel:DWORD src1_sel:WORD_1
    ds_read_u16_d16_hi v132, v136 offset:32768
    ds_read_u16_d16_hi v133, v137 offset:32768
    s_waitcnt lgkmcnt(2)
    s_set_gpr_idx_on s56, 0xc
    v_pk_fma_f32 v[16:17], v[128:129], v[96:97], v[16:17] op_sel:[0,0,0] op_sel_hi:[0,1,1]
    v_pk_fma_f32 v[18:19], v[128:129], v[98:99], v[18:19] op_sel:[0,0,0] op_sel_hi:[0,1,1]
    v_pk_fma_f32 v[20:21], v[130:131], v[100:101], v[20:21] op_sel:[0,0,0] op_sel_hi:[0,1,1]
    v_pk_fma_f32 v[22:23], v[130:131], v[102:103], v[22:23] op_sel:[0,0,0] op_sel_hi:[0,1,1]
    s_set_gpr_idx_off
    v_mfma_f32_4x4x4_16b_bf16 v[148:151], v[168:169], v[180:181], 0
    v_lshlrev_b32_sdwa v138, v15, v118 dst_sel:DWORD dst_unused:UNUSED_PAD src0_sel:DWORD src1_sel:WORD_1
    s_waitcnt vmcnt(12)
    v_mfma_f32_4x4x4_16b_bf16 v[96:99], v[144:145], v[72:73], 0 cbsz:4 abid:10
    s_nop 0
    v_mfma_f32_4x4x4_16b_bf16 v[100:103], v[144:145], v[74:75], 0 cbsz:4 abid:10
    v_lshlrev_b32_sdwa v139, v15, v119 dst_sel:DWORD dst_unused:UNUSED_PAD src0_sel:DWORD src1_sel:WORD_1
    ds_read_u16_d16_hi v134, v138 offset:32768
    ds_read_u16_d16_hi v135, v139 offset:32768
    s_set_gpr_idx_on s57, 0xc
    v_pk_fma_f32 v[16:17], v[128:129], v[104:105], v[16:17] op_sel:[1,0,0] op_sel_hi:[1,1,1]
    v_pk_fma_f32 v[18:19], v[128:129], v[106:107], v[18:19] op_sel:[1,0,0] op_sel_hi:[1,1,1]
    v_pk_fma_f32 v[20:21], v[130:131], v[108:109], v[20:21] op_sel:[1,0,0] op_sel_hi:[1,1,1]
    v_pk_fma_f32 v[22:23], v[130:131], v[110:111], v[22:23] op_sel:[1,0,0] op_sel_hi:[1,1,1]
    s_set_gpr_idx_off
    v_mfma_f32_4x4x4_16b_bf16 v[112:115], v[172:173], v[176:177], 0 cbsz:4 abid:12
    v_lshlrev_b32_sdwa v136, v15, v120 dst_sel:DWORD dst_unused:UNUSED_PAD src0_sel:DWORD src1_sel:WORD_1
    s_waitcnt vmcnt(11)
    v_mfma_f32_4x4x4_16b_bf16 v[104:107], v[146:147], v[76:77], 0 cbsz:4 abid:10
    s_nop 0
    v_mfma_f32_4x4x4_16b_bf16 v[108:111], v[146:147], v[78:79], 0 cbsz:4 abid:10
    v_lshlrev_b32_sdwa v137, v15, v121 dst_sel:DWORD dst_unused:UNUSED_PAD src0_sel:DWORD src1_sel:WORD_1
    ds_read_u16_d16_hi v128, v136 offset:32768
    ds_read_u16_d16_hi v129, v137 offset:32768
    s_waitcnt lgkmcnt(2)
    s_set_gpr_idx_on s58, 0xc
    v_pk_fma_f32 v[16:17], v[132:133], v[96:97], v[16:17] op_sel:[0,0,0] op_sel_hi:[0,1,1]
    v_pk_fma_f32 v[18:19], v[132:133], v[98:99], v[18:19] op_sel:[0,0,0] op_sel_hi:[0,1,1]
    v_pk_fma_f32 v[20:21], v[134:135], v[100:101], v[20:21] op_sel:[0,0,0] op_sel_hi:[0,1,1]
    v_pk_fma_f32 v[22:23], v[134:135], v[102:103], v[22:23] op_sel:[0,0,0] op_sel_hi:[0,1,1]
    s_set_gpr_idx_off
    v_mfma_f32_4x4x4_16b_bf16 v[152:155], v[168:169], v[182:183], 0
    v_lshlrev_b32_sdwa v138, v15, v124 dst_sel:DWORD dst_unused:UNUSED_PAD src0_sel:DWORD src1_sel:WORD_1
    s_waitcnt vmcnt(10)
    v_mfma_f32_4x4x4_16b_bf16 v[96:99], v[140:141], v[80:81], 0 cbsz:4 abid:11
    s_nop 0
    v_mfma_f32_4x4x4_16b_bf16 v[100:103], v[140:141], v[82:83], 0 cbsz:4 abid:11
    v_lshlrev_b32_sdwa v139, v15, v125 dst_sel:DWORD dst_unused:UNUSED_PAD src0_sel:DWORD src1_sel:WORD_1
    ds_read_u16_d16_hi v130, v138 offset:32768
    ds_read_u16_d16_hi v131, v139 offset:32768
    s_set_gpr_idx_on s59, 0xc
    v_pk_fma_f32 v[16:17], v[132:133], v[104:105], v[16:17] op_sel:[1,0,0] op_sel_hi:[1,1,1]
    v_pk_fma_f32 v[18:19], v[132:133], v[106:107], v[18:19] op_sel:[1,0,0] op_sel_hi:[1,1,1]
    v_pk_fma_f32 v[20:21], v[134:135], v[108:109], v[20:21] op_sel:[1,0,0] op_sel_hi:[1,1,1]
    v_pk_fma_f32 v[22:23], v[134:135], v[110:111], v[22:23] op_sel:[1,0,0] op_sel_hi:[1,1,1]
    s_set_gpr_idx_off
B_44:
    s_sub_u32 s32, s32, 4
    s_cbranch_scc1 MAIN_DONE
    v_mfma_f32_4x4x4_16b_bf16 v[116:119], v[172:173], v[178:179], 0 cbsz:4 abid:12
    v_lshlrev_b32_sdwa v136, v15, v122 dst_sel:DWORD dst_unused:UNUSED_PAD src0_sel:DWORD src1_sel:WORD_1
    s_waitcnt vmcnt(13)
    v_mfma_f32_4x4x4_16b_bf16 v[104:107], v[142:143], v[84:85], 0 cbsz:4 abid:11
    s_nop 0
    v_mfma_f32_4x4x4_16b_bf16 v[108:111], v[142:143], v[86:87], 0 cbsz:4 abid:11
    v_lshlrev_b32_sdwa v137, v15, v123 dst_sel:DWORD dst_unused:UNUSED_PAD src0_sel:DWORD src1_sel:WORD_1
    ds_read_u16_d16_hi v132, v136 offset:32768
    ds_read_u16_d16_hi v133, v137 offset:32768
    s_waitcnt lgkmcnt(2)
    s_set_gpr_idx_on s60, 0xc
    v_pk_fma_f32 v[16:17], v[128:129], v[96:97], v[16:17] op_sel:[0,0,0] op_sel_hi:[0,1,1]
    v_pk_fma_f32 v[18:19], v[128:129], v[98:99], v[18:19] op_sel:[0,0,0] op_sel_hi:[0,1,1]
    v_pk_fma_f32 v[20:21], v[130:131], v[100:101], v[20:21] op_sel:[0,0,0] op_sel_hi:[0,1,1]
    v_pk_fma_f32 v[22:23], v[130:131], v[102:103], v[22:23] op_sel:[0,0,0] op_sel_hi:[0,1,1]
    s_set_gpr_idx_off
    v_mfma_f32_4x4x4_16b_bf16 v[156:159], v[168:169], v[184:185], 0
    v_lshlrev_b32_sdwa v138, v15, v126 dst_sel:DWORD dst_unused:UNUSED_PAD src0_sel:DWORD src1_sel:WORD_1
    s_waitcnt vmcnt(12)
    v_mfma_f32_4x4x4_16b_bf16 v[96:99], v[144:145], v[88:89], 0 cbsz:4 abid:11
    s_nop 0
    v_mfma_f32_4x4x4_16b_bf16 v[100:103], v[144:145], v[90:91], 0 cbsz:4 abid:11
    v_lshlrev_b32_sdwa v139, v15, v127 dst_sel:DWORD dst_unused:UNUSED_PAD src0_sel:DWORD src1_sel:WORD_1
    ds_read_u16_d16_hi v134, v138 offset:32768
    ds_read_u16_d16_hi v135, v139 offset:32768
    s_set_gpr_idx_on s61, 0xc
    v_pk_fma_f32 v[16:17], v[128:129], v[104:105], v[16:17] op_sel:[1,0,0] op_sel_hi:[1,1,1]
    v_pk_fma_f32 v[18:19], v[128:129], v[106:107], v[18:19] op_sel:[1,0,0] op_sel_hi:[1,1,1]
    v_pk_fma_f32 v[20:21], v[130:131], v[108:109], v[20:21] op_sel:[1,0,0] op_sel_hi:[1,1,1]
    v_pk_fma_f32 v[22:23], v[130:131], v[110:111], v[22:23] op_sel:[1,0,0] op_sel_hi:[1,1,1]
    s_set_gpr_idx_off
    v_mfma_f32_4x4x4_16b_bf16 v[120:123], v[172:173], v[176:177], 0 cbsz:4 abid:13
    v_lshlrev_b32_sdwa v136, v15, v112 dst_sel:DWORD dst_unused:UNUSED_PAD src0_sel:DWORD src1_sel:WORD_1
    s_waitcnt vmcnt(11)
    v_mfma_f32_4x4x4_16b_bf16 v[104:107], v[146:147], v[92:93], 0 cbsz:4 abid:11
    s_nop 0
    v_mfma_f32_4x4x4_16b_bf16 v[108:111], v[146:147], v[94:95], 0 cbsz:4 abid:11
    v_lshlrev_b32_sdwa v137, v15, v113 dst_sel:DWORD dst_unused:UNUSED_PAD src0_sel:DWORD src1_sel:WORD_1
    ds_read_u16_d16_hi v128, v136 offset:32768
    ds_read_u16_d16_hi v129, v137 offset:32768
    s_waitcnt lgkmcnt(2)
    s_set_gpr_idx_on s62, 0xc
    v_pk_fma_f32 v[16:17], v[132:133], v[96:97], v[16:17] op_sel:[0,0,0] op_sel_hi:[0,1,1]
    v_pk_fma_f32 v[18:19], v[132:133], v[98:99], v[18:19] op_sel:[0,0,0] op_sel_hi:[0,1,1]
    v_pk_fma_f32 v[20:21], v[134:135], v[100:101], v[20:21] op_sel:[0,0,0] op_sel_hi:[0,1,1]
    v_pk_fma_f32 v[22:23], v[134:135], v[102:103], v[22:23] op_sel:[0,0,0] op_sel_hi:[0,1,1]
    s_set_gpr_idx_off
    v_mfma_f32_4x4x4_16b_bf16 v[160:163], v[168:169], v[186:187], 0
    v_lshlrev_b32_sdwa v138, v15, v116 dst_sel:DWORD dst_unused:UNUSED_PAD src0_sel:DWORD src1_sel:WORD_1
    s_waitcnt vmcnt(10)
    v_mfma_f32_4x4x4_16b_bf16 v[96:99], v[140:141], v[64:65], 0 cbsz:4 abid:12
    s_nop 0
    v_mfma_f32_4x4x4_16b_bf16 v[100:103], v[140:141], v[66:67], 0 cbsz:4 abid:12
    v_lshlrev_b32_sdwa v139, v15, v117 dst_sel:DWORD dst_unused:UNUSED_PAD src0_sel:DWORD src1_sel:WORD_1
    ds_read_u16_d16_hi v130, v138 offset:32768
    ds_read_u16_d16_hi v131, v139 offset:32768
    s_set_gpr_idx_on s63, 0xc
    v_pk_fma_f32 v[16:17], v[132:133], v[104:105], v[16:17] op_sel:[1,0,0] op_sel_hi:[1,1,1]
    v_pk_fma_f32 v[18:19], v[132:133], v[106:107], v[18:19] op_sel:[1,0,0] op_sel_hi:[1,1,1]
    v_pk_fma_f32 v[20:21], v[134:135], v[108:109], v[20:21] op_sel:[1,0,0] op_sel_hi:[1,1,1]
    v_pk_fma_f32 v[22:23], v[134:135], v[110:111], v[22:23] op_sel:[1,0,0] op_sel_hi:[1,1,1]
    s_set_gpr_idx_off
B_48:
    s_sub_u32 s32, s32, 4
    s_cbranch_scc1 MAIN_DONE
    v_mfma_f32_4x4x4_16b_bf16 v[124:127], v[172:173], v[178:179], 0 cbsz:4 abid:13
    v_lshlrev_b32_sdwa v136, v15, v114 dst_sel:DWORD dst_unused:UNUSED_PAD src0_sel:DWORD src1_sel:WORD_1
    s_waitcnt vmcnt(13)
    v_mfma_f32_4x4x4_16b_bf16 v[104:107], v[142:143], v[68:69], 0 cbsz:4 abid:12
    s_nop 0
    v_mfma_f32_4x4x4_16b_bf16 v[108:111], v[142:143], v[70:71], 0 cbsz:4 abid:12
    v_lshlrev_b32_sdwa v137, v15, v115 dst_sel:DWORD dst_unused:UNUSED_PAD src0_sel:DWORD src1_sel:WORD_1
    ds_read_u16_d16_hi v132, v136 offset:32768
    ds_read_u16_d16_hi v133, v137 offset:32768
    s_waitcnt lgkmcnt(2)
    s_set_gpr_idx_on s48, 0xc
    v_pk_fma_f32 v[16:17], v[128:129], v[96:97], v[16:17] op_sel:[0,0,0] op_sel_hi:[0,1,1]
    v_pk_fma_f32 v[18:19], v[128:129], v[98:99], v[18:19] op_sel:[0,0,0] op_sel_hi:[0,1,1]
    v_pk_fma_f32 v[20:21], v[130:131], v[100:101], v[20:21] op_sel:[0,0,0] op_sel_hi:[0,1,1]
    v_pk_fma_f32 v[22:23], v[130:131], v[102:103], v[22:23] op_sel:[0,0,0] op_sel_hi:[0,1,1]
    s_set_gpr_idx_off
    v_lshlrev_b32_sdwa v138, v15, v118 dst_sel:DWORD dst_unused:UNUSED_PAD src0_sel:DWORD src1_sel:WORD_1
    s_waitcnt vmcnt(12)
    v_mfma_f32_4x4x4_16b_bf16 v[96:99], v[144:145], v[72:73], 0 cbsz:4 abid:12
    s_nop 0
    v_mfma_f32_4x4x4_16b_bf16 v[100:103], v[144:145], v[74:75], 0 cbsz:4 abid:12
    v_lshlrev_b32_sdwa v139, v15, v119 dst_sel:DWORD dst_unused:UNUSED_PAD src0_sel:DWORD src1_sel:WORD_1
    ds_read_u16_d16_hi v134, v138 offset:32768
    ds_read_u16_d16_hi v135, v139 offset:32768
    s_set_gpr_idx_on s49, 0xc
    v_pk_fma_f32 v[16:17], v[128:129], v[104:105], v[16:17] op_sel:[1,0,0] op_sel_hi:[1,1,1]
    v_pk_fma_f32 v[18:19], v[128:129], v[106:107], v[18:19] op_sel:[1,0,0] op_sel_hi:[1,1,1]
    v_pk_fma_f32 v[20:21], v[130:131], v[108:109], v[20:21] op_sel:[1,0,0] op_sel_hi:[1,1,1]
    v_pk_fma_f32 v[22:23], v[130:131], v[110:111], v[22:23] op_sel:[1,0,0] op_sel_hi:[1,1,1]
    s_set_gpr_idx_off
    v_mfma_f32_4x4x4_16b_bf16 v[112:115], v[172:173], v[176:177], 0 cbsz:4 abid:14
    v_lshlrev_b32_sdwa v136, v15, v120 dst_sel:DWORD dst_unused:UNUSED_PAD src0_sel:DWORD src1_sel:WORD_1
    s_waitcnt vmcnt(11)
    v_mfma_f32_4x4x4_16b_bf16 v[104:107], v[146:147], v[76:77], 0 cbsz:4 abid:12
    s_nop 0
    v_mfma_f32_4x4x4_16b_bf16 v[108:111], v[146:147], v[78:79], 0 cbsz:4 abid:12
    v_lshlrev_b32_sdwa v137, v15, v121 dst_sel:DWORD dst_unused:UNUSED_PAD src0_sel:DWORD src1_sel:WORD_1
    ds_read_u16_d16_hi v128, v136 offset:32768
    ds_read_u16_d16_hi v129, v137 offset:32768
    s_waitcnt lgkmcnt(2)
    s_set_gpr_idx_on s50, 0xc
    v_pk_fma_f32 v[16:17], v[132:133], v[96:97], v[16:17] op_sel:[0,0,0] op_sel_hi:[0,1,1]
    v_pk_fma_f32 v[18:19], v[132:133], v[98:99], v[18:19] op_sel:[0,0,0] op_sel_hi:[0,1,1]
    v_pk_fma_f32 v[20:21], v[134:135], v[100:101], v[20:21] op_sel:[0,0,0] op_sel_hi:[0,1,1]
    v_pk_fma_f32 v[22:23], v[134:135], v[102:103], v[22:23] op_sel:[0,0,0] op_sel_hi:[0,1,1]
    s_set_gpr_idx_off
    v_lshlrev_b32_sdwa v138, v15, v124 dst_sel:DWORD dst_unused:UNUSED_PAD src0_sel:DWORD src1_sel:WORD_1
    s_waitcnt vmcnt(10)
    v_mfma_f32_4x4x4_16b_bf16 v[96:99], v[140:141], v[80:81], 0 cbsz:4 abid:13
    s_nop 0
    v_mfma_f32_4x4x4_16b_bf16 v[100:103], v[140:141], v[82:83], 0 cbsz:4 abid:13
    v_lshlrev_b32_sdwa v139, v15, v125 dst_sel:DWORD dst_unused:UNUSED_PAD src0_sel:DWORD src1_sel:WORD_1
    ds_read_u16_d16_hi v130, v138 offset:32768
    ds_read_u16_d16_hi v131, v139 offset:32768
    s_set_gpr_idx_on s51, 0xc
    v_pk_fma_f32 v[16:17], v[132:133], v[104:105], v[16:17] op_sel:[1,0,0] op_sel_hi:[1,1,1]
    v_pk_fma_f32 v[18:19], v[132:133], v[106:107], v[18:19] op_sel:[1,0,0] op_sel_hi:[1,1,1]
    v_pk_fma_f32 v[20:21], v[134:135], v[108:109], v[20:21] op_sel:[1,0,0] op_sel_hi:[1,1,1]
    v_pk_fma_f32 v[22:23], v[134:135], v[110:111], v[22:23] op_sel:[1,0,0] op_sel_hi:[1,1,1]
    s_set_gpr_idx_off
B_52:
    s_sub_u32 s32, s32, 4
    s_cbranch_scc1 MAIN_DONE
    v_mfma_f32_4x4x4_16b_bf16 v[116:119], v[172:173], v[178:179], 0 cbsz:4 abid:14
    v_lshlrev_b32_sdwa v136, v15, v122 dst_sel:DWORD dst_unused:UNUSED_PAD src0_sel:DWORD src1_sel:WORD_1
    s_waitcnt vmcnt(13)
    v_mfma_f32_4x4x4_16b_bf16 v[104:107], v[142:143], v[84:85], 0 cbsz:4 abid:13
    s_nop 0
    v_mfma_f32_4x4x4_16b_bf16 v[108:111], v[142:143], v[86:87], 0 cbsz:4 abid:13
    v_lshlrev_b32_sdwa v137, v15, v123 dst_sel:DWORD dst_unused:UNUSED_PAD src0_sel:DWORD src1_sel:WORD_1
    ds_read_u16_d16_hi v132, v136 offset:32768
    ds_read_u16_d16_hi v133, v137 offset:32768
    s_waitcnt lgkmcnt(2)
    s_set_gpr_idx_on s52, 0xc
    v_pk_fma_f32 v[16:17], v[128:129], v[96:97], v[16:17] op_sel:[0,0,0] op_sel_hi:[0,1,1]
    v_pk_fma_f32 v[18:19], v[128:129], v[98:99], v[18:19] op_sel:[0,0,0] op_sel_hi:[0,1,1]
    v_pk_fma_f32 v[20:21], v[130:131], v[100:101], v[20:21] op_sel:[0,0,0] op_sel_hi:[0,1,1]
    v_pk_fma_f32 v[22:23], v[130:131], v[102:103], v[22:23] op_sel:[0,0,0] op_sel_hi:[0,1,1]
    s_set_gpr_idx_off
    v_lshlrev_b32_sdwa v138, v15, v126 dst_sel:DWORD dst_unused:UNUSED_PAD src0_sel:DWORD src1_sel:WORD_1
    s_waitcnt vmcnt(12)
    v_mfma_f32_4x4x4_16b_bf16 v[96:99], v[144:145], v[88:89], 0 cbsz:4 abid:13
    s_nop 0
    v_mfma_f32_4x4x4_16b_bf16 v[100:103], v[144:145], v[90:91], 0 cbsz:4 abid:13
    v_lshlrev_b32_sdwa v139, v15, v127 dst_sel:DWORD dst_unused:UNUSED_PAD src0_sel:DWORD src1_sel:WORD_1
    ds_read_u16_d16_hi v134, v138 offset:32768
    ds_read_u16_d16_hi v135, v139 offset:32768
    s_set_gpr_idx_on s53, 0xc
    v_pk_fma_f32 v[16:17], v[128:129], v[104:105], v[16:17] op_sel:[1,0,0] op_sel_hi:[1,1,1]
    v_pk_fma_f32 v[18:19], v[128:129], v[106:107], v[18:19] op_sel:[1,0,0] op_sel_hi:[1,1,1]
    v_pk_fma_f32 v[20:21], v[130:131], v[108:109], v[20:21] op_sel:[1,0,0] op_sel_hi:[1,1,1]
    v_pk_fma_f32 v[22:23], v[130:131], v[110:111], v[22:23] op_sel:[1,0,0] op_sel_hi:[1,1,1]
    s_set_gpr_idx_off
    v_mfma_f32_4x4x4_16b_bf16 v[120:123], v[172:173], v[176:177], 0 cbsz:4 abid:15
    v_lshlrev_b32_sdwa v136, v15, v112 dst_sel:DWORD dst_unused:UNUSED_PAD src0_sel:DWORD src1_sel:WORD_1
    s_waitcnt vmcnt(11)
    v_mfma_f32_4x4x4_16b_bf16 v[104:107], v[146:147], v[92:93], 0 cbsz:4 abid:13
    s_nop 0
    v_mfma_f32_4x4x4_16b_bf16 v[108:111], v[146:147], v[94:95], 0 cbsz:4 abid:13
    v_lshlrev_b32_sdwa v137, v15, v113 dst_sel:DWORD dst_unused:UNUSED_PAD src0_sel:DWORD src1_sel:WORD_1
    ds_read_u16_d16_hi v128, v136 offset:32768
    ds_read_u16_d16_hi v129, v137 offset:32768
    s_waitcnt lgkmcnt(2)
    s_set_gpr_idx_on s54, 0xc
    v_pk_fma_f32 v[16:17], v[132:133], v[96:97], v[16:17] op_sel:[0,0,0] op_sel_hi:[0,1,1]
    v_pk_fma_f32 v[18:19], v[132:133], v[98:99], v[18:19] op_sel:[0,0,0] op_sel_hi:[0,1,1]
    v_pk_fma_f32 v[20:21], v[134:135], v[100:101], v[20:21] op_sel:[0,0,0] op_sel_hi:[0,1,1]
    v_pk_fma_f32 v[22:23], v[134:135], v[102:103], v[22:23] op_sel:[0,0,0] op_sel_hi:[0,1,1]
    s_set_gpr_idx_off
    v_lshlrev_b32_sdwa v138, v15, v116 dst_sel:DWORD dst_unused:UNUSED_PAD src0_sel:DWORD src1_sel:WORD_1
    s_waitcnt vmcnt(10)
    v_mfma_f32_4x4x4_16b_bf16 v[96:99], v[140:141], v[64:65], 0 cbsz:4 abid:14
    s_nop 0
    v_mfma_f32_4x4x4_16b_bf16 v[100:103], v[140:141], v[66:67], 0 cbsz:4 abid:14
    v_lshlrev_b32_sdwa v139, v15, v117 dst_sel:DWORD dst_unused:UNUSED_PAD src0_sel:DWORD src1_sel:WORD_1
    ds_read_u16_d16_hi v130, v138 offset:32768
    ds_read_u16_d16_hi v131, v139 offset:32768
    s_set_gpr_idx_on s55, 0xc
    v_pk_fma_f32 v[16:17], v[132:133], v[104:105], v[16:17] op_sel:[1,0,0] op_sel_hi:[1,1,1]
    v_pk_fma_f32 v[18:19], v[132:133], v[106:107], v[18:19] op_sel:[1,0,0] op_sel_hi:[1,1,1]
    v_pk_fma_f32 v[20:21], v[134:135], v[108:109], v[20:21] op_sel:[1,0,0] op_sel_hi:[1,1,1]
    v_pk_fma_f32 v[22:23], v[134:135], v[110:111], v[22:23] op_sel:[1,0,0] op_sel_hi:[1,1,1]
    s_set_gpr_idx_off
B_56:
    s_sub_u32 s32, s32, 4
    s_cbranch_scc1 MAIN_DONE
    v_mfma_f32_4x4x4_16b_bf16 v[124:127], v[172:173], v[178:179], 0 cbsz:4 abid:15
    v_lshlrev_b32_sdwa v136, v15, v114 dst_sel:DWORD dst_unused:UNUSED_PAD src0_sel:DWORD src1_sel:WORD_1
    s_waitcnt vmcnt(13)
    v_mfma_f32_4x4x4_16b_bf16 v[104:107], v[142:143], v[68:69], 0 cbsz:4 abid:14
    s_nop 0
    v_mfma_f32_4x4x4_16b_bf16 v[108:111], v[142:143], v[70:71], 0 cbsz:4 abid:14
    v_lshlrev_b32_sdwa v137, v15, v115 dst_sel:DWORD dst_unused:UNUSED_PAD src0_sel:DWORD src1_sel:WORD_1
    ds_read_u16_d16_hi v132, v136 offset:32768
    ds_read_u16_d16_hi v133, v137 offset:32768
    s_waitcnt lgkmcnt(2)
    s_set_gpr_idx_on s56, 0xc
    v_pk_fma_f32 v[16:17], v[128:129], v[96:97], v[16:17] op_sel:[0,0,0] op_sel_hi:[0,1,1]
    v_pk_fma_f32 v[18:19], v[128:129], v[98:99], v[18:19] op_sel:[0,0,0] op_sel_hi:[0,1,1]
    v_pk_fma_f32 v[20:21], v[130:131], v[100:101], v[20:21] op_sel:[0,0,0] op_sel_hi:[0,1,1]
    v_pk_fma_f32 v[22:23], v[130:131], v[102:103], v[22:23] op_sel:[0,0,0] op_sel_hi:[0,1,1]
    s_set_gpr_idx_off
    v_lshlrev_b32_sdwa v138, v15, v118 dst_sel:DWORD dst_unused:UNUSED_PAD src0_sel:DWORD src1_sel:WORD_1
    s_waitcnt vmcnt(12)
    v_mfma_f32_4x4x4_16b_bf16 v[96:99], v[144:145], v[72:73], 0 cbsz:4 abid:14
    s_nop 0
    v_mfma_f32_4x4x4_16b_bf16 v[100:103], v[144:145], v[74:75], 0 cbsz:4 abid:14
    v_lshlrev_b32_sdwa v139, v15, v119 dst_sel:DWORD dst_unused:UNUSED_PAD src0_sel:DWORD src1_sel:WORD_1
    ds_read_u16_d16_hi v134, v138 offset:32768
    ds_read_u16_d16_hi v135, v139 offset:32768
    s_set_gpr_idx_on s57, 0xc
    v_pk_fma_f32 v[16:17], v[128:129], v[104:105], v[16:17] op_sel:[1,0,0] op_sel_hi:[1,1,1]
    v_pk_fma_f32 v[18:19], v[128:129], v[106:107], v[18:19] op_sel:[1,0,0] op_sel_hi:[1,1,1]
    v_pk_fma_f32 v[20:21], v[130:131], v[108:109], v[20:21] op_sel:[1,0,0] op_sel_hi:[1,1,1]
    v_pk_fma_f32 v[22:23], v[130:131], v[110:111], v[22:23] op_sel:[1,0,0] op_sel_hi:[1,1,1]
    s_set_gpr_idx_off
    v_mov_b32 v172, v170
    v_mov_b32 v173, v171
    s_nop 1
    v_mfma_f32_4x4x4_16b_bf16 v[112:115], v[172:173], v[176:177], 0 cbsz:4 abid:0
    v_lshlrev_b32_sdwa v136, v15, v120 dst_sel:DWORD dst_unused:UNUSED_PAD src0_sel:DWORD src1_sel:WORD_1
    s_waitcnt vmcnt(11)
    v_mfma_f32_4x4x4_16b_bf16 v[104:107], v[146:147], v[76:77], 0 cbsz:4 abid:14
    s_nop 0
    v_mfma_f32_4x4x4_16b_bf16 v[108:111], v[146:147], v[78:79], 0 cbsz:4 abid:14
    v_lshlrev_b32_sdwa v137, v15, v121 dst_sel:DWORD dst_unused:UNUSED_PAD src0_sel:DWORD src1_sel:WORD_1
    ds_read_u16_d16_hi v128, v136 offset:32768
    ds_read_u16_d16_hi v129, v137 offset:32768
    s_waitcnt lgkmcnt(2)
    s_set_gpr_idx_on s58, 0xc
    v_pk_fma_f32 v[16:17], v[132:133], v[96:97], v[16:17] op_sel:[0,0,0] op_sel_hi:[0,1,1]
    v_pk_fma_f32 v[18:19], v[132:133], v[98:99], v[18:19] op_sel:[0,0,0] op_sel_hi:[0,1,1]
    v_pk_fma_f32 v[20:21], v[134:135], v[100:101], v[20:21] op_sel:[0,0,0] op_sel_hi:[0,1,1]
    v_pk_fma_f32 v[22:23], v[134:135], v[102:103], v[22:23] op_sel:[0,0,0] op_sel_hi:[0,1,1]
    s_set_gpr_idx_off
    v_lshlrev_b32_sdwa v138, v15, v124 dst_sel:DWORD dst_unused:UNUSED_PAD src0_sel:DWORD src1_sel:WORD_1
    s_waitcnt vmcnt(10)
    v_mfma_f32_4x4x4_16b_bf16 v[96:99], v[140:141], v[80:81], 0 cbsz:4 abid:15
    s_nop 0
    v_mfma_f32_4x4x4_16b_bf16 v[100:103], v[140:141], v[82:83], 0 cbsz:4 abid:15
    v_lshlrev_b32_sdwa v139, v15, v125 dst_sel:DWORD dst_unused:UNUSED_PAD src0_sel:DWORD src1_sel:WORD_1
    ds_read_u16_d16_hi v130, v138 offset:32768
    ds_read_u16_d16_hi v131, v139 offset:32768
    s_set_gpr_idx_on s59, 0xc
    v_pk_fma_f32 v[16:17], v[132:133], v[104:105], v[16:17] op_sel:[1,0,0] op_sel_hi:[1,1,1]
    v_pk_fma_f32 v[18:19], v[132:133], v[106:107], v[18:19] op_sel:[1,0,0] op_sel_hi:[1,1,1]
    v_pk_fma_f32 v[20:21], v[134:135], v[108:109], v[20:21] op_sel:[1,0,0] op_sel_hi:[1,1,1]
    v_pk_fma_f32 v[22:23], v[134:135], v[110:111], v[22:23] op_sel:[1,0,0] op_sel_hi:[1,1,1]
    s_set_gpr_idx_off
B_60:
    s_sub_u32 s32, s32, 4
    s_cbranch_scc1 MAIN_DONE
    v_mfma_f32_4x4x4_16b_bf16 v[116:119], v[172:173], v[178:179], 0 cbsz:4 abid:0
    v_lshlrev_b32_sdwa v136, v15, v122 dst_sel:DWORD dst_unused:UNUSED_PAD src0_sel:DWORD src1_sel:WORD_1
    s_waitcnt vmcnt(13)
    v_mfma_f32_4x4x4_16b_bf16 v[104:107], v[142:143], v[84:85], 0 cbsz:4 abid:15
    s_nop 0
    v_mfma_f32_4x4x4_16b_bf16 v[108:111], v[142:143], v[86:87], 0 cbsz:4 abid:15
    v_lshlrev_b32_sdwa v137, v15, v123 dst_sel:DWORD dst_unused:UNUSED_PAD src0_sel:DWORD src1_sel:WORD_1
    ds_read_u16_d16_hi v132, v136 offset:32768
    ds_read_u16_d16_hi v133, v137 offset:32768
    v_cvt_pk_bf16_f32 v140, v148, v152
    v_cvt_pk_bf16_f32 v141, v156, v160
    s_waitcnt lgkmcnt(2)
    s_set_gpr_idx_on s60, 0xc
    v_pk_fma_f32 v[16:17], v[128:129], v[96:97], v[16:17] op_sel:[0,0,0] op_sel_hi:[0,1,1]
    v_pk_fma_f32 v[18:19], v[128:129], v[98:99], v[18:19] op_sel:[0,0,0] op_sel_hi:[0,1,1]
    v_pk_fma_f32 v[20:21], v[130:131], v[100:101], v[20:21] op_sel:[0,0,0] op_sel_hi:[0,1,1]
    v_pk_fma_f32 v[22:23], v[130:131], v[102:103], v[22:23] op_sel:[0,0,0] op_sel_hi:[0,1,1]
    s_set_gpr_idx_off
    v_lshlrev_b32_sdwa v138, v15, v126 dst_sel:DWORD dst_unused:UNUSED_PAD src0_sel:DWORD src1_sel:WORD_1
    s_waitcnt vmcnt(12)
    v_mfma_f32_4x4x4_16b_bf16 v[96:99], v[144:145], v[88:89], 0 cbsz:4 abid:15
    s_nop 0
    v_mfma_f32_4x4x4_16b_bf16 v[100:103], v[144:145], v[90:91], 0 cbsz:4 abid:15
    v_lshlrev_b32_sdwa v139, v15, v127 dst_sel:DWORD dst_unused:UNUSED_PAD src0_sel:DWORD src1_sel:WORD_1
    ds_read_u16_d16_hi v134, v138 offset:32768
    ds_read_u16_d16_hi v135, v139 offset:32768
    v_cvt_pk_bf16_f32 v142, v149, v153
    v_cvt_pk_bf16_f32 v143, v157, v161
    s_set_gpr_idx_on s61, 0xc
    v_pk_fma_f32 v[16:17], v[128:129], v[104:105], v[16:17] op_sel:[1,0,0] op_sel_hi:[1,1,1]
    v_pk_fma_f32 v[18:19], v[128:129], v[106:107], v[18:19] op_sel:[1,0,0] op_sel_hi:[1,1,1]
    v_pk_fma_f32 v[20:21], v[130:131], v[108:109], v[20:21] op_sel:[1,0,0] op_sel_hi:[1,1,1]
    v_pk_fma_f32 v[22:23], v[130:131], v[110:111], v[22:23] op_sel:[1,0,0] op_sel_hi:[1,1,1]
    s_set_gpr_idx_off
    v_mfma_f32_4x4x4_16b_bf16 v[120:123], v[172:173], v[176:177], 0 cbsz:4 abid:1
    v_lshlrev_b32_sdwa v136, v15, v112 dst_sel:DWORD dst_unused:UNUSED_PAD src0_sel:DWORD src1_sel:WORD_1
    s_waitcnt vmcnt(11)
    v_mfma_f32_4x4x4_16b_bf16 v[104:107], v[146:147], v[92:93], 0 cbsz:4 abid:15
    s_nop 0
    v_mfma_f32_4x4x4_16b_bf16 v[108:111], v[146:147], v[94:95], 0 cbsz:4 abid:15
    v_lshlrev_b32_sdwa v137, v15, v113 dst_sel:DWORD dst_unused:UNUSED_PAD src0_sel:DWORD src1_sel:WORD_1
    ds_read_u16_d16_hi v128, v136 offset:32768
    ds_read_u16_d16_hi v129, v137 offset:32768
    v_cvt_pk_bf16_f32 v144, v150, v154
    v_cvt_pk_bf16_f32 v145, v158, v162
    s_waitcnt lgkmcnt(2)
    s_set_gpr_idx_on s62, 0xc
    v_pk_fma_f32 v[16:17], v[132:133], v[96:97], v[16:17] op_sel:[0,0,0] op_sel_hi:[0,1,1]
    v_pk_fma_f32 v[18:19], v[132:133], v[98:99], v[18:19] op_sel:[0,0,0] op_sel_hi:[0,1,1]
    v_pk_fma_f32 v[20:21], v[134:135], v[100:101], v[20:21] op_sel:[0,0,0] op_sel_hi:[0,1,1]
    v_pk_fma_f32 v[22:23], v[134:135], v[102:103], v[22:23] op_sel:[0,0,0] op_sel_hi:[0,1,1]
    s_set_gpr_idx_off
    v_lshlrev_b32_sdwa v138, v15, v116 dst_sel:DWORD dst_unused:UNUSED_PAD src0_sel:DWORD src1_sel:WORD_1
    s_waitcnt vmcnt(10)
    v_mfma_f32_4x4x4_16b_bf16 v[96:99], v[140:141], v[64:65], 0 cbsz:4 abid:0
    s_nop 0
    v_mfma_f32_4x4x4_16b_bf16 v[100:103], v[140:141], v[66:67], 0 cbsz:4 abid:0
    v_lshlrev_b32_sdwa v139, v15, v117 dst_sel:DWORD dst_unused:UNUSED_PAD src0_sel:DWORD src1_sel:WORD_1
    ds_read_u16_d16_hi v130, v138 offset:32768
    ds_read_u16_d16_hi v131, v139 offset:32768
    v_cvt_pk_bf16_f32 v146, v151, v155
    v_cvt_pk_bf16_f32 v147, v159, v163
    s_set_gpr_idx_on s63, 0xc
    v_pk_fma_f32 v[16:17], v[132:133], v[104:105], v[16:17] op_sel:[1,0,0] op_sel_hi:[1,1,1]
    v_pk_fma_f32 v[18:19], v[132:133], v[106:107], v[18:19] op_sel:[1,0,0] op_sel_hi:[1,1,1]
    v_pk_fma_f32 v[20:21], v[134:135], v[108:109], v[20:21] op_sel:[1,0,0] op_sel_hi:[1,1,1]
    v_pk_fma_f32 v[22:23], v[134:135], v[110:111], v[22:23] op_sel:[1,0,0] op_sel_hi:[1,1,1]
    s_set_gpr_idx_off
    v_mov_b32 v164, v165
    s_branch B_0
MAIN_DONE:
    s_waitcnt vmcnt(0) lgkmcnt(0)
    s_add_u32 s27, s27, 1472
    s_cmp_ge_u32 s27, s26
    s_cbranch_scc1 ALL_DONE
    v_lshlrev_b32 v11, 2, v0
    v_mov_b32 v12, 0
    v_cmp_gt_u32 vcc, 480, v0
    s_and_saveexec_b64 s[42:43], vcc
    ds_write_b32 v11, v12 offset:0
    s_mov_b64 exec, s[42:43]
    s_waitcnt lgkmcnt(0)
    s_barrier
    s_branch ROUND
ALL_DONE:
    v_cvt_pk_bf16_f32 v64, v16, v20
    v_cvt_pk_bf16_f32 v65, v17, v21
    v_cvt_pk_bf16_f32 v66, v18, v22
    v_cvt_pk_bf16_f32 v67, v19, v23
    v_cvt_pk_bf16_f32 v68, v24, v28
    v_cvt_pk_bf16_f32 v69, v25, v29
    v_cvt_pk_bf16_f32 v70, v26, v30
    v_cvt_pk_bf16_f32 v71, v27, v31
    v_cvt_pk_bf16_f32 v72, v32, v36
    v_cvt_pk_bf16_f32 v73, v33, v37
    v_cvt_pk_bf16_f32 v74, v34, v38
    v_cvt_pk_bf16_f32 v75, v35, v39
    v_cvt_pk_bf16_f32 v76, v40, v44
    v_cvt_pk_bf16_f32 v77, v41, v45
    v_cvt_pk_bf16_f32 v78, v42, v46
    v_cvt_pk_bf16_f32 v79, v43, v47
    v_cvt_pk_bf16_f32 v80, v48, v52
    v_cvt_pk_bf16_f32 v81, v49, v53
    v_cvt_pk_bf16_f32 v82, v50, v54
    v_cvt_pk_bf16_f32 v83, v51, v55
    v_lshrrev_b32 v8, 2, v1
    v_add_u32 v8, 32768, v8
    s_mul_i32 s42, s4, 1152
    v_add_u32 v96, s42, v8
    s_mul_i32 s42, s5, 1152
    v_add_u32 v97, s42, v8
    s_mul_i32 s42, s6, 1152
    v_add_u32 v98, s42, v8
    s_mul_i32 s42, s7, 1152
    v_add_u32 v99, s42, v8
    s_mul_i32 s42, s8, 1152
    v_add_u32 v100, s42, v8
    v_lshrrev_b32 v9, 4, v1
    v_and_b32 v10, 15, v9
    v_lshrrev_b32 v11, 4, v9
    s_lshr_b32 s42, s25, 2
    s_mul_i32 s43, s42, 23040
    s_add_u32 s43, s43, 32768
    v_mul_u32_u24 v8, 288, v10
    v_lshl_add_u32 v8, v11, 4, v8
    v_add_u32 v8, s43, v8
    s_mul_i32 s42, s42, 5242880
    s_lshl_b32 s43, s24, 10
    s_add_u32 s42, s42, s43
    s_and_b32 s43, s25, 3
    s_lshl_b32 s43, s43, 8
    s_add_u32 s42, s42, s43
    v_lshlrev_b32 v11, 18, v11
    v_lshl_add_u32 v11, v10, 4, v11
    v_add_u32 v11, s42, v11
    s_barrier
    ds_write_b32 v96, v64 offset:0
    ds_write_b32 v96, v65 offset:288
    ds_write_b32 v96, v66 offset:576
    ds_write_b32 v96, v67 offset:864
    ds_write_b32 v97, v68 offset:0
    ds_write_b32 v97, v69 offset:288
    ds_write_b32 v97, v70 offset:576
    ds_write_b32 v97, v71 offset:864
    ds_write_b32 v98, v72 offset:0
    ds_write_b32 v98, v73 offset:288
    ds_write_b32 v98, v74 offset:576
    ds_write_b32 v98, v75 offset:864
    ds_write_b32 v99, v76 offset:0
    ds_write_b32 v99, v77 offset:288
    ds_write_b32 v99, v78 offset:576
    ds_write_b32 v99, v79 offset:864
    ds_write_b32 v100, v80 offset:0
    ds_write_b32 v100, v81 offset:288
    ds_write_b32 v100, v82 offset:576
    ds_write_b32 v100, v83 offset:864
    s_waitcnt lgkmcnt(0)
    s_barrier
    ds_read_b128 v[64:67], v8 offset:0
    ds_read_b128 v[68:71], v8 offset:64
    ds_read_b128 v[72:75], v8 offset:128
    ds_read_b128 v[76:79], v8 offset:192
    ds_read_b128 v[80:83], v8 offset:4608
    ds_read_b128 v[84:87], v8 offset:4672
    ds_read_b128 v[88:91], v8 offset:4736
    ds_read_b128 v[92:95], v8 offset:4800
    s_waitcnt lgkmcnt(7)
    v_mfma_f32_16x16x32_bf16 v[16:19], v[64:67], v[188:191], 0
    v_mfma_f32_16x16x32_bf16 v[20:23], v[64:67], v[204:207], 0
    s_waitcnt lgkmcnt(6)
    v_mfma_f32_16x16x32_bf16 v[16:19], v[68:71], v[192:195], v[16:19]
    v_mfma_f32_16x16x32_bf16 v[20:23], v[68:71], v[208:211], v[20:23]
    s_waitcnt lgkmcnt(5)
    v_mfma_f32_16x16x32_bf16 v[16:19], v[72:75], v[196:199], v[16:19]
    v_mfma_f32_16x16x32_bf16 v[20:23], v[72:75], v[212:215], v[20:23]
    s_waitcnt lgkmcnt(4)
    v_mfma_f32_16x16x32_bf16 v[16:19], v[76:79], v[200:203], v[16:19]
    v_mfma_f32_16x16x32_bf16 v[20:23], v[76:79], v[216:219], v[20:23]
    ds_read_b128 v[64:67], v8 offset:9216
    ds_read_b128 v[68:71], v8 offset:9280
    ds_read_b128 v[72:75], v8 offset:9344
    ds_read_b128 v[76:79], v8 offset:9408
    s_waitcnt lgkmcnt(7)
    v_mfma_f32_16x16x32_bf16 v[24:27], v[80:83], v[188:191], 0
    v_mfma_f32_16x16x32_bf16 v[28:31], v[80:83], v[204:207], 0
    s_waitcnt lgkmcnt(6)
    v_mfma_f32_16x16x32_bf16 v[24:27], v[84:87], v[192:195], v[24:27]
    v_mfma_f32_16x16x32_bf16 v[28:31], v[84:87], v[208:211], v[28:31]
    s_waitcnt lgkmcnt(5)
    v_mfma_f32_16x16x32_bf16 v[24:27], v[88:91], v[196:199], v[24:27]
    v_mfma_f32_16x16x32_bf16 v[28:31], v[88:91], v[212:215], v[28:31]
    s_waitcnt lgkmcnt(4)
    v_mfma_f32_16x16x32_bf16 v[24:27], v[92:95], v[200:203], v[24:27]
    v_mfma_f32_16x16x32_bf16 v[28:31], v[92:95], v[216:219], v[28:31]
    v_cvt_pk_bf16_f32 v128, v16, v17
    v_cvt_pk_bf16_f32 v129, v18, v19
    v_cvt_pk_bf16_f32 v130, v20, v21
    v_cvt_pk_bf16_f32 v131, v22, v23
    buffer_store_dwordx4 v[128:131], v11, s[20:23], 0 offen sc0 sc1
    v_add_u32 v11, 1048576, v11
    ds_read_b128 v[80:83], v8 offset:13824
    ds_read_b128 v[84:87], v8 offset:13888
    ds_read_b128 v[88:91], v8 offset:13952
    ds_read_b128 v[92:95], v8 offset:14016
    s_waitcnt lgkmcnt(7)
    v_mfma_f32_16x16x32_bf16 v[32:35], v[64:67], v[188:191], 0
    v_mfma_f32_16x16x32_bf16 v[36:39], v[64:67], v[204:207], 0
    s_waitcnt lgkmcnt(6)
    v_mfma_f32_16x16x32_bf16 v[32:35], v[68:71], v[192:195], v[32:35]
    v_mfma_f32_16x16x32_bf16 v[36:39], v[68:71], v[208:211], v[36:39]
    s_waitcnt lgkmcnt(5)
    v_mfma_f32_16x16x32_bf16 v[32:35], v[72:75], v[196:199], v[32:35]
    v_mfma_f32_16x16x32_bf16 v[36:39], v[72:75], v[212:215], v[36:39]
    s_waitcnt lgkmcnt(4)
    v_mfma_f32_16x16x32_bf16 v[32:35], v[76:79], v[200:203], v[32:35]
    v_mfma_f32_16x16x32_bf16 v[36:39], v[76:79], v[216:219], v[36:39]
    v_cvt_pk_bf16_f32 v132, v24, v25
    v_cvt_pk_bf16_f32 v133, v26, v27
    v_cvt_pk_bf16_f32 v134, v28, v29
    v_cvt_pk_bf16_f32 v135, v30, v31
    buffer_store_dwordx4 v[132:135], v11, s[20:23], 0 offen sc0 sc1
    v_add_u32 v11, 1048576, v11
    ds_read_b128 v[64:67], v8 offset:18432
    ds_read_b128 v[68:71], v8 offset:18496
    ds_read_b128 v[72:75], v8 offset:18560
    ds_read_b128 v[76:79], v8 offset:18624
    s_waitcnt lgkmcnt(7)
    v_mfma_f32_16x16x32_bf16 v[40:43], v[80:83], v[188:191], 0
    v_mfma_f32_16x16x32_bf16 v[44:47], v[80:83], v[204:207], 0
    s_waitcnt lgkmcnt(6)
    v_mfma_f32_16x16x32_bf16 v[40:43], v[84:87], v[192:195], v[40:43]
    v_mfma_f32_16x16x32_bf16 v[44:47], v[84:87], v[208:211], v[44:47]
    s_waitcnt lgkmcnt(5)
    v_mfma_f32_16x16x32_bf16 v[40:43], v[88:91], v[196:199], v[40:43]
    v_mfma_f32_16x16x32_bf16 v[44:47], v[88:91], v[212:215], v[44:47]
    s_waitcnt lgkmcnt(4)
    v_mfma_f32_16x16x32_bf16 v[40:43], v[92:95], v[200:203], v[40:43]
    v_mfma_f32_16x16x32_bf16 v[44:47], v[92:95], v[216:219], v[44:47]
    v_cvt_pk_bf16_f32 v128, v32, v33
    v_cvt_pk_bf16_f32 v129, v34, v35
    v_cvt_pk_bf16_f32 v130, v36, v37
    v_cvt_pk_bf16_f32 v131, v38, v39
    buffer_store_dwordx4 v[128:131], v11, s[20:23], 0 offen sc0 sc1
    v_add_u32 v11, 1048576, v11
    s_waitcnt lgkmcnt(3)
    v_mfma_f32_16x16x32_bf16 v[48:51], v[64:67], v[188:191], 0
    v_mfma_f32_16x16x32_bf16 v[52:55], v[64:67], v[204:207], 0
    s_waitcnt lgkmcnt(2)
    v_mfma_f32_16x16x32_bf16 v[48:51], v[68:71], v[192:195], v[48:51]
    v_mfma_f32_16x16x32_bf16 v[52:55], v[68:71], v[208:211], v[52:55]
    s_waitcnt lgkmcnt(1)
    v_mfma_f32_16x16x32_bf16 v[48:51], v[72:75], v[196:199], v[48:51]
    v_mfma_f32_16x16x32_bf16 v[52:55], v[72:75], v[212:215], v[52:55]
    s_waitcnt lgkmcnt(0)
    v_mfma_f32_16x16x32_bf16 v[48:51], v[76:79], v[200:203], v[48:51]
    v_mfma_f32_16x16x32_bf16 v[52:55], v[76:79], v[216:219], v[52:55]
    v_cvt_pk_bf16_f32 v132, v40, v41
    v_cvt_pk_bf16_f32 v133, v42, v43
    v_cvt_pk_bf16_f32 v134, v44, v45
    v_cvt_pk_bf16_f32 v135, v46, v47
    buffer_store_dwordx4 v[132:135], v11, s[20:23], 0 offen sc0 sc1
    v_add_u32 v11, 1048576, v11
    s_nop 7
    v_cvt_pk_bf16_f32 v128, v48, v49
    v_cvt_pk_bf16_f32 v129, v50, v51
    v_cvt_pk_bf16_f32 v130, v52, v53
    v_cvt_pk_bf16_f32 v131, v54, v55
    buffer_store_dwordx4 v[128:131], v11, s[20:23], 0 offen sc0 sc1
END:
    s_endpgm
.section .rodata,"a"
.p2align 6
.amdhsa_kernel gather_scatter__tensor_product_equiv_tfn__graph_kernel
  .amdhsa_next_free_vgpr 220
  .amdhsa_next_free_sgpr 66
  .amdhsa_accum_offset 220
  .amdhsa_group_segment_fixed_size 0
  .amdhsa_kernarg_size 88
  .amdhsa_user_sgpr_count 2
  .amdhsa_user_sgpr_kernarg_segment_ptr 1
  .amdhsa_system_sgpr_workgroup_id_x 1
  .amdhsa_float_denorm_mode_32 3
.end_amdhsa_kernel
```

```asm
; @launch grid=(256,1,1) block=(512,1,1) lds=163840
.amdgcn_target "amdgcn-amd-amdhsa--gfx950"
.text
.globl gather_scatter__tensor_product_equiv_tfn__graph_kernel
.p2align 8
.type gather_scatter__tensor_product_equiv_tfn__graph_kernel,@function
gather_scatter__tensor_product_equiv_tfn__graph_kernel:
    s_cmp_ge_u32 s2, 256
    s_cbranch_scc1 END
    s_load_dwordx16 s[40:55], s[0:1], 0
    s_load_dwordx2 s[16:17], s[0:1], 80
    s_load_dwordx2 s[12:13], s[0:1], 0
    s_load_dwordx2 s[20:21], s[0:1], 64
    s_getpc_b64 s[6:7]
CODE_HERE:
    v_lshrrev_b32 v8, 6, v0
    s_lshr_b32 s5, s2, 3
    s_lshl_b32 s4, s5, 10
    v_readfirstlane_b32 s25, v8
    v_and_b32 v10, 7, v0
    v_lshl_add_u32 v10, v10, 7, s4
    v_min_u32 v10, END-CODE_HERE, v10
    s_cmp_lg_u32 s25, 7
    s_cbranch_scc1 NO_CODE_TOUCH
    global_load_dword v167, v10, s[6:7]
NO_CODE_TOUCH:
    s_mul_i32 s3, s2, 5120
    v_lshl_add_u32 v8, v0, 4, s3
    v_and_b32 v10, 63, v0
    v_lshlrev_b32 v1, 4, v10
    v_lshlrev_b32 v193, 2, v10
    s_cmp_ge_u32 s25, 5
    s_cselect_b32 s3, 250, s2
    s_cmp_ge_u32 s3, 250
    s_waitcnt lgkmcnt(0)
    s_cbranch_scc1 NO_EDGES
    s_setprio 1
    global_load_dwordx4 v[64:67], v8, s[44:45]
    global_load_dwordx4 v[68:71], v8, s[42:43]
NO_EDGES:
    global_load_dword v188, v193, s[50:51] offset:0
    global_load_dword v189, v193, s[50:51] offset:256
    global_load_dword v190, v193, s[50:51] offset:512
    global_load_dword v191, v193, s[50:51] offset:768
    v_and_b32 v193, 0x7f, v193
    global_load_dword v192, v193, s[52:53]
    v_lshlrev_b32 v9, 1, v8
    v_lshlrev_b32 v11, 3, v0
    v_mov_b32 v12, 0
    v_mov_b32 v13, 0
    ds_write_b64 v11, v[12:13]
    s_and_b32 s4, s2, 7
    s_lshl_b32 s4, s4, 5
    s_lshr_b32 s5, s2, 3
    s_or_b32 s24, s4, s5
    v_mov_b32 v15, 1
    s_mov_b32 s14, 10240000
    s_mov_b32 s15, 0x20000
    s_mov_b32 s18, 8650880
    s_mov_b32 s19, 0x20000
    s_mov_b32 s22, 10240000
    s_mov_b32 s23, 0x20000
    s_mov_b32 s34, 0xfffffc00
    s_mov_b32 s27, 0
    s_mov_b32 s10, 0xbfb8aa3b
    s_mov_b32 s11, 0xbfb8aa3b
    v_mul_u32_u24 v14, 52, v10
    v_lshrrev_b32 v14, 8, v14
    v_mul_u32_u24 v7, 5, v14
    v_sub_u32 v7, v10, v7
    v_lshlrev_b32 v14, 2, v14
    v_lshlrev_b32 v7, 2, v7
    s_mov_b32 s35, 2097152
    v_and_b32 v4, 0xff, v0
    s_lshl_b32 s3, s24, 3
    s_add_u32 s3, s3, 7864320
    v_lshl_add_u32 v6, v4, 11, s3
    s_and_b32 s3, s2, 7
    s_lshl_b32 s3, s3, 7
    s_add_u32 s3, s3, 8388608
    s_lshl_b32 s8, s25, 15
    s_add_u32 s3, s3, s8
    v_and_b32 v166, 31, v0
    v_lshl_add_u32 v166, v166, 10, s3
    v_mul_u32_u24 v4, 1280, v4
    v_mul_u32_u24 v138, 0x8000, v1
    v_lshl_add_u32 v138, v10, 3, v138
    v_pk_mov_b32 v[16:17], v[12:13], v[12:13]
    v_pk_mov_b32 v[18:19], v[12:13], v[12:13]
    v_pk_mov_b32 v[20:21], v[12:13], v[12:13]
    v_pk_mov_b32 v[22:23], v[12:13], v[12:13]
    v_pk_mov_b32 v[24:25], v[12:13], v[12:13]
    v_pk_mov_b32 v[26:27], v[12:13], v[12:13]
    v_pk_mov_b32 v[28:29], v[12:13], v[12:13]
    v_pk_mov_b32 v[30:31], v[12:13], v[12:13]
    v_pk_mov_b32 v[32:33], v[12:13], v[12:13]
    v_pk_mov_b32 v[34:35], v[12:13], v[12:13]
    v_pk_mov_b32 v[36:37], v[12:13], v[12:13]
    v_pk_mov_b32 v[38:39], v[12:13], v[12:13]
    v_pk_mov_b32 v[40:41], v[12:13], v[12:13]
    v_pk_mov_b32 v[42:43], v[12:13], v[12:13]
    v_pk_mov_b32 v[44:45], v[12:13], v[12:13]
    v_pk_mov_b32 v[46:47], v[12:13], v[12:13]
    v_pk_mov_b32 v[48:49], v[12:13], v[12:13]
    v_pk_mov_b32 v[50:51], v[12:13], v[12:13]
    v_pk_mov_b32 v[52:53], v[12:13], v[12:13]
    v_pk_mov_b32 v[54:55], v[12:13], v[12:13]
    v_pk_mov_b32 v[56:57], v[12:13], v[12:13]
    v_pk_mov_b32 v[58:59], v[12:13], v[12:13]
    v_pk_mov_b32 v[60:61], v[12:13], v[12:13]
    v_pk_mov_b32 v[62:63], v[12:13], v[12:13]
    s_waitcnt lgkmcnt(0)
    s_add_u32 s4, s16, 8650752
    s_addc_u32 s5, s17, 0
    s_load_dwordx2 s[64:65], s[4:5], 0
    s_barrier
    s_cmp_ge_u32 s25, 5
    s_cbranch_scc1 HELP
    s_add_u32 s62, s25, 1
LUTP_W0L:
    s_mul_i32 s3, s62, 33554944
    s_add_u32 s3, s3, 4286709632
    v_add_u32 v128, s3, v138
    s_lshl_b32 s3, s62, 10
    v_add_u32 v136, s3, v1
    v_add_u32 v129, 131074, v128
    v_add_u32 v130, 262148, v128
    v_add_u32 v131, 393222, v128
    v_add_u32 v137, 0x10000, v136
    v_or_b32 v132, 0x80008000, v128
    v_or_b32 v133, 0x80008000, v129
    v_or_b32 v134, 0x80008000, v130
    v_or_b32 v135, 0x80008000, v131
    ds_write_b128 v136, v[128:131] offset:32768
    ds_write_b128 v137, v[132:135] offset:32768
    s_add_u32 s62, s62, 5
    s_cmp_le_u32 s62, 5
    s_cbranch_scc1 LUTP_W0L
LUTP_END_W0:
    s_cmp_ge_u32 s2, 250
    s_cbranch_scc1 AUX_LOAD
    global_load_dwordx4 v[72:75], v9, s[46:47]
    global_load_dwordx4 v[76:79], v9, s[46:47] offset:16
    global_load_dwordx4 v[80:83], v9, s[48:49]
    global_load_dwordx4 v[84:87], v9, s[48:49] offset:16
LOADED:
    s_cmp_ge_u32 s2, 250
    s_cbranch_scc1 AUX
    s_waitcnt vmcnt(10)
    v_and_b32 v88, 0xff, v64
    v_lshlrev_b32 v88, 2, v88
    ds_add_rtn_u32 v92, v88, v15 offset:2304
    v_and_b32 v89, 0xff, v65
    v_lshlrev_b32 v89, 2, v89
    ds_add_rtn_u32 v93, v89, v15 offset:2304
    v_and_b32 v90, 0xff, v66
    v_lshlrev_b32 v90, 2, v90
    ds_add_rtn_u32 v94, v90, v15 offset:2304
    v_and_b32 v91, 0xff, v67
    v_lshlrev_b32 v91, 2, v91
    ds_add_rtn_u32 v95, v91, v15 offset:2304
    s_waitcnt vmcnt(9)
    v_lshrrev_b32 v64, 8, v64
    v_lshl_or_b32 v108, v68, 10, v64
    v_lshrrev_b32 v65, 8, v65
    v_lshl_or_b32 v110, v69, 10, v65
    v_lshrrev_b32 v66, 8, v66
    v_lshl_or_b32 v112, v70, 10, v66
    v_lshrrev_b32 v67, 8, v67
    v_lshl_or_b32 v114, v71, 10, v67
    s_mov_b32 s9, 87040
    s_waitcnt lgkmcnt(0)
    s_barrier
    ds_read_b128 v[96:99], v1 offset:2304
    s_add_u32 s64, s64, 1
    s_and_b32 s65, s65, 0x3ff
    v_mov_b32 v109, s64
    v_mov_b32 v111, s64
    v_mov_b32 v113, s64
    v_mov_b32 v115, s64
    s_waitcnt lgkmcnt(0)
    v_add_u32 v10, v96, v97
    v_add3_u32 v10, v10, v98, v99
    v_mov_b32 v11, v10
    s_nop 1
    v_add_u32_dpp v11, v11, v11 row_shr:1 row_mask:0xf bank_mask:0xf bound_ctrl:0
    s_nop 1
    v_add_u32_dpp v11, v11, v11 row_shr:2 row_mask:0xf bank_mask:0xf bound_ctrl:0
    s_nop 1
    v_add_u32_dpp v11, v11, v11 row_shr:4 row_mask:0xf bank_mask:0xf bound_ctrl:0
    s_nop 1
    v_add_u32_dpp v11, v11, v11 row_shr:8 row_mask:0xf bank_mask:0xf bound_ctrl:0
    s_nop 1
    v_add_u32_dpp v11, v11, v11 row_bcast:15 row_mask:0xa bank_mask:0xf
    s_nop 1
    v_add_u32_dpp v11, v11, v11 row_bcast:31 row_mask:0xc bank_mask:0xf
    v_sub_u32 v100, v11, v10
    v_add_u32 v101, v100, v96
    v_add_u32 v102, v101, v97
    v_add_u32 v103, v102, v98
    ds_write_b128 v1, v[100:103] offset:3328
    ds_read_b32 v96, v88 offset:3328
    ds_read_b32 v97, v89 offset:3328
    ds_read_b32 v98, v90 offset:3328
    ds_read_b32 v99, v91 offset:3328
    s_waitcnt lgkmcnt(3)
    v_add_u32 v92, v92, v96
    v_lshl_add_u32 v88, v92, 3, s9
    ds_write_b64 v88, v[108:109]
    s_waitcnt lgkmcnt(3)
    v_add_u32 v93, v93, v97
    v_lshl_add_u32 v89, v93, 3, s9
    ds_write_b64 v89, v[110:111]
    s_waitcnt lgkmcnt(3)
    v_add_u32 v94, v94, v98
    v_lshl_add_u32 v90, v94, 3, s9
    ds_write_b64 v90, v[112:113]
    s_waitcnt lgkmcnt(3)
    v_add_u32 v95, v95, v99
    v_lshl_add_u32 v91, v95, 3, s9
    ds_write_b64 v91, v[114:115]
    v_lshlrev_b32 v92, 4, v92
    v_add_u32 v92, 4352, v92
    v_lshlrev_b32 v93, 4, v93
    v_add_u32 v93, 4352, v93
    v_lshlrev_b32 v94, 4, v94
    v_add_u32 v94, 4352, v94
    v_lshlrev_b32 v95, 4, v95
    v_add_u32 v95, 4352, v95
    s_waitcnt lgkmcnt(0)
    s_barrier
    s_waitcnt vmcnt(0)
    ds_write2_b64 v92, v[72:73], v[80:81] offset0:0 offset1:1
    ds_write2_b64 v93, v[74:75], v[82:83] offset0:0 offset1:1
    ds_write2_b64 v94, v[76:77], v[84:85] offset0:0 offset1:1
    ds_write2_b64 v95, v[78:79], v[86:87] offset0:0 offset1:1
BINNED:
    s_setprio 0
    s_call_b64 s[6:7], CONST_SUB
    s_cmp_gt_u32 s62, 24
    s_cbranch_scc1 LUTP_END_W
LUTP_WL:
    s_mul_i32 s3, s62, 33554944
    s_add_u32 s3, s3, 4286709632
    v_add_u32 v128, s3, v138
    s_lshl_b32 s3, s62, 10
    v_add_u32 v136, s3, v1
    v_add_u32 v129, 131074, v128
    v_add_u32 v130, 262148, v128
    v_add_u32 v131, 393222, v128
    v_add_u32 v137, 0x10000, v136
    v_or_b32 v132, 0x80008000, v128
    v_or_b32 v133, 0x80008000, v129
    v_or_b32 v134, 0x80008000, v130
    v_or_b32 v135, 0x80008000, v131
    ds_write_b128 v136, v[128:131] offset:32768
    ds_write_b128 v137, v[132:135] offset:32768
    s_add_u32 s62, s62, 5
    s_cmp_le_u32 s62, 24
    s_cbranch_scc1 LUTP_WL
LUTP_END_W:
    v_mov_b32 v2, 0
    s_cmp_eq_u32 s25, 4
    s_cbranch_scc1 WAVE4
    s_add_u32 s62, s25, 34
    v_mov_b32 v132, 0x80008000
    v_mov_b32 v133, 0x80008000
    v_mov_b32 v134, 0x80008000
    v_mov_b32 v135, 0x80008000
LUTP_UH:
    s_mul_i32 s3, s62, 33554944
    s_add_u32 s3, s3, 131072
    v_add_u32 v128, s3, v138
    s_lshl_b32 s3, s62, 10
    v_add_u32 v136, s3, v1
    v_add_u32 v129, 131074, v128
    v_add_u32 v130, 262148, v128
    v_add_u32 v131, 393222, v128
    v_add_u32 v137, 0x10000, v136
    ds_write_b128 v136, v[128:131] offset:32768
    ds_write_b128 v137, v[132:135] offset:32768
    s_add_u32 s62, s62, 4
    s_cmp_le_u32 s62, 37
    s_cbranch_scc1 LUTP_UH
LUTP_END_U:
    buffer_load_dwordx2 v[2:3], v6, s[16:19], 0 offen sc1
    s_waitcnt lgkmcnt(0)
    s_barrier
    s_cmp_gt_u32 s62, 62
    s_cbranch_scc1 LUTP_END_V
LUTP_VH:
    s_mul_i32 s3, s62, 33554944
    s_add_u32 s3, s3, 131072
    v_add_u32 v128, s3, v138
    s_lshl_b32 s3, s62, 10
    v_add_u32 v136, s3, v1
    v_add_u32 v129, 131074, v128
    v_add_u32 v130, 262148, v128
    v_add_u32 v131, 393222, v128
    v_add_u32 v137, 0x10000, v136
    ds_write_b128 v136, v[128:131] offset:32768
    ds_write_b128 v137, v[132:135] offset:32768
    s_add_u32 s62, s62, 4
    s_cmp_le_u32 s62, 62
    s_cbranch_scc1 LUTP_VH
LUTP_END_V:
POLL_TAB:
    s_waitcnt vmcnt(0)
CHECK_TAB:
    v_lshrrev_b32 v11, 22, v2
    v_cmp_ne_u32 vcc, s64, v3
    v_cmp_ne_u32 s[42:43], s65, v11
    s_or_b64 vcc, vcc, s[42:43]
    s_and_b64 exec, exec, vcc
    s_cbranch_execz POLLED_TAB
    s_sub_u32 s35, s35, 1
    s_cbranch_scc1 END
    buffer_load_dwordx2 v[2:3], v6, s[16:19], 0 offen sc1
    s_branch POLL_TAB
POLLED_TAB:
    s_mov_b64 exec, -1
    s_branch TAB_DONE
LUT_SUB:
    s_lshl_b32 s3, s62, 25
    s_add_u32 s3, s3, 0x8000
    v_lshl_add_u32 v128, v1, 15, s3
    v_add_u32 v129, 0x10000, v128
    v_add_u32 v130, 0x10000, v129
    v_add_u32 v131, 0x10000, v130
    v_add_u32 v132, 0x10000, v131
    v_add_u32 v133, 0x10000, v132
    v_add_u32 v134, 0x10000, v133
    v_add_u32 v135, 0x10000, v134
    v_pk_mul_f32 v[136:137], v[128:129], s[10:11]
    v_pk_mul_f32 v[138:139], v[130:131], s[10:11]
    v_pk_mul_f32 v[140:141], v[132:133], s[10:11]
    v_pk_mul_f32 v[142:143], v[134:135], s[10:11]
    v_exp_f32 v136, v136
    v_exp_f32 v137, v137
    v_exp_f32 v138, v138
    v_exp_f32 v139, v139
    v_exp_f32 v140, v140
    v_exp_f32 v141, v141
    v_exp_f32 v142, v142
    v_exp_f32 v143, v143
    s_lshl_b32 s3, s62, 10
    v_pk_add_f32 v[144:145], v[136:137], 1.0 op_sel_hi:[1,0]
    v_pk_add_f32 v[146:147], v[138:139], 1.0 op_sel_hi:[1,0]
    v_pk_add_f32 v[148:149], v[140:141], 1.0 op_sel_hi:[1,0]
    v_pk_add_f32 v[150:151], v[142:143], 1.0 op_sel_hi:[1,0]
    v_rcp_f32 v144, v144
    v_rcp_f32 v145, v145
    v_rcp_f32 v146, v146
    v_rcp_f32 v147, v147
    v_rcp_f32 v148, v148
    v_rcp_f32 v149, v149
    v_rcp_f32 v150, v150
    v_rcp_f32 v151, v151
    v_add_u32 v160, s3, v1
    v_pk_mul_f32 v[128:129], v[128:129], v[144:145]
    v_pk_mul_f32 v[130:131], v[130:131], v[146:147]
    v_pk_mul_f32 v[132:133], v[132:133], v[148:149]
    v_pk_mul_f32 v[134:135], v[134:135], v[150:151]
    v_add_u32 v161, 0x10000, v160
    v_pk_mul_f32 v[136:137], v[128:129], v[136:137] neg_lo:[1,0] neg_hi:[1,0]
    v_pk_mul_f32 v[138:139], v[130:131], v[138:139] neg_lo:[1,0] neg_hi:[1,0]
    v_pk_mul_f32 v[140:141], v[132:133], v[140:141] neg_lo:[1,0] neg_hi:[1,0]
    v_pk_mul_f32 v[142:143], v[134:135], v[142:143] neg_lo:[1,0] neg_hi:[1,0]
    v_cvt_pk_bf16_f32 v152, v128, v129
    v_cvt_pk_bf16_f32 v153, v130, v131
    v_cvt_pk_bf16_f32 v154, v132, v133
    v_cvt_pk_bf16_f32 v155, v134, v135
    v_cvt_pk_bf16_f32 v156, v136, v137
    v_cvt_pk_bf16_f32 v157, v138, v139
    v_cvt_pk_bf16_f32 v158, v140, v141
    v_cvt_pk_bf16_f32 v159, v142, v143
    ds_write_b128 v160, v[152:155] offset:32768
    ds_write_b128 v161, v[156:159] offset:32768
    s_add_u32 s62, s62, 1
    s_sub_u32 s63, s63, 1
    s_cmp_lg_u32 s63, 0
    s_cbranch_scc1 LUT_SUB
    s_setpc_b64 s[6:7]
CONST_SUB:
    ds_write_b32 v193, v192 offset:31744
    v_lshrrev_b32 v193, 3, v1
    v_and_b32 v193, 24, v193
    s_mov_b32 s4, 0x05040100
    s_mov_b32 s5, 0x07060302
    ds_read_b64_tr_b16 v[180:181], v193 offset:31744
    ds_read_b64_tr_b16 v[182:183], v193 offset:31776
    ds_read_b64_tr_b16 v[184:185], v193 offset:31808
    ds_read_b64_tr_b16 v[186:187], v193 offset:31840
    v_perm_b32 v176, v189, v188, s4
    v_perm_b32 v178, v189, v188, s5
    v_perm_b32 v177, v191, v190, s4
    v_perm_b32 v179, v191, v190, s5
    s_setpc_b64 s[6:7]
HELP:
    s_cmp_eq_u32 s25, 6
    s_cselect_b32 s62, 25, 0
    s_cmp_eq_u32 s25, 7
    s_cselect_b32 s62, 63, s62
    s_mov_b32 s63, 1
    s_call_b64 s[6:7], LUT_SUB
    v_mov_b32 v10, 65280
    v_mov_b32 v11, 0x7f80
    s_cmp_lg_u32 s25, 7
    s_cbranch_scc1 NO_INF
    ds_write_b16 v10, v11 offset:32768
NO_INF:
    s_waitcnt vmcnt(0)
    s_call_b64 s[6:7], CONST_SUB
    s_sub_u32 s8, s25, 5
    s_mul_i32 s4, s8, 3072
    s_cmp_eq_u32 s8, 1
    s_cselect_b32 s4, 4096, s4
    s_mul_i32 s3, s2, 10240
    s_add_u32 s3, s3, s4
    v_add_u32 v8, s3, v1
    s_add_u32 s4, s4, 87040
    v_add_u32 v9, s4, v1
    s_mul_i32 s4, s8, 7168
    s_mul_i32 s3, s2, 20480
    s_add_u32 s3, s3, s4
    s_add_u32 s3, s3, 2621440
    v_add_u32 v12, s3, v1
    v_add_u32 v13, s4, v1
    s_waitcnt lgkmcnt(0)
    s_add_u32 s64, s64, 1
    s_and_b32 s65, s65, 0x3ff
    s_barrier
    s_cmp_lg_u32 s25, 6
    s_cbranch_scc1 NO_ROW
    ds_read_b128 v[96:99], v1 offset:2304
    s_lshl_b32 s3, s2, 11
    s_add_u32 s3, s3, 7864320
    v_lshl_add_u32 v116, v1, 1, s3
    s_lshl_b32 s3, s65, 22
    s_waitcnt lgkmcnt(0)
    v_add_u32 v10, v96, v97
    v_add3_u32 v10, v10, v98, v99
    v_mov_b32 v11, v10
    s_nop 1
    v_add_u32_dpp v11, v11, v11 row_shr:1 row_mask:0xf bank_mask:0xf bound_ctrl:0
    s_nop 1
    v_add_u32_dpp v11, v11, v11 row_shr:2 row_mask:0xf bank_mask:0xf bound_ctrl:0
    s_nop 1
    v_add_u32_dpp v11, v11, v11 row_shr:4 row_mask:0xf bank_mask:0xf bound_ctrl:0
    s_nop 1
    v_add_u32_dpp v11, v11, v11 row_shr:8 row_mask:0xf bank_mask:0xf bound_ctrl:0
    s_nop 1
    v_add_u32_dpp v11, v11, v11 row_bcast:15 row_mask:0xa bank_mask:0xf
    s_nop 1
    v_add_u32_dpp v11, v11, v11 row_bcast:31 row_mask:0xc bank_mask:0xf
    v_sub_u32 v100, v11, v10
    v_add_u32 v101, v100, v96
    v_add_u32 v102, v101, v97
    v_add_u32 v103, v102, v98
    v_lshl_or_b32 v108, v96, 11, v100
    v_or_b32 v108, s3, v108
    v_mov_b32 v109, s64
    v_lshl_or_b32 v110, v97, 11, v101
    v_or_b32 v110, s3, v110
    v_mov_b32 v111, s64
    v_lshl_or_b32 v112, v98, 11, v102
    v_or_b32 v112, s3, v112
    v_mov_b32 v113, s64
    v_lshl_or_b32 v114, v99, 11, v103
    v_or_b32 v114, s3, v114
    v_mov_b32 v115, s64
    global_store_dwordx4 v116, v[108:111], s[16:17] sc0 sc1
    global_store_dwordx4 v116, v[112:115], s[16:17] offset:16 sc0 sc1
NO_ROW:
    s_barrier
    ds_read_b128 v[64:67], v9 offset:0
    ds_read_b128 v[68:71], v9 offset:1024
    ds_read_b128 v[72:75], v9 offset:2048
    ds_read_b128 v[76:79], v9 offset:3072
    s_waitcnt lgkmcnt(3)
    global_store_dwordx4 v8, v[64:67], s[16:17] offset:0 sc0 sc1
    s_waitcnt lgkmcnt(2)
    global_store_dwordx4 v8, v[68:71], s[16:17] offset:1024 sc0 sc1
    s_cmp_eq_u32 s8, 1
    s_cbranch_scc1 KEYS_STORED
    s_waitcnt lgkmcnt(1)
    global_store_dwordx4 v8, v[72:75], s[16:17] offset:2048 sc0 sc1
    s_waitcnt lgkmcnt(0)
    global_store_dwordx4 v8, v[76:79], s[16:17] offset:3072 sc0 sc1
KEYS_STORED:
    v_mov_b32 v2, 0
    s_waitcnt lgkmcnt(0)
    s_barrier
    s_cmp_ge_u32 s2, 250
    s_cbranch_scc1 TAB_DONE
    ds_read_b128 v[84:87], v13 offset:4352
    ds_read_b128 v[88:91], v13 offset:5376
    ds_read_b128 v[92:95], v13 offset:6400
    ds_read_b128 v[96:99], v13 offset:7424
    ds_read_b128 v[100:103], v13 offset:8448
    ds_read_b128 v[104:107], v13 offset:9472
    ds_read_b128 v[108:111], v13 offset:10496
    s_waitcnt lgkmcnt(6)
    global_store_dwordx4 v12, v[84:87], s[16:17] offset:0 sc0 sc1
    s_waitcnt lgkmcnt(5)
    global_store_dwordx4 v12, v[88:91], s[16:17] offset:1024 sc0 sc1
    s_waitcnt lgkmcnt(4)
    global_store_dwordx4 v12, v[92:95], s[16:17] offset:2048 sc0 sc1
    s_waitcnt lgkmcnt(3)
    global_store_dwordx4 v12, v[96:99], s[16:17] offset:3072 sc0 sc1
    v_add_u32 v12, 4096, v12
    s_waitcnt lgkmcnt(2)
    global_store_dwordx4 v12, v[100:103], s[16:17] offset:0 sc0 sc1
    s_waitcnt lgkmcnt(1)
    global_store_dwordx4 v12, v[104:107], s[16:17] offset:1024 sc0 sc1
    s_cmp_eq_u32 s8, 2
    s_cbranch_scc1 TAB_DONE
    s_waitcnt lgkmcnt(0)
    global_store_dwordx4 v12, v[108:111], s[16:17] offset:2048 sc0 sc1
    s_branch TAB_DONE
AUX_LOAD:
    s_cmp_ge_u32 s2, 254
    s_cbranch_scc1 LOADED
    s_cmp_ge_u32 s25, 4
    s_cbranch_scc1 LOADED
    s_sub_u32 s4, s2, 250
    s_lshl_b32 s5, s25, 13
    s_lshl_b32 s8, s4, 6
    s_add_u32 s5, s5, s8
    v_lshrrev_b32 v9, 8, v1
    v_lshlrev_b32 v9, 11, v9
    v_bfe_u32 v10, v1, 4, 4
    v_lshl_add_u32 v9, v10, 2, v9
    v_add_u32 v9, s5, v9
    s_lshl_b32 s5, s4, 13
    s_lshl_b32 s8, s25, 10
    s_add_u32 s5, s5, s8
    s_add_u32 s5, s5, 7802880
    v_add_u32 v10, s5, v1
    global_load_dword v64, v9, s[54:55] offset:0
    global_load_dword v65, v9, s[54:55] offset:256
    global_load_dword v66, v9, s[54:55] offset:512
    global_load_dword v67, v9, s[54:55] offset:768
    global_load_dword v68, v9, s[54:55] offset:1024
    global_load_dword v69, v9, s[54:55] offset:1280
    global_load_dword v70, v9, s[54:55] offset:1536
    global_load_dword v71, v9, s[54:55] offset:1792
    s_branch LOADED
AUX:
    s_cmp_ge_u32 s2, 254
    s_cbranch_scc1 AUX_DONE
    s_cmp_ge_u32 s25, 4
    s_cbranch_scc1 AUX_DONE
    s_mov_b32 s4, 0x05040100
    s_mov_b32 s5, 0x07060302
    s_waitcnt vmcnt(0)
    v_perm_b32 v72, v65, v64, s4
    v_perm_b32 v76, v65, v64, s5
    v_perm_b32 v73, v67, v66, s4
    v_perm_b32 v77, v67, v66, s5
    v_perm_b32 v74, v69, v68, s4
    v_perm_b32 v78, v69, v68, s5
    v_perm_b32 v75, v71, v70, s4
    v_perm_b32 v79, v71, v70, s5
    global_store_dwordx4 v10, v[72:75], s[16:17] sc0 sc1
    v_add_u32 v10, 4096, v10
    global_store_dwordx4 v10, v[76:79], s[16:17] sc0 sc1
AUX_DONE:
    s_waitcnt lgkmcnt(0)
    s_add_u32 s64, s64, 1
    s_and_b32 s65, s65, 0x3ff
    s_barrier
    s_barrier
    s_waitcnt vmcnt(0)
    s_branch BINNED
WAVE4:
    s_mov_b32 s62, 26
    s_waitcnt lgkmcnt(0)
    s_barrier
    s_mov_b32 s63, 2
    s_call_b64 s[6:7], LUT_SUB
TAB_DONE:
    s_cmp_ge_u32 s25, 4
    s_cbranch_scc1 NOT_POLLER
    v_and_b32 v13, 0x7ff, v2
    v_bfe_u32 v2, v2, 11, 11
    v_add_u32 v4, v4, v13
    v_mov_b32 v3, v2
    v_lshlrev_b32 v10, 3, v4
    buffer_load_dword v167, v10, s[16:19], 0 offen sc1
    s_nop 1
    v_add_u32_dpp v3, v3, v3 row_shr:1 row_mask:0xf bank_mask:0xf bound_ctrl:0
    s_nop 1
    v_add_u32_dpp v3, v3, v3 row_shr:2 row_mask:0xf bank_mask:0xf bound_ctrl:0
    s_nop 1
    v_add_u32_dpp v3, v3, v3 row_shr:4 row_mask:0xf bank_mask:0xf bound_ctrl:0
    s_nop 1
    v_add_u32_dpp v3, v3, v3 row_shr:8 row_mask:0xf bank_mask:0xf bound_ctrl:0
    s_nop 1
    v_add_u32_dpp v3, v3, v3 row_bcast:15 row_mask:0xa bank_mask:0xf
    s_nop 1
    v_add_u32_dpp v3, v3, v3 row_bcast:31 row_mask:0xc bank_mask:0xf
    s_lshl_b32 s3, s25, 2
    v_mov_b32 v10, s3
    v_add_u32 v11, 1, v3
    v_sub_u32 v3, v3, v2
    s_mov_b32 exec_lo, 0
    s_mov_b32 exec_hi, 0x80000000
    ds_write_b32 v10, v11 offset:2176
    s_mov_b64 exec, -1
    s_branch TOTALS
NOT_POLLER:
    s_cmp_eq_u32 s25, 4
    s_cbranch_scc1 TOTALS
    v_mov_b32 v10, 2240
    s_waitcnt vmcnt(0)
    s_mov_b64 exec, 1
    ds_add_rtn_u32 v10, v10, v15
    s_mov_b64 exec, -1
    s_waitcnt lgkmcnt(0)
    v_readfirstlane_b32 s3, v10
    s_cmp_lg_u32 s3, 2
    s_cbranch_scc1 TOTALS
    s_lshl_b32 s3, s2, 10
    s_add_u32 s3, s3, 8388608
    v_lshl_add_u32 v10, v1, 3, s3
    v_mov_b32 v12, s64
    v_mov_b32 v13, s65
    s_mov_b64 exec, 0xff
    global_store_dwordx2 v10, v[12:13], s[16:17] sc0 sc1
    s_mov_b64 exec, -1
TOTALS:
    v_mov_b32 v10, 0
TOTALS_SPIN:
    ds_read_b128 v[64:67], v10 offset:2176
    s_waitcnt lgkmcnt(0)
    v_readfirstlane_b32 s4, v64
    v_readfirstlane_b32 s5, v65
    v_readfirstlane_b32 s6, v66
    v_readfirstlane_b32 s7, v67
    s_min_u32 s3, s4, s5
    s_min_u32 s8, s6, s7
    s_min_u32 s3, s3, s8
    s_cmp_eq_u32 s3, 0
    s_cbranch_scc0 TOTALS_OK
    s_sub_u32 s35, s35, 1
    s_cbranch_scc0 TOTALS_SPIN
    s_endpgm
TOTALS_OK:
    s_add_u32 s5, s5, s4
    s_add_u32 s6, s6, s5
    s_add_u32 s7, s7, s6
    s_sub_u32 s26, s7, 4
    s_cmp_eq_u32 s25, 1
    s_cselect_b32 s3, s4, 0
    s_cmp_eq_u32 s25, 2
    s_cselect_b32 s3, s5, s3
    s_cmp_eq_u32 s25, 3
    s_cselect_b32 s3, s6, s3
    s_sub_u32 s3, s3, s25
    v_add_u32 v3, s3, v3
    s_cmp_lg_u32 s25, 4
    s_cbranch_scc1 EPOCH_DONE
    s_cmp_lg_u32 s2, 0
    s_cbranch_scc1 EPOCH_DONE
    v_mov_b32 v12, s64
    v_mov_b32 v10, 8650752
    s_mov_b64 exec, 1
    global_store_dword v10, v12, s[16:17] sc0 sc1
    s_mov_b64 exec, -1
EPOCH_DONE:
    s_lshl_b32 s4, s2, 3
    s_add_u32 s4, s4, s25
    s_lshl_b32 s4, s4, 7
    s_add_u32 s4, s4, 0
    v_min_u32 v139, 304, v1
    v_lshl_add_u32 v139, v139, 14, s4
    buffer_load_dword v167, v139, s[12:15], 0 offen
NO_X_TOUCH_3:
ROUND:
    v_mov_b32 v8, 0
    v_subrev_u32 v9, s27, v3
    v_mov_b32 v10, v4
    s_mov_b32 s3, 1472
    s_cmp_gt_u32 s26, 1472
    s_cbranch_scc1 EXPAND
    v_lshlrev_b32 v11, 2, v3
    v_cmpx_lt_u32 vcc, 0, v2
    ds_write_b32 v11, v10 offset:2304
    v_add_u32 v10, 1, v10
    v_cmpx_lt_u32 vcc, 1, v2
    ds_write_b32 v11, v10 offset:2308
    v_add_u32 v10, 1, v10
    v_cmpx_lt_u32 vcc, 2, v2
    ds_write_b32 v11, v10 offset:2312
    v_add_u32 v10, 1, v10
    v_cmpx_lt_u32 vcc, 3, v2
    ds_write_b32 v11, v10 offset:2316
    v_add_u32 v10, 1, v10
    v_cmpx_lt_u32 vcc, 4, v2
    ds_write_b32 v11, v10 offset:2320
    v_add_u32 v10, 1, v10
    v_cmpx_lt_u32 vcc, 5, v2
    ds_write_b32 v11, v10 offset:2324
    v_add_u32 v10, 1, v10
    v_cmpx_lt_u32 vcc, 6, v2
    s_cbranch_execz EXPAND_DONE
    ds_write_b32 v11, v10 offset:2328
    v_add_u32 v10, 1, v10
    v_cmpx_lt_u32 vcc, 7, v2
    ds_write_b32 v11, v10 offset:2332
    v_add_u32 v10, 1, v10
    v_cmpx_lt_u32 vcc, 8, v2
    s_cbranch_execz EXPAND_DONE
    ds_write_b32 v11, v10 offset:2336
    v_add_u32 v10, 1, v10
    v_cmpx_lt_u32 vcc, 9, v2
    ds_write_b32 v11, v10 offset:2340
    v_add_u32 v10, 1, v10
    v_cmpx_lt_u32 vcc, 10, v2
    s_cbranch_execz EXPAND_DONE
    ds_write_b32 v11, v10 offset:2344
    v_add_u32 v10, 1, v10
    v_cmpx_lt_u32 vcc, 11, v2
    ds_write_b32 v11, v10 offset:2348
    v_add_u32 v10, 1, v10
    v_cmpx_lt_u32 vcc, 12, v2
    s_cbranch_execz EXPAND_DONE
    ds_write_b32 v11, v10 offset:2352
    v_add_u32 v10, 1, v10
    v_cmpx_lt_u32 vcc, 13, v2
    ds_write_b32 v11, v10 offset:2356
    v_add_u32 v10, 1, v10
    v_cmpx_lt_u32 vcc, 14, v2
    s_cbranch_execz EXPAND_DONE
    ds_write_b32 v11, v10 offset:2360
    v_add_u32 v10, 1, v10
    v_cmpx_lt_u32 vcc, 15, v2
    ds_write_b32 v11, v10 offset:2364
    v_add_u32 v10, 1, v10
    v_mov_b32 v8, 16
    v_add_u32 v9, 16, v9
EXPAND:
    v_cmp_lt_u32 vcc, v8, v2
    s_and_b64 exec, exec, vcc
    s_cbranch_execz EXPAND_DONE
    v_cmp_gt_u32 vcc, s3, v9
    v_lshlrev_b32 v11, 2, v9
    s_and_saveexec_b64 s[42:43], vcc
    ds_write_b32 v11, v10 offset:2304
    s_mov_b64 exec, s[42:43]
    v_add_u32 v8, 1, v8
    v_add_u32 v9, 1, v9
    v_add_u32 v10, 1, v10
    s_branch EXPAND
EXPAND_DONE:
    s_mov_b64 exec, -1
    s_sub_u32 s28, s26, s27
    s_min_u32 s28, s28, 1472
    v_lshlrev_b32 v8, 2, v0
    v_add_u32 v9, 0, v0
    v_cmp_gt_u32 s[36:37], s28, v9
    v_add_u32 v9, 512, v0
    v_cmp_gt_u32 s[38:39], s28, v9
    v_add_u32 v9, 1024, v0
    v_cmp_gt_u32 s[40:41], s28, v9
    s_waitcnt lgkmcnt(0)
    s_barrier
    ds_read_b32 v64, v8 offset:2304
    ds_read_b32 v65, v8 offset:4352
    ds_read_b32 v66, v8 offset:6400
    s_mov_b32 s44, 5033
    s_waitcnt lgkmcnt(0)
    v_lshlrev_b32 v68, 3, v64
    v_lshlrev_b32 v64, 4, v64
    v_lshlrev_b32 v69, 3, v65
    v_lshlrev_b32 v65, 4, v65
    v_lshlrev_b32 v70, 3, v66
    v_lshlrev_b32 v66, 4, v66
KEY_LOAD:
    s_mov_b64 exec, s[40:41]
    s_cbranch_execz SKIP3
    buffer_load_dwordx2 v[100:101], v70, s[16:19], 0 offen sc1
SKIP3:
    s_mov_b64 exec, s[36:37]
    buffer_load_dwordx2 v[96:97], v68, s[16:19], 0 offen sc1
    s_mov_b64 exec, s[38:39]
    buffer_load_dwordx2 v[98:99], v69, s[16:19], 0 offen sc1
    s_mov_b64 exec, -1
    s_cmp_lt_u32 s25, 2
    s_cbranch_scc1 NO_LAST_JOB
    s_mov_b32 s10, 0xbfb8aa3b
    s_mov_b32 s11, 0xbfb8aa3b
    s_add_u32 s62, s25, 26
    s_mov_b32 s63, 1
    s_call_b64 s[6:7], LUT_SUB
NO_LAST_JOB:
    s_waitcnt vmcnt(0)
    v_cmp_ne_u32 s[48:49], s64, v97
    v_cmp_ne_u32 s[50:51], s64, v99
    v_cmp_ne_u32 s[52:53], s64, v101
    s_and_b64 s[48:49], s[48:49], s[36:37]
    s_and_b64 s[50:51], s[50:51], s[38:39]
    s_and_b64 s[52:53], s[52:53], s[40:41]
    s_or_b64 s[48:49], s[48:49], s[50:51]
    s_or_b64 s[48:49], s[48:49], s[52:53]
    s_cbranch_scc0 KEYS_OK
    s_sub_u32 s35, s35, 1
    s_cbranch_scc0 KEY_LOAD
    s_endpgm
KEYS_OK:
    buffer_load_dwordx2 v[136:137], v166, s[16:19], 0 offen sc1
    v_mul_hi_u32 v9, s44, v96
    v_and_b32 v72, 63, v96
    v_mul_u32_u24 v72, 48, v72
    v_lshl_add_u32 v72, v9, 2, v72
    v_mul_hi_u32 v9, s44, v98
    v_and_b32 v73, 63, v98
    v_mul_u32_u24 v73, 48, v73
    v_lshl_add_u32 v73, v9, 2, v73
    v_mul_hi_u32 v9, s44, v100
    v_and_b32 v74, 63, v100
    v_mul_u32_u24 v74, 48, v74
    v_lshl_add_u32 v74, v9, 2, v74
    s_mov_b64 exec, s[36:37]
    ds_add_rtn_u32 v76, v72, v15 offset:0
    s_mov_b64 exec, s[38:39]
    ds_add_rtn_u32 v77, v73, v15 offset:0
    s_mov_b64 exec, s[40:41]
    ds_add_rtn_u32 v78, v74, v15 offset:0
    s_mov_b64 exec, -1
    v_add_u32 v9, 0, v0
    v_lshlrev_b32 v9, 21, v9
    v_lshrrev_b32 v80, 10, v96
    v_lshl_or_b32 v80, v80, 7, v9
    v_add_u32 v9, 512, v0
    v_lshlrev_b32 v9, 21, v9
    v_lshrrev_b32 v81, 10, v98
    v_lshl_or_b32 v81, v81, 7, v9
    v_add_u32 v9, 1024, v0
    v_lshlrev_b32 v9, 21, v9
    v_lshrrev_b32 v82, 10, v100
    v_lshl_or_b32 v82, v82, 7, v9
    v_lshrrev_b32 v8, 4, v1
    v_min_u32 v9, 39, v8
    v_mul_u32_u24 v9, 48, v9
    v_cmp_gt_u32 s[46:47], 40, v8
    v_sub_u32 v10, 63, v8
    s_mul_i32 s10, s25, 5
    s_lshl_b32 s3, s25, 10
    s_add_u32 s3, s3, 8192
    s_mov_b32 s9, 2621440
    s_waitcnt lgkmcnt(0)
    s_barrier
    ds_read_b128 v[84:87], v9 offset:0
    ds_read_b128 v[88:91], v9 offset:16
    ds_read_b128 v[92:95], v9 offset:32
    s_waitcnt lgkmcnt(1)
    v_add3_u32 v84, v84, v85, v86
    v_add3_u32 v87, v87, v88, v89
    v_add3_u32 v84, v84, v90, v91
    s_waitcnt lgkmcnt(0)
    v_add3_u32 v87, v87, v92, v93
    v_add3_u32 v84, v84, v94, v95
    v_add_u32 v84, v84, v87
    v_lshl_or_b32 v85, v84, 6, v10
    v_cndmask_b32 v85, 0, v85, s[46:47]
    s_cmp_lg_u32 s27, 0
    s_cbranch_scc1 DEALT
    v_readlane_b32 s4, v85, s10
    s_add_u32 s10, s10, 1
    v_readlane_b32 s5, v85, s10
    s_add_u32 s10, s10, 1
    v_readlane_b32 s6, v85, s10
    s_add_u32 s10, s10, 1
    v_readlane_b32 s7, v85, s10
    s_add_u32 s10, s10, 1
    v_readlane_b32 s8, v85, s10
    v_cmp_lt_u32 s[48:49], s4, v85
    v_cmp_lt_u32 s[50:51], s5, v85
    v_cmp_lt_u32 s[52:53], s6, v85
    v_cmp_lt_u32 s[54:55], s7, v85
    v_cmp_lt_u32 s[56:57], s8, v85
    s_bcnt1_i32_b64 s4, s[48:49]
    s_bcnt1_i32_b64 s5, s[50:51]
    s_bcnt1_i32_b64 s6, s[52:53]
    s_bcnt1_i32_b64 s7, s[54:55]
    s_bcnt1_i32_b64 s8, s[56:57]
    v_writelane_b32 v9, s4, 0
    v_writelane_b32 v9, s5, 1
    v_writelane_b32 v9, s6, 2
    v_writelane_b32 v9, s7, 3
    v_writelane_b32 v9, s8, 4
    s_sub_u32 s10, s10, 4
    v_add_u32 v10, s10, v8
    v_lshrrev_b32 v11, 3, v9
    v_and_b32 v9, 7, v9
    v_lshrrev_b32 v12, v11, 18
    v_and_b32 v12, 1, v12
    v_mul_u32_u24 v12, 7, v12
    v_xor_b32 v9, v9, v12
    v_mad_u32_u24 v9, v9, 5, v11
    v_lshlrev_b32 v9, 2, v9
    s_mov_b64 exec, 0x1f
    ds_write_b32 v9, v10 offset:1920
    s_mov_b64 exec, -1
DEALT:
    s_lshl_b32 s11, s10, 2
    v_add_u32 v9, s11, v7
    v_lshlrev_b32 v13, 2, v8
POLL_REC:
    s_waitcnt vmcnt(0)
CHECK_REC:
    v_cmp_ne_u32 vcc, s64, v136
    v_cmp_ne_u32 s[42:43], s65, v137
    s_or_b64 vcc, vcc, s[42:43]
    s_and_b64 exec, exec, vcc
    s_cbranch_execz POLLED_REC
    s_sub_u32 s35, s35, 1
    s_cbranch_scc1 END
    buffer_load_dwordx2 v[136:137], v166, s[16:19], 0 offen sc1
    s_branch POLL_REC
POLLED_REC:
    s_mov_b64 exec, -1
    v_cmp_gt_u32 s[42:43], 60, v8
    s_waitcnt lgkmcnt(0)
    s_barrier
    ds_read_b32 v9, v9 offset:1920
    ds_read_b32 v13, v13 offset:1920
    v_lshlrev_b32 v12, 17, v7
    s_add_u32 m0, s3, 0
    s_mov_b64 exec, s[36:37]
    buffer_load_dwordx4 v64, s[16:19], s9 offen sc1 lds
    s_add_u32 m0, s3, 8192
    s_mov_b64 exec, s[38:39]
    buffer_load_dwordx4 v65, s[16:19], s9 offen sc1 lds
    s_add_u32 m0, s3, 16384
    s_mov_b64 exec, s[40:41]
    s_cbranch_execz SKIP3R
    buffer_load_dwordx4 v66, s[16:19], s9 offen sc1 lds
SKIP3R:
    s_mov_b64 exec, -1
    s_waitcnt lgkmcnt(1)
    v_mul_u32_u24 v10, 48, v9
    v_add_u32 v10, v10, v14
    ds_read_b32 v11, v10 offset:0
    s_waitcnt lgkmcnt(1)
    v_lshlrev_b32 v13, 2, v13
    ds_bpermute_b32 v86, v13, v84
    v_readlane_b32 s4, v9, 0
    v_readlane_b32 s5, v9, 1
    v_readlane_b32 s6, v9, 2
    v_readlane_b32 s7, v9, 3
    v_readlane_b32 s8, v9, 4
    s_waitcnt lgkmcnt(0)
    v_cndmask_b32 v11, 0, v11, s[42:43]
    v_cndmask_b32 v86, 0, v86, s[46:47]
    v_sub_u32 v12, v12, v11
    v_mov_b32 v87, v86
    s_nop 0
    v_add_u32_dpp v11, v11, v11 row_shr:1 row_mask:0xf bank_mask:0xf bound_ctrl:0
    v_add_u32_dpp v87, v87, v87 row_shr:1 row_mask:0xf bank_mask:0xf bound_ctrl:0
    s_nop 0
    v_add_u32_dpp v11, v11, v11 row_shr:2 row_mask:0xf bank_mask:0xf bound_ctrl:0
    v_add_u32_dpp v87, v87, v87 row_shr:2 row_mask:0xf bank_mask:0xf bound_ctrl:0
    s_nop 0
    v_add_u32_dpp v11, v11, v11 row_shr:4 row_mask:0xf bank_mask:0xf bound_ctrl:0
    v_add_u32_dpp v87, v87, v87 row_shr:4 row_mask:0xf bank_mask:0xf bound_ctrl:0
    s_nop 0
    v_add_u32_dpp v11, v11, v11 row_shr:8 row_mask:0xf bank_mask:0xf bound_ctrl:0
    v_add_u32_dpp v87, v87, v87 row_shr:8 row_mask:0xf bank_mask:0xf bound_ctrl:0
    s_nop 0
    v_add_u32_dpp v11, v11, v11 row_bcast:15 row_mask:0xa bank_mask:0xf
    v_add_u32_dpp v87, v87, v87 row_bcast:15 row_mask:0xa bank_mask:0xf
    s_nop 0
    v_add_u32_dpp v11, v11, v11 row_bcast:31 row_mask:0xc bank_mask:0xf
    v_add_u32_dpp v87, v87, v87 row_bcast:31 row_mask:0xc bank_mask:0xf
    v_sub_u32 v87, v87, v86
    v_add_u32 v12, v12, v11
    v_readlane_b32 s29, v87, s10
    v_readlane_b32 s30, v11, 63
    s_nop 0
    v_add_u32 v12, s29, v12
    s_mov_b64 exec, s[42:43]
    ds_write_b32 v10, v12 offset:0
    s_mov_b64 exec, -1
    v_add_u32 v6, s29, v8
    v_lshlrev_b32 v5, 2, v6
    v_add_u32 v5, 2304, v5
    s_add_u32 s10, s30, 3
    s_and_b32 s10, s10, -4
    s_min_u32 s32, s10, 4
    s_sub_u32 s31, s10, s32
    s_add_u32 s30, s30, s29
    s_waitcnt lgkmcnt(0)
    s_barrier
    ds_read_b32 v72, v72 offset:0
    ds_read_b32 v73, v73 offset:0
    ds_read_b32 v74, v74 offset:0
    s_waitcnt lgkmcnt(2)
    v_lshrrev_b32 v9, 16, v72
    v_and_b32 v72, 0xffff, v72
    v_or_b32 v80, v80, v9
    v_add_lshl_u32 v72, v72, v76, 2
    s_waitcnt lgkmcnt(1)
    v_lshrrev_b32 v9, 16, v73
    v_and_b32 v73, 0xffff, v73
    v_or_b32 v81, v81, v9
    v_add_lshl_u32 v73, v73, v77, 2
    s_waitcnt lgkmcnt(0)
    v_lshrrev_b32 v9, 16, v74
    v_and_b32 v74, 0xffff, v74
    v_or_b32 v82, v82, v9
    v_add_lshl_u32 v74, v74, v78, 2
    s_mov_b64 exec, s[36:37]
    ds_write_b32 v72, v80 offset:2304
    s_mov_b64 exec, s[38:39]
    ds_write_b32 v73, v81 offset:2304
    s_mov_b64 exec, s[40:41]
    ds_write_b32 v74, v82 offset:2304
    s_mov_b64 exec, -1
    s_waitcnt lgkmcnt(0)
    s_barrier
    ds_read_b32 v165, v5
    s_and_b32 s10, s25, 3
    s_lshl_b32 s10, s10, 13
    s_add_u32 s10, s10, 7802880
    s_add_u32 s11, s10, 4096
    v_mov_b32 v128, 0
    v_mov_b32 v129, 0
    v_mov_b32 v130, 0
    v_mov_b32 v131, 0
    v_mov_b32 v132, 0
    v_mov_b32 v133, 0
    v_mov_b32 v134, 0
    v_mov_b32 v135, 0
    s_waitcnt lgkmcnt(0)
    v_cmp_gt_u32 vcc, s30, v6
    v_add_u32 v6, 64, v6
    v_add_u32 v5, 256, v5
    v_cndmask_b32 v165, 40, v165, vcc
    v_lshrrev_b32 v8, 21, v165
    v_lshlrev_b32 v8, 4, v8
    v_lshlrev_b32 v9, 3, v165
    v_and_b32 v9, 0xfffc00, v9
    v_and_or_b32 v165, v165, 56, v9
    s_nop 0
    v_readlane_b32 s48, v165, 0
    s_and_b32 s33, s48, s34
    buffer_load_dwordx4 v[64:67], v1, s[12:15], s33 offen
    v_readlane_b32 s49, v165, 1
    s_and_b32 s33, s49, s34
    buffer_load_dwordx4 v[68:71], v1, s[12:15], s33 offen
    v_readlane_b32 s50, v165, 2
    s_and_b32 s33, s50, s34
    buffer_load_dwordx4 v[72:75], v1, s[12:15], s33 offen
    v_readlane_b32 s51, v165, 3
    s_and_b32 s33, s51, s34
    buffer_load_dwordx4 v[76:79], v1, s[12:15], s33 offen
    v_readlane_b32 s52, v165, 4
    s_and_b32 s33, s52, s34
    buffer_load_dwordx4 v[80:83], v1, s[12:15], s33 offen
    v_readlane_b32 s53, v165, 5
    s_and_b32 s33, s53, s34
    buffer_load_dwordx4 v[84:87], v1, s[12:15], s33 offen
    v_readlane_b32 s54, v165, 6
    s_and_b32 s33, s54, s34
    buffer_load_dwordx4 v[88:91], v1, s[12:15], s33 offen
    v_mov_b32 v164, v165
    s_waitcnt vmcnt(7)
    s_barrier
    ds_read_b128 v[168:171], v8 offset:8192
    s_waitcnt lgkmcnt(0)
    v_mov_b32 v172, v170
    v_mov_b32 v173, v171
    v_mfma_f32_4x4x4_16b_bf16 v[148:151], v[168:169], v[180:181], 0
    v_mfma_f32_4x4x4_16b_bf16 v[152:155], v[168:169], v[182:183], 0
    v_mfma_f32_4x4x4_16b_bf16 v[156:159], v[168:169], v[184:185], 0
    v_mfma_f32_4x4x4_16b_bf16 v[160:163], v[168:169], v[186:187], 0
    v_mfma_f32_4x4x4_16b_bf16 v[112:115], v[172:173], v[176:177], 0 cbsz:4 abid:0
    v_mfma_f32_4x4x4_16b_bf16 v[116:119], v[172:173], v[178:179], 0 cbsz:4 abid:0
    v_mfma_f32_4x4x4_16b_bf16 v[120:123], v[172:173], v[176:177], 0 cbsz:4 abid:1
    s_nop 1
    v_cvt_pk_bf16_f32 v140, v148, v152
    v_cvt_pk_bf16_f32 v141, v156, v160
    v_cvt_pk_bf16_f32 v142, v149, v153
    v_cvt_pk_bf16_f32 v143, v157, v161
    v_cvt_pk_bf16_f32 v144, v150, v154
    v_cvt_pk_bf16_f32 v145, v158, v162
    v_cvt_pk_bf16_f32 v146, v151, v155
    v_cvt_pk_bf16_f32 v147, v159, v163
    v_lshlrev_b32_sdwa v136, v15, v112 dst_sel:DWORD dst_unused:UNUSED_PAD src0_sel:DWORD src1_sel:WORD_1
    v_lshlrev_b32_sdwa v137, v15, v113 dst_sel:DWORD dst_unused:UNUSED_PAD src0_sel:DWORD src1_sel:WORD_1
    ds_read_u16_d16_hi v128, v136 offset:32768
    ds_read_u16_d16_hi v129, v137 offset:32768
    v_lshlrev_b32_sdwa v138, v15, v116 dst_sel:DWORD dst_unused:UNUSED_PAD src0_sel:DWORD src1_sel:WORD_1
    v_lshlrev_b32_sdwa v139, v15, v117 dst_sel:DWORD dst_unused:UNUSED_PAD src0_sel:DWORD src1_sel:WORD_1
    ds_read_u16_d16_hi v130, v138 offset:32768
    ds_read_u16_d16_hi v131, v139 offset:32768
    s_waitcnt vmcnt(6)
    v_mfma_f32_4x4x4_16b_bf16 v[96:99], v[140:141], v[64:65], 0 cbsz:4 abid:0
    v_mfma_f32_4x4x4_16b_bf16 v[100:103], v[140:141], v[66:67], 0 cbsz:4 abid:0
A_0:
    s_sub_u32 s31, s31, 4
    s_cbranch_scc1 TO_B_0
    v_mfma_f32_4x4x4_16b_bf16 v[124:127], v[172:173], v[178:179], 0 cbsz:4 abid:1
    v_lshlrev_b32_sdwa v136, v15, v114 dst_sel:DWORD dst_unused:UNUSED_PAD src0_sel:DWORD src1_sel:WORD_1
    s_waitcnt vmcnt(5)
    v_mfma_f32_4x4x4_16b_bf16 v[104:107], v[142:143], v[68:69], 0 cbsz:4 abid:0
    v_readlane_b32 s55, v164, 7
    v_mfma_f32_4x4x4_16b_bf16 v[108:111], v[142:143], v[70:71], 0 cbsz:4 abid:0
    v_lshlrev_b32_sdwa v137, v15, v115 dst_sel:DWORD dst_unused:UNUSED_PAD src0_sel:DWORD src1_sel:WORD_1
    ds_read_u16_d16_hi v132, v136 offset:32768
    ds_read_u16_d16_hi v133, v137 offset:32768
    s_and_b32 s33, s55, s34
    buffer_load_dwordx4 v[92:95], v1, s[12:15], s33 offen
    s_waitcnt lgkmcnt(2)
    s_set_gpr_idx_on s48, 0xc
    v_pk_fma_f32 v[16:17], v[128:129], v[96:97], v[16:17] op_sel:[0,0,0] op_sel_hi:[0,1,1]
    v_pk_fma_f32 v[18:19], v[128:129], v[98:99], v[18:19] op_sel:[0,0,0] op_sel_hi:[0,1,1]
    v_pk_fma_f32 v[20:21], v[130:131], v[100:101], v[20:21] op_sel:[0,0,0] op_sel_hi:[0,1,1]
    v_pk_fma_f32 v[22:23], v[130:131], v[102:103], v[22:23] op_sel:[0,0,0] op_sel_hi:[0,1,1]
    s_set_gpr_idx_off
    v_lshlrev_b32_sdwa v138, v15, v118 dst_sel:DWORD dst_unused:UNUSED_PAD src0_sel:DWORD src1_sel:WORD_1
    s_waitcnt vmcnt(5)
    v_mfma_f32_4x4x4_16b_bf16 v[96:99], v[144:145], v[72:73], 0 cbsz:4 abid:0
    v_readlane_b32 s56, v164, 8
    v_mfma_f32_4x4x4_16b_bf16 v[100:103], v[144:145], v[74:75], 0 cbsz:4 abid:0
    v_lshlrev_b32_sdwa v139, v15, v119 dst_sel:DWORD dst_unused:UNUSED_PAD src0_sel:DWORD src1_sel:WORD_1
    ds_read_u16_d16_hi v134, v138 offset:32768
    ds_read_u16_d16_hi v135, v139 offset:32768
    s_and_b32 s33, s56, s34
    buffer_load_dwordx4 v[64:67], v1, s[12:15], s33 offen
    s_set_gpr_idx_on s49, 0xc
    v_pk_fma_f32 v[16:17], v[128:129], v[104:105], v[16:17] op_sel:[1,0,0] op_sel_hi:[1,1,1]
    v_pk_fma_f32 v[18:19], v[128:129], v[106:107], v[18:19] op_sel:[1,0,0] op_sel_hi:[1,1,1]
    v_pk_fma_f32 v[20:21], v[130:131], v[108:109], v[20:21] op_sel:[1,0,0] op_sel_hi:[1,1,1]
    v_pk_fma_f32 v[22:23], v[130:131], v[110:111], v[22:23] op_sel:[1,0,0] op_sel_hi:[1,1,1]
    s_set_gpr_idx_off
    v_mfma_f32_4x4x4_16b_bf16 v[112:115], v[172:173], v[176:177], 0 cbsz:4 abid:2
    v_lshlrev_b32_sdwa v136, v15, v120 dst_sel:DWORD dst_unused:UNUSED_PAD src0_sel:DWORD src1_sel:WORD_1
    s_waitcnt vmcnt(5)
    v_mfma_f32_4x4x4_16b_bf16 v[104:107], v[146:147], v[76:77], 0 cbsz:4 abid:0
    v_readlane_b32 s57, v164, 9
    v_mfma_f32_4x4x4_16b_bf16 v[108:111], v[146:147], v[78:79], 0 cbsz:4 abid:0
    v_lshlrev_b32_sdwa v137, v15, v121 dst_sel:DWORD dst_unused:UNUSED_PAD src0_sel:DWORD src1_sel:WORD_1
    ds_read_u16_d16_hi v128, v136 offset:32768
    ds_read_u16_d16_hi v129, v137 offset:32768
    s_and_b32 s33, s57, s34
    buffer_load_dwordx4 v[68:71], v1, s[12:15], s33 offen
    s_waitcnt lgkmcnt(2)
    s_set_gpr_idx_on s50, 0xc
    v_pk_fma_f32 v[16:17], v[132:133], v[96:97], v[16:17] op_sel:[0,0,0] op_sel_hi:[0,1,1]
    v_pk_fma_f32 v[18:19], v[132:133], v[98:99], v[18:19] op_sel:[0,0,0] op_sel_hi:[0,1,1]
    v_pk_fma_f32 v[20:21], v[134:135], v[100:101], v[20:21] op_sel:[0,0,0] op_sel_hi:[0,1,1]
    v_pk_fma_f32 v[22:23], v[134:135], v[102:103], v[22:23] op_sel:[0,0,0] op_sel_hi:[0,1,1]
    s_set_gpr_idx_off
    v_lshlrev_b32_sdwa v138, v15, v124 dst_sel:DWORD dst_unused:UNUSED_PAD src0_sel:DWORD src1_sel:WORD_1
    s_waitcnt vmcnt(5)
    v_mfma_f32_4x4x4_16b_bf16 v[96:99], v[140:141], v[80:81], 0 cbsz:4 abid:1
    v_readlane_b32 s58, v164, 10
    v_mfma_f32_4x4x4_16b_bf16 v[100:103], v[140:141], v[82:83], 0 cbsz:4 abid:1
    v_lshlrev_b32_sdwa v139, v15, v125 dst_sel:DWORD dst_unused:UNUSED_PAD src0_sel:DWORD src1_sel:WORD_1
    ds_read_u16_d16_hi v130, v138 offset:32768
    ds_read_u16_d16_hi v131, v139 offset:32768
    s_and_b32 s33, s58, s34
    buffer_load_dwordx4 v[72:75], v1, s[12:15], s33 offen
    s_set_gpr_idx_on s51, 0xc
    v_pk_fma_f32 v[16:17], v[132:133], v[104:105], v[16:17] op_sel:[1,0,0] op_sel_hi:[1,1,1]
    v_pk_fma_f32 v[18:19], v[132:133], v[106:107], v[18:19] op_sel:[1,0,0] op_sel_hi:[1,1,1]
    v_pk_fma_f32 v[20:21], v[134:135], v[108:109], v[20:21] op_sel:[1,0,0] op_sel_hi:[1,1,1]
    v_pk_fma_f32 v[22:23], v[134:135], v[110:111], v[22:23] op_sel:[1,0,0] op_sel_hi:[1,1,1]
    s_set_gpr_idx_off
A_4:
    s_sub_u32 s31, s31, 4
    s_cbranch_scc1 TO_B_4
    v_mfma_f32_4x4x4_16b_bf16 v[116:119], v[172:173], v[178:179], 0 cbsz:4 abid:2
    v_lshlrev_b32_sdwa v136, v15, v122 dst_sel:DWORD dst_unused:UNUSED_PAD src0_sel:DWORD src1_sel:WORD_1
    s_waitcnt vmcnt(5)
    v_mfma_f32_4x4x4_16b_bf16 v[104:107], v[142:143], v[84:85], 0 cbsz:4 abid:1
    v_readlane_b32 s59, v164, 11
    v_mfma_f32_4x4x4_16b_bf16 v[108:111], v[142:143], v[86:87], 0 cbsz:4 abid:1
    v_lshlrev_b32_sdwa v137, v15, v123 dst_sel:DWORD dst_unused:UNUSED_PAD src0_sel:DWORD src1_sel:WORD_1
    ds_read_u16_d16_hi v132, v136 offset:32768
    ds_read_u16_d16_hi v133, v137 offset:32768
    s_and_b32 s33, s59, s34
    buffer_load_dwordx4 v[76:79], v1, s[12:15], s33 offen
    s_waitcnt lgkmcnt(2)
    s_set_gpr_idx_on s52, 0xc
    v_pk_fma_f32 v[16:17], v[128:129], v[96:97], v[16:17] op_sel:[0,0,0] op_sel_hi:[0,1,1]
    v_pk_fma_f32 v[18:19], v[128:129], v[98:99], v[18:19] op_sel:[0,0,0] op_sel_hi:[0,1,1]
    v_pk_fma_f32 v[20:21], v[130:131], v[100:101], v[20:21] op_sel:[0,0,0] op_sel_hi:[0,1,1]
    v_pk_fma_f32 v[22:23], v[130:131], v[102:103], v[22:23] op_sel:[0,0,0] op_sel_hi:[0,1,1]
    s_set_gpr_idx_off
    v_lshlrev_b32_sdwa v138, v15, v126 dst_sel:DWORD dst_unused:UNUSED_PAD src0_sel:DWORD src1_sel:WORD_1
    s_waitcnt vmcnt(5)
    v_mfma_f32_4x4x4_16b_bf16 v[96:99], v[144:145], v[88:89], 0 cbsz:4 abid:1
    v_readlane_b32 s60, v164, 12
    v_mfma_f32_4x4x4_16b_bf16 v[100:103], v[144:145], v[90:91], 0 cbsz:4 abid:1
    v_lshlrev_b32_sdwa v139, v15, v127 dst_sel:DWORD dst_unused:UNUSED_PAD src0_sel:DWORD src1_sel:WORD_1
    ds_read_u16_d16_hi v134, v138 offset:32768
    ds_read_u16_d16_hi v135, v139 offset:32768
    s_and_b32 s33, s60, s34
    buffer_load_dwordx4 v[80:83], v1, s[12:15], s33 offen
    s_set_gpr_idx_on s53, 0xc
    v_pk_fma_f32 v[16:17], v[128:129], v[104:105], v[16:17] op_sel:[1,0,0] op_sel_hi:[1,1,1]
    v_pk_fma_f32 v[18:19], v[128:129], v[106:107], v[18:19] op_sel:[1,0,0] op_sel_hi:[1,1,1]
    v_pk_fma_f32 v[20:21], v[130:131], v[108:109], v[20:21] op_sel:[1,0,0] op_sel_hi:[1,1,1]
    v_pk_fma_f32 v[22:23], v[130:131], v[110:111], v[22:23] op_sel:[1,0,0] op_sel_hi:[1,1,1]
    s_set_gpr_idx_off
    v_mfma_f32_4x4x4_16b_bf16 v[120:123], v[172:173], v[176:177], 0 cbsz:4 abid:3
    v_lshlrev_b32_sdwa v136, v15, v112 dst_sel:DWORD dst_unused:UNUSED_PAD src0_sel:DWORD src1_sel:WORD_1
    s_waitcnt vmcnt(5)
    v_mfma_f32_4x4x4_16b_bf16 v[104:107], v[146:147], v[92:93], 0 cbsz:4 abid:1
    v_readlane_b32 s61, v164, 13
    v_mfma_f32_4x4x4_16b_bf16 v[108:111], v[146:147], v[94:95], 0 cbsz:4 abid:1
    v_lshlrev_b32_sdwa v137, v15, v113 dst_sel:DWORD dst_unused:UNUSED_PAD src0_sel:DWORD src1_sel:WORD_1
    ds_read_u16_d16_hi v128, v136 offset:32768
    ds_read_u16_d16_hi v129, v137 offset:32768
    s_and_b32 s33, s61, s34
    buffer_load_dwordx4 v[84:87], v1, s[12:15], s33 offen
    s_waitcnt lgkmcnt(2)
    s_set_gpr_idx_on s54, 0xc
    v_pk_fma_f32 v[16:17], v[132:133], v[96:97], v[16:17] op_sel:[0,0,0] op_sel_hi:[0,1,1]
    v_pk_fma_f32 v[18:19], v[132:133], v[98:99], v[18:19] op_sel:[0,0,0] op_sel_hi:[0,1,1]
    v_pk_fma_f32 v[20:21], v[134:135], v[100:101], v[20:21] op_sel:[0,0,0] op_sel_hi:[0,1,1]
    v_pk_fma_f32 v[22:23], v[134:135], v[102:103], v[22:23] op_sel:[0,0,0] op_sel_hi:[0,1,1]
    s_set_gpr_idx_off
    v_lshlrev_b32_sdwa v138, v15, v116 dst_sel:DWORD dst_unused:UNUSED_PAD src0_sel:DWORD src1_sel:WORD_1
    s_waitcnt vmcnt(5)
    v_mfma_f32_4x4x4_16b_bf16 v[96:99], v[140:141], v[64:65], 0 cbsz:4 abid:2
    v_readlane_b32 s62, v164, 14
    v_mfma_f32_4x4x4_16b_bf16 v[100:103], v[140:141], v[66:67], 0 cbsz:4 abid:2
    v_lshlrev_b32_sdwa v139, v15, v117 dst_sel:DWORD dst_unused:UNUSED_PAD src0_sel:DWORD src1_sel:WORD_1
    ds_read_u16_d16_hi v130, v138 offset:32768
    ds_read_u16_d16_hi v131, v139 offset:32768
    s_and_b32 s33, s62, s34
    buffer_load_dwordx4 v[88:91], v1, s[12:15], s33 offen
    s_set_gpr_idx_on s55, 0xc
    v_pk_fma_f32 v[16:17], v[132:133], v[104:105], v[16:17] op_sel:[1,0,0] op_sel_hi:[1,1,1]
    v_pk_fma_f32 v[18:19], v[132:133], v[106:107], v[18:19] op_sel:[1,0,0] op_sel_hi:[1,1,1]
    v_pk_fma_f32 v[20:21], v[134:135], v[108:109], v[20:21] op_sel:[1,0,0] op_sel_hi:[1,1,1]
    v_pk_fma_f32 v[22:23], v[134:135], v[110:111], v[22:23] op_sel:[1,0,0] op_sel_hi:[1,1,1]
    s_set_gpr_idx_off
A_8:
    s_sub_u32 s31, s31, 4
    s_cbranch_scc1 TO_B_8
    v_mfma_f32_4x4x4_16b_bf16 v[124:127], v[172:173], v[178:179], 0 cbsz:4 abid:3
    v_lshlrev_b32_sdwa v136, v15, v114 dst_sel:DWORD dst_unused:UNUSED_PAD src0_sel:DWORD src1_sel:WORD_1
    s_waitcnt vmcnt(5)
    v_mfma_f32_4x4x4_16b_bf16 v[104:107], v[142:143], v[68:69], 0 cbsz:4 abid:2
    v_readlane_b32 s63, v164, 15
    v_mfma_f32_4x4x4_16b_bf16 v[108:111], v[142:143], v[70:71], 0 cbsz:4 abid:2
    v_lshlrev_b32_sdwa v137, v15, v115 dst_sel:DWORD dst_unused:UNUSED_PAD src0_sel:DWORD src1_sel:WORD_1
    ds_read_u16_d16_hi v132, v136 offset:32768
    ds_read_u16_d16_hi v133, v137 offset:32768
    s_and_b32 s33, s63, s34
    buffer_load_dwordx4 v[92:95], v1, s[12:15], s33 offen
    s_waitcnt lgkmcnt(2)
    s_set_gpr_idx_on s56, 0xc
    v_pk_fma_f32 v[16:17], v[128:129], v[96:97], v[16:17] op_sel:[0,0,0] op_sel_hi:[0,1,1]
    v_pk_fma_f32 v[18:19], v[128:129], v[98:99], v[18:19] op_sel:[0,0,0] op_sel_hi:[0,1,1]
    v_pk_fma_f32 v[20:21], v[130:131], v[100:101], v[20:21] op_sel:[0,0,0] op_sel_hi:[0,1,1]
    v_pk_fma_f32 v[22:23], v[130:131], v[102:103], v[22:23] op_sel:[0,0,0] op_sel_hi:[0,1,1]
    s_set_gpr_idx_off
    ds_read_b32 v165, v5
    v_lshlrev_b32_sdwa v138, v15, v118 dst_sel:DWORD dst_unused:UNUSED_PAD src0_sel:DWORD src1_sel:WORD_1
    s_waitcnt vmcnt(5)
    v_mfma_f32_4x4x4_16b_bf16 v[96:99], v[144:145], v[72:73], 0 cbsz:4 abid:2
    v_readlane_b32 s48, v164, 16
    v_mfma_f32_4x4x4_16b_bf16 v[100:103], v[144:145], v[74:75], 0 cbsz:4 abid:2
    v_lshlrev_b32_sdwa v139, v15, v119 dst_sel:DWORD dst_unused:UNUSED_PAD src0_sel:DWORD src1_sel:WORD_1
    ds_read_u16_d16_hi v134, v138 offset:32768
    ds_read_u16_d16_hi v135, v139 offset:32768
    s_and_b32 s33, s48, s34
    buffer_load_dwordx4 v[64:67], v1, s[12:15], s33 offen
    s_set_gpr_idx_on s57, 0xc
    v_pk_fma_f32 v[16:17], v[128:129], v[104:105], v[16:17] op_sel:[1,0,0] op_sel_hi:[1,1,1]
    v_pk_fma_f32 v[18:19], v[128:129], v[106:107], v[18:19] op_sel:[1,0,0] op_sel_hi:[1,1,1]
    v_pk_fma_f32 v[20:21], v[130:131], v[108:109], v[20:21] op_sel:[1,0,0] op_sel_hi:[1,1,1]
    v_pk_fma_f32 v[22:23], v[130:131], v[110:111], v[22:23] op_sel:[1,0,0] op_sel_hi:[1,1,1]
    s_set_gpr_idx_off
    v_mfma_f32_4x4x4_16b_bf16 v[112:115], v[172:173], v[176:177], 0 cbsz:4 abid:4
    v_lshlrev_b32_sdwa v136, v15, v120 dst_sel:DWORD dst_unused:UNUSED_PAD src0_sel:DWORD src1_sel:WORD_1
    s_waitcnt vmcnt(5)
    v_mfma_f32_4x4x4_16b_bf16 v[104:107], v[146:147], v[76:77], 0 cbsz:4 abid:2
    v_readlane_b32 s49, v164, 17
    v_mfma_f32_4x4x4_16b_bf16 v[108:111], v[146:147], v[78:79], 0 cbsz:4 abid:2
    v_lshlrev_b32_sdwa v137, v15, v121 dst_sel:DWORD dst_unused:UNUSED_PAD src0_sel:DWORD src1_sel:WORD_1
    ds_read_u16_d16_hi v128, v136 offset:32768
    ds_read_u16_d16_hi v129, v137 offset:32768
    s_and_b32 s33, s49, s34
    buffer_load_dwordx4 v[68:71], v1, s[12:15], s33 offen
    s_waitcnt lgkmcnt(2)
    s_set_gpr_idx_on s58, 0xc
    v_pk_fma_f32 v[16:17], v[132:133], v[96:97], v[16:17] op_sel:[0,0,0] op_sel_hi:[0,1,1]
    v_pk_fma_f32 v[18:19], v[132:133], v[98:99], v[18:19] op_sel:[0,0,0] op_sel_hi:[0,1,1]
    v_pk_fma_f32 v[20:21], v[134:135], v[100:101], v[20:21] op_sel:[0,0,0] op_sel_hi:[0,1,1]
    v_pk_fma_f32 v[22:23], v[134:135], v[102:103], v[22:23] op_sel:[0,0,0] op_sel_hi:[0,1,1]
    s_set_gpr_idx_off
    v_lshlrev_b32_sdwa v138, v15, v124 dst_sel:DWORD dst_unused:UNUSED_PAD src0_sel:DWORD src1_sel:WORD_1
    s_waitcnt vmcnt(5)
    v_mfma_f32_4x4x4_16b_bf16 v[96:99], v[140:141], v[80:81], 0 cbsz:4 abid:3
    v_readlane_b32 s50, v164, 18
    v_mfma_f32_4x4x4_16b_bf16 v[100:103], v[140:141], v[82:83], 0 cbsz:4 abid:3
    v_lshlrev_b32_sdwa v139, v15, v125 dst_sel:DWORD dst_unused:UNUSED_PAD src0_sel:DWORD src1_sel:WORD_1
    ds_read_u16_d16_hi v130, v138 offset:32768
    ds_read_u16_d16_hi v131, v139 offset:32768
    s_and_b32 s33, s50, s34
    buffer_load_dwordx4 v[72:75], v1, s[12:15], s33 offen
    s_set_gpr_idx_on s59, 0xc
    v_pk_fma_f32 v[16:17], v[132:133], v[104:105], v[16:17] op_sel:[1,0,0] op_sel_hi:[1,1,1]
    v_pk_fma_f32 v[18:19], v[132:133], v[106:107], v[18:19] op_sel:[1,0,0] op_sel_hi:[1,1,1]
    v_pk_fma_f32 v[20:21], v[134:135], v[108:109], v[20:21] op_sel:[1,0,0] op_sel_hi:[1,1,1]
    v_pk_fma_f32 v[22:23], v[134:135], v[110:111], v[22:23] op_sel:[1,0,0] op_sel_hi:[1,1,1]
    s_set_gpr_idx_off
A_12:
    s_sub_u32 s31, s31, 4
    s_cbranch_scc1 TO_B_12
    v_mfma_f32_4x4x4_16b_bf16 v[116:119], v[172:173], v[178:179], 0 cbsz:4 abid:4
    v_lshlrev_b32_sdwa v136, v15, v122 dst_sel:DWORD dst_unused:UNUSED_PAD src0_sel:DWORD src1_sel:WORD_1
    s_waitcnt vmcnt(5)
    v_mfma_f32_4x4x4_16b_bf16 v[104:107], v[142:143], v[84:85], 0 cbsz:4 abid:3
    v_readlane_b32 s51, v164, 19
    v_mfma_f32_4x4x4_16b_bf16 v[108:111], v[142:143], v[86:87], 0 cbsz:4 abid:3
    v_lshlrev_b32_sdwa v137, v15, v123 dst_sel:DWORD dst_unused:UNUSED_PAD src0_sel:DWORD src1_sel:WORD_1
    ds_read_u16_d16_hi v132, v136 offset:32768
    ds_read_u16_d16_hi v133, v137 offset:32768
    s_and_b32 s33, s51, s34
    buffer_load_dwordx4 v[76:79], v1, s[12:15], s33 offen
    s_waitcnt lgkmcnt(2)
    s_set_gpr_idx_on s60, 0xc
    v_pk_fma_f32 v[16:17], v[128:129], v[96:97], v[16:17] op_sel:[0,0,0] op_sel_hi:[0,1,1]
    v_pk_fma_f32 v[18:19], v[128:129], v[98:99], v[18:19] op_sel:[0,0,0] op_sel_hi:[0,1,1]
    v_pk_fma_f32 v[20:21], v[130:131], v[100:101], v[20:21] op_sel:[0,0,0] op_sel_hi:[0,1,1]
    v_pk_fma_f32 v[22:23], v[130:131], v[102:103], v[22:23] op_sel:[0,0,0] op_sel_hi:[0,1,1]
    s_set_gpr_idx_off
    v_cmp_gt_u32 vcc, s30, v6
    v_add_u32 v6, 64, v6
    v_add_u32 v5, 256, v5
    v_cndmask_b32 v165, 40, v165, vcc
    v_lshrrev_b32 v8, 21, v165
    v_lshlrev_b32 v8, 4, v8
    v_lshlrev_b32 v9, 3, v165
    ds_read_b128 v[168:171], v8 offset:8192
    v_and_b32 v9, 0xfffc00, v9
    v_and_or_b32 v165, v165, 56, v9
    v_lshlrev_b32_sdwa v138, v15, v126 dst_sel:DWORD dst_unused:UNUSED_PAD src0_sel:DWORD src1_sel:WORD_1
    s_waitcnt vmcnt(5)
    v_mfma_f32_4x4x4_16b_bf16 v[96:99], v[144:145], v[88:89], 0 cbsz:4 abid:3
    v_readlane_b32 s52, v164, 20
    v_mfma_f32_4x4x4_16b_bf16 v[100:103], v[144:145], v[90:91], 0 cbsz:4 abid:3
    v_lshlrev_b32_sdwa v139, v15, v127 dst_sel:DWORD dst_unused:UNUSED_PAD src0_sel:DWORD src1_sel:WORD_1
    ds_read_u16_d16_hi v134, v138 offset:32768
    ds_read_u16_d16_hi v135, v139 offset:32768
    s_and_b32 s33, s52, s34
    buffer_load_dwordx4 v[80:83], v1, s[12:15], s33 offen
    s_set_gpr_idx_on s61, 0xc
    v_pk_fma_f32 v[16:17], v[128:129], v[104:105], v[16:17] op_sel:[1,0,0] op_sel_hi:[1,1,1]
    v_pk_fma_f32 v[18:19], v[128:129], v[106:107], v[18:19] op_sel:[1,0,0] op_sel_hi:[1,1,1]
    v_pk_fma_f32 v[20:21], v[130:131], v[108:109], v[20:21] op_sel:[1,0,0] op_sel_hi:[1,1,1]
    v_pk_fma_f32 v[22:23], v[130:131], v[110:111], v[22:23] op_sel:[1,0,0] op_sel_hi:[1,1,1]
    s_set_gpr_idx_off
    v_mfma_f32_4x4x4_16b_bf16 v[120:123], v[172:173], v[176:177], 0 cbsz:4 abid:5
    v_lshlrev_b32_sdwa v136, v15, v112 dst_sel:DWORD dst_unused:UNUSED_PAD src0_sel:DWORD src1_sel:WORD_1
    s_waitcnt vmcnt(5)
    v_mfma_f32_4x4x4_16b_bf16 v[104:107], v[146:147], v[92:93], 0 cbsz:4 abid:3
    v_readlane_b32 s53, v164, 21
    v_mfma_f32_4x4x4_16b_bf16 v[108:111], v[146:147], v[94:95], 0 cbsz:4 abid:3
    v_lshlrev_b32_sdwa v137, v15, v113 dst_sel:DWORD dst_unused:UNUSED_PAD src0_sel:DWORD src1_sel:WORD_1
    ds_read_u16_d16_hi v128, v136 offset:32768
    ds_read_u16_d16_hi v129, v137 offset:32768
    s_and_b32 s33, s53, s34
    buffer_load_dwordx4 v[84:87], v1, s[12:15], s33 offen
    s_waitcnt lgkmcnt(2)
    s_set_gpr_idx_on s62, 0xc
    v_pk_fma_f32 v[16:17], v[132:133], v[96:97], v[16:17] op_sel:[0,0,0] op_sel_hi:[0,1,1]
    v_pk_fma_f32 v[18:19], v[132:133], v[98:99], v[18:19] op_sel:[0,0,0] op_sel_hi:[0,1,1]
    v_pk_fma_f32 v[20:21], v[134:135], v[100:101], v[20:21] op_sel:[0,0,0] op_sel_hi:[0,1,1]
    v_pk_fma_f32 v[22:23], v[134:135], v[102:103], v[22:23] op_sel:[0,0,0] op_sel_hi:[0,1,1]
    s_set_gpr_idx_off
    v_lshlrev_b32_sdwa v138, v15, v116 dst_sel:DWORD dst_unused:UNUSED_PAD src0_sel:DWORD src1_sel:WORD_1
    s_waitcnt vmcnt(5)
    v_mfma_f32_4x4x4_16b_bf16 v[96:99], v[140:141], v[64:65], 0 cbsz:4 abid:4
    v_readlane_b32 s54, v164, 22
    v_mfma_f32_4x4x4_16b_bf16 v[100:103], v[140:141], v[66:67], 0 cbsz:4 abid:4
    v_lshlrev_b32_sdwa v139, v15, v117 dst_sel:DWORD dst_unused:UNUSED_PAD src0_sel:DWORD src1_sel:WORD_1
    ds_read_u16_d16_hi v130, v138 offset:32768
    ds_read_u16_d16_hi v131, v139 offset:32768
    s_and_b32 s33, s54, s34
    buffer_load_dwordx4 v[88:91], v1, s[12:15], s33 offen
    s_set_gpr_idx_on s63, 0xc
    v_pk_fma_f32 v[16:17], v[132:133], v[104:105], v[16:17] op_sel:[1,0,0] op_sel_hi:[1,1,1]
    v_pk_fma_f32 v[18:19], v[132:133], v[106:107], v[18:19] op_sel:[1,0,0] op_sel_hi:[1,1,1]
    v_pk_fma_f32 v[20:21], v[134:135], v[108:109], v[20:21] op_sel:[1,0,0] op_sel_hi:[1,1,1]
    v_pk_fma_f32 v[22:23], v[134:135], v[110:111], v[22:23] op_sel:[1,0,0] op_sel_hi:[1,1,1]
    s_set_gpr_idx_off
A_16:
    s_sub_u32 s31, s31, 4
    s_cbranch_scc1 TO_B_16
    v_mfma_f32_4x4x4_16b_bf16 v[124:127], v[172:173], v[178:179], 0 cbsz:4 abid:5
    v_lshlrev_b32_sdwa v136, v15, v114 dst_sel:DWORD dst_unused:UNUSED_PAD src0_sel:DWORD src1_sel:WORD_1
    s_waitcnt vmcnt(5)
    v_mfma_f32_4x4x4_16b_bf16 v[104:107], v[142:143], v[68:69], 0 cbsz:4 abid:4
    v_readlane_b32 s55, v164, 23
    v_mfma_f32_4x4x4_16b_bf16 v[108:111], v[142:143], v[70:71], 0 cbsz:4 abid:4
    v_lshlrev_b32_sdwa v137, v15, v115 dst_sel:DWORD dst_unused:UNUSED_PAD src0_sel:DWORD src1_sel:WORD_1
    ds_read_u16_d16_hi v132, v136 offset:32768
    ds_read_u16_d16_hi v133, v137 offset:32768
    s_and_b32 s33, s55, s34
    buffer_load_dwordx4 v[92:95], v1, s[12:15], s33 offen
    s_waitcnt lgkmcnt(2)
    s_set_gpr_idx_on s48, 0xc
    v_pk_fma_f32 v[16:17], v[128:129], v[96:97], v[16:17] op_sel:[0,0,0] op_sel_hi:[0,1,1]
    v_pk_fma_f32 v[18:19], v[128:129], v[98:99], v[18:19] op_sel:[0,0,0] op_sel_hi:[0,1,1]
    v_pk_fma_f32 v[20:21], v[130:131], v[100:101], v[20:21] op_sel:[0,0,0] op_sel_hi:[0,1,1]
    v_pk_fma_f32 v[22:23], v[130:131], v[102:103], v[22:23] op_sel:[0,0,0] op_sel_hi:[0,1,1]
    s_set_gpr_idx_off
    v_lshlrev_b32_sdwa v138, v15, v118 dst_sel:DWORD dst_unused:UNUSED_PAD src0_sel:DWORD src1_sel:WORD_1
    s_waitcnt vmcnt(5)
    v_mfma_f32_4x4x4_16b_bf16 v[96:99], v[144:145], v[72:73], 0 cbsz:4 abid:4
    v_readlane_b32 s56, v164, 24
    v_mfma_f32_4x4x4_16b_bf16 v[100:103], v[144:145], v[74:75], 0 cbsz:4 abid:4
    v_lshlrev_b32_sdwa v139, v15, v119 dst_sel:DWORD dst_unused:UNUSED_PAD src0_sel:DWORD src1_sel:WORD_1
    ds_read_u16_d16_hi v134, v138 offset:32768
    ds_read_u16_d16_hi v135, v139 offset:32768
    s_and_b32 s33, s56, s34
    buffer_load_dwordx4 v[64:67], v1, s[12:15], s33 offen
    s_set_gpr_idx_on s49, 0xc
    v_pk_fma_f32 v[16:17], v[128:129], v[104:105], v[16:17] op_sel:[1,0,0] op_sel_hi:[1,1,1]
    v_pk_fma_f32 v[18:19], v[128:129], v[106:107], v[18:19] op_sel:[1,0,0] op_sel_hi:[1,1,1]
    v_pk_fma_f32 v[20:21], v[130:131], v[108:109], v[20:21] op_sel:[1,0,0] op_sel_hi:[1,1,1]
    v_pk_fma_f32 v[22:23], v[130:131], v[110:111], v[22:23] op_sel:[1,0,0] op_sel_hi:[1,1,1]
    s_set_gpr_idx_off
    v_mfma_f32_4x4x4_16b_bf16 v[112:115], v[172:173], v[176:177], 0 cbsz:4 abid:6
    v_lshlrev_b32_sdwa v136, v15, v120 dst_sel:DWORD dst_unused:UNUSED_PAD src0_sel:DWORD src1_sel:WORD_1
    s_waitcnt vmcnt(5)
    v_mfma_f32_4x4x4_16b_bf16 v[104:107], v[146:147], v[76:77], 0 cbsz:4 abid:4
    v_readlane_b32 s57, v164, 25
    v_mfma_f32_4x4x4_16b_bf16 v[108:111], v[146:147], v[78:79], 0 cbsz:4 abid:4
    v_lshlrev_b32_sdwa v137, v15, v121 dst_sel:DWORD dst_unused:UNUSED_PAD src0_sel:DWORD src1_sel:WORD_1
    ds_read_u16_d16_hi v128, v136 offset:32768
    ds_read_u16_d16_hi v129, v137 offset:32768
    s_and_b32 s33, s57, s34
    buffer_load_dwordx4 v[68:71], v1, s[12:15], s33 offen
    s_waitcnt lgkmcnt(2)
    s_set_gpr_idx_on s50, 0xc
    v_pk_fma_f32 v[16:17], v[132:133], v[96:97], v[16:17] op_sel:[0,0,0] op_sel_hi:[0,1,1]
    v_pk_fma_f32 v[18:19], v[132:133], v[98:99], v[18:19] op_sel:[0,0,0] op_sel_hi:[0,1,1]
    v_pk_fma_f32 v[20:21], v[134:135], v[100:101], v[20:21] op_sel:[0,0,0] op_sel_hi:[0,1,1]
    v_pk_fma_f32 v[22:23], v[134:135], v[102:103], v[22:23] op_sel:[0,0,0] op_sel_hi:[0,1,1]
    s_set_gpr_idx_off
    v_lshlrev_b32_sdwa v138, v15, v124 dst_sel:DWORD dst_unused:UNUSED_PAD src0_sel:DWORD src1_sel:WORD_1
    s_waitcnt vmcnt(5)
    v_mfma_f32_4x4x4_16b_bf16 v[96:99], v[140:141], v[80:81], 0 cbsz:4 abid:5
    v_readlane_b32 s58, v164, 26
    v_mfma_f32_4x4x4_16b_bf16 v[100:103], v[140:141], v[82:83], 0 cbsz:4 abid:5
    v_lshlrev_b32_sdwa v139, v15, v125 dst_sel:DWORD dst_unused:UNUSED_PAD src0_sel:DWORD src1_sel:WORD_1
    ds_read_u16_d16_hi v130, v138 offset:32768
    ds_read_u16_d16_hi v131, v139 offset:32768
    s_and_b32 s33, s58, s34
    buffer_load_dwordx4 v[72:75], v1, s[12:15], s33 offen
    s_set_gpr_idx_on s51, 0xc
    v_pk_fma_f32 v[16:17], v[132:133], v[104:105], v[16:17] op_sel:[1,0,0] op_sel_hi:[1,1,1]
    v_pk_fma_f32 v[18:19], v[132:133], v[106:107], v[18:19] op_sel:[1,0,0] op_sel_hi:[1,1,1]
    v_pk_fma_f32 v[20:21], v[134:135], v[108:109], v[20:21] op_sel:[1,0,0] op_sel_hi:[1,1,1]
    v_pk_fma_f32 v[22:23], v[134:135], v[110:111], v[22:23] op_sel:[1,0,0] op_sel_hi:[1,1,1]
    s_set_gpr_idx_off
A_20:
    s_sub_u32 s31, s31, 4
    s_cbranch_scc1 TO_B_20
    v_mfma_f32_4x4x4_16b_bf16 v[116:119], v[172:173], v[178:179], 0 cbsz:4 abid:6
    v_lshlrev_b32_sdwa v136, v15, v122 dst_sel:DWORD dst_unused:UNUSED_PAD src0_sel:DWORD src1_sel:WORD_1
    s_waitcnt vmcnt(5)
    v_mfma_f32_4x4x4_16b_bf16 v[104:107], v[142:143], v[84:85], 0 cbsz:4 abid:5
    v_readlane_b32 s59, v164, 27
    v_mfma_f32_4x4x4_16b_bf16 v[108:111], v[142:143], v[86:87], 0 cbsz:4 abid:5
    v_lshlrev_b32_sdwa v137, v15, v123 dst_sel:DWORD dst_unused:UNUSED_PAD src0_sel:DWORD src1_sel:WORD_1
    ds_read_u16_d16_hi v132, v136 offset:32768
    ds_read_u16_d16_hi v133, v137 offset:32768
    s_and_b32 s33, s59, s34
    buffer_load_dwordx4 v[76:79], v1, s[12:15], s33 offen
    s_waitcnt lgkmcnt(2)
    s_set_gpr_idx_on s52, 0xc
    v_pk_fma_f32 v[16:17], v[128:129], v[96:97], v[16:17] op_sel:[0,0,0] op_sel_hi:[0,1,1]
    v_pk_fma_f32 v[18:19], v[128:129], v[98:99], v[18:19] op_sel:[0,0,0] op_sel_hi:[0,1,1]
    v_pk_fma_f32 v[20:21], v[130:131], v[100:101], v[20:21] op_sel:[0,0,0] op_sel_hi:[0,1,1]
    v_pk_fma_f32 v[22:23], v[130:131], v[102:103], v[22:23] op_sel:[0,0,0] op_sel_hi:[0,1,1]
    s_set_gpr_idx_off
    v_lshlrev_b32_sdwa v138, v15, v126 dst_sel:DWORD dst_unused:UNUSED_PAD src0_sel:DWORD src1_sel:WORD_1
    s_waitcnt vmcnt(5)
    v_mfma_f32_4x4x4_16b_bf16 v[96:99], v[144:145], v[88:89], 0 cbsz:4 abid:5
    v_readlane_b32 s60, v164, 28
    v_mfma_f32_4x4x4_16b_bf16 v[100:103], v[144:145], v[90:91], 0 cbsz:4 abid:5
    v_lshlrev_b32_sdwa v139, v15, v127 dst_sel:DWORD dst_unused:UNUSED_PAD src0_sel:DWORD src1_sel:WORD_1
    ds_read_u16_d16_hi v134, v138 offset:32768
    ds_read_u16_d16_hi v135, v139 offset:32768
    s_and_b32 s33, s60, s34
    buffer_load_dwordx4 v[80:83], v1, s[12:15], s33 offen
    s_set_gpr_idx_on s53, 0xc
    v_pk_fma_f32 v[16:17], v[128:129], v[104:105], v[16:17] op_sel:[1,0,0] op_sel_hi:[1,1,1]
    v_pk_fma_f32 v[18:19], v[128:129], v[106:107], v[18:19] op_sel:[1,0,0] op_sel_hi:[1,1,1]
    v_pk_fma_f32 v[20:21], v[130:131], v[108:109], v[20:21] op_sel:[1,0,0] op_sel_hi:[1,1,1]
    v_pk_fma_f32 v[22:23], v[130:131], v[110:111], v[22:23] op_sel:[1,0,0] op_sel_hi:[1,1,1]
    s_set_gpr_idx_off
    v_mfma_f32_4x4x4_16b_bf16 v[120:123], v[172:173], v[176:177], 0 cbsz:4 abid:7
    v_lshlrev_b32_sdwa v136, v15, v112 dst_sel:DWORD dst_unused:UNUSED_PAD src0_sel:DWORD src1_sel:WORD_1
    s_waitcnt vmcnt(5)
    v_mfma_f32_4x4x4_16b_bf16 v[104:107], v[146:147], v[92:93], 0 cbsz:4 abid:5
    v_readlane_b32 s61, v164, 29
    v_mfma_f32_4x4x4_16b_bf16 v[108:111], v[146:147], v[94:95], 0 cbsz:4 abid:5
    v_lshlrev_b32_sdwa v137, v15, v113 dst_sel:DWORD dst_unused:UNUSED_PAD src0_sel:DWORD src1_sel:WORD_1
    ds_read_u16_d16_hi v128, v136 offset:32768
    ds_read_u16_d16_hi v129, v137 offset:32768
    s_and_b32 s33, s61, s34
    buffer_load_dwordx4 v[84:87], v1, s[12:15], s33 offen
    s_waitcnt lgkmcnt(2)
    s_set_gpr_idx_on s54, 0xc
    v_pk_fma_f32 v[16:17], v[132:133], v[96:97], v[16:17] op_sel:[0,0,0] op_sel_hi:[0,1,1]
    v_pk_fma_f32 v[18:19], v[132:133], v[98:99], v[18:19] op_sel:[0,0,0] op_sel_hi:[0,1,1]
    v_pk_fma_f32 v[20:21], v[134:135], v[100:101], v[20:21] op_sel:[0,0,0] op_sel_hi:[0,1,1]
    v_pk_fma_f32 v[22:23], v[134:135], v[102:103], v[22:23] op_sel:[0,0,0] op_sel_hi:[0,1,1]
    s_set_gpr_idx_off
    v_lshlrev_b32_sdwa v138, v15, v116 dst_sel:DWORD dst_unused:UNUSED_PAD src0_sel:DWORD src1_sel:WORD_1
    s_waitcnt vmcnt(5)
    v_mfma_f32_4x4x4_16b_bf16 v[96:99], v[140:141], v[64:65], 0 cbsz:4 abid:6
    v_readlane_b32 s62, v164, 30
    v_mfma_f32_4x4x4_16b_bf16 v[100:103], v[140:141], v[66:67], 0 cbsz:4 abid:6
    v_lshlrev_b32_sdwa v139, v15, v117 dst_sel:DWORD dst_unused:UNUSED_PAD src0_sel:DWORD src1_sel:WORD_1
    ds_read_u16_d16_hi v130, v138 offset:32768
    ds_read_u16_d16_hi v131, v139 offset:32768
    s_and_b32 s33, s62, s34
    buffer_load_dwordx4 v[88:91], v1, s[12:15], s33 offen
    s_set_gpr_idx_on s55, 0xc
    v_pk_fma_f32 v[16:17], v[132:133], v[104:105], v[16:17] op_sel:[1,0,0] op_sel_hi:[1,1,1]
    v_pk_fma_f32 v[18:19], v[132:133], v[106:107], v[18:19] op_sel:[1,0,0] op_sel_hi:[1,1,1]
    v_pk_fma_f32 v[20:21], v[134:135], v[108:109], v[20:21] op_sel:[1,0,0] op_sel_hi:[1,1,1]
    v_pk_fma_f32 v[22:23], v[134:135], v[110:111], v[22:23] op_sel:[1,0,0] op_sel_hi:[1,1,1]
    s_set_gpr_idx_off
A_24:
    s_sub_u32 s31, s31, 4
    s_cbranch_scc1 TO_B_24
    v_mfma_f32_4x4x4_16b_bf16 v[124:127], v[172:173], v[178:179], 0 cbsz:4 abid:7
    v_lshlrev_b32_sdwa v136, v15, v114 dst_sel:DWORD dst_unused:UNUSED_PAD src0_sel:DWORD src1_sel:WORD_1
    s_waitcnt vmcnt(5)
    v_mfma_f32_4x4x4_16b_bf16 v[104:107], v[142:143], v[68:69], 0 cbsz:4 abid:6
    v_readlane_b32 s63, v164, 31
    v_mfma_f32_4x4x4_16b_bf16 v[108:111], v[142:143], v[70:71], 0 cbsz:4 abid:6
    v_lshlrev_b32_sdwa v137, v15, v115 dst_sel:DWORD dst_unused:UNUSED_PAD src0_sel:DWORD src1_sel:WORD_1
    ds_read_u16_d16_hi v132, v136 offset:32768
    ds_read_u16_d16_hi v133, v137 offset:32768
    s_and_b32 s33, s63, s34
    buffer_load_dwordx4 v[92:95], v1, s[12:15], s33 offen
    s_waitcnt lgkmcnt(2)
    s_set_gpr_idx_on s56, 0xc
    v_pk_fma_f32 v[16:17], v[128:129], v[96:97], v[16:17] op_sel:[0,0,0] op_sel_hi:[0,1,1]
    v_pk_fma_f32 v[18:19], v[128:129], v[98:99], v[18:19] op_sel:[0,0,0] op_sel_hi:[0,1,1]
    v_pk_fma_f32 v[20:21], v[130:131], v[100:101], v[20:21] op_sel:[0,0,0] op_sel_hi:[0,1,1]
    v_pk_fma_f32 v[22:23], v[130:131], v[102:103], v[22:23] op_sel:[0,0,0] op_sel_hi:[0,1,1]
    s_set_gpr_idx_off
    v_lshlrev_b32_sdwa v138, v15, v118 dst_sel:DWORD dst_unused:UNUSED_PAD src0_sel:DWORD src1_sel:WORD_1
    s_waitcnt vmcnt(5)
    v_mfma_f32_4x4x4_16b_bf16 v[96:99], v[144:145], v[72:73], 0 cbsz:4 abid:6
    v_readlane_b32 s48, v164, 32
    v_mfma_f32_4x4x4_16b_bf16 v[100:103], v[144:145], v[74:75], 0 cbsz:4 abid:6
    v_lshlrev_b32_sdwa v139, v15, v119 dst_sel:DWORD dst_unused:UNUSED_PAD src0_sel:DWORD src1_sel:WORD_1
    ds_read_u16_d16_hi v134, v138 offset:32768
    ds_read_u16_d16_hi v135, v139 offset:32768
    s_and_b32 s33, s48, s34
    buffer_load_dwordx4 v[64:67], v1, s[12:15], s33 offen
    s_set_gpr_idx_on s57, 0xc
    v_pk_fma_f32 v[16:17], v[128:129], v[104:105], v[16:17] op_sel:[1,0,0] op_sel_hi:[1,1,1]
    v_pk_fma_f32 v[18:19], v[128:129], v[106:107], v[18:19] op_sel:[1,0,0] op_sel_hi:[1,1,1]
    v_pk_fma_f32 v[20:21], v[130:131], v[108:109], v[20:21] op_sel:[1,0,0] op_sel_hi:[1,1,1]
    v_pk_fma_f32 v[22:23], v[130:131], v[110:111], v[22:23] op_sel:[1,0,0] op_sel_hi:[1,1,1]
    s_set_gpr_idx_off
    v_mfma_f32_4x4x4_16b_bf16 v[112:115], v[172:173], v[176:177], 0 cbsz:4 abid:8
    v_lshlrev_b32_sdwa v136, v15, v120 dst_sel:DWORD dst_unused:UNUSED_PAD src0_sel:DWORD src1_sel:WORD_1
    s_waitcnt vmcnt(5)
    v_mfma_f32_4x4x4_16b_bf16 v[104:107], v[146:147], v[76:77], 0 cbsz:4 abid:6
    v_readlane_b32 s49, v164, 33
    v_mfma_f32_4x4x4_16b_bf16 v[108:111], v[146:147], v[78:79], 0 cbsz:4 abid:6
    v_lshlrev_b32_sdwa v137, v15, v121 dst_sel:DWORD dst_unused:UNUSED_PAD src0_sel:DWORD src1_sel:WORD_1
    ds_read_u16_d16_hi v128, v136 offset:32768
    ds_read_u16_d16_hi v129, v137 offset:32768
    s_and_b32 s33, s49, s34
    buffer_load_dwordx4 v[68:71], v1, s[12:15], s33 offen
    s_waitcnt lgkmcnt(2)
    s_set_gpr_idx_on s58, 0xc
    v_pk_fma_f32 v[16:17], v[132:133], v[96:97], v[16:17] op_sel:[0,0,0] op_sel_hi:[0,1,1]
    v_pk_fma_f32 v[18:19], v[132:133], v[98:99], v[18:19] op_sel:[0,0,0] op_sel_hi:[0,1,1]
    v_pk_fma_f32 v[20:21], v[134:135], v[100:101], v[20:21] op_sel:[0,0,0] op_sel_hi:[0,1,1]
    v_pk_fma_f32 v[22:23], v[134:135], v[102:103], v[22:23] op_sel:[0,0,0] op_sel_hi:[0,1,1]
    s_set_gpr_idx_off
    v_lshlrev_b32_sdwa v138, v15, v124 dst_sel:DWORD dst_unused:UNUSED_PAD src0_sel:DWORD src1_sel:WORD_1
    s_waitcnt vmcnt(5)
    v_mfma_f32_4x4x4_16b_bf16 v[96:99], v[140:141], v[80:81], 0 cbsz:4 abid:7
    v_readlane_b32 s50, v164, 34
    v_mfma_f32_4x4x4_16b_bf16 v[100:103], v[140:141], v[82:83], 0 cbsz:4 abid:7
    v_lshlrev_b32_sdwa v139, v15, v125 dst_sel:DWORD dst_unused:UNUSED_PAD src0_sel:DWORD src1_sel:WORD_1
    ds_read_u16_d16_hi v130, v138 offset:32768
    ds_read_u16_d16_hi v131, v139 offset:32768
    s_and_b32 s33, s50, s34
    buffer_load_dwordx4 v[72:75], v1, s[12:15], s33 offen
    s_set_gpr_idx_on s59, 0xc
    v_pk_fma_f32 v[16:17], v[132:133], v[104:105], v[16:17] op_sel:[1,0,0] op_sel_hi:[1,1,1]
    v_pk_fma_f32 v[18:19], v[132:133], v[106:107], v[18:19] op_sel:[1,0,0] op_sel_hi:[1,1,1]
    v_pk_fma_f32 v[20:21], v[134:135], v[108:109], v[20:21] op_sel:[1,0,0] op_sel_hi:[1,1,1]
    v_pk_fma_f32 v[22:23], v[134:135], v[110:111], v[22:23] op_sel:[1,0,0] op_sel_hi:[1,1,1]
    s_set_gpr_idx_off
A_28:
    s_sub_u32 s31, s31, 4
    s_cbranch_scc1 TO_B_28
    v_mfma_f32_4x4x4_16b_bf16 v[116:119], v[172:173], v[178:179], 0 cbsz:4 abid:8
    v_lshlrev_b32_sdwa v136, v15, v122 dst_sel:DWORD dst_unused:UNUSED_PAD src0_sel:DWORD src1_sel:WORD_1
    s_waitcnt vmcnt(5)
    v_mfma_f32_4x4x4_16b_bf16 v[104:107], v[142:143], v[84:85], 0 cbsz:4 abid:7
    v_readlane_b32 s51, v164, 35
    v_mfma_f32_4x4x4_16b_bf16 v[108:111], v[142:143], v[86:87], 0 cbsz:4 abid:7
    v_lshlrev_b32_sdwa v137, v15, v123 dst_sel:DWORD dst_unused:UNUSED_PAD src0_sel:DWORD src1_sel:WORD_1
    ds_read_u16_d16_hi v132, v136 offset:32768
    ds_read_u16_d16_hi v133, v137 offset:32768
    s_and_b32 s33, s51, s34
    buffer_load_dwordx4 v[76:79], v1, s[12:15], s33 offen
    s_waitcnt lgkmcnt(2)
    s_set_gpr_idx_on s60, 0xc
    v_pk_fma_f32 v[16:17], v[128:129], v[96:97], v[16:17] op_sel:[0,0,0] op_sel_hi:[0,1,1]
    v_pk_fma_f32 v[18:19], v[128:129], v[98:99], v[18:19] op_sel:[0,0,0] op_sel_hi:[0,1,1]
    v_pk_fma_f32 v[20:21], v[130:131], v[100:101], v[20:21] op_sel:[0,0,0] op_sel_hi:[0,1,1]
    v_pk_fma_f32 v[22:23], v[130:131], v[102:103], v[22:23] op_sel:[0,0,0] op_sel_hi:[0,1,1]
    s_set_gpr_idx_off
    v_lshlrev_b32_sdwa v138, v15, v126 dst_sel:DWORD dst_unused:UNUSED_PAD src0_sel:DWORD src1_sel:WORD_1
    s_waitcnt vmcnt(5)
    v_mfma_f32_4x4x4_16b_bf16 v[96:99], v[144:145], v[88:89], 0 cbsz:4 abid:7
    v_readlane_b32 s52, v164, 36
    v_mfma_f32_4x4x4_16b_bf16 v[100:103], v[144:145], v[90:91], 0 cbsz:4 abid:7
    v_lshlrev_b32_sdwa v139, v15, v127 dst_sel:DWORD dst_unused:UNUSED_PAD src0_sel:DWORD src1_sel:WORD_1
    ds_read_u16_d16_hi v134, v138 offset:32768
    ds_read_u16_d16_hi v135, v139 offset:32768
    s_and_b32 s33, s52, s34
    buffer_load_dwordx4 v[80:83], v1, s[12:15], s33 offen
    s_set_gpr_idx_on s61, 0xc
    v_pk_fma_f32 v[16:17], v[128:129], v[104:105], v[16:17] op_sel:[1,0,0] op_sel_hi:[1,1,1]
    v_pk_fma_f32 v[18:19], v[128:129], v[106:107], v[18:19] op_sel:[1,0,0] op_sel_hi:[1,1,1]
    v_pk_fma_f32 v[20:21], v[130:131], v[108:109], v[20:21] op_sel:[1,0,0] op_sel_hi:[1,1,1]
    v_pk_fma_f32 v[22:23], v[130:131], v[110:111], v[22:23] op_sel:[1,0,0] op_sel_hi:[1,1,1]
    s_set_gpr_idx_off
    v_mfma_f32_4x4x4_16b_bf16 v[120:123], v[172:173], v[176:177], 0 cbsz:4 abid:9
    v_lshlrev_b32_sdwa v136, v15, v112 dst_sel:DWORD dst_unused:UNUSED_PAD src0_sel:DWORD src1_sel:WORD_1
    s_waitcnt vmcnt(5)
    v_mfma_f32_4x4x4_16b_bf16 v[104:107], v[146:147], v[92:93], 0 cbsz:4 abid:7
    v_readlane_b32 s53, v164, 37
    v_mfma_f32_4x4x4_16b_bf16 v[108:111], v[146:147], v[94:95], 0 cbsz:4 abid:7
    v_lshlrev_b32_sdwa v137, v15, v113 dst_sel:DWORD dst_unused:UNUSED_PAD src0_sel:DWORD src1_sel:WORD_1
    ds_read_u16_d16_hi v128, v136 offset:32768
    ds_read_u16_d16_hi v129, v137 offset:32768
    s_and_b32 s33, s53, s34
    buffer_load_dwordx4 v[84:87], v1, s[12:15], s33 offen
    s_waitcnt lgkmcnt(2)
    s_set_gpr_idx_on s62, 0xc
    v_pk_fma_f32 v[16:17], v[132:133], v[96:97], v[16:17] op_sel:[0,0,0] op_sel_hi:[0,1,1]
    v_pk_fma_f32 v[18:19], v[132:133], v[98:99], v[18:19] op_sel:[0,0,0] op_sel_hi:[0,1,1]
    v_pk_fma_f32 v[20:21], v[134:135], v[100:101], v[20:21] op_sel:[0,0,0] op_sel_hi:[0,1,1]
    v_pk_fma_f32 v[22:23], v[134:135], v[102:103], v[22:23] op_sel:[0,0,0] op_sel_hi:[0,1,1]
    s_set_gpr_idx_off
    v_lshlrev_b32_sdwa v138, v15, v116 dst_sel:DWORD dst_unused:UNUSED_PAD src0_sel:DWORD src1_sel:WORD_1
    s_waitcnt vmcnt(5)
    v_mfma_f32_4x4x4_16b_bf16 v[96:99], v[140:141], v[64:65], 0 cbsz:4 abid:8
    v_readlane_b32 s54, v164, 38
    v_mfma_f32_4x4x4_16b_bf16 v[100:103], v[140:141], v[66:67], 0 cbsz:4 abid:8
    v_lshlrev_b32_sdwa v139, v15, v117 dst_sel:DWORD dst_unused:UNUSED_PAD src0_sel:DWORD src1_sel:WORD_1
    ds_read_u16_d16_hi v130, v138 offset:32768
    ds_read_u16_d16_hi v131, v139 offset:32768
    s_and_b32 s33, s54, s34
    buffer_load_dwordx4 v[88:91], v1, s[12:15], s33 offen
    s_set_gpr_idx_on s63, 0xc
    v_pk_fma_f32 v[16:17], v[132:133], v[104:105], v[16:17] op_sel:[1,0,0] op_sel_hi:[1,1,1]
    v_pk_fma_f32 v[18:19], v[132:133], v[106:107], v[18:19] op_sel:[1,0,0] op_sel_hi:[1,1,1]
    v_pk_fma_f32 v[20:21], v[134:135], v[108:109], v[20:21] op_sel:[1,0,0] op_sel_hi:[1,1,1]
    v_pk_fma_f32 v[22:23], v[134:135], v[110:111], v[22:23] op_sel:[1,0,0] op_sel_hi:[1,1,1]
    s_set_gpr_idx_off
A_32:
    s_sub_u32 s31, s31, 4
    s_cbranch_scc1 TO_B_32
    v_mfma_f32_4x4x4_16b_bf16 v[124:127], v[172:173], v[178:179], 0 cbsz:4 abid:9
    v_lshlrev_b32_sdwa v136, v15, v114 dst_sel:DWORD dst_unused:UNUSED_PAD src0_sel:DWORD src1_sel:WORD_1
    s_waitcnt vmcnt(5)
    v_mfma_f32_4x4x4_16b_bf16 v[104:107], v[142:143], v[68:69], 0 cbsz:4 abid:8
    v_readlane_b32 s55, v164, 39
    v_mfma_f32_4x4x4_16b_bf16 v[108:111], v[142:143], v[70:71], 0 cbsz:4 abid:8
    v_lshlrev_b32_sdwa v137, v15, v115 dst_sel:DWORD dst_unused:UNUSED_PAD src0_sel:DWORD src1_sel:WORD_1
    ds_read_u16_d16_hi v132, v136 offset:32768
    ds_read_u16_d16_hi v133, v137 offset:32768
    s_and_b32 s33, s55, s34
    buffer_load_dwordx4 v[92:95], v1, s[12:15], s33 offen
    s_waitcnt lgkmcnt(2)
    s_set_gpr_idx_on s48, 0xc
    v_pk_fma_f32 v[16:17], v[128:129], v[96:97], v[16:17] op_sel:[0,0,0] op_sel_hi:[0,1,1]
    v_pk_fma_f32 v[18:19], v[128:129], v[98:99], v[18:19] op_sel:[0,0,0] op_sel_hi:[0,1,1]
    v_pk_fma_f32 v[20:21], v[130:131], v[100:101], v[20:21] op_sel:[0,0,0] op_sel_hi:[0,1,1]
    v_pk_fma_f32 v[22:23], v[130:131], v[102:103], v[22:23] op_sel:[0,0,0] op_sel_hi:[0,1,1]
    s_set_gpr_idx_off
    v_lshlrev_b32_sdwa v138, v15, v118 dst_sel:DWORD dst_unused:UNUSED_PAD src0_sel:DWORD src1_sel:WORD_1
    s_waitcnt vmcnt(5)
    v_mfma_f32_4x4x4_16b_bf16 v[96:99], v[144:145], v[72:73], 0 cbsz:4 abid:8
    v_readlane_b32 s56, v164, 40
    v_mfma_f32_4x4x4_16b_bf16 v[100:103], v[144:145], v[74:75], 0 cbsz:4 abid:8
    v_lshlrev_b32_sdwa v139, v15, v119 dst_sel:DWORD dst_unused:UNUSED_PAD src0_sel:DWORD src1_sel:WORD_1
    ds_read_u16_d16_hi v134, v138 offset:32768
    ds_read_u16_d16_hi v135, v139 offset:32768
    s_and_b32 s33, s56, s34
    buffer_load_dwordx4 v[64:67], v1, s[12:15], s33 offen
    s_set_gpr_idx_on s49, 0xc
    v_pk_fma_f32 v[16:17], v[128:129], v[104:105], v[16:17] op_sel:[1,0,0] op_sel_hi:[1,1,1]
    v_pk_fma_f32 v[18:19], v[128:129], v[106:107], v[18:19] op_sel:[1,0,0] op_sel_hi:[1,1,1]
    v_pk_fma_f32 v[20:21], v[130:131], v[108:109], v[20:21] op_sel:[1,0,0] op_sel_hi:[1,1,1]
    v_pk_fma_f32 v[22:23], v[130:131], v[110:111], v[22:23] op_sel:[1,0,0] op_sel_hi:[1,1,1]
    s_set_gpr_idx_off
    v_mfma_f32_4x4x4_16b_bf16 v[112:115], v[172:173], v[176:177], 0 cbsz:4 abid:10
    v_lshlrev_b32_sdwa v136, v15, v120 dst_sel:DWORD dst_unused:UNUSED_PAD src0_sel:DWORD src1_sel:WORD_1
    s_waitcnt vmcnt(5)
    v_mfma_f32_4x4x4_16b_bf16 v[104:107], v[146:147], v[76:77], 0 cbsz:4 abid:8
    v_readlane_b32 s57, v164, 41
    v_mfma_f32_4x4x4_16b_bf16 v[108:111], v[146:147], v[78:79], 0 cbsz:4 abid:8
    v_lshlrev_b32_sdwa v137, v15, v121 dst_sel:DWORD dst_unused:UNUSED_PAD src0_sel:DWORD src1_sel:WORD_1
    ds_read_u16_d16_hi v128, v136 offset:32768
    ds_read_u16_d16_hi v129, v137 offset:32768
    s_and_b32 s33, s57, s34
    buffer_load_dwordx4 v[68:71], v1, s[12:15], s33 offen
    s_waitcnt lgkmcnt(2)
    s_set_gpr_idx_on s50, 0xc
    v_pk_fma_f32 v[16:17], v[132:133], v[96:97], v[16:17] op_sel:[0,0,0] op_sel_hi:[0,1,1]
    v_pk_fma_f32 v[18:19], v[132:133], v[98:99], v[18:19] op_sel:[0,0,0] op_sel_hi:[0,1,1]
    v_pk_fma_f32 v[20:21], v[134:135], v[100:101], v[20:21] op_sel:[0,0,0] op_sel_hi:[0,1,1]
    v_pk_fma_f32 v[22:23], v[134:135], v[102:103], v[22:23] op_sel:[0,0,0] op_sel_hi:[0,1,1]
    s_set_gpr_idx_off
    v_lshlrev_b32_sdwa v138, v15, v124 dst_sel:DWORD dst_unused:UNUSED_PAD src0_sel:DWORD src1_sel:WORD_1
    s_waitcnt vmcnt(5)
    v_mfma_f32_4x4x4_16b_bf16 v[96:99], v[140:141], v[80:81], 0 cbsz:4 abid:9
    v_readlane_b32 s58, v164, 42
    v_mfma_f32_4x4x4_16b_bf16 v[100:103], v[140:141], v[82:83], 0 cbsz:4 abid:9
    v_lshlrev_b32_sdwa v139, v15, v125 dst_sel:DWORD dst_unused:UNUSED_PAD src0_sel:DWORD src1_sel:WORD_1
    ds_read_u16_d16_hi v130, v138 offset:32768
    ds_read_u16_d16_hi v131, v139 offset:32768
    s_and_b32 s33, s58, s34
    buffer_load_dwordx4 v[72:75], v1, s[12:15], s33 offen
    s_set_gpr_idx_on s51, 0xc
    v_pk_fma_f32 v[16:17], v[132:133], v[104:105], v[16:17] op_sel:[1,0,0] op_sel_hi:[1,1,1]
    v_pk_fma_f32 v[18:19], v[132:133], v[106:107], v[18:19] op_sel:[1,0,0] op_sel_hi:[1,1,1]
    v_pk_fma_f32 v[20:21], v[134:135], v[108:109], v[20:21] op_sel:[1,0,0] op_sel_hi:[1,1,1]
    v_pk_fma_f32 v[22:23], v[134:135], v[110:111], v[22:23] op_sel:[1,0,0] op_sel_hi:[1,1,1]
    s_set_gpr_idx_off
A_36:
    s_sub_u32 s31, s31, 4
    s_cbranch_scc1 TO_B_36
    v_mfma_f32_4x4x4_16b_bf16 v[116:119], v[172:173], v[178:179], 0 cbsz:4 abid:10
    v_lshlrev_b32_sdwa v136, v15, v122 dst_sel:DWORD dst_unused:UNUSED_PAD src0_sel:DWORD src1_sel:WORD_1
    s_waitcnt vmcnt(5)
    v_mfma_f32_4x4x4_16b_bf16 v[104:107], v[142:143], v[84:85], 0 cbsz:4 abid:9
    v_readlane_b32 s59, v164, 43
    v_mfma_f32_4x4x4_16b_bf16 v[108:111], v[142:143], v[86:87], 0 cbsz:4 abid:9
    v_lshlrev_b32_sdwa v137, v15, v123 dst_sel:DWORD dst_unused:UNUSED_PAD src0_sel:DWORD src1_sel:WORD_1
    ds_read_u16_d16_hi v132, v136 offset:32768
    ds_read_u16_d16_hi v133, v137 offset:32768
    s_and_b32 s33, s59, s34
    buffer_load_dwordx4 v[76:79], v1, s[12:15], s33 offen
    s_waitcnt lgkmcnt(2)
    s_set_gpr_idx_on s52, 0xc
    v_pk_fma_f32 v[16:17], v[128:129], v[96:97], v[16:17] op_sel:[0,0,0] op_sel_hi:[0,1,1]
    v_pk_fma_f32 v[18:19], v[128:129], v[98:99], v[18:19] op_sel:[0,0,0] op_sel_hi:[0,1,1]
    v_pk_fma_f32 v[20:21], v[130:131], v[100:101], v[20:21] op_sel:[0,0,0] op_sel_hi:[0,1,1]
    v_pk_fma_f32 v[22:23], v[130:131], v[102:103], v[22:23] op_sel:[0,0,0] op_sel_hi:[0,1,1]
    s_set_gpr_idx_off
    v_lshlrev_b32_sdwa v138, v15, v126 dst_sel:DWORD dst_unused:UNUSED_PAD src0_sel:DWORD src1_sel:WORD_1
    s_waitcnt vmcnt(5)
    v_mfma_f32_4x4x4_16b_bf16 v[96:99], v[144:145], v[88:89], 0 cbsz:4 abid:9
    v_readlane_b32 s60, v164, 44
    v_mfma_f32_4x4x4_16b_bf16 v[100:103], v[144:145], v[90:91], 0 cbsz:4 abid:9
    v_lshlrev_b32_sdwa v139, v15, v127 dst_sel:DWORD dst_unused:UNUSED_PAD src0_sel:DWORD src1_sel:WORD_1
    ds_read_u16_d16_hi v134, v138 offset:32768
    ds_read_u16_d16_hi v135, v139 offset:32768
    s_and_b32 s33, s60, s34
    buffer_load_dwordx4 v[80:83], v1, s[12:15], s33 offen
    s_set_gpr_idx_on s53, 0xc
    v_pk_fma_f32 v[16:17], v[128:129], v[104:105], v[16:17] op_sel:[1,0,0] op_sel_hi:[1,1,1]
    v_pk_fma_f32 v[18:19], v[128:129], v[106:107], v[18:19] op_sel:[1,0,0] op_sel_hi:[1,1,1]
    v_pk_fma_f32 v[20:21], v[130:131], v[108:109], v[20:21] op_sel:[1,0,0] op_sel_hi:[1,1,1]
    v_pk_fma_f32 v[22:23], v[130:131], v[110:111], v[22:23] op_sel:[1,0,0] op_sel_hi:[1,1,1]
    s_set_gpr_idx_off
    v_mfma_f32_4x4x4_16b_bf16 v[120:123], v[172:173], v[176:177], 0 cbsz:4 abid:11
    v_lshlrev_b32_sdwa v136, v15, v112 dst_sel:DWORD dst_unused:UNUSED_PAD src0_sel:DWORD src1_sel:WORD_1
    s_waitcnt vmcnt(5)
    v_mfma_f32_4x4x4_16b_bf16 v[104:107], v[146:147], v[92:93], 0 cbsz:4 abid:9
    v_readlane_b32 s61, v164, 45
    v_mfma_f32_4x4x4_16b_bf16 v[108:111], v[146:147], v[94:95], 0 cbsz:4 abid:9
    v_lshlrev_b32_sdwa v137, v15, v113 dst_sel:DWORD dst_unused:UNUSED_PAD src0_sel:DWORD src1_sel:WORD_1
    ds_read_u16_d16_hi v128, v136 offset:32768
    ds_read_u16_d16_hi v129, v137 offset:32768
    s_and_b32 s33, s61, s34
    buffer_load_dwordx4 v[84:87], v1, s[12:15], s33 offen
    s_waitcnt lgkmcnt(2)
    s_set_gpr_idx_on s54, 0xc
    v_pk_fma_f32 v[16:17], v[132:133], v[96:97], v[16:17] op_sel:[0,0,0] op_sel_hi:[0,1,1]
    v_pk_fma_f32 v[18:19], v[132:133], v[98:99], v[18:19] op_sel:[0,0,0] op_sel_hi:[0,1,1]
    v_pk_fma_f32 v[20:21], v[134:135], v[100:101], v[20:21] op_sel:[0,0,0] op_sel_hi:[0,1,1]
    v_pk_fma_f32 v[22:23], v[134:135], v[102:103], v[22:23] op_sel:[0,0,0] op_sel_hi:[0,1,1]
    s_set_gpr_idx_off
    v_lshlrev_b32_sdwa v138, v15, v116 dst_sel:DWORD dst_unused:UNUSED_PAD src0_sel:DWORD src1_sel:WORD_1
    s_waitcnt vmcnt(5)
    v_mfma_f32_4x4x4_16b_bf16 v[96:99], v[140:141], v[64:65], 0 cbsz:4 abid:10
    v_readlane_b32 s62, v164, 46
    v_mfma_f32_4x4x4_16b_bf16 v[100:103], v[140:141], v[66:67], 0 cbsz:4 abid:10
    v_lshlrev_b32_sdwa v139, v15, v117 dst_sel:DWORD dst_unused:UNUSED_PAD src0_sel:DWORD src1_sel:WORD_1
    ds_read_u16_d16_hi v130, v138 offset:32768
    ds_read_u16_d16_hi v131, v139 offset:32768
    s_and_b32 s33, s62, s34
    buffer_load_dwordx4 v[88:91], v1, s[12:15], s33 offen
    s_set_gpr_idx_on s55, 0xc
    v_pk_fma_f32 v[16:17], v[132:133], v[104:105], v[16:17] op_sel:[1,0,0] op_sel_hi:[1,1,1]
    v_pk_fma_f32 v[18:19], v[132:133], v[106:107], v[18:19] op_sel:[1,0,0] op_sel_hi:[1,1,1]
    v_pk_fma_f32 v[20:21], v[134:135], v[108:109], v[20:21] op_sel:[1,0,0] op_sel_hi:[1,1,1]
    v_pk_fma_f32 v[22:23], v[134:135], v[110:111], v[22:23] op_sel:[1,0,0] op_sel_hi:[1,1,1]
    s_set_gpr_idx_off
A_40:
    s_sub_u32 s31, s31, 4
    s_cbranch_scc1 TO_B_40
    v_mfma_f32_4x4x4_16b_bf16 v[124:127], v[172:173], v[178:179], 0 cbsz:4 abid:11
    v_lshlrev_b32_sdwa v136, v15, v114 dst_sel:DWORD dst_unused:UNUSED_PAD src0_sel:DWORD src1_sel:WORD_1
    s_waitcnt vmcnt(5)
    v_mfma_f32_4x4x4_16b_bf16 v[104:107], v[142:143], v[68:69], 0 cbsz:4 abid:10
    v_readlane_b32 s63, v164, 47
    v_mfma_f32_4x4x4_16b_bf16 v[108:111], v[142:143], v[70:71], 0 cbsz:4 abid:10
    v_lshlrev_b32_sdwa v137, v15, v115 dst_sel:DWORD dst_unused:UNUSED_PAD src0_sel:DWORD src1_sel:WORD_1
    ds_read_u16_d16_hi v132, v136 offset:32768
    ds_read_u16_d16_hi v133, v137 offset:32768
    s_and_b32 s33, s63, s34
    buffer_load_dwordx4 v[92:95], v1, s[12:15], s33 offen
    s_waitcnt lgkmcnt(2)
    s_set_gpr_idx_on s56, 0xc
    v_pk_fma_f32 v[16:17], v[128:129], v[96:97], v[16:17] op_sel:[0,0,0] op_sel_hi:[0,1,1]
    v_pk_fma_f32 v[18:19], v[128:129], v[98:99], v[18:19] op_sel:[0,0,0] op_sel_hi:[0,1,1]
    v_pk_fma_f32 v[20:21], v[130:131], v[100:101], v[20:21] op_sel:[0,0,0] op_sel_hi:[0,1,1]
    v_pk_fma_f32 v[22:23], v[130:131], v[102:103], v[22:23] op_sel:[0,0,0] op_sel_hi:[0,1,1]
    s_set_gpr_idx_off
    v_mfma_f32_4x4x4_16b_bf16 v[148:151], v[168:169], v[180:181], 0
    v_lshlrev_b32_sdwa v138, v15, v118 dst_sel:DWORD dst_unused:UNUSED_PAD src0_sel:DWORD src1_sel:WORD_1
    s_waitcnt vmcnt(5)
    v_mfma_f32_4x4x4_16b_bf16 v[96:99], v[144:145], v[72:73], 0 cbsz:4 abid:10
    v_readlane_b32 s48, v164, 48
    v_mfma_f32_4x4x4_16b_bf16 v[100:103], v[144:145], v[74:75], 0 cbsz:4 abid:10
    v_lshlrev_b32_sdwa v139, v15, v119 dst_sel:DWORD dst_unused:UNUSED_PAD src0_sel:DWORD src1_sel:WORD_1
    ds_read_u16_d16_hi v134, v138 offset:32768
    ds_read_u16_d16_hi v135, v139 offset:32768
    s_and_b32 s33, s48, s34
    buffer_load_dwordx4 v[64:67], v1, s[12:15], s33 offen
    s_set_gpr_idx_on s57, 0xc
    v_pk_fma_f32 v[16:17], v[128:129], v[104:105], v[16:17] op_sel:[1,0,0] op_sel_hi:[1,1,1]
    v_pk_fma_f32 v[18:19], v[128:129], v[106:107], v[18:19] op_sel:[1,0,0] op_sel_hi:[1,1,1]
    v_pk_fma_f32 v[20:21], v[130:131], v[108:109], v[20:21] op_sel:[1,0,0] op_sel_hi:[1,1,1]
    v_pk_fma_f32 v[22:23], v[130:131], v[110:111], v[22:23] op_sel:[1,0,0] op_sel_hi:[1,1,1]
    s_set_gpr_idx_off
    v_mfma_f32_4x4x4_16b_bf16 v[112:115], v[172:173], v[176:177], 0 cbsz:4 abid:12
    v_lshlrev_b32_sdwa v136, v15, v120 dst_sel:DWORD dst_unused:UNUSED_PAD src0_sel:DWORD src1_sel:WORD_1
    s_waitcnt vmcnt(5)
    v_mfma_f32_4x4x4_16b_bf16 v[104:107], v[146:147], v[76:77], 0 cbsz:4 abid:10
    v_readlane_b32 s49, v164, 49
    v_mfma_f32_4x4x4_16b_bf16 v[108:111], v[146:147], v[78:79], 0 cbsz:4 abid:10
    v_lshlrev_b32_sdwa v137, v15, v121 dst_sel:DWORD dst_unused:UNUSED_PAD src0_sel:DWORD src1_sel:WORD_1
    ds_read_u16_d16_hi v128, v136 offset:32768
    ds_read_u16_d16_hi v129, v137 offset:32768
    s_and_b32 s33, s49, s34
    buffer_load_dwordx4 v[68:71], v1, s[12:15], s33 offen
    s_waitcnt lgkmcnt(2)
    s_set_gpr_idx_on s58, 0xc
    v_pk_fma_f32 v[16:17], v[132:133], v[96:97], v[16:17] op_sel:[0,0,0] op_sel_hi:[0,1,1]
    v_pk_fma_f32 v[18:19], v[132:133], v[98:99], v[18:19] op_sel:[0,0,0] op_sel_hi:[0,1,1]
    v_pk_fma_f32 v[20:21], v[134:135], v[100:101], v[20:21] op_sel:[0,0,0] op_sel_hi:[0,1,1]
    v_pk_fma_f32 v[22:23], v[134:135], v[102:103], v[22:23] op_sel:[0,0,0] op_sel_hi:[0,1,1]
    s_set_gpr_idx_off
    v_mfma_f32_4x4x4_16b_bf16 v[152:155], v[168:169], v[182:183], 0
    v_lshlrev_b32_sdwa v138, v15, v124 dst_sel:DWORD dst_unused:UNUSED_PAD src0_sel:DWORD src1_sel:WORD_1
    s_waitcnt vmcnt(5)
    v_mfma_f32_4x4x4_16b_bf16 v[96:99], v[140:141], v[80:81], 0 cbsz:4 abid:11
    v_readlane_b32 s50, v164, 50
    v_mfma_f32_4x4x4_16b_bf16 v[100:103], v[140:141], v[82:83], 0 cbsz:4 abid:11
    v_lshlrev_b32_sdwa v139, v15, v125 dst_sel:DWORD dst_unused:UNUSED_PAD src0_sel:DWORD src1_sel:WORD_1
    ds_read_u16_d16_hi v130, v138 offset:32768
    ds_read_u16_d16_hi v131, v139 offset:32768
    s_and_b32 s33, s50, s34
    buffer_load_dwordx4 v[72:75], v1, s[12:15], s33 offen
    s_set_gpr_idx_on s59, 0xc
    v_pk_fma_f32 v[16:17], v[132:133], v[104:105], v[16:17] op_sel:[1,0,0] op_sel_hi:[1,1,1]
    v_pk_fma_f32 v[18:19], v[132:133], v[106:107], v[18:19] op_sel:[1,0,0] op_sel_hi:[1,1,1]
    v_pk_fma_f32 v[20:21], v[134:135], v[108:109], v[20:21] op_sel:[1,0,0] op_sel_hi:[1,1,1]
    v_pk_fma_f32 v[22:23], v[134:135], v[110:111], v[22:23] op_sel:[1,0,0] op_sel_hi:[1,1,1]
    s_set_gpr_idx_off
A_44:
    s_sub_u32 s31, s31, 4
    s_cbranch_scc1 TO_B_44
    v_mfma_f32_4x4x4_16b_bf16 v[116:119], v[172:173], v[178:179], 0 cbsz:4 abid:12
    v_lshlrev_b32_sdwa v136, v15, v122 dst_sel:DWORD dst_unused:UNUSED_PAD src0_sel:DWORD src1_sel:WORD_1
    s_waitcnt vmcnt(5)
    v_mfma_f32_4x4x4_16b_bf16 v[104:107], v[142:143], v[84:85], 0 cbsz:4 abid:11
    v_readlane_b32 s51, v164, 51
    v_mfma_f32_4x4x4_16b_bf16 v[108:111], v[142:143], v[86:87], 0 cbsz:4 abid:11
    v_lshlrev_b32_sdwa v137, v15, v123 dst_sel:DWORD dst_unused:UNUSED_PAD src0_sel:DWORD src1_sel:WORD_1
    ds_read_u16_d16_hi v132, v136 offset:32768
    ds_read_u16_d16_hi v133, v137 offset:32768
    s_and_b32 s33, s51, s34
    buffer_load_dwordx4 v[76:79], v1, s[12:15], s33 offen
    s_waitcnt lgkmcnt(2)
    s_set_gpr_idx_on s60, 0xc
    v_pk_fma_f32 v[16:17], v[128:129], v[96:97], v[16:17] op_sel:[0,0,0] op_sel_hi:[0,1,1]
    v_pk_fma_f32 v[18:19], v[128:129], v[98:99], v[18:19] op_sel:[0,0,0] op_sel_hi:[0,1,1]
    v_pk_fma_f32 v[20:21], v[130:131], v[100:101], v[20:21] op_sel:[0,0,0] op_sel_hi:[0,1,1]
    v_pk_fma_f32 v[22:23], v[130:131], v[102:103], v[22:23] op_sel:[0,0,0] op_sel_hi:[0,1,1]
    s_set_gpr_idx_off
    v_mfma_f32_4x4x4_16b_bf16 v[156:159], v[168:169], v[184:185], 0
    v_lshlrev_b32_sdwa v138, v15, v126 dst_sel:DWORD dst_unused:UNUSED_PAD src0_sel:DWORD src1_sel:WORD_1
    s_waitcnt vmcnt(5)
    v_mfma_f32_4x4x4_16b_bf16 v[96:99], v[144:145], v[88:89], 0 cbsz:4 abid:11
    v_readlane_b32 s52, v164, 52
    v_mfma_f32_4x4x4_16b_bf16 v[100:103], v[144:145], v[90:91], 0 cbsz:4 abid:11
    v_lshlrev_b32_sdwa v139, v15, v127 dst_sel:DWORD dst_unused:UNUSED_PAD src0_sel:DWORD src1_sel:WORD_1
    ds_read_u16_d16_hi v134, v138 offset:32768
    ds_read_u16_d16_hi v135, v139 offset:32768
    s_and_b32 s33, s52, s34
    buffer_load_dwordx4 v[80:83], v1, s[12:15], s33 offen
    s_set_gpr_idx_on s61, 0xc
    v_pk_fma_f32 v[16:17], v[128:129], v[104:105], v[16:17] op_sel:[1,0,0] op_sel_hi:[1,1,1]
    v_pk_fma_f32 v[18:19], v[128:129], v[106:107], v[18:19] op_sel:[1,0,0] op_sel_hi:[1,1,1]
    v_pk_fma_f32 v[20:21], v[130:131], v[108:109], v[20:21] op_sel:[1,0,0] op_sel_hi:[1,1,1]
    v_pk_fma_f32 v[22:23], v[130:131], v[110:111], v[22:23] op_sel:[1,0,0] op_sel_hi:[1,1,1]
    s_set_gpr_idx_off
    v_mfma_f32_4x4x4_16b_bf16 v[120:123], v[172:173], v[176:177], 0 cbsz:4 abid:13
    v_lshlrev_b32_sdwa v136, v15, v112 dst_sel:DWORD dst_unused:UNUSED_PAD src0_sel:DWORD src1_sel:WORD_1
    s_waitcnt vmcnt(5)
    v_mfma_f32_4x4x4_16b_bf16 v[104:107], v[146:147], v[92:93], 0 cbsz:4 abid:11
    v_readlane_b32 s53, v164, 53
    v_mfma_f32_4x4x4_16b_bf16 v[108:111], v[146:147], v[94:95], 0 cbsz:4 abid:11
    v_lshlrev_b32_sdwa v137, v15, v113 dst_sel:DWORD dst_unused:UNUSED_PAD src0_sel:DWORD src1_sel:WORD_1
    ds_read_u16_d16_hi v128, v136 offset:32768
    ds_read_u16_d16_hi v129, v137 offset:32768
    s_and_b32 s33, s53, s34
    buffer_load_dwordx4 v[84:87], v1, s[12:15], s33 offen
    s_waitcnt lgkmcnt(2)
    s_set_gpr_idx_on s62, 0xc
    v_pk_fma_f32 v[16:17], v[132:133], v[96:97], v[16:17] op_sel:[0,0,0] op_sel_hi:[0,1,1]
    v_pk_fma_f32 v[18:19], v[132:133], v[98:99], v[18:19] op_sel:[0,0,0] op_sel_hi:[0,1,1]
    v_pk_fma_f32 v[20:21], v[134:135], v[100:101], v[20:21] op_sel:[0,0,0] op_sel_hi:[0,1,1]
    v_pk_fma_f32 v[22:23], v[134:135], v[102:103], v[22:23] op_sel:[0,0,0] op_sel_hi:[0,1,1]
    s_set_gpr_idx_off
    v_mfma_f32_4x4x4_16b_bf16 v[160:163], v[168:169], v[186:187], 0
    v_lshlrev_b32_sdwa v138, v15, v116 dst_sel:DWORD dst_unused:UNUSED_PAD src0_sel:DWORD src1_sel:WORD_1
    s_waitcnt vmcnt(5)
    v_mfma_f32_4x4x4_16b_bf16 v[96:99], v[140:141], v[64:65], 0 cbsz:4 abid:12
    v_readlane_b32 s54, v164, 54
    v_mfma_f32_4x4x4_16b_bf16 v[100:103], v[140:141], v[66:67], 0 cbsz:4 abid:12
    v_lshlrev_b32_sdwa v139, v15, v117 dst_sel:DWORD dst_unused:UNUSED_PAD src0_sel:DWORD src1_sel:WORD_1
    ds_read_u16_d16_hi v130, v138 offset:32768
    ds_read_u16_d16_hi v131, v139 offset:32768
    s_and_b32 s33, s54, s34
    buffer_load_dwordx4 v[88:91], v1, s[12:15], s33 offen
    s_set_gpr_idx_on s63, 0xc
    v_pk_fma_f32 v[16:17], v[132:133], v[104:105], v[16:17] op_sel:[1,0,0] op_sel_hi:[1,1,1]
    v_pk_fma_f32 v[18:19], v[132:133], v[106:107], v[18:19] op_sel:[1,0,0] op_sel_hi:[1,1,1]
    v_pk_fma_f32 v[20:21], v[134:135], v[108:109], v[20:21] op_sel:[1,0,0] op_sel_hi:[1,1,1]
    v_pk_fma_f32 v[22:23], v[134:135], v[110:111], v[22:23] op_sel:[1,0,0] op_sel_hi:[1,1,1]
    s_set_gpr_idx_off
A_48:
    s_sub_u32 s31, s31, 4
    s_cbranch_scc1 TO_B_48
    v_mfma_f32_4x4x4_16b_bf16 v[124:127], v[172:173], v[178:179], 0 cbsz:4 abid:13
    v_lshlrev_b32_sdwa v136, v15, v114 dst_sel:DWORD dst_unused:UNUSED_PAD src0_sel:DWORD src1_sel:WORD_1
    s_waitcnt vmcnt(5)
    v_mfma_f32_4x4x4_16b_bf16 v[104:107], v[142:143], v[68:69], 0 cbsz:4 abid:12
    v_readlane_b32 s55, v164, 55
    v_mfma_f32_4x4x4_16b_bf16 v[108:111], v[142:143], v[70:71], 0 cbsz:4 abid:12
    v_lshlrev_b32_sdwa v137, v15, v115 dst_sel:DWORD dst_unused:UNUSED_PAD src0_sel:DWORD src1_sel:WORD_1
    ds_read_u16_d16_hi v132, v136 offset:32768
    ds_read_u16_d16_hi v133, v137 offset:32768
    s_and_b32 s33, s55, s34
    buffer_load_dwordx4 v[92:95], v1, s[12:15], s33 offen
    s_waitcnt lgkmcnt(2)
    s_set_gpr_idx_on s48, 0xc
    v_pk_fma_f32 v[16:17], v[128:129], v[96:97], v[16:17] op_sel:[0,0,0] op_sel_hi:[0,1,1]
    v_pk_fma_f32 v[18:19], v[128:129], v[98:99], v[18:19] op_sel:[0,0,0] op_sel_hi:[0,1,1]
    v_pk_fma_f32 v[20:21], v[130:131], v[100:101], v[20:21] op_sel:[0,0,0] op_sel_hi:[0,1,1]
    v_pk_fma_f32 v[22:23], v[130:131], v[102:103], v[22:23] op_sel:[0,0,0] op_sel_hi:[0,1,1]
    s_set_gpr_idx_off
    v_lshlrev_b32_sdwa v138, v15, v118 dst_sel:DWORD dst_unused:UNUSED_PAD src0_sel:DWORD src1_sel:WORD_1
    s_waitcnt vmcnt(5)
    v_mfma_f32_4x4x4_16b_bf16 v[96:99], v[144:145], v[72:73], 0 cbsz:4 abid:12
    v_readlane_b32 s56, v164, 56
    v_mfma_f32_4x4x4_16b_bf16 v[100:103], v[144:145], v[74:75], 0 cbsz:4 abid:12
    v_lshlrev_b32_sdwa v139, v15, v119 dst_sel:DWORD dst_unused:UNUSED_PAD src0_sel:DWORD src1_sel:WORD_1
    ds_read_u16_d16_hi v134, v138 offset:32768
    ds_read_u16_d16_hi v135, v139 offset:32768
    s_and_b32 s33, s56, s34
    buffer_load_dwordx4 v[64:67], v1, s[12:15], s33 offen
    s_set_gpr_idx_on s49, 0xc
    v_pk_fma_f32 v[16:17], v[128:129], v[104:105], v[16:17] op_sel:[1,0,0] op_sel_hi:[1,1,1]
    v_pk_fma_f32 v[18:19], v[128:129], v[106:107], v[18:19] op_sel:[1,0,0] op_sel_hi:[1,1,1]
    v_pk_fma_f32 v[20:21], v[130:131], v[108:109], v[20:21] op_sel:[1,0,0] op_sel_hi:[1,1,1]
    v_pk_fma_f32 v[22:23], v[130:131], v[110:111], v[22:23] op_sel:[1,0,0] op_sel_hi:[1,1,1]
    s_set_gpr_idx_off
    v_mfma_f32_4x4x4_16b_bf16 v[112:115], v[172:173], v[176:177], 0 cbsz:4 abid:14
    v_lshlrev_b32_sdwa v136, v15, v120 dst_sel:DWORD dst_unused:UNUSED_PAD src0_sel:DWORD src1_sel:WORD_1
    s_waitcnt vmcnt(5)
    v_mfma_f32_4x4x4_16b_bf16 v[104:107], v[146:147], v[76:77], 0 cbsz:4 abid:12
    v_readlane_b32 s57, v164, 57
    v_mfma_f32_4x4x4_16b_bf16 v[108:111], v[146:147], v[78:79], 0 cbsz:4 abid:12
    v_lshlrev_b32_sdwa v137, v15, v121 dst_sel:DWORD dst_unused:UNUSED_PAD src0_sel:DWORD src1_sel:WORD_1
    ds_read_u16_d16_hi v128, v136 offset:32768
    ds_read_u16_d16_hi v129, v137 offset:32768
    s_and_b32 s33, s57, s34
    buffer_load_dwordx4 v[68:71], v1, s[12:15], s33 offen
    s_waitcnt lgkmcnt(2)
    s_set_gpr_idx_on s50, 0xc
    v_pk_fma_f32 v[16:17], v[132:133], v[96:97], v[16:17] op_sel:[0,0,0] op_sel_hi:[0,1,1]
    v_pk_fma_f32 v[18:19], v[132:133], v[98:99], v[18:19] op_sel:[0,0,0] op_sel_hi:[0,1,1]
    v_pk_fma_f32 v[20:21], v[134:135], v[100:101], v[20:21] op_sel:[0,0,0] op_sel_hi:[0,1,1]
    v_pk_fma_f32 v[22:23], v[134:135], v[102:103], v[22:23] op_sel:[0,0,0] op_sel_hi:[0,1,1]
    s_set_gpr_idx_off
    v_lshlrev_b32_sdwa v138, v15, v124 dst_sel:DWORD dst_unused:UNUSED_PAD src0_sel:DWORD src1_sel:WORD_1
    s_waitcnt vmcnt(5)
    v_mfma_f32_4x4x4_16b_bf16 v[96:99], v[140:141], v[80:81], 0 cbsz:4 abid:13
    v_readlane_b32 s58, v164, 58
    v_mfma_f32_4x4x4_16b_bf16 v[100:103], v[140:141], v[82:83], 0 cbsz:4 abid:13
    v_lshlrev_b32_sdwa v139, v15, v125 dst_sel:DWORD dst_unused:UNUSED_PAD src0_sel:DWORD src1_sel:WORD_1
    ds_read_u16_d16_hi v130, v138 offset:32768
    ds_read_u16_d16_hi v131, v139 offset:32768
    s_and_b32 s33, s58, s34
    buffer_load_dwordx4 v[72:75], v1, s[12:15], s33 offen
    s_set_gpr_idx_on s51, 0xc
    v_pk_fma_f32 v[16:17], v[132:133], v[104:105], v[16:17] op_sel:[1,0,0] op_sel_hi:[1,1,1]
    v_pk_fma_f32 v[18:19], v[132:133], v[106:107], v[18:19] op_sel:[1,0,0] op_sel_hi:[1,1,1]
    v_pk_fma_f32 v[20:21], v[134:135], v[108:109], v[20:21] op_sel:[1,0,0] op_sel_hi:[1,1,1]
    v_pk_fma_f32 v[22:23], v[134:135], v[110:111], v[22:23] op_sel:[1,0,0] op_sel_hi:[1,1,1]
    s_set_gpr_idx_off
A_52:
    s_sub_u32 s31, s31, 4
    s_cbranch_scc1 TO_B_52
    v_mfma_f32_4x4x4_16b_bf16 v[116:119], v[172:173], v[178:179], 0 cbsz:4 abid:14
    v_lshlrev_b32_sdwa v136, v15, v122 dst_sel:DWORD dst_unused:UNUSED_PAD src0_sel:DWORD src1_sel:WORD_1
    s_waitcnt vmcnt(5)
    v_mfma_f32_4x4x4_16b_bf16 v[104:107], v[142:143], v[84:85], 0 cbsz:4 abid:13
    v_readlane_b32 s59, v164, 59
    v_mfma_f32_4x4x4_16b_bf16 v[108:111], v[142:143], v[86:87], 0 cbsz:4 abid:13
    v_lshlrev_b32_sdwa v137, v15, v123 dst_sel:DWORD dst_unused:UNUSED_PAD src0_sel:DWORD src1_sel:WORD_1
    ds_read_u16_d16_hi v132, v136 offset:32768
    ds_read_u16_d16_hi v133, v137 offset:32768
    s_and_b32 s33, s59, s34
    buffer_load_dwordx4 v[76:79], v1, s[12:15], s33 offen
    s_waitcnt lgkmcnt(2)
    s_set_gpr_idx_on s52, 0xc
    v_pk_fma_f32 v[16:17], v[128:129], v[96:97], v[16:17] op_sel:[0,0,0] op_sel_hi:[0,1,1]
    v_pk_fma_f32 v[18:19], v[128:129], v[98:99], v[18:19] op_sel:[0,0,0] op_sel_hi:[0,1,1]
    v_pk_fma_f32 v[20:21], v[130:131], v[100:101], v[20:21] op_sel:[0,0,0] op_sel_hi:[0,1,1]
    v_pk_fma_f32 v[22:23], v[130:131], v[102:103], v[22:23] op_sel:[0,0,0] op_sel_hi:[0,1,1]
    s_set_gpr_idx_off
    v_lshlrev_b32_sdwa v138, v15, v126 dst_sel:DWORD dst_unused:UNUSED_PAD src0_sel:DWORD src1_sel:WORD_1
    s_waitcnt vmcnt(5)
    v_mfma_f32_4x4x4_16b_bf16 v[96:99], v[144:145], v[88:89], 0 cbsz:4 abid:13
    v_readlane_b32 s60, v164, 60
    v_mfma_f32_4x4x4_16b_bf16 v[100:103], v[144:145], v[90:91], 0 cbsz:4 abid:13
    v_lshlrev_b32_sdwa v139, v15, v127 dst_sel:DWORD dst_unused:UNUSED_PAD src0_sel:DWORD src1_sel:WORD_1
    ds_read_u16_d16_hi v134, v138 offset:32768
    ds_read_u16_d16_hi v135, v139 offset:32768
    s_and_b32 s33, s60, s34
    buffer_load_dwordx4 v[80:83], v1, s[12:15], s33 offen
    s_set_gpr_idx_on s53, 0xc
    v_pk_fma_f32 v[16:17], v[128:129], v[104:105], v[16:17] op_sel:[1,0,0] op_sel_hi:[1,1,1]
    v_pk_fma_f32 v[18:19], v[128:129], v[106:107], v[18:19] op_sel:[1,0,0] op_sel_hi:[1,1,1]
    v_pk_fma_f32 v[20:21], v[130:131], v[108:109], v[20:21] op_sel:[1,0,0] op_sel_hi:[1,1,1]
    v_pk_fma_f32 v[22:23], v[130:131], v[110:111], v[22:23] op_sel:[1,0,0] op_sel_hi:[1,1,1]
    s_set_gpr_idx_off
    v_mfma_f32_4x4x4_16b_bf16 v[120:123], v[172:173], v[176:177], 0 cbsz:4 abid:15
    v_lshlrev_b32_sdwa v136, v15, v112 dst_sel:DWORD dst_unused:UNUSED_PAD src0_sel:DWORD src1_sel:WORD_1
    s_waitcnt vmcnt(5)
    v_mfma_f32_4x4x4_16b_bf16 v[104:107], v[146:147], v[92:93], 0 cbsz:4 abid:13
    v_readlane_b32 s61, v164, 61
    v_mfma_f32_4x4x4_16b_bf16 v[108:111], v[146:147], v[94:95], 0 cbsz:4 abid:13
    v_lshlrev_b32_sdwa v137, v15, v113 dst_sel:DWORD dst_unused:UNUSED_PAD src0_sel:DWORD src1_sel:WORD_1
    ds_read_u16_d16_hi v128, v136 offset:32768
    ds_read_u16_d16_hi v129, v137 offset:32768
    s_and_b32 s33, s61, s34
    buffer_load_dwordx4 v[84:87], v1, s[12:15], s33 offen
    s_waitcnt lgkmcnt(2)
    s_set_gpr_idx_on s54, 0xc
    v_pk_fma_f32 v[16:17], v[132:133], v[96:97], v[16:17] op_sel:[0,0,0] op_sel_hi:[0,1,1]
    v_pk_fma_f32 v[18:19], v[132:133], v[98:99], v[18:19] op_sel:[0,0,0] op_sel_hi:[0,1,1]
    v_pk_fma_f32 v[20:21], v[134:135], v[100:101], v[20:21] op_sel:[0,0,0] op_sel_hi:[0,1,1]
    v_pk_fma_f32 v[22:23], v[134:135], v[102:103], v[22:23] op_sel:[0,0,0] op_sel_hi:[0,1,1]
    s_set_gpr_idx_off
    v_lshlrev_b32_sdwa v138, v15, v116 dst_sel:DWORD dst_unused:UNUSED_PAD src0_sel:DWORD src1_sel:WORD_1
    s_waitcnt vmcnt(5)
    v_mfma_f32_4x4x4_16b_bf16 v[96:99], v[140:141], v[64:65], 0 cbsz:4 abid:14
    v_readlane_b32 s62, v164, 62
    v_mfma_f32_4x4x4_16b_bf16 v[100:103], v[140:141], v[66:67], 0 cbsz:4 abid:14
    v_lshlrev_b32_sdwa v139, v15, v117 dst_sel:DWORD dst_unused:UNUSED_PAD src0_sel:DWORD src1_sel:WORD_1
    ds_read_u16_d16_hi v130, v138 offset:32768
    ds_read_u16_d16_hi v131, v139 offset:32768
    s_and_b32 s33, s62, s34
    buffer_load_dwordx4 v[88:91], v1, s[12:15], s33 offen
    s_set_gpr_idx_on s55, 0xc
    v_pk_fma_f32 v[16:17], v[132:133], v[104:105], v[16:17] op_sel:[1,0,0] op_sel_hi:[1,1,1]
    v_pk_fma_f32 v[18:19], v[132:133], v[106:107], v[18:19] op_sel:[1,0,0] op_sel_hi:[1,1,1]
    v_pk_fma_f32 v[20:21], v[134:135], v[108:109], v[20:21] op_sel:[1,0,0] op_sel_hi:[1,1,1]
    v_pk_fma_f32 v[22:23], v[134:135], v[110:111], v[22:23] op_sel:[1,0,0] op_sel_hi:[1,1,1]
    s_set_gpr_idx_off
A_56:
    s_sub_u32 s31, s31, 4
    s_cbranch_scc1 TO_B_56
    v_mfma_f32_4x4x4_16b_bf16 v[124:127], v[172:173], v[178:179], 0 cbsz:4 abid:15
    v_lshlrev_b32_sdwa v136, v15, v114 dst_sel:DWORD dst_unused:UNUSED_PAD src0_sel:DWORD src1_sel:WORD_1
    s_waitcnt vmcnt(5)
    v_mfma_f32_4x4x4_16b_bf16 v[104:107], v[142:143], v[68:69], 0 cbsz:4 abid:14
    v_readlane_b32 s63, v164, 63
    v_mfma_f32_4x4x4_16b_bf16 v[108:111], v[142:143], v[70:71], 0 cbsz:4 abid:14
    v_lshlrev_b32_sdwa v137, v15, v115 dst_sel:DWORD dst_unused:UNUSED_PAD src0_sel:DWORD src1_sel:WORD_1
    ds_read_u16_d16_hi v132, v136 offset:32768
    ds_read_u16_d16_hi v133, v137 offset:32768
    s_and_b32 s33, s63, s34
    buffer_load_dwordx4 v[92:95], v1, s[12:15], s33 offen
    s_waitcnt lgkmcnt(2)
    s_set_gpr_idx_on s56, 0xc
    v_pk_fma_f32 v[16:17], v[128:129], v[96:97], v[16:17] op_sel:[0,0,0] op_sel_hi:[0,1,1]
    v_pk_fma_f32 v[18:19], v[128:129], v[98:99], v[18:19] op_sel:[0,0,0] op_sel_hi:[0,1,1]
    v_pk_fma_f32 v[20:21], v[130:131], v[100:101], v[20:21] op_sel:[0,0,0] op_sel_hi:[0,1,1]
    v_pk_fma_f32 v[22:23], v[130:131], v[102:103], v[22:23] op_sel:[0,0,0] op_sel_hi:[0,1,1]
    s_set_gpr_idx_off
    v_lshlrev_b32_sdwa v138, v15, v118 dst_sel:DWORD dst_unused:UNUSED_PAD src0_sel:DWORD src1_sel:WORD_1
    s_waitcnt vmcnt(5)
    v_mfma_f32_4x4x4_16b_bf16 v[96:99], v[144:145], v[72:73], 0 cbsz:4 abid:14
    v_readlane_b32 s48, v165, 0
    v_mfma_f32_4x4x4_16b_bf16 v[100:103], v[144:145], v[74:75], 0 cbsz:4 abid:14
    v_lshlrev_b32_sdwa v139, v15, v119 dst_sel:DWORD dst_unused:UNUSED_PAD src0_sel:DWORD src1_sel:WORD_1
    ds_read_u16_d16_hi v134, v138 offset:32768
    ds_read_u16_d16_hi v135, v139 offset:32768
    s_and_b32 s33, s48, s34
    buffer_load_dwordx4 v[64:67], v1, s[12:15], s33 offen
    s_set_gpr_idx_on s57, 0xc
    v_pk_fma_f32 v[16:17], v[128:129], v[104:105], v[16:17] op_sel:[1,0,0] op_sel_hi:[1,1,1]
    v_pk_fma_f32 v[18:19], v[128:129], v[106:107], v[18:19] op_sel:[1,0,0] op_sel_hi:[1,1,1]
    v_pk_fma_f32 v[20:21], v[130:131], v[108:109], v[20:21] op_sel:[1,0,0] op_sel_hi:[1,1,1]
    v_pk_fma_f32 v[22:23], v[130:131], v[110:111], v[22:23] op_sel:[1,0,0] op_sel_hi:[1,1,1]
    s_set_gpr_idx_off
    v_mov_b32 v172, v170
    v_mov_b32 v173, v171
    s_nop 1
    v_mfma_f32_4x4x4_16b_bf16 v[112:115], v[172:173], v[176:177], 0 cbsz:4 abid:0
    v_lshlrev_b32_sdwa v136, v15, v120 dst_sel:DWORD dst_unused:UNUSED_PAD src0_sel:DWORD src1_sel:WORD_1
    s_waitcnt vmcnt(5)
    v_mfma_f32_4x4x4_16b_bf16 v[104:107], v[146:147], v[76:77], 0 cbsz:4 abid:14
    v_readlane_b32 s49, v165, 1
    v_mfma_f32_4x4x4_16b_bf16 v[108:111], v[146:147], v[78:79], 0 cbsz:4 abid:14
    v_lshlrev_b32_sdwa v137, v15, v121 dst_sel:DWORD dst_unused:UNUSED_PAD src0_sel:DWORD src1_sel:WORD_1
    ds_read_u16_d16_hi v128, v136 offset:32768
    ds_read_u16_d16_hi v129, v137 offset:32768
    s_and_b32 s33, s49, s34
    buffer_load_dwordx4 v[68:71], v1, s[12:15], s33 offen
    s_waitcnt lgkmcnt(2)
    s_set_gpr_idx_on s58, 0xc
    v_pk_fma_f32 v[16:17], v[132:133], v[96:97], v[16:17] op_sel:[0,0,0] op_sel_hi:[0,1,1]
    v_pk_fma_f32 v[18:19], v[132:133], v[98:99], v[18:19] op_sel:[0,0,0] op_sel_hi:[0,1,1]
    v_pk_fma_f32 v[20:21], v[134:135], v[100:101], v[20:21] op_sel:[0,0,0] op_sel_hi:[0,1,1]
    v_pk_fma_f32 v[22:23], v[134:135], v[102:103], v[22:23] op_sel:[0,0,0] op_sel_hi:[0,1,1]
    s_set_gpr_idx_off
    v_lshlrev_b32_sdwa v138, v15, v124 dst_sel:DWORD dst_unused:UNUSED_PAD src0_sel:DWORD src1_sel:WORD_1
    s_waitcnt vmcnt(5)
    v_mfma_f32_4x4x4_16b_bf16 v[96:99], v[140:141], v[80:81], 0 cbsz:4 abid:15
    v_readlane_b32 s50, v165, 2
    v_mfma_f32_4x4x4_16b_bf16 v[100:103], v[140:141], v[82:83], 0 cbsz:4 abid:15
    v_lshlrev_b32_sdwa v139, v15, v125 dst_sel:DWORD dst_unused:UNUSED_PAD src0_sel:DWORD src1_sel:WORD_1
    ds_read_u16_d16_hi v130, v138 offset:32768
    ds_read_u16_d16_hi v131, v139 offset:32768
    s_and_b32 s33, s50, s34
    buffer_load_dwordx4 v[72:75], v1, s[12:15], s33 offen
    s_set_gpr_idx_on s59, 0xc
    v_pk_fma_f32 v[16:17], v[132:133], v[104:105], v[16:17] op_sel:[1,0,0] op_sel_hi:[1,1,1]
    v_pk_fma_f32 v[18:19], v[132:133], v[106:107], v[18:19] op_sel:[1,0,0] op_sel_hi:[1,1,1]
    v_pk_fma_f32 v[20:21], v[134:135], v[108:109], v[20:21] op_sel:[1,0,0] op_sel_hi:[1,1,1]
    v_pk_fma_f32 v[22:23], v[134:135], v[110:111], v[22:23] op_sel:[1,0,0] op_sel_hi:[1,1,1]
    s_set_gpr_idx_off
A_60:
    s_sub_u32 s31, s31, 4
    s_cbranch_scc1 TO_B_60
    v_mfma_f32_4x4x4_16b_bf16 v[116:119], v[172:173], v[178:179], 0 cbsz:4 abid:0
    v_lshlrev_b32_sdwa v136, v15, v122 dst_sel:DWORD dst_unused:UNUSED_PAD src0_sel:DWORD src1_sel:WORD_1
    s_waitcnt vmcnt(5)
    v_mfma_f32_4x4x4_16b_bf16 v[104:107], v[142:143], v[84:85], 0 cbsz:4 abid:15
    v_readlane_b32 s51, v165, 3
    v_mfma_f32_4x4x4_16b_bf16 v[108:111], v[142:143], v[86:87], 0 cbsz:4 abid:15
    v_lshlrev_b32_sdwa v137, v15, v123 dst_sel:DWORD dst_unused:UNUSED_PAD src0_sel:DWORD src1_sel:WORD_1
    ds_read_u16_d16_hi v132, v136 offset:32768
    ds_read_u16_d16_hi v133, v137 offset:32768
    v_cvt_pk_bf16_f32 v140, v148, v152
    v_cvt_pk_bf16_f32 v141, v156, v160
    s_and_b32 s33, s51, s34
    buffer_load_dwordx4 v[76:79], v1, s[12:15], s33 offen
    s_waitcnt lgkmcnt(2)
    s_set_gpr_idx_on s60, 0xc
    v_pk_fma_f32 v[16:17], v[128:129], v[96:97], v[16:17] op_sel:[0,0,0] op_sel_hi:[0,1,1]
    v_pk_fma_f32 v[18:19], v[128:129], v[98:99], v[18:19] op_sel:[0,0,0] op_sel_hi:[0,1,1]
    v_pk_fma_f32 v[20:21], v[130:131], v[100:101], v[20:21] op_sel:[0,0,0] op_sel_hi:[0,1,1]
    v_pk_fma_f32 v[22:23], v[130:131], v[102:103], v[22:23] op_sel:[0,0,0] op_sel_hi:[0,1,1]
    s_set_gpr_idx_off
    v_lshlrev_b32_sdwa v138, v15, v126 dst_sel:DWORD dst_unused:UNUSED_PAD src0_sel:DWORD src1_sel:WORD_1
    s_waitcnt vmcnt(5)
    v_mfma_f32_4x4x4_16b_bf16 v[96:99], v[144:145], v[88:89], 0 cbsz:4 abid:15
    v_readlane_b32 s52, v165, 4
    v_mfma_f32_4x4x4_16b_bf16 v[100:103], v[144:145], v[90:91], 0 cbsz:4 abid:15
    v_lshlrev_b32_sdwa v139, v15, v127 dst_sel:DWORD dst_unused:UNUSED_PAD src0_sel:DWORD src1_sel:WORD_1
    ds_read_u16_d16_hi v134, v138 offset:32768
    ds_read_u16_d16_hi v135, v139 offset:32768
    v_cvt_pk_bf16_f32 v142, v149, v153
    v_cvt_pk_bf16_f32 v143, v157, v161
    s_and_b32 s33, s52, s34
    buffer_load_dwordx4 v[80:83], v1, s[12:15], s33 offen
    s_set_gpr_idx_on s61, 0xc
    v_pk_fma_f32 v[16:17], v[128:129], v[104:105], v[16:17] op_sel:[1,0,0] op_sel_hi:[1,1,1]
    v_pk_fma_f32 v[18:19], v[128:129], v[106:107], v[18:19] op_sel:[1,0,0] op_sel_hi:[1,1,1]
    v_pk_fma_f32 v[20:21], v[130:131], v[108:109], v[20:21] op_sel:[1,0,0] op_sel_hi:[1,1,1]
    v_pk_fma_f32 v[22:23], v[130:131], v[110:111], v[22:23] op_sel:[1,0,0] op_sel_hi:[1,1,1]
    s_set_gpr_idx_off
    v_mfma_f32_4x4x4_16b_bf16 v[120:123], v[172:173], v[176:177], 0 cbsz:4 abid:1
    v_lshlrev_b32_sdwa v136, v15, v112 dst_sel:DWORD dst_unused:UNUSED_PAD src0_sel:DWORD src1_sel:WORD_1
    s_waitcnt vmcnt(5)
    v_mfma_f32_4x4x4_16b_bf16 v[104:107], v[146:147], v[92:93], 0 cbsz:4 abid:15
    v_readlane_b32 s53, v165, 5
    v_mfma_f32_4x4x4_16b_bf16 v[108:111], v[146:147], v[94:95], 0 cbsz:4 abid:15
    v_lshlrev_b32_sdwa v137, v15, v113 dst_sel:DWORD dst_unused:UNUSED_PAD src0_sel:DWORD src1_sel:WORD_1
    ds_read_u16_d16_hi v128, v136 offset:32768
    ds_read_u16_d16_hi v129, v137 offset:32768
    v_cvt_pk_bf16_f32 v144, v150, v154
    v_cvt_pk_bf16_f32 v145, v158, v162
    s_and_b32 s33, s53, s34
    buffer_load_dwordx4 v[84:87], v1, s[12:15], s33 offen
    s_waitcnt lgkmcnt(2)
    s_set_gpr_idx_on s62, 0xc
    v_pk_fma_f32 v[16:17], v[132:133], v[96:97], v[16:17] op_sel:[0,0,0] op_sel_hi:[0,1,1]
    v_pk_fma_f32 v[18:19], v[132:133], v[98:99], v[18:19] op_sel:[0,0,0] op_sel_hi:[0,1,1]
    v_pk_fma_f32 v[20:21], v[134:135], v[100:101], v[20:21] op_sel:[0,0,0] op_sel_hi:[0,1,1]
    v_pk_fma_f32 v[22:23], v[134:135], v[102:103], v[22:23] op_sel:[0,0,0] op_sel_hi:[0,1,1]
    s_set_gpr_idx_off
    v_lshlrev_b32_sdwa v138, v15, v116 dst_sel:DWORD dst_unused:UNUSED_PAD src0_sel:DWORD src1_sel:WORD_1
    s_waitcnt vmcnt(5)
    v_mfma_f32_4x4x4_16b_bf16 v[96:99], v[140:141], v[64:65], 0 cbsz:4 abid:0
    v_readlane_b32 s54, v165, 6
    v_mfma_f32_4x4x4_16b_bf16 v[100:103], v[140:141], v[66:67], 0 cbsz:4 abid:0
    v_lshlrev_b32_sdwa v139, v15, v117 dst_sel:DWORD dst_unused:UNUSED_PAD src0_sel:DWORD src1_sel:WORD_1
    ds_read_u16_d16_hi v130, v138 offset:32768
    ds_read_u16_d16_hi v131, v139 offset:32768
    v_cvt_pk_bf16_f32 v146, v151, v155
    v_cvt_pk_bf16_f32 v147, v159, v163
    s_and_b32 s33, s54, s34
    buffer_load_dwordx4 v[88:91], v1, s[12:15], s33 offen
    s_set_gpr_idx_on s63, 0xc
    v_pk_fma_f32 v[16:17], v[132:133], v[104:105], v[16:17] op_sel:[1,0,0] op_sel_hi:[1,1,1]
    v_pk_fma_f32 v[18:19], v[132:133], v[106:107], v[18:19] op_sel:[1,0,0] op_sel_hi:[1,1,1]
    v_pk_fma_f32 v[20:21], v[134:135], v[108:109], v[20:21] op_sel:[1,0,0] op_sel_hi:[1,1,1]
    v_pk_fma_f32 v[22:23], v[134:135], v[110:111], v[22:23] op_sel:[1,0,0] op_sel_hi:[1,1,1]
    s_set_gpr_idx_off
    v_mov_b32 v164, v165
    s_branch A_0
TO_B_0:
    buffer_load_dwordx4 v[188:191], v1, s[16:19], s10 offen offset:0 sc1
    buffer_load_dwordx4 v[192:195], v1, s[16:19], s10 offen offset:1024 sc1
    buffer_load_dwordx4 v[196:199], v1, s[16:19], s10 offen offset:2048 sc1
    buffer_load_dwordx4 v[200:203], v1, s[16:19], s10 offen offset:3072 sc1
    buffer_load_dwordx4 v[204:207], v1, s[16:19], s11 offen offset:0 sc1
    buffer_load_dwordx4 v[208:211], v1, s[16:19], s11 offen offset:1024 sc1
    buffer_load_dwordx4 v[212:215], v1, s[16:19], s11 offen offset:2048 sc1
    buffer_load_dwordx4 v[216:219], v1, s[16:19], s11 offen offset:3072 sc1
    s_branch B_0
TO_B_4:
    buffer_load_dwordx4 v[188:191], v1, s[16:19], s10 offen offset:0 sc1
    buffer_load_dwordx4 v[192:195], v1, s[16:19], s10 offen offset:1024 sc1
    buffer_load_dwordx4 v[196:199], v1, s[16:19], s10 offen offset:2048 sc1
    buffer_load_dwordx4 v[200:203], v1, s[16:19], s10 offen offset:3072 sc1
    buffer_load_dwordx4 v[204:207], v1, s[16:19], s11 offen offset:0 sc1
    buffer_load_dwordx4 v[208:211], v1, s[16:19], s11 offen offset:1024 sc1
    buffer_load_dwordx4 v[212:215], v1, s[16:19], s11 offen offset:2048 sc1
    buffer_load_dwordx4 v[216:219], v1, s[16:19], s11 offen offset:3072 sc1
    s_branch B_4
TO_B_8:
    buffer_load_dwordx4 v[188:191], v1, s[16:19], s10 offen offset:0 sc1
    buffer_load_dwordx4 v[192:195], v1, s[16:19], s10 offen offset:1024 sc1
    buffer_load_dwordx4 v[196:199], v1, s[16:19], s10 offen offset:2048 sc1
    buffer_load_dwordx4 v[200:203], v1, s[16:19], s10 offen offset:3072 sc1
    buffer_load_dwordx4 v[204:207], v1, s[16:19], s11 offen offset:0 sc1
    buffer_load_dwordx4 v[208:211], v1, s[16:19], s11 offen offset:1024 sc1
    buffer_load_dwordx4 v[212:215], v1, s[16:19], s11 offen offset:2048 sc1
    buffer_load_dwordx4 v[216:219], v1, s[16:19], s11 offen offset:3072 sc1
    s_branch B_8
TO_B_12:
    buffer_load_dwordx4 v[188:191], v1, s[16:19], s10 offen offset:0 sc1
    buffer_load_dwordx4 v[192:195], v1, s[16:19], s10 offen offset:1024 sc1
    buffer_load_dwordx4 v[196:199], v1, s[16:19], s10 offen offset:2048 sc1
    buffer_load_dwordx4 v[200:203], v1, s[16:19], s10 offen offset:3072 sc1
    buffer_load_dwordx4 v[204:207], v1, s[16:19], s11 offen offset:0 sc1
    buffer_load_dwordx4 v[208:211], v1, s[16:19], s11 offen offset:1024 sc1
    buffer_load_dwordx4 v[212:215], v1, s[16:19], s11 offen offset:2048 sc1
    buffer_load_dwordx4 v[216:219], v1, s[16:19], s11 offen offset:3072 sc1
    s_branch B_12
TO_B_16:
    buffer_load_dwordx4 v[188:191], v1, s[16:19], s10 offen offset:0 sc1
    buffer_load_dwordx4 v[192:195], v1, s[16:19], s10 offen offset:1024 sc1
    buffer_load_dwordx4 v[196:199], v1, s[16:19], s10 offen offset:2048 sc1
    buffer_load_dwordx4 v[200:203], v1, s[16:19], s10 offen offset:3072 sc1
    buffer_load_dwordx4 v[204:207], v1, s[16:19], s11 offen offset:0 sc1
    buffer_load_dwordx4 v[208:211], v1, s[16:19], s11 offen offset:1024 sc1
    buffer_load_dwordx4 v[212:215], v1, s[16:19], s11 offen offset:2048 sc1
    buffer_load_dwordx4 v[216:219], v1, s[16:19], s11 offen offset:3072 sc1
    s_branch B_16
TO_B_20:
    buffer_load_dwordx4 v[188:191], v1, s[16:19], s10 offen offset:0 sc1
    buffer_load_dwordx4 v[192:195], v1, s[16:19], s10 offen offset:1024 sc1
    buffer_load_dwordx4 v[196:199], v1, s[16:19], s10 offen offset:2048 sc1
    buffer_load_dwordx4 v[200:203], v1, s[16:19], s10 offen offset:3072 sc1
    buffer_load_dwordx4 v[204:207], v1, s[16:19], s11 offen offset:0 sc1
    buffer_load_dwordx4 v[208:211], v1, s[16:19], s11 offen offset:1024 sc1
    buffer_load_dwordx4 v[212:215], v1, s[16:19], s11 offen offset:2048 sc1
    buffer_load_dwordx4 v[216:219], v1, s[16:19], s11 offen offset:3072 sc1
    s_branch B_20
TO_B_24:
    buffer_load_dwordx4 v[188:191], v1, s[16:19], s10 offen offset:0 sc1
    buffer_load_dwordx4 v[192:195], v1, s[16:19], s10 offen offset:1024 sc1
    buffer_load_dwordx4 v[196:199], v1, s[16:19], s10 offen offset:2048 sc1
    buffer_load_dwordx4 v[200:203], v1, s[16:19], s10 offen offset:3072 sc1
    buffer_load_dwordx4 v[204:207], v1, s[16:19], s11 offen offset:0 sc1
    buffer_load_dwordx4 v[208:211], v1, s[16:19], s11 offen offset:1024 sc1
    buffer_load_dwordx4 v[212:215], v1, s[16:19], s11 offen offset:2048 sc1
    buffer_load_dwordx4 v[216:219], v1, s[16:19], s11 offen offset:3072 sc1
    s_branch B_24
TO_B_28:
    buffer_load_dwordx4 v[188:191], v1, s[16:19], s10 offen offset:0 sc1
    buffer_load_dwordx4 v[192:195], v1, s[16:19], s10 offen offset:1024 sc1
    buffer_load_dwordx4 v[196:199], v1, s[16:19], s10 offen offset:2048 sc1
    buffer_load_dwordx4 v[200:203], v1, s[16:19], s10 offen offset:3072 sc1
    buffer_load_dwordx4 v[204:207], v1, s[16:19], s11 offen offset:0 sc1
    buffer_load_dwordx4 v[208:211], v1, s[16:19], s11 offen offset:1024 sc1
    buffer_load_dwordx4 v[212:215], v1, s[16:19], s11 offen offset:2048 sc1
    buffer_load_dwordx4 v[216:219], v1, s[16:19], s11 offen offset:3072 sc1
    s_branch B_28
TO_B_32:
    buffer_load_dwordx4 v[188:191], v1, s[16:19], s10 offen offset:0 sc1
    buffer_load_dwordx4 v[192:195], v1, s[16:19], s10 offen offset:1024 sc1
    buffer_load_dwordx4 v[196:199], v1, s[16:19], s10 offen offset:2048 sc1
    buffer_load_dwordx4 v[200:203], v1, s[16:19], s10 offen offset:3072 sc1
    buffer_load_dwordx4 v[204:207], v1, s[16:19], s11 offen offset:0 sc1
    buffer_load_dwordx4 v[208:211], v1, s[16:19], s11 offen offset:1024 sc1
    buffer_load_dwordx4 v[212:215], v1, s[16:19], s11 offen offset:2048 sc1
    buffer_load_dwordx4 v[216:219], v1, s[16:19], s11 offen offset:3072 sc1
    s_branch B_32
TO_B_36:
    buffer_load_dwordx4 v[188:191], v1, s[16:19], s10 offen offset:0 sc1
    buffer_load_dwordx4 v[192:195], v1, s[16:19], s10 offen offset:1024 sc1
    buffer_load_dwordx4 v[196:199], v1, s[16:19], s10 offen offset:2048 sc1
    buffer_load_dwordx4 v[200:203], v1, s[16:19], s10 offen offset:3072 sc1
    buffer_load_dwordx4 v[204:207], v1, s[16:19], s11 offen offset:0 sc1
    buffer_load_dwordx4 v[208:211], v1, s[16:19], s11 offen offset:1024 sc1
    buffer_load_dwordx4 v[212:215], v1, s[16:19], s11 offen offset:2048 sc1
    buffer_load_dwordx4 v[216:219], v1, s[16:19], s11 offen offset:3072 sc1
    s_branch B_36
TO_B_40:
    buffer_load_dwordx4 v[188:191], v1, s[16:19], s10 offen offset:0 sc1
    buffer_load_dwordx4 v[192:195], v1, s[16:19], s10 offen offset:1024 sc1
    buffer_load_dwordx4 v[196:199], v1, s[16:19], s10 offen offset:2048 sc1
    buffer_load_dwordx4 v[200:203], v1, s[16:19], s10 offen offset:3072 sc1
    buffer_load_dwordx4 v[204:207], v1, s[16:19], s11 offen offset:0 sc1
    buffer_load_dwordx4 v[208:211], v1, s[16:19], s11 offen offset:1024 sc1
    buffer_load_dwordx4 v[212:215], v1, s[16:19], s11 offen offset:2048 sc1
    buffer_load_dwordx4 v[216:219], v1, s[16:19], s11 offen offset:3072 sc1
    s_branch B_40
TO_B_44:
    buffer_load_dwordx4 v[188:191], v1, s[16:19], s10 offen offset:0 sc1
    buffer_load_dwordx4 v[192:195], v1, s[16:19], s10 offen offset:1024 sc1
    buffer_load_dwordx4 v[196:199], v1, s[16:19], s10 offen offset:2048 sc1
    buffer_load_dwordx4 v[200:203], v1, s[16:19], s10 offen offset:3072 sc1
    buffer_load_dwordx4 v[204:207], v1, s[16:19], s11 offen offset:0 sc1
    buffer_load_dwordx4 v[208:211], v1, s[16:19], s11 offen offset:1024 sc1
    buffer_load_dwordx4 v[212:215], v1, s[16:19], s11 offen offset:2048 sc1
    buffer_load_dwordx4 v[216:219], v1, s[16:19], s11 offen offset:3072 sc1
    s_branch B_44
TO_B_48:
    buffer_load_dwordx4 v[188:191], v1, s[16:19], s10 offen offset:0 sc1
    buffer_load_dwordx4 v[192:195], v1, s[16:19], s10 offen offset:1024 sc1
    buffer_load_dwordx4 v[196:199], v1, s[16:19], s10 offen offset:2048 sc1
    buffer_load_dwordx4 v[200:203], v1, s[16:19], s10 offen offset:3072 sc1
    buffer_load_dwordx4 v[204:207], v1, s[16:19], s11 offen offset:0 sc1
    buffer_load_dwordx4 v[208:211], v1, s[16:19], s11 offen offset:1024 sc1
    buffer_load_dwordx4 v[212:215], v1, s[16:19], s11 offen offset:2048 sc1
    buffer_load_dwordx4 v[216:219], v1, s[16:19], s11 offen offset:3072 sc1
    s_branch B_48
TO_B_52:
    buffer_load_dwordx4 v[188:191], v1, s[16:19], s10 offen offset:0 sc1
    buffer_load_dwordx4 v[192:195], v1, s[16:19], s10 offen offset:1024 sc1
    buffer_load_dwordx4 v[196:199], v1, s[16:19], s10 offen offset:2048 sc1
    buffer_load_dwordx4 v[200:203], v1, s[16:19], s10 offen offset:3072 sc1
    buffer_load_dwordx4 v[204:207], v1, s[16:19], s11 offen offset:0 sc1
    buffer_load_dwordx4 v[208:211], v1, s[16:19], s11 offen offset:1024 sc1
    buffer_load_dwordx4 v[212:215], v1, s[16:19], s11 offen offset:2048 sc1
    buffer_load_dwordx4 v[216:219], v1, s[16:19], s11 offen offset:3072 sc1
    s_branch B_52
TO_B_56:
    buffer_load_dwordx4 v[188:191], v1, s[16:19], s10 offen offset:0 sc1
    buffer_load_dwordx4 v[192:195], v1, s[16:19], s10 offen offset:1024 sc1
    buffer_load_dwordx4 v[196:199], v1, s[16:19], s10 offen offset:2048 sc1
    buffer_load_dwordx4 v[200:203], v1, s[16:19], s10 offen offset:3072 sc1
    buffer_load_dwordx4 v[204:207], v1, s[16:19], s11 offen offset:0 sc1
    buffer_load_dwordx4 v[208:211], v1, s[16:19], s11 offen offset:1024 sc1
    buffer_load_dwordx4 v[212:215], v1, s[16:19], s11 offen offset:2048 sc1
    buffer_load_dwordx4 v[216:219], v1, s[16:19], s11 offen offset:3072 sc1
    s_branch B_56
TO_B_60:
    buffer_load_dwordx4 v[188:191], v1, s[16:19], s10 offen offset:0 sc1
    buffer_load_dwordx4 v[192:195], v1, s[16:19], s10 offen offset:1024 sc1
    buffer_load_dwordx4 v[196:199], v1, s[16:19], s10 offen offset:2048 sc1
    buffer_load_dwordx4 v[200:203], v1, s[16:19], s10 offen offset:3072 sc1
    buffer_load_dwordx4 v[204:207], v1, s[16:19], s11 offen offset:0 sc1
    buffer_load_dwordx4 v[208:211], v1, s[16:19], s11 offen offset:1024 sc1
    buffer_load_dwordx4 v[212:215], v1, s[16:19], s11 offen offset:2048 sc1
    buffer_load_dwordx4 v[216:219], v1, s[16:19], s11 offen offset:3072 sc1
    s_branch B_60
B_0:
    s_sub_u32 s32, s32, 4
    s_cbranch_scc1 MAIN_DONE
    v_mfma_f32_4x4x4_16b_bf16 v[124:127], v[172:173], v[178:179], 0 cbsz:4 abid:1
    v_lshlrev_b32_sdwa v136, v15, v114 dst_sel:DWORD dst_unused:UNUSED_PAD src0_sel:DWORD src1_sel:WORD_1
    s_waitcnt vmcnt(13)
    v_mfma_f32_4x4x4_16b_bf16 v[104:107], v[142:143], v[68:69], 0 cbsz:4 abid:0
    s_nop 0
    v_mfma_f32_4x4x4_16b_bf16 v[108:111], v[142:143], v[70:71], 0 cbsz:4 abid:0
    v_lshlrev_b32_sdwa v137, v15, v115 dst_sel:DWORD dst_unused:UNUSED_PAD src0_sel:DWORD src1_sel:WORD_1
    ds_read_u16_d16_hi v132, v136 offset:32768
    ds_read_u16_d16_hi v133, v137 offset:32768
    s_waitcnt lgkmcnt(2)
    s_set_gpr_idx_on s48, 0xc
    v_pk_fma_f32 v[16:17], v[128:129], v[96:97], v[16:17] op_sel:[0,0,0] op_sel_hi:[0,1,1]
    v_pk_fma_f32 v[18:19], v[128:129], v[98:99], v[18:19] op_sel:[0,0,0] op_sel_hi:[0,1,1]
    v_pk_fma_f32 v[20:21], v[130:131], v[100:101], v[20:21] op_sel:[0,0,0] op_sel_hi:[0,1,1]
    v_pk_fma_f32 v[22:23], v[130:131], v[102:103], v[22:23] op_sel:[0,0,0] op_sel_hi:[0,1,1]
    s_set_gpr_idx_off
    v_lshlrev_b32_sdwa v138, v15, v118 dst_sel:DWORD dst_unused:UNUSED_PAD src0_sel:DWORD src1_sel:WORD_1
    s_waitcnt vmcnt(12)
    v_mfma_f32_4x4x4_16b_bf16 v[96:99], v[144:145], v[72:73], 0 cbsz:4 abid:0
    s_nop 0
    v_mfma_f32_4x4x4_16b_bf16 v[100:103], v[144:145], v[74:75], 0 cbsz:4 abid:0
    v_lshlrev_b32_sdwa v139, v15, v119 dst_sel:DWORD dst_unused:UNUSED_PAD src0_sel:DWORD src1_sel:WORD_1
    ds_read_u16_d16_hi v134, v138 offset:32768
    ds_read_u16_d16_hi v135, v139 offset:32768
    s_set_gpr_idx_on s49, 0xc
    v_pk_fma_f32 v[16:17], v[128:129], v[104:105], v[16:17] op_sel:[1,0,0] op_sel_hi:[1,1,1]
    v_pk_fma_f32 v[18:19], v[128:129], v[106:107], v[18:19] op_sel:[1,0,0] op_sel_hi:[1,1,1]
    v_pk_fma_f32 v[20:21], v[130:131], v[108:109], v[20:21] op_sel:[1,0,0] op_sel_hi:[1,1,1]
    v_pk_fma_f32 v[22:23], v[130:131], v[110:111], v[22:23] op_sel:[1,0,0] op_sel_hi:[1,1,1]
    s_set_gpr_idx_off
    v_mfma_f32_4x4x4_16b_bf16 v[112:115], v[172:173], v[176:177], 0 cbsz:4 abid:2
    v_lshlrev_b32_sdwa v136, v15, v120 dst_sel:DWORD dst_unused:UNUSED_PAD src0_sel:DWORD src1_sel:WORD_1
    s_waitcnt vmcnt(11)
    v_mfma_f32_4x4x4_16b_bf16 v[104:107], v[146:147], v[76:77], 0 cbsz:4 abid:0
    s_nop 0
    v_mfma_f32_4x4x4_16b_bf16 v[108:111], v[146:147], v[78:79], 0 cbsz:4 abid:0
    v_lshlrev_b32_sdwa v137, v15, v121 dst_sel:DWORD dst_unused:UNUSED_PAD src0_sel:DWORD src1_sel:WORD_1
    ds_read_u16_d16_hi v128, v136 offset:32768
    ds_read_u16_d16_hi v129, v137 offset:32768
    s_waitcnt lgkmcnt(2)
    s_set_gpr_idx_on s50, 0xc
    v_pk_fma_f32 v[16:17], v[132:133], v[96:97], v[16:17] op_sel:[0,0,0] op_sel_hi:[0,1,1]
    v_pk_fma_f32 v[18:19], v[132:133], v[98:99], v[18:19] op_sel:[0,0,0] op_sel_hi:[0,1,1]
    v_pk_fma_f32 v[20:21], v[134:135], v[100:101], v[20:21] op_sel:[0,0,0] op_sel_hi:[0,1,1]
    v_pk_fma_f32 v[22:23], v[134:135], v[102:103], v[22:23] op_sel:[0,0,0] op_sel_hi:[0,1,1]
    s_set_gpr_idx_off
    v_lshlrev_b32_sdwa v138, v15, v124 dst_sel:DWORD dst_unused:UNUSED_PAD src0_sel:DWORD src1_sel:WORD_1
    s_waitcnt vmcnt(10)
    v_mfma_f32_4x4x4_16b_bf16 v[96:99], v[140:141], v[80:81], 0 cbsz:4 abid:1
    s_nop 0
    v_mfma_f32_4x4x4_16b_bf16 v[100:103], v[140:141], v[82:83], 0 cbsz:4 abid:1
    v_lshlrev_b32_sdwa v139, v15, v125 dst_sel:DWORD dst_unused:UNUSED_PAD src0_sel:DWORD src1_sel:WORD_1
    ds_read_u16_d16_hi v130, v138 offset:32768
    ds_read_u16_d16_hi v131, v139 offset:32768
    s_set_gpr_idx_on s51, 0xc
    v_pk_fma_f32 v[16:17], v[132:133], v[104:105], v[16:17] op_sel:[1,0,0] op_sel_hi:[1,1,1]
    v_pk_fma_f32 v[18:19], v[132:133], v[106:107], v[18:19] op_sel:[1,0,0] op_sel_hi:[1,1,1]
    v_pk_fma_f32 v[20:21], v[134:135], v[108:109], v[20:21] op_sel:[1,0,0] op_sel_hi:[1,1,1]
    v_pk_fma_f32 v[22:23], v[134:135], v[110:111], v[22:23] op_sel:[1,0,0] op_sel_hi:[1,1,1]
    s_set_gpr_idx_off
B_4:
    s_sub_u32 s32, s32, 4
    s_cbranch_scc1 MAIN_DONE
    v_mfma_f32_4x4x4_16b_bf16 v[116:119], v[172:173], v[178:179], 0 cbsz:4 abid:2
    v_lshlrev_b32_sdwa v136, v15, v122 dst_sel:DWORD dst_unused:UNUSED_PAD src0_sel:DWORD src1_sel:WORD_1
    s_waitcnt vmcnt(13)
    v_mfma_f32_4x4x4_16b_bf16 v[104:107], v[142:143], v[84:85], 0 cbsz:4 abid:1
    s_nop 0
    v_mfma_f32_4x4x4_16b_bf16 v[108:111], v[142:143], v[86:87], 0 cbsz:4 abid:1
    v_lshlrev_b32_sdwa v137, v15, v123 dst_sel:DWORD dst_unused:UNUSED_PAD src0_sel:DWORD src1_sel:WORD_1
    ds_read_u16_d16_hi v132, v136 offset:32768
    ds_read_u16_d16_hi v133, v137 offset:32768
    s_waitcnt lgkmcnt(2)
    s_set_gpr_idx_on s52, 0xc
    v_pk_fma_f32 v[16:17], v[128:129], v[96:97], v[16:17] op_sel:[0,0,0] op_sel_hi:[0,1,1]
    v_pk_fma_f32 v[18:19], v[128:129], v[98:99], v[18:19] op_sel:[0,0,0] op_sel_hi:[0,1,1]
    v_pk_fma_f32 v[20:21], v[130:131], v[100:101], v[20:21] op_sel:[0,0,0] op_sel_hi:[0,1,1]
    v_pk_fma_f32 v[22:23], v[130:131], v[102:103], v[22:23] op_sel:[0,0,0] op_sel_hi:[0,1,1]
    s_set_gpr_idx_off
    v_lshlrev_b32_sdwa v138, v15, v126 dst_sel:DWORD dst_unused:UNUSED_PAD src0_sel:DWORD src1_sel:WORD_1
    s_waitcnt vmcnt(12)
    v_mfma_f32_4x4x4_16b_bf16 v[96:99], v[144:145], v[88:89], 0 cbsz:4 abid:1
    s_nop 0
    v_mfma_f32_4x4x4_16b_bf16 v[100:103], v[144:145], v[90:91], 0 cbsz:4 abid:1
    v_lshlrev_b32_sdwa v139, v15, v127 dst_sel:DWORD dst_unused:UNUSED_PAD src0_sel:DWORD src1_sel:WORD_1
    ds_read_u16_d16_hi v134, v138 offset:32768
    ds_read_u16_d16_hi v135, v139 offset:32768
    s_set_gpr_idx_on s53, 0xc
    v_pk_fma_f32 v[16:17], v[128:129], v[104:105], v[16:17] op_sel:[1,0,0] op_sel_hi:[1,1,1]
    v_pk_fma_f32 v[18:19], v[128:129], v[106:107], v[18:19] op_sel:[1,0,0] op_sel_hi:[1,1,1]
    v_pk_fma_f32 v[20:21], v[130:131], v[108:109], v[20:21] op_sel:[1,0,0] op_sel_hi:[1,1,1]
    v_pk_fma_f32 v[22:23], v[130:131], v[110:111], v[22:23] op_sel:[1,0,0] op_sel_hi:[1,1,1]
    s_set_gpr_idx_off
    v_mfma_f32_4x4x4_16b_bf16 v[120:123], v[172:173], v[176:177], 0 cbsz:4 abid:3
    v_lshlrev_b32_sdwa v136, v15, v112 dst_sel:DWORD dst_unused:UNUSED_PAD src0_sel:DWORD src1_sel:WORD_1
    s_waitcnt vmcnt(11)
    v_mfma_f32_4x4x4_16b_bf16 v[104:107], v[146:147], v[92:93], 0 cbsz:4 abid:1
    s_nop 0
    v_mfma_f32_4x4x4_16b_bf16 v[108:111], v[146:147], v[94:95], 0 cbsz:4 abid:1
    v_lshlrev_b32_sdwa v137, v15, v113 dst_sel:DWORD dst_unused:UNUSED_PAD src0_sel:DWORD src1_sel:WORD_1
    ds_read_u16_d16_hi v128, v136 offset:32768
    ds_read_u16_d16_hi v129, v137 offset:32768
    s_waitcnt lgkmcnt(2)
    s_set_gpr_idx_on s54, 0xc
    v_pk_fma_f32 v[16:17], v[132:133], v[96:97], v[16:17] op_sel:[0,0,0] op_sel_hi:[0,1,1]
    v_pk_fma_f32 v[18:19], v[132:133], v[98:99], v[18:19] op_sel:[0,0,0] op_sel_hi:[0,1,1]
    v_pk_fma_f32 v[20:21], v[134:135], v[100:101], v[20:21] op_sel:[0,0,0] op_sel_hi:[0,1,1]
    v_pk_fma_f32 v[22:23], v[134:135], v[102:103], v[22:23] op_sel:[0,0,0] op_sel_hi:[0,1,1]
    s_set_gpr_idx_off
    v_lshlrev_b32_sdwa v138, v15, v116 dst_sel:DWORD dst_unused:UNUSED_PAD src0_sel:DWORD src1_sel:WORD_1
    s_waitcnt vmcnt(10)
    v_mfma_f32_4x4x4_16b_bf16 v[96:99], v[140:141], v[64:65], 0 cbsz:4 abid:2
    s_nop 0
    v_mfma_f32_4x4x4_16b_bf16 v[100:103], v[140:141], v[66:67], 0 cbsz:4 abid:2
    v_lshlrev_b32_sdwa v139, v15, v117 dst_sel:DWORD dst_unused:UNUSED_PAD src0_sel:DWORD src1_sel:WORD_1
    ds_read_u16_d16_hi v130, v138 offset:32768
    ds_read_u16_d16_hi v131, v139 offset:32768
    s_set_gpr_idx_on s55, 0xc
    v_pk_fma_f32 v[16:17], v[132:133], v[104:105], v[16:17] op_sel:[1,0,0] op_sel_hi:[1,1,1]
    v_pk_fma_f32 v[18:19], v[132:133], v[106:107], v[18:19] op_sel:[1,0,0] op_sel_hi:[1,1,1]
    v_pk_fma_f32 v[20:21], v[134:135], v[108:109], v[20:21] op_sel:[1,0,0] op_sel_hi:[1,1,1]
    v_pk_fma_f32 v[22:23], v[134:135], v[110:111], v[22:23] op_sel:[1,0,0] op_sel_hi:[1,1,1]
    s_set_gpr_idx_off
B_8:
    s_sub_u32 s32, s32, 4
    s_cbranch_scc1 MAIN_DONE
    v_mfma_f32_4x4x4_16b_bf16 v[124:127], v[172:173], v[178:179], 0 cbsz:4 abid:3
    v_lshlrev_b32_sdwa v136, v15, v114 dst_sel:DWORD dst_unused:UNUSED_PAD src0_sel:DWORD src1_sel:WORD_1
    s_waitcnt vmcnt(13)
    v_mfma_f32_4x4x4_16b_bf16 v[104:107], v[142:143], v[68:69], 0 cbsz:4 abid:2
    s_nop 0
    v_mfma_f32_4x4x4_16b_bf16 v[108:111], v[142:143], v[70:71], 0 cbsz:4 abid:2
    v_lshlrev_b32_sdwa v137, v15, v115 dst_sel:DWORD dst_unused:UNUSED_PAD src0_sel:DWORD src1_sel:WORD_1
    ds_read_u16_d16_hi v132, v136 offset:32768
    ds_read_u16_d16_hi v133, v137 offset:32768
    s_waitcnt lgkmcnt(2)
    s_set_gpr_idx_on s56, 0xc
    v_pk_fma_f32 v[16:17], v[128:129], v[96:97], v[16:17] op_sel:[0,0,0] op_sel_hi:[0,1,1]
    v_pk_fma_f32 v[18:19], v[128:129], v[98:99], v[18:19] op_sel:[0,0,0] op_sel_hi:[0,1,1]
    v_pk_fma_f32 v[20:21], v[130:131], v[100:101], v[20:21] op_sel:[0,0,0] op_sel_hi:[0,1,1]
    v_pk_fma_f32 v[22:23], v[130:131], v[102:103], v[22:23] op_sel:[0,0,0] op_sel_hi:[0,1,1]
    s_set_gpr_idx_off
    ds_read_b32 v165, v5
    v_lshlrev_b32_sdwa v138, v15, v118 dst_sel:DWORD dst_unused:UNUSED_PAD src0_sel:DWORD src1_sel:WORD_1
    s_waitcnt vmcnt(12)
    v_mfma_f32_4x4x4_16b_bf16 v[96:99], v[144:145], v[72:73], 0 cbsz:4 abid:2
    s_nop 0
    v_mfma_f32_4x4x4_16b_bf16 v[100:103], v[144:145], v[74:75], 0 cbsz:4 abid:2
    v_lshlrev_b32_sdwa v139, v15, v119 dst_sel:DWORD dst_unused:UNUSED_PAD src0_sel:DWORD src1_sel:WORD_1
    ds_read_u16_d16_hi v134, v138 offset:32768
    ds_read_u16_d16_hi v135, v139 offset:32768
    s_set_gpr_idx_on s57, 0xc
    v_pk_fma_f32 v[16:17], v[128:129], v[104:105], v[16:17] op_sel:[1,0,0] op_sel_hi:[1,1,1]
    v_pk_fma_f32 v[18:19], v[128:129], v[106:107], v[18:19] op_sel:[1,0,0] op_sel_hi:[1,1,1]
    v_pk_fma_f32 v[20:21], v[130:131], v[108:109], v[20:21] op_sel:[1,0,0] op_sel_hi:[1,1,1]
    v_pk_fma_f32 v[22:23], v[130:131], v[110:111], v[22:23] op_sel:[1,0,0] op_sel_hi:[1,1,1]
    s_set_gpr_idx_off
    v_mfma_f32_4x4x4_16b_bf16 v[112:115], v[172:173], v[176:177], 0 cbsz:4 abid:4
    v_lshlrev_b32_sdwa v136, v15, v120 dst_sel:DWORD dst_unused:UNUSED_PAD src0_sel:DWORD src1_sel:WORD_1
    s_waitcnt vmcnt(11)
    v_mfma_f32_4x4x4_16b_bf16 v[104:107], v[146:147], v[76:77], 0 cbsz:4 abid:2
    s_nop 0
    v_mfma_f32_4x4x4_16b_bf16 v[108:111], v[146:147], v[78:79], 0 cbsz:4 abid:2
    v_lshlrev_b32_sdwa v137, v15, v121 dst_sel:DWORD dst_unused:UNUSED_PAD src0_sel:DWORD src1_sel:WORD_1
    ds_read_u16_d16_hi v128, v136 offset:32768
    ds_read_u16_d16_hi v129, v137 offset:32768
    s_waitcnt lgkmcnt(2)
    s_set_gpr_idx_on s58, 0xc
    v_pk_fma_f32 v[16:17], v[132:133], v[96:97], v[16:17] op_sel:[0,0,0] op_sel_hi:[0,1,1]
    v_pk_fma_f32 v[18:19], v[132:133], v[98:99], v[18:19] op_sel:[0,0,0] op_sel_hi:[0,1,1]
    v_pk_fma_f32 v[20:21], v[134:135], v[100:101], v[20:21] op_sel:[0,0,0] op_sel_hi:[0,1,1]
    v_pk_fma_f32 v[22:23], v[134:135], v[102:103], v[22:23] op_sel:[0,0,0] op_sel_hi:[0,1,1]
    s_set_gpr_idx_off
    v_lshlrev_b32_sdwa v138, v15, v124 dst_sel:DWORD dst_unused:UNUSED_PAD src0_sel:DWORD src1_sel:WORD_1
    s_waitcnt vmcnt(10)
    v_mfma_f32_4x4x4_16b_bf16 v[96:99], v[140:141], v[80:81], 0 cbsz:4 abid:3
    s_nop 0
    v_mfma_f32_4x4x4_16b_bf16 v[100:103], v[140:141], v[82:83], 0 cbsz:4 abid:3
    v_lshlrev_b32_sdwa v139, v15, v125 dst_sel:DWORD dst_unused:UNUSED_PAD src0_sel:DWORD src1_sel:WORD_1
    ds_read_u16_d16_hi v130, v138 offset:32768
    ds_read_u16_d16_hi v131, v139 offset:32768
    s_set_gpr_idx_on s59, 0xc
    v_pk_fma_f32 v[16:17], v[132:133], v[104:105], v[16:17] op_sel:[1,0,0] op_sel_hi:[1,1,1]
    v_pk_fma_f32 v[18:19], v[132:133], v[106:107], v[18:19] op_sel:[1,0,0] op_sel_hi:[1,1,1]
    v_pk_fma_f32 v[20:21], v[134:135], v[108:109], v[20:21] op_sel:[1,0,0] op_sel_hi:[1,1,1]
    v_pk_fma_f32 v[22:23], v[134:135], v[110:111], v[22:23] op_sel:[1,0,0] op_sel_hi:[1,1,1]
    s_set_gpr_idx_off
B_12:
    s_sub_u32 s32, s32, 4
    s_cbranch_scc1 MAIN_DONE
    v_mfma_f32_4x4x4_16b_bf16 v[116:119], v[172:173], v[178:179], 0 cbsz:4 abid:4
    v_lshlrev_b32_sdwa v136, v15, v122 dst_sel:DWORD dst_unused:UNUSED_PAD src0_sel:DWORD src1_sel:WORD_1
    s_waitcnt vmcnt(13)
    v_mfma_f32_4x4x4_16b_bf16 v[104:107], v[142:143], v[84:85], 0 cbsz:4 abid:3
    s_nop 0
    v_mfma_f32_4x4x4_16b_bf16 v[108:111], v[142:143], v[86:87], 0 cbsz:4 abid:3
    v_lshlrev_b32_sdwa v137, v15, v123 dst_sel:DWORD dst_unused:UNUSED_PAD src0_sel:DWORD src1_sel:WORD_1
    ds_read_u16_d16_hi v132, v136 offset:32768
    ds_read_u16_d16_hi v133, v137 offset:32768
    s_waitcnt lgkmcnt(2)
    s_set_gpr_idx_on s60, 0xc
    v_pk_fma_f32 v[16:17], v[128:129], v[96:97], v[16:17] op_sel:[0,0,0] op_sel_hi:[0,1,1]
    v_pk_fma_f32 v[18:19], v[128:129], v[98:99], v[18:19] op_sel:[0,0,0] op_sel_hi:[0,1,1]
    v_pk_fma_f32 v[20:21], v[130:131], v[100:101], v[20:21] op_sel:[0,0,0] op_sel_hi:[0,1,1]
    v_pk_fma_f32 v[22:23], v[130:131], v[102:103], v[22:23] op_sel:[0,0,0] op_sel_hi:[0,1,1]
    s_set_gpr_idx_off
    v_cmp_gt_u32 vcc, s30, v6
    v_add_u32 v6, 64, v6
    v_add_u32 v5, 256, v5
    v_cndmask_b32 v165, 40, v165, vcc
    v_lshrrev_b32 v8, 21, v165
    v_lshlrev_b32 v8, 4, v8
    v_lshlrev_b32 v9, 3, v165
    ds_read_b128 v[168:171], v8 offset:8192
    v_and_b32 v9, 0xfffc00, v9
    v_and_or_b32 v165, v165, 56, v9
    v_lshlrev_b32_sdwa v138, v15, v126 dst_sel:DWORD dst_unused:UNUSED_PAD src0_sel:DWORD src1_sel:WORD_1
    s_waitcnt vmcnt(12)
    v_mfma_f32_4x4x4_16b_bf16 v[96:99], v[144:145], v[88:89], 0 cbsz:4 abid:3
    s_nop 0
    v_mfma_f32_4x4x4_16b_bf16 v[100:103], v[144:145], v[90:91], 0 cbsz:4 abid:3
    v_lshlrev_b32_sdwa v139, v15, v127 dst_sel:DWORD dst_unused:UNUSED_PAD src0_sel:DWORD src1_sel:WORD_1
    ds_read_u16_d16_hi v134, v138 offset:32768
    ds_read_u16_d16_hi v135, v139 offset:32768
    s_set_gpr_idx_on s61, 0xc
    v_pk_fma_f32 v[16:17], v[128:129], v[104:105], v[16:17] op_sel:[1,0,0] op_sel_hi:[1,1,1]
    v_pk_fma_f32 v[18:19], v[128:129], v[106:107], v[18:19] op_sel:[1,0,0] op_sel_hi:[1,1,1]
    v_pk_fma_f32 v[20:21], v[130:131], v[108:109], v[20:21] op_sel:[1,0,0] op_sel_hi:[1,1,1]
    v_pk_fma_f32 v[22:23], v[130:131], v[110:111], v[22:23] op_sel:[1,0,0] op_sel_hi:[1,1,1]
    s_set_gpr_idx_off
    v_mfma_f32_4x4x4_16b_bf16 v[120:123], v[172:173], v[176:177], 0 cbsz:4 abid:5
    v_lshlrev_b32_sdwa v136, v15, v112 dst_sel:DWORD dst_unused:UNUSED_PAD src0_sel:DWORD src1_sel:WORD_1
    s_waitcnt vmcnt(11)
    v_mfma_f32_4x4x4_16b_bf16 v[104:107], v[146:147], v[92:93], 0 cbsz:4 abid:3
    s_nop 0
    v_mfma_f32_4x4x4_16b_bf16 v[108:111], v[146:147], v[94:95], 0 cbsz:4 abid:3
    v_lshlrev_b32_sdwa v137, v15, v113 dst_sel:DWORD dst_unused:UNUSED_PAD src0_sel:DWORD src1_sel:WORD_1
    ds_read_u16_d16_hi v128, v136 offset:32768
    ds_read_u16_d16_hi v129, v137 offset:32768
    s_waitcnt lgkmcnt(2)
    s_set_gpr_idx_on s62, 0xc
    v_pk_fma_f32 v[16:17], v[132:133], v[96:97], v[16:17] op_sel:[0,0,0] op_sel_hi:[0,1,1]
    v_pk_fma_f32 v[18:19], v[132:133], v[98:99], v[18:19] op_sel:[0,0,0] op_sel_hi:[0,1,1]
    v_pk_fma_f32 v[20:21], v[134:135], v[100:101], v[20:21] op_sel:[0,0,0] op_sel_hi:[0,1,1]
    v_pk_fma_f32 v[22:23], v[134:135], v[102:103], v[22:23] op_sel:[0,0,0] op_sel_hi:[0,1,1]
    s_set_gpr_idx_off
    v_lshlrev_b32_sdwa v138, v15, v116 dst_sel:DWORD dst_unused:UNUSED_PAD src0_sel:DWORD src1_sel:WORD_1
    s_waitcnt vmcnt(10)
    v_mfma_f32_4x4x4_16b_bf16 v[96:99], v[140:141], v[64:65], 0 cbsz:4 abid:4
    s_nop 0
    v_mfma_f32_4x4x4_16b_bf16 v[100:103], v[140:141], v[66:67], 0 cbsz:4 abid:4
    v_lshlrev_b32_sdwa v139, v15, v117 dst_sel:DWORD dst_unused:UNUSED_PAD src0_sel:DWORD src1_sel:WORD_1
    ds_read_u16_d16_hi v130, v138 offset:32768
    ds_read_u16_d16_hi v131, v139 offset:32768
    s_set_gpr_idx_on s63, 0xc
    v_pk_fma_f32 v[16:17], v[132:133], v[104:105], v[16:17] op_sel:[1,0,0] op_sel_hi:[1,1,1]
    v_pk_fma_f32 v[18:19], v[132:133], v[106:107], v[18:19] op_sel:[1,0,0] op_sel_hi:[1,1,1]
    v_pk_fma_f32 v[20:21], v[134:135], v[108:109], v[20:21] op_sel:[1,0,0] op_sel_hi:[1,1,1]
    v_pk_fma_f32 v[22:23], v[134:135], v[110:111], v[22:23] op_sel:[1,0,0] op_sel_hi:[1,1,1]
    s_set_gpr_idx_off
B_16:
    s_sub_u32 s32, s32, 4
    s_cbranch_scc1 MAIN_DONE
    v_mfma_f32_4x4x4_16b_bf16 v[124:127], v[172:173], v[178:179], 0 cbsz:4 abid:5
    v_lshlrev_b32_sdwa v136, v15, v114 dst_sel:DWORD dst_unused:UNUSED_PAD src0_sel:DWORD src1_sel:WORD_1
    s_waitcnt vmcnt(13)
    v_mfma_f32_4x4x4_16b_bf16 v[104:107], v[142:143], v[68:69], 0 cbsz:4 abid:4
    s_nop 0
    v_mfma_f32_4x4x4_16b_bf16 v[108:111], v[142:143], v[70:71], 0 cbsz:4 abid:4
    v_lshlrev_b32_sdwa v137, v15, v115 dst_sel:DWORD dst_unused:UNUSED_PAD src0_sel:DWORD src1_sel:WORD_1
    ds_read_u16_d16_hi v132, v136 offset:32768
    ds_read_u16_d16_hi v133, v137 offset:32768
    s_waitcnt lgkmcnt(2)
    s_set_gpr_idx_on s48, 0xc
    v_pk_fma_f32 v[16:17], v[128:129], v[96:97], v[16:17] op_sel:[0,0,0] op_sel_hi:[0,1,1]
    v_pk_fma_f32 v[18:19], v[128:129], v[98:99], v[18:19] op_sel:[0,0,0] op_sel_hi:[0,1,1]
    v_pk_fma_f32 v[20:21], v[130:131], v[100:101], v[20:21] op_sel:[0,0,0] op_sel_hi:[0,1,1]
    v_pk_fma_f32 v[22:23], v[130:131], v[102:103], v[22:23] op_sel:[0,0,0] op_sel_hi:[0,1,1]
    s_set_gpr_idx_off
    v_lshlrev_b32_sdwa v138, v15, v118 dst_sel:DWORD dst_unused:UNUSED_PAD src0_sel:DWORD src1_sel:WORD_1
    s_waitcnt vmcnt(12)
    v_mfma_f32_4x4x4_16b_bf16 v[96:99], v[144:145], v[72:73], 0 cbsz:4 abid:4
    s_nop 0
    v_mfma_f32_4x4x4_16b_bf16 v[100:103], v[144:145], v[74:75], 0 cbsz:4 abid:4
    v_lshlrev_b32_sdwa v139, v15, v119 dst_sel:DWORD dst_unused:UNUSED_PAD src0_sel:DWORD src1_sel:WORD_1
    ds_read_u16_d16_hi v134, v138 offset:32768
    ds_read_u16_d16_hi v135, v139 offset:32768
    s_set_gpr_idx_on s49, 0xc
    v_pk_fma_f32 v[16:17], v[128:129], v[104:105], v[16:17] op_sel:[1,0,0] op_sel_hi:[1,1,1]
    v_pk_fma_f32 v[18:19], v[128:129], v[106:107], v[18:19] op_sel:[1,0,0] op_sel_hi:[1,1,1]
    v_pk_fma_f32 v[20:21], v[130:131], v[108:109], v[20:21] op_sel:[1,0,0] op_sel_hi:[1,1,1]
    v_pk_fma_f32 v[22:23], v[130:131], v[110:111], v[22:23] op_sel:[1,0,0] op_sel_hi:[1,1,1]
    s_set_gpr_idx_off
    v_mfma_f32_4x4x4_16b_bf16 v[112:115], v[172:173], v[176:177], 0 cbsz:4 abid:6
    v_lshlrev_b32_sdwa v136, v15, v120 dst_sel:DWORD dst_unused:UNUSED_PAD src0_sel:DWORD src1_sel:WORD_1
    s_waitcnt vmcnt(11)
    v_mfma_f32_4x4x4_16b_bf16 v[104:107], v[146:147], v[76:77], 0 cbsz:4 abid:4
    s_nop 0
    v_mfma_f32_4x4x4_16b_bf16 v[108:111], v[146:147], v[78:79], 0 cbsz:4 abid:4
    v_lshlrev_b32_sdwa v137, v15, v121 dst_sel:DWORD dst_unused:UNUSED_PAD src0_sel:DWORD src1_sel:WORD_1
    ds_read_u16_d16_hi v128, v136 offset:32768
    ds_read_u16_d16_hi v129, v137 offset:32768
    s_waitcnt lgkmcnt(2)
    s_set_gpr_idx_on s50, 0xc
    v_pk_fma_f32 v[16:17], v[132:133], v[96:97], v[16:17] op_sel:[0,0,0] op_sel_hi:[0,1,1]
    v_pk_fma_f32 v[18:19], v[132:133], v[98:99], v[18:19] op_sel:[0,0,0] op_sel_hi:[0,1,1]
    v_pk_fma_f32 v[20:21], v[134:135], v[100:101], v[20:21] op_sel:[0,0,0] op_sel_hi:[0,1,1]
    v_pk_fma_f32 v[22:23], v[134:135], v[102:103], v[22:23] op_sel:[0,0,0] op_sel_hi:[0,1,1]
    s_set_gpr_idx_off
    v_lshlrev_b32_sdwa v138, v15, v124 dst_sel:DWORD dst_unused:UNUSED_PAD src0_sel:DWORD src1_sel:WORD_1
    s_waitcnt vmcnt(10)
    v_mfma_f32_4x4x4_16b_bf16 v[96:99], v[140:141], v[80:81], 0 cbsz:4 abid:5
    s_nop 0
    v_mfma_f32_4x4x4_16b_bf16 v[100:103], v[140:141], v[82:83], 0 cbsz:4 abid:5
    v_lshlrev_b32_sdwa v139, v15, v125 dst_sel:DWORD dst_unused:UNUSED_PAD src0_sel:DWORD src1_sel:WORD_1
    ds_read_u16_d16_hi v130, v138 offset:32768
    ds_read_u16_d16_hi v131, v139 offset:32768
    s_set_gpr_idx_on s51, 0xc
    v_pk_fma_f32 v[16:17], v[132:133], v[104:105], v[16:17] op_sel:[1,0,0] op_sel_hi:[1,1,1]
    v_pk_fma_f32 v[18:19], v[132:133], v[106:107], v[18:19] op_sel:[1,0,0] op_sel_hi:[1,1,1]
    v_pk_fma_f32 v[20:21], v[134:135], v[108:109], v[20:21] op_sel:[1,0,0] op_sel_hi:[1,1,1]
    v_pk_fma_f32 v[22:23], v[134:135], v[110:111], v[22:23] op_sel:[1,0,0] op_sel_hi:[1,1,1]
    s_set_gpr_idx_off
B_20:
    s_sub_u32 s32, s32, 4
    s_cbranch_scc1 MAIN_DONE
    v_mfma_f32_4x4x4_16b_bf16 v[116:119], v[172:173], v[178:179], 0 cbsz:4 abid:6
    v_lshlrev_b32_sdwa v136, v15, v122 dst_sel:DWORD dst_unused:UNUSED_PAD src0_sel:DWORD src1_sel:WORD_1
    s_waitcnt vmcnt(13)
    v_mfma_f32_4x4x4_16b_bf16 v[104:107], v[142:143], v[84:85], 0 cbsz:4 abid:5
    s_nop 0
    v_mfma_f32_4x4x4_16b_bf16 v[108:111], v[142:143], v[86:87], 0 cbsz:4 abid:5
    v_lshlrev_b32_sdwa v137, v15, v123 dst_sel:DWORD dst_unused:UNUSED_PAD src0_sel:DWORD src1_sel:WORD_1
    ds_read_u16_d16_hi v132, v136 offset:32768
    ds_read_u16_d16_hi v133, v137 offset:32768
    s_waitcnt lgkmcnt(2)
    s_set_gpr_idx_on s52, 0xc
    v_pk_fma_f32 v[16:17], v[128:129], v[96:97], v[16:17] op_sel:[0,0,0] op_sel_hi:[0,1,1]
    v_pk_fma_f32 v[18:19], v[128:129], v[98:99], v[18:19] op_sel:[0,0,0] op_sel_hi:[0,1,1]
    v_pk_fma_f32 v[20:21], v[130:131], v[100:101], v[20:21] op_sel:[0,0,0] op_sel_hi:[0,1,1]
    v_pk_fma_f32 v[22:23], v[130:131], v[102:103], v[22:23] op_sel:[0,0,0] op_sel_hi:[0,1,1]
    s_set_gpr_idx_off
    v_lshlrev_b32_sdwa v138, v15, v126 dst_sel:DWORD dst_unused:UNUSED_PAD src0_sel:DWORD src1_sel:WORD_1
    s_waitcnt vmcnt(12)
    v_mfma_f32_4x4x4_16b_bf16 v[96:99], v[144:145], v[88:89], 0 cbsz:4 abid:5
    s_nop 0
    v_mfma_f32_4x4x4_16b_bf16 v[100:103], v[144:145], v[90:91], 0 cbsz:4 abid:5
    v_lshlrev_b32_sdwa v139, v15, v127 dst_sel:DWORD dst_unused:UNUSED_PAD src0_sel:DWORD src1_sel:WORD_1
    ds_read_u16_d16_hi v134, v138 offset:32768
    ds_read_u16_d16_hi v135, v139 offset:32768
    s_set_gpr_idx_on s53, 0xc
    v_pk_fma_f32 v[16:17], v[128:129], v[104:105], v[16:17] op_sel:[1,0,0] op_sel_hi:[1,1,1]
    v_pk_fma_f32 v[18:19], v[128:129], v[106:107], v[18:19] op_sel:[1,0,0] op_sel_hi:[1,1,1]
    v_pk_fma_f32 v[20:21], v[130:131], v[108:109], v[20:21] op_sel:[1,0,0] op_sel_hi:[1,1,1]
    v_pk_fma_f32 v[22:23], v[130:131], v[110:111], v[22:23] op_sel:[1,0,0] op_sel_hi:[1,1,1]
    s_set_gpr_idx_off
    v_mfma_f32_4x4x4_16b_bf16 v[120:123], v[172:173], v[176:177], 0 cbsz:4 abid:7
    v_lshlrev_b32_sdwa v136, v15, v112 dst_sel:DWORD dst_unused:UNUSED_PAD src0_sel:DWORD src1_sel:WORD_1
    s_waitcnt vmcnt(11)
    v_mfma_f32_4x4x4_16b_bf16 v[104:107], v[146:147], v[92:93], 0 cbsz:4 abid:5
    s_nop 0
    v_mfma_f32_4x4x4_16b_bf16 v[108:111], v[146:147], v[94:95], 0 cbsz:4 abid:5
    v_lshlrev_b32_sdwa v137, v15, v113 dst_sel:DWORD dst_unused:UNUSED_PAD src0_sel:DWORD src1_sel:WORD_1
    ds_read_u16_d16_hi v128, v136 offset:32768
    ds_read_u16_d16_hi v129, v137 offset:32768
    s_waitcnt lgkmcnt(2)
    s_set_gpr_idx_on s54, 0xc
    v_pk_fma_f32 v[16:17], v[132:133], v[96:97], v[16:17] op_sel:[0,0,0] op_sel_hi:[0,1,1]
    v_pk_fma_f32 v[18:19], v[132:133], v[98:99], v[18:19] op_sel:[0,0,0] op_sel_hi:[0,1,1]
    v_pk_fma_f32 v[20:21], v[134:135], v[100:101], v[20:21] op_sel:[0,0,0] op_sel_hi:[0,1,1]
    v_pk_fma_f32 v[22:23], v[134:135], v[102:103], v[22:23] op_sel:[0,0,0] op_sel_hi:[0,1,1]
    s_set_gpr_idx_off
    v_lshlrev_b32_sdwa v138, v15, v116 dst_sel:DWORD dst_unused:UNUSED_PAD src0_sel:DWORD src1_sel:WORD_1
    s_waitcnt vmcnt(10)
    v_mfma_f32_4x4x4_16b_bf16 v[96:99], v[140:141], v[64:65], 0 cbsz:4 abid:6
    s_nop 0
    v_mfma_f32_4x4x4_16b_bf16 v[100:103], v[140:141], v[66:67], 0 cbsz:4 abid:6
    v_lshlrev_b32_sdwa v139, v15, v117 dst_sel:DWORD dst_unused:UNUSED_PAD src0_sel:DWORD src1_sel:WORD_1
    ds_read_u16_d16_hi v130, v138 offset:32768
    ds_read_u16_d16_hi v131, v139 offset:32768
    s_set_gpr_idx_on s55, 0xc
    v_pk_fma_f32 v[16:17], v[132:133], v[104:105], v[16:17] op_sel:[1,0,0] op_sel_hi:[1,1,1]
    v_pk_fma_f32 v[18:19], v[132:133], v[106:107], v[18:19] op_sel:[1,0,0] op_sel_hi:[1,1,1]
    v_pk_fma_f32 v[20:21], v[134:135], v[108:109], v[20:21] op_sel:[1,0,0] op_sel_hi:[1,1,1]
    v_pk_fma_f32 v[22:23], v[134:135], v[110:111], v[22:23] op_sel:[1,0,0] op_sel_hi:[1,1,1]
    s_set_gpr_idx_off
B_24:
    s_sub_u32 s32, s32, 4
    s_cbranch_scc1 MAIN_DONE
    v_mfma_f32_4x4x4_16b_bf16 v[124:127], v[172:173], v[178:179], 0 cbsz:4 abid:7
    v_lshlrev_b32_sdwa v136, v15, v114 dst_sel:DWORD dst_unused:UNUSED_PAD src0_sel:DWORD src1_sel:WORD_1
    s_waitcnt vmcnt(13)
    v_mfma_f32_4x4x4_16b_bf16 v[104:107], v[142:143], v[68:69], 0 cbsz:4 abid:6
    s_nop 0
    v_mfma_f32_4x4x4_16b_bf16 v[108:111], v[142:143], v[70:71], 0 cbsz:4 abid:6
    v_lshlrev_b32_sdwa v137, v15, v115 dst_sel:DWORD dst_unused:UNUSED_PAD src0_sel:DWORD src1_sel:WORD_1
    ds_read_u16_d16_hi v132, v136 offset:32768
    ds_read_u16_d16_hi v133, v137 offset:32768
    s_waitcnt lgkmcnt(2)
    s_set_gpr_idx_on s56, 0xc
    v_pk_fma_f32 v[16:17], v[128:129], v[96:97], v[16:17] op_sel:[0,0,0] op_sel_hi:[0,1,1]
    v_pk_fma_f32 v[18:19], v[128:129], v[98:99], v[18:19] op_sel:[0,0,0] op_sel_hi:[0,1,1]
    v_pk_fma_f32 v[20:21], v[130:131], v[100:101], v[20:21] op_sel:[0,0,0] op_sel_hi:[0,1,1]
    v_pk_fma_f32 v[22:23], v[130:131], v[102:103], v[22:23] op_sel:[0,0,0] op_sel_hi:[0,1,1]
    s_set_gpr_idx_off
    v_lshlrev_b32_sdwa v138, v15, v118 dst_sel:DWORD dst_unused:UNUSED_PAD src0_sel:DWORD src1_sel:WORD_1
    s_waitcnt vmcnt(12)
    v_mfma_f32_4x4x4_16b_bf16 v[96:99], v[144:145], v[72:73], 0 cbsz:4 abid:6
    s_nop 0
    v_mfma_f32_4x4x4_16b_bf16 v[100:103], v[144:145], v[74:75], 0 cbsz:4 abid:6
    v_lshlrev_b32_sdwa v139, v15, v119 dst_sel:DWORD dst_unused:UNUSED_PAD src0_sel:DWORD src1_sel:WORD_1
    ds_read_u16_d16_hi v134, v138 offset:32768
    ds_read_u16_d16_hi v135, v139 offset:32768
    s_set_gpr_idx_on s57, 0xc
    v_pk_fma_f32 v[16:17], v[128:129], v[104:105], v[16:17] op_sel:[1,0,0] op_sel_hi:[1,1,1]
    v_pk_fma_f32 v[18:19], v[128:129], v[106:107], v[18:19] op_sel:[1,0,0] op_sel_hi:[1,1,1]
    v_pk_fma_f32 v[20:21], v[130:131], v[108:109], v[20:21] op_sel:[1,0,0] op_sel_hi:[1,1,1]
    v_pk_fma_f32 v[22:23], v[130:131], v[110:111], v[22:23] op_sel:[1,0,0] op_sel_hi:[1,1,1]
    s_set_gpr_idx_off
    v_mfma_f32_4x4x4_16b_bf16 v[112:115], v[172:173], v[176:177], 0 cbsz:4 abid:8
    v_lshlrev_b32_sdwa v136, v15, v120 dst_sel:DWORD dst_unused:UNUSED_PAD src0_sel:DWORD src1_sel:WORD_1
    s_waitcnt vmcnt(11)
    v_mfma_f32_4x4x4_16b_bf16 v[104:107], v[146:147], v[76:77], 0 cbsz:4 abid:6
    s_nop 0
    v_mfma_f32_4x4x4_16b_bf16 v[108:111], v[146:147], v[78:79], 0 cbsz:4 abid:6
    v_lshlrev_b32_sdwa v137, v15, v121 dst_sel:DWORD dst_unused:UNUSED_PAD src0_sel:DWORD src1_sel:WORD_1
    ds_read_u16_d16_hi v128, v136 offset:32768
    ds_read_u16_d16_hi v129, v137 offset:32768
    s_waitcnt lgkmcnt(2)
    s_set_gpr_idx_on s58, 0xc
    v_pk_fma_f32 v[16:17], v[132:133], v[96:97], v[16:17] op_sel:[0,0,0] op_sel_hi:[0,1,1]
    v_pk_fma_f32 v[18:19], v[132:133], v[98:99], v[18:19] op_sel:[0,0,0] op_sel_hi:[0,1,1]
    v_pk_fma_f32 v[20:21], v[134:135], v[100:101], v[20:21] op_sel:[0,0,0] op_sel_hi:[0,1,1]
    v_pk_fma_f32 v[22:23], v[134:135], v[102:103], v[22:23] op_sel:[0,0,0] op_sel_hi:[0,1,1]
    s_set_gpr_idx_off
    v_lshlrev_b32_sdwa v138, v15, v124 dst_sel:DWORD dst_unused:UNUSED_PAD src0_sel:DWORD src1_sel:WORD_1
    s_waitcnt vmcnt(10)
    v_mfma_f32_4x4x4_16b_bf16 v[96:99], v[140:141], v[80:81], 0 cbsz:4 abid:7
    s_nop 0
    v_mfma_f32_4x4x4_16b_bf16 v[100:103], v[140:141], v[82:83], 0 cbsz:4 abid:7
    v_lshlrev_b32_sdwa v139, v15, v125 dst_sel:DWORD dst_unused:UNUSED_PAD src0_sel:DWORD src1_sel:WORD_1
    ds_read_u16_d16_hi v130, v138 offset:32768
    ds_read_u16_d16_hi v131, v139 offset:32768
    s_set_gpr_idx_on s59, 0xc
    v_pk_fma_f32 v[16:17], v[132:133], v[104:105], v[16:17] op_sel:[1,0,0] op_sel_hi:[1,1,1]
    v_pk_fma_f32 v[18:19], v[132:133], v[106:107], v[18:19] op_sel:[1,0,0] op_sel_hi:[1,1,1]
    v_pk_fma_f32 v[20:21], v[134:135], v[108:109], v[20:21] op_sel:[1,0,0] op_sel_hi:[1,1,1]
    v_pk_fma_f32 v[22:23], v[134:135], v[110:111], v[22:23] op_sel:[1,0,0] op_sel_hi:[1,1,1]
    s_set_gpr_idx_off
B_28:
    s_sub_u32 s32, s32, 4
    s_cbranch_scc1 MAIN_DONE
    v_mfma_f32_4x4x4_16b_bf16 v[116:119], v[172:173], v[178:179], 0 cbsz:4 abid:8
    v_lshlrev_b32_sdwa v136, v15, v122 dst_sel:DWORD dst_unused:UNUSED_PAD src0_sel:DWORD src1_sel:WORD_1
    s_waitcnt vmcnt(13)
    v_mfma_f32_4x4x4_16b_bf16 v[104:107], v[142:143], v[84:85], 0 cbsz:4 abid:7
    s_nop 0
    v_mfma_f32_4x4x4_16b_bf16 v[108:111], v[142:143], v[86:87], 0 cbsz:4 abid:7
    v_lshlrev_b32_sdwa v137, v15, v123 dst_sel:DWORD dst_unused:UNUSED_PAD src0_sel:DWORD src1_sel:WORD_1
    ds_read_u16_d16_hi v132, v136 offset:32768
    ds_read_u16_d16_hi v133, v137 offset:32768
    s_waitcnt lgkmcnt(2)
    s_set_gpr_idx_on s60, 0xc
    v_pk_fma_f32 v[16:17], v[128:129], v[96:97], v[16:17] op_sel:[0,0,0] op_sel_hi:[0,1,1]
    v_pk_fma_f32 v[18:19], v[128:129], v[98:99], v[18:19] op_sel:[0,0,0] op_sel_hi:[0,1,1]
    v_pk_fma_f32 v[20:21], v[130:131], v[100:101], v[20:21] op_sel:[0,0,0] op_sel_hi:[0,1,1]
    v_pk_fma_f32 v[22:23], v[130:131], v[102:103], v[22:23] op_sel:[0,0,0] op_sel_hi:[0,1,1]
    s_set_gpr_idx_off
    v_lshlrev_b32_sdwa v138, v15, v126 dst_sel:DWORD dst_unused:UNUSED_PAD src0_sel:DWORD src1_sel:WORD_1
    s_waitcnt vmcnt(12)
    v_mfma_f32_4x4x4_16b_bf16 v[96:99], v[144:145], v[88:89], 0 cbsz:4 abid:7
    s_nop 0
    v_mfma_f32_4x4x4_16b_bf16 v[100:103], v[144:145], v[90:91], 0 cbsz:4 abid:7
    v_lshlrev_b32_sdwa v139, v15, v127 dst_sel:DWORD dst_unused:UNUSED_PAD src0_sel:DWORD src1_sel:WORD_1
    ds_read_u16_d16_hi v134, v138 offset:32768
    ds_read_u16_d16_hi v135, v139 offset:32768
    s_set_gpr_idx_on s61, 0xc
    v_pk_fma_f32 v[16:17], v[128:129], v[104:105], v[16:17] op_sel:[1,0,0] op_sel_hi:[1,1,1]
    v_pk_fma_f32 v[18:19], v[128:129], v[106:107], v[18:19] op_sel:[1,0,0] op_sel_hi:[1,1,1]
    v_pk_fma_f32 v[20:21], v[130:131], v[108:109], v[20:21] op_sel:[1,0,0] op_sel_hi:[1,1,1]
    v_pk_fma_f32 v[22:23], v[130:131], v[110:111], v[22:23] op_sel:[1,0,0] op_sel_hi:[1,1,1]
    s_set_gpr_idx_off
    v_mfma_f32_4x4x4_16b_bf16 v[120:123], v[172:173], v[176:177], 0 cbsz:4 abid:9
    v_lshlrev_b32_sdwa v136, v15, v112 dst_sel:DWORD dst_unused:UNUSED_PAD src0_sel:DWORD src1_sel:WORD_1
    s_waitcnt vmcnt(11)
    v_mfma_f32_4x4x4_16b_bf16 v[104:107], v[146:147], v[92:93], 0 cbsz:4 abid:7
    s_nop 0
    v_mfma_f32_4x4x4_16b_bf16 v[108:111], v[146:147], v[94:95], 0 cbsz:4 abid:7
    v_lshlrev_b32_sdwa v137, v15, v113 dst_sel:DWORD dst_unused:UNUSED_PAD src0_sel:DWORD src1_sel:WORD_1
    ds_read_u16_d16_hi v128, v136 offset:32768
    ds_read_u16_d16_hi v129, v137 offset:32768
    s_waitcnt lgkmcnt(2)
    s_set_gpr_idx_on s62, 0xc
    v_pk_fma_f32 v[16:17], v[132:133], v[96:97], v[16:17] op_sel:[0,0,0] op_sel_hi:[0,1,1]
    v_pk_fma_f32 v[18:19], v[132:133], v[98:99], v[18:19] op_sel:[0,0,0] op_sel_hi:[0,1,1]
    v_pk_fma_f32 v[20:21], v[134:135], v[100:101], v[20:21] op_sel:[0,0,0] op_sel_hi:[0,1,1]
    v_pk_fma_f32 v[22:23], v[134:135], v[102:103], v[22:23] op_sel:[0,0,0] op_sel_hi:[0,1,1]
    s_set_gpr_idx_off
    v_lshlrev_b32_sdwa v138, v15, v116 dst_sel:DWORD dst_unused:UNUSED_PAD src0_sel:DWORD src1_sel:WORD_1
    s_waitcnt vmcnt(10)
    v_mfma_f32_4x4x4_16b_bf16 v[96:99], v[140:141], v[64:65], 0 cbsz:4 abid:8
    s_nop 0
    v_mfma_f32_4x4x4_16b_bf16 v[100:103], v[140:141], v[66:67], 0 cbsz:4 abid:8
    v_lshlrev_b32_sdwa v139, v15, v117 dst_sel:DWORD dst_unused:UNUSED_PAD src0_sel:DWORD src1_sel:WORD_1
    ds_read_u16_d16_hi v130, v138 offset:32768
    ds_read_u16_d16_hi v131, v139 offset:32768
    s_set_gpr_idx_on s63, 0xc
    v_pk_fma_f32 v[16:17], v[132:133], v[104:105], v[16:17] op_sel:[1,0,0] op_sel_hi:[1,1,1]
    v_pk_fma_f32 v[18:19], v[132:133], v[106:107], v[18:19] op_sel:[1,0,0] op_sel_hi:[1,1,1]
    v_pk_fma_f32 v[20:21], v[134:135], v[108:109], v[20:21] op_sel:[1,0,0] op_sel_hi:[1,1,1]
    v_pk_fma_f32 v[22:23], v[134:135], v[110:111], v[22:23] op_sel:[1,0,0] op_sel_hi:[1,1,1]
    s_set_gpr_idx_off
B_32:
    s_sub_u32 s32, s32, 4
    s_cbranch_scc1 MAIN_DONE
    v_mfma_f32_4x4x4_16b_bf16 v[124:127], v[172:173], v[178:179], 0 cbsz:4 abid:9
    v_lshlrev_b32_sdwa v136, v15, v114 dst_sel:DWORD dst_unused:UNUSED_PAD src0_sel:DWORD src1_sel:WORD_1
    s_waitcnt vmcnt(13)
    v_mfma_f32_4x4x4_16b_bf16 v[104:107], v[142:143], v[68:69], 0 cbsz:4 abid:8
    s_nop 0
    v_mfma_f32_4x4x4_16b_bf16 v[108:111], v[142:143], v[70:71], 0 cbsz:4 abid:8
    v_lshlrev_b32_sdwa v137, v15, v115 dst_sel:DWORD dst_unused:UNUSED_PAD src0_sel:DWORD src1_sel:WORD_1
    ds_read_u16_d16_hi v132, v136 offset:32768
    ds_read_u16_d16_hi v133, v137 offset:32768
    s_waitcnt lgkmcnt(2)
    s_set_gpr_idx_on s48, 0xc
    v_pk_fma_f32 v[16:17], v[128:129], v[96:97], v[16:17] op_sel:[0,0,0] op_sel_hi:[0,1,1]
    v_pk_fma_f32 v[18:19], v[128:129], v[98:99], v[18:19] op_sel:[0,0,0] op_sel_hi:[0,1,1]
    v_pk_fma_f32 v[20:21], v[130:131], v[100:101], v[20:21] op_sel:[0,0,0] op_sel_hi:[0,1,1]
    v_pk_fma_f32 v[22:23], v[130:131], v[102:103], v[22:23] op_sel:[0,0,0] op_sel_hi:[0,1,1]
    s_set_gpr_idx_off
    v_lshlrev_b32_sdwa v138, v15, v118 dst_sel:DWORD dst_unused:UNUSED_PAD src0_sel:DWORD src1_sel:WORD_1
    s_waitcnt vmcnt(12)
    v_mfma_f32_4x4x4_16b_bf16 v[96:99], v[144:145], v[72:73], 0 cbsz:4 abid:8
    s_nop 0
    v_mfma_f32_4x4x4_16b_bf16 v[100:103], v[144:145], v[74:75], 0 cbsz:4 abid:8
    v_lshlrev_b32_sdwa v139, v15, v119 dst_sel:DWORD dst_unused:UNUSED_PAD src0_sel:DWORD src1_sel:WORD_1
    ds_read_u16_d16_hi v134, v138 offset:32768
    ds_read_u16_d16_hi v135, v139 offset:32768
    s_set_gpr_idx_on s49, 0xc
    v_pk_fma_f32 v[16:17], v[128:129], v[104:105], v[16:17] op_sel:[1,0,0] op_sel_hi:[1,1,1]
    v_pk_fma_f32 v[18:19], v[128:129], v[106:107], v[18:19] op_sel:[1,0,0] op_sel_hi:[1,1,1]
    v_pk_fma_f32 v[20:21], v[130:131], v[108:109], v[20:21] op_sel:[1,0,0] op_sel_hi:[1,1,1]
    v_pk_fma_f32 v[22:23], v[130:131], v[110:111], v[22:23] op_sel:[1,0,0] op_sel_hi:[1,1,1]
    s_set_gpr_idx_off
    v_mfma_f32_4x4x4_16b_bf16 v[112:115], v[172:173], v[176:177], 0 cbsz:4 abid:10
    v_lshlrev_b32_sdwa v136, v15, v120 dst_sel:DWORD dst_unused:UNUSED_PAD src0_sel:DWORD src1_sel:WORD_1
    s_waitcnt vmcnt(11)
    v_mfma_f32_4x4x4_16b_bf16 v[104:107], v[146:147], v[76:77], 0 cbsz:4 abid:8
    s_nop 0
    v_mfma_f32_4x4x4_16b_bf16 v[108:111], v[146:147], v[78:79], 0 cbsz:4 abid:8
    v_lshlrev_b32_sdwa v137, v15, v121 dst_sel:DWORD dst_unused:UNUSED_PAD src0_sel:DWORD src1_sel:WORD_1
    ds_read_u16_d16_hi v128, v136 offset:32768
    ds_read_u16_d16_hi v129, v137 offset:32768
    s_waitcnt lgkmcnt(2)
    s_set_gpr_idx_on s50, 0xc
    v_pk_fma_f32 v[16:17], v[132:133], v[96:97], v[16:17] op_sel:[0,0,0] op_sel_hi:[0,1,1]
    v_pk_fma_f32 v[18:19], v[132:133], v[98:99], v[18:19] op_sel:[0,0,0] op_sel_hi:[0,1,1]
    v_pk_fma_f32 v[20:21], v[134:135], v[100:101], v[20:21] op_sel:[0,0,0] op_sel_hi:[0,1,1]
    v_pk_fma_f32 v[22:23], v[134:135], v[102:103], v[22:23] op_sel:[0,0,0] op_sel_hi:[0,1,1]
    s_set_gpr_idx_off
    v_lshlrev_b32_sdwa v138, v15, v124 dst_sel:DWORD dst_unused:UNUSED_PAD src0_sel:DWORD src1_sel:WORD_1
    s_waitcnt vmcnt(10)
    v_mfma_f32_4x4x4_16b_bf16 v[96:99], v[140:141], v[80:81], 0 cbsz:4 abid:9
    s_nop 0
    v_mfma_f32_4x4x4_16b_bf16 v[100:103], v[140:141], v[82:83], 0 cbsz:4 abid:9
    v_lshlrev_b32_sdwa v139, v15, v125 dst_sel:DWORD dst_unused:UNUSED_PAD src0_sel:DWORD src1_sel:WORD_1
    ds_read_u16_d16_hi v130, v138 offset:32768
    ds_read_u16_d16_hi v131, v139 offset:32768
    s_set_gpr_idx_on s51, 0xc
    v_pk_fma_f32 v[16:17], v[132:133], v[104:105], v[16:17] op_sel:[1,0,0] op_sel_hi:[1,1,1]
    v_pk_fma_f32 v[18:19], v[132:133], v[106:107], v[18:19] op_sel:[1,0,0] op_sel_hi:[1,1,1]
    v_pk_fma_f32 v[20:21], v[134:135], v[108:109], v[20:21] op_sel:[1,0,0] op_sel_hi:[1,1,1]
    v_pk_fma_f32 v[22:23], v[134:135], v[110:111], v[22:23] op_sel:[1,0,0] op_sel_hi:[1,1,1]
    s_set_gpr_idx_off
B_36:
    s_sub_u32 s32, s32, 4
    s_cbranch_scc1 MAIN_DONE
    v_mfma_f32_4x4x4_16b_bf16 v[116:119], v[172:173], v[178:179], 0 cbsz:4 abid:10
    v_lshlrev_b32_sdwa v136, v15, v122 dst_sel:DWORD dst_unused:UNUSED_PAD src0_sel:DWORD src1_sel:WORD_1
    s_waitcnt vmcnt(13)
    v_mfma_f32_4x4x4_16b_bf16 v[104:107], v[142:143], v[84:85], 0 cbsz:4 abid:9
    s_nop 0
    v_mfma_f32_4x4x4_16b_bf16 v[108:111], v[142:143], v[86:87], 0 cbsz:4 abid:9
    v_lshlrev_b32_sdwa v137, v15, v123 dst_sel:DWORD dst_unused:UNUSED_PAD src0_sel:DWORD src1_sel:WORD_1
    ds_read_u16_d16_hi v132, v136 offset:32768
    ds_read_u16_d16_hi v133, v137 offset:32768
    s_waitcnt lgkmcnt(2)
    s_set_gpr_idx_on s52, 0xc
    v_pk_fma_f32 v[16:17], v[128:129], v[96:97], v[16:17] op_sel:[0,0,0] op_sel_hi:[0,1,1]
    v_pk_fma_f32 v[18:19], v[128:129], v[98:99], v[18:19] op_sel:[0,0,0] op_sel_hi:[0,1,1]
    v_pk_fma_f32 v[20:21], v[130:131], v[100:101], v[20:21] op_sel:[0,0,0] op_sel_hi:[0,1,1]
    v_pk_fma_f32 v[22:23], v[130:131], v[102:103], v[22:23] op_sel:[0,0,0] op_sel_hi:[0,1,1]
    s_set_gpr_idx_off
    v_lshlrev_b32_sdwa v138, v15, v126 dst_sel:DWORD dst_unused:UNUSED_PAD src0_sel:DWORD src1_sel:WORD_1
    s_waitcnt vmcnt(12)
    v_mfma_f32_4x4x4_16b_bf16 v[96:99], v[144:145], v[88:89], 0 cbsz:4 abid:9
    s_nop 0
    v_mfma_f32_4x4x4_16b_bf16 v[100:103], v[144:145], v[90:91], 0 cbsz:4 abid:9
    v_lshlrev_b32_sdwa v139, v15, v127 dst_sel:DWORD dst_unused:UNUSED_PAD src0_sel:DWORD src1_sel:WORD_1
    ds_read_u16_d16_hi v134, v138 offset:32768
    ds_read_u16_d16_hi v135, v139 offset:32768
    s_set_gpr_idx_on s53, 0xc
    v_pk_fma_f32 v[16:17], v[128:129], v[104:105], v[16:17] op_sel:[1,0,0] op_sel_hi:[1,1,1]
    v_pk_fma_f32 v[18:19], v[128:129], v[106:107], v[18:19] op_sel:[1,0,0] op_sel_hi:[1,1,1]
    v_pk_fma_f32 v[20:21], v[130:131], v[108:109], v[20:21] op_sel:[1,0,0] op_sel_hi:[1,1,1]
    v_pk_fma_f32 v[22:23], v[130:131], v[110:111], v[22:23] op_sel:[1,0,0] op_sel_hi:[1,1,1]
    s_set_gpr_idx_off
    v_mfma_f32_4x4x4_16b_bf16 v[120:123], v[172:173], v[176:177], 0 cbsz:4 abid:11
    v_lshlrev_b32_sdwa v136, v15, v112 dst_sel:DWORD dst_unused:UNUSED_PAD src0_sel:DWORD src1_sel:WORD_1
    s_waitcnt vmcnt(11)
    v_mfma_f32_4x4x4_16b_bf16 v[104:107], v[146:147], v[92:93], 0 cbsz:4 abid:9
    s_nop 0
    v_mfma_f32_4x4x4_16b_bf16 v[108:111], v[146:147], v[94:95], 0 cbsz:4 abid:9
    v_lshlrev_b32_sdwa v137, v15, v113 dst_sel:DWORD dst_unused:UNUSED_PAD src0_sel:DWORD src1_sel:WORD_1
    ds_read_u16_d16_hi v128, v136 offset:32768
    ds_read_u16_d16_hi v129, v137 offset:32768
    s_waitcnt lgkmcnt(2)
    s_set_gpr_idx_on s54, 0xc
    v_pk_fma_f32 v[16:17], v[132:133], v[96:97], v[16:17] op_sel:[0,0,0] op_sel_hi:[0,1,1]
    v_pk_fma_f32 v[18:19], v[132:133], v[98:99], v[18:19] op_sel:[0,0,0] op_sel_hi:[0,1,1]
    v_pk_fma_f32 v[20:21], v[134:135], v[100:101], v[20:21] op_sel:[0,0,0] op_sel_hi:[0,1,1]
    v_pk_fma_f32 v[22:23], v[134:135], v[102:103], v[22:23] op_sel:[0,0,0] op_sel_hi:[0,1,1]
    s_set_gpr_idx_off
    v_lshlrev_b32_sdwa v138, v15, v116 dst_sel:DWORD dst_unused:UNUSED_PAD src0_sel:DWORD src1_sel:WORD_1
    s_waitcnt vmcnt(10)
    v_mfma_f32_4x4x4_16b_bf16 v[96:99], v[140:141], v[64:65], 0 cbsz:4 abid:10
    s_nop 0
    v_mfma_f32_4x4x4_16b_bf16 v[100:103], v[140:141], v[66:67], 0 cbsz:4 abid:10
    v_lshlrev_b32_sdwa v139, v15, v117 dst_sel:DWORD dst_unused:UNUSED_PAD src0_sel:DWORD src1_sel:WORD_1
    ds_read_u16_d16_hi v130, v138 offset:32768
    ds_read_u16_d16_hi v131, v139 offset:32768
    s_set_gpr_idx_on s55, 0xc
    v_pk_fma_f32 v[16:17], v[132:133], v[104:105], v[16:17] op_sel:[1,0,0] op_sel_hi:[1,1,1]
    v_pk_fma_f32 v[18:19], v[132:133], v[106:107], v[18:19] op_sel:[1,0,0] op_sel_hi:[1,1,1]
    v_pk_fma_f32 v[20:21], v[134:135], v[108:109], v[20:21] op_sel:[1,0,0] op_sel_hi:[1,1,1]
    v_pk_fma_f32 v[22:23], v[134:135], v[110:111], v[22:23] op_sel:[1,0,0] op_sel_hi:[1,1,1]
    s_set_gpr_idx_off
B_40:
    s_sub_u32 s32, s32, 4
    s_cbranch_scc1 MAIN_DONE
    v_mfma_f32_4x4x4_16b_bf16 v[124:127], v[172:173], v[178:179], 0 cbsz:4 abid:11
    v_lshlrev_b32_sdwa v136, v15, v114 dst_sel:DWORD dst_unused:UNUSED_PAD src0_sel:DWORD src1_sel:WORD_1
    s_waitcnt vmcnt(13)
    v_mfma_f32_4x4x4_16b_bf16 v[104:107], v[142:143], v[68:69], 0 cbsz:4 abid:10
    s_nop 0
    v_mfma_f32_4x4x4_16b_bf16 v[108:111], v[142:143], v[70:71], 0 cbsz:4 abid:10
    v_lshlrev_b32_sdwa v137, v15, v115 dst_sel:DWORD dst_unused:UNUSED_PAD src0_sel:DWORD src1_sel:WORD_1
    ds_read_u16_d16_hi v132, v136 offset:32768
    ds_read_u16_d16_hi v133, v137 offset:32768
    s_waitcnt lgkmcnt(2)
    s_set_gpr_idx_on s56, 0xc
    v_pk_fma_f32 v[16:17], v[128:129], v[96:97], v[16:17] op_sel:[0,0,0] op_sel_hi:[0,1,1]
    v_pk_fma_f32 v[18:19], v[128:129], v[98:99], v[18:19] op_sel:[0,0,0] op_sel_hi:[0,1,1]
    v_pk_fma_f32 v[20:21], v[130:131], v[100:101], v[20:21] op_sel:[0,0,0] op_sel_hi:[0,1,1]
    v_pk_fma_f32 v[22:23], v[130:131], v[102:103], v[22:23] op_sel:[0,0,0] op_sel_hi:[0,1,1]
    s_set_gpr_idx_off
    v_mfma_f32_4x4x4_16b_bf16 v[148:151], v[168:169], v[180:181], 0
    v_lshlrev_b32_sdwa v138, v15, v118 dst_sel:DWORD dst_unused:UNUSED_PAD src0_sel:DWORD src1_sel:WORD_1
    s_waitcnt vmcnt(12)
    v_mfma_f32_4x4x4_16b_bf16 v[96:99], v[144:145], v[72:73], 0 cbsz:4 abid:10
    s_nop 0
    v_mfma_f32_4x4x4_16b_bf16 v[100:103], v[144:145], v[74:75], 0 cbsz:4 abid:10
    v_lshlrev_b32_sdwa v139, v15, v119 dst_sel:DWORD dst_unused:UNUSED_PAD src0_sel:DWORD src1_sel:WORD_1
    ds_read_u16_d16_hi v134, v138 offset:32768
    ds_read_u16_d16_hi v135, v139 offset:32768
    s_set_gpr_idx_on s57, 0xc
    v_pk_fma_f32 v[16:17], v[128:129], v[104:105], v[16:17] op_sel:[1,0,0] op_sel_hi:[1,1,1]
    v_pk_fma_f32 v[18:19], v[128:129], v[106:107], v[18:19] op_sel:[1,0,0] op_sel_hi:[1,1,1]
    v_pk_fma_f32 v[20:21], v[130:131], v[108:109], v[20:21] op_sel:[1,0,0] op_sel_hi:[1,1,1]
    v_pk_fma_f32 v[22:23], v[130:131], v[110:111], v[22:23] op_sel:[1,0,0] op_sel_hi:[1,1,1]
    s_set_gpr_idx_off
    v_mfma_f32_4x4x4_16b_bf16 v[112:115], v[172:173], v[176:177], 0 cbsz:4 abid:12
    v_lshlrev_b32_sdwa v136, v15, v120 dst_sel:DWORD dst_unused:UNUSED_PAD src0_sel:DWORD src1_sel:WORD_1
    s_waitcnt vmcnt(11)
    v_mfma_f32_4x4x4_16b_bf16 v[104:107], v[146:147], v[76:77], 0 cbsz:4 abid:10
    s_nop 0
    v_mfma_f32_4x4x4_16b_bf16 v[108:111], v[146:147], v[78:79], 0 cbsz:4 abid:10
    v_lshlrev_b32_sdwa v137, v15, v121 dst_sel:DWORD dst_unused:UNUSED_PAD src0_sel:DWORD src1_sel:WORD_1
    ds_read_u16_d16_hi v128, v136 offset:32768
    ds_read_u16_d16_hi v129, v137 offset:32768
    s_waitcnt lgkmcnt(2)
    s_set_gpr_idx_on s58, 0xc
    v_pk_fma_f32 v[16:17], v[132:133], v[96:97], v[16:17] op_sel:[0,0,0] op_sel_hi:[0,1,1]
    v_pk_fma_f32 v[18:19], v[132:133], v[98:99], v[18:19] op_sel:[0,0,0] op_sel_hi:[0,1,1]
    v_pk_fma_f32 v[20:21], v[134:135], v[100:101], v[20:21] op_sel:[0,0,0] op_sel_hi:[0,1,1]
    v_pk_fma_f32 v[22:23], v[134:135], v[102:103], v[22:23] op_sel:[0,0,0] op_sel_hi:[0,1,1]
    s_set_gpr_idx_off
    v_mfma_f32_4x4x4_16b_bf16 v[152:155], v[168:169], v[182:183], 0
    v_lshlrev_b32_sdwa v138, v15, v124 dst_sel:DWORD dst_unused:UNUSED_PAD src0_sel:DWORD src1_sel:WORD_1
    s_waitcnt vmcnt(10)
    v_mfma_f32_4x4x4_16b_bf16 v[96:99], v[140:141], v[80:81], 0 cbsz:4 abid:11
    s_nop 0
    v_mfma_f32_4x4x4_16b_bf16 v[100:103], v[140:141], v[82:83], 0 cbsz:4 abid:11
    v_lshlrev_b32_sdwa v139, v15, v125 dst_sel:DWORD dst_unused:UNUSED_PAD src0_sel:DWORD src1_sel:WORD_1
    ds_read_u16_d16_hi v130, v138 offset:32768
    ds_read_u16_d16_hi v131, v139 offset:32768
    s_set_gpr_idx_on s59, 0xc
    v_pk_fma_f32 v[16:17], v[132:133], v[104:105], v[16:17] op_sel:[1,0,0] op_sel_hi:[1,1,1]
    v_pk_fma_f32 v[18:19], v[132:133], v[106:107], v[18:19] op_sel:[1,0,0] op_sel_hi:[1,1,1]
    v_pk_fma_f32 v[20:21], v[134:135], v[108:109], v[20:21] op_sel:[1,0,0] op_sel_hi:[1,1,1]
    v_pk_fma_f32 v[22:23], v[134:135], v[110:111], v[22:23] op_sel:[1,0,0] op_sel_hi:[1,1,1]
    s_set_gpr_idx_off
B_44:
    s_sub_u32 s32, s32, 4
    s_cbranch_scc1 MAIN_DONE
    v_mfma_f32_4x4x4_16b_bf16 v[116:119], v[172:173], v[178:179], 0 cbsz:4 abid:12
    v_lshlrev_b32_sdwa v136, v15, v122 dst_sel:DWORD dst_unused:UNUSED_PAD src0_sel:DWORD src1_sel:WORD_1
    s_waitcnt vmcnt(13)
    v_mfma_f32_4x4x4_16b_bf16 v[104:107], v[142:143], v[84:85], 0 cbsz:4 abid:11
    s_nop 0
    v_mfma_f32_4x4x4_16b_bf16 v[108:111], v[142:143], v[86:87], 0 cbsz:4 abid:11
    v_lshlrev_b32_sdwa v137, v15, v123 dst_sel:DWORD dst_unused:UNUSED_PAD src0_sel:DWORD src1_sel:WORD_1
    ds_read_u16_d16_hi v132, v136 offset:32768
    ds_read_u16_d16_hi v133, v137 offset:32768
    s_waitcnt lgkmcnt(2)
    s_set_gpr_idx_on s60, 0xc
    v_pk_fma_f32 v[16:17], v[128:129], v[96:97], v[16:17] op_sel:[0,0,0] op_sel_hi:[0,1,1]
    v_pk_fma_f32 v[18:19], v[128:129], v[98:99], v[18:19] op_sel:[0,0,0] op_sel_hi:[0,1,1]
    v_pk_fma_f32 v[20:21], v[130:131], v[100:101], v[20:21] op_sel:[0,0,0] op_sel_hi:[0,1,1]
    v_pk_fma_f32 v[22:23], v[130:131], v[102:103], v[22:23] op_sel:[0,0,0] op_sel_hi:[0,1,1]
    s_set_gpr_idx_off
    v_mfma_f32_4x4x4_16b_bf16 v[156:159], v[168:169], v[184:185], 0
    v_lshlrev_b32_sdwa v138, v15, v126 dst_sel:DWORD dst_unused:UNUSED_PAD src0_sel:DWORD src1_sel:WORD_1
    s_waitcnt vmcnt(12)
    v_mfma_f32_4x4x4_16b_bf16 v[96:99], v[144:145], v[88:89], 0 cbsz:4 abid:11
    s_nop 0
    v_mfma_f32_4x4x4_16b_bf16 v[100:103], v[144:145], v[90:91], 0 cbsz:4 abid:11
    v_lshlrev_b32_sdwa v139, v15, v127 dst_sel:DWORD dst_unused:UNUSED_PAD src0_sel:DWORD src1_sel:WORD_1
    ds_read_u16_d16_hi v134, v138 offset:32768
    ds_read_u16_d16_hi v135, v139 offset:32768
    s_set_gpr_idx_on s61, 0xc
    v_pk_fma_f32 v[16:17], v[128:129], v[104:105], v[16:17] op_sel:[1,0,0] op_sel_hi:[1,1,1]
    v_pk_fma_f32 v[18:19], v[128:129], v[106:107], v[18:19] op_sel:[1,0,0] op_sel_hi:[1,1,1]
    v_pk_fma_f32 v[20:21], v[130:131], v[108:109], v[20:21] op_sel:[1,0,0] op_sel_hi:[1,1,1]
    v_pk_fma_f32 v[22:23], v[130:131], v[110:111], v[22:23] op_sel:[1,0,0] op_sel_hi:[1,1,1]
    s_set_gpr_idx_off
    v_mfma_f32_4x4x4_16b_bf16 v[120:123], v[172:173], v[176:177], 0 cbsz:4 abid:13
    v_lshlrev_b32_sdwa v136, v15, v112 dst_sel:DWORD dst_unused:UNUSED_PAD src0_sel:DWORD src1_sel:WORD_1
    s_waitcnt vmcnt(11)
    v_mfma_f32_4x4x4_16b_bf16 v[104:107], v[146:147], v[92:93], 0 cbsz:4 abid:11
    s_nop 0
    v_mfma_f32_4x4x4_16b_bf16 v[108:111], v[146:147], v[94:95], 0 cbsz:4 abid:11
    v_lshlrev_b32_sdwa v137, v15, v113 dst_sel:DWORD dst_unused:UNUSED_PAD src0_sel:DWORD src1_sel:WORD_1
    ds_read_u16_d16_hi v128, v136 offset:32768
    ds_read_u16_d16_hi v129, v137 offset:32768
    s_waitcnt lgkmcnt(2)
    s_set_gpr_idx_on s62, 0xc
    v_pk_fma_f32 v[16:17], v[132:133], v[96:97], v[16:17] op_sel:[0,0,0] op_sel_hi:[0,1,1]
    v_pk_fma_f32 v[18:19], v[132:133], v[98:99], v[18:19] op_sel:[0,0,0] op_sel_hi:[0,1,1]
    v_pk_fma_f32 v[20:21], v[134:135], v[100:101], v[20:21] op_sel:[0,0,0] op_sel_hi:[0,1,1]
    v_pk_fma_f32 v[22:23], v[134:135], v[102:103], v[22:23] op_sel:[0,0,0] op_sel_hi:[0,1,1]
    s_set_gpr_idx_off
    v_mfma_f32_4x4x4_16b_bf16 v[160:163], v[168:169], v[186:187], 0
    v_lshlrev_b32_sdwa v138, v15, v116 dst_sel:DWORD dst_unused:UNUSED_PAD src0_sel:DWORD src1_sel:WORD_1
    s_waitcnt vmcnt(10)
    v_mfma_f32_4x4x4_16b_bf16 v[96:99], v[140:141], v[64:65], 0 cbsz:4 abid:12
    s_nop 0
    v_mfma_f32_4x4x4_16b_bf16 v[100:103], v[140:141], v[66:67], 0 cbsz:4 abid:12
    v_lshlrev_b32_sdwa v139, v15, v117 dst_sel:DWORD dst_unused:UNUSED_PAD src0_sel:DWORD src1_sel:WORD_1
    ds_read_u16_d16_hi v130, v138 offset:32768
    ds_read_u16_d16_hi v131, v139 offset:32768
    s_set_gpr_idx_on s63, 0xc
    v_pk_fma_f32 v[16:17], v[132:133], v[104:105], v[16:17] op_sel:[1,0,0] op_sel_hi:[1,1,1]
    v_pk_fma_f32 v[18:19], v[132:133], v[106:107], v[18:19] op_sel:[1,0,0] op_sel_hi:[1,1,1]
    v_pk_fma_f32 v[20:21], v[134:135], v[108:109], v[20:21] op_sel:[1,0,0] op_sel_hi:[1,1,1]
    v_pk_fma_f32 v[22:23], v[134:135], v[110:111], v[22:23] op_sel:[1,0,0] op_sel_hi:[1,1,1]
    s_set_gpr_idx_off
B_48:
    s_sub_u32 s32, s32, 4
    s_cbranch_scc1 MAIN_DONE
    v_mfma_f32_4x4x4_16b_bf16 v[124:127], v[172:173], v[178:179], 0 cbsz:4 abid:13
    v_lshlrev_b32_sdwa v136, v15, v114 dst_sel:DWORD dst_unused:UNUSED_PAD src0_sel:DWORD src1_sel:WORD_1
    s_waitcnt vmcnt(13)
    v_mfma_f32_4x4x4_16b_bf16 v[104:107], v[142:143], v[68:69], 0 cbsz:4 abid:12
    s_nop 0
    v_mfma_f32_4x4x4_16b_bf16 v[108:111], v[142:143], v[70:71], 0 cbsz:4 abid:12
    v_lshlrev_b32_sdwa v137, v15, v115 dst_sel:DWORD dst_unused:UNUSED_PAD src0_sel:DWORD src1_sel:WORD_1
    ds_read_u16_d16_hi v132, v136 offset:32768
    ds_read_u16_d16_hi v133, v137 offset:32768
    s_waitcnt lgkmcnt(2)
    s_set_gpr_idx_on s48, 0xc
    v_pk_fma_f32 v[16:17], v[128:129], v[96:97], v[16:17] op_sel:[0,0,0] op_sel_hi:[0,1,1]
    v_pk_fma_f32 v[18:19], v[128:129], v[98:99], v[18:19] op_sel:[0,0,0] op_sel_hi:[0,1,1]
    v_pk_fma_f32 v[20:21], v[130:131], v[100:101], v[20:21] op_sel:[0,0,0] op_sel_hi:[0,1,1]
    v_pk_fma_f32 v[22:23], v[130:131], v[102:103], v[22:23] op_sel:[0,0,0] op_sel_hi:[0,1,1]
    s_set_gpr_idx_off
    v_lshlrev_b32_sdwa v138, v15, v118 dst_sel:DWORD dst_unused:UNUSED_PAD src0_sel:DWORD src1_sel:WORD_1
    s_waitcnt vmcnt(12)
    v_mfma_f32_4x4x4_16b_bf16 v[96:99], v[144:145], v[72:73], 0 cbsz:4 abid:12
    s_nop 0
    v_mfma_f32_4x4x4_16b_bf16 v[100:103], v[144:145], v[74:75], 0 cbsz:4 abid:12
    v_lshlrev_b32_sdwa v139, v15, v119 dst_sel:DWORD dst_unused:UNUSED_PAD src0_sel:DWORD src1_sel:WORD_1
    ds_read_u16_d16_hi v134, v138 offset:32768
    ds_read_u16_d16_hi v135, v139 offset:32768
    s_set_gpr_idx_on s49, 0xc
    v_pk_fma_f32 v[16:17], v[128:129], v[104:105], v[16:17] op_sel:[1,0,0] op_sel_hi:[1,1,1]
    v_pk_fma_f32 v[18:19], v[128:129], v[106:107], v[18:19] op_sel:[1,0,0] op_sel_hi:[1,1,1]
    v_pk_fma_f32 v[20:21], v[130:131], v[108:109], v[20:21] op_sel:[1,0,0] op_sel_hi:[1,1,1]
    v_pk_fma_f32 v[22:23], v[130:131], v[110:111], v[22:23] op_sel:[1,0,0] op_sel_hi:[1,1,1]
    s_set_gpr_idx_off
    v_mfma_f32_4x4x4_16b_bf16 v[112:115], v[172:173], v[176:177], 0 cbsz:4 abid:14
    v_lshlrev_b32_sdwa v136, v15, v120 dst_sel:DWORD dst_unused:UNUSED_PAD src0_sel:DWORD src1_sel:WORD_1
    s_waitcnt vmcnt(11)
    v_mfma_f32_4x4x4_16b_bf16 v[104:107], v[146:147], v[76:77], 0 cbsz:4 abid:12
    s_nop 0
    v_mfma_f32_4x4x4_16b_bf16 v[108:111], v[146:147], v[78:79], 0 cbsz:4 abid:12
    v_lshlrev_b32_sdwa v137, v15, v121 dst_sel:DWORD dst_unused:UNUSED_PAD src0_sel:DWORD src1_sel:WORD_1
    ds_read_u16_d16_hi v128, v136 offset:32768
    ds_read_u16_d16_hi v129, v137 offset:32768
    s_waitcnt lgkmcnt(2)
    s_set_gpr_idx_on s50, 0xc
    v_pk_fma_f32 v[16:17], v[132:133], v[96:97], v[16:17] op_sel:[0,0,0] op_sel_hi:[0,1,1]
    v_pk_fma_f32 v[18:19], v[132:133], v[98:99], v[18:19] op_sel:[0,0,0] op_sel_hi:[0,1,1]
    v_pk_fma_f32 v[20:21], v[134:135], v[100:101], v[20:21] op_sel:[0,0,0] op_sel_hi:[0,1,1]
    v_pk_fma_f32 v[22:23], v[134:135], v[102:103], v[22:23] op_sel:[0,0,0] op_sel_hi:[0,1,1]
    s_set_gpr_idx_off
    v_lshlrev_b32_sdwa v138, v15, v124 dst_sel:DWORD dst_unused:UNUSED_PAD src0_sel:DWORD src1_sel:WORD_1
    s_waitcnt vmcnt(10)
    v_mfma_f32_4x4x4_16b_bf16 v[96:99], v[140:141], v[80:81], 0 cbsz:4 abid:13
    s_nop 0
    v_mfma_f32_4x4x4_16b_bf16 v[100:103], v[140:141], v[82:83], 0 cbsz:4 abid:13
    v_lshlrev_b32_sdwa v139, v15, v125 dst_sel:DWORD dst_unused:UNUSED_PAD src0_sel:DWORD src1_sel:WORD_1
    ds_read_u16_d16_hi v130, v138 offset:32768
    ds_read_u16_d16_hi v131, v139 offset:32768
    s_set_gpr_idx_on s51, 0xc
    v_pk_fma_f32 v[16:17], v[132:133], v[104:105], v[16:17] op_sel:[1,0,0] op_sel_hi:[1,1,1]
    v_pk_fma_f32 v[18:19], v[132:133], v[106:107], v[18:19] op_sel:[1,0,0] op_sel_hi:[1,1,1]
    v_pk_fma_f32 v[20:21], v[134:135], v[108:109], v[20:21] op_sel:[1,0,0] op_sel_hi:[1,1,1]
    v_pk_fma_f32 v[22:23], v[134:135], v[110:111], v[22:23] op_sel:[1,0,0] op_sel_hi:[1,1,1]
    s_set_gpr_idx_off
B_52:
    s_sub_u32 s32, s32, 4
    s_cbranch_scc1 MAIN_DONE
    v_mfma_f32_4x4x4_16b_bf16 v[116:119], v[172:173], v[178:179], 0 cbsz:4 abid:14
    v_lshlrev_b32_sdwa v136, v15, v122 dst_sel:DWORD dst_unused:UNUSED_PAD src0_sel:DWORD src1_sel:WORD_1
    s_waitcnt vmcnt(13)
    v_mfma_f32_4x4x4_16b_bf16 v[104:107], v[142:143], v[84:85], 0 cbsz:4 abid:13
    s_nop 0
    v_mfma_f32_4x4x4_16b_bf16 v[108:111], v[142:143], v[86:87], 0 cbsz:4 abid:13
    v_lshlrev_b32_sdwa v137, v15, v123 dst_sel:DWORD dst_unused:UNUSED_PAD src0_sel:DWORD src1_sel:WORD_1
    ds_read_u16_d16_hi v132, v136 offset:32768
    ds_read_u16_d16_hi v133, v137 offset:32768
    s_waitcnt lgkmcnt(2)
    s_set_gpr_idx_on s52, 0xc
    v_pk_fma_f32 v[16:17], v[128:129], v[96:97], v[16:17] op_sel:[0,0,0] op_sel_hi:[0,1,1]
    v_pk_fma_f32 v[18:19], v[128:129], v[98:99], v[18:19] op_sel:[0,0,0] op_sel_hi:[0,1,1]
    v_pk_fma_f32 v[20:21], v[130:131], v[100:101], v[20:21] op_sel:[0,0,0] op_sel_hi:[0,1,1]
    v_pk_fma_f32 v[22:23], v[130:131], v[102:103], v[22:23] op_sel:[0,0,0] op_sel_hi:[0,1,1]
    s_set_gpr_idx_off
    v_lshlrev_b32_sdwa v138, v15, v126 dst_sel:DWORD dst_unused:UNUSED_PAD src0_sel:DWORD src1_sel:WORD_1
    s_waitcnt vmcnt(12)
    v_mfma_f32_4x4x4_16b_bf16 v[96:99], v[144:145], v[88:89], 0 cbsz:4 abid:13
    s_nop 0
    v_mfma_f32_4x4x4_16b_bf16 v[100:103], v[144:145], v[90:91], 0 cbsz:4 abid:13
    v_lshlrev_b32_sdwa v139, v15, v127 dst_sel:DWORD dst_unused:UNUSED_PAD src0_sel:DWORD src1_sel:WORD_1
    ds_read_u16_d16_hi v134, v138 offset:32768
    ds_read_u16_d16_hi v135, v139 offset:32768
    s_set_gpr_idx_on s53, 0xc
    v_pk_fma_f32 v[16:17], v[128:129], v[104:105], v[16:17] op_sel:[1,0,0] op_sel_hi:[1,1,1]
    v_pk_fma_f32 v[18:19], v[128:129], v[106:107], v[18:19] op_sel:[1,0,0] op_sel_hi:[1,1,1]
    v_pk_fma_f32 v[20:21], v[130:131], v[108:109], v[20:21] op_sel:[1,0,0] op_sel_hi:[1,1,1]
    v_pk_fma_f32 v[22:23], v[130:131], v[110:111], v[22:23] op_sel:[1,0,0] op_sel_hi:[1,1,1]
    s_set_gpr_idx_off
    v_mfma_f32_4x4x4_16b_bf16 v[120:123], v[172:173], v[176:177], 0 cbsz:4 abid:15
    v_lshlrev_b32_sdwa v136, v15, v112 dst_sel:DWORD dst_unused:UNUSED_PAD src0_sel:DWORD src1_sel:WORD_1
    s_waitcnt vmcnt(11)
    v_mfma_f32_4x4x4_16b_bf16 v[104:107], v[146:147], v[92:93], 0 cbsz:4 abid:13
    s_nop 0
    v_mfma_f32_4x4x4_16b_bf16 v[108:111], v[146:147], v[94:95], 0 cbsz:4 abid:13
    v_lshlrev_b32_sdwa v137, v15, v113 dst_sel:DWORD dst_unused:UNUSED_PAD src0_sel:DWORD src1_sel:WORD_1
    ds_read_u16_d16_hi v128, v136 offset:32768
    ds_read_u16_d16_hi v129, v137 offset:32768
    s_waitcnt lgkmcnt(2)
    s_set_gpr_idx_on s54, 0xc
    v_pk_fma_f32 v[16:17], v[132:133], v[96:97], v[16:17] op_sel:[0,0,0] op_sel_hi:[0,1,1]
    v_pk_fma_f32 v[18:19], v[132:133], v[98:99], v[18:19] op_sel:[0,0,0] op_sel_hi:[0,1,1]
    v_pk_fma_f32 v[20:21], v[134:135], v[100:101], v[20:21] op_sel:[0,0,0] op_sel_hi:[0,1,1]
    v_pk_fma_f32 v[22:23], v[134:135], v[102:103], v[22:23] op_sel:[0,0,0] op_sel_hi:[0,1,1]
    s_set_gpr_idx_off
    v_lshlrev_b32_sdwa v138, v15, v116 dst_sel:DWORD dst_unused:UNUSED_PAD src0_sel:DWORD src1_sel:WORD_1
    s_waitcnt vmcnt(10)
    v_mfma_f32_4x4x4_16b_bf16 v[96:99], v[140:141], v[64:65], 0 cbsz:4 abid:14
    s_nop 0
    v_mfma_f32_4x4x4_16b_bf16 v[100:103], v[140:141], v[66:67], 0 cbsz:4 abid:14
    v_lshlrev_b32_sdwa v139, v15, v117 dst_sel:DWORD dst_unused:UNUSED_PAD src0_sel:DWORD src1_sel:WORD_1
    ds_read_u16_d16_hi v130, v138 offset:32768
    ds_read_u16_d16_hi v131, v139 offset:32768
    s_set_gpr_idx_on s55, 0xc
    v_pk_fma_f32 v[16:17], v[132:133], v[104:105], v[16:17] op_sel:[1,0,0] op_sel_hi:[1,1,1]
    v_pk_fma_f32 v[18:19], v[132:133], v[106:107], v[18:19] op_sel:[1,0,0] op_sel_hi:[1,1,1]
    v_pk_fma_f32 v[20:21], v[134:135], v[108:109], v[20:21] op_sel:[1,0,0] op_sel_hi:[1,1,1]
    v_pk_fma_f32 v[22:23], v[134:135], v[110:111], v[22:23] op_sel:[1,0,0] op_sel_hi:[1,1,1]
    s_set_gpr_idx_off
B_56:
    s_sub_u32 s32, s32, 4
    s_cbranch_scc1 MAIN_DONE
    v_mfma_f32_4x4x4_16b_bf16 v[124:127], v[172:173], v[178:179], 0 cbsz:4 abid:15
    v_lshlrev_b32_sdwa v136, v15, v114 dst_sel:DWORD dst_unused:UNUSED_PAD src0_sel:DWORD src1_sel:WORD_1
    s_waitcnt vmcnt(13)
    v_mfma_f32_4x4x4_16b_bf16 v[104:107], v[142:143], v[68:69], 0 cbsz:4 abid:14
    s_nop 0
    v_mfma_f32_4x4x4_16b_bf16 v[108:111], v[142:143], v[70:71], 0 cbsz:4 abid:14
    v_lshlrev_b32_sdwa v137, v15, v115 dst_sel:DWORD dst_unused:UNUSED_PAD src0_sel:DWORD src1_sel:WORD_1
    ds_read_u16_d16_hi v132, v136 offset:32768
    ds_read_u16_d16_hi v133, v137 offset:32768
    s_waitcnt lgkmcnt(2)
    s_set_gpr_idx_on s56, 0xc
    v_pk_fma_f32 v[16:17], v[128:129], v[96:97], v[16:17] op_sel:[0,0,0] op_sel_hi:[0,1,1]
    v_pk_fma_f32 v[18:19], v[128:129], v[98:99], v[18:19] op_sel:[0,0,0] op_sel_hi:[0,1,1]
    v_pk_fma_f32 v[20:21], v[130:131], v[100:101], v[20:21] op_sel:[0,0,0] op_sel_hi:[0,1,1]
    v_pk_fma_f32 v[22:23], v[130:131], v[102:103], v[22:23] op_sel:[0,0,0] op_sel_hi:[0,1,1]
    s_set_gpr_idx_off
    v_lshlrev_b32_sdwa v138, v15, v118 dst_sel:DWORD dst_unused:UNUSED_PAD src0_sel:DWORD src1_sel:WORD_1
    s_waitcnt vmcnt(12)
    v_mfma_f32_4x4x4_16b_bf16 v[96:99], v[144:145], v[72:73], 0 cbsz:4 abid:14
    s_nop 0
    v_mfma_f32_4x4x4_16b_bf16 v[100:103], v[144:145], v[74:75], 0 cbsz:4 abid:14
    v_lshlrev_b32_sdwa v139, v15, v119 dst_sel:DWORD dst_unused:UNUSED_PAD src0_sel:DWORD src1_sel:WORD_1
    ds_read_u16_d16_hi v134, v138 offset:32768
    ds_read_u16_d16_hi v135, v139 offset:32768
    s_set_gpr_idx_on s57, 0xc
    v_pk_fma_f32 v[16:17], v[128:129], v[104:105], v[16:17] op_sel:[1,0,0] op_sel_hi:[1,1,1]
    v_pk_fma_f32 v[18:19], v[128:129], v[106:107], v[18:19] op_sel:[1,0,0] op_sel_hi:[1,1,1]
    v_pk_fma_f32 v[20:21], v[130:131], v[108:109], v[20:21] op_sel:[1,0,0] op_sel_hi:[1,1,1]
    v_pk_fma_f32 v[22:23], v[130:131], v[110:111], v[22:23] op_sel:[1,0,0] op_sel_hi:[1,1,1]
    s_set_gpr_idx_off
    v_mov_b32 v172, v170
    v_mov_b32 v173, v171
    s_nop 1
    v_mfma_f32_4x4x4_16b_bf16 v[112:115], v[172:173], v[176:177], 0 cbsz:4 abid:0
    v_lshlrev_b32_sdwa v136, v15, v120 dst_sel:DWORD dst_unused:UNUSED_PAD src0_sel:DWORD src1_sel:WORD_1
    s_waitcnt vmcnt(11)
    v_mfma_f32_4x4x4_16b_bf16 v[104:107], v[146:147], v[76:77], 0 cbsz:4 abid:14
    s_nop 0
    v_mfma_f32_4x4x4_16b_bf16 v[108:111], v[146:147], v[78:79], 0 cbsz:4 abid:14
    v_lshlrev_b32_sdwa v137, v15, v121 dst_sel:DWORD dst_unused:UNUSED_PAD src0_sel:DWORD src1_sel:WORD_1
    ds_read_u16_d16_hi v128, v136 offset:32768
    ds_read_u16_d16_hi v129, v137 offset:32768
    s_waitcnt lgkmcnt(2)
    s_set_gpr_idx_on s58, 0xc
    v_pk_fma_f32 v[16:17], v[132:133], v[96:97], v[16:17] op_sel:[0,0,0] op_sel_hi:[0,1,1]
    v_pk_fma_f32 v[18:19], v[132:133], v[98:99], v[18:19] op_sel:[0,0,0] op_sel_hi:[0,1,1]
    v_pk_fma_f32 v[20:21], v[134:135], v[100:101], v[20:21] op_sel:[0,0,0] op_sel_hi:[0,1,1]
    v_pk_fma_f32 v[22:23], v[134:135], v[102:103], v[22:23] op_sel:[0,0,0] op_sel_hi:[0,1,1]
    s_set_gpr_idx_off
    v_lshlrev_b32_sdwa v138, v15, v124 dst_sel:DWORD dst_unused:UNUSED_PAD src0_sel:DWORD src1_sel:WORD_1
    s_waitcnt vmcnt(10)
    v_mfma_f32_4x4x4_16b_bf16 v[96:99], v[140:141], v[80:81], 0 cbsz:4 abid:15
    s_nop 0
    v_mfma_f32_4x4x4_16b_bf16 v[100:103], v[140:141], v[82:83], 0 cbsz:4 abid:15
    v_lshlrev_b32_sdwa v139, v15, v125 dst_sel:DWORD dst_unused:UNUSED_PAD src0_sel:DWORD src1_sel:WORD_1
    ds_read_u16_d16_hi v130, v138 offset:32768
    ds_read_u16_d16_hi v131, v139 offset:32768
    s_set_gpr_idx_on s59, 0xc
    v_pk_fma_f32 v[16:17], v[132:133], v[104:105], v[16:17] op_sel:[1,0,0] op_sel_hi:[1,1,1]
    v_pk_fma_f32 v[18:19], v[132:133], v[106:107], v[18:19] op_sel:[1,0,0] op_sel_hi:[1,1,1]
    v_pk_fma_f32 v[20:21], v[134:135], v[108:109], v[20:21] op_sel:[1,0,0] op_sel_hi:[1,1,1]
    v_pk_fma_f32 v[22:23], v[134:135], v[110:111], v[22:23] op_sel:[1,0,0] op_sel_hi:[1,1,1]
    s_set_gpr_idx_off
B_60:
    s_sub_u32 s32, s32, 4
    s_cbranch_scc1 MAIN_DONE
    v_mfma_f32_4x4x4_16b_bf16 v[116:119], v[172:173], v[178:179], 0 cbsz:4 abid:0
    v_lshlrev_b32_sdwa v136, v15, v122 dst_sel:DWORD dst_unused:UNUSED_PAD src0_sel:DWORD src1_sel:WORD_1
    s_waitcnt vmcnt(13)
    v_mfma_f32_4x4x4_16b_bf16 v[104:107], v[142:143], v[84:85], 0 cbsz:4 abid:15
    s_nop 0
    v_mfma_f32_4x4x4_16b_bf16 v[108:111], v[142:143], v[86:87], 0 cbsz:4 abid:15
    v_lshlrev_b32_sdwa v137, v15, v123 dst_sel:DWORD dst_unused:UNUSED_PAD src0_sel:DWORD src1_sel:WORD_1
    ds_read_u16_d16_hi v132, v136 offset:32768
    ds_read_u16_d16_hi v133, v137 offset:32768
    v_cvt_pk_bf16_f32 v140, v148, v152
    v_cvt_pk_bf16_f32 v141, v156, v160
    s_waitcnt lgkmcnt(2)
    s_set_gpr_idx_on s60, 0xc
    v_pk_fma_f32 v[16:17], v[128:129], v[96:97], v[16:17] op_sel:[0,0,0] op_sel_hi:[0,1,1]
    v_pk_fma_f32 v[18:19], v[128:129], v[98:99], v[18:19] op_sel:[0,0,0] op_sel_hi:[0,1,1]
    v_pk_fma_f32 v[20:21], v[130:131], v[100:101], v[20:21] op_sel:[0,0,0] op_sel_hi:[0,1,1]
    v_pk_fma_f32 v[22:23], v[130:131], v[102:103], v[22:23] op_sel:[0,0,0] op_sel_hi:[0,1,1]
    s_set_gpr_idx_off
    v_lshlrev_b32_sdwa v138, v15, v126 dst_sel:DWORD dst_unused:UNUSED_PAD src0_sel:DWORD src1_sel:WORD_1
    s_waitcnt vmcnt(12)
    v_mfma_f32_4x4x4_16b_bf16 v[96:99], v[144:145], v[88:89], 0 cbsz:4 abid:15
    s_nop 0
    v_mfma_f32_4x4x4_16b_bf16 v[100:103], v[144:145], v[90:91], 0 cbsz:4 abid:15
    v_lshlrev_b32_sdwa v139, v15, v127 dst_sel:DWORD dst_unused:UNUSED_PAD src0_sel:DWORD src1_sel:WORD_1
    ds_read_u16_d16_hi v134, v138 offset:32768
    ds_read_u16_d16_hi v135, v139 offset:32768
    v_cvt_pk_bf16_f32 v142, v149, v153
    v_cvt_pk_bf16_f32 v143, v157, v161
    s_set_gpr_idx_on s61, 0xc
    v_pk_fma_f32 v[16:17], v[128:129], v[104:105], v[16:17] op_sel:[1,0,0] op_sel_hi:[1,1,1]
    v_pk_fma_f32 v[18:19], v[128:129], v[106:107], v[18:19] op_sel:[1,0,0] op_sel_hi:[1,1,1]
    v_pk_fma_f32 v[20:21], v[130:131], v[108:109], v[20:21] op_sel:[1,0,0] op_sel_hi:[1,1,1]
    v_pk_fma_f32 v[22:23], v[130:131], v[110:111], v[22:23] op_sel:[1,0,0] op_sel_hi:[1,1,1]
    s_set_gpr_idx_off
    v_mfma_f32_4x4x4_16b_bf16 v[120:123], v[172:173], v[176:177], 0 cbsz:4 abid:1
    v_lshlrev_b32_sdwa v136, v15, v112 dst_sel:DWORD dst_unused:UNUSED_PAD src0_sel:DWORD src1_sel:WORD_1
    s_waitcnt vmcnt(11)
    v_mfma_f32_4x4x4_16b_bf16 v[104:107], v[146:147], v[92:93], 0 cbsz:4 abid:15
    s_nop 0
    v_mfma_f32_4x4x4_16b_bf16 v[108:111], v[146:147], v[94:95], 0 cbsz:4 abid:15
    v_lshlrev_b32_sdwa v137, v15, v113 dst_sel:DWORD dst_unused:UNUSED_PAD src0_sel:DWORD src1_sel:WORD_1
    ds_read_u16_d16_hi v128, v136 offset:32768
    ds_read_u16_d16_hi v129, v137 offset:32768
    v_cvt_pk_bf16_f32 v144, v150, v154
    v_cvt_pk_bf16_f32 v145, v158, v162
    s_waitcnt lgkmcnt(2)
    s_set_gpr_idx_on s62, 0xc
    v_pk_fma_f32 v[16:17], v[132:133], v[96:97], v[16:17] op_sel:[0,0,0] op_sel_hi:[0,1,1]
    v_pk_fma_f32 v[18:19], v[132:133], v[98:99], v[18:19] op_sel:[0,0,0] op_sel_hi:[0,1,1]
    v_pk_fma_f32 v[20:21], v[134:135], v[100:101], v[20:21] op_sel:[0,0,0] op_sel_hi:[0,1,1]
    v_pk_fma_f32 v[22:23], v[134:135], v[102:103], v[22:23] op_sel:[0,0,0] op_sel_hi:[0,1,1]
    s_set_gpr_idx_off
    v_lshlrev_b32_sdwa v138, v15, v116 dst_sel:DWORD dst_unused:UNUSED_PAD src0_sel:DWORD src1_sel:WORD_1
    s_waitcnt vmcnt(10)
    v_mfma_f32_4x4x4_16b_bf16 v[96:99], v[140:141], v[64:65], 0 cbsz:4 abid:0
    s_nop 0
    v_mfma_f32_4x4x4_16b_bf16 v[100:103], v[140:141], v[66:67], 0 cbsz:4 abid:0
    v_lshlrev_b32_sdwa v139, v15, v117 dst_sel:DWORD dst_unused:UNUSED_PAD src0_sel:DWORD src1_sel:WORD_1
    ds_read_u16_d16_hi v130, v138 offset:32768
    ds_read_u16_d16_hi v131, v139 offset:32768
    v_cvt_pk_bf16_f32 v146, v151, v155
    v_cvt_pk_bf16_f32 v147, v159, v163
    s_set_gpr_idx_on s63, 0xc
    v_pk_fma_f32 v[16:17], v[132:133], v[104:105], v[16:17] op_sel:[1,0,0] op_sel_hi:[1,1,1]
    v_pk_fma_f32 v[18:19], v[132:133], v[106:107], v[18:19] op_sel:[1,0,0] op_sel_hi:[1,1,1]
    v_pk_fma_f32 v[20:21], v[134:135], v[108:109], v[20:21] op_sel:[1,0,0] op_sel_hi:[1,1,1]
    v_pk_fma_f32 v[22:23], v[134:135], v[110:111], v[22:23] op_sel:[1,0,0] op_sel_hi:[1,1,1]
    s_set_gpr_idx_off
    v_mov_b32 v164, v165
    s_branch B_0
MAIN_DONE:
    s_waitcnt vmcnt(0) lgkmcnt(0)
    s_add_u32 s27, s27, 1472
    s_cmp_ge_u32 s27, s26
    s_cbranch_scc1 ALL_DONE
    v_lshlrev_b32 v11, 2, v0
    v_mov_b32 v12, 0
    v_cmp_gt_u32 vcc, 480, v0
    s_and_saveexec_b64 s[42:43], vcc
    ds_write_b32 v11, v12 offset:0
    s_mov_b64 exec, s[42:43]
    s_waitcnt lgkmcnt(0)
    s_barrier
    s_branch ROUND
ALL_DONE:
    v_cvt_pk_bf16_f32 v64, v16, v20
    v_cvt_pk_bf16_f32 v65, v17, v21
    v_cvt_pk_bf16_f32 v66, v18, v22
    v_cvt_pk_bf16_f32 v67, v19, v23
    v_cvt_pk_bf16_f32 v68, v24, v28
    v_cvt_pk_bf16_f32 v69, v25, v29
    v_cvt_pk_bf16_f32 v70, v26, v30
    v_cvt_pk_bf16_f32 v71, v27, v31
    v_cvt_pk_bf16_f32 v72, v32, v36
    v_cvt_pk_bf16_f32 v73, v33, v37
    v_cvt_pk_bf16_f32 v74, v34, v38
    v_cvt_pk_bf16_f32 v75, v35, v39
    v_cvt_pk_bf16_f32 v76, v40, v44
    v_cvt_pk_bf16_f32 v77, v41, v45
    v_cvt_pk_bf16_f32 v78, v42, v46
    v_cvt_pk_bf16_f32 v79, v43, v47
    v_cvt_pk_bf16_f32 v80, v48, v52
    v_cvt_pk_bf16_f32 v81, v49, v53
    v_cvt_pk_bf16_f32 v82, v50, v54
    v_cvt_pk_bf16_f32 v83, v51, v55
    v_lshrrev_b32 v8, 2, v1
    v_add_u32 v8, 32768, v8
    s_mul_i32 s42, s4, 1152
    v_add_u32 v96, s42, v8
    s_mul_i32 s42, s5, 1152
    v_add_u32 v97, s42, v8
    s_mul_i32 s42, s6, 1152
    v_add_u32 v98, s42, v8
    s_mul_i32 s42, s7, 1152
    v_add_u32 v99, s42, v8
    s_mul_i32 s42, s8, 1152
    v_add_u32 v100, s42, v8
    v_lshrrev_b32 v9, 4, v1
    v_and_b32 v10, 15, v9
    v_lshrrev_b32 v11, 4, v9
    s_lshr_b32 s42, s25, 2
    s_mul_i32 s43, s42, 23040
    s_add_u32 s43, s43, 32768
    v_mul_u32_u24 v8, 288, v10
    v_lshl_add_u32 v8, v11, 4, v8
    v_add_u32 v8, s43, v8
    s_mul_i32 s42, s42, 5242880
    s_lshl_b32 s43, s24, 10
    s_add_u32 s42, s42, s43
    s_and_b32 s43, s25, 3
    s_lshl_b32 s43, s43, 8
    s_add_u32 s42, s42, s43
    v_lshlrev_b32 v11, 18, v11
    v_lshl_add_u32 v11, v10, 4, v11
    v_add_u32 v11, s42, v11
    s_barrier
    ds_write_b32 v96, v64 offset:0
    ds_write_b32 v96, v65 offset:288
    ds_write_b32 v96, v66 offset:576
    ds_write_b32 v96, v67 offset:864
    ds_write_b32 v97, v68 offset:0
    ds_write_b32 v97, v69 offset:288
    ds_write_b32 v97, v70 offset:576
    ds_write_b32 v97, v71 offset:864
    ds_write_b32 v98, v72 offset:0
    ds_write_b32 v98, v73 offset:288
    ds_write_b32 v98, v74 offset:576
    ds_write_b32 v98, v75 offset:864
    ds_write_b32 v99, v76 offset:0
    ds_write_b32 v99, v77 offset:288
    ds_write_b32 v99, v78 offset:576
    ds_write_b32 v99, v79 offset:864
    ds_write_b32 v100, v80 offset:0
    ds_write_b32 v100, v81 offset:288
    ds_write_b32 v100, v82 offset:576
    ds_write_b32 v100, v83 offset:864
    s_waitcnt lgkmcnt(0)
    s_barrier
    ds_read_b128 v[64:67], v8 offset:0
    ds_read_b128 v[68:71], v8 offset:64
    ds_read_b128 v[72:75], v8 offset:128
    ds_read_b128 v[76:79], v8 offset:192
    ds_read_b128 v[80:83], v8 offset:4608
    ds_read_b128 v[84:87], v8 offset:4672
    ds_read_b128 v[88:91], v8 offset:4736
    ds_read_b128 v[92:95], v8 offset:4800
    s_waitcnt lgkmcnt(7)
    v_mfma_f32_16x16x32_bf16 v[16:19], v[64:67], v[188:191], 0
    v_mfma_f32_16x16x32_bf16 v[20:23], v[64:67], v[204:207], 0
    s_waitcnt lgkmcnt(6)
    v_mfma_f32_16x16x32_bf16 v[16:19], v[68:71], v[192:195], v[16:19]
    v_mfma_f32_16x16x32_bf16 v[20:23], v[68:71], v[208:211], v[20:23]
    s_waitcnt lgkmcnt(5)
    v_mfma_f32_16x16x32_bf16 v[16:19], v[72:75], v[196:199], v[16:19]
    v_mfma_f32_16x16x32_bf16 v[20:23], v[72:75], v[212:215], v[20:23]
    s_waitcnt lgkmcnt(4)
    v_mfma_f32_16x16x32_bf16 v[16:19], v[76:79], v[200:203], v[16:19]
    v_mfma_f32_16x16x32_bf16 v[20:23], v[76:79], v[216:219], v[20:23]
    ds_read_b128 v[64:67], v8 offset:9216
    ds_read_b128 v[68:71], v8 offset:9280
    ds_read_b128 v[72:75], v8 offset:9344
    ds_read_b128 v[76:79], v8 offset:9408
    s_waitcnt lgkmcnt(7)
    v_mfma_f32_16x16x32_bf16 v[24:27], v[80:83], v[188:191], 0
    v_mfma_f32_16x16x32_bf16 v[28:31], v[80:83], v[204:207], 0
    s_waitcnt lgkmcnt(6)
    v_mfma_f32_16x16x32_bf16 v[24:27], v[84:87], v[192:195], v[24:27]
    v_mfma_f32_16x16x32_bf16 v[28:31], v[84:87], v[208:211], v[28:31]
    s_waitcnt lgkmcnt(5)
    v_mfma_f32_16x16x32_bf16 v[24:27], v[88:91], v[196:199], v[24:27]
    v_mfma_f32_16x16x32_bf16 v[28:31], v[88:91], v[212:215], v[28:31]
    s_waitcnt lgkmcnt(4)
    v_mfma_f32_16x16x32_bf16 v[24:27], v[92:95], v[200:203], v[24:27]
    v_mfma_f32_16x16x32_bf16 v[28:31], v[92:95], v[216:219], v[28:31]
    v_cvt_pk_bf16_f32 v128, v16, v17
    v_cvt_pk_bf16_f32 v129, v18, v19
    v_cvt_pk_bf16_f32 v130, v20, v21
    v_cvt_pk_bf16_f32 v131, v22, v23
    buffer_store_dwordx4 v[128:131], v11, s[20:23], 0 offen sc0 sc1
    v_add_u32 v11, 1048576, v11
    ds_read_b128 v[80:83], v8 offset:13824
    ds_read_b128 v[84:87], v8 offset:13888
    ds_read_b128 v[88:91], v8 offset:13952
    ds_read_b128 v[92:95], v8 offset:14016
    s_waitcnt lgkmcnt(7)
    v_mfma_f32_16x16x32_bf16 v[32:35], v[64:67], v[188:191], 0
    v_mfma_f32_16x16x32_bf16 v[36:39], v[64:67], v[204:207], 0
    s_waitcnt lgkmcnt(6)
    v_mfma_f32_16x16x32_bf16 v[32:35], v[68:71], v[192:195], v[32:35]
    v_mfma_f32_16x16x32_bf16 v[36:39], v[68:71], v[208:211], v[36:39]
    s_waitcnt lgkmcnt(5)
    v_mfma_f32_16x16x32_bf16 v[32:35], v[72:75], v[196:199], v[32:35]
    v_mfma_f32_16x16x32_bf16 v[36:39], v[72:75], v[212:215], v[36:39]
    s_waitcnt lgkmcnt(4)
    v_mfma_f32_16x16x32_bf16 v[32:35], v[76:79], v[200:203], v[32:35]
    v_mfma_f32_16x16x32_bf16 v[36:39], v[76:79], v[216:219], v[36:39]
    v_cvt_pk_bf16_f32 v132, v24, v25
    v_cvt_pk_bf16_f32 v133, v26, v27
    v_cvt_pk_bf16_f32 v134, v28, v29
    v_cvt_pk_bf16_f32 v135, v30, v31
    buffer_store_dwordx4 v[132:135], v11, s[20:23], 0 offen sc0 sc1
    v_add_u32 v11, 1048576, v11
    ds_read_b128 v[64:67], v8 offset:18432
    ds_read_b128 v[68:71], v8 offset:18496
    ds_read_b128 v[72:75], v8 offset:18560
    ds_read_b128 v[76:79], v8 offset:18624
    s_waitcnt lgkmcnt(7)
    v_mfma_f32_16x16x32_bf16 v[40:43], v[80:83], v[188:191], 0
    v_mfma_f32_16x16x32_bf16 v[44:47], v[80:83], v[204:207], 0
    s_waitcnt lgkmcnt(6)
    v_mfma_f32_16x16x32_bf16 v[40:43], v[84:87], v[192:195], v[40:43]
    v_mfma_f32_16x16x32_bf16 v[44:47], v[84:87], v[208:211], v[44:47]
    s_waitcnt lgkmcnt(5)
    v_mfma_f32_16x16x32_bf16 v[40:43], v[88:91], v[196:199], v[40:43]
    v_mfma_f32_16x16x32_bf16 v[44:47], v[88:91], v[212:215], v[44:47]
    s_waitcnt lgkmcnt(4)
    v_mfma_f32_16x16x32_bf16 v[40:43], v[92:95], v[200:203], v[40:43]
    v_mfma_f32_16x16x32_bf16 v[44:47], v[92:95], v[216:219], v[44:47]
    v_cvt_pk_bf16_f32 v128, v32, v33
    v_cvt_pk_bf16_f32 v129, v34, v35
    v_cvt_pk_bf16_f32 v130, v36, v37
    v_cvt_pk_bf16_f32 v131, v38, v39
    buffer_store_dwordx4 v[128:131], v11, s[20:23], 0 offen sc0 sc1
    v_add_u32 v11, 1048576, v11
    s_waitcnt lgkmcnt(3)
    v_mfma_f32_16x16x32_bf16 v[48:51], v[64:67], v[188:191], 0
    v_mfma_f32_16x16x32_bf16 v[52:55], v[64:67], v[204:207], 0
    s_waitcnt lgkmcnt(2)
    v_mfma_f32_16x16x32_bf16 v[48:51], v[68:71], v[192:195], v[48:51]
    v_mfma_f32_16x16x32_bf16 v[52:55], v[68:71], v[208:211], v[52:55]
    s_waitcnt lgkmcnt(1)
    v_mfma_f32_16x16x32_bf16 v[48:51], v[72:75], v[196:199], v[48:51]
    v_mfma_f32_16x16x32_bf16 v[52:55], v[72:75], v[212:215], v[52:55]
    s_waitcnt lgkmcnt(0)
    v_mfma_f32_16x16x32_bf16 v[48:51], v[76:79], v[200:203], v[48:51]
    v_mfma_f32_16x16x32_bf16 v[52:55], v[76:79], v[216:219], v[52:55]
    v_cvt_pk_bf16_f32 v132, v40, v41
    v_cvt_pk_bf16_f32 v133, v42, v43
    v_cvt_pk_bf16_f32 v134, v44, v45
    v_cvt_pk_bf16_f32 v135, v46, v47
    buffer_store_dwordx4 v[132:135], v11, s[20:23], 0 offen sc0 sc1
    v_add_u32 v11, 1048576, v11
    s_nop 7
    v_cvt_pk_bf16_f32 v128, v48, v49
    v_cvt_pk_bf16_f32 v129, v50, v51
    v_cvt_pk_bf16_f32 v130, v52, v53
    v_cvt_pk_bf16_f32 v131, v54, v55
    buffer_store_dwordx4 v[128:131], v11, s[20:23], 0 offen sc0 sc1
END:
    s_endpgm
.section .rodata,"a"
.p2align 6
.amdhsa_kernel gather_scatter__tensor_product_equiv_tfn__graph_kernel
  .amdhsa_next_free_vgpr 220
  .amdhsa_next_free_sgpr 66
  .amdhsa_accum_offset 220
  .amdhsa_group_segment_fixed_size 0
  .amdhsa_kernarg_size 88
  .amdhsa_user_sgpr_count 2
  .amdhsa_user_sgpr_kernarg_segment_ptr 1
  .amdhsa_system_sgpr_workgroup_id_x 1
  .amdhsa_float_denorm_mode_32 3
.end_amdhsa_kernel
```

```asm
; @launch grid=(256,1,1) block=(512,1,1) lds=163840
.amdgcn_target "amdgcn-amd-amdhsa--gfx950"
.text
.globl gather_scatter__tensor_product_equiv_tfn__graph_kernel
.p2align 8
.type gather_scatter__tensor_product_equiv_tfn__graph_kernel,@function
gather_scatter__tensor_product_equiv_tfn__graph_kernel:
    s_cmp_ge_u32 s2, 256
    s_cbranch_scc1 END
    s_load_dwordx16 s[40:55], s[0:1], 0
    s_load_dwordx2 s[16:17], s[0:1], 80
    s_load_dwordx2 s[12:13], s[0:1], 0
    s_load_dwordx2 s[20:21], s[0:1], 64
    s_getpc_b64 s[6:7]
CODE_HERE:
    v_lshrrev_b32 v8, 6, v0
    s_lshr_b32 s5, s2, 3
    s_lshl_b32 s4, s5, 10
    v_readfirstlane_b32 s25, v8
    v_and_b32 v10, 7, v0
    v_lshl_add_u32 v10, v10, 7, s4
    v_min_u32 v10, END-CODE_HERE, v10
    s_cmp_lg_u32 s25, 7
    s_cbranch_scc1 NO_CODE_TOUCH
    global_load_dword v167, v10, s[6:7]
NO_CODE_TOUCH:
    s_mul_i32 s3, s2, 5120
    v_lshl_add_u32 v8, v0, 4, s3
    v_and_b32 v10, 63, v0
    v_lshlrev_b32 v1, 4, v10
    v_lshlrev_b32 v193, 2, v10
    s_cmp_ge_u32 s25, 5
    s_cselect_b32 s3, 250, s2
    s_cmp_ge_u32 s3, 250
    s_waitcnt lgkmcnt(0)
    s_cbranch_scc1 NO_EDGES
    s_setprio 1
    global_load_dwordx4 v[64:67], v8, s[44:45]
    global_load_dwordx4 v[68:71], v8, s[42:43]
NO_EDGES:
    global_load_dword v188, v193, s[50:51] offset:0
    global_load_dword v189, v193, s[50:51] offset:256
    global_load_dword v190, v193, s[50:51] offset:512
    global_load_dword v191, v193, s[50:51] offset:768
    v_and_b32 v193, 0x7f, v193
    global_load_dword v192, v193, s[52:53]
    v_lshlrev_b32 v9, 1, v8
    v_lshlrev_b32 v11, 3, v0
    v_mov_b32 v12, 0
    v_mov_b32 v13, 0
    ds_write_b64 v11, v[12:13]
    s_and_b32 s4, s2, 7
    s_lshl_b32 s4, s4, 5
    s_lshr_b32 s5, s2, 3
    s_or_b32 s24, s4, s5
    v_mov_b32 v15, 1
    s_mov_b32 s14, 10240000
    s_mov_b32 s15, 0x20000
    s_mov_b32 s18, 8650880
    s_mov_b32 s19, 0x20000
    s_mov_b32 s22, 10240000
    s_mov_b32 s23, 0x20000
    s_mov_b32 s34, 0xfffffc00
    s_mov_b32 s27, 0
    s_mov_b32 s10, 0xbfb8aa3b
    s_mov_b32 s11, 0xbfb8aa3b
    v_mul_u32_u24 v14, 52, v10
    v_lshrrev_b32 v14, 8, v14
    v_mul_u32_u24 v7, 5, v14
    v_sub_u32 v7, v10, v7
    v_lshlrev_b32 v14, 2, v14
    v_lshlrev_b32 v7, 2, v7
    s_mov_b32 s35, 2097152
    v_and_b32 v4, 0xff, v0
    s_lshl_b32 s3, s24, 3
    s_add_u32 s3, s3, 7864320
    v_lshl_add_u32 v6, v4, 11, s3
    s_and_b32 s3, s2, 7
    s_lshl_b32 s3, s3, 7
    s_add_u32 s3, s3, 8388608
    s_lshl_b32 s8, s25, 15
    s_add_u32 s3, s3, s8
    v_and_b32 v166, 31, v0
    v_lshl_add_u32 v166, v166, 10, s3
    v_mul_u32_u24 v4, 1280, v4
    v_mul_u32_u24 v138, 0x8000, v1
    v_lshl_add_u32 v138, v10, 3, v138
    v_pk_mov_b32 v[16:17], v[12:13], v[12:13]
    v_pk_mov_b32 v[18:19], v[12:13], v[12:13]
    v_pk_mov_b32 v[20:21], v[12:13], v[12:13]
    v_pk_mov_b32 v[22:23], v[12:13], v[12:13]
    v_pk_mov_b32 v[24:25], v[12:13], v[12:13]
    v_pk_mov_b32 v[26:27], v[12:13], v[12:13]
    v_pk_mov_b32 v[28:29], v[12:13], v[12:13]
    v_pk_mov_b32 v[30:31], v[12:13], v[12:13]
    v_pk_mov_b32 v[32:33], v[12:13], v[12:13]
    v_pk_mov_b32 v[34:35], v[12:13], v[12:13]
    v_pk_mov_b32 v[36:37], v[12:13], v[12:13]
    v_pk_mov_b32 v[38:39], v[12:13], v[12:13]
    v_pk_mov_b32 v[40:41], v[12:13], v[12:13]
    v_pk_mov_b32 v[42:43], v[12:13], v[12:13]
    v_pk_mov_b32 v[44:45], v[12:13], v[12:13]
    v_pk_mov_b32 v[46:47], v[12:13], v[12:13]
    v_pk_mov_b32 v[48:49], v[12:13], v[12:13]
    v_pk_mov_b32 v[50:51], v[12:13], v[12:13]
    v_pk_mov_b32 v[52:53], v[12:13], v[12:13]
    v_pk_mov_b32 v[54:55], v[12:13], v[12:13]
    v_pk_mov_b32 v[56:57], v[12:13], v[12:13]
    v_pk_mov_b32 v[58:59], v[12:13], v[12:13]
    v_pk_mov_b32 v[60:61], v[12:13], v[12:13]
    v_pk_mov_b32 v[62:63], v[12:13], v[12:13]
    s_waitcnt lgkmcnt(0)
    s_add_u32 s4, s16, 8650752
    s_addc_u32 s5, s17, 0
    s_load_dwordx2 s[64:65], s[4:5], 0
    s_barrier
    s_cmp_ge_u32 s25, 5
    s_cbranch_scc1 HELP
    s_add_u32 s62, s25, 1
LUTP_W0L:
    s_mul_i32 s3, s62, 33554944
    s_add_u32 s3, s3, 4286709632
    v_add_u32 v128, s3, v138
    s_lshl_b32 s3, s62, 10
    v_add_u32 v136, s3, v1
    v_add_u32 v129, 131074, v128
    v_add_u32 v130, 262148, v128
    v_add_u32 v131, 393222, v128
    v_add_u32 v137, 0x10000, v136
    v_or_b32 v132, 0x80008000, v128
    v_or_b32 v133, 0x80008000, v129
    v_or_b32 v134, 0x80008000, v130
    v_or_b32 v135, 0x80008000, v131
    ds_write_b128 v136, v[128:131] offset:32768
    ds_write_b128 v137, v[132:135] offset:32768
    s_add_u32 s62, s62, 5
    s_cmp_le_u32 s62, 5
    s_cbranch_scc1 LUTP_W0L
LUTP_END_W0:
    s_cmp_ge_u32 s2, 250
    s_cbranch_scc1 AUX_LOAD
    global_load_dwordx4 v[72:75], v9, s[46:47]
    global_load_dwordx4 v[76:79], v9, s[46:47] offset:16
    global_load_dwordx4 v[80:83], v9, s[48:49]
    global_load_dwordx4 v[84:87], v9, s[48:49] offset:16
LOADED:
    s_cmp_ge_u32 s2, 250
    s_cbranch_scc1 AUX
    s_waitcnt vmcnt(10)
    v_and_b32 v88, 0xff, v64
    v_lshlrev_b32 v88, 2, v88
    ds_add_rtn_u32 v92, v88, v15 offset:2304
    v_and_b32 v89, 0xff, v65
    v_lshlrev_b32 v89, 2, v89
    ds_add_rtn_u32 v93, v89, v15 offset:2304
    v_and_b32 v90, 0xff, v66
    v_lshlrev_b32 v90, 2, v90
    ds_add_rtn_u32 v94, v90, v15 offset:2304
    v_and_b32 v91, 0xff, v67
    v_lshlrev_b32 v91, 2, v91
    ds_add_rtn_u32 v95, v91, v15 offset:2304
    s_waitcnt vmcnt(9)
    v_lshrrev_b32 v64, 8, v64
    v_lshl_or_b32 v108, v68, 10, v64
    v_lshrrev_b32 v65, 8, v65
    v_lshl_or_b32 v110, v69, 10, v65
    v_lshrrev_b32 v66, 8, v66
    v_lshl_or_b32 v112, v70, 10, v66
    v_lshrrev_b32 v67, 8, v67
    v_lshl_or_b32 v114, v71, 10, v67
    s_mov_b32 s9, 87040
    s_waitcnt lgkmcnt(0)
    s_barrier
    ds_read_b128 v[96:99], v1 offset:2304
    s_add_u32 s64, s64, 1
    s_and_b32 s65, s65, 0x3ff
    v_mov_b32 v109, s64
    v_mov_b32 v111, s64
    v_mov_b32 v113, s64
    v_mov_b32 v115, s64
    s_waitcnt lgkmcnt(0)
    v_add_u32 v10, v96, v97
    v_add3_u32 v10, v10, v98, v99
    v_mov_b32 v11, v10
    s_nop 1
    v_add_u32_dpp v11, v11, v11 row_shr:1 row_mask:0xf bank_mask:0xf bound_ctrl:0
    s_nop 1
    v_add_u32_dpp v11, v11, v11 row_shr:2 row_mask:0xf bank_mask:0xf bound_ctrl:0
    s_nop 1
    v_add_u32_dpp v11, v11, v11 row_shr:4 row_mask:0xf bank_mask:0xf bound_ctrl:0
    s_nop 1
    v_add_u32_dpp v11, v11, v11 row_shr:8 row_mask:0xf bank_mask:0xf bound_ctrl:0
    s_nop 1
    v_add_u32_dpp v11, v11, v11 row_bcast:15 row_mask:0xa bank_mask:0xf
    s_nop 1
    v_add_u32_dpp v11, v11, v11 row_bcast:31 row_mask:0xc bank_mask:0xf
    v_sub_u32 v100, v11, v10
    v_add_u32 v101, v100, v96
    v_add_u32 v102, v101, v97
    v_add_u32 v103, v102, v98
    ds_write_b128 v1, v[100:103] offset:3328
    ds_read_b32 v96, v88 offset:3328
    ds_read_b32 v97, v89 offset:3328
    ds_read_b32 v98, v90 offset:3328
    ds_read_b32 v99, v91 offset:3328
    s_waitcnt lgkmcnt(3)
    v_add_u32 v92, v92, v96
    v_lshl_add_u32 v88, v92, 3, s9
    ds_write_b64 v88, v[108:109]
    s_waitcnt lgkmcnt(3)
    v_add_u32 v93, v93, v97
    v_lshl_add_u32 v89, v93, 3, s9
    ds_write_b64 v89, v[110:111]
    s_waitcnt lgkmcnt(3)
    v_add_u32 v94, v94, v98
    v_lshl_add_u32 v90, v94, 3, s9
    ds_write_b64 v90, v[112:113]
    s_waitcnt lgkmcnt(3)
    v_add_u32 v95, v95, v99
    v_lshl_add_u32 v91, v95, 3, s9
    ds_write_b64 v91, v[114:115]
    v_lshlrev_b32 v92, 4, v92
    v_add_u32 v92, 4352, v92
    v_lshlrev_b32 v93, 4, v93
    v_add_u32 v93, 4352, v93
    v_lshlrev_b32 v94, 4, v94
    v_add_u32 v94, 4352, v94
    v_lshlrev_b32 v95, 4, v95
    v_add_u32 v95, 4352, v95
    s_waitcnt lgkmcnt(0)
    s_barrier
    s_waitcnt vmcnt(0)
    ds_write2_b64 v92, v[72:73], v[80:81] offset0:0 offset1:1
    ds_write2_b64 v93, v[74:75], v[82:83] offset0:0 offset1:1
    ds_write2_b64 v94, v[76:77], v[84:85] offset0:0 offset1:1
    ds_write2_b64 v95, v[78:79], v[86:87] offset0:0 offset1:1
BINNED:
    s_setprio 0
    s_call_b64 s[6:7], CONST_SUB
    s_cmp_gt_u32 s62, 20
    s_cbranch_scc1 LUTP_END_W1
LUTP_W1L:
    s_mul_i32 s3, s62, 33554944
    s_add_u32 s3, s3, 4286709632
    v_add_u32 v128, s3, v138
    s_lshl_b32 s3, s62, 10
    v_add_u32 v136, s3, v1
    v_add_u32 v129, 131074, v128
    v_add_u32 v130, 262148, v128
    v_add_u32 v131, 393222, v128
    v_add_u32 v137, 0x10000, v136
    v_or_b32 v132, 0x80008000, v128
    v_or_b32 v133, 0x80008000, v129
    v_or_b32 v134, 0x80008000, v130
    v_or_b32 v135, 0x80008000, v131
    ds_write_b128 v136, v[128:131] offset:32768
    ds_write_b128 v137, v[132:135] offset:32768
    s_add_u32 s62, s62, 5
    s_cmp_le_u32 s62, 20
    s_cbranch_scc1 LUTP_W1L
LUTP_END_W1:
    v_mov_b32 v2, 0
    s_cmp_eq_u32 s25, 4
    s_cbranch_scc1 NO_TAB
    buffer_load_dwordx2 v[2:3], v6, s[16:19], 0 offen sc1
NO_TAB:
    s_waitcnt lgkmcnt(0)
    s_barrier
    s_cmp_gt_u32 s62, 24
    s_cbranch_scc1 LUTP_END_W
LUTP_WL:
    s_mul_i32 s3, s62, 33554944
    s_add_u32 s3, s3, 4286709632
    v_add_u32 v128, s3, v138
    s_lshl_b32 s3, s62, 10
    v_add_u32 v136, s3, v1
    v_add_u32 v129, 131074, v128
    v_add_u32 v130, 262148, v128
    v_add_u32 v131, 393222, v128
    v_add_u32 v137, 0x10000, v136
    v_or_b32 v132, 0x80008000, v128
    v_or_b32 v133, 0x80008000, v129
    v_or_b32 v134, 0x80008000, v130
    v_or_b32 v135, 0x80008000, v131
    ds_write_b128 v136, v[128:131] offset:32768
    ds_write_b128 v137, v[132:135] offset:32768
    s_add_u32 s62, s62, 5
    s_cmp_le_u32 s62, 24
    s_cbranch_scc1 LUTP_WL
LUTP_END_W:
    s_cmp_eq_u32 s25, 4
    s_cbranch_scc1 WAVE4
    s_add_u32 s62, s25, 34
    v_mov_b32 v132, 0x80008000
    v_mov_b32 v133, 0x80008000
    v_mov_b32 v134, 0x80008000
    v_mov_b32 v135, 0x80008000
LUTP_VH:
    s_mul_i32 s3, s62, 33554944
    s_add_u32 s3, s3, 131072
    v_add_u32 v128, s3, v138
    s_lshl_b32 s3, s62, 10
    v_add_u32 v136, s3, v1
    v_add_u32 v129, 131074, v128
    v_add_u32 v130, 262148, v128
    v_add_u32 v131, 393222, v128
    v_add_u32 v137, 0x10000, v136
    ds_write_b128 v136, v[128:131] offset:32768
    ds_write_b128 v137, v[132:135] offset:32768
    s_add_u32 s62, s62, 4
    s_cmp_le_u32 s62, 62
    s_cbranch_scc1 LUTP_VH
LUTP_END_V:
POLL_TAB:
    s_waitcnt vmcnt(0)
CHECK_TAB:
    v_lshrrev_b32 v11, 22, v2
    v_cmp_ne_u32 vcc, s64, v3
    v_cmp_ne_u32 s[42:43], s65, v11
    s_or_b64 vcc, vcc, s[42:43]
    s_and_b64 exec, exec, vcc
    s_cbranch_execz POLLED_TAB
    s_sub_u32 s35, s35, 1
    s_cbranch_scc1 END
    buffer_load_dwordx2 v[2:3], v6, s[16:19], 0 offen sc1
    s_branch POLL_TAB
POLLED_TAB:
    s_mov_b64 exec, -1
    s_branch TAB_DONE
LUT_SUB:
    s_lshl_b32 s3, s62, 25
    s_add_u32 s3, s3, 0x8000
    v_lshl_add_u32 v128, v1, 15, s3
    v_add_u32 v129, 0x10000, v128
    v_add_u32 v130, 0x10000, v129
    v_add_u32 v131, 0x10000, v130
    v_add_u32 v132, 0x10000, v131
    v_add_u32 v133, 0x10000, v132
    v_add_u32 v134, 0x10000, v133
    v_add_u32 v135, 0x10000, v134
    v_pk_mul_f32 v[136:137], v[128:129], s[10:11]
    v_pk_mul_f32 v[138:139], v[130:131], s[10:11]
    v_pk_mul_f32 v[140:141], v[132:133], s[10:11]
    v_pk_mul_f32 v[142:143], v[134:135], s[10:11]
    v_exp_f32 v136, v136
    v_exp_f32 v137, v137
    v_exp_f32 v138, v138
    v_exp_f32 v139, v139
    v_exp_f32 v140, v140
    v_exp_f32 v141, v141
    v_exp_f32 v142, v142
    v_exp_f32 v143, v143
    s_lshl_b32 s3, s62, 10
    v_pk_add_f32 v[144:145], v[136:137], 1.0 op_sel_hi:[1,0]
    v_pk_add_f32 v[146:147], v[138:139], 1.0 op_sel_hi:[1,0]
    v_pk_add_f32 v[148:149], v[140:141], 1.0 op_sel_hi:[1,0]
    v_pk_add_f32 v[150:151], v[142:143], 1.0 op_sel_hi:[1,0]
    v_rcp_f32 v144, v144
    v_rcp_f32 v145, v145
    v_rcp_f32 v146, v146
    v_rcp_f32 v147, v147
    v_rcp_f32 v148, v148
    v_rcp_f32 v149, v149
    v_rcp_f32 v150, v150
    v_rcp_f32 v151, v151
    v_add_u32 v160, s3, v1
    v_pk_mul_f32 v[128:129], v[128:129], v[144:145]
    v_pk_mul_f32 v[130:131], v[130:131], v[146:147]
    v_pk_mul_f32 v[132:133], v[132:133], v[148:149]
    v_pk_mul_f32 v[134:135], v[134:135], v[150:151]
    v_add_u32 v161, 0x10000, v160
    v_pk_mul_f32 v[136:137], v[128:129], v[136:137] neg_lo:[1,0] neg_hi:[1,0]
    v_pk_mul_f32 v[138:139], v[130:131], v[138:139] neg_lo:[1,0] neg_hi:[1,0]
    v_pk_mul_f32 v[140:141], v[132:133], v[140:141] neg_lo:[1,0] neg_hi:[1,0]
    v_pk_mul_f32 v[142:143], v[134:135], v[142:143] neg_lo:[1,0] neg_hi:[1,0]
    v_cvt_pk_bf16_f32 v152, v128, v129
    v_cvt_pk_bf16_f32 v153, v130, v131
    v_cvt_pk_bf16_f32 v154, v132, v133
    v_cvt_pk_bf16_f32 v155, v134, v135
    v_cvt_pk_bf16_f32 v156, v136, v137
    v_cvt_pk_bf16_f32 v157, v138, v139
    v_cvt_pk_bf16_f32 v158, v140, v141
    v_cvt_pk_bf16_f32 v159, v142, v143
    ds_write_b128 v160, v[152:155] offset:32768
    ds_write_b128 v161, v[156:159] offset:32768
    s_add_u32 s62, s62, 1
    s_sub_u32 s63, s63, 1
    s_cmp_lg_u32 s63, 0
    s_cbranch_scc1 LUT_SUB
    s_setpc_b64 s[6:7]
CONST_SUB:
    ds_write_b32 v193, v192 offset:31744
    v_lshrrev_b32 v193, 3, v1
    v_and_b32 v193, 24, v193
    s_mov_b32 s4, 0x05040100
    s_mov_b32 s5, 0x07060302
    ds_read_b64_tr_b16 v[180:181], v193 offset:31744
    ds_read_b64_tr_b16 v[182:183], v193 offset:31776
    ds_read_b64_tr_b16 v[184:185], v193 offset:31808
    ds_read_b64_tr_b16 v[186:187], v193 offset:31840
    v_perm_b32 v176, v189, v188, s4
    v_perm_b32 v178, v189, v188, s5
    v_perm_b32 v177, v191, v190, s4
    v_perm_b32 v179, v191, v190, s5
    s_setpc_b64 s[6:7]
HELP:
    s_cmp_eq_u32 s25, 6
    s_cselect_b32 s62, 25, 0
    s_cmp_eq_u32 s25, 7
    s_cselect_b32 s62, 63, s62
    s_mov_b32 s63, 1
    s_call_b64 s[6:7], LUT_SUB
    v_mov_b32 v10, 65280
    v_mov_b32 v11, 0x7f80
    s_cmp_lg_u32 s25, 7
    s_cbranch_scc1 NO_INF
    ds_write_b16 v10, v11 offset:32768
NO_INF:
    s_waitcnt vmcnt(0)
    s_call_b64 s[6:7], CONST_SUB
    s_sub_u32 s8, s25, 5
    s_mul_i32 s4, s8, 3072
    s_cmp_eq_u32 s8, 1
    s_cselect_b32 s4, 4096, s4
    s_mul_i32 s3, s2, 10240
    s_add_u32 s3, s3, s4
    v_add_u32 v8, s3, v1
    s_add_u32 s4, s4, 87040
    v_add_u32 v9, s4, v1
    s_mul_i32 s4, s8, 7168
    s_mul_i32 s3, s2, 20480
    s_add_u32 s3, s3, s4
    s_add_u32 s3, s3, 2621440
    v_add_u32 v12, s3, v1
    v_add_u32 v13, s4, v1
    s_waitcnt lgkmcnt(0)
    s_add_u32 s64, s64, 1
    s_and_b32 s65, s65, 0x3ff
    s_barrier
    s_cmp_lg_u32 s25, 6
    s_cbranch_scc1 NO_ROW
    v_lshrrev_b32 v117, 1, v1
    ds_read_b64 v[96:97], v117 offset:2304
    ds_read_b64 v[98:99], v117 offset:2816
    s_lshl_b32 s3, s2, 11
    s_add_u32 s3, s3, 7864320
    v_add_u32 v116, s3, v1
    s_lshl_b32 s3, s65, 22
    s_waitcnt lgkmcnt(0)
    v_add_u32 v10, v96, v97
    v_add_u32 v11, v98, v99
    v_mov_b32 v100, v10
    v_mov_b32 v102, v11
    s_nop 0
    v_add_u32_dpp v100, v100, v100 row_shr:1 row_mask:0xf bank_mask:0xf bound_ctrl:0
    v_add_u32_dpp v102, v102, v102 row_shr:1 row_mask:0xf bank_mask:0xf bound_ctrl:0
    s_nop 0
    v_add_u32_dpp v100, v100, v100 row_shr:2 row_mask:0xf bank_mask:0xf bound_ctrl:0
    v_add_u32_dpp v102, v102, v102 row_shr:2 row_mask:0xf bank_mask:0xf bound_ctrl:0
    s_nop 0
    v_add_u32_dpp v100, v100, v100 row_shr:4 row_mask:0xf bank_mask:0xf bound_ctrl:0
    v_add_u32_dpp v102, v102, v102 row_shr:4 row_mask:0xf bank_mask:0xf bound_ctrl:0
    s_nop 0
    v_add_u32_dpp v100, v100, v100 row_shr:8 row_mask:0xf bank_mask:0xf bound_ctrl:0
    v_add_u32_dpp v102, v102, v102 row_shr:8 row_mask:0xf bank_mask:0xf bound_ctrl:0
    s_nop 0
    v_add_u32_dpp v100, v100, v100 row_bcast:15 row_mask:0xa bank_mask:0xf
    v_add_u32_dpp v102, v102, v102 row_bcast:15 row_mask:0xa bank_mask:0xf
    s_nop 0
    v_add_u32_dpp v100, v100, v100 row_bcast:31 row_mask:0xc bank_mask:0xf
    v_add_u32_dpp v102, v102, v102 row_bcast:31 row_mask:0xc bank_mask:0xf
    v_sub_u32 v102, v102, v11
    v_readlane_b32 s4, v100, 63
    v_sub_u32 v100, v100, v10
    v_add_u32 v101, v100, v96
    v_add_u32 v102, s4, v102
    v_add_u32 v103, v102, v98
    v_lshl_or_b32 v108, v96, 11, v100
    v_or_b32 v108, s3, v108
    v_mov_b32 v109, s64
    v_lshl_or_b32 v110, v97, 11, v101
    v_or_b32 v110, s3, v110
    v_mov_b32 v111, s64
    v_lshl_or_b32 v112, v98, 11, v102
    v_or_b32 v112, s3, v112
    v_mov_b32 v113, s64
    v_lshl_or_b32 v114, v99, 11, v103
    v_or_b32 v114, s3, v114
    v_mov_b32 v115, s64
    global_store_dwordx4 v116, v[108:111], s[16:17] sc0 sc1
    global_store_dwordx4 v116, v[112:115], s[16:17] offset:1024 sc0 sc1
NO_ROW:
    s_barrier
    ds_read_b128 v[64:67], v9 offset:0
    ds_read_b128 v[68:71], v9 offset:1024
    ds_read_b128 v[72:75], v9 offset:2048
    ds_read_b128 v[76:79], v9 offset:3072
    s_waitcnt lgkmcnt(3)
    global_store_dwordx4 v8, v[64:67], s[16:17] offset:0 sc0 sc1
    s_waitcnt lgkmcnt(2)
    global_store_dwordx4 v8, v[68:71], s[16:17] offset:1024 sc0 sc1
    s_cmp_eq_u32 s8, 1
    s_cbranch_scc1 KEYS_STORED
    s_waitcnt lgkmcnt(1)
    global_store_dwordx4 v8, v[72:75], s[16:17] offset:2048 sc0 sc1
    s_waitcnt lgkmcnt(0)
    global_store_dwordx4 v8, v[76:79], s[16:17] offset:3072 sc0 sc1
KEYS_STORED:
    v_mov_b32 v2, 0
    s_waitcnt lgkmcnt(0)
    s_barrier
    s_cmp_ge_u32 s2, 250
    s_cbranch_scc1 TAB_DONE
    ds_read_b128 v[84:87], v13 offset:4352
    ds_read_b128 v[88:91], v13 offset:5376
    ds_read_b128 v[92:95], v13 offset:6400
    ds_read_b128 v[96:99], v13 offset:7424
    ds_read_b128 v[100:103], v13 offset:8448
    ds_read_b128 v[104:107], v13 offset:9472
    ds_read_b128 v[108:111], v13 offset:10496
    s_waitcnt lgkmcnt(6)
    global_store_dwordx4 v12, v[84:87], s[16:17] offset:0 sc0 sc1
    s_waitcnt lgkmcnt(5)
    global_store_dwordx4 v12, v[88:91], s[16:17] offset:1024 sc0 sc1
    s_waitcnt lgkmcnt(4)
    global_store_dwordx4 v12, v[92:95], s[16:17] offset:2048 sc0 sc1
    s_waitcnt lgkmcnt(3)
    global_store_dwordx4 v12, v[96:99], s[16:17] offset:3072 sc0 sc1
    v_add_u32 v12, 4096, v12
    s_waitcnt lgkmcnt(2)
    global_store_dwordx4 v12, v[100:103], s[16:17] offset:0 sc0 sc1
    s_waitcnt lgkmcnt(1)
    global_store_dwordx4 v12, v[104:107], s[16:17] offset:1024 sc0 sc1
    s_cmp_eq_u32 s8, 2
    s_cbranch_scc1 TAB_DONE
    s_waitcnt lgkmcnt(0)
    global_store_dwordx4 v12, v[108:111], s[16:17] offset:2048 sc0 sc1
    s_branch TAB_DONE
AUX_LOAD:
    s_cmp_ge_u32 s2, 254
    s_cbranch_scc1 LOADED
    s_cmp_ge_u32 s25, 4
    s_cbranch_scc1 LOADED
    s_sub_u32 s4, s2, 250
    s_lshl_b32 s5, s25, 13
    s_lshl_b32 s8, s4, 6
    s_add_u32 s5, s5, s8
    v_lshrrev_b32 v9, 8, v1
    v_lshlrev_b32 v9, 11, v9
    v_bfe_u32 v10, v1, 4, 4
    v_lshl_add_u32 v9, v10, 2, v9
    v_add_u32 v9, s5, v9
    s_lshl_b32 s5, s4, 13
    s_lshl_b32 s8, s25, 10
    s_add_u32 s5, s5, s8
    s_add_u32 s5, s5, 7802880
    v_add_u32 v10, s5, v1
    global_load_dword v64, v9, s[54:55] offset:0
    global_load_dword v65, v9, s[54:55] offset:256
    global_load_dword v66, v9, s[54:55] offset:512
    global_load_dword v67, v9, s[54:55] offset:768
    global_load_dword v68, v9, s[54:55] offset:1024
    global_load_dword v69, v9, s[54:55] offset:1280
    global_load_dword v70, v9, s[54:55] offset:1536
    global_load_dword v71, v9, s[54:55] offset:1792
    s_branch LOADED
AUX:
    s_waitcnt lgkmcnt(0)
    s_add_u32 s64, s64, 1
    s_and_b32 s65, s65, 0x3ff
    s_barrier
    s_cmp_ge_u32 s2, 254
    s_cbranch_scc1 AUX_DONE
    s_cmp_ge_u32 s25, 4
    s_cbranch_scc1 AUX_DONE
    s_mov_b32 s4, 0x05040100
    s_mov_b32 s5, 0x07060302
    s_waitcnt vmcnt(0)
    v_perm_b32 v72, v65, v64, s4
    v_perm_b32 v76, v65, v64, s5
    v_perm_b32 v73, v67, v66, s4
    v_perm_b32 v77, v67, v66, s5
    v_perm_b32 v74, v69, v68, s4
    v_perm_b32 v78, v69, v68, s5
    v_perm_b32 v75, v71, v70, s4
    v_perm_b32 v79, v71, v70, s5
    global_store_dwordx4 v10, v[72:75], s[16:17] sc0 sc1
    v_add_u32 v10, 4096, v10
    global_store_dwordx4 v10, v[76:79], s[16:17] sc0 sc1
AUX_DONE:
    s_barrier
    s_waitcnt vmcnt(0)
    s_branch BINNED
WAVE4:
    s_mov_b32 s62, 26
    s_mov_b32 s63, 2
    s_call_b64 s[6:7], LUT_SUB
TAB_DONE:
    s_cmp_ge_u32 s25, 4
    s_cbranch_scc1 NOT_POLLER
    v_and_b32 v13, 0x7ff, v2
    v_bfe_u32 v2, v2, 11, 11
    v_add_u32 v4, v4, v13
    v_mov_b32 v3, v2
    v_lshlrev_b32 v10, 3, v4
    buffer_load_dword v167, v10, s[16:19], 0 offen sc1
    s_nop 1
    v_add_u32_dpp v3, v3, v3 row_shr:1 row_mask:0xf bank_mask:0xf bound_ctrl:0
    s_nop 1
    v_add_u32_dpp v3, v3, v3 row_shr:2 row_mask:0xf bank_mask:0xf bound_ctrl:0
    s_nop 1
    v_add_u32_dpp v3, v3, v3 row_shr:4 row_mask:0xf bank_mask:0xf bound_ctrl:0
    s_nop 1
    v_add_u32_dpp v3, v3, v3 row_shr:8 row_mask:0xf bank_mask:0xf bound_ctrl:0
    s_nop 1
    v_add_u32_dpp v3, v3, v3 row_bcast:15 row_mask:0xa bank_mask:0xf
    s_nop 1
    v_add_u32_dpp v3, v3, v3 row_bcast:31 row_mask:0xc bank_mask:0xf
    s_lshl_b32 s3, s25, 2
    v_mov_b32 v10, s3
    v_add_u32 v11, 1, v3
    v_sub_u32 v3, v3, v2
    s_mov_b32 exec_lo, 0
    s_mov_b32 exec_hi, 0x80000000
    ds_write_b32 v10, v11 offset:2176
    s_mov_b64 exec, -1
    s_branch TOTALS
NOT_POLLER:
    s_cmp_eq_u32 s25, 4
    s_cbranch_scc1 TOTALS
    v_mov_b32 v10, 2240
    s_waitcnt vmcnt(0)
    s_mov_b64 exec, 1
    ds_add_rtn_u32 v10, v10, v15
    s_mov_b64 exec, -1
    s_waitcnt lgkmcnt(0)
    v_readfirstlane_b32 s3, v10
    s_cmp_lg_u32 s3, 2
    s_cbranch_scc1 TOTALS
    s_lshl_b32 s3, s2, 10
    s_add_u32 s3, s3, 8388608
    v_add_u32 v9, s3, v1
    v_mov_b32 v10, s64
    v_mov_b32 v11, s65
    v_mov_b32 v12, s64
    v_mov_b32 v13, s65
    global_store_dwordx4 v9, v[10:13], s[16:17] sc0 sc1
    s_nop 1
TOTALS:
    v_mov_b32 v10, 0
TOTALS_SPIN:
    ds_read_b128 v[64:67], v10 offset:2176
    s_waitcnt lgkmcnt(0)
    v_readfirstlane_b32 s4, v64
    v_readfirstlane_b32 s5, v65
    v_readfirstlane_b32 s6, v66
    v_readfirstlane_b32 s7, v67
    s_min_u32 s3, s4, s5
    s_min_u32 s8, s6, s7
    s_min_u32 s3, s3, s8
    s_cmp_eq_u32 s3, 0
    s_cbranch_scc0 TOTALS_OK
    s_sub_u32 s35, s35, 1
    s_cbranch_scc0 TOTALS_SPIN
    s_endpgm
TOTALS_OK:
    s_add_u32 s5, s5, s4
    s_add_u32 s6, s6, s5
    s_add_u32 s7, s7, s6
    s_sub_u32 s26, s7, 4
    s_cmp_eq_u32 s25, 1
    s_cselect_b32 s3, s4, 0
    s_cmp_eq_u32 s25, 2
    s_cselect_b32 s3, s5, s3
    s_cmp_eq_u32 s25, 3
    s_cselect_b32 s3, s6, s3
    s_sub_u32 s3, s3, s25
    v_add_u32 v3, s3, v3
    s_cmp_lg_u32 s25, 4
    s_cbranch_scc1 EPOCH_DONE
    s_cmp_lg_u32 s2, 0
    s_cbranch_scc1 EPOCH_DONE
    v_mov_b32 v12, s64
    v_mov_b32 v10, 8650752
    s_mov_b64 exec, 1
    global_store_dword v10, v12, s[16:17] sc0 sc1
    s_mov_b64 exec, -1
EPOCH_DONE:
    s_lshl_b32 s4, s2, 3
    s_add_u32 s4, s4, s25
    s_lshl_b32 s4, s4, 7
    s_add_u32 s4, s4, 0
    v_min_u32 v139, 240, v1
    v_lshl_add_u32 v139, v139, 14, s4
    buffer_load_dword v167, v139, s[12:15], 0 offen
NO_X_TOUCH_3:
ROUND:
    v_mov_b32 v8, 0
    v_subrev_u32 v9, s27, v3
    v_mov_b32 v10, v4
    s_mov_b32 s3, 1472
    s_cmp_gt_u32 s26, 1472
    s_cbranch_scc1 EXPAND
    v_lshlrev_b32 v11, 2, v3
    v_cmpx_lt_u32 vcc, 0, v2
    ds_write_b32 v11, v10 offset:2304
    v_add_u32 v10, 1, v10
    v_cmpx_lt_u32 vcc, 1, v2
    ds_write_b32 v11, v10 offset:2308
    v_add_u32 v10, 1, v10
    v_cmpx_lt_u32 vcc, 2, v2
    ds_write_b32 v11, v10 offset:2312
    v_add_u32 v10, 1, v10
    v_cmpx_lt_u32 vcc, 3, v2
    ds_write_b32 v11, v10 offset:2316
    v_add_u32 v10, 1, v10
    v_cmpx_lt_u32 vcc, 4, v2
    ds_write_b32 v11, v10 offset:2320
    v_add_u32 v10, 1, v10
    v_cmpx_lt_u32 vcc, 5, v2
    ds_write_b32 v11, v10 offset:2324
    v_add_u32 v10, 1, v10
    v_cmpx_lt_u32 vcc, 6, v2
    s_cbranch_execz EXPAND_DONE
    ds_write_b32 v11, v10 offset:2328
    v_add_u32 v10, 1, v10
    v_cmpx_lt_u32 vcc, 7, v2
    ds_write_b32 v11, v10 offset:2332
    v_add_u32 v10, 1, v10
    v_cmpx_lt_u32 vcc, 8, v2
    s_cbranch_execz EXPAND_DONE
    ds_write_b32 v11, v10 offset:2336
    v_add_u32 v10, 1, v10
    v_cmpx_lt_u32 vcc, 9, v2
    ds_write_b32 v11, v10 offset:2340
    v_add_u32 v10, 1, v10
    v_cmpx_lt_u32 vcc, 10, v2
    s_cbranch_execz EXPAND_DONE
    ds_write_b32 v11, v10 offset:2344
    v_add_u32 v10, 1, v10
    v_cmpx_lt_u32 vcc, 11, v2
    ds_write_b32 v11, v10 offset:2348
    v_add_u32 v10, 1, v10
    v_cmpx_lt_u32 vcc, 12, v2
    s_cbranch_execz EXPAND_DONE
    ds_write_b32 v11, v10 offset:2352
    v_add_u32 v10, 1, v10
    v_cmpx_lt_u32 vcc, 13, v2
    ds_write_b32 v11, v10 offset:2356
    v_add_u32 v10, 1, v10
    v_cmpx_lt_u32 vcc, 14, v2
    s_cbranch_execz EXPAND_DONE
    ds_write_b32 v11, v10 offset:2360
    v_add_u32 v10, 1, v10
    v_cmpx_lt_u32 vcc, 15, v2
    ds_write_b32 v11, v10 offset:2364
    v_add_u32 v10, 1, v10
    v_mov_b32 v8, 16
    v_add_u32 v9, 16, v9
EXPAND:
    v_cmp_lt_u32 vcc, v8, v2
    s_and_b64 exec, exec, vcc
    s_cbranch_execz EXPAND_DONE
    v_cmp_gt_u32 vcc, s3, v9
    v_lshlrev_b32 v11, 2, v9
    s_and_saveexec_b64 s[42:43], vcc
    ds_write_b32 v11, v10 offset:2304
    s_mov_b64 exec, s[42:43]
    v_add_u32 v8, 1, v8
    v_add_u32 v9, 1, v9
    v_add_u32 v10, 1, v10
    s_branch EXPAND
EXPAND_DONE:
    s_mov_b64 exec, -1
    s_sub_u32 s28, s26, s27
    s_min_u32 s28, s28, 1472
    v_lshlrev_b32 v8, 2, v0
    v_add_u32 v9, 0, v0
    v_cmp_gt_u32 s[36:37], s28, v9
    v_add_u32 v9, 512, v0
    v_cmp_gt_u32 s[38:39], s28, v9
    v_add_u32 v9, 1024, v0
    v_cmp_gt_u32 s[40:41], s28, v9
    s_waitcnt lgkmcnt(0)
    s_barrier
    ds_read_b32 v64, v8 offset:2304
    ds_read_b32 v65, v8 offset:4352
    ds_read_b32 v66, v8 offset:6400
    s_mov_b32 s44, 5033
    s_waitcnt lgkmcnt(0)
    v_lshlrev_b32 v68, 3, v64
    v_lshlrev_b32 v64, 4, v64
    v_lshlrev_b32 v69, 3, v65
    v_lshlrev_b32 v65, 4, v65
    v_lshlrev_b32 v70, 3, v66
    v_lshlrev_b32 v66, 4, v66
KEY_LOAD:
    s_mov_b64 exec, s[40:41]
    s_cbranch_execz SKIP3
    buffer_load_dwordx2 v[100:101], v70, s[16:19], 0 offen sc1
SKIP3:
    s_mov_b64 exec, s[36:37]
    buffer_load_dwordx2 v[96:97], v68, s[16:19], 0 offen sc1
    s_mov_b64 exec, s[38:39]
    buffer_load_dwordx2 v[98:99], v69, s[16:19], 0 offen sc1
    s_mov_b64 exec, -1
    s_cmp_lt_u32 s25, 2
    s_cbranch_scc1 NO_LAST_JOB
    s_mov_b32 s10, 0xbfb8aa3b
    s_mov_b32 s11, 0xbfb8aa3b
    s_add_u32 s62, s25, 26
    s_mov_b32 s63, 1
    s_call_b64 s[6:7], LUT_SUB
NO_LAST_JOB:
    s_waitcnt vmcnt(0)
    v_cmp_ne_u32 s[48:49], s64, v97
    v_cmp_ne_u32 s[50:51], s64, v99
    v_cmp_ne_u32 s[52:53], s64, v101
    s_and_b64 s[48:49], s[48:49], s[36:37]
    s_and_b64 s[50:51], s[50:51], s[38:39]
    s_and_b64 s[52:53], s[52:53], s[40:41]
    s_or_b64 s[48:49], s[48:49], s[50:51]
    s_or_b64 s[48:49], s[48:49], s[52:53]
    s_cbranch_scc0 KEYS_OK
    s_sub_u32 s35, s35, 1
    s_cbranch_scc0 KEY_LOAD
    s_endpgm
KEYS_OK:
    buffer_load_dwordx2 v[136:137], v166, s[16:19], 0 offen sc1
    v_mul_hi_u32 v9, s44, v96
    v_and_b32 v72, 63, v96
    v_mul_u32_u24 v72, 48, v72
    v_lshl_add_u32 v72, v9, 2, v72
    v_mul_hi_u32 v9, s44, v98
    v_and_b32 v73, 63, v98
    v_mul_u32_u24 v73, 48, v73
    v_lshl_add_u32 v73, v9, 2, v73
    v_mul_hi_u32 v9, s44, v100
    v_and_b32 v74, 63, v100
    v_mul_u32_u24 v74, 48, v74
    v_lshl_add_u32 v74, v9, 2, v74
    s_mov_b64 exec, s[36:37]
    ds_add_rtn_u32 v76, v72, v15 offset:0
    s_mov_b64 exec, s[38:39]
    ds_add_rtn_u32 v77, v73, v15 offset:0
    s_mov_b64 exec, s[40:41]
    ds_add_rtn_u32 v78, v74, v15 offset:0
    s_mov_b64 exec, -1
    v_add_u32 v9, 0, v0
    v_lshlrev_b32 v9, 21, v9
    v_lshrrev_b32 v80, 10, v96
    v_lshl_or_b32 v80, v80, 7, v9
    v_add_u32 v9, 512, v0
    v_lshlrev_b32 v9, 21, v9
    v_lshrrev_b32 v81, 10, v98
    v_lshl_or_b32 v81, v81, 7, v9
    v_add_u32 v9, 1024, v0
    v_lshlrev_b32 v9, 21, v9
    v_lshrrev_b32 v82, 10, v100
    v_lshl_or_b32 v82, v82, 7, v9
    v_lshrrev_b32 v8, 4, v1
    v_min_u32 v9, 39, v8
    v_mul_u32_u24 v9, 48, v9
    v_cmp_gt_u32 s[46:47], 40, v8
    v_sub_u32 v10, 63, v8
    s_mul_i32 s10, s25, 5
    s_lshl_b32 s3, s25, 10
    s_add_u32 s3, s3, 8192
    s_mov_b32 s9, 2621440
    s_waitcnt lgkmcnt(0)
    s_barrier
    ds_read_b128 v[84:87], v9 offset:0
    ds_read_b128 v[88:91], v9 offset:16
    ds_read_b128 v[92:95], v9 offset:32
    s_waitcnt lgkmcnt(1)
    v_add3_u32 v84, v84, v85, v86
    v_add3_u32 v87, v87, v88, v89
    v_add3_u32 v84, v84, v90, v91
    s_waitcnt lgkmcnt(0)
    v_add3_u32 v87, v87, v92, v93
    v_add3_u32 v84, v84, v94, v95
    v_add_u32 v84, v84, v87
    v_lshl_or_b32 v85, v84, 6, v10
    v_cndmask_b32 v85, 0, v85, s[46:47]
    s_cmp_lg_u32 s27, 0
    s_cbranch_scc1 DEALT
    v_readlane_b32 s4, v85, s10
    s_add_u32 s10, s10, 1
    v_readlane_b32 s5, v85, s10
    s_add_u32 s10, s10, 1
    v_readlane_b32 s6, v85, s10
    s_add_u32 s10, s10, 1
    v_readlane_b32 s7, v85, s10
    s_add_u32 s10, s10, 1
    v_readlane_b32 s8, v85, s10
    v_cmp_lt_u32 s[48:49], s4, v85
    v_cmp_lt_u32 s[50:51], s5, v85
    v_cmp_lt_u32 s[52:53], s6, v85
    v_cmp_lt_u32 s[54:55], s7, v85
    v_cmp_lt_u32 s[56:57], s8, v85
    s_bcnt1_i32_b64 s4, s[48:49]
    s_bcnt1_i32_b64 s5, s[50:51]
    s_bcnt1_i32_b64 s6, s[52:53]
    s_bcnt1_i32_b64 s7, s[54:55]
    s_bcnt1_i32_b64 s8, s[56:57]
    v_writelane_b32 v9, s4, 0
    v_writelane_b32 v9, s5, 1
    v_writelane_b32 v9, s6, 2
    v_writelane_b32 v9, s7, 3
    v_writelane_b32 v9, s8, 4
    s_sub_u32 s10, s10, 4
    v_add_u32 v10, s10, v8
    v_lshrrev_b32 v11, 3, v9
    v_and_b32 v9, 7, v9
    v_lshrrev_b32 v12, v11, 18
    v_and_b32 v12, 1, v12
    v_mul_u32_u24 v12, 7, v12
    v_xor_b32 v9, v9, v12
    v_mad_u32_u24 v9, v9, 5, v11
    v_lshlrev_b32 v9, 2, v9
    s_mov_b64 exec, 0x1f
    ds_write_b32 v9, v10 offset:1920
    s_mov_b64 exec, -1
DEALT:
    s_lshl_b32 s11, s10, 2
    v_add_u32 v9, s11, v7
    v_lshlrev_b32 v13, 2, v8
POLL_REC:
    s_waitcnt vmcnt(0)
CHECK_REC:
    v_cmp_ne_u32 vcc, s64, v136
    v_cmp_ne_u32 s[42:43], s65, v137
    s_or_b64 vcc, vcc, s[42:43]
    s_and_b64 exec, exec, vcc
    s_cbranch_execz POLLED_REC
    s_sub_u32 s35, s35, 1
    s_cbranch_scc1 END
    buffer_load_dwordx2 v[136:137], v166, s[16:19], 0 offen sc1
    s_branch POLL_REC
POLLED_REC:
    s_mov_b64 exec, -1
    v_cmp_gt_u32 s[42:43], 60, v8
    s_waitcnt lgkmcnt(0)
    s_barrier
    ds_read_b32 v9, v9 offset:1920
    ds_read_b32 v13, v13 offset:1920
    v_lshlrev_b32 v12, 17, v7
    s_add_u32 m0, s3, 0
    s_mov_b64 exec, s[36:37]
    buffer_load_dwordx4 v64, s[16:19], s9 offen sc1 lds
    s_add_u32 m0, s3, 8192
    s_mov_b64 exec, s[38:39]
    buffer_load_dwordx4 v65, s[16:19], s9 offen sc1 lds
    s_add_u32 m0, s3, 16384
    s_mov_b64 exec, s[40:41]
    s_cbranch_execz SKIP3R
    buffer_load_dwordx4 v66, s[16:19], s9 offen sc1 lds
SKIP3R:
    s_mov_b64 exec, -1
    s_waitcnt lgkmcnt(1)
    v_mul_u32_u24 v10, 48, v9
    v_add_u32 v10, v10, v14
    ds_read_b32 v11, v10 offset:0
    s_waitcnt lgkmcnt(1)
    v_lshlrev_b32 v13, 2, v13
    ds_bpermute_b32 v86, v13, v84
    v_readlane_b32 s4, v9, 0
    v_readlane_b32 s5, v9, 1
    v_readlane_b32 s6, v9, 2
    v_readlane_b32 s7, v9, 3
    v_readlane_b32 s8, v9, 4
    s_waitcnt lgkmcnt(0)
    v_cndmask_b32 v11, 0, v11, s[42:43]
    v_cndmask_b32 v86, 0, v86, s[46:47]
    v_sub_u32 v12, v12, v11
    v_mov_b32 v87, v86
    s_nop 0
    v_add_u32_dpp v11, v11, v11 row_shr:1 row_mask:0xf bank_mask:0xf bound_ctrl:0
    v_add_u32_dpp v87, v87, v87 row_shr:1 row_mask:0xf bank_mask:0xf bound_ctrl:0
    s_nop 0
    v_add_u32_dpp v11, v11, v11 row_shr:2 row_mask:0xf bank_mask:0xf bound_ctrl:0
    v_add_u32_dpp v87, v87, v87 row_shr:2 row_mask:0xf bank_mask:0xf bound_ctrl:0
    s_nop 0
    v_add_u32_dpp v11, v11, v11 row_shr:4 row_mask:0xf bank_mask:0xf bound_ctrl:0
    v_add_u32_dpp v87, v87, v87 row_shr:4 row_mask:0xf bank_mask:0xf bound_ctrl:0
    s_nop 0
    v_add_u32_dpp v11, v11, v11 row_shr:8 row_mask:0xf bank_mask:0xf bound_ctrl:0
    v_add_u32_dpp v87, v87, v87 row_shr:8 row_mask:0xf bank_mask:0xf bound_ctrl:0
    s_nop 0
    v_add_u32_dpp v11, v11, v11 row_bcast:15 row_mask:0xa bank_mask:0xf
    v_add_u32_dpp v87, v87, v87 row_bcast:15 row_mask:0xa bank_mask:0xf
    s_nop 0
    v_add_u32_dpp v11, v11, v11 row_bcast:31 row_mask:0xc bank_mask:0xf
    v_add_u32_dpp v87, v87, v87 row_bcast:31 row_mask:0xc bank_mask:0xf
    v_sub_u32 v87, v87, v86
    v_add_u32 v12, v12, v11
    v_readlane_b32 s29, v87, s10
    v_readlane_b32 s30, v11, 63
    s_nop 0
    v_add_u32 v12, s29, v12
    s_mov_b64 exec, s[42:43]
    ds_write_b32 v10, v12 offset:0
    s_mov_b64 exec, -1
    v_add_u32 v6, s29, v8
    v_lshlrev_b32 v5, 2, v6
    v_add_u32 v5, 2304, v5
    s_add_u32 s10, s30, 3
    s_and_b32 s10, s10, -4
    s_min_u32 s32, s10, 4
    s_sub_u32 s31, s10, s32
    s_add_u32 s30, s30, s29
    s_waitcnt lgkmcnt(0)
    s_barrier
    ds_read_b32 v72, v72 offset:0
    ds_read_b32 v73, v73 offset:0
    ds_read_b32 v74, v74 offset:0
    s_waitcnt lgkmcnt(2)
    v_lshrrev_b32 v9, 16, v72
    v_and_b32 v72, 0xffff, v72
    v_or_b32 v80, v80, v9
    v_add_lshl_u32 v72, v72, v76, 2
    s_waitcnt lgkmcnt(1)
    v_lshrrev_b32 v9, 16, v73
    v_and_b32 v73, 0xffff, v73
    v_or_b32 v81, v81, v9
    v_add_lshl_u32 v73, v73, v77, 2
    s_waitcnt lgkmcnt(0)
    v_lshrrev_b32 v9, 16, v74
    v_and_b32 v74, 0xffff, v74
    v_or_b32 v82, v82, v9
    v_add_lshl_u32 v74, v74, v78, 2
    s_mov_b64 exec, s[36:37]
    ds_write_b32 v72, v80 offset:2304
    s_mov_b64 exec, s[38:39]
    ds_write_b32 v73, v81 offset:2304
    s_mov_b64 exec, s[40:41]
    ds_write_b32 v74, v82 offset:2304
    s_mov_b64 exec, -1
    s_waitcnt lgkmcnt(0)
    s_barrier
    ds_read_b32 v165, v5
    s_and_b32 s10, s25, 3
    s_lshl_b32 s10, s10, 13
    s_add_u32 s10, s10, 7802880
    s_add_u32 s11, s10, 4096
    v_mov_b32 v128, 0
    v_mov_b32 v129, 0
    v_mov_b32 v130, 0
    v_mov_b32 v131, 0
    v_mov_b32 v132, 0
    v_mov_b32 v133, 0
    v_mov_b32 v134, 0
    v_mov_b32 v135, 0
    s_waitcnt lgkmcnt(0)
    v_cmp_gt_u32 vcc, s30, v6
    v_add_u32 v6, 64, v6
    v_add_u32 v5, 256, v5
    v_cndmask_b32 v165, 40, v165, vcc
    v_lshrrev_b32 v8, 21, v165
    v_lshlrev_b32 v8, 4, v8
    v_lshlrev_b32 v9, 3, v165
    v_and_b32 v9, 0xfffc00, v9
    v_and_or_b32 v165, v165, 56, v9
    s_nop 0
    v_readlane_b32 s48, v165, 0
    s_and_b32 s33, s48, s34
    buffer_load_dwordx4 v[64:67], v1, s[12:15], s33 offen
    v_readlane_b32 s49, v165, 1
    s_and_b32 s33, s49, s34
    buffer_load_dwordx4 v[68:71], v1, s[12:15], s33 offen
    s_waitcnt vmcnt(2)
    s_barrier
    ds_read_b128 v[168:171], v8 offset:8192
    v_readlane_b32 s50, v165, 2
    s_and_b32 s33, s50, s34
    buffer_load_dwordx4 v[72:75], v1, s[12:15], s33 offen
    v_readlane_b32 s51, v165, 3
    s_and_b32 s33, s51, s34
    buffer_load_dwordx4 v[76:79], v1, s[12:15], s33 offen
    v_readlane_b32 s52, v165, 4
    s_and_b32 s33, s52, s34
    buffer_load_dwordx4 v[80:83], v1, s[12:15], s33 offen
    v_readlane_b32 s53, v165, 5
    s_and_b32 s33, s53, s34
    buffer_load_dwordx4 v[84:87], v1, s[12:15], s33 offen
    v_mov_b32 v164, v165
    s_waitcnt lgkmcnt(0)
    v_mov_b32 v172, v170
    v_mov_b32 v173, v171
    v_mfma_f32_4x4x4_16b_bf16 v[148:151], v[168:169], v[180:181], 0
    v_mfma_f32_4x4x4_16b_bf16 v[152:155], v[168:169], v[182:183], 0
    v_mfma_f32_4x4x4_16b_bf16 v[156:159], v[168:169], v[184:185], 0
    v_mfma_f32_4x4x4_16b_bf16 v[160:163], v[168:169], v[186:187], 0
    v_mfma_f32_4x4x4_16b_bf16 v[112:115], v[172:173], v[176:177], 0 cbsz:4 abid:0
    v_mfma_f32_4x4x4_16b_bf16 v[116:119], v[172:173], v[178:179], 0 cbsz:4 abid:0
    v_mfma_f32_4x4x4_16b_bf16 v[120:123], v[172:173], v[176:177], 0 cbsz:4 abid:1
    s_nop 1
    v_cvt_pk_bf16_f32 v140, v148, v152
    v_cvt_pk_bf16_f32 v141, v156, v160
    v_cvt_pk_bf16_f32 v142, v149, v153
    v_cvt_pk_bf16_f32 v143, v157, v161
    v_cvt_pk_bf16_f32 v144, v150, v154
    v_cvt_pk_bf16_f32 v145, v158, v162
    v_cvt_pk_bf16_f32 v146, v151, v155
    v_cvt_pk_bf16_f32 v147, v159, v163
    v_lshlrev_b32_sdwa v136, v15, v112 dst_sel:DWORD dst_unused:UNUSED_PAD src0_sel:DWORD src1_sel:WORD_1
    v_lshlrev_b32_sdwa v137, v15, v113 dst_sel:DWORD dst_unused:UNUSED_PAD src0_sel:DWORD src1_sel:WORD_1
    ds_read_u16_d16_hi v128, v136 offset:32768
    ds_read_u16_d16_hi v129, v137 offset:32768
    v_lshlrev_b32_sdwa v138, v15, v116 dst_sel:DWORD dst_unused:UNUSED_PAD src0_sel:DWORD src1_sel:WORD_1
    v_lshlrev_b32_sdwa v139, v15, v117 dst_sel:DWORD dst_unused:UNUSED_PAD src0_sel:DWORD src1_sel:WORD_1
    ds_read_u16_d16_hi v130, v138 offset:32768
    ds_read_u16_d16_hi v131, v139 offset:32768
    s_waitcnt vmcnt(5)
    v_mfma_f32_4x4x4_16b_bf16 v[96:99], v[140:141], v[64:65], 0 cbsz:4 abid:0
    v_mfma_f32_4x4x4_16b_bf16 v[100:103], v[140:141], v[66:67], 0 cbsz:4 abid:0
A_0:
    s_sub_u32 s31, s31, 4
    s_cbranch_scc1 TO_B_0
    v_mfma_f32_4x4x4_16b_bf16 v[124:127], v[172:173], v[178:179], 0 cbsz:4 abid:1
    v_lshlrev_b32_sdwa v136, v15, v114 dst_sel:DWORD dst_unused:UNUSED_PAD src0_sel:DWORD src1_sel:WORD_1
    s_waitcnt vmcnt(4)
    v_mfma_f32_4x4x4_16b_bf16 v[104:107], v[142:143], v[68:69], 0 cbsz:4 abid:0
    v_readlane_b32 s54, v164, 6
    v_mfma_f32_4x4x4_16b_bf16 v[108:111], v[142:143], v[70:71], 0 cbsz:4 abid:0
    v_lshlrev_b32_sdwa v137, v15, v115 dst_sel:DWORD dst_unused:UNUSED_PAD src0_sel:DWORD src1_sel:WORD_1
    ds_read_u16_d16_hi v132, v136 offset:32768
    ds_read_u16_d16_hi v133, v137 offset:32768
    s_and_b32 s33, s54, s34
    buffer_load_dwordx4 v[88:91], v1, s[12:15], s33 offen
    s_waitcnt lgkmcnt(2)
    s_set_gpr_idx_on s48, 0xc
    v_pk_fma_f32 v[16:17], v[128:129], v[96:97], v[16:17] op_sel:[0,0,0] op_sel_hi:[0,1,1]
    v_pk_fma_f32 v[18:19], v[128:129], v[98:99], v[18:19] op_sel:[0,0,0] op_sel_hi:[0,1,1]
    v_pk_fma_f32 v[20:21], v[130:131], v[100:101], v[20:21] op_sel:[0,0,0] op_sel_hi:[0,1,1]
    v_pk_fma_f32 v[22:23], v[130:131], v[102:103], v[22:23] op_sel:[0,0,0] op_sel_hi:[0,1,1]
    s_set_gpr_idx_off
    v_lshlrev_b32_sdwa v138, v15, v118 dst_sel:DWORD dst_unused:UNUSED_PAD src0_sel:DWORD src1_sel:WORD_1
    s_waitcnt vmcnt(4)
    v_mfma_f32_4x4x4_16b_bf16 v[96:99], v[144:145], v[72:73], 0 cbsz:4 abid:0
    v_readlane_b32 s55, v164, 7
    v_mfma_f32_4x4x4_16b_bf16 v[100:103], v[144:145], v[74:75], 0 cbsz:4 abid:0
    v_lshlrev_b32_sdwa v139, v15, v119 dst_sel:DWORD dst_unused:UNUSED_PAD src0_sel:DWORD src1_sel:WORD_1
    ds_read_u16_d16_hi v134, v138 offset:32768
    ds_read_u16_d16_hi v135, v139 offset:32768
    s_and_b32 s33, s55, s34
    buffer_load_dwordx4 v[92:95], v1, s[12:15], s33 offen
    s_set_gpr_idx_on s49, 0xc
    v_pk_fma_f32 v[16:17], v[128:129], v[104:105], v[16:17] op_sel:[1,0,0] op_sel_hi:[1,1,1]
    v_pk_fma_f32 v[18:19], v[128:129], v[106:107], v[18:19] op_sel:[1,0,0] op_sel_hi:[1,1,1]
    v_pk_fma_f32 v[20:21], v[130:131], v[108:109], v[20:21] op_sel:[1,0,0] op_sel_hi:[1,1,1]
    v_pk_fma_f32 v[22:23], v[130:131], v[110:111], v[22:23] op_sel:[1,0,0] op_sel_hi:[1,1,1]
    s_set_gpr_idx_off
    v_mfma_f32_4x4x4_16b_bf16 v[112:115], v[172:173], v[176:177], 0 cbsz:4 abid:2
    v_lshlrev_b32_sdwa v136, v15, v120 dst_sel:DWORD dst_unused:UNUSED_PAD src0_sel:DWORD src1_sel:WORD_1
    s_waitcnt vmcnt(4)
    v_mfma_f32_4x4x4_16b_bf16 v[104:107], v[146:147], v[76:77], 0 cbsz:4 abid:0
    v_readlane_b32 s56, v164, 8
    v_mfma_f32_4x4x4_16b_bf16 v[108:111], v[146:147], v[78:79], 0 cbsz:4 abid:0
    v_lshlrev_b32_sdwa v137, v15, v121 dst_sel:DWORD dst_unused:UNUSED_PAD src0_sel:DWORD src1_sel:WORD_1
    ds_read_u16_d16_hi v128, v136 offset:32768
    ds_read_u16_d16_hi v129, v137 offset:32768
    s_and_b32 s33, s56, s34
    buffer_load_dwordx4 v[64:67], v1, s[12:15], s33 offen
    s_waitcnt lgkmcnt(2)
    s_set_gpr_idx_on s50, 0xc
    v_pk_fma_f32 v[16:17], v[132:133], v[96:97], v[16:17] op_sel:[0,0,0] op_sel_hi:[0,1,1]
    v_pk_fma_f32 v[18:19], v[132:133], v[98:99], v[18:19] op_sel:[0,0,0] op_sel_hi:[0,1,1]
    v_pk_fma_f32 v[20:21], v[134:135], v[100:101], v[20:21] op_sel:[0,0,0] op_sel_hi:[0,1,1]
    v_pk_fma_f32 v[22:23], v[134:135], v[102:103], v[22:23] op_sel:[0,0,0] op_sel_hi:[0,1,1]
    s_set_gpr_idx_off
    v_lshlrev_b32_sdwa v138, v15, v124 dst_sel:DWORD dst_unused:UNUSED_PAD src0_sel:DWORD src1_sel:WORD_1
    s_waitcnt vmcnt(4)
    v_mfma_f32_4x4x4_16b_bf16 v[96:99], v[140:141], v[80:81], 0 cbsz:4 abid:1
    v_readlane_b32 s57, v164, 9
    v_mfma_f32_4x4x4_16b_bf16 v[100:103], v[140:141], v[82:83], 0 cbsz:4 abid:1
    v_lshlrev_b32_sdwa v139, v15, v125 dst_sel:DWORD dst_unused:UNUSED_PAD src0_sel:DWORD src1_sel:WORD_1
    ds_read_u16_d16_hi v130, v138 offset:32768
    ds_read_u16_d16_hi v131, v139 offset:32768
    s_and_b32 s33, s57, s34
    buffer_load_dwordx4 v[68:71], v1, s[12:15], s33 offen
    s_set_gpr_idx_on s51, 0xc
    v_pk_fma_f32 v[16:17], v[132:133], v[104:105], v[16:17] op_sel:[1,0,0] op_sel_hi:[1,1,1]
    v_pk_fma_f32 v[18:19], v[132:133], v[106:107], v[18:19] op_sel:[1,0,0] op_sel_hi:[1,1,1]
    v_pk_fma_f32 v[20:21], v[134:135], v[108:109], v[20:21] op_sel:[1,0,0] op_sel_hi:[1,1,1]
    v_pk_fma_f32 v[22:23], v[134:135], v[110:111], v[22:23] op_sel:[1,0,0] op_sel_hi:[1,1,1]
    s_set_gpr_idx_off
A_4:
    s_sub_u32 s31, s31, 4
    s_cbranch_scc1 TO_B_4
    v_mfma_f32_4x4x4_16b_bf16 v[116:119], v[172:173], v[178:179], 0 cbsz:4 abid:2
    v_lshlrev_b32_sdwa v136, v15, v122 dst_sel:DWORD dst_unused:UNUSED_PAD src0_sel:DWORD src1_sel:WORD_1
    s_waitcnt vmcnt(4)
    v_mfma_f32_4x4x4_16b_bf16 v[104:107], v[142:143], v[84:85], 0 cbsz:4 abid:1
    v_readlane_b32 s58, v164, 10
    v_mfma_f32_4x4x4_16b_bf16 v[108:111], v[142:143], v[86:87], 0 cbsz:4 abid:1
    v_lshlrev_b32_sdwa v137, v15, v123 dst_sel:DWORD dst_unused:UNUSED_PAD src0_sel:DWORD src1_sel:WORD_1
    ds_read_u16_d16_hi v132, v136 offset:32768
    ds_read_u16_d16_hi v133, v137 offset:32768
    s_and_b32 s33, s58, s34
    buffer_load_dwordx4 v[72:75], v1, s[12:15], s33 offen
    s_waitcnt lgkmcnt(2)
    s_set_gpr_idx_on s52, 0xc
    v_pk_fma_f32 v[16:17], v[128:129], v[96:97], v[16:17] op_sel:[0,0,0] op_sel_hi:[0,1,1]
    v_pk_fma_f32 v[18:19], v[128:129], v[98:99], v[18:19] op_sel:[0,0,0] op_sel_hi:[0,1,1]
    v_pk_fma_f32 v[20:21], v[130:131], v[100:101], v[20:21] op_sel:[0,0,0] op_sel_hi:[0,1,1]
    v_pk_fma_f32 v[22:23], v[130:131], v[102:103], v[22:23] op_sel:[0,0,0] op_sel_hi:[0,1,1]
    s_set_gpr_idx_off
    v_lshlrev_b32_sdwa v138, v15, v126 dst_sel:DWORD dst_unused:UNUSED_PAD src0_sel:DWORD src1_sel:WORD_1
    s_waitcnt vmcnt(4)
    v_mfma_f32_4x4x4_16b_bf16 v[96:99], v[144:145], v[88:89], 0 cbsz:4 abid:1
    v_readlane_b32 s59, v164, 11
    v_mfma_f32_4x4x4_16b_bf16 v[100:103], v[144:145], v[90:91], 0 cbsz:4 abid:1
    v_lshlrev_b32_sdwa v139, v15, v127 dst_sel:DWORD dst_unused:UNUSED_PAD src0_sel:DWORD src1_sel:WORD_1
    ds_read_u16_d16_hi v134, v138 offset:32768
    ds_read_u16_d16_hi v135, v139 offset:32768
    s_and_b32 s33, s59, s34
    buffer_load_dwordx4 v[76:79], v1, s[12:15], s33 offen
    s_set_gpr_idx_on s53, 0xc
    v_pk_fma_f32 v[16:17], v[128:129], v[104:105], v[16:17] op_sel:[1,0,0] op_sel_hi:[1,1,1]
    v_pk_fma_f32 v[18:19], v[128:129], v[106:107], v[18:19] op_sel:[1,0,0] op_sel_hi:[1,1,1]
    v_pk_fma_f32 v[20:21], v[130:131], v[108:109], v[20:21] op_sel:[1,0,0] op_sel_hi:[1,1,1]
    v_pk_fma_f32 v[22:23], v[130:131], v[110:111], v[22:23] op_sel:[1,0,0] op_sel_hi:[1,1,1]
    s_set_gpr_idx_off
    v_mfma_f32_4x4x4_16b_bf16 v[120:123], v[172:173], v[176:177], 0 cbsz:4 abid:3
    v_lshlrev_b32_sdwa v136, v15, v112 dst_sel:DWORD dst_unused:UNUSED_PAD src0_sel:DWORD src1_sel:WORD_1
    s_waitcnt vmcnt(4)
    v_mfma_f32_4x4x4_16b_bf16 v[104:107], v[146:147], v[92:93], 0 cbsz:4 abid:1
    v_readlane_b32 s60, v164, 12
    v_mfma_f32_4x4x4_16b_bf16 v[108:111], v[146:147], v[94:95], 0 cbsz:4 abid:1
    v_lshlrev_b32_sdwa v137, v15, v113 dst_sel:DWORD dst_unused:UNUSED_PAD src0_sel:DWORD src1_sel:WORD_1
    ds_read_u16_d16_hi v128, v136 offset:32768
    ds_read_u16_d16_hi v129, v137 offset:32768
    s_and_b32 s33, s60, s34
    buffer_load_dwordx4 v[80:83], v1, s[12:15], s33 offen
    s_waitcnt lgkmcnt(2)
    s_set_gpr_idx_on s54, 0xc
    v_pk_fma_f32 v[16:17], v[132:133], v[96:97], v[16:17] op_sel:[0,0,0] op_sel_hi:[0,1,1]
    v_pk_fma_f32 v[18:19], v[132:133], v[98:99], v[18:19] op_sel:[0,0,0] op_sel_hi:[0,1,1]
    v_pk_fma_f32 v[20:21], v[134:135], v[100:101], v[20:21] op_sel:[0,0,0] op_sel_hi:[0,1,1]
    v_pk_fma_f32 v[22:23], v[134:135], v[102:103], v[22:23] op_sel:[0,0,0] op_sel_hi:[0,1,1]
    s_set_gpr_idx_off
    v_lshlrev_b32_sdwa v138, v15, v116 dst_sel:DWORD dst_unused:UNUSED_PAD src0_sel:DWORD src1_sel:WORD_1
    s_waitcnt vmcnt(4)
    v_mfma_f32_4x4x4_16b_bf16 v[96:99], v[140:141], v[64:65], 0 cbsz:4 abid:2
    v_readlane_b32 s61, v164, 13
    v_mfma_f32_4x4x4_16b_bf16 v[100:103], v[140:141], v[66:67], 0 cbsz:4 abid:2
    v_lshlrev_b32_sdwa v139, v15, v117 dst_sel:DWORD dst_unused:UNUSED_PAD src0_sel:DWORD src1_sel:WORD_1
    ds_read_u16_d16_hi v130, v138 offset:32768
    ds_read_u16_d16_hi v131, v139 offset:32768
    s_and_b32 s33, s61, s34
    buffer_load_dwordx4 v[84:87], v1, s[12:15], s33 offen
    s_set_gpr_idx_on s55, 0xc
    v_pk_fma_f32 v[16:17], v[132:133], v[104:105], v[16:17] op_sel:[1,0,0] op_sel_hi:[1,1,1]
    v_pk_fma_f32 v[18:19], v[132:133], v[106:107], v[18:19] op_sel:[1,0,0] op_sel_hi:[1,1,1]
    v_pk_fma_f32 v[20:21], v[134:135], v[108:109], v[20:21] op_sel:[1,0,0] op_sel_hi:[1,1,1]
    v_pk_fma_f32 v[22:23], v[134:135], v[110:111], v[22:23] op_sel:[1,0,0] op_sel_hi:[1,1,1]
    s_set_gpr_idx_off
A_8:
    s_sub_u32 s31, s31, 4
    s_cbranch_scc1 TO_B_8
    v_mfma_f32_4x4x4_16b_bf16 v[124:127], v[172:173], v[178:179], 0 cbsz:4 abid:3
    v_lshlrev_b32_sdwa v136, v15, v114 dst_sel:DWORD dst_unused:UNUSED_PAD src0_sel:DWORD src1_sel:WORD_1
    s_waitcnt vmcnt(4)
    v_mfma_f32_4x4x4_16b_bf16 v[104:107], v[142:143], v[68:69], 0 cbsz:4 abid:2
    v_readlane_b32 s62, v164, 14
    v_mfma_f32_4x4x4_16b_bf16 v[108:111], v[142:143], v[70:71], 0 cbsz:4 abid:2
    v_lshlrev_b32_sdwa v137, v15, v115 dst_sel:DWORD dst_unused:UNUSED_PAD src0_sel:DWORD src1_sel:WORD_1
    ds_read_u16_d16_hi v132, v136 offset:32768
    ds_read_u16_d16_hi v133, v137 offset:32768
    s_and_b32 s33, s62, s34
    buffer_load_dwordx4 v[88:91], v1, s[12:15], s33 offen
    s_waitcnt lgkmcnt(2)
    s_set_gpr_idx_on s56, 0xc
    v_pk_fma_f32 v[16:17], v[128:129], v[96:97], v[16:17] op_sel:[0,0,0] op_sel_hi:[0,1,1]
    v_pk_fma_f32 v[18:19], v[128:129], v[98:99], v[18:19] op_sel:[0,0,0] op_sel_hi:[0,1,1]
    v_pk_fma_f32 v[20:21], v[130:131], v[100:101], v[20:21] op_sel:[0,0,0] op_sel_hi:[0,1,1]
    v_pk_fma_f32 v[22:23], v[130:131], v[102:103], v[22:23] op_sel:[0,0,0] op_sel_hi:[0,1,1]
    s_set_gpr_idx_off
    ds_read_b32 v165, v5
    v_lshlrev_b32_sdwa v138, v15, v118 dst_sel:DWORD dst_unused:UNUSED_PAD src0_sel:DWORD src1_sel:WORD_1
    s_waitcnt vmcnt(4)
    v_mfma_f32_4x4x4_16b_bf16 v[96:99], v[144:145], v[72:73], 0 cbsz:4 abid:2
    v_readlane_b32 s63, v164, 15
    v_mfma_f32_4x4x4_16b_bf16 v[100:103], v[144:145], v[74:75], 0 cbsz:4 abid:2
    v_lshlrev_b32_sdwa v139, v15, v119 dst_sel:DWORD dst_unused:UNUSED_PAD src0_sel:DWORD src1_sel:WORD_1
    ds_read_u16_d16_hi v134, v138 offset:32768
    ds_read_u16_d16_hi v135, v139 offset:32768
    s_and_b32 s33, s63, s34
    buffer_load_dwordx4 v[92:95], v1, s[12:15], s33 offen
    s_set_gpr_idx_on s57, 0xc
    v_pk_fma_f32 v[16:17], v[128:129], v[104:105], v[16:17] op_sel:[1,0,0] op_sel_hi:[1,1,1]
    v_pk_fma_f32 v[18:19], v[128:129], v[106:107], v[18:19] op_sel:[1,0,0] op_sel_hi:[1,1,1]
    v_pk_fma_f32 v[20:21], v[130:131], v[108:109], v[20:21] op_sel:[1,0,0] op_sel_hi:[1,1,1]
    v_pk_fma_f32 v[22:23], v[130:131], v[110:111], v[22:23] op_sel:[1,0,0] op_sel_hi:[1,1,1]
    s_set_gpr_idx_off
    v_mfma_f32_4x4x4_16b_bf16 v[112:115], v[172:173], v[176:177], 0 cbsz:4 abid:4
    v_lshlrev_b32_sdwa v136, v15, v120 dst_sel:DWORD dst_unused:UNUSED_PAD src0_sel:DWORD src1_sel:WORD_1
    s_waitcnt vmcnt(4)
    v_mfma_f32_4x4x4_16b_bf16 v[104:107], v[146:147], v[76:77], 0 cbsz:4 abid:2
    v_readlane_b32 s48, v164, 16
    v_mfma_f32_4x4x4_16b_bf16 v[108:111], v[146:147], v[78:79], 0 cbsz:4 abid:2
    v_lshlrev_b32_sdwa v137, v15, v121 dst_sel:DWORD dst_unused:UNUSED_PAD src0_sel:DWORD src1_sel:WORD_1
    ds_read_u16_d16_hi v128, v136 offset:32768
    ds_read_u16_d16_hi v129, v137 offset:32768
    s_and_b32 s33, s48, s34
    buffer_load_dwordx4 v[64:67], v1, s[12:15], s33 offen
    s_waitcnt lgkmcnt(2)
    s_set_gpr_idx_on s58, 0xc
    v_pk_fma_f32 v[16:17], v[132:133], v[96:97], v[16:17] op_sel:[0,0,0] op_sel_hi:[0,1,1]
    v_pk_fma_f32 v[18:19], v[132:133], v[98:99], v[18:19] op_sel:[0,0,0] op_sel_hi:[0,1,1]
    v_pk_fma_f32 v[20:21], v[134:135], v[100:101], v[20:21] op_sel:[0,0,0] op_sel_hi:[0,1,1]
    v_pk_fma_f32 v[22:23], v[134:135], v[102:103], v[22:23] op_sel:[0,0,0] op_sel_hi:[0,1,1]
    s_set_gpr_idx_off
    v_lshlrev_b32_sdwa v138, v15, v124 dst_sel:DWORD dst_unused:UNUSED_PAD src0_sel:DWORD src1_sel:WORD_1
    s_waitcnt vmcnt(4)
    v_mfma_f32_4x4x4_16b_bf16 v[96:99], v[140:141], v[80:81], 0 cbsz:4 abid:3
    v_readlane_b32 s49, v164, 17
    v_mfma_f32_4x4x4_16b_bf16 v[100:103], v[140:141], v[82:83], 0 cbsz:4 abid:3
    v_lshlrev_b32_sdwa v139, v15, v125 dst_sel:DWORD dst_unused:UNUSED_PAD src0_sel:DWORD src1_sel:WORD_1
    ds_read_u16_d16_hi v130, v138 offset:32768
    ds_read_u16_d16_hi v131, v139 offset:32768
    s_and_b32 s33, s49, s34
    buffer_load_dwordx4 v[68:71], v1, s[12:15], s33 offen
    s_set_gpr_idx_on s59, 0xc
    v_pk_fma_f32 v[16:17], v[132:133], v[104:105], v[16:17] op_sel:[1,0,0] op_sel_hi:[1,1,1]
    v_pk_fma_f32 v[18:19], v[132:133], v[106:107], v[18:19] op_sel:[1,0,0] op_sel_hi:[1,1,1]
    v_pk_fma_f32 v[20:21], v[134:135], v[108:109], v[20:21] op_sel:[1,0,0] op_sel_hi:[1,1,1]
    v_pk_fma_f32 v[22:23], v[134:135], v[110:111], v[22:23] op_sel:[1,0,0] op_sel_hi:[1,1,1]
    s_set_gpr_idx_off
A_12:
    s_sub_u32 s31, s31, 4
    s_cbranch_scc1 TO_B_12
    v_mfma_f32_4x4x4_16b_bf16 v[116:119], v[172:173], v[178:179], 0 cbsz:4 abid:4
    v_lshlrev_b32_sdwa v136, v15, v122 dst_sel:DWORD dst_unused:UNUSED_PAD src0_sel:DWORD src1_sel:WORD_1
    s_waitcnt vmcnt(4)
    v_mfma_f32_4x4x4_16b_bf16 v[104:107], v[142:143], v[84:85], 0 cbsz:4 abid:3
    v_readlane_b32 s50, v164, 18
    v_mfma_f32_4x4x4_16b_bf16 v[108:111], v[142:143], v[86:87], 0 cbsz:4 abid:3
    v_lshlrev_b32_sdwa v137, v15, v123 dst_sel:DWORD dst_unused:UNUSED_PAD src0_sel:DWORD src1_sel:WORD_1
    ds_read_u16_d16_hi v132, v136 offset:32768
    ds_read_u16_d16_hi v133, v137 offset:32768
    s_and_b32 s33, s50, s34
    buffer_load_dwordx4 v[72:75], v1, s[12:15], s33 offen
    s_waitcnt lgkmcnt(2)
    s_set_gpr_idx_on s60, 0xc
    v_pk_fma_f32 v[16:17], v[128:129], v[96:97], v[16:17] op_sel:[0,0,0] op_sel_hi:[0,1,1]
    v_pk_fma_f32 v[18:19], v[128:129], v[98:99], v[18:19] op_sel:[0,0,0] op_sel_hi:[0,1,1]
    v_pk_fma_f32 v[20:21], v[130:131], v[100:101], v[20:21] op_sel:[0,0,0] op_sel_hi:[0,1,1]
    v_pk_fma_f32 v[22:23], v[130:131], v[102:103], v[22:23] op_sel:[0,0,0] op_sel_hi:[0,1,1]
    s_set_gpr_idx_off
    v_cmp_gt_u32 vcc, s30, v6
    v_add_u32 v6, 64, v6
    v_add_u32 v5, 256, v5
    v_cndmask_b32 v165, 40, v165, vcc
    v_lshrrev_b32 v8, 21, v165
    v_lshlrev_b32 v8, 4, v8
    v_lshlrev_b32 v9, 3, v165
    ds_read_b128 v[168:171], v8 offset:8192
    v_and_b32 v9, 0xfffc00, v9
    v_and_or_b32 v165, v165, 56, v9
    v_lshlrev_b32_sdwa v138, v15, v126 dst_sel:DWORD dst_unused:UNUSED_PAD src0_sel:DWORD src1_sel:WORD_1
    s_waitcnt vmcnt(4)
    v_mfma_f32_4x4x4_16b_bf16 v[96:99], v[144:145], v[88:89], 0 cbsz:4 abid:3
    v_readlane_b32 s51, v164, 19
    v_mfma_f32_4x4x4_16b_bf16 v[100:103], v[144:145], v[90:91], 0 cbsz:4 abid:3
    v_lshlrev_b32_sdwa v139, v15, v127 dst_sel:DWORD dst_unused:UNUSED_PAD src0_sel:DWORD src1_sel:WORD_1
    ds_read_u16_d16_hi v134, v138 offset:32768
    ds_read_u16_d16_hi v135, v139 offset:32768
    s_and_b32 s33, s51, s34
    buffer_load_dwordx4 v[76:79], v1, s[12:15], s33 offen
    s_set_gpr_idx_on s61, 0xc
    v_pk_fma_f32 v[16:17], v[128:129], v[104:105], v[16:17] op_sel:[1,0,0] op_sel_hi:[1,1,1]
    v_pk_fma_f32 v[18:19], v[128:129], v[106:107], v[18:19] op_sel:[1,0,0] op_sel_hi:[1,1,1]
    v_pk_fma_f32 v[20:21], v[130:131], v[108:109], v[20:21] op_sel:[1,0,0] op_sel_hi:[1,1,1]
    v_pk_fma_f32 v[22:23], v[130:131], v[110:111], v[22:23] op_sel:[1,0,0] op_sel_hi:[1,1,1]
    s_set_gpr_idx_off
    v_mfma_f32_4x4x4_16b_bf16 v[120:123], v[172:173], v[176:177], 0 cbsz:4 abid:5
    v_lshlrev_b32_sdwa v136, v15, v112 dst_sel:DWORD dst_unused:UNUSED_PAD src0_sel:DWORD src1_sel:WORD_1
    s_waitcnt vmcnt(4)
    v_mfma_f32_4x4x4_16b_bf16 v[104:107], v[146:147], v[92:93], 0 cbsz:4 abid:3
    v_readlane_b32 s52, v164, 20
    v_mfma_f32_4x4x4_16b_bf16 v[108:111], v[146:147], v[94:95], 0 cbsz:4 abid:3
    v_lshlrev_b32_sdwa v137, v15, v113 dst_sel:DWORD dst_unused:UNUSED_PAD src0_sel:DWORD src1_sel:WORD_1
    ds_read_u16_d16_hi v128, v136 offset:32768
    ds_read_u16_d16_hi v129, v137 offset:32768
    s_and_b32 s33, s52, s34
    buffer_load_dwordx4 v[80:83], v1, s[12:15], s33 offen
    s_waitcnt lgkmcnt(2)
    s_set_gpr_idx_on s62, 0xc
    v_pk_fma_f32 v[16:17], v[132:133], v[96:97], v[16:17] op_sel:[0,0,0] op_sel_hi:[0,1,1]
    v_pk_fma_f32 v[18:19], v[132:133], v[98:99], v[18:19] op_sel:[0,0,0] op_sel_hi:[0,1,1]
    v_pk_fma_f32 v[20:21], v[134:135], v[100:101], v[20:21] op_sel:[0,0,0] op_sel_hi:[0,1,1]
    v_pk_fma_f32 v[22:23], v[134:135], v[102:103], v[22:23] op_sel:[0,0,0] op_sel_hi:[0,1,1]
    s_set_gpr_idx_off
    v_lshlrev_b32_sdwa v138, v15, v116 dst_sel:DWORD dst_unused:UNUSED_PAD src0_sel:DWORD src1_sel:WORD_1
    s_waitcnt vmcnt(4)
    v_mfma_f32_4x4x4_16b_bf16 v[96:99], v[140:141], v[64:65], 0 cbsz:4 abid:4
    v_readlane_b32 s53, v164, 21
    v_mfma_f32_4x4x4_16b_bf16 v[100:103], v[140:141], v[66:67], 0 cbsz:4 abid:4
    v_lshlrev_b32_sdwa v139, v15, v117 dst_sel:DWORD dst_unused:UNUSED_PAD src0_sel:DWORD src1_sel:WORD_1
    ds_read_u16_d16_hi v130, v138 offset:32768
    ds_read_u16_d16_hi v131, v139 offset:32768
    s_and_b32 s33, s53, s34
    buffer_load_dwordx4 v[84:87], v1, s[12:15], s33 offen
    s_set_gpr_idx_on s63, 0xc
    v_pk_fma_f32 v[16:17], v[132:133], v[104:105], v[16:17] op_sel:[1,0,0] op_sel_hi:[1,1,1]
    v_pk_fma_f32 v[18:19], v[132:133], v[106:107], v[18:19] op_sel:[1,0,0] op_sel_hi:[1,1,1]
    v_pk_fma_f32 v[20:21], v[134:135], v[108:109], v[20:21] op_sel:[1,0,0] op_sel_hi:[1,1,1]
    v_pk_fma_f32 v[22:23], v[134:135], v[110:111], v[22:23] op_sel:[1,0,0] op_sel_hi:[1,1,1]
    s_set_gpr_idx_off
A_16:
    s_sub_u32 s31, s31, 4
    s_cbranch_scc1 TO_B_16
    v_mfma_f32_4x4x4_16b_bf16 v[124:127], v[172:173], v[178:179], 0 cbsz:4 abid:5
    v_lshlrev_b32_sdwa v136, v15, v114 dst_sel:DWORD dst_unused:UNUSED_PAD src0_sel:DWORD src1_sel:WORD_1
    s_waitcnt vmcnt(4)
    v_mfma_f32_4x4x4_16b_bf16 v[104:107], v[142:143], v[68:69], 0 cbsz:4 abid:4
    v_readlane_b32 s54, v164, 22
    v_mfma_f32_4x4x4_16b_bf16 v[108:111], v[142:143], v[70:71], 0 cbsz:4 abid:4
    v_lshlrev_b32_sdwa v137, v15, v115 dst_sel:DWORD dst_unused:UNUSED_PAD src0_sel:DWORD src1_sel:WORD_1
    ds_read_u16_d16_hi v132, v136 offset:32768
    ds_read_u16_d16_hi v133, v137 offset:32768
    s_and_b32 s33, s54, s34
    buffer_load_dwordx4 v[88:91], v1, s[12:15], s33 offen
    s_waitcnt lgkmcnt(2)
    s_set_gpr_idx_on s48, 0xc
    v_pk_fma_f32 v[16:17], v[128:129], v[96:97], v[16:17] op_sel:[0,0,0] op_sel_hi:[0,1,1]
    v_pk_fma_f32 v[18:19], v[128:129], v[98:99], v[18:19] op_sel:[0,0,0] op_sel_hi:[0,1,1]
    v_pk_fma_f32 v[20:21], v[130:131], v[100:101], v[20:21] op_sel:[0,0,0] op_sel_hi:[0,1,1]
    v_pk_fma_f32 v[22:23], v[130:131], v[102:103], v[22:23] op_sel:[0,0,0] op_sel_hi:[0,1,1]
    s_set_gpr_idx_off
    v_lshlrev_b32_sdwa v138, v15, v118 dst_sel:DWORD dst_unused:UNUSED_PAD src0_sel:DWORD src1_sel:WORD_1
    s_waitcnt vmcnt(4)
    v_mfma_f32_4x4x4_16b_bf16 v[96:99], v[144:145], v[72:73], 0 cbsz:4 abid:4
    v_readlane_b32 s55, v164, 23
    v_mfma_f32_4x4x4_16b_bf16 v[100:103], v[144:145], v[74:75], 0 cbsz:4 abid:4
    v_lshlrev_b32_sdwa v139, v15, v119 dst_sel:DWORD dst_unused:UNUSED_PAD src0_sel:DWORD src1_sel:WORD_1
    ds_read_u16_d16_hi v134, v138 offset:32768
    ds_read_u16_d16_hi v135, v139 offset:32768
    s_and_b32 s33, s55, s34
    buffer_load_dwordx4 v[92:95], v1, s[12:15], s33 offen
    s_set_gpr_idx_on s49, 0xc
    v_pk_fma_f32 v[16:17], v[128:129], v[104:105], v[16:17] op_sel:[1,0,0] op_sel_hi:[1,1,1]
    v_pk_fma_f32 v[18:19], v[128:129], v[106:107], v[18:19] op_sel:[1,0,0] op_sel_hi:[1,1,1]
    v_pk_fma_f32 v[20:21], v[130:131], v[108:109], v[20:21] op_sel:[1,0,0] op_sel_hi:[1,1,1]
    v_pk_fma_f32 v[22:23], v[130:131], v[110:111], v[22:23] op_sel:[1,0,0] op_sel_hi:[1,1,1]
    s_set_gpr_idx_off
    v_mfma_f32_4x4x4_16b_bf16 v[112:115], v[172:173], v[176:177], 0 cbsz:4 abid:6
    v_lshlrev_b32_sdwa v136, v15, v120 dst_sel:DWORD dst_unused:UNUSED_PAD src0_sel:DWORD src1_sel:WORD_1
    s_waitcnt vmcnt(4)
    v_mfma_f32_4x4x4_16b_bf16 v[104:107], v[146:147], v[76:77], 0 cbsz:4 abid:4
    v_readlane_b32 s56, v164, 24
    v_mfma_f32_4x4x4_16b_bf16 v[108:111], v[146:147], v[78:79], 0 cbsz:4 abid:4
    v_lshlrev_b32_sdwa v137, v15, v121 dst_sel:DWORD dst_unused:UNUSED_PAD src0_sel:DWORD src1_sel:WORD_1
    ds_read_u16_d16_hi v128, v136 offset:32768
    ds_read_u16_d16_hi v129, v137 offset:32768
    s_and_b32 s33, s56, s34
    buffer_load_dwordx4 v[64:67], v1, s[12:15], s33 offen
    s_waitcnt lgkmcnt(2)
    s_set_gpr_idx_on s50, 0xc
    v_pk_fma_f32 v[16:17], v[132:133], v[96:97], v[16:17] op_sel:[0,0,0] op_sel_hi:[0,1,1]
    v_pk_fma_f32 v[18:19], v[132:133], v[98:99], v[18:19] op_sel:[0,0,0] op_sel_hi:[0,1,1]
    v_pk_fma_f32 v[20:21], v[134:135], v[100:101], v[20:21] op_sel:[0,0,0] op_sel_hi:[0,1,1]
    v_pk_fma_f32 v[22:23], v[134:135], v[102:103], v[22:23] op_sel:[0,0,0] op_sel_hi:[0,1,1]
    s_set_gpr_idx_off
    v_lshlrev_b32_sdwa v138, v15, v124 dst_sel:DWORD dst_unused:UNUSED_PAD src0_sel:DWORD src1_sel:WORD_1
    s_waitcnt vmcnt(4)
    v_mfma_f32_4x4x4_16b_bf16 v[96:99], v[140:141], v[80:81], 0 cbsz:4 abid:5
    v_readlane_b32 s57, v164, 25
    v_mfma_f32_4x4x4_16b_bf16 v[100:103], v[140:141], v[82:83], 0 cbsz:4 abid:5
    v_lshlrev_b32_sdwa v139, v15, v125 dst_sel:DWORD dst_unused:UNUSED_PAD src0_sel:DWORD src1_sel:WORD_1
    ds_read_u16_d16_hi v130, v138 offset:32768
    ds_read_u16_d16_hi v131, v139 offset:32768
    s_and_b32 s33, s57, s34
    buffer_load_dwordx4 v[68:71], v1, s[12:15], s33 offen
    s_set_gpr_idx_on s51, 0xc
    v_pk_fma_f32 v[16:17], v[132:133], v[104:105], v[16:17] op_sel:[1,0,0] op_sel_hi:[1,1,1]
    v_pk_fma_f32 v[18:19], v[132:133], v[106:107], v[18:19] op_sel:[1,0,0] op_sel_hi:[1,1,1]
    v_pk_fma_f32 v[20:21], v[134:135], v[108:109], v[20:21] op_sel:[1,0,0] op_sel_hi:[1,1,1]
    v_pk_fma_f32 v[22:23], v[134:135], v[110:111], v[22:23] op_sel:[1,0,0] op_sel_hi:[1,1,1]
    s_set_gpr_idx_off
A_20:
    s_sub_u32 s31, s31, 4
    s_cbranch_scc1 TO_B_20
    v_mfma_f32_4x4x4_16b_bf16 v[116:119], v[172:173], v[178:179], 0 cbsz:4 abid:6
    v_lshlrev_b32_sdwa v136, v15, v122 dst_sel:DWORD dst_unused:UNUSED_PAD src0_sel:DWORD src1_sel:WORD_1
    s_waitcnt vmcnt(4)
    v_mfma_f32_4x4x4_16b_bf16 v[104:107], v[142:143], v[84:85], 0 cbsz:4 abid:5
    v_readlane_b32 s58, v164, 26
    v_mfma_f32_4x4x4_16b_bf16 v[108:111], v[142:143], v[86:87], 0 cbsz:4 abid:5
    v_lshlrev_b32_sdwa v137, v15, v123 dst_sel:DWORD dst_unused:UNUSED_PAD src0_sel:DWORD src1_sel:WORD_1
    ds_read_u16_d16_hi v132, v136 offset:32768
    ds_read_u16_d16_hi v133, v137 offset:32768
    s_and_b32 s33, s58, s34
    buffer_load_dwordx4 v[72:75], v1, s[12:15], s33 offen
    s_waitcnt lgkmcnt(2)
    s_set_gpr_idx_on s52, 0xc
    v_pk_fma_f32 v[16:17], v[128:129], v[96:97], v[16:17] op_sel:[0,0,0] op_sel_hi:[0,1,1]
    v_pk_fma_f32 v[18:19], v[128:129], v[98:99], v[18:19] op_sel:[0,0,0] op_sel_hi:[0,1,1]
    v_pk_fma_f32 v[20:21], v[130:131], v[100:101], v[20:21] op_sel:[0,0,0] op_sel_hi:[0,1,1]
    v_pk_fma_f32 v[22:23], v[130:131], v[102:103], v[22:23] op_sel:[0,0,0] op_sel_hi:[0,1,1]
    s_set_gpr_idx_off
    v_lshlrev_b32_sdwa v138, v15, v126 dst_sel:DWORD dst_unused:UNUSED_PAD src0_sel:DWORD src1_sel:WORD_1
    s_waitcnt vmcnt(4)
    v_mfma_f32_4x4x4_16b_bf16 v[96:99], v[144:145], v[88:89], 0 cbsz:4 abid:5
    v_readlane_b32 s59, v164, 27
    v_mfma_f32_4x4x4_16b_bf16 v[100:103], v[144:145], v[90:91], 0 cbsz:4 abid:5
    v_lshlrev_b32_sdwa v139, v15, v127 dst_sel:DWORD dst_unused:UNUSED_PAD src0_sel:DWORD src1_sel:WORD_1
    ds_read_u16_d16_hi v134, v138 offset:32768
    ds_read_u16_d16_hi v135, v139 offset:32768
    s_and_b32 s33, s59, s34
    buffer_load_dwordx4 v[76:79], v1, s[12:15], s33 offen
    s_set_gpr_idx_on s53, 0xc
    v_pk_fma_f32 v[16:17], v[128:129], v[104:105], v[16:17] op_sel:[1,0,0] op_sel_hi:[1,1,1]
    v_pk_fma_f32 v[18:19], v[128:129], v[106:107], v[18:19] op_sel:[1,0,0] op_sel_hi:[1,1,1]
    v_pk_fma_f32 v[20:21], v[130:131], v[108:109], v[20:21] op_sel:[1,0,0] op_sel_hi:[1,1,1]
    v_pk_fma_f32 v[22:23], v[130:131], v[110:111], v[22:23] op_sel:[1,0,0] op_sel_hi:[1,1,1]
    s_set_gpr_idx_off
    v_mfma_f32_4x4x4_16b_bf16 v[120:123], v[172:173], v[176:177], 0 cbsz:4 abid:7
    v_lshlrev_b32_sdwa v136, v15, v112 dst_sel:DWORD dst_unused:UNUSED_PAD src0_sel:DWORD src1_sel:WORD_1
    s_waitcnt vmcnt(4)
    v_mfma_f32_4x4x4_16b_bf16 v[104:107], v[146:147], v[92:93], 0 cbsz:4 abid:5
    v_readlane_b32 s60, v164, 28
    v_mfma_f32_4x4x4_16b_bf16 v[108:111], v[146:147], v[94:95], 0 cbsz:4 abid:5
    v_lshlrev_b32_sdwa v137, v15, v113 dst_sel:DWORD dst_unused:UNUSED_PAD src0_sel:DWORD src1_sel:WORD_1
    ds_read_u16_d16_hi v128, v136 offset:32768
    ds_read_u16_d16_hi v129, v137 offset:32768
    s_and_b32 s33, s60, s34
    buffer_load_dwordx4 v[80:83], v1, s[12:15], s33 offen
    s_waitcnt lgkmcnt(2)
    s_set_gpr_idx_on s54, 0xc
    v_pk_fma_f32 v[16:17], v[132:133], v[96:97], v[16:17] op_sel:[0,0,0] op_sel_hi:[0,1,1]
    v_pk_fma_f32 v[18:19], v[132:133], v[98:99], v[18:19] op_sel:[0,0,0] op_sel_hi:[0,1,1]
    v_pk_fma_f32 v[20:21], v[134:135], v[100:101], v[20:21] op_sel:[0,0,0] op_sel_hi:[0,1,1]
    v_pk_fma_f32 v[22:23], v[134:135], v[102:103], v[22:23] op_sel:[0,0,0] op_sel_hi:[0,1,1]
    s_set_gpr_idx_off
    v_lshlrev_b32_sdwa v138, v15, v116 dst_sel:DWORD dst_unused:UNUSED_PAD src0_sel:DWORD src1_sel:WORD_1
    s_waitcnt vmcnt(4)
    v_mfma_f32_4x4x4_16b_bf16 v[96:99], v[140:141], v[64:65], 0 cbsz:4 abid:6
    v_readlane_b32 s61, v164, 29
    v_mfma_f32_4x4x4_16b_bf16 v[100:103], v[140:141], v[66:67], 0 cbsz:4 abid:6
    v_lshlrev_b32_sdwa v139, v15, v117 dst_sel:DWORD dst_unused:UNUSED_PAD src0_sel:DWORD src1_sel:WORD_1
    ds_read_u16_d16_hi v130, v138 offset:32768
    ds_read_u16_d16_hi v131, v139 offset:32768
    s_and_b32 s33, s61, s34
    buffer_load_dwordx4 v[84:87], v1, s[12:15], s33 offen
    s_set_gpr_idx_on s55, 0xc
    v_pk_fma_f32 v[16:17], v[132:133], v[104:105], v[16:17] op_sel:[1,0,0] op_sel_hi:[1,1,1]
    v_pk_fma_f32 v[18:19], v[132:133], v[106:107], v[18:19] op_sel:[1,0,0] op_sel_hi:[1,1,1]
    v_pk_fma_f32 v[20:21], v[134:135], v[108:109], v[20:21] op_sel:[1,0,0] op_sel_hi:[1,1,1]
    v_pk_fma_f32 v[22:23], v[134:135], v[110:111], v[22:23] op_sel:[1,0,0] op_sel_hi:[1,1,1]
    s_set_gpr_idx_off
A_24:
    s_sub_u32 s31, s31, 4
    s_cbranch_scc1 TO_B_24
    v_mfma_f32_4x4x4_16b_bf16 v[124:127], v[172:173], v[178:179], 0 cbsz:4 abid:7
    v_lshlrev_b32_sdwa v136, v15, v114 dst_sel:DWORD dst_unused:UNUSED_PAD src0_sel:DWORD src1_sel:WORD_1
    s_waitcnt vmcnt(4)
    v_mfma_f32_4x4x4_16b_bf16 v[104:107], v[142:143], v[68:69], 0 cbsz:4 abid:6
    v_readlane_b32 s62, v164, 30
    v_mfma_f32_4x4x4_16b_bf16 v[108:111], v[142:143], v[70:71], 0 cbsz:4 abid:6
    v_lshlrev_b32_sdwa v137, v15, v115 dst_sel:DWORD dst_unused:UNUSED_PAD src0_sel:DWORD src1_sel:WORD_1
    ds_read_u16_d16_hi v132, v136 offset:32768
    ds_read_u16_d16_hi v133, v137 offset:32768
    s_and_b32 s33, s62, s34
    buffer_load_dwordx4 v[88:91], v1, s[12:15], s33 offen
    s_waitcnt lgkmcnt(2)
    s_set_gpr_idx_on s56, 0xc
    v_pk_fma_f32 v[16:17], v[128:129], v[96:97], v[16:17] op_sel:[0,0,0] op_sel_hi:[0,1,1]
    v_pk_fma_f32 v[18:19], v[128:129], v[98:99], v[18:19] op_sel:[0,0,0] op_sel_hi:[0,1,1]
    v_pk_fma_f32 v[20:21], v[130:131], v[100:101], v[20:21] op_sel:[0,0,0] op_sel_hi:[0,1,1]
    v_pk_fma_f32 v[22:23], v[130:131], v[102:103], v[22:23] op_sel:[0,0,0] op_sel_hi:[0,1,1]
    s_set_gpr_idx_off
    v_lshlrev_b32_sdwa v138, v15, v118 dst_sel:DWORD dst_unused:UNUSED_PAD src0_sel:DWORD src1_sel:WORD_1
    s_waitcnt vmcnt(4)
    v_mfma_f32_4x4x4_16b_bf16 v[96:99], v[144:145], v[72:73], 0 cbsz:4 abid:6
    v_readlane_b32 s63, v164, 31
    v_mfma_f32_4x4x4_16b_bf16 v[100:103], v[144:145], v[74:75], 0 cbsz:4 abid:6
    v_lshlrev_b32_sdwa v139, v15, v119 dst_sel:DWORD dst_unused:UNUSED_PAD src0_sel:DWORD src1_sel:WORD_1
    ds_read_u16_d16_hi v134, v138 offset:32768
    ds_read_u16_d16_hi v135, v139 offset:32768
    s_and_b32 s33, s63, s34
    buffer_load_dwordx4 v[92:95], v1, s[12:15], s33 offen
    s_set_gpr_idx_on s57, 0xc
    v_pk_fma_f32 v[16:17], v[128:129], v[104:105], v[16:17] op_sel:[1,0,0] op_sel_hi:[1,1,1]
    v_pk_fma_f32 v[18:19], v[128:129], v[106:107], v[18:19] op_sel:[1,0,0] op_sel_hi:[1,1,1]
    v_pk_fma_f32 v[20:21], v[130:131], v[108:109], v[20:21] op_sel:[1,0,0] op_sel_hi:[1,1,1]
    v_pk_fma_f32 v[22:23], v[130:131], v[110:111], v[22:23] op_sel:[1,0,0] op_sel_hi:[1,1,1]
    s_set_gpr_idx_off
    v_mfma_f32_4x4x4_16b_bf16 v[112:115], v[172:173], v[176:177], 0 cbsz:4 abid:8
    v_lshlrev_b32_sdwa v136, v15, v120 dst_sel:DWORD dst_unused:UNUSED_PAD src0_sel:DWORD src1_sel:WORD_1
    s_waitcnt vmcnt(4)
    v_mfma_f32_4x4x4_16b_bf16 v[104:107], v[146:147], v[76:77], 0 cbsz:4 abid:6
    v_readlane_b32 s48, v164, 32
    v_mfma_f32_4x4x4_16b_bf16 v[108:111], v[146:147], v[78:79], 0 cbsz:4 abid:6
    v_lshlrev_b32_sdwa v137, v15, v121 dst_sel:DWORD dst_unused:UNUSED_PAD src0_sel:DWORD src1_sel:WORD_1
    ds_read_u16_d16_hi v128, v136 offset:32768
    ds_read_u16_d16_hi v129, v137 offset:32768
    s_and_b32 s33, s48, s34
    buffer_load_dwordx4 v[64:67], v1, s[12:15], s33 offen
    s_waitcnt lgkmcnt(2)
    s_set_gpr_idx_on s58, 0xc
    v_pk_fma_f32 v[16:17], v[132:133], v[96:97], v[16:17] op_sel:[0,0,0] op_sel_hi:[0,1,1]
    v_pk_fma_f32 v[18:19], v[132:133], v[98:99], v[18:19] op_sel:[0,0,0] op_sel_hi:[0,1,1]
    v_pk_fma_f32 v[20:21], v[134:135], v[100:101], v[20:21] op_sel:[0,0,0] op_sel_hi:[0,1,1]
    v_pk_fma_f32 v[22:23], v[134:135], v[102:103], v[22:23] op_sel:[0,0,0] op_sel_hi:[0,1,1]
    s_set_gpr_idx_off
    v_lshlrev_b32_sdwa v138, v15, v124 dst_sel:DWORD dst_unused:UNUSED_PAD src0_sel:DWORD src1_sel:WORD_1
    s_waitcnt vmcnt(4)
    v_mfma_f32_4x4x4_16b_bf16 v[96:99], v[140:141], v[80:81], 0 cbsz:4 abid:7
    v_readlane_b32 s49, v164, 33
    v_mfma_f32_4x4x4_16b_bf16 v[100:103], v[140:141], v[82:83], 0 cbsz:4 abid:7
    v_lshlrev_b32_sdwa v139, v15, v125 dst_sel:DWORD dst_unused:UNUSED_PAD src0_sel:DWORD src1_sel:WORD_1
    ds_read_u16_d16_hi v130, v138 offset:32768
    ds_read_u16_d16_hi v131, v139 offset:32768
    s_and_b32 s33, s49, s34
    buffer_load_dwordx4 v[68:71], v1, s[12:15], s33 offen
    s_set_gpr_idx_on s59, 0xc
    v_pk_fma_f32 v[16:17], v[132:133], v[104:105], v[16:17] op_sel:[1,0,0] op_sel_hi:[1,1,1]
    v_pk_fma_f32 v[18:19], v[132:133], v[106:107], v[18:19] op_sel:[1,0,0] op_sel_hi:[1,1,1]
    v_pk_fma_f32 v[20:21], v[134:135], v[108:109], v[20:21] op_sel:[1,0,0] op_sel_hi:[1,1,1]
    v_pk_fma_f32 v[22:23], v[134:135], v[110:111], v[22:23] op_sel:[1,0,0] op_sel_hi:[1,1,1]
    s_set_gpr_idx_off
A_28:
    s_sub_u32 s31, s31, 4
    s_cbranch_scc1 TO_B_28
    v_mfma_f32_4x4x4_16b_bf16 v[116:119], v[172:173], v[178:179], 0 cbsz:4 abid:8
    v_lshlrev_b32_sdwa v136, v15, v122 dst_sel:DWORD dst_unused:UNUSED_PAD src0_sel:DWORD src1_sel:WORD_1
    s_waitcnt vmcnt(4)
    v_mfma_f32_4x4x4_16b_bf16 v[104:107], v[142:143], v[84:85], 0 cbsz:4 abid:7
    v_readlane_b32 s50, v164, 34
    v_mfma_f32_4x4x4_16b_bf16 v[108:111], v[142:143], v[86:87], 0 cbsz:4 abid:7
    v_lshlrev_b32_sdwa v137, v15, v123 dst_sel:DWORD dst_unused:UNUSED_PAD src0_sel:DWORD src1_sel:WORD_1
    ds_read_u16_d16_hi v132, v136 offset:32768
    ds_read_u16_d16_hi v133, v137 offset:32768
    s_and_b32 s33, s50, s34
    buffer_load_dwordx4 v[72:75], v1, s[12:15], s33 offen
    s_waitcnt lgkmcnt(2)
    s_set_gpr_idx_on s60, 0xc
    v_pk_fma_f32 v[16:17], v[128:129], v[96:97], v[16:17] op_sel:[0,0,0] op_sel_hi:[0,1,1]
    v_pk_fma_f32 v[18:19], v[128:129], v[98:99], v[18:19] op_sel:[0,0,0] op_sel_hi:[0,1,1]
    v_pk_fma_f32 v[20:21], v[130:131], v[100:101], v[20:21] op_sel:[0,0,0] op_sel_hi:[0,1,1]
    v_pk_fma_f32 v[22:23], v[130:131], v[102:103], v[22:23] op_sel:[0,0,0] op_sel_hi:[0,1,1]
    s_set_gpr_idx_off
    v_lshlrev_b32_sdwa v138, v15, v126 dst_sel:DWORD dst_unused:UNUSED_PAD src0_sel:DWORD src1_sel:WORD_1
    s_waitcnt vmcnt(4)
    v_mfma_f32_4x4x4_16b_bf16 v[96:99], v[144:145], v[88:89], 0 cbsz:4 abid:7
    v_readlane_b32 s51, v164, 35
    v_mfma_f32_4x4x4_16b_bf16 v[100:103], v[144:145], v[90:91], 0 cbsz:4 abid:7
    v_lshlrev_b32_sdwa v139, v15, v127 dst_sel:DWORD dst_unused:UNUSED_PAD src0_sel:DWORD src1_sel:WORD_1
    ds_read_u16_d16_hi v134, v138 offset:32768
    ds_read_u16_d16_hi v135, v139 offset:32768
    s_and_b32 s33, s51, s34
    buffer_load_dwordx4 v[76:79], v1, s[12:15], s33 offen
    s_set_gpr_idx_on s61, 0xc
    v_pk_fma_f32 v[16:17], v[128:129], v[104:105], v[16:17] op_sel:[1,0,0] op_sel_hi:[1,1,1]
    v_pk_fma_f32 v[18:19], v[128:129], v[106:107], v[18:19] op_sel:[1,0,0] op_sel_hi:[1,1,1]
    v_pk_fma_f32 v[20:21], v[130:131], v[108:109], v[20:21] op_sel:[1,0,0] op_sel_hi:[1,1,1]
    v_pk_fma_f32 v[22:23], v[130:131], v[110:111], v[22:23] op_sel:[1,0,0] op_sel_hi:[1,1,1]
    s_set_gpr_idx_off
    v_mfma_f32_4x4x4_16b_bf16 v[120:123], v[172:173], v[176:177], 0 cbsz:4 abid:9
    v_lshlrev_b32_sdwa v136, v15, v112 dst_sel:DWORD dst_unused:UNUSED_PAD src0_sel:DWORD src1_sel:WORD_1
    s_waitcnt vmcnt(4)
    v_mfma_f32_4x4x4_16b_bf16 v[104:107], v[146:147], v[92:93], 0 cbsz:4 abid:7
    v_readlane_b32 s52, v164, 36
    v_mfma_f32_4x4x4_16b_bf16 v[108:111], v[146:147], v[94:95], 0 cbsz:4 abid:7
    v_lshlrev_b32_sdwa v137, v15, v113 dst_sel:DWORD dst_unused:UNUSED_PAD src0_sel:DWORD src1_sel:WORD_1
    ds_read_u16_d16_hi v128, v136 offset:32768
    ds_read_u16_d16_hi v129, v137 offset:32768
    s_and_b32 s33, s52, s34
    buffer_load_dwordx4 v[80:83], v1, s[12:15], s33 offen
    s_waitcnt lgkmcnt(2)
    s_set_gpr_idx_on s62, 0xc
    v_pk_fma_f32 v[16:17], v[132:133], v[96:97], v[16:17] op_sel:[0,0,0] op_sel_hi:[0,1,1]
    v_pk_fma_f32 v[18:19], v[132:133], v[98:99], v[18:19] op_sel:[0,0,0] op_sel_hi:[0,1,1]
    v_pk_fma_f32 v[20:21], v[134:135], v[100:101], v[20:21] op_sel:[0,0,0] op_sel_hi:[0,1,1]
    v_pk_fma_f32 v[22:23], v[134:135], v[102:103], v[22:23] op_sel:[0,0,0] op_sel_hi:[0,1,1]
    s_set_gpr_idx_off
    v_lshlrev_b32_sdwa v138, v15, v116 dst_sel:DWORD dst_unused:UNUSED_PAD src0_sel:DWORD src1_sel:WORD_1
    s_waitcnt vmcnt(4)
    v_mfma_f32_4x4x4_16b_bf16 v[96:99], v[140:141], v[64:65], 0 cbsz:4 abid:8
    v_readlane_b32 s53, v164, 37
    v_mfma_f32_4x4x4_16b_bf16 v[100:103], v[140:141], v[66:67], 0 cbsz:4 abid:8
    v_lshlrev_b32_sdwa v139, v15, v117 dst_sel:DWORD dst_unused:UNUSED_PAD src0_sel:DWORD src1_sel:WORD_1
    ds_read_u16_d16_hi v130, v138 offset:32768
    ds_read_u16_d16_hi v131, v139 offset:32768
    s_and_b32 s33, s53, s34
    buffer_load_dwordx4 v[84:87], v1, s[12:15], s33 offen
    s_set_gpr_idx_on s63, 0xc
    v_pk_fma_f32 v[16:17], v[132:133], v[104:105], v[16:17] op_sel:[1,0,0] op_sel_hi:[1,1,1]
    v_pk_fma_f32 v[18:19], v[132:133], v[106:107], v[18:19] op_sel:[1,0,0] op_sel_hi:[1,1,1]
    v_pk_fma_f32 v[20:21], v[134:135], v[108:109], v[20:21] op_sel:[1,0,0] op_sel_hi:[1,1,1]
    v_pk_fma_f32 v[22:23], v[134:135], v[110:111], v[22:23] op_sel:[1,0,0] op_sel_hi:[1,1,1]
    s_set_gpr_idx_off
A_32:
    s_sub_u32 s31, s31, 4
    s_cbranch_scc1 TO_B_32
    v_mfma_f32_4x4x4_16b_bf16 v[124:127], v[172:173], v[178:179], 0 cbsz:4 abid:9
    v_lshlrev_b32_sdwa v136, v15, v114 dst_sel:DWORD dst_unused:UNUSED_PAD src0_sel:DWORD src1_sel:WORD_1
    s_waitcnt vmcnt(4)
    v_mfma_f32_4x4x4_16b_bf16 v[104:107], v[142:143], v[68:69], 0 cbsz:4 abid:8
    v_readlane_b32 s54, v164, 38
    v_mfma_f32_4x4x4_16b_bf16 v[108:111], v[142:143], v[70:71], 0 cbsz:4 abid:8
    v_lshlrev_b32_sdwa v137, v15, v115 dst_sel:DWORD dst_unused:UNUSED_PAD src0_sel:DWORD src1_sel:WORD_1
    ds_read_u16_d16_hi v132, v136 offset:32768
    ds_read_u16_d16_hi v133, v137 offset:32768
    s_and_b32 s33, s54, s34
    buffer_load_dwordx4 v[88:91], v1, s[12:15], s33 offen
    s_waitcnt lgkmcnt(2)
    s_set_gpr_idx_on s48, 0xc
    v_pk_fma_f32 v[16:17], v[128:129], v[96:97], v[16:17] op_sel:[0,0,0] op_sel_hi:[0,1,1]
    v_pk_fma_f32 v[18:19], v[128:129], v[98:99], v[18:19] op_sel:[0,0,0] op_sel_hi:[0,1,1]
    v_pk_fma_f32 v[20:21], v[130:131], v[100:101], v[20:21] op_sel:[0,0,0] op_sel_hi:[0,1,1]
    v_pk_fma_f32 v[22:23], v[130:131], v[102:103], v[22:23] op_sel:[0,0,0] op_sel_hi:[0,1,1]
    s_set_gpr_idx_off
    v_lshlrev_b32_sdwa v138, v15, v118 dst_sel:DWORD dst_unused:UNUSED_PAD src0_sel:DWORD src1_sel:WORD_1
    s_waitcnt vmcnt(4)
    v_mfma_f32_4x4x4_16b_bf16 v[96:99], v[144:145], v[72:73], 0 cbsz:4 abid:8
    v_readlane_b32 s55, v164, 39
    v_mfma_f32_4x4x4_16b_bf16 v[100:103], v[144:145], v[74:75], 0 cbsz:4 abid:8
    v_lshlrev_b32_sdwa v139, v15, v119 dst_sel:DWORD dst_unused:UNUSED_PAD src0_sel:DWORD src1_sel:WORD_1
    ds_read_u16_d16_hi v134, v138 offset:32768
    ds_read_u16_d16_hi v135, v139 offset:32768
    s_and_b32 s33, s55, s34
    buffer_load_dwordx4 v[92:95], v1, s[12:15], s33 offen
    s_set_gpr_idx_on s49, 0xc
    v_pk_fma_f32 v[16:17], v[128:129], v[104:105], v[16:17] op_sel:[1,0,0] op_sel_hi:[1,1,1]
    v_pk_fma_f32 v[18:19], v[128:129], v[106:107], v[18:19] op_sel:[1,0,0] op_sel_hi:[1,1,1]
    v_pk_fma_f32 v[20:21], v[130:131], v[108:109], v[20:21] op_sel:[1,0,0] op_sel_hi:[1,1,1]
    v_pk_fma_f32 v[22:23], v[130:131], v[110:111], v[22:23] op_sel:[1,0,0] op_sel_hi:[1,1,1]
    s_set_gpr_idx_off
    v_mfma_f32_4x4x4_16b_bf16 v[112:115], v[172:173], v[176:177], 0 cbsz:4 abid:10
    v_lshlrev_b32_sdwa v136, v15, v120 dst_sel:DWORD dst_unused:UNUSED_PAD src0_sel:DWORD src1_sel:WORD_1
    s_waitcnt vmcnt(4)
    v_mfma_f32_4x4x4_16b_bf16 v[104:107], v[146:147], v[76:77], 0 cbsz:4 abid:8
    v_readlane_b32 s56, v164, 40
    v_mfma_f32_4x4x4_16b_bf16 v[108:111], v[146:147], v[78:79], 0 cbsz:4 abid:8
    v_lshlrev_b32_sdwa v137, v15, v121 dst_sel:DWORD dst_unused:UNUSED_PAD src0_sel:DWORD src1_sel:WORD_1
    ds_read_u16_d16_hi v128, v136 offset:32768
    ds_read_u16_d16_hi v129, v137 offset:32768
    s_and_b32 s33, s56, s34
    buffer_load_dwordx4 v[64:67], v1, s[12:15], s33 offen
    s_waitcnt lgkmcnt(2)
    s_set_gpr_idx_on s50, 0xc
    v_pk_fma_f32 v[16:17], v[132:133], v[96:97], v[16:17] op_sel:[0,0,0] op_sel_hi:[0,1,1]
    v_pk_fma_f32 v[18:19], v[132:133], v[98:99], v[18:19] op_sel:[0,0,0] op_sel_hi:[0,1,1]
    v_pk_fma_f32 v[20:21], v[134:135], v[100:101], v[20:21] op_sel:[0,0,0] op_sel_hi:[0,1,1]
    v_pk_fma_f32 v[22:23], v[134:135], v[102:103], v[22:23] op_sel:[0,0,0] op_sel_hi:[0,1,1]
    s_set_gpr_idx_off
    v_lshlrev_b32_sdwa v138, v15, v124 dst_sel:DWORD dst_unused:UNUSED_PAD src0_sel:DWORD src1_sel:WORD_1
    s_waitcnt vmcnt(4)
    v_mfma_f32_4x4x4_16b_bf16 v[96:99], v[140:141], v[80:81], 0 cbsz:4 abid:9
    v_readlane_b32 s57, v164, 41
    v_mfma_f32_4x4x4_16b_bf16 v[100:103], v[140:141], v[82:83], 0 cbsz:4 abid:9
    v_lshlrev_b32_sdwa v139, v15, v125 dst_sel:DWORD dst_unused:UNUSED_PAD src0_sel:DWORD src1_sel:WORD_1
    ds_read_u16_d16_hi v130, v138 offset:32768
    ds_read_u16_d16_hi v131, v139 offset:32768
    s_and_b32 s33, s57, s34
    buffer_load_dwordx4 v[68:71], v1, s[12:15], s33 offen
    s_set_gpr_idx_on s51, 0xc
    v_pk_fma_f32 v[16:17], v[132:133], v[104:105], v[16:17] op_sel:[1,0,0] op_sel_hi:[1,1,1]
    v_pk_fma_f32 v[18:19], v[132:133], v[106:107], v[18:19] op_sel:[1,0,0] op_sel_hi:[1,1,1]
    v_pk_fma_f32 v[20:21], v[134:135], v[108:109], v[20:21] op_sel:[1,0,0] op_sel_hi:[1,1,1]
    v_pk_fma_f32 v[22:23], v[134:135], v[110:111], v[22:23] op_sel:[1,0,0] op_sel_hi:[1,1,1]
    s_set_gpr_idx_off
A_36:
    s_sub_u32 s31, s31, 4
    s_cbranch_scc1 TO_B_36
    v_mfma_f32_4x4x4_16b_bf16 v[116:119], v[172:173], v[178:179], 0 cbsz:4 abid:10
    v_lshlrev_b32_sdwa v136, v15, v122 dst_sel:DWORD dst_unused:UNUSED_PAD src0_sel:DWORD src1_sel:WORD_1
    s_waitcnt vmcnt(4)
    v_mfma_f32_4x4x4_16b_bf16 v[104:107], v[142:143], v[84:85], 0 cbsz:4 abid:9
    v_readlane_b32 s58, v164, 42
    v_mfma_f32_4x4x4_16b_bf16 v[108:111], v[142:143], v[86:87], 0 cbsz:4 abid:9
    v_lshlrev_b32_sdwa v137, v15, v123 dst_sel:DWORD dst_unused:UNUSED_PAD src0_sel:DWORD src1_sel:WORD_1
    ds_read_u16_d16_hi v132, v136 offset:32768
    ds_read_u16_d16_hi v133, v137 offset:32768
    s_and_b32 s33, s58, s34
    buffer_load_dwordx4 v[72:75], v1, s[12:15], s33 offen
    s_waitcnt lgkmcnt(2)
    s_set_gpr_idx_on s52, 0xc
    v_pk_fma_f32 v[16:17], v[128:129], v[96:97], v[16:17] op_sel:[0,0,0] op_sel_hi:[0,1,1]
    v_pk_fma_f32 v[18:19], v[128:129], v[98:99], v[18:19] op_sel:[0,0,0] op_sel_hi:[0,1,1]
    v_pk_fma_f32 v[20:21], v[130:131], v[100:101], v[20:21] op_sel:[0,0,0] op_sel_hi:[0,1,1]
    v_pk_fma_f32 v[22:23], v[130:131], v[102:103], v[22:23] op_sel:[0,0,0] op_sel_hi:[0,1,1]
    s_set_gpr_idx_off
    v_lshlrev_b32_sdwa v138, v15, v126 dst_sel:DWORD dst_unused:UNUSED_PAD src0_sel:DWORD src1_sel:WORD_1
    s_waitcnt vmcnt(4)
    v_mfma_f32_4x4x4_16b_bf16 v[96:99], v[144:145], v[88:89], 0 cbsz:4 abid:9
    v_readlane_b32 s59, v164, 43
    v_mfma_f32_4x4x4_16b_bf16 v[100:103], v[144:145], v[90:91], 0 cbsz:4 abid:9
    v_lshlrev_b32_sdwa v139, v15, v127 dst_sel:DWORD dst_unused:UNUSED_PAD src0_sel:DWORD src1_sel:WORD_1
    ds_read_u16_d16_hi v134, v138 offset:32768
    ds_read_u16_d16_hi v135, v139 offset:32768
    s_and_b32 s33, s59, s34
    buffer_load_dwordx4 v[76:79], v1, s[12:15], s33 offen
    s_set_gpr_idx_on s53, 0xc
    v_pk_fma_f32 v[16:17], v[128:129], v[104:105], v[16:17] op_sel:[1,0,0] op_sel_hi:[1,1,1]
    v_pk_fma_f32 v[18:19], v[128:129], v[106:107], v[18:19] op_sel:[1,0,0] op_sel_hi:[1,1,1]
    v_pk_fma_f32 v[20:21], v[130:131], v[108:109], v[20:21] op_sel:[1,0,0] op_sel_hi:[1,1,1]
    v_pk_fma_f32 v[22:23], v[130:131], v[110:111], v[22:23] op_sel:[1,0,0] op_sel_hi:[1,1,1]
    s_set_gpr_idx_off
    v_mfma_f32_4x4x4_16b_bf16 v[120:123], v[172:173], v[176:177], 0 cbsz:4 abid:11
    v_lshlrev_b32_sdwa v136, v15, v112 dst_sel:DWORD dst_unused:UNUSED_PAD src0_sel:DWORD src1_sel:WORD_1
    s_waitcnt vmcnt(4)
    v_mfma_f32_4x4x4_16b_bf16 v[104:107], v[146:147], v[92:93], 0 cbsz:4 abid:9
    v_readlane_b32 s60, v164, 44
    v_mfma_f32_4x4x4_16b_bf16 v[108:111], v[146:147], v[94:95], 0 cbsz:4 abid:9
    v_lshlrev_b32_sdwa v137, v15, v113 dst_sel:DWORD dst_unused:UNUSED_PAD src0_sel:DWORD src1_sel:WORD_1
    ds_read_u16_d16_hi v128, v136 offset:32768
    ds_read_u16_d16_hi v129, v137 offset:32768
    s_and_b32 s33, s60, s34
    buffer_load_dwordx4 v[80:83], v1, s[12:15], s33 offen
    s_waitcnt lgkmcnt(2)
    s_set_gpr_idx_on s54, 0xc
    v_pk_fma_f32 v[16:17], v[132:133], v[96:97], v[16:17] op_sel:[0,0,0] op_sel_hi:[0,1,1]
    v_pk_fma_f32 v[18:19], v[132:133], v[98:99], v[18:19] op_sel:[0,0,0] op_sel_hi:[0,1,1]
    v_pk_fma_f32 v[20:21], v[134:135], v[100:101], v[20:21] op_sel:[0,0,0] op_sel_hi:[0,1,1]
    v_pk_fma_f32 v[22:23], v[134:135], v[102:103], v[22:23] op_sel:[0,0,0] op_sel_hi:[0,1,1]
    s_set_gpr_idx_off
    v_lshlrev_b32_sdwa v138, v15, v116 dst_sel:DWORD dst_unused:UNUSED_PAD src0_sel:DWORD src1_sel:WORD_1
    s_waitcnt vmcnt(4)
    v_mfma_f32_4x4x4_16b_bf16 v[96:99], v[140:141], v[64:65], 0 cbsz:4 abid:10
    v_readlane_b32 s61, v164, 45
    v_mfma_f32_4x4x4_16b_bf16 v[100:103], v[140:141], v[66:67], 0 cbsz:4 abid:10
    v_lshlrev_b32_sdwa v139, v15, v117 dst_sel:DWORD dst_unused:UNUSED_PAD src0_sel:DWORD src1_sel:WORD_1
    ds_read_u16_d16_hi v130, v138 offset:32768
    ds_read_u16_d16_hi v131, v139 offset:32768
    s_and_b32 s33, s61, s34
    buffer_load_dwordx4 v[84:87], v1, s[12:15], s33 offen
    s_set_gpr_idx_on s55, 0xc
    v_pk_fma_f32 v[16:17], v[132:133], v[104:105], v[16:17] op_sel:[1,0,0] op_sel_hi:[1,1,1]
    v_pk_fma_f32 v[18:19], v[132:133], v[106:107], v[18:19] op_sel:[1,0,0] op_sel_hi:[1,1,1]
    v_pk_fma_f32 v[20:21], v[134:135], v[108:109], v[20:21] op_sel:[1,0,0] op_sel_hi:[1,1,1]
    v_pk_fma_f32 v[22:23], v[134:135], v[110:111], v[22:23] op_sel:[1,0,0] op_sel_hi:[1,1,1]
    s_set_gpr_idx_off
A_40:
    s_sub_u32 s31, s31, 4
    s_cbranch_scc1 TO_B_40
    v_mfma_f32_4x4x4_16b_bf16 v[124:127], v[172:173], v[178:179], 0 cbsz:4 abid:11
    v_lshlrev_b32_sdwa v136, v15, v114 dst_sel:DWORD dst_unused:UNUSED_PAD src0_sel:DWORD src1_sel:WORD_1
    s_waitcnt vmcnt(4)
    v_mfma_f32_4x4x4_16b_bf16 v[104:107], v[142:143], v[68:69], 0 cbsz:4 abid:10
    v_readlane_b32 s62, v164, 46
    v_mfma_f32_4x4x4_16b_bf16 v[108:111], v[142:143], v[70:71], 0 cbsz:4 abid:10
    v_lshlrev_b32_sdwa v137, v15, v115 dst_sel:DWORD dst_unused:UNUSED_PAD src0_sel:DWORD src1_sel:WORD_1
    ds_read_u16_d16_hi v132, v136 offset:32768
    ds_read_u16_d16_hi v133, v137 offset:32768
    s_and_b32 s33, s62, s34
    buffer_load_dwordx4 v[88:91], v1, s[12:15], s33 offen
    s_waitcnt lgkmcnt(2)
    s_set_gpr_idx_on s56, 0xc
    v_pk_fma_f32 v[16:17], v[128:129], v[96:97], v[16:17] op_sel:[0,0,0] op_sel_hi:[0,1,1]
    v_pk_fma_f32 v[18:19], v[128:129], v[98:99], v[18:19] op_sel:[0,0,0] op_sel_hi:[0,1,1]
    v_pk_fma_f32 v[20:21], v[130:131], v[100:101], v[20:21] op_sel:[0,0,0] op_sel_hi:[0,1,1]
    v_pk_fma_f32 v[22:23], v[130:131], v[102:103], v[22:23] op_sel:[0,0,0] op_sel_hi:[0,1,1]
    s_set_gpr_idx_off
    v_mfma_f32_4x4x4_16b_bf16 v[148:151], v[168:169], v[180:181], 0
    v_lshlrev_b32_sdwa v138, v15, v118 dst_sel:DWORD dst_unused:UNUSED_PAD src0_sel:DWORD src1_sel:WORD_1
    s_waitcnt vmcnt(4)
    v_mfma_f32_4x4x4_16b_bf16 v[96:99], v[144:145], v[72:73], 0 cbsz:4 abid:10
    v_readlane_b32 s63, v164, 47
    v_mfma_f32_4x4x4_16b_bf16 v[100:103], v[144:145], v[74:75], 0 cbsz:4 abid:10
    v_lshlrev_b32_sdwa v139, v15, v119 dst_sel:DWORD dst_unused:UNUSED_PAD src0_sel:DWORD src1_sel:WORD_1
    ds_read_u16_d16_hi v134, v138 offset:32768
    ds_read_u16_d16_hi v135, v139 offset:32768
    s_and_b32 s33, s63, s34
    buffer_load_dwordx4 v[92:95], v1, s[12:15], s33 offen
    s_set_gpr_idx_on s57, 0xc
    v_pk_fma_f32 v[16:17], v[128:129], v[104:105], v[16:17] op_sel:[1,0,0] op_sel_hi:[1,1,1]
    v_pk_fma_f32 v[18:19], v[128:129], v[106:107], v[18:19] op_sel:[1,0,0] op_sel_hi:[1,1,1]
    v_pk_fma_f32 v[20:21], v[130:131], v[108:109], v[20:21] op_sel:[1,0,0] op_sel_hi:[1,1,1]
    v_pk_fma_f32 v[22:23], v[130:131], v[110:111], v[22:23] op_sel:[1,0,0] op_sel_hi:[1,1,1]
    s_set_gpr_idx_off
    v_mfma_f32_4x4x4_16b_bf16 v[112:115], v[172:173], v[176:177], 0 cbsz:4 abid:12
    v_lshlrev_b32_sdwa v136, v15, v120 dst_sel:DWORD dst_unused:UNUSED_PAD src0_sel:DWORD src1_sel:WORD_1
    s_waitcnt vmcnt(4)
    v_mfma_f32_4x4x4_16b_bf16 v[104:107], v[146:147], v[76:77], 0 cbsz:4 abid:10
    v_readlane_b32 s48, v164, 48
    v_mfma_f32_4x4x4_16b_bf16 v[108:111], v[146:147], v[78:79], 0 cbsz:4 abid:10
    v_lshlrev_b32_sdwa v137, v15, v121 dst_sel:DWORD dst_unused:UNUSED_PAD src0_sel:DWORD src1_sel:WORD_1
    ds_read_u16_d16_hi v128, v136 offset:32768
    ds_read_u16_d16_hi v129, v137 offset:32768
    s_and_b32 s33, s48, s34
    buffer_load_dwordx4 v[64:67], v1, s[12:15], s33 offen
    s_waitcnt lgkmcnt(2)
    s_set_gpr_idx_on s58, 0xc
    v_pk_fma_f32 v[16:17], v[132:133], v[96:97], v[16:17] op_sel:[0,0,0] op_sel_hi:[0,1,1]
    v_pk_fma_f32 v[18:19], v[132:133], v[98:99], v[18:19] op_sel:[0,0,0] op_sel_hi:[0,1,1]
    v_pk_fma_f32 v[20:21], v[134:135], v[100:101], v[20:21] op_sel:[0,0,0] op_sel_hi:[0,1,1]
    v_pk_fma_f32 v[22:23], v[134:135], v[102:103], v[22:23] op_sel:[0,0,0] op_sel_hi:[0,1,1]
    s_set_gpr_idx_off
    v_mfma_f32_4x4x4_16b_bf16 v[152:155], v[168:169], v[182:183], 0
    v_lshlrev_b32_sdwa v138, v15, v124 dst_sel:DWORD dst_unused:UNUSED_PAD src0_sel:DWORD src1_sel:WORD_1
    s_waitcnt vmcnt(4)
    v_mfma_f32_4x4x4_16b_bf16 v[96:99], v[140:141], v[80:81], 0 cbsz:4 abid:11
    v_readlane_b32 s49, v164, 49
    v_mfma_f32_4x4x4_16b_bf16 v[100:103], v[140:141], v[82:83], 0 cbsz:4 abid:11
    v_lshlrev_b32_sdwa v139, v15, v125 dst_sel:DWORD dst_unused:UNUSED_PAD src0_sel:DWORD src1_sel:WORD_1
    ds_read_u16_d16_hi v130, v138 offset:32768
    ds_read_u16_d16_hi v131, v139 offset:32768
    s_and_b32 s33, s49, s34
    buffer_load_dwordx4 v[68:71], v1, s[12:15], s33 offen
    s_set_gpr_idx_on s59, 0xc
    v_pk_fma_f32 v[16:17], v[132:133], v[104:105], v[16:17] op_sel:[1,0,0] op_sel_hi:[1,1,1]
    v_pk_fma_f32 v[18:19], v[132:133], v[106:107], v[18:19] op_sel:[1,0,0] op_sel_hi:[1,1,1]
    v_pk_fma_f32 v[20:21], v[134:135], v[108:109], v[20:21] op_sel:[1,0,0] op_sel_hi:[1,1,1]
    v_pk_fma_f32 v[22:23], v[134:135], v[110:111], v[22:23] op_sel:[1,0,0] op_sel_hi:[1,1,1]
    s_set_gpr_idx_off
A_44:
    s_sub_u32 s31, s31, 4
    s_cbranch_scc1 TO_B_44
    v_mfma_f32_4x4x4_16b_bf16 v[116:119], v[172:173], v[178:179], 0 cbsz:4 abid:12
    v_lshlrev_b32_sdwa v136, v15, v122 dst_sel:DWORD dst_unused:UNUSED_PAD src0_sel:DWORD src1_sel:WORD_1
    s_waitcnt vmcnt(4)
    v_mfma_f32_4x4x4_16b_bf16 v[104:107], v[142:143], v[84:85], 0 cbsz:4 abid:11
    v_readlane_b32 s50, v164, 50
    v_mfma_f32_4x4x4_16b_bf16 v[108:111], v[142:143], v[86:87], 0 cbsz:4 abid:11
    v_lshlrev_b32_sdwa v137, v15, v123 dst_sel:DWORD dst_unused:UNUSED_PAD src0_sel:DWORD src1_sel:WORD_1
    ds_read_u16_d16_hi v132, v136 offset:32768
    ds_read_u16_d16_hi v133, v137 offset:32768
    s_and_b32 s33, s50, s34
    buffer_load_dwordx4 v[72:75], v1, s[12:15], s33 offen
    s_waitcnt lgkmcnt(2)
    s_set_gpr_idx_on s60, 0xc
    v_pk_fma_f32 v[16:17], v[128:129], v[96:97], v[16:17] op_sel:[0,0,0] op_sel_hi:[0,1,1]
    v_pk_fma_f32 v[18:19], v[128:129], v[98:99], v[18:19] op_sel:[0,0,0] op_sel_hi:[0,1,1]
    v_pk_fma_f32 v[20:21], v[130:131], v[100:101], v[20:21] op_sel:[0,0,0] op_sel_hi:[0,1,1]
    v_pk_fma_f32 v[22:23], v[130:131], v[102:103], v[22:23] op_sel:[0,0,0] op_sel_hi:[0,1,1]
    s_set_gpr_idx_off
    v_mfma_f32_4x4x4_16b_bf16 v[156:159], v[168:169], v[184:185], 0
    v_lshlrev_b32_sdwa v138, v15, v126 dst_sel:DWORD dst_unused:UNUSED_PAD src0_sel:DWORD src1_sel:WORD_1
    s_waitcnt vmcnt(4)
    v_mfma_f32_4x4x4_16b_bf16 v[96:99], v[144:145], v[88:89], 0 cbsz:4 abid:11
    v_readlane_b32 s51, v164, 51
    v_mfma_f32_4x4x4_16b_bf16 v[100:103], v[144:145], v[90:91], 0 cbsz:4 abid:11
    v_lshlrev_b32_sdwa v139, v15, v127 dst_sel:DWORD dst_unused:UNUSED_PAD src0_sel:DWORD src1_sel:WORD_1
    ds_read_u16_d16_hi v134, v138 offset:32768
    ds_read_u16_d16_hi v135, v139 offset:32768
    s_and_b32 s33, s51, s34
    buffer_load_dwordx4 v[76:79], v1, s[12:15], s33 offen
    s_set_gpr_idx_on s61, 0xc
    v_pk_fma_f32 v[16:17], v[128:129], v[104:105], v[16:17] op_sel:[1,0,0] op_sel_hi:[1,1,1]
    v_pk_fma_f32 v[18:19], v[128:129], v[106:107], v[18:19] op_sel:[1,0,0] op_sel_hi:[1,1,1]
    v_pk_fma_f32 v[20:21], v[130:131], v[108:109], v[20:21] op_sel:[1,0,0] op_sel_hi:[1,1,1]
    v_pk_fma_f32 v[22:23], v[130:131], v[110:111], v[22:23] op_sel:[1,0,0] op_sel_hi:[1,1,1]
    s_set_gpr_idx_off
    v_mfma_f32_4x4x4_16b_bf16 v[120:123], v[172:173], v[176:177], 0 cbsz:4 abid:13
    v_lshlrev_b32_sdwa v136, v15, v112 dst_sel:DWORD dst_unused:UNUSED_PAD src0_sel:DWORD src1_sel:WORD_1
    s_waitcnt vmcnt(4)
    v_mfma_f32_4x4x4_16b_bf16 v[104:107], v[146:147], v[92:93], 0 cbsz:4 abid:11
    v_readlane_b32 s52, v164, 52
    v_mfma_f32_4x4x4_16b_bf16 v[108:111], v[146:147], v[94:95], 0 cbsz:4 abid:11
    v_lshlrev_b32_sdwa v137, v15, v113 dst_sel:DWORD dst_unused:UNUSED_PAD src0_sel:DWORD src1_sel:WORD_1
    ds_read_u16_d16_hi v128, v136 offset:32768
    ds_read_u16_d16_hi v129, v137 offset:32768
    s_and_b32 s33, s52, s34
    buffer_load_dwordx4 v[80:83], v1, s[12:15], s33 offen
    s_waitcnt lgkmcnt(2)
    s_set_gpr_idx_on s62, 0xc
    v_pk_fma_f32 v[16:17], v[132:133], v[96:97], v[16:17] op_sel:[0,0,0] op_sel_hi:[0,1,1]
    v_pk_fma_f32 v[18:19], v[132:133], v[98:99], v[18:19] op_sel:[0,0,0] op_sel_hi:[0,1,1]
    v_pk_fma_f32 v[20:21], v[134:135], v[100:101], v[20:21] op_sel:[0,0,0] op_sel_hi:[0,1,1]
    v_pk_fma_f32 v[22:23], v[134:135], v[102:103], v[22:23] op_sel:[0,0,0] op_sel_hi:[0,1,1]
    s_set_gpr_idx_off
    v_mfma_f32_4x4x4_16b_bf16 v[160:163], v[168:169], v[186:187], 0
    v_lshlrev_b32_sdwa v138, v15, v116 dst_sel:DWORD dst_unused:UNUSED_PAD src0_sel:DWORD src1_sel:WORD_1
    s_waitcnt vmcnt(4)
    v_mfma_f32_4x4x4_16b_bf16 v[96:99], v[140:141], v[64:65], 0 cbsz:4 abid:12
    v_readlane_b32 s53, v164, 53
    v_mfma_f32_4x4x4_16b_bf16 v[100:103], v[140:141], v[66:67], 0 cbsz:4 abid:12
    v_lshlrev_b32_sdwa v139, v15, v117 dst_sel:DWORD dst_unused:UNUSED_PAD src0_sel:DWORD src1_sel:WORD_1
    ds_read_u16_d16_hi v130, v138 offset:32768
    ds_read_u16_d16_hi v131, v139 offset:32768
    s_and_b32 s33, s53, s34
    buffer_load_dwordx4 v[84:87], v1, s[12:15], s33 offen
    s_set_gpr_idx_on s63, 0xc
    v_pk_fma_f32 v[16:17], v[132:133], v[104:105], v[16:17] op_sel:[1,0,0] op_sel_hi:[1,1,1]
    v_pk_fma_f32 v[18:19], v[132:133], v[106:107], v[18:19] op_sel:[1,0,0] op_sel_hi:[1,1,1]
    v_pk_fma_f32 v[20:21], v[134:135], v[108:109], v[20:21] op_sel:[1,0,0] op_sel_hi:[1,1,1]
    v_pk_fma_f32 v[22:23], v[134:135], v[110:111], v[22:23] op_sel:[1,0,0] op_sel_hi:[1,1,1]
    s_set_gpr_idx_off
A_48:
    s_sub_u32 s31, s31, 4
    s_cbranch_scc1 TO_B_48
    v_mfma_f32_4x4x4_16b_bf16 v[124:127], v[172:173], v[178:179], 0 cbsz:4 abid:13
    v_lshlrev_b32_sdwa v136, v15, v114 dst_sel:DWORD dst_unused:UNUSED_PAD src0_sel:DWORD src1_sel:WORD_1
    s_waitcnt vmcnt(4)
    v_mfma_f32_4x4x4_16b_bf16 v[104:107], v[142:143], v[68:69], 0 cbsz:4 abid:12
    v_readlane_b32 s54, v164, 54
    v_mfma_f32_4x4x4_16b_bf16 v[108:111], v[142:143], v[70:71], 0 cbsz:4 abid:12
    v_lshlrev_b32_sdwa v137, v15, v115 dst_sel:DWORD dst_unused:UNUSED_PAD src0_sel:DWORD src1_sel:WORD_1
    ds_read_u16_d16_hi v132, v136 offset:32768
    ds_read_u16_d16_hi v133, v137 offset:32768
    s_and_b32 s33, s54, s34
    buffer_load_dwordx4 v[88:91], v1, s[12:15], s33 offen
    s_waitcnt lgkmcnt(2)
    s_set_gpr_idx_on s48, 0xc
    v_pk_fma_f32 v[16:17], v[128:129], v[96:97], v[16:17] op_sel:[0,0,0] op_sel_hi:[0,1,1]
    v_pk_fma_f32 v[18:19], v[128:129], v[98:99], v[18:19] op_sel:[0,0,0] op_sel_hi:[0,1,1]
    v_pk_fma_f32 v[20:21], v[130:131], v[100:101], v[20:21] op_sel:[0,0,0] op_sel_hi:[0,1,1]
    v_pk_fma_f32 v[22:23], v[130:131], v[102:103], v[22:23] op_sel:[0,0,0] op_sel_hi:[0,1,1]
    s_set_gpr_idx_off
    v_lshlrev_b32_sdwa v138, v15, v118 dst_sel:DWORD dst_unused:UNUSED_PAD src0_sel:DWORD src1_sel:WORD_1
    s_waitcnt vmcnt(4)
    v_mfma_f32_4x4x4_16b_bf16 v[96:99], v[144:145], v[72:73], 0 cbsz:4 abid:12
    v_readlane_b32 s55, v164, 55
    v_mfma_f32_4x4x4_16b_bf16 v[100:103], v[144:145], v[74:75], 0 cbsz:4 abid:12
    v_lshlrev_b32_sdwa v139, v15, v119 dst_sel:DWORD dst_unused:UNUSED_PAD src0_sel:DWORD src1_sel:WORD_1
    ds_read_u16_d16_hi v134, v138 offset:32768
    ds_read_u16_d16_hi v135, v139 offset:32768
    s_and_b32 s33, s55, s34
    buffer_load_dwordx4 v[92:95], v1, s[12:15], s33 offen
    s_set_gpr_idx_on s49, 0xc
    v_pk_fma_f32 v[16:17], v[128:129], v[104:105], v[16:17] op_sel:[1,0,0] op_sel_hi:[1,1,1]
    v_pk_fma_f32 v[18:19], v[128:129], v[106:107], v[18:19] op_sel:[1,0,0] op_sel_hi:[1,1,1]
    v_pk_fma_f32 v[20:21], v[130:131], v[108:109], v[20:21] op_sel:[1,0,0] op_sel_hi:[1,1,1]
    v_pk_fma_f32 v[22:23], v[130:131], v[110:111], v[22:23] op_sel:[1,0,0] op_sel_hi:[1,1,1]
    s_set_gpr_idx_off
    v_mfma_f32_4x4x4_16b_bf16 v[112:115], v[172:173], v[176:177], 0 cbsz:4 abid:14
    v_lshlrev_b32_sdwa v136, v15, v120 dst_sel:DWORD dst_unused:UNUSED_PAD src0_sel:DWORD src1_sel:WORD_1
    s_waitcnt vmcnt(4)
    v_mfma_f32_4x4x4_16b_bf16 v[104:107], v[146:147], v[76:77], 0 cbsz:4 abid:12
    v_readlane_b32 s56, v164, 56
    v_mfma_f32_4x4x4_16b_bf16 v[108:111], v[146:147], v[78:79], 0 cbsz:4 abid:12
    v_lshlrev_b32_sdwa v137, v15, v121 dst_sel:DWORD dst_unused:UNUSED_PAD src0_sel:DWORD src1_sel:WORD_1
    ds_read_u16_d16_hi v128, v136 offset:32768
    ds_read_u16_d16_hi v129, v137 offset:32768
    s_and_b32 s33, s56, s34
    buffer_load_dwordx4 v[64:67], v1, s[12:15], s33 offen
    s_waitcnt lgkmcnt(2)
    s_set_gpr_idx_on s50, 0xc
    v_pk_fma_f32 v[16:17], v[132:133], v[96:97], v[16:17] op_sel:[0,0,0] op_sel_hi:[0,1,1]
    v_pk_fma_f32 v[18:19], v[132:133], v[98:99], v[18:19] op_sel:[0,0,0] op_sel_hi:[0,1,1]
    v_pk_fma_f32 v[20:21], v[134:135], v[100:101], v[20:21] op_sel:[0,0,0] op_sel_hi:[0,1,1]
    v_pk_fma_f32 v[22:23], v[134:135], v[102:103], v[22:23] op_sel:[0,0,0] op_sel_hi:[0,1,1]
    s_set_gpr_idx_off
    v_lshlrev_b32_sdwa v138, v15, v124 dst_sel:DWORD dst_unused:UNUSED_PAD src0_sel:DWORD src1_sel:WORD_1
    s_waitcnt vmcnt(4)
    v_mfma_f32_4x4x4_16b_bf16 v[96:99], v[140:141], v[80:81], 0 cbsz:4 abid:13
    v_readlane_b32 s57, v164, 57
    v_mfma_f32_4x4x4_16b_bf16 v[100:103], v[140:141], v[82:83], 0 cbsz:4 abid:13
    v_lshlrev_b32_sdwa v139, v15, v125 dst_sel:DWORD dst_unused:UNUSED_PAD src0_sel:DWORD src1_sel:WORD_1
    ds_read_u16_d16_hi v130, v138 offset:32768
    ds_read_u16_d16_hi v131, v139 offset:32768
    s_and_b32 s33, s57, s34
    buffer_load_dwordx4 v[68:71], v1, s[12:15], s33 offen
    s_set_gpr_idx_on s51, 0xc
    v_pk_fma_f32 v[16:17], v[132:133], v[104:105], v[16:17] op_sel:[1,0,0] op_sel_hi:[1,1,1]
    v_pk_fma_f32 v[18:19], v[132:133], v[106:107], v[18:19] op_sel:[1,0,0] op_sel_hi:[1,1,1]
    v_pk_fma_f32 v[20:21], v[134:135], v[108:109], v[20:21] op_sel:[1,0,0] op_sel_hi:[1,1,1]
    v_pk_fma_f32 v[22:23], v[134:135], v[110:111], v[22:23] op_sel:[1,0,0] op_sel_hi:[1,1,1]
    s_set_gpr_idx_off
A_52:
    s_sub_u32 s31, s31, 4
    s_cbranch_scc1 TO_B_52
    v_mfma_f32_4x4x4_16b_bf16 v[116:119], v[172:173], v[178:179], 0 cbsz:4 abid:14
    v_lshlrev_b32_sdwa v136, v15, v122 dst_sel:DWORD dst_unused:UNUSED_PAD src0_sel:DWORD src1_sel:WORD_1
    s_waitcnt vmcnt(4)
    v_mfma_f32_4x4x4_16b_bf16 v[104:107], v[142:143], v[84:85], 0 cbsz:4 abid:13
    v_readlane_b32 s58, v164, 58
    v_mfma_f32_4x4x4_16b_bf16 v[108:111], v[142:143], v[86:87], 0 cbsz:4 abid:13
    v_lshlrev_b32_sdwa v137, v15, v123 dst_sel:DWORD dst_unused:UNUSED_PAD src0_sel:DWORD src1_sel:WORD_1
    ds_read_u16_d16_hi v132, v136 offset:32768
    ds_read_u16_d16_hi v133, v137 offset:32768
    s_and_b32 s33, s58, s34
    buffer_load_dwordx4 v[72:75], v1, s[12:15], s33 offen
    s_waitcnt lgkmcnt(2)
    s_set_gpr_idx_on s52, 0xc
    v_pk_fma_f32 v[16:17], v[128:129], v[96:97], v[16:17] op_sel:[0,0,0] op_sel_hi:[0,1,1]
    v_pk_fma_f32 v[18:19], v[128:129], v[98:99], v[18:19] op_sel:[0,0,0] op_sel_hi:[0,1,1]
    v_pk_fma_f32 v[20:21], v[130:131], v[100:101], v[20:21] op_sel:[0,0,0] op_sel_hi:[0,1,1]
    v_pk_fma_f32 v[22:23], v[130:131], v[102:103], v[22:23] op_sel:[0,0,0] op_sel_hi:[0,1,1]
    s_set_gpr_idx_off
    v_lshlrev_b32_sdwa v138, v15, v126 dst_sel:DWORD dst_unused:UNUSED_PAD src0_sel:DWORD src1_sel:WORD_1
    s_waitcnt vmcnt(4)
    v_mfma_f32_4x4x4_16b_bf16 v[96:99], v[144:145], v[88:89], 0 cbsz:4 abid:13
    v_readlane_b32 s59, v164, 59
    v_mfma_f32_4x4x4_16b_bf16 v[100:103], v[144:145], v[90:91], 0 cbsz:4 abid:13
    v_lshlrev_b32_sdwa v139, v15, v127 dst_sel:DWORD dst_unused:UNUSED_PAD src0_sel:DWORD src1_sel:WORD_1
    ds_read_u16_d16_hi v134, v138 offset:32768
    ds_read_u16_d16_hi v135, v139 offset:32768
    s_and_b32 s33, s59, s34
    buffer_load_dwordx4 v[76:79], v1, s[12:15], s33 offen
    s_set_gpr_idx_on s53, 0xc
    v_pk_fma_f32 v[16:17], v[128:129], v[104:105], v[16:17] op_sel:[1,0,0] op_sel_hi:[1,1,1]
    v_pk_fma_f32 v[18:19], v[128:129], v[106:107], v[18:19] op_sel:[1,0,0] op_sel_hi:[1,1,1]
    v_pk_fma_f32 v[20:21], v[130:131], v[108:109], v[20:21] op_sel:[1,0,0] op_sel_hi:[1,1,1]
    v_pk_fma_f32 v[22:23], v[130:131], v[110:111], v[22:23] op_sel:[1,0,0] op_sel_hi:[1,1,1]
    s_set_gpr_idx_off
    v_mfma_f32_4x4x4_16b_bf16 v[120:123], v[172:173], v[176:177], 0 cbsz:4 abid:15
    v_lshlrev_b32_sdwa v136, v15, v112 dst_sel:DWORD dst_unused:UNUSED_PAD src0_sel:DWORD src1_sel:WORD_1
    s_waitcnt vmcnt(4)
    v_mfma_f32_4x4x4_16b_bf16 v[104:107], v[146:147], v[92:93], 0 cbsz:4 abid:13
    v_readlane_b32 s60, v164, 60
    v_mfma_f32_4x4x4_16b_bf16 v[108:111], v[146:147], v[94:95], 0 cbsz:4 abid:13
    v_lshlrev_b32_sdwa v137, v15, v113 dst_sel:DWORD dst_unused:UNUSED_PAD src0_sel:DWORD src1_sel:WORD_1
    ds_read_u16_d16_hi v128, v136 offset:32768
    ds_read_u16_d16_hi v129, v137 offset:32768
    s_and_b32 s33, s60, s34
    buffer_load_dwordx4 v[80:83], v1, s[12:15], s33 offen
    s_waitcnt lgkmcnt(2)
    s_set_gpr_idx_on s54, 0xc
    v_pk_fma_f32 v[16:17], v[132:133], v[96:97], v[16:17] op_sel:[0,0,0] op_sel_hi:[0,1,1]
    v_pk_fma_f32 v[18:19], v[132:133], v[98:99], v[18:19] op_sel:[0,0,0] op_sel_hi:[0,1,1]
    v_pk_fma_f32 v[20:21], v[134:135], v[100:101], v[20:21] op_sel:[0,0,0] op_sel_hi:[0,1,1]
    v_pk_fma_f32 v[22:23], v[134:135], v[102:103], v[22:23] op_sel:[0,0,0] op_sel_hi:[0,1,1]
    s_set_gpr_idx_off
    v_lshlrev_b32_sdwa v138, v15, v116 dst_sel:DWORD dst_unused:UNUSED_PAD src0_sel:DWORD src1_sel:WORD_1
    s_waitcnt vmcnt(4)
    v_mfma_f32_4x4x4_16b_bf16 v[96:99], v[140:141], v[64:65], 0 cbsz:4 abid:14
    v_readlane_b32 s61, v164, 61
    v_mfma_f32_4x4x4_16b_bf16 v[100:103], v[140:141], v[66:67], 0 cbsz:4 abid:14
    v_lshlrev_b32_sdwa v139, v15, v117 dst_sel:DWORD dst_unused:UNUSED_PAD src0_sel:DWORD src1_sel:WORD_1
    ds_read_u16_d16_hi v130, v138 offset:32768
    ds_read_u16_d16_hi v131, v139 offset:32768
    s_and_b32 s33, s61, s34
    buffer_load_dwordx4 v[84:87], v1, s[12:15], s33 offen
    s_set_gpr_idx_on s55, 0xc
    v_pk_fma_f32 v[16:17], v[132:133], v[104:105], v[16:17] op_sel:[1,0,0] op_sel_hi:[1,1,1]
    v_pk_fma_f32 v[18:19], v[132:133], v[106:107], v[18:19] op_sel:[1,0,0] op_sel_hi:[1,1,1]
    v_pk_fma_f32 v[20:21], v[134:135], v[108:109], v[20:21] op_sel:[1,0,0] op_sel_hi:[1,1,1]
    v_pk_fma_f32 v[22:23], v[134:135], v[110:111], v[22:23] op_sel:[1,0,0] op_sel_hi:[1,1,1]
    s_set_gpr_idx_off
A_56:
    s_sub_u32 s31, s31, 4
    s_cbranch_scc1 TO_B_56
    v_mfma_f32_4x4x4_16b_bf16 v[124:127], v[172:173], v[178:179], 0 cbsz:4 abid:15
    v_lshlrev_b32_sdwa v136, v15, v114 dst_sel:DWORD dst_unused:UNUSED_PAD src0_sel:DWORD src1_sel:WORD_1
    s_waitcnt vmcnt(4)
    v_mfma_f32_4x4x4_16b_bf16 v[104:107], v[142:143], v[68:69], 0 cbsz:4 abid:14
    v_readlane_b32 s62, v164, 62
    v_mfma_f32_4x4x4_16b_bf16 v[108:111], v[142:143], v[70:71], 0 cbsz:4 abid:14
    v_lshlrev_b32_sdwa v137, v15, v115 dst_sel:DWORD dst_unused:UNUSED_PAD src0_sel:DWORD src1_sel:WORD_1
    ds_read_u16_d16_hi v132, v136 offset:32768
    ds_read_u16_d16_hi v133, v137 offset:32768
    s_and_b32 s33, s62, s34
    buffer_load_dwordx4 v[88:91], v1, s[12:15], s33 offen
    s_waitcnt lgkmcnt(2)
    s_set_gpr_idx_on s56, 0xc
    v_pk_fma_f32 v[16:17], v[128:129], v[96:97], v[16:17] op_sel:[0,0,0] op_sel_hi:[0,1,1]
    v_pk_fma_f32 v[18:19], v[128:129], v[98:99], v[18:19] op_sel:[0,0,0] op_sel_hi:[0,1,1]
    v_pk_fma_f32 v[20:21], v[130:131], v[100:101], v[20:21] op_sel:[0,0,0] op_sel_hi:[0,1,1]
    v_pk_fma_f32 v[22:23], v[130:131], v[102:103], v[22:23] op_sel:[0,0,0] op_sel_hi:[0,1,1]
    s_set_gpr_idx_off
    v_lshlrev_b32_sdwa v138, v15, v118 dst_sel:DWORD dst_unused:UNUSED_PAD src0_sel:DWORD src1_sel:WORD_1
    s_waitcnt vmcnt(4)
    v_mfma_f32_4x4x4_16b_bf16 v[96:99], v[144:145], v[72:73], 0 cbsz:4 abid:14
    v_readlane_b32 s63, v164, 63
    v_mfma_f32_4x4x4_16b_bf16 v[100:103], v[144:145], v[74:75], 0 cbsz:4 abid:14
    v_lshlrev_b32_sdwa v139, v15, v119 dst_sel:DWORD dst_unused:UNUSED_PAD src0_sel:DWORD src1_sel:WORD_1
    ds_read_u16_d16_hi v134, v138 offset:32768
    ds_read_u16_d16_hi v135, v139 offset:32768
    s_and_b32 s33, s63, s34
    buffer_load_dwordx4 v[92:95], v1, s[12:15], s33 offen
    s_set_gpr_idx_on s57, 0xc
    v_pk_fma_f32 v[16:17], v[128:129], v[104:105], v[16:17] op_sel:[1,0,0] op_sel_hi:[1,1,1]
    v_pk_fma_f32 v[18:19], v[128:129], v[106:107], v[18:19] op_sel:[1,0,0] op_sel_hi:[1,1,1]
    v_pk_fma_f32 v[20:21], v[130:131], v[108:109], v[20:21] op_sel:[1,0,0] op_sel_hi:[1,1,1]
    v_pk_fma_f32 v[22:23], v[130:131], v[110:111], v[22:23] op_sel:[1,0,0] op_sel_hi:[1,1,1]
    s_set_gpr_idx_off
    v_mov_b32 v172, v170
    v_mov_b32 v173, v171
    s_nop 1
    v_mfma_f32_4x4x4_16b_bf16 v[112:115], v[172:173], v[176:177], 0 cbsz:4 abid:0
    v_lshlrev_b32_sdwa v136, v15, v120 dst_sel:DWORD dst_unused:UNUSED_PAD src0_sel:DWORD src1_sel:WORD_1
    s_waitcnt vmcnt(4)
    v_mfma_f32_4x4x4_16b_bf16 v[104:107], v[146:147], v[76:77], 0 cbsz:4 abid:14
    v_readlane_b32 s48, v165, 0
    v_mfma_f32_4x4x4_16b_bf16 v[108:111], v[146:147], v[78:79], 0 cbsz:4 abid:14
    v_lshlrev_b32_sdwa v137, v15, v121 dst_sel:DWORD dst_unused:UNUSED_PAD src0_sel:DWORD src1_sel:WORD_1
    ds_read_u16_d16_hi v128, v136 offset:32768
    ds_read_u16_d16_hi v129, v137 offset:32768
    s_and_b32 s33, s48, s34
    buffer_load_dwordx4 v[64:67], v1, s[12:15], s33 offen
    s_waitcnt lgkmcnt(2)
    s_set_gpr_idx_on s58, 0xc
    v_pk_fma_f32 v[16:17], v[132:133], v[96:97], v[16:17] op_sel:[0,0,0] op_sel_hi:[0,1,1]
    v_pk_fma_f32 v[18:19], v[132:133], v[98:99], v[18:19] op_sel:[0,0,0] op_sel_hi:[0,1,1]
    v_pk_fma_f32 v[20:21], v[134:135], v[100:101], v[20:21] op_sel:[0,0,0] op_sel_hi:[0,1,1]
    v_pk_fma_f32 v[22:23], v[134:135], v[102:103], v[22:23] op_sel:[0,0,0] op_sel_hi:[0,1,1]
    s_set_gpr_idx_off
    v_lshlrev_b32_sdwa v138, v15, v124 dst_sel:DWORD dst_unused:UNUSED_PAD src0_sel:DWORD src1_sel:WORD_1
    s_waitcnt vmcnt(4)
    v_mfma_f32_4x4x4_16b_bf16 v[96:99], v[140:141], v[80:81], 0 cbsz:4 abid:15
    v_readlane_b32 s49, v165, 1
    v_mfma_f32_4x4x4_16b_bf16 v[100:103], v[140:141], v[82:83], 0 cbsz:4 abid:15
    v_lshlrev_b32_sdwa v139, v15, v125 dst_sel:DWORD dst_unused:UNUSED_PAD src0_sel:DWORD src1_sel:WORD_1
    ds_read_u16_d16_hi v130, v138 offset:32768
    ds_read_u16_d16_hi v131, v139 offset:32768
    s_and_b32 s33, s49, s34
    buffer_load_dwordx4 v[68:71], v1, s[12:15], s33 offen
    s_set_gpr_idx_on s59, 0xc
    v_pk_fma_f32 v[16:17], v[132:133], v[104:105], v[16:17] op_sel:[1,0,0] op_sel_hi:[1,1,1]
    v_pk_fma_f32 v[18:19], v[132:133], v[106:107], v[18:19] op_sel:[1,0,0] op_sel_hi:[1,1,1]
    v_pk_fma_f32 v[20:21], v[134:135], v[108:109], v[20:21] op_sel:[1,0,0] op_sel_hi:[1,1,1]
    v_pk_fma_f32 v[22:23], v[134:135], v[110:111], v[22:23] op_sel:[1,0,0] op_sel_hi:[1,1,1]
    s_set_gpr_idx_off
A_60:
    s_sub_u32 s31, s31, 4
    s_cbranch_scc1 TO_B_60
    v_mfma_f32_4x4x4_16b_bf16 v[116:119], v[172:173], v[178:179], 0 cbsz:4 abid:0
    v_lshlrev_b32_sdwa v136, v15, v122 dst_sel:DWORD dst_unused:UNUSED_PAD src0_sel:DWORD src1_sel:WORD_1
    s_waitcnt vmcnt(4)
    v_mfma_f32_4x4x4_16b_bf16 v[104:107], v[142:143], v[84:85], 0 cbsz:4 abid:15
    v_readlane_b32 s50, v165, 2
    v_mfma_f32_4x4x4_16b_bf16 v[108:111], v[142:143], v[86:87], 0 cbsz:4 abid:15
    v_lshlrev_b32_sdwa v137, v15, v123 dst_sel:DWORD dst_unused:UNUSED_PAD src0_sel:DWORD src1_sel:WORD_1
    ds_read_u16_d16_hi v132, v136 offset:32768
    ds_read_u16_d16_hi v133, v137 offset:32768
    v_cvt_pk_bf16_f32 v140, v148, v152
    v_cvt_pk_bf16_f32 v141, v156, v160
    s_and_b32 s33, s50, s34
    buffer_load_dwordx4 v[72:75], v1, s[12:15], s33 offen
    s_waitcnt lgkmcnt(2)
    s_set_gpr_idx_on s60, 0xc
    v_pk_fma_f32 v[16:17], v[128:129], v[96:97], v[16:17] op_sel:[0,0,0] op_sel_hi:[0,1,1]
    v_pk_fma_f32 v[18:19], v[128:129], v[98:99], v[18:19] op_sel:[0,0,0] op_sel_hi:[0,1,1]
    v_pk_fma_f32 v[20:21], v[130:131], v[100:101], v[20:21] op_sel:[0,0,0] op_sel_hi:[0,1,1]
    v_pk_fma_f32 v[22:23], v[130:131], v[102:103], v[22:23] op_sel:[0,0,0] op_sel_hi:[0,1,1]
    s_set_gpr_idx_off
    v_lshlrev_b32_sdwa v138, v15, v126 dst_sel:DWORD dst_unused:UNUSED_PAD src0_sel:DWORD src1_sel:WORD_1
    s_waitcnt vmcnt(4)
    v_mfma_f32_4x4x4_16b_bf16 v[96:99], v[144:145], v[88:89], 0 cbsz:4 abid:15
    v_readlane_b32 s51, v165, 3
    v_mfma_f32_4x4x4_16b_bf16 v[100:103], v[144:145], v[90:91], 0 cbsz:4 abid:15
    v_lshlrev_b32_sdwa v139, v15, v127 dst_sel:DWORD dst_unused:UNUSED_PAD src0_sel:DWORD src1_sel:WORD_1
    ds_read_u16_d16_hi v134, v138 offset:32768
    ds_read_u16_d16_hi v135, v139 offset:32768
    v_cvt_pk_bf16_f32 v142, v149, v153
    v_cvt_pk_bf16_f32 v143, v157, v161
    s_and_b32 s33, s51, s34
    buffer_load_dwordx4 v[76:79], v1, s[12:15], s33 offen
    s_set_gpr_idx_on s61, 0xc
    v_pk_fma_f32 v[16:17], v[128:129], v[104:105], v[16:17] op_sel:[1,0,0] op_sel_hi:[1,1,1]
    v_pk_fma_f32 v[18:19], v[128:129], v[106:107], v[18:19] op_sel:[1,0,0] op_sel_hi:[1,1,1]
    v_pk_fma_f32 v[20:21], v[130:131], v[108:109], v[20:21] op_sel:[1,0,0] op_sel_hi:[1,1,1]
    v_pk_fma_f32 v[22:23], v[130:131], v[110:111], v[22:23] op_sel:[1,0,0] op_sel_hi:[1,1,1]
    s_set_gpr_idx_off
    v_mfma_f32_4x4x4_16b_bf16 v[120:123], v[172:173], v[176:177], 0 cbsz:4 abid:1
    v_lshlrev_b32_sdwa v136, v15, v112 dst_sel:DWORD dst_unused:UNUSED_PAD src0_sel:DWORD src1_sel:WORD_1
    s_waitcnt vmcnt(4)
    v_mfma_f32_4x4x4_16b_bf16 v[104:107], v[146:147], v[92:93], 0 cbsz:4 abid:15
    v_readlane_b32 s52, v165, 4
    v_mfma_f32_4x4x4_16b_bf16 v[108:111], v[146:147], v[94:95], 0 cbsz:4 abid:15
    v_lshlrev_b32_sdwa v137, v15, v113 dst_sel:DWORD dst_unused:UNUSED_PAD src0_sel:DWORD src1_sel:WORD_1
    ds_read_u16_d16_hi v128, v136 offset:32768
    ds_read_u16_d16_hi v129, v137 offset:32768
    v_cvt_pk_bf16_f32 v144, v150, v154
    v_cvt_pk_bf16_f32 v145, v158, v162
    s_and_b32 s33, s52, s34
    buffer_load_dwordx4 v[80:83], v1, s[12:15], s33 offen
    s_waitcnt lgkmcnt(2)
    s_set_gpr_idx_on s62, 0xc
    v_pk_fma_f32 v[16:17], v[132:133], v[96:97], v[16:17] op_sel:[0,0,0] op_sel_hi:[0,1,1]
    v_pk_fma_f32 v[18:19], v[132:133], v[98:99], v[18:19] op_sel:[0,0,0] op_sel_hi:[0,1,1]
    v_pk_fma_f32 v[20:21], v[134:135], v[100:101], v[20:21] op_sel:[0,0,0] op_sel_hi:[0,1,1]
    v_pk_fma_f32 v[22:23], v[134:135], v[102:103], v[22:23] op_sel:[0,0,0] op_sel_hi:[0,1,1]
    s_set_gpr_idx_off
    v_lshlrev_b32_sdwa v138, v15, v116 dst_sel:DWORD dst_unused:UNUSED_PAD src0_sel:DWORD src1_sel:WORD_1
    s_waitcnt vmcnt(4)
    v_mfma_f32_4x4x4_16b_bf16 v[96:99], v[140:141], v[64:65], 0 cbsz:4 abid:0
    v_readlane_b32 s53, v165, 5
    v_mfma_f32_4x4x4_16b_bf16 v[100:103], v[140:141], v[66:67], 0 cbsz:4 abid:0
    v_lshlrev_b32_sdwa v139, v15, v117 dst_sel:DWORD dst_unused:UNUSED_PAD src0_sel:DWORD src1_sel:WORD_1
    ds_read_u16_d16_hi v130, v138 offset:32768
    ds_read_u16_d16_hi v131, v139 offset:32768
    v_cvt_pk_bf16_f32 v146, v151, v155
    v_cvt_pk_bf16_f32 v147, v159, v163
    s_and_b32 s33, s53, s34
    buffer_load_dwordx4 v[84:87], v1, s[12:15], s33 offen
    s_set_gpr_idx_on s63, 0xc
    v_pk_fma_f32 v[16:17], v[132:133], v[104:105], v[16:17] op_sel:[1,0,0] op_sel_hi:[1,1,1]
    v_pk_fma_f32 v[18:19], v[132:133], v[106:107], v[18:19] op_sel:[1,0,0] op_sel_hi:[1,1,1]
    v_pk_fma_f32 v[20:21], v[134:135], v[108:109], v[20:21] op_sel:[1,0,0] op_sel_hi:[1,1,1]
    v_pk_fma_f32 v[22:23], v[134:135], v[110:111], v[22:23] op_sel:[1,0,0] op_sel_hi:[1,1,1]
    s_set_gpr_idx_off
    v_mov_b32 v164, v165
    s_branch A_0
TO_B_0:
    buffer_load_dwordx4 v[188:191], v1, s[16:19], s10 offen offset:0 sc1
    buffer_load_dwordx4 v[192:195], v1, s[16:19], s10 offen offset:1024 sc1
    buffer_load_dwordx4 v[196:199], v1, s[16:19], s10 offen offset:2048 sc1
    buffer_load_dwordx4 v[200:203], v1, s[16:19], s10 offen offset:3072 sc1
    buffer_load_dwordx4 v[204:207], v1, s[16:19], s11 offen offset:0 sc1
    buffer_load_dwordx4 v[208:211], v1, s[16:19], s11 offen offset:1024 sc1
    buffer_load_dwordx4 v[212:215], v1, s[16:19], s11 offen offset:2048 sc1
    buffer_load_dwordx4 v[216:219], v1, s[16:19], s11 offen offset:3072 sc1
    s_branch B_0
TO_B_4:
    buffer_load_dwordx4 v[188:191], v1, s[16:19], s10 offen offset:0 sc1
    buffer_load_dwordx4 v[192:195], v1, s[16:19], s10 offen offset:1024 sc1
    buffer_load_dwordx4 v[196:199], v1, s[16:19], s10 offen offset:2048 sc1
    buffer_load_dwordx4 v[200:203], v1, s[16:19], s10 offen offset:3072 sc1
    buffer_load_dwordx4 v[204:207], v1, s[16:19], s11 offen offset:0 sc1
    buffer_load_dwordx4 v[208:211], v1, s[16:19], s11 offen offset:1024 sc1
    buffer_load_dwordx4 v[212:215], v1, s[16:19], s11 offen offset:2048 sc1
    buffer_load_dwordx4 v[216:219], v1, s[16:19], s11 offen offset:3072 sc1
    s_branch B_4
TO_B_8:
    buffer_load_dwordx4 v[188:191], v1, s[16:19], s10 offen offset:0 sc1
    buffer_load_dwordx4 v[192:195], v1, s[16:19], s10 offen offset:1024 sc1
    buffer_load_dwordx4 v[196:199], v1, s[16:19], s10 offen offset:2048 sc1
    buffer_load_dwordx4 v[200:203], v1, s[16:19], s10 offen offset:3072 sc1
    buffer_load_dwordx4 v[204:207], v1, s[16:19], s11 offen offset:0 sc1
    buffer_load_dwordx4 v[208:211], v1, s[16:19], s11 offen offset:1024 sc1
    buffer_load_dwordx4 v[212:215], v1, s[16:19], s11 offen offset:2048 sc1
    buffer_load_dwordx4 v[216:219], v1, s[16:19], s11 offen offset:3072 sc1
    s_branch B_8
TO_B_12:
    buffer_load_dwordx4 v[188:191], v1, s[16:19], s10 offen offset:0 sc1
    buffer_load_dwordx4 v[192:195], v1, s[16:19], s10 offen offset:1024 sc1
    buffer_load_dwordx4 v[196:199], v1, s[16:19], s10 offen offset:2048 sc1
    buffer_load_dwordx4 v[200:203], v1, s[16:19], s10 offen offset:3072 sc1
    buffer_load_dwordx4 v[204:207], v1, s[16:19], s11 offen offset:0 sc1
    buffer_load_dwordx4 v[208:211], v1, s[16:19], s11 offen offset:1024 sc1
    buffer_load_dwordx4 v[212:215], v1, s[16:19], s11 offen offset:2048 sc1
    buffer_load_dwordx4 v[216:219], v1, s[16:19], s11 offen offset:3072 sc1
    s_branch B_12
TO_B_16:
    buffer_load_dwordx4 v[188:191], v1, s[16:19], s10 offen offset:0 sc1
    buffer_load_dwordx4 v[192:195], v1, s[16:19], s10 offen offset:1024 sc1
    buffer_load_dwordx4 v[196:199], v1, s[16:19], s10 offen offset:2048 sc1
    buffer_load_dwordx4 v[200:203], v1, s[16:19], s10 offen offset:3072 sc1
    buffer_load_dwordx4 v[204:207], v1, s[16:19], s11 offen offset:0 sc1
    buffer_load_dwordx4 v[208:211], v1, s[16:19], s11 offen offset:1024 sc1
    buffer_load_dwordx4 v[212:215], v1, s[16:19], s11 offen offset:2048 sc1
    buffer_load_dwordx4 v[216:219], v1, s[16:19], s11 offen offset:3072 sc1
    s_branch B_16
TO_B_20:
    buffer_load_dwordx4 v[188:191], v1, s[16:19], s10 offen offset:0 sc1
    buffer_load_dwordx4 v[192:195], v1, s[16:19], s10 offen offset:1024 sc1
    buffer_load_dwordx4 v[196:199], v1, s[16:19], s10 offen offset:2048 sc1
    buffer_load_dwordx4 v[200:203], v1, s[16:19], s10 offen offset:3072 sc1
    buffer_load_dwordx4 v[204:207], v1, s[16:19], s11 offen offset:0 sc1
    buffer_load_dwordx4 v[208:211], v1, s[16:19], s11 offen offset:1024 sc1
    buffer_load_dwordx4 v[212:215], v1, s[16:19], s11 offen offset:2048 sc1
    buffer_load_dwordx4 v[216:219], v1, s[16:19], s11 offen offset:3072 sc1
    s_branch B_20
TO_B_24:
    buffer_load_dwordx4 v[188:191], v1, s[16:19], s10 offen offset:0 sc1
    buffer_load_dwordx4 v[192:195], v1, s[16:19], s10 offen offset:1024 sc1
    buffer_load_dwordx4 v[196:199], v1, s[16:19], s10 offen offset:2048 sc1
    buffer_load_dwordx4 v[200:203], v1, s[16:19], s10 offen offset:3072 sc1
    buffer_load_dwordx4 v[204:207], v1, s[16:19], s11 offen offset:0 sc1
    buffer_load_dwordx4 v[208:211], v1, s[16:19], s11 offen offset:1024 sc1
    buffer_load_dwordx4 v[212:215], v1, s[16:19], s11 offen offset:2048 sc1
    buffer_load_dwordx4 v[216:219], v1, s[16:19], s11 offen offset:3072 sc1
    s_branch B_24
TO_B_28:
    buffer_load_dwordx4 v[188:191], v1, s[16:19], s10 offen offset:0 sc1
    buffer_load_dwordx4 v[192:195], v1, s[16:19], s10 offen offset:1024 sc1
    buffer_load_dwordx4 v[196:199], v1, s[16:19], s10 offen offset:2048 sc1
    buffer_load_dwordx4 v[200:203], v1, s[16:19], s10 offen offset:3072 sc1
    buffer_load_dwordx4 v[204:207], v1, s[16:19], s11 offen offset:0 sc1
    buffer_load_dwordx4 v[208:211], v1, s[16:19], s11 offen offset:1024 sc1
    buffer_load_dwordx4 v[212:215], v1, s[16:19], s11 offen offset:2048 sc1
    buffer_load_dwordx4 v[216:219], v1, s[16:19], s11 offen offset:3072 sc1
    s_branch B_28
TO_B_32:
    buffer_load_dwordx4 v[188:191], v1, s[16:19], s10 offen offset:0 sc1
    buffer_load_dwordx4 v[192:195], v1, s[16:19], s10 offen offset:1024 sc1
    buffer_load_dwordx4 v[196:199], v1, s[16:19], s10 offen offset:2048 sc1
    buffer_load_dwordx4 v[200:203], v1, s[16:19], s10 offen offset:3072 sc1
    buffer_load_dwordx4 v[204:207], v1, s[16:19], s11 offen offset:0 sc1
    buffer_load_dwordx4 v[208:211], v1, s[16:19], s11 offen offset:1024 sc1
    buffer_load_dwordx4 v[212:215], v1, s[16:19], s11 offen offset:2048 sc1
    buffer_load_dwordx4 v[216:219], v1, s[16:19], s11 offen offset:3072 sc1
    s_branch B_32
TO_B_36:
    buffer_load_dwordx4 v[188:191], v1, s[16:19], s10 offen offset:0 sc1
    buffer_load_dwordx4 v[192:195], v1, s[16:19], s10 offen offset:1024 sc1
    buffer_load_dwordx4 v[196:199], v1, s[16:19], s10 offen offset:2048 sc1
    buffer_load_dwordx4 v[200:203], v1, s[16:19], s10 offen offset:3072 sc1
    buffer_load_dwordx4 v[204:207], v1, s[16:19], s11 offen offset:0 sc1
    buffer_load_dwordx4 v[208:211], v1, s[16:19], s11 offen offset:1024 sc1
    buffer_load_dwordx4 v[212:215], v1, s[16:19], s11 offen offset:2048 sc1
    buffer_load_dwordx4 v[216:219], v1, s[16:19], s11 offen offset:3072 sc1
    s_branch B_36
TO_B_40:
    buffer_load_dwordx4 v[188:191], v1, s[16:19], s10 offen offset:0 sc1
    buffer_load_dwordx4 v[192:195], v1, s[16:19], s10 offen offset:1024 sc1
    buffer_load_dwordx4 v[196:199], v1, s[16:19], s10 offen offset:2048 sc1
    buffer_load_dwordx4 v[200:203], v1, s[16:19], s10 offen offset:3072 sc1
    buffer_load_dwordx4 v[204:207], v1, s[16:19], s11 offen offset:0 sc1
    buffer_load_dwordx4 v[208:211], v1, s[16:19], s11 offen offset:1024 sc1
    buffer_load_dwordx4 v[212:215], v1, s[16:19], s11 offen offset:2048 sc1
    buffer_load_dwordx4 v[216:219], v1, s[16:19], s11 offen offset:3072 sc1
    s_branch B_40
TO_B_44:
    buffer_load_dwordx4 v[188:191], v1, s[16:19], s10 offen offset:0 sc1
    buffer_load_dwordx4 v[192:195], v1, s[16:19], s10 offen offset:1024 sc1
    buffer_load_dwordx4 v[196:199], v1, s[16:19], s10 offen offset:2048 sc1
    buffer_load_dwordx4 v[200:203], v1, s[16:19], s10 offen offset:3072 sc1
    buffer_load_dwordx4 v[204:207], v1, s[16:19], s11 offen offset:0 sc1
    buffer_load_dwordx4 v[208:211], v1, s[16:19], s11 offen offset:1024 sc1
    buffer_load_dwordx4 v[212:215], v1, s[16:19], s11 offen offset:2048 sc1
    buffer_load_dwordx4 v[216:219], v1, s[16:19], s11 offen offset:3072 sc1
    s_branch B_44
TO_B_48:
    buffer_load_dwordx4 v[188:191], v1, s[16:19], s10 offen offset:0 sc1
    buffer_load_dwordx4 v[192:195], v1, s[16:19], s10 offen offset:1024 sc1
    buffer_load_dwordx4 v[196:199], v1, s[16:19], s10 offen offset:2048 sc1
    buffer_load_dwordx4 v[200:203], v1, s[16:19], s10 offen offset:3072 sc1
    buffer_load_dwordx4 v[204:207], v1, s[16:19], s11 offen offset:0 sc1
    buffer_load_dwordx4 v[208:211], v1, s[16:19], s11 offen offset:1024 sc1
    buffer_load_dwordx4 v[212:215], v1, s[16:19], s11 offen offset:2048 sc1
    buffer_load_dwordx4 v[216:219], v1, s[16:19], s11 offen offset:3072 sc1
    s_branch B_48
TO_B_52:
    buffer_load_dwordx4 v[188:191], v1, s[16:19], s10 offen offset:0 sc1
    buffer_load_dwordx4 v[192:195], v1, s[16:19], s10 offen offset:1024 sc1
    buffer_load_dwordx4 v[196:199], v1, s[16:19], s10 offen offset:2048 sc1
    buffer_load_dwordx4 v[200:203], v1, s[16:19], s10 offen offset:3072 sc1
    buffer_load_dwordx4 v[204:207], v1, s[16:19], s11 offen offset:0 sc1
    buffer_load_dwordx4 v[208:211], v1, s[16:19], s11 offen offset:1024 sc1
    buffer_load_dwordx4 v[212:215], v1, s[16:19], s11 offen offset:2048 sc1
    buffer_load_dwordx4 v[216:219], v1, s[16:19], s11 offen offset:3072 sc1
    s_branch B_52
TO_B_56:
    buffer_load_dwordx4 v[188:191], v1, s[16:19], s10 offen offset:0 sc1
    buffer_load_dwordx4 v[192:195], v1, s[16:19], s10 offen offset:1024 sc1
    buffer_load_dwordx4 v[196:199], v1, s[16:19], s10 offen offset:2048 sc1
    buffer_load_dwordx4 v[200:203], v1, s[16:19], s10 offen offset:3072 sc1
    buffer_load_dwordx4 v[204:207], v1, s[16:19], s11 offen offset:0 sc1
    buffer_load_dwordx4 v[208:211], v1, s[16:19], s11 offen offset:1024 sc1
    buffer_load_dwordx4 v[212:215], v1, s[16:19], s11 offen offset:2048 sc1
    buffer_load_dwordx4 v[216:219], v1, s[16:19], s11 offen offset:3072 sc1
    s_branch B_56
TO_B_60:
    buffer_load_dwordx4 v[188:191], v1, s[16:19], s10 offen offset:0 sc1
    buffer_load_dwordx4 v[192:195], v1, s[16:19], s10 offen offset:1024 sc1
    buffer_load_dwordx4 v[196:199], v1, s[16:19], s10 offen offset:2048 sc1
    buffer_load_dwordx4 v[200:203], v1, s[16:19], s10 offen offset:3072 sc1
    buffer_load_dwordx4 v[204:207], v1, s[16:19], s11 offen offset:0 sc1
    buffer_load_dwordx4 v[208:211], v1, s[16:19], s11 offen offset:1024 sc1
    buffer_load_dwordx4 v[212:215], v1, s[16:19], s11 offen offset:2048 sc1
    buffer_load_dwordx4 v[216:219], v1, s[16:19], s11 offen offset:3072 sc1
    s_branch B_60
B_0:
    s_sub_u32 s32, s32, 4
    s_cbranch_scc1 MAIN_DONE
    v_mfma_f32_4x4x4_16b_bf16 v[124:127], v[172:173], v[178:179], 0 cbsz:4 abid:1
    v_lshlrev_b32_sdwa v136, v15, v114 dst_sel:DWORD dst_unused:UNUSED_PAD src0_sel:DWORD src1_sel:WORD_1
    s_waitcnt vmcnt(12)
    v_mfma_f32_4x4x4_16b_bf16 v[104:107], v[142:143], v[68:69], 0 cbsz:4 abid:0
    s_nop 0
    v_mfma_f32_4x4x4_16b_bf16 v[108:111], v[142:143], v[70:71], 0 cbsz:4 abid:0
    v_lshlrev_b32_sdwa v137, v15, v115 dst_sel:DWORD dst_unused:UNUSED_PAD src0_sel:DWORD src1_sel:WORD_1
    ds_read_u16_d16_hi v132, v136 offset:32768
    ds_read_u16_d16_hi v133, v137 offset:32768
    s_waitcnt lgkmcnt(2)
    s_set_gpr_idx_on s48, 0xc
    v_pk_fma_f32 v[16:17], v[128:129], v[96:97], v[16:17] op_sel:[0,0,0] op_sel_hi:[0,1,1]
    v_pk_fma_f32 v[18:19], v[128:129], v[98:99], v[18:19] op_sel:[0,0,0] op_sel_hi:[0,1,1]
    v_pk_fma_f32 v[20:21], v[130:131], v[100:101], v[20:21] op_sel:[0,0,0] op_sel_hi:[0,1,1]
    v_pk_fma_f32 v[22:23], v[130:131], v[102:103], v[22:23] op_sel:[0,0,0] op_sel_hi:[0,1,1]
    s_set_gpr_idx_off
    v_lshlrev_b32_sdwa v138, v15, v118 dst_sel:DWORD dst_unused:UNUSED_PAD src0_sel:DWORD src1_sel:WORD_1
    s_waitcnt vmcnt(11)
    v_mfma_f32_4x4x4_16b_bf16 v[96:99], v[144:145], v[72:73], 0 cbsz:4 abid:0
    s_nop 0
    v_mfma_f32_4x4x4_16b_bf16 v[100:103], v[144:145], v[74:75], 0 cbsz:4 abid:0
    v_lshlrev_b32_sdwa v139, v15, v119 dst_sel:DWORD dst_unused:UNUSED_PAD src0_sel:DWORD src1_sel:WORD_1
    ds_read_u16_d16_hi v134, v138 offset:32768
    ds_read_u16_d16_hi v135, v139 offset:32768
    s_set_gpr_idx_on s49, 0xc
    v_pk_fma_f32 v[16:17], v[128:129], v[104:105], v[16:17] op_sel:[1,0,0] op_sel_hi:[1,1,1]
    v_pk_fma_f32 v[18:19], v[128:129], v[106:107], v[18:19] op_sel:[1,0,0] op_sel_hi:[1,1,1]
    v_pk_fma_f32 v[20:21], v[130:131], v[108:109], v[20:21] op_sel:[1,0,0] op_sel_hi:[1,1,1]
    v_pk_fma_f32 v[22:23], v[130:131], v[110:111], v[22:23] op_sel:[1,0,0] op_sel_hi:[1,1,1]
    s_set_gpr_idx_off
    v_mfma_f32_4x4x4_16b_bf16 v[112:115], v[172:173], v[176:177], 0 cbsz:4 abid:2
    v_lshlrev_b32_sdwa v136, v15, v120 dst_sel:DWORD dst_unused:UNUSED_PAD src0_sel:DWORD src1_sel:WORD_1
    s_waitcnt vmcnt(10)
    v_mfma_f32_4x4x4_16b_bf16 v[104:107], v[146:147], v[76:77], 0 cbsz:4 abid:0
    s_nop 0
    v_mfma_f32_4x4x4_16b_bf16 v[108:111], v[146:147], v[78:79], 0 cbsz:4 abid:0
    v_lshlrev_b32_sdwa v137, v15, v121 dst_sel:DWORD dst_unused:UNUSED_PAD src0_sel:DWORD src1_sel:WORD_1
    ds_read_u16_d16_hi v128, v136 offset:32768
    ds_read_u16_d16_hi v129, v137 offset:32768
    s_waitcnt lgkmcnt(2)
    s_set_gpr_idx_on s50, 0xc
    v_pk_fma_f32 v[16:17], v[132:133], v[96:97], v[16:17] op_sel:[0,0,0] op_sel_hi:[0,1,1]
    v_pk_fma_f32 v[18:19], v[132:133], v[98:99], v[18:19] op_sel:[0,0,0] op_sel_hi:[0,1,1]
    v_pk_fma_f32 v[20:21], v[134:135], v[100:101], v[20:21] op_sel:[0,0,0] op_sel_hi:[0,1,1]
    v_pk_fma_f32 v[22:23], v[134:135], v[102:103], v[22:23] op_sel:[0,0,0] op_sel_hi:[0,1,1]
    s_set_gpr_idx_off
    v_lshlrev_b32_sdwa v138, v15, v124 dst_sel:DWORD dst_unused:UNUSED_PAD src0_sel:DWORD src1_sel:WORD_1
    s_waitcnt vmcnt(9)
    v_mfma_f32_4x4x4_16b_bf16 v[96:99], v[140:141], v[80:81], 0 cbsz:4 abid:1
    s_nop 0
    v_mfma_f32_4x4x4_16b_bf16 v[100:103], v[140:141], v[82:83], 0 cbsz:4 abid:1
    v_lshlrev_b32_sdwa v139, v15, v125 dst_sel:DWORD dst_unused:UNUSED_PAD src0_sel:DWORD src1_sel:WORD_1
    ds_read_u16_d16_hi v130, v138 offset:32768
    ds_read_u16_d16_hi v131, v139 offset:32768
    s_set_gpr_idx_on s51, 0xc
    v_pk_fma_f32 v[16:17], v[132:133], v[104:105], v[16:17] op_sel:[1,0,0] op_sel_hi:[1,1,1]
    v_pk_fma_f32 v[18:19], v[132:133], v[106:107], v[18:19] op_sel:[1,0,0] op_sel_hi:[1,1,1]
    v_pk_fma_f32 v[20:21], v[134:135], v[108:109], v[20:21] op_sel:[1,0,0] op_sel_hi:[1,1,1]
    v_pk_fma_f32 v[22:23], v[134:135], v[110:111], v[22:23] op_sel:[1,0,0] op_sel_hi:[1,1,1]
    s_set_gpr_idx_off
B_4:
    s_sub_u32 s32, s32, 4
    s_cbranch_scc1 MAIN_DONE
    v_mfma_f32_4x4x4_16b_bf16 v[116:119], v[172:173], v[178:179], 0 cbsz:4 abid:2
    v_lshlrev_b32_sdwa v136, v15, v122 dst_sel:DWORD dst_unused:UNUSED_PAD src0_sel:DWORD src1_sel:WORD_1
    s_waitcnt vmcnt(12)
    v_mfma_f32_4x4x4_16b_bf16 v[104:107], v[142:143], v[84:85], 0 cbsz:4 abid:1
    s_nop 0
    v_mfma_f32_4x4x4_16b_bf16 v[108:111], v[142:143], v[86:87], 0 cbsz:4 abid:1
    v_lshlrev_b32_sdwa v137, v15, v123 dst_sel:DWORD dst_unused:UNUSED_PAD src0_sel:DWORD src1_sel:WORD_1
    ds_read_u16_d16_hi v132, v136 offset:32768
    ds_read_u16_d16_hi v133, v137 offset:32768
    s_waitcnt lgkmcnt(2)
    s_set_gpr_idx_on s52, 0xc
    v_pk_fma_f32 v[16:17], v[128:129], v[96:97], v[16:17] op_sel:[0,0,0] op_sel_hi:[0,1,1]
    v_pk_fma_f32 v[18:19], v[128:129], v[98:99], v[18:19] op_sel:[0,0,0] op_sel_hi:[0,1,1]
    v_pk_fma_f32 v[20:21], v[130:131], v[100:101], v[20:21] op_sel:[0,0,0] op_sel_hi:[0,1,1]
    v_pk_fma_f32 v[22:23], v[130:131], v[102:103], v[22:23] op_sel:[0,0,0] op_sel_hi:[0,1,1]
    s_set_gpr_idx_off
    v_lshlrev_b32_sdwa v138, v15, v126 dst_sel:DWORD dst_unused:UNUSED_PAD src0_sel:DWORD src1_sel:WORD_1
    s_waitcnt vmcnt(11)
    v_mfma_f32_4x4x4_16b_bf16 v[96:99], v[144:145], v[88:89], 0 cbsz:4 abid:1
    s_nop 0
    v_mfma_f32_4x4x4_16b_bf16 v[100:103], v[144:145], v[90:91], 0 cbsz:4 abid:1
    v_lshlrev_b32_sdwa v139, v15, v127 dst_sel:DWORD dst_unused:UNUSED_PAD src0_sel:DWORD src1_sel:WORD_1
    ds_read_u16_d16_hi v134, v138 offset:32768
    ds_read_u16_d16_hi v135, v139 offset:32768
    s_set_gpr_idx_on s53, 0xc
    v_pk_fma_f32 v[16:17], v[128:129], v[104:105], v[16:17] op_sel:[1,0,0] op_sel_hi:[1,1,1]
    v_pk_fma_f32 v[18:19], v[128:129], v[106:107], v[18:19] op_sel:[1,0,0] op_sel_hi:[1,1,1]
    v_pk_fma_f32 v[20:21], v[130:131], v[108:109], v[20:21] op_sel:[1,0,0] op_sel_hi:[1,1,1]
    v_pk_fma_f32 v[22:23], v[130:131], v[110:111], v[22:23] op_sel:[1,0,0] op_sel_hi:[1,1,1]
    s_set_gpr_idx_off
    v_mfma_f32_4x4x4_16b_bf16 v[120:123], v[172:173], v[176:177], 0 cbsz:4 abid:3
    v_lshlrev_b32_sdwa v136, v15, v112 dst_sel:DWORD dst_unused:UNUSED_PAD src0_sel:DWORD src1_sel:WORD_1
    s_waitcnt vmcnt(10)
    v_mfma_f32_4x4x4_16b_bf16 v[104:107], v[146:147], v[92:93], 0 cbsz:4 abid:1
    s_nop 0
    v_mfma_f32_4x4x4_16b_bf16 v[108:111], v[146:147], v[94:95], 0 cbsz:4 abid:1
    v_lshlrev_b32_sdwa v137, v15, v113 dst_sel:DWORD dst_unused:UNUSED_PAD src0_sel:DWORD src1_sel:WORD_1
    ds_read_u16_d16_hi v128, v136 offset:32768
    ds_read_u16_d16_hi v129, v137 offset:32768
    s_waitcnt lgkmcnt(2)
    s_set_gpr_idx_on s54, 0xc
    v_pk_fma_f32 v[16:17], v[132:133], v[96:97], v[16:17] op_sel:[0,0,0] op_sel_hi:[0,1,1]
    v_pk_fma_f32 v[18:19], v[132:133], v[98:99], v[18:19] op_sel:[0,0,0] op_sel_hi:[0,1,1]
    v_pk_fma_f32 v[20:21], v[134:135], v[100:101], v[20:21] op_sel:[0,0,0] op_sel_hi:[0,1,1]
    v_pk_fma_f32 v[22:23], v[134:135], v[102:103], v[22:23] op_sel:[0,0,0] op_sel_hi:[0,1,1]
    s_set_gpr_idx_off
    v_lshlrev_b32_sdwa v138, v15, v116 dst_sel:DWORD dst_unused:UNUSED_PAD src0_sel:DWORD src1_sel:WORD_1
    s_waitcnt vmcnt(9)
    v_mfma_f32_4x4x4_16b_bf16 v[96:99], v[140:141], v[64:65], 0 cbsz:4 abid:2
    s_nop 0
    v_mfma_f32_4x4x4_16b_bf16 v[100:103], v[140:141], v[66:67], 0 cbsz:4 abid:2
    v_lshlrev_b32_sdwa v139, v15, v117 dst_sel:DWORD dst_unused:UNUSED_PAD src0_sel:DWORD src1_sel:WORD_1
    ds_read_u16_d16_hi v130, v138 offset:32768
    ds_read_u16_d16_hi v131, v139 offset:32768
    s_set_gpr_idx_on s55, 0xc
    v_pk_fma_f32 v[16:17], v[132:133], v[104:105], v[16:17] op_sel:[1,0,0] op_sel_hi:[1,1,1]
    v_pk_fma_f32 v[18:19], v[132:133], v[106:107], v[18:19] op_sel:[1,0,0] op_sel_hi:[1,1,1]
    v_pk_fma_f32 v[20:21], v[134:135], v[108:109], v[20:21] op_sel:[1,0,0] op_sel_hi:[1,1,1]
    v_pk_fma_f32 v[22:23], v[134:135], v[110:111], v[22:23] op_sel:[1,0,0] op_sel_hi:[1,1,1]
    s_set_gpr_idx_off
B_8:
    s_sub_u32 s32, s32, 4
    s_cbranch_scc1 MAIN_DONE
    v_mfma_f32_4x4x4_16b_bf16 v[124:127], v[172:173], v[178:179], 0 cbsz:4 abid:3
    v_lshlrev_b32_sdwa v136, v15, v114 dst_sel:DWORD dst_unused:UNUSED_PAD src0_sel:DWORD src1_sel:WORD_1
    s_waitcnt vmcnt(12)
    v_mfma_f32_4x4x4_16b_bf16 v[104:107], v[142:143], v[68:69], 0 cbsz:4 abid:2
    s_nop 0
    v_mfma_f32_4x4x4_16b_bf16 v[108:111], v[142:143], v[70:71], 0 cbsz:4 abid:2
    v_lshlrev_b32_sdwa v137, v15, v115 dst_sel:DWORD dst_unused:UNUSED_PAD src0_sel:DWORD src1_sel:WORD_1
    ds_read_u16_d16_hi v132, v136 offset:32768
    ds_read_u16_d16_hi v133, v137 offset:32768
    s_waitcnt lgkmcnt(2)
    s_set_gpr_idx_on s56, 0xc
    v_pk_fma_f32 v[16:17], v[128:129], v[96:97], v[16:17] op_sel:[0,0,0] op_sel_hi:[0,1,1]
    v_pk_fma_f32 v[18:19], v[128:129], v[98:99], v[18:19] op_sel:[0,0,0] op_sel_hi:[0,1,1]
    v_pk_fma_f32 v[20:21], v[130:131], v[100:101], v[20:21] op_sel:[0,0,0] op_sel_hi:[0,1,1]
    v_pk_fma_f32 v[22:23], v[130:131], v[102:103], v[22:23] op_sel:[0,0,0] op_sel_hi:[0,1,1]
    s_set_gpr_idx_off
    ds_read_b32 v165, v5
    v_lshlrev_b32_sdwa v138, v15, v118 dst_sel:DWORD dst_unused:UNUSED_PAD src0_sel:DWORD src1_sel:WORD_1
    s_waitcnt vmcnt(11)
    v_mfma_f32_4x4x4_16b_bf16 v[96:99], v[144:145], v[72:73], 0 cbsz:4 abid:2
    s_nop 0
    v_mfma_f32_4x4x4_16b_bf16 v[100:103], v[144:145], v[74:75], 0 cbsz:4 abid:2
    v_lshlrev_b32_sdwa v139, v15, v119 dst_sel:DWORD dst_unused:UNUSED_PAD src0_sel:DWORD src1_sel:WORD_1
    ds_read_u16_d16_hi v134, v138 offset:32768
    ds_read_u16_d16_hi v135, v139 offset:32768
    s_set_gpr_idx_on s57, 0xc
    v_pk_fma_f32 v[16:17], v[128:129], v[104:105], v[16:17] op_sel:[1,0,0] op_sel_hi:[1,1,1]
    v_pk_fma_f32 v[18:19], v[128:129], v[106:107], v[18:19] op_sel:[1,0,0] op_sel_hi:[1,1,1]
    v_pk_fma_f32 v[20:21], v[130:131], v[108:109], v[20:21] op_sel:[1,0,0] op_sel_hi:[1,1,1]
    v_pk_fma_f32 v[22:23], v[130:131], v[110:111], v[22:23] op_sel:[1,0,0] op_sel_hi:[1,1,1]
    s_set_gpr_idx_off
    v_mfma_f32_4x4x4_16b_bf16 v[112:115], v[172:173], v[176:177], 0 cbsz:4 abid:4
    v_lshlrev_b32_sdwa v136, v15, v120 dst_sel:DWORD dst_unused:UNUSED_PAD src0_sel:DWORD src1_sel:WORD_1
    s_waitcnt vmcnt(10)
    v_mfma_f32_4x4x4_16b_bf16 v[104:107], v[146:147], v[76:77], 0 cbsz:4 abid:2
    s_nop 0
    v_mfma_f32_4x4x4_16b_bf16 v[108:111], v[146:147], v[78:79], 0 cbsz:4 abid:2
    v_lshlrev_b32_sdwa v137, v15, v121 dst_sel:DWORD dst_unused:UNUSED_PAD src0_sel:DWORD src1_sel:WORD_1
    ds_read_u16_d16_hi v128, v136 offset:32768
    ds_read_u16_d16_hi v129, v137 offset:32768
    s_waitcnt lgkmcnt(2)
    s_set_gpr_idx_on s58, 0xc
    v_pk_fma_f32 v[16:17], v[132:133], v[96:97], v[16:17] op_sel:[0,0,0] op_sel_hi:[0,1,1]
    v_pk_fma_f32 v[18:19], v[132:133], v[98:99], v[18:19] op_sel:[0,0,0] op_sel_hi:[0,1,1]
    v_pk_fma_f32 v[20:21], v[134:135], v[100:101], v[20:21] op_sel:[0,0,0] op_sel_hi:[0,1,1]
    v_pk_fma_f32 v[22:23], v[134:135], v[102:103], v[22:23] op_sel:[0,0,0] op_sel_hi:[0,1,1]
    s_set_gpr_idx_off
    v_lshlrev_b32_sdwa v138, v15, v124 dst_sel:DWORD dst_unused:UNUSED_PAD src0_sel:DWORD src1_sel:WORD_1
    s_waitcnt vmcnt(9)
    v_mfma_f32_4x4x4_16b_bf16 v[96:99], v[140:141], v[80:81], 0 cbsz:4 abid:3
    s_nop 0
    v_mfma_f32_4x4x4_16b_bf16 v[100:103], v[140:141], v[82:83], 0 cbsz:4 abid:3
    v_lshlrev_b32_sdwa v139, v15, v125 dst_sel:DWORD dst_unused:UNUSED_PAD src0_sel:DWORD src1_sel:WORD_1
    ds_read_u16_d16_hi v130, v138 offset:32768
    ds_read_u16_d16_hi v131, v139 offset:32768
    s_set_gpr_idx_on s59, 0xc
    v_pk_fma_f32 v[16:17], v[132:133], v[104:105], v[16:17] op_sel:[1,0,0] op_sel_hi:[1,1,1]
    v_pk_fma_f32 v[18:19], v[132:133], v[106:107], v[18:19] op_sel:[1,0,0] op_sel_hi:[1,1,1]
    v_pk_fma_f32 v[20:21], v[134:135], v[108:109], v[20:21] op_sel:[1,0,0] op_sel_hi:[1,1,1]
    v_pk_fma_f32 v[22:23], v[134:135], v[110:111], v[22:23] op_sel:[1,0,0] op_sel_hi:[1,1,1]
    s_set_gpr_idx_off
B_12:
    s_sub_u32 s32, s32, 4
    s_cbranch_scc1 MAIN_DONE
    v_mfma_f32_4x4x4_16b_bf16 v[116:119], v[172:173], v[178:179], 0 cbsz:4 abid:4
    v_lshlrev_b32_sdwa v136, v15, v122 dst_sel:DWORD dst_unused:UNUSED_PAD src0_sel:DWORD src1_sel:WORD_1
    s_waitcnt vmcnt(12)
    v_mfma_f32_4x4x4_16b_bf16 v[104:107], v[142:143], v[84:85], 0 cbsz:4 abid:3
    s_nop 0
    v_mfma_f32_4x4x4_16b_bf16 v[108:111], v[142:143], v[86:87], 0 cbsz:4 abid:3
    v_lshlrev_b32_sdwa v137, v15, v123 dst_sel:DWORD dst_unused:UNUSED_PAD src0_sel:DWORD src1_sel:WORD_1
    ds_read_u16_d16_hi v132, v136 offset:32768
    ds_read_u16_d16_hi v133, v137 offset:32768
    s_waitcnt lgkmcnt(2)
    s_set_gpr_idx_on s60, 0xc
    v_pk_fma_f32 v[16:17], v[128:129], v[96:97], v[16:17] op_sel:[0,0,0] op_sel_hi:[0,1,1]
    v_pk_fma_f32 v[18:19], v[128:129], v[98:99], v[18:19] op_sel:[0,0,0] op_sel_hi:[0,1,1]
    v_pk_fma_f32 v[20:21], v[130:131], v[100:101], v[20:21] op_sel:[0,0,0] op_sel_hi:[0,1,1]
    v_pk_fma_f32 v[22:23], v[130:131], v[102:103], v[22:23] op_sel:[0,0,0] op_sel_hi:[0,1,1]
    s_set_gpr_idx_off
    v_cmp_gt_u32 vcc, s30, v6
    v_add_u32 v6, 64, v6
    v_add_u32 v5, 256, v5
    v_cndmask_b32 v165, 40, v165, vcc
    v_lshrrev_b32 v8, 21, v165
    v_lshlrev_b32 v8, 4, v8
    v_lshlrev_b32 v9, 3, v165
    ds_read_b128 v[168:171], v8 offset:8192
    v_and_b32 v9, 0xfffc00, v9
    v_and_or_b32 v165, v165, 56, v9
    v_lshlrev_b32_sdwa v138, v15, v126 dst_sel:DWORD dst_unused:UNUSED_PAD src0_sel:DWORD src1_sel:WORD_1
    s_waitcnt vmcnt(11)
    v_mfma_f32_4x4x4_16b_bf16 v[96:99], v[144:145], v[88:89], 0 cbsz:4 abid:3
    s_nop 0
    v_mfma_f32_4x4x4_16b_bf16 v[100:103], v[144:145], v[90:91], 0 cbsz:4 abid:3
    v_lshlrev_b32_sdwa v139, v15, v127 dst_sel:DWORD dst_unused:UNUSED_PAD src0_sel:DWORD src1_sel:WORD_1
    ds_read_u16_d16_hi v134, v138 offset:32768
    ds_read_u16_d16_hi v135, v139 offset:32768
    s_set_gpr_idx_on s61, 0xc
    v_pk_fma_f32 v[16:17], v[128:129], v[104:105], v[16:17] op_sel:[1,0,0] op_sel_hi:[1,1,1]
    v_pk_fma_f32 v[18:19], v[128:129], v[106:107], v[18:19] op_sel:[1,0,0] op_sel_hi:[1,1,1]
    v_pk_fma_f32 v[20:21], v[130:131], v[108:109], v[20:21] op_sel:[1,0,0] op_sel_hi:[1,1,1]
    v_pk_fma_f32 v[22:23], v[130:131], v[110:111], v[22:23] op_sel:[1,0,0] op_sel_hi:[1,1,1]
    s_set_gpr_idx_off
    v_mfma_f32_4x4x4_16b_bf16 v[120:123], v[172:173], v[176:177], 0 cbsz:4 abid:5
    v_lshlrev_b32_sdwa v136, v15, v112 dst_sel:DWORD dst_unused:UNUSED_PAD src0_sel:DWORD src1_sel:WORD_1
    s_waitcnt vmcnt(10)
    v_mfma_f32_4x4x4_16b_bf16 v[104:107], v[146:147], v[92:93], 0 cbsz:4 abid:3
    s_nop 0
    v_mfma_f32_4x4x4_16b_bf16 v[108:111], v[146:147], v[94:95], 0 cbsz:4 abid:3
    v_lshlrev_b32_sdwa v137, v15, v113 dst_sel:DWORD dst_unused:UNUSED_PAD src0_sel:DWORD src1_sel:WORD_1
    ds_read_u16_d16_hi v128, v136 offset:32768
    ds_read_u16_d16_hi v129, v137 offset:32768
    s_waitcnt lgkmcnt(2)
    s_set_gpr_idx_on s62, 0xc
    v_pk_fma_f32 v[16:17], v[132:133], v[96:97], v[16:17] op_sel:[0,0,0] op_sel_hi:[0,1,1]
    v_pk_fma_f32 v[18:19], v[132:133], v[98:99], v[18:19] op_sel:[0,0,0] op_sel_hi:[0,1,1]
    v_pk_fma_f32 v[20:21], v[134:135], v[100:101], v[20:21] op_sel:[0,0,0] op_sel_hi:[0,1,1]
    v_pk_fma_f32 v[22:23], v[134:135], v[102:103], v[22:23] op_sel:[0,0,0] op_sel_hi:[0,1,1]
    s_set_gpr_idx_off
    v_lshlrev_b32_sdwa v138, v15, v116 dst_sel:DWORD dst_unused:UNUSED_PAD src0_sel:DWORD src1_sel:WORD_1
    s_waitcnt vmcnt(9)
    v_mfma_f32_4x4x4_16b_bf16 v[96:99], v[140:141], v[64:65], 0 cbsz:4 abid:4
    s_nop 0
    v_mfma_f32_4x4x4_16b_bf16 v[100:103], v[140:141], v[66:67], 0 cbsz:4 abid:4
    v_lshlrev_b32_sdwa v139, v15, v117 dst_sel:DWORD dst_unused:UNUSED_PAD src0_sel:DWORD src1_sel:WORD_1
    ds_read_u16_d16_hi v130, v138 offset:32768
    ds_read_u16_d16_hi v131, v139 offset:32768
    s_set_gpr_idx_on s63, 0xc
    v_pk_fma_f32 v[16:17], v[132:133], v[104:105], v[16:17] op_sel:[1,0,0] op_sel_hi:[1,1,1]
    v_pk_fma_f32 v[18:19], v[132:133], v[106:107], v[18:19] op_sel:[1,0,0] op_sel_hi:[1,1,1]
    v_pk_fma_f32 v[20:21], v[134:135], v[108:109], v[20:21] op_sel:[1,0,0] op_sel_hi:[1,1,1]
    v_pk_fma_f32 v[22:23], v[134:135], v[110:111], v[22:23] op_sel:[1,0,0] op_sel_hi:[1,1,1]
    s_set_gpr_idx_off
B_16:
    s_sub_u32 s32, s32, 4
    s_cbranch_scc1 MAIN_DONE
    v_mfma_f32_4x4x4_16b_bf16 v[124:127], v[172:173], v[178:179], 0 cbsz:4 abid:5
    v_lshlrev_b32_sdwa v136, v15, v114 dst_sel:DWORD dst_unused:UNUSED_PAD src0_sel:DWORD src1_sel:WORD_1
    s_waitcnt vmcnt(12)
    v_mfma_f32_4x4x4_16b_bf16 v[104:107], v[142:143], v[68:69], 0 cbsz:4 abid:4
    s_nop 0
    v_mfma_f32_4x4x4_16b_bf16 v[108:111], v[142:143], v[70:71], 0 cbsz:4 abid:4
    v_lshlrev_b32_sdwa v137, v15, v115 dst_sel:DWORD dst_unused:UNUSED_PAD src0_sel:DWORD src1_sel:WORD_1
    ds_read_u16_d16_hi v132, v136 offset:32768
    ds_read_u16_d16_hi v133, v137 offset:32768
    s_waitcnt lgkmcnt(2)
    s_set_gpr_idx_on s48, 0xc
    v_pk_fma_f32 v[16:17], v[128:129], v[96:97], v[16:17] op_sel:[0,0,0] op_sel_hi:[0,1,1]
    v_pk_fma_f32 v[18:19], v[128:129], v[98:99], v[18:19] op_sel:[0,0,0] op_sel_hi:[0,1,1]
    v_pk_fma_f32 v[20:21], v[130:131], v[100:101], v[20:21] op_sel:[0,0,0] op_sel_hi:[0,1,1]
    v_pk_fma_f32 v[22:23], v[130:131], v[102:103], v[22:23] op_sel:[0,0,0] op_sel_hi:[0,1,1]
    s_set_gpr_idx_off
    v_lshlrev_b32_sdwa v138, v15, v118 dst_sel:DWORD dst_unused:UNUSED_PAD src0_sel:DWORD src1_sel:WORD_1
    s_waitcnt vmcnt(11)
    v_mfma_f32_4x4x4_16b_bf16 v[96:99], v[144:145], v[72:73], 0 cbsz:4 abid:4
    s_nop 0
    v_mfma_f32_4x4x4_16b_bf16 v[100:103], v[144:145], v[74:75], 0 cbsz:4 abid:4
    v_lshlrev_b32_sdwa v139, v15, v119 dst_sel:DWORD dst_unused:UNUSED_PAD src0_sel:DWORD src1_sel:WORD_1
    ds_read_u16_d16_hi v134, v138 offset:32768
    ds_read_u16_d16_hi v135, v139 offset:32768
    s_set_gpr_idx_on s49, 0xc
    v_pk_fma_f32 v[16:17], v[128:129], v[104:105], v[16:17] op_sel:[1,0,0] op_sel_hi:[1,1,1]
    v_pk_fma_f32 v[18:19], v[128:129], v[106:107], v[18:19] op_sel:[1,0,0] op_sel_hi:[1,1,1]
    v_pk_fma_f32 v[20:21], v[130:131], v[108:109], v[20:21] op_sel:[1,0,0] op_sel_hi:[1,1,1]
    v_pk_fma_f32 v[22:23], v[130:131], v[110:111], v[22:23] op_sel:[1,0,0] op_sel_hi:[1,1,1]
    s_set_gpr_idx_off
    v_mfma_f32_4x4x4_16b_bf16 v[112:115], v[172:173], v[176:177], 0 cbsz:4 abid:6
    v_lshlrev_b32_sdwa v136, v15, v120 dst_sel:DWORD dst_unused:UNUSED_PAD src0_sel:DWORD src1_sel:WORD_1
    s_waitcnt vmcnt(10)
    v_mfma_f32_4x4x4_16b_bf16 v[104:107], v[146:147], v[76:77], 0 cbsz:4 abid:4
    s_nop 0
    v_mfma_f32_4x4x4_16b_bf16 v[108:111], v[146:147], v[78:79], 0 cbsz:4 abid:4
    v_lshlrev_b32_sdwa v137, v15, v121 dst_sel:DWORD dst_unused:UNUSED_PAD src0_sel:DWORD src1_sel:WORD_1
    ds_read_u16_d16_hi v128, v136 offset:32768
    ds_read_u16_d16_hi v129, v137 offset:32768
    s_waitcnt lgkmcnt(2)
    s_set_gpr_idx_on s50, 0xc
    v_pk_fma_f32 v[16:17], v[132:133], v[96:97], v[16:17] op_sel:[0,0,0] op_sel_hi:[0,1,1]
    v_pk_fma_f32 v[18:19], v[132:133], v[98:99], v[18:19] op_sel:[0,0,0] op_sel_hi:[0,1,1]
    v_pk_fma_f32 v[20:21], v[134:135], v[100:101], v[20:21] op_sel:[0,0,0] op_sel_hi:[0,1,1]
    v_pk_fma_f32 v[22:23], v[134:135], v[102:103], v[22:23] op_sel:[0,0,0] op_sel_hi:[0,1,1]
    s_set_gpr_idx_off
    v_lshlrev_b32_sdwa v138, v15, v124 dst_sel:DWORD dst_unused:UNUSED_PAD src0_sel:DWORD src1_sel:WORD_1
    s_waitcnt vmcnt(9)
    v_mfma_f32_4x4x4_16b_bf16 v[96:99], v[140:141], v[80:81], 0 cbsz:4 abid:5
    s_nop 0
    v_mfma_f32_4x4x4_16b_bf16 v[100:103], v[140:141], v[82:83], 0 cbsz:4 abid:5
    v_lshlrev_b32_sdwa v139, v15, v125 dst_sel:DWORD dst_unused:UNUSED_PAD src0_sel:DWORD src1_sel:WORD_1
    ds_read_u16_d16_hi v130, v138 offset:32768
    ds_read_u16_d16_hi v131, v139 offset:32768
    s_set_gpr_idx_on s51, 0xc
    v_pk_fma_f32 v[16:17], v[132:133], v[104:105], v[16:17] op_sel:[1,0,0] op_sel_hi:[1,1,1]
    v_pk_fma_f32 v[18:19], v[132:133], v[106:107], v[18:19] op_sel:[1,0,0] op_sel_hi:[1,1,1]
    v_pk_fma_f32 v[20:21], v[134:135], v[108:109], v[20:21] op_sel:[1,0,0] op_sel_hi:[1,1,1]
    v_pk_fma_f32 v[22:23], v[134:135], v[110:111], v[22:23] op_sel:[1,0,0] op_sel_hi:[1,1,1]
    s_set_gpr_idx_off
B_20:
    s_sub_u32 s32, s32, 4
    s_cbranch_scc1 MAIN_DONE
    v_mfma_f32_4x4x4_16b_bf16 v[116:119], v[172:173], v[178:179], 0 cbsz:4 abid:6
    v_lshlrev_b32_sdwa v136, v15, v122 dst_sel:DWORD dst_unused:UNUSED_PAD src0_sel:DWORD src1_sel:WORD_1
    s_waitcnt vmcnt(12)
    v_mfma_f32_4x4x4_16b_bf16 v[104:107], v[142:143], v[84:85], 0 cbsz:4 abid:5
    s_nop 0
    v_mfma_f32_4x4x4_16b_bf16 v[108:111], v[142:143], v[86:87], 0 cbsz:4 abid:5
    v_lshlrev_b32_sdwa v137, v15, v123 dst_sel:DWORD dst_unused:UNUSED_PAD src0_sel:DWORD src1_sel:WORD_1
    ds_read_u16_d16_hi v132, v136 offset:32768
    ds_read_u16_d16_hi v133, v137 offset:32768
    s_waitcnt lgkmcnt(2)
    s_set_gpr_idx_on s52, 0xc
    v_pk_fma_f32 v[16:17], v[128:129], v[96:97], v[16:17] op_sel:[0,0,0] op_sel_hi:[0,1,1]
    v_pk_fma_f32 v[18:19], v[128:129], v[98:99], v[18:19] op_sel:[0,0,0] op_sel_hi:[0,1,1]
    v_pk_fma_f32 v[20:21], v[130:131], v[100:101], v[20:21] op_sel:[0,0,0] op_sel_hi:[0,1,1]
    v_pk_fma_f32 v[22:23], v[130:131], v[102:103], v[22:23] op_sel:[0,0,0] op_sel_hi:[0,1,1]
    s_set_gpr_idx_off
    v_lshlrev_b32_sdwa v138, v15, v126 dst_sel:DWORD dst_unused:UNUSED_PAD src0_sel:DWORD src1_sel:WORD_1
    s_waitcnt vmcnt(11)
    v_mfma_f32_4x4x4_16b_bf16 v[96:99], v[144:145], v[88:89], 0 cbsz:4 abid:5
    s_nop 0
    v_mfma_f32_4x4x4_16b_bf16 v[100:103], v[144:145], v[90:91], 0 cbsz:4 abid:5
    v_lshlrev_b32_sdwa v139, v15, v127 dst_sel:DWORD dst_unused:UNUSED_PAD src0_sel:DWORD src1_sel:WORD_1
    ds_read_u16_d16_hi v134, v138 offset:32768
    ds_read_u16_d16_hi v135, v139 offset:32768
    s_set_gpr_idx_on s53, 0xc
    v_pk_fma_f32 v[16:17], v[128:129], v[104:105], v[16:17] op_sel:[1,0,0] op_sel_hi:[1,1,1]
    v_pk_fma_f32 v[18:19], v[128:129], v[106:107], v[18:19] op_sel:[1,0,0] op_sel_hi:[1,1,1]
    v_pk_fma_f32 v[20:21], v[130:131], v[108:109], v[20:21] op_sel:[1,0,0] op_sel_hi:[1,1,1]
    v_pk_fma_f32 v[22:23], v[130:131], v[110:111], v[22:23] op_sel:[1,0,0] op_sel_hi:[1,1,1]
    s_set_gpr_idx_off
    v_mfma_f32_4x4x4_16b_bf16 v[120:123], v[172:173], v[176:177], 0 cbsz:4 abid:7
    v_lshlrev_b32_sdwa v136, v15, v112 dst_sel:DWORD dst_unused:UNUSED_PAD src0_sel:DWORD src1_sel:WORD_1
    s_waitcnt vmcnt(10)
    v_mfma_f32_4x4x4_16b_bf16 v[104:107], v[146:147], v[92:93], 0 cbsz:4 abid:5
    s_nop 0
    v_mfma_f32_4x4x4_16b_bf16 v[108:111], v[146:147], v[94:95], 0 cbsz:4 abid:5
    v_lshlrev_b32_sdwa v137, v15, v113 dst_sel:DWORD dst_unused:UNUSED_PAD src0_sel:DWORD src1_sel:WORD_1
    ds_read_u16_d16_hi v128, v136 offset:32768
    ds_read_u16_d16_hi v129, v137 offset:32768
    s_waitcnt lgkmcnt(2)
    s_set_gpr_idx_on s54, 0xc
    v_pk_fma_f32 v[16:17], v[132:133], v[96:97], v[16:17] op_sel:[0,0,0] op_sel_hi:[0,1,1]
    v_pk_fma_f32 v[18:19], v[132:133], v[98:99], v[18:19] op_sel:[0,0,0] op_sel_hi:[0,1,1]
    v_pk_fma_f32 v[20:21], v[134:135], v[100:101], v[20:21] op_sel:[0,0,0] op_sel_hi:[0,1,1]
    v_pk_fma_f32 v[22:23], v[134:135], v[102:103], v[22:23] op_sel:[0,0,0] op_sel_hi:[0,1,1]
    s_set_gpr_idx_off
    v_lshlrev_b32_sdwa v138, v15, v116 dst_sel:DWORD dst_unused:UNUSED_PAD src0_sel:DWORD src1_sel:WORD_1
    s_waitcnt vmcnt(9)
    v_mfma_f32_4x4x4_16b_bf16 v[96:99], v[140:141], v[64:65], 0 cbsz:4 abid:6
    s_nop 0
    v_mfma_f32_4x4x4_16b_bf16 v[100:103], v[140:141], v[66:67], 0 cbsz:4 abid:6
    v_lshlrev_b32_sdwa v139, v15, v117 dst_sel:DWORD dst_unused:UNUSED_PAD src0_sel:DWORD src1_sel:WORD_1
    ds_read_u16_d16_hi v130, v138 offset:32768
    ds_read_u16_d16_hi v131, v139 offset:32768
    s_set_gpr_idx_on s55, 0xc
    v_pk_fma_f32 v[16:17], v[132:133], v[104:105], v[16:17] op_sel:[1,0,0] op_sel_hi:[1,1,1]
    v_pk_fma_f32 v[18:19], v[132:133], v[106:107], v[18:19] op_sel:[1,0,0] op_sel_hi:[1,1,1]
    v_pk_fma_f32 v[20:21], v[134:135], v[108:109], v[20:21] op_sel:[1,0,0] op_sel_hi:[1,1,1]
    v_pk_fma_f32 v[22:23], v[134:135], v[110:111], v[22:23] op_sel:[1,0,0] op_sel_hi:[1,1,1]
    s_set_gpr_idx_off
B_24:
    s_sub_u32 s32, s32, 4
    s_cbranch_scc1 MAIN_DONE
    v_mfma_f32_4x4x4_16b_bf16 v[124:127], v[172:173], v[178:179], 0 cbsz:4 abid:7
    v_lshlrev_b32_sdwa v136, v15, v114 dst_sel:DWORD dst_unused:UNUSED_PAD src0_sel:DWORD src1_sel:WORD_1
    s_waitcnt vmcnt(12)
    v_mfma_f32_4x4x4_16b_bf16 v[104:107], v[142:143], v[68:69], 0 cbsz:4 abid:6
    s_nop 0
    v_mfma_f32_4x4x4_16b_bf16 v[108:111], v[142:143], v[70:71], 0 cbsz:4 abid:6
    v_lshlrev_b32_sdwa v137, v15, v115 dst_sel:DWORD dst_unused:UNUSED_PAD src0_sel:DWORD src1_sel:WORD_1
    ds_read_u16_d16_hi v132, v136 offset:32768
    ds_read_u16_d16_hi v133, v137 offset:32768
    s_waitcnt lgkmcnt(2)
    s_set_gpr_idx_on s56, 0xc
    v_pk_fma_f32 v[16:17], v[128:129], v[96:97], v[16:17] op_sel:[0,0,0] op_sel_hi:[0,1,1]
    v_pk_fma_f32 v[18:19], v[128:129], v[98:99], v[18:19] op_sel:[0,0,0] op_sel_hi:[0,1,1]
    v_pk_fma_f32 v[20:21], v[130:131], v[100:101], v[20:21] op_sel:[0,0,0] op_sel_hi:[0,1,1]
    v_pk_fma_f32 v[22:23], v[130:131], v[102:103], v[22:23] op_sel:[0,0,0] op_sel_hi:[0,1,1]
    s_set_gpr_idx_off
    v_lshlrev_b32_sdwa v138, v15, v118 dst_sel:DWORD dst_unused:UNUSED_PAD src0_sel:DWORD src1_sel:WORD_1
    s_waitcnt vmcnt(11)
    v_mfma_f32_4x4x4_16b_bf16 v[96:99], v[144:145], v[72:73], 0 cbsz:4 abid:6
    s_nop 0
    v_mfma_f32_4x4x4_16b_bf16 v[100:103], v[144:145], v[74:75], 0 cbsz:4 abid:6
    v_lshlrev_b32_sdwa v139, v15, v119 dst_sel:DWORD dst_unused:UNUSED_PAD src0_sel:DWORD src1_sel:WORD_1
    ds_read_u16_d16_hi v134, v138 offset:32768
    ds_read_u16_d16_hi v135, v139 offset:32768
    s_set_gpr_idx_on s57, 0xc
    v_pk_fma_f32 v[16:17], v[128:129], v[104:105], v[16:17] op_sel:[1,0,0] op_sel_hi:[1,1,1]
    v_pk_fma_f32 v[18:19], v[128:129], v[106:107], v[18:19] op_sel:[1,0,0] op_sel_hi:[1,1,1]
    v_pk_fma_f32 v[20:21], v[130:131], v[108:109], v[20:21] op_sel:[1,0,0] op_sel_hi:[1,1,1]
    v_pk_fma_f32 v[22:23], v[130:131], v[110:111], v[22:23] op_sel:[1,0,0] op_sel_hi:[1,1,1]
    s_set_gpr_idx_off
    v_mfma_f32_4x4x4_16b_bf16 v[112:115], v[172:173], v[176:177], 0 cbsz:4 abid:8
    v_lshlrev_b32_sdwa v136, v15, v120 dst_sel:DWORD dst_unused:UNUSED_PAD src0_sel:DWORD src1_sel:WORD_1
    s_waitcnt vmcnt(10)
    v_mfma_f32_4x4x4_16b_bf16 v[104:107], v[146:147], v[76:77], 0 cbsz:4 abid:6
    s_nop 0
    v_mfma_f32_4x4x4_16b_bf16 v[108:111], v[146:147], v[78:79], 0 cbsz:4 abid:6
    v_lshlrev_b32_sdwa v137, v15, v121 dst_sel:DWORD dst_unused:UNUSED_PAD src0_sel:DWORD src1_sel:WORD_1
    ds_read_u16_d16_hi v128, v136 offset:32768
    ds_read_u16_d16_hi v129, v137 offset:32768
    s_waitcnt lgkmcnt(2)
    s_set_gpr_idx_on s58, 0xc
    v_pk_fma_f32 v[16:17], v[132:133], v[96:97], v[16:17] op_sel:[0,0,0] op_sel_hi:[0,1,1]
    v_pk_fma_f32 v[18:19], v[132:133], v[98:99], v[18:19] op_sel:[0,0,0] op_sel_hi:[0,1,1]
    v_pk_fma_f32 v[20:21], v[134:135], v[100:101], v[20:21] op_sel:[0,0,0] op_sel_hi:[0,1,1]
    v_pk_fma_f32 v[22:23], v[134:135], v[102:103], v[22:23] op_sel:[0,0,0] op_sel_hi:[0,1,1]
    s_set_gpr_idx_off
    v_lshlrev_b32_sdwa v138, v15, v124 dst_sel:DWORD dst_unused:UNUSED_PAD src0_sel:DWORD src1_sel:WORD_1
    s_waitcnt vmcnt(9)
    v_mfma_f32_4x4x4_16b_bf16 v[96:99], v[140:141], v[80:81], 0 cbsz:4 abid:7
    s_nop 0
    v_mfma_f32_4x4x4_16b_bf16 v[100:103], v[140:141], v[82:83], 0 cbsz:4 abid:7
    v_lshlrev_b32_sdwa v139, v15, v125 dst_sel:DWORD dst_unused:UNUSED_PAD src0_sel:DWORD src1_sel:WORD_1
    ds_read_u16_d16_hi v130, v138 offset:32768
    ds_read_u16_d16_hi v131, v139 offset:32768
    s_set_gpr_idx_on s59, 0xc
    v_pk_fma_f32 v[16:17], v[132:133], v[104:105], v[16:17] op_sel:[1,0,0] op_sel_hi:[1,1,1]
    v_pk_fma_f32 v[18:19], v[132:133], v[106:107], v[18:19] op_sel:[1,0,0] op_sel_hi:[1,1,1]
    v_pk_fma_f32 v[20:21], v[134:135], v[108:109], v[20:21] op_sel:[1,0,0] op_sel_hi:[1,1,1]
    v_pk_fma_f32 v[22:23], v[134:135], v[110:111], v[22:23] op_sel:[1,0,0] op_sel_hi:[1,1,1]
    s_set_gpr_idx_off
B_28:
    s_sub_u32 s32, s32, 4
    s_cbranch_scc1 MAIN_DONE
    v_mfma_f32_4x4x4_16b_bf16 v[116:119], v[172:173], v[178:179], 0 cbsz:4 abid:8
    v_lshlrev_b32_sdwa v136, v15, v122 dst_sel:DWORD dst_unused:UNUSED_PAD src0_sel:DWORD src1_sel:WORD_1
    s_waitcnt vmcnt(12)
    v_mfma_f32_4x4x4_16b_bf16 v[104:107], v[142:143], v[84:85], 0 cbsz:4 abid:7
    s_nop 0
    v_mfma_f32_4x4x4_16b_bf16 v[108:111], v[142:143], v[86:87], 0 cbsz:4 abid:7
    v_lshlrev_b32_sdwa v137, v15, v123 dst_sel:DWORD dst_unused:UNUSED_PAD src0_sel:DWORD src1_sel:WORD_1
    ds_read_u16_d16_hi v132, v136 offset:32768
    ds_read_u16_d16_hi v133, v137 offset:32768
    s_waitcnt lgkmcnt(2)
    s_set_gpr_idx_on s60, 0xc
    v_pk_fma_f32 v[16:17], v[128:129], v[96:97], v[16:17] op_sel:[0,0,0] op_sel_hi:[0,1,1]
    v_pk_fma_f32 v[18:19], v[128:129], v[98:99], v[18:19] op_sel:[0,0,0] op_sel_hi:[0,1,1]
    v_pk_fma_f32 v[20:21], v[130:131], v[100:101], v[20:21] op_sel:[0,0,0] op_sel_hi:[0,1,1]
    v_pk_fma_f32 v[22:23], v[130:131], v[102:103], v[22:23] op_sel:[0,0,0] op_sel_hi:[0,1,1]
    s_set_gpr_idx_off
    v_lshlrev_b32_sdwa v138, v15, v126 dst_sel:DWORD dst_unused:UNUSED_PAD src0_sel:DWORD src1_sel:WORD_1
    s_waitcnt vmcnt(11)
    v_mfma_f32_4x4x4_16b_bf16 v[96:99], v[144:145], v[88:89], 0 cbsz:4 abid:7
    s_nop 0
    v_mfma_f32_4x4x4_16b_bf16 v[100:103], v[144:145], v[90:91], 0 cbsz:4 abid:7
    v_lshlrev_b32_sdwa v139, v15, v127 dst_sel:DWORD dst_unused:UNUSED_PAD src0_sel:DWORD src1_sel:WORD_1
    ds_read_u16_d16_hi v134, v138 offset:32768
    ds_read_u16_d16_hi v135, v139 offset:32768
    s_set_gpr_idx_on s61, 0xc
    v_pk_fma_f32 v[16:17], v[128:129], v[104:105], v[16:17] op_sel:[1,0,0] op_sel_hi:[1,1,1]
    v_pk_fma_f32 v[18:19], v[128:129], v[106:107], v[18:19] op_sel:[1,0,0] op_sel_hi:[1,1,1]
    v_pk_fma_f32 v[20:21], v[130:131], v[108:109], v[20:21] op_sel:[1,0,0] op_sel_hi:[1,1,1]
    v_pk_fma_f32 v[22:23], v[130:131], v[110:111], v[22:23] op_sel:[1,0,0] op_sel_hi:[1,1,1]
    s_set_gpr_idx_off
    v_mfma_f32_4x4x4_16b_bf16 v[120:123], v[172:173], v[176:177], 0 cbsz:4 abid:9
    v_lshlrev_b32_sdwa v136, v15, v112 dst_sel:DWORD dst_unused:UNUSED_PAD src0_sel:DWORD src1_sel:WORD_1
    s_waitcnt vmcnt(10)
    v_mfma_f32_4x4x4_16b_bf16 v[104:107], v[146:147], v[92:93], 0 cbsz:4 abid:7
    s_nop 0
    v_mfma_f32_4x4x4_16b_bf16 v[108:111], v[146:147], v[94:95], 0 cbsz:4 abid:7
    v_lshlrev_b32_sdwa v137, v15, v113 dst_sel:DWORD dst_unused:UNUSED_PAD src0_sel:DWORD src1_sel:WORD_1
    ds_read_u16_d16_hi v128, v136 offset:32768
    ds_read_u16_d16_hi v129, v137 offset:32768
    s_waitcnt lgkmcnt(2)
    s_set_gpr_idx_on s62, 0xc
    v_pk_fma_f32 v[16:17], v[132:133], v[96:97], v[16:17] op_sel:[0,0,0] op_sel_hi:[0,1,1]
    v_pk_fma_f32 v[18:19], v[132:133], v[98:99], v[18:19] op_sel:[0,0,0] op_sel_hi:[0,1,1]
    v_pk_fma_f32 v[20:21], v[134:135], v[100:101], v[20:21] op_sel:[0,0,0] op_sel_hi:[0,1,1]
    v_pk_fma_f32 v[22:23], v[134:135], v[102:103], v[22:23] op_sel:[0,0,0] op_sel_hi:[0,1,1]
    s_set_gpr_idx_off
    v_lshlrev_b32_sdwa v138, v15, v116 dst_sel:DWORD dst_unused:UNUSED_PAD src0_sel:DWORD src1_sel:WORD_1
    s_waitcnt vmcnt(9)
    v_mfma_f32_4x4x4_16b_bf16 v[96:99], v[140:141], v[64:65], 0 cbsz:4 abid:8
    s_nop 0
    v_mfma_f32_4x4x4_16b_bf16 v[100:103], v[140:141], v[66:67], 0 cbsz:4 abid:8
    v_lshlrev_b32_sdwa v139, v15, v117 dst_sel:DWORD dst_unused:UNUSED_PAD src0_sel:DWORD src1_sel:WORD_1
    ds_read_u16_d16_hi v130, v138 offset:32768
    ds_read_u16_d16_hi v131, v139 offset:32768
    s_set_gpr_idx_on s63, 0xc
    v_pk_fma_f32 v[16:17], v[132:133], v[104:105], v[16:17] op_sel:[1,0,0] op_sel_hi:[1,1,1]
    v_pk_fma_f32 v[18:19], v[132:133], v[106:107], v[18:19] op_sel:[1,0,0] op_sel_hi:[1,1,1]
    v_pk_fma_f32 v[20:21], v[134:135], v[108:109], v[20:21] op_sel:[1,0,0] op_sel_hi:[1,1,1]
    v_pk_fma_f32 v[22:23], v[134:135], v[110:111], v[22:23] op_sel:[1,0,0] op_sel_hi:[1,1,1]
    s_set_gpr_idx_off
B_32:
    s_sub_u32 s32, s32, 4
    s_cbranch_scc1 MAIN_DONE
    v_mfma_f32_4x4x4_16b_bf16 v[124:127], v[172:173], v[178:179], 0 cbsz:4 abid:9
    v_lshlrev_b32_sdwa v136, v15, v114 dst_sel:DWORD dst_unused:UNUSED_PAD src0_sel:DWORD src1_sel:WORD_1
    s_waitcnt vmcnt(12)
    v_mfma_f32_4x4x4_16b_bf16 v[104:107], v[142:143], v[68:69], 0 cbsz:4 abid:8
    s_nop 0
    v_mfma_f32_4x4x4_16b_bf16 v[108:111], v[142:143], v[70:71], 0 cbsz:4 abid:8
    v_lshlrev_b32_sdwa v137, v15, v115 dst_sel:DWORD dst_unused:UNUSED_PAD src0_sel:DWORD src1_sel:WORD_1
    ds_read_u16_d16_hi v132, v136 offset:32768
    ds_read_u16_d16_hi v133, v137 offset:32768
    s_waitcnt lgkmcnt(2)
    s_set_gpr_idx_on s48, 0xc
    v_pk_fma_f32 v[16:17], v[128:129], v[96:97], v[16:17] op_sel:[0,0,0] op_sel_hi:[0,1,1]
    v_pk_fma_f32 v[18:19], v[128:129], v[98:99], v[18:19] op_sel:[0,0,0] op_sel_hi:[0,1,1]
    v_pk_fma_f32 v[20:21], v[130:131], v[100:101], v[20:21] op_sel:[0,0,0] op_sel_hi:[0,1,1]
    v_pk_fma_f32 v[22:23], v[130:131], v[102:103], v[22:23] op_sel:[0,0,0] op_sel_hi:[0,1,1]
    s_set_gpr_idx_off
    v_lshlrev_b32_sdwa v138, v15, v118 dst_sel:DWORD dst_unused:UNUSED_PAD src0_sel:DWORD src1_sel:WORD_1
    s_waitcnt vmcnt(11)
    v_mfma_f32_4x4x4_16b_bf16 v[96:99], v[144:145], v[72:73], 0 cbsz:4 abid:8
    s_nop 0
    v_mfma_f32_4x4x4_16b_bf16 v[100:103], v[144:145], v[74:75], 0 cbsz:4 abid:8
    v_lshlrev_b32_sdwa v139, v15, v119 dst_sel:DWORD dst_unused:UNUSED_PAD src0_sel:DWORD src1_sel:WORD_1
    ds_read_u16_d16_hi v134, v138 offset:32768
    ds_read_u16_d16_hi v135, v139 offset:32768
    s_set_gpr_idx_on s49, 0xc
    v_pk_fma_f32 v[16:17], v[128:129], v[104:105], v[16:17] op_sel:[1,0,0] op_sel_hi:[1,1,1]
    v_pk_fma_f32 v[18:19], v[128:129], v[106:107], v[18:19] op_sel:[1,0,0] op_sel_hi:[1,1,1]
    v_pk_fma_f32 v[20:21], v[130:131], v[108:109], v[20:21] op_sel:[1,0,0] op_sel_hi:[1,1,1]
    v_pk_fma_f32 v[22:23], v[130:131], v[110:111], v[22:23] op_sel:[1,0,0] op_sel_hi:[1,1,1]
    s_set_gpr_idx_off
    v_mfma_f32_4x4x4_16b_bf16 v[112:115], v[172:173], v[176:177], 0 cbsz:4 abid:10
    v_lshlrev_b32_sdwa v136, v15, v120 dst_sel:DWORD dst_unused:UNUSED_PAD src0_sel:DWORD src1_sel:WORD_1
    s_waitcnt vmcnt(10)
    v_mfma_f32_4x4x4_16b_bf16 v[104:107], v[146:147], v[76:77], 0 cbsz:4 abid:8
    s_nop 0
    v_mfma_f32_4x4x4_16b_bf16 v[108:111], v[146:147], v[78:79], 0 cbsz:4 abid:8
    v_lshlrev_b32_sdwa v137, v15, v121 dst_sel:DWORD dst_unused:UNUSED_PAD src0_sel:DWORD src1_sel:WORD_1
    ds_read_u16_d16_hi v128, v136 offset:32768
    ds_read_u16_d16_hi v129, v137 offset:32768
    s_waitcnt lgkmcnt(2)
    s_set_gpr_idx_on s50, 0xc
    v_pk_fma_f32 v[16:17], v[132:133], v[96:97], v[16:17] op_sel:[0,0,0] op_sel_hi:[0,1,1]
    v_pk_fma_f32 v[18:19], v[132:133], v[98:99], v[18:19] op_sel:[0,0,0] op_sel_hi:[0,1,1]
    v_pk_fma_f32 v[20:21], v[134:135], v[100:101], v[20:21] op_sel:[0,0,0] op_sel_hi:[0,1,1]
    v_pk_fma_f32 v[22:23], v[134:135], v[102:103], v[22:23] op_sel:[0,0,0] op_sel_hi:[0,1,1]
    s_set_gpr_idx_off
    v_lshlrev_b32_sdwa v138, v15, v124 dst_sel:DWORD dst_unused:UNUSED_PAD src0_sel:DWORD src1_sel:WORD_1
    s_waitcnt vmcnt(9)
    v_mfma_f32_4x4x4_16b_bf16 v[96:99], v[140:141], v[80:81], 0 cbsz:4 abid:9
    s_nop 0
    v_mfma_f32_4x4x4_16b_bf16 v[100:103], v[140:141], v[82:83], 0 cbsz:4 abid:9
    v_lshlrev_b32_sdwa v139, v15, v125 dst_sel:DWORD dst_unused:UNUSED_PAD src0_sel:DWORD src1_sel:WORD_1
    ds_read_u16_d16_hi v130, v138 offset:32768
    ds_read_u16_d16_hi v131, v139 offset:32768
    s_set_gpr_idx_on s51, 0xc
    v_pk_fma_f32 v[16:17], v[132:133], v[104:105], v[16:17] op_sel:[1,0,0] op_sel_hi:[1,1,1]
    v_pk_fma_f32 v[18:19], v[132:133], v[106:107], v[18:19] op_sel:[1,0,0] op_sel_hi:[1,1,1]
    v_pk_fma_f32 v[20:21], v[134:135], v[108:109], v[20:21] op_sel:[1,0,0] op_sel_hi:[1,1,1]
    v_pk_fma_f32 v[22:23], v[134:135], v[110:111], v[22:23] op_sel:[1,0,0] op_sel_hi:[1,1,1]
    s_set_gpr_idx_off
B_36:
    s_sub_u32 s32, s32, 4
    s_cbranch_scc1 MAIN_DONE
    v_mfma_f32_4x4x4_16b_bf16 v[116:119], v[172:173], v[178:179], 0 cbsz:4 abid:10
    v_lshlrev_b32_sdwa v136, v15, v122 dst_sel:DWORD dst_unused:UNUSED_PAD src0_sel:DWORD src1_sel:WORD_1
    s_waitcnt vmcnt(12)
    v_mfma_f32_4x4x4_16b_bf16 v[104:107], v[142:143], v[84:85], 0 cbsz:4 abid:9
    s_nop 0
    v_mfma_f32_4x4x4_16b_bf16 v[108:111], v[142:143], v[86:87], 0 cbsz:4 abid:9
    v_lshlrev_b32_sdwa v137, v15, v123 dst_sel:DWORD dst_unused:UNUSED_PAD src0_sel:DWORD src1_sel:WORD_1
    ds_read_u16_d16_hi v132, v136 offset:32768
    ds_read_u16_d16_hi v133, v137 offset:32768
    s_waitcnt lgkmcnt(2)
    s_set_gpr_idx_on s52, 0xc
    v_pk_fma_f32 v[16:17], v[128:129], v[96:97], v[16:17] op_sel:[0,0,0] op_sel_hi:[0,1,1]
    v_pk_fma_f32 v[18:19], v[128:129], v[98:99], v[18:19] op_sel:[0,0,0] op_sel_hi:[0,1,1]
    v_pk_fma_f32 v[20:21], v[130:131], v[100:101], v[20:21] op_sel:[0,0,0] op_sel_hi:[0,1,1]
    v_pk_fma_f32 v[22:23], v[130:131], v[102:103], v[22:23] op_sel:[0,0,0] op_sel_hi:[0,1,1]
    s_set_gpr_idx_off
    v_lshlrev_b32_sdwa v138, v15, v126 dst_sel:DWORD dst_unused:UNUSED_PAD src0_sel:DWORD src1_sel:WORD_1
    s_waitcnt vmcnt(11)
    v_mfma_f32_4x4x4_16b_bf16 v[96:99], v[144:145], v[88:89], 0 cbsz:4 abid:9
    s_nop 0
    v_mfma_f32_4x4x4_16b_bf16 v[100:103], v[144:145], v[90:91], 0 cbsz:4 abid:9
    v_lshlrev_b32_sdwa v139, v15, v127 dst_sel:DWORD dst_unused:UNUSED_PAD src0_sel:DWORD src1_sel:WORD_1
    ds_read_u16_d16_hi v134, v138 offset:32768
    ds_read_u16_d16_hi v135, v139 offset:32768
    s_set_gpr_idx_on s53, 0xc
    v_pk_fma_f32 v[16:17], v[128:129], v[104:105], v[16:17] op_sel:[1,0,0] op_sel_hi:[1,1,1]
    v_pk_fma_f32 v[18:19], v[128:129], v[106:107], v[18:19] op_sel:[1,0,0] op_sel_hi:[1,1,1]
    v_pk_fma_f32 v[20:21], v[130:131], v[108:109], v[20:21] op_sel:[1,0,0] op_sel_hi:[1,1,1]
    v_pk_fma_f32 v[22:23], v[130:131], v[110:111], v[22:23] op_sel:[1,0,0] op_sel_hi:[1,1,1]
    s_set_gpr_idx_off
    v_mfma_f32_4x4x4_16b_bf16 v[120:123], v[172:173], v[176:177], 0 cbsz:4 abid:11
    v_lshlrev_b32_sdwa v136, v15, v112 dst_sel:DWORD dst_unused:UNUSED_PAD src0_sel:DWORD src1_sel:WORD_1
    s_waitcnt vmcnt(10)
    v_mfma_f32_4x4x4_16b_bf16 v[104:107], v[146:147], v[92:93], 0 cbsz:4 abid:9
    s_nop 0
    v_mfma_f32_4x4x4_16b_bf16 v[108:111], v[146:147], v[94:95], 0 cbsz:4 abid:9
    v_lshlrev_b32_sdwa v137, v15, v113 dst_sel:DWORD dst_unused:UNUSED_PAD src0_sel:DWORD src1_sel:WORD_1
    ds_read_u16_d16_hi v128, v136 offset:32768
    ds_read_u16_d16_hi v129, v137 offset:32768
    s_waitcnt lgkmcnt(2)
    s_set_gpr_idx_on s54, 0xc
    v_pk_fma_f32 v[16:17], v[132:133], v[96:97], v[16:17] op_sel:[0,0,0] op_sel_hi:[0,1,1]
    v_pk_fma_f32 v[18:19], v[132:133], v[98:99], v[18:19] op_sel:[0,0,0] op_sel_hi:[0,1,1]
    v_pk_fma_f32 v[20:21], v[134:135], v[100:101], v[20:21] op_sel:[0,0,0] op_sel_hi:[0,1,1]
    v_pk_fma_f32 v[22:23], v[134:135], v[102:103], v[22:23] op_sel:[0,0,0] op_sel_hi:[0,1,1]
    s_set_gpr_idx_off
    v_lshlrev_b32_sdwa v138, v15, v116 dst_sel:DWORD dst_unused:UNUSED_PAD src0_sel:DWORD src1_sel:WORD_1
    s_waitcnt vmcnt(9)
    v_mfma_f32_4x4x4_16b_bf16 v[96:99], v[140:141], v[64:65], 0 cbsz:4 abid:10
    s_nop 0
    v_mfma_f32_4x4x4_16b_bf16 v[100:103], v[140:141], v[66:67], 0 cbsz:4 abid:10
    v_lshlrev_b32_sdwa v139, v15, v117 dst_sel:DWORD dst_unused:UNUSED_PAD src0_sel:DWORD src1_sel:WORD_1
    ds_read_u16_d16_hi v130, v138 offset:32768
    ds_read_u16_d16_hi v131, v139 offset:32768
    s_set_gpr_idx_on s55, 0xc
    v_pk_fma_f32 v[16:17], v[132:133], v[104:105], v[16:17] op_sel:[1,0,0] op_sel_hi:[1,1,1]
    v_pk_fma_f32 v[18:19], v[132:133], v[106:107], v[18:19] op_sel:[1,0,0] op_sel_hi:[1,1,1]
    v_pk_fma_f32 v[20:21], v[134:135], v[108:109], v[20:21] op_sel:[1,0,0] op_sel_hi:[1,1,1]
    v_pk_fma_f32 v[22:23], v[134:135], v[110:111], v[22:23] op_sel:[1,0,0] op_sel_hi:[1,1,1]
    s_set_gpr_idx_off
B_40:
    s_sub_u32 s32, s32, 4
    s_cbranch_scc1 MAIN_DONE
    v_mfma_f32_4x4x4_16b_bf16 v[124:127], v[172:173], v[178:179], 0 cbsz:4 abid:11
    v_lshlrev_b32_sdwa v136, v15, v114 dst_sel:DWORD dst_unused:UNUSED_PAD src0_sel:DWORD src1_sel:WORD_1
    s_waitcnt vmcnt(12)
    v_mfma_f32_4x4x4_16b_bf16 v[104:107], v[142:143], v[68:69], 0 cbsz:4 abid:10
    s_nop 0
    v_mfma_f32_4x4x4_16b_bf16 v[108:111], v[142:143], v[70:71], 0 cbsz:4 abid:10
    v_lshlrev_b32_sdwa v137, v15, v115 dst_sel:DWORD dst_unused:UNUSED_PAD src0_sel:DWORD src1_sel:WORD_1
    ds_read_u16_d16_hi v132, v136 offset:32768
    ds_read_u16_d16_hi v133, v137 offset:32768
    s_waitcnt lgkmcnt(2)
    s_set_gpr_idx_on s56, 0xc
    v_pk_fma_f32 v[16:17], v[128:129], v[96:97], v[16:17] op_sel:[0,0,0] op_sel_hi:[0,1,1]
    v_pk_fma_f32 v[18:19], v[128:129], v[98:99], v[18:19] op_sel:[0,0,0] op_sel_hi:[0,1,1]
    v_pk_fma_f32 v[20:21], v[130:131], v[100:101], v[20:21] op_sel:[0,0,0] op_sel_hi:[0,1,1]
    v_pk_fma_f32 v[22:23], v[130:131], v[102:103], v[22:23] op_sel:[0,0,0] op_sel_hi:[0,1,1]
    s_set_gpr_idx_off
    v_mfma_f32_4x4x4_16b_bf16 v[148:151], v[168:169], v[180:181], 0
    v_lshlrev_b32_sdwa v138, v15, v118 dst_sel:DWORD dst_unused:UNUSED_PAD src0_sel:DWORD src1_sel:WORD_1
    s_waitcnt vmcnt(11)
    v_mfma_f32_4x4x4_16b_bf16 v[96:99], v[144:145], v[72:73], 0 cbsz:4 abid:10
    s_nop 0
    v_mfma_f32_4x4x4_16b_bf16 v[100:103], v[144:145], v[74:75], 0 cbsz:4 abid:10
    v_lshlrev_b32_sdwa v139, v15, v119 dst_sel:DWORD dst_unused:UNUSED_PAD src0_sel:DWORD src1_sel:WORD_1
    ds_read_u16_d16_hi v134, v138 offset:32768
    ds_read_u16_d16_hi v135, v139 offset:32768
    s_set_gpr_idx_on s57, 0xc
    v_pk_fma_f32 v[16:17], v[128:129], v[104:105], v[16:17] op_sel:[1,0,0] op_sel_hi:[1,1,1]
    v_pk_fma_f32 v[18:19], v[128:129], v[106:107], v[18:19] op_sel:[1,0,0] op_sel_hi:[1,1,1]
    v_pk_fma_f32 v[20:21], v[130:131], v[108:109], v[20:21] op_sel:[1,0,0] op_sel_hi:[1,1,1]
    v_pk_fma_f32 v[22:23], v[130:131], v[110:111], v[22:23] op_sel:[1,0,0] op_sel_hi:[1,1,1]
    s_set_gpr_idx_off
    v_mfma_f32_4x4x4_16b_bf16 v[112:115], v[172:173], v[176:177], 0 cbsz:4 abid:12
    v_lshlrev_b32_sdwa v136, v15, v120 dst_sel:DWORD dst_unused:UNUSED_PAD src0_sel:DWORD src1_sel:WORD_1
    s_waitcnt vmcnt(10)
    v_mfma_f32_4x4x4_16b_bf16 v[104:107], v[146:147], v[76:77], 0 cbsz:4 abid:10
    s_nop 0
    v_mfma_f32_4x4x4_16b_bf16 v[108:111], v[146:147], v[78:79], 0 cbsz:4 abid:10
    v_lshlrev_b32_sdwa v137, v15, v121 dst_sel:DWORD dst_unused:UNUSED_PAD src0_sel:DWORD src1_sel:WORD_1
    ds_read_u16_d16_hi v128, v136 offset:32768
    ds_read_u16_d16_hi v129, v137 offset:32768
    s_waitcnt lgkmcnt(2)
    s_set_gpr_idx_on s58, 0xc
    v_pk_fma_f32 v[16:17], v[132:133], v[96:97], v[16:17] op_sel:[0,0,0] op_sel_hi:[0,1,1]
    v_pk_fma_f32 v[18:19], v[132:133], v[98:99], v[18:19] op_sel:[0,0,0] op_sel_hi:[0,1,1]
    v_pk_fma_f32 v[20:21], v[134:135], v[100:101], v[20:21] op_sel:[0,0,0] op_sel_hi:[0,1,1]
    v_pk_fma_f32 v[22:23], v[134:135], v[102:103], v[22:23] op_sel:[0,0,0] op_sel_hi:[0,1,1]
    s_set_gpr_idx_off
    v_mfma_f32_4x4x4_16b_bf16 v[152:155], v[168:169], v[182:183], 0
    v_lshlrev_b32_sdwa v138, v15, v124 dst_sel:DWORD dst_unused:UNUSED_PAD src0_sel:DWORD src1_sel:WORD_1
    s_waitcnt vmcnt(9)
    v_mfma_f32_4x4x4_16b_bf16 v[96:99], v[140:141], v[80:81], 0 cbsz:4 abid:11
    s_nop 0
    v_mfma_f32_4x4x4_16b_bf16 v[100:103], v[140:141], v[82:83], 0 cbsz:4 abid:11
    v_lshlrev_b32_sdwa v139, v15, v125 dst_sel:DWORD dst_unused:UNUSED_PAD src0_sel:DWORD src1_sel:WORD_1
    ds_read_u16_d16_hi v130, v138 offset:32768
    ds_read_u16_d16_hi v131, v139 offset:32768
    s_set_gpr_idx_on s59, 0xc
    v_pk_fma_f32 v[16:17], v[132:133], v[104:105], v[16:17] op_sel:[1,0,0] op_sel_hi:[1,1,1]
    v_pk_fma_f32 v[18:19], v[132:133], v[106:107], v[18:19] op_sel:[1,0,0] op_sel_hi:[1,1,1]
    v_pk_fma_f32 v[20:21], v[134:135], v[108:109], v[20:21] op_sel:[1,0,0] op_sel_hi:[1,1,1]
    v_pk_fma_f32 v[22:23], v[134:135], v[110:111], v[22:23] op_sel:[1,0,0] op_sel_hi:[1,1,1]
    s_set_gpr_idx_off
B_44:
    s_sub_u32 s32, s32, 4
    s_cbranch_scc1 MAIN_DONE
    v_mfma_f32_4x4x4_16b_bf16 v[116:119], v[172:173], v[178:179], 0 cbsz:4 abid:12
    v_lshlrev_b32_sdwa v136, v15, v122 dst_sel:DWORD dst_unused:UNUSED_PAD src0_sel:DWORD src1_sel:WORD_1
    s_waitcnt vmcnt(12)
    v_mfma_f32_4x4x4_16b_bf16 v[104:107], v[142:143], v[84:85], 0 cbsz:4 abid:11
    s_nop 0
    v_mfma_f32_4x4x4_16b_bf16 v[108:111], v[142:143], v[86:87], 0 cbsz:4 abid:11
    v_lshlrev_b32_sdwa v137, v15, v123 dst_sel:DWORD dst_unused:UNUSED_PAD src0_sel:DWORD src1_sel:WORD_1
    ds_read_u16_d16_hi v132, v136 offset:32768
    ds_read_u16_d16_hi v133, v137 offset:32768
    s_waitcnt lgkmcnt(2)
    s_set_gpr_idx_on s60, 0xc
    v_pk_fma_f32 v[16:17], v[128:129], v[96:97], v[16:17] op_sel:[0,0,0] op_sel_hi:[0,1,1]
    v_pk_fma_f32 v[18:19], v[128:129], v[98:99], v[18:19] op_sel:[0,0,0] op_sel_hi:[0,1,1]
    v_pk_fma_f32 v[20:21], v[130:131], v[100:101], v[20:21] op_sel:[0,0,0] op_sel_hi:[0,1,1]
    v_pk_fma_f32 v[22:23], v[130:131], v[102:103], v[22:23] op_sel:[0,0,0] op_sel_hi:[0,1,1]
    s_set_gpr_idx_off
    v_mfma_f32_4x4x4_16b_bf16 v[156:159], v[168:169], v[184:185], 0
    v_lshlrev_b32_sdwa v138, v15, v126 dst_sel:DWORD dst_unused:UNUSED_PAD src0_sel:DWORD src1_sel:WORD_1
    s_waitcnt vmcnt(11)
    v_mfma_f32_4x4x4_16b_bf16 v[96:99], v[144:145], v[88:89], 0 cbsz:4 abid:11
    s_nop 0
    v_mfma_f32_4x4x4_16b_bf16 v[100:103], v[144:145], v[90:91], 0 cbsz:4 abid:11
    v_lshlrev_b32_sdwa v139, v15, v127 dst_sel:DWORD dst_unused:UNUSED_PAD src0_sel:DWORD src1_sel:WORD_1
    ds_read_u16_d16_hi v134, v138 offset:32768
    ds_read_u16_d16_hi v135, v139 offset:32768
    s_set_gpr_idx_on s61, 0xc
    v_pk_fma_f32 v[16:17], v[128:129], v[104:105], v[16:17] op_sel:[1,0,0] op_sel_hi:[1,1,1]
    v_pk_fma_f32 v[18:19], v[128:129], v[106:107], v[18:19] op_sel:[1,0,0] op_sel_hi:[1,1,1]
    v_pk_fma_f32 v[20:21], v[130:131], v[108:109], v[20:21] op_sel:[1,0,0] op_sel_hi:[1,1,1]
    v_pk_fma_f32 v[22:23], v[130:131], v[110:111], v[22:23] op_sel:[1,0,0] op_sel_hi:[1,1,1]
    s_set_gpr_idx_off
    v_mfma_f32_4x4x4_16b_bf16 v[120:123], v[172:173], v[176:177], 0 cbsz:4 abid:13
    v_lshlrev_b32_sdwa v136, v15, v112 dst_sel:DWORD dst_unused:UNUSED_PAD src0_sel:DWORD src1_sel:WORD_1
    s_waitcnt vmcnt(10)
    v_mfma_f32_4x4x4_16b_bf16 v[104:107], v[146:147], v[92:93], 0 cbsz:4 abid:11
    s_nop 0
    v_mfma_f32_4x4x4_16b_bf16 v[108:111], v[146:147], v[94:95], 0 cbsz:4 abid:11
    v_lshlrev_b32_sdwa v137, v15, v113 dst_sel:DWORD dst_unused:UNUSED_PAD src0_sel:DWORD src1_sel:WORD_1
    ds_read_u16_d16_hi v128, v136 offset:32768
    ds_read_u16_d16_hi v129, v137 offset:32768
    s_waitcnt lgkmcnt(2)
    s_set_gpr_idx_on s62, 0xc
    v_pk_fma_f32 v[16:17], v[132:133], v[96:97], v[16:17] op_sel:[0,0,0] op_sel_hi:[0,1,1]
    v_pk_fma_f32 v[18:19], v[132:133], v[98:99], v[18:19] op_sel:[0,0,0] op_sel_hi:[0,1,1]
    v_pk_fma_f32 v[20:21], v[134:135], v[100:101], v[20:21] op_sel:[0,0,0] op_sel_hi:[0,1,1]
    v_pk_fma_f32 v[22:23], v[134:135], v[102:103], v[22:23] op_sel:[0,0,0] op_sel_hi:[0,1,1]
    s_set_gpr_idx_off
    v_mfma_f32_4x4x4_16b_bf16 v[160:163], v[168:169], v[186:187], 0
    v_lshlrev_b32_sdwa v138, v15, v116 dst_sel:DWORD dst_unused:UNUSED_PAD src0_sel:DWORD src1_sel:WORD_1
    s_waitcnt vmcnt(9)
    v_mfma_f32_4x4x4_16b_bf16 v[96:99], v[140:141], v[64:65], 0 cbsz:4 abid:12
    s_nop 0
    v_mfma_f32_4x4x4_16b_bf16 v[100:103], v[140:141], v[66:67], 0 cbsz:4 abid:12
    v_lshlrev_b32_sdwa v139, v15, v117 dst_sel:DWORD dst_unused:UNUSED_PAD src0_sel:DWORD src1_sel:WORD_1
    ds_read_u16_d16_hi v130, v138 offset:32768
    ds_read_u16_d16_hi v131, v139 offset:32768
    s_set_gpr_idx_on s63, 0xc
    v_pk_fma_f32 v[16:17], v[132:133], v[104:105], v[16:17] op_sel:[1,0,0] op_sel_hi:[1,1,1]
    v_pk_fma_f32 v[18:19], v[132:133], v[106:107], v[18:19] op_sel:[1,0,0] op_sel_hi:[1,1,1]
    v_pk_fma_f32 v[20:21], v[134:135], v[108:109], v[20:21] op_sel:[1,0,0] op_sel_hi:[1,1,1]
    v_pk_fma_f32 v[22:23], v[134:135], v[110:111], v[22:23] op_sel:[1,0,0] op_sel_hi:[1,1,1]
    s_set_gpr_idx_off
B_48:
    s_sub_u32 s32, s32, 4
    s_cbranch_scc1 MAIN_DONE
    v_mfma_f32_4x4x4_16b_bf16 v[124:127], v[172:173], v[178:179], 0 cbsz:4 abid:13
    v_lshlrev_b32_sdwa v136, v15, v114 dst_sel:DWORD dst_unused:UNUSED_PAD src0_sel:DWORD src1_sel:WORD_1
    s_waitcnt vmcnt(12)
    v_mfma_f32_4x4x4_16b_bf16 v[104:107], v[142:143], v[68:69], 0 cbsz:4 abid:12
    s_nop 0
    v_mfma_f32_4x4x4_16b_bf16 v[108:111], v[142:143], v[70:71], 0 cbsz:4 abid:12
    v_lshlrev_b32_sdwa v137, v15, v115 dst_sel:DWORD dst_unused:UNUSED_PAD src0_sel:DWORD src1_sel:WORD_1
    ds_read_u16_d16_hi v132, v136 offset:32768
    ds_read_u16_d16_hi v133, v137 offset:32768
    s_waitcnt lgkmcnt(2)
    s_set_gpr_idx_on s48, 0xc
    v_pk_fma_f32 v[16:17], v[128:129], v[96:97], v[16:17] op_sel:[0,0,0] op_sel_hi:[0,1,1]
    v_pk_fma_f32 v[18:19], v[128:129], v[98:99], v[18:19] op_sel:[0,0,0] op_sel_hi:[0,1,1]
    v_pk_fma_f32 v[20:21], v[130:131], v[100:101], v[20:21] op_sel:[0,0,0] op_sel_hi:[0,1,1]
    v_pk_fma_f32 v[22:23], v[130:131], v[102:103], v[22:23] op_sel:[0,0,0] op_sel_hi:[0,1,1]
    s_set_gpr_idx_off
    v_lshlrev_b32_sdwa v138, v15, v118 dst_sel:DWORD dst_unused:UNUSED_PAD src0_sel:DWORD src1_sel:WORD_1
    s_waitcnt vmcnt(11)
    v_mfma_f32_4x4x4_16b_bf16 v[96:99], v[144:145], v[72:73], 0 cbsz:4 abid:12
    s_nop 0
    v_mfma_f32_4x4x4_16b_bf16 v[100:103], v[144:145], v[74:75], 0 cbsz:4 abid:12
    v_lshlrev_b32_sdwa v139, v15, v119 dst_sel:DWORD dst_unused:UNUSED_PAD src0_sel:DWORD src1_sel:WORD_1
    ds_read_u16_d16_hi v134, v138 offset:32768
    ds_read_u16_d16_hi v135, v139 offset:32768
    s_set_gpr_idx_on s49, 0xc
    v_pk_fma_f32 v[16:17], v[128:129], v[104:105], v[16:17] op_sel:[1,0,0] op_sel_hi:[1,1,1]
    v_pk_fma_f32 v[18:19], v[128:129], v[106:107], v[18:19] op_sel:[1,0,0] op_sel_hi:[1,1,1]
    v_pk_fma_f32 v[20:21], v[130:131], v[108:109], v[20:21] op_sel:[1,0,0] op_sel_hi:[1,1,1]
    v_pk_fma_f32 v[22:23], v[130:131], v[110:111], v[22:23] op_sel:[1,0,0] op_sel_hi:[1,1,1]
    s_set_gpr_idx_off
    v_mfma_f32_4x4x4_16b_bf16 v[112:115], v[172:173], v[176:177], 0 cbsz:4 abid:14
    v_lshlrev_b32_sdwa v136, v15, v120 dst_sel:DWORD dst_unused:UNUSED_PAD src0_sel:DWORD src1_sel:WORD_1
    s_waitcnt vmcnt(10)
    v_mfma_f32_4x4x4_16b_bf16 v[104:107], v[146:147], v[76:77], 0 cbsz:4 abid:12
    s_nop 0
    v_mfma_f32_4x4x4_16b_bf16 v[108:111], v[146:147], v[78:79], 0 cbsz:4 abid:12
    v_lshlrev_b32_sdwa v137, v15, v121 dst_sel:DWORD dst_unused:UNUSED_PAD src0_sel:DWORD src1_sel:WORD_1
    ds_read_u16_d16_hi v128, v136 offset:32768
    ds_read_u16_d16_hi v129, v137 offset:32768
    s_waitcnt lgkmcnt(2)
    s_set_gpr_idx_on s50, 0xc
    v_pk_fma_f32 v[16:17], v[132:133], v[96:97], v[16:17] op_sel:[0,0,0] op_sel_hi:[0,1,1]
    v_pk_fma_f32 v[18:19], v[132:133], v[98:99], v[18:19] op_sel:[0,0,0] op_sel_hi:[0,1,1]
    v_pk_fma_f32 v[20:21], v[134:135], v[100:101], v[20:21] op_sel:[0,0,0] op_sel_hi:[0,1,1]
    v_pk_fma_f32 v[22:23], v[134:135], v[102:103], v[22:23] op_sel:[0,0,0] op_sel_hi:[0,1,1]
    s_set_gpr_idx_off
    v_lshlrev_b32_sdwa v138, v15, v124 dst_sel:DWORD dst_unused:UNUSED_PAD src0_sel:DWORD src1_sel:WORD_1
    s_waitcnt vmcnt(9)
    v_mfma_f32_4x4x4_16b_bf16 v[96:99], v[140:141], v[80:81], 0 cbsz:4 abid:13
    s_nop 0
    v_mfma_f32_4x4x4_16b_bf16 v[100:103], v[140:141], v[82:83], 0 cbsz:4 abid:13
    v_lshlrev_b32_sdwa v139, v15, v125 dst_sel:DWORD dst_unused:UNUSED_PAD src0_sel:DWORD src1_sel:WORD_1
    ds_read_u16_d16_hi v130, v138 offset:32768
    ds_read_u16_d16_hi v131, v139 offset:32768
    s_set_gpr_idx_on s51, 0xc
    v_pk_fma_f32 v[16:17], v[132:133], v[104:105], v[16:17] op_sel:[1,0,0] op_sel_hi:[1,1,1]
    v_pk_fma_f32 v[18:19], v[132:133], v[106:107], v[18:19] op_sel:[1,0,0] op_sel_hi:[1,1,1]
    v_pk_fma_f32 v[20:21], v[134:135], v[108:109], v[20:21] op_sel:[1,0,0] op_sel_hi:[1,1,1]
    v_pk_fma_f32 v[22:23], v[134:135], v[110:111], v[22:23] op_sel:[1,0,0] op_sel_hi:[1,1,1]
    s_set_gpr_idx_off
B_52:
    s_sub_u32 s32, s32, 4
    s_cbranch_scc1 MAIN_DONE
    v_mfma_f32_4x4x4_16b_bf16 v[116:119], v[172:173], v[178:179], 0 cbsz:4 abid:14
    v_lshlrev_b32_sdwa v136, v15, v122 dst_sel:DWORD dst_unused:UNUSED_PAD src0_sel:DWORD src1_sel:WORD_1
    s_waitcnt vmcnt(12)
    v_mfma_f32_4x4x4_16b_bf16 v[104:107], v[142:143], v[84:85], 0 cbsz:4 abid:13
    s_nop 0
    v_mfma_f32_4x4x4_16b_bf16 v[108:111], v[142:143], v[86:87], 0 cbsz:4 abid:13
    v_lshlrev_b32_sdwa v137, v15, v123 dst_sel:DWORD dst_unused:UNUSED_PAD src0_sel:DWORD src1_sel:WORD_1
    ds_read_u16_d16_hi v132, v136 offset:32768
    ds_read_u16_d16_hi v133, v137 offset:32768
    s_waitcnt lgkmcnt(2)
    s_set_gpr_idx_on s52, 0xc
    v_pk_fma_f32 v[16:17], v[128:129], v[96:97], v[16:17] op_sel:[0,0,0] op_sel_hi:[0,1,1]
    v_pk_fma_f32 v[18:19], v[128:129], v[98:99], v[18:19] op_sel:[0,0,0] op_sel_hi:[0,1,1]
    v_pk_fma_f32 v[20:21], v[130:131], v[100:101], v[20:21] op_sel:[0,0,0] op_sel_hi:[0,1,1]
    v_pk_fma_f32 v[22:23], v[130:131], v[102:103], v[22:23] op_sel:[0,0,0] op_sel_hi:[0,1,1]
    s_set_gpr_idx_off
    v_lshlrev_b32_sdwa v138, v15, v126 dst_sel:DWORD dst_unused:UNUSED_PAD src0_sel:DWORD src1_sel:WORD_1
    s_waitcnt vmcnt(11)
    v_mfma_f32_4x4x4_16b_bf16 v[96:99], v[144:145], v[88:89], 0 cbsz:4 abid:13
    s_nop 0
    v_mfma_f32_4x4x4_16b_bf16 v[100:103], v[144:145], v[90:91], 0 cbsz:4 abid:13
    v_lshlrev_b32_sdwa v139, v15, v127 dst_sel:DWORD dst_unused:UNUSED_PAD src0_sel:DWORD src1_sel:WORD_1
    ds_read_u16_d16_hi v134, v138 offset:32768
    ds_read_u16_d16_hi v135, v139 offset:32768
    s_set_gpr_idx_on s53, 0xc
    v_pk_fma_f32 v[16:17], v[128:129], v[104:105], v[16:17] op_sel:[1,0,0] op_sel_hi:[1,1,1]
    v_pk_fma_f32 v[18:19], v[128:129], v[106:107], v[18:19] op_sel:[1,0,0] op_sel_hi:[1,1,1]
    v_pk_fma_f32 v[20:21], v[130:131], v[108:109], v[20:21] op_sel:[1,0,0] op_sel_hi:[1,1,1]
    v_pk_fma_f32 v[22:23], v[130:131], v[110:111], v[22:23] op_sel:[1,0,0] op_sel_hi:[1,1,1]
    s_set_gpr_idx_off
    v_mfma_f32_4x4x4_16b_bf16 v[120:123], v[172:173], v[176:177], 0 cbsz:4 abid:15
    v_lshlrev_b32_sdwa v136, v15, v112 dst_sel:DWORD dst_unused:UNUSED_PAD src0_sel:DWORD src1_sel:WORD_1
    s_waitcnt vmcnt(10)
    v_mfma_f32_4x4x4_16b_bf16 v[104:107], v[146:147], v[92:93], 0 cbsz:4 abid:13
    s_nop 0
    v_mfma_f32_4x4x4_16b_bf16 v[108:111], v[146:147], v[94:95], 0 cbsz:4 abid:13
    v_lshlrev_b32_sdwa v137, v15, v113 dst_sel:DWORD dst_unused:UNUSED_PAD src0_sel:DWORD src1_sel:WORD_1
    ds_read_u16_d16_hi v128, v136 offset:32768
    ds_read_u16_d16_hi v129, v137 offset:32768
    s_waitcnt lgkmcnt(2)
    s_set_gpr_idx_on s54, 0xc
    v_pk_fma_f32 v[16:17], v[132:133], v[96:97], v[16:17] op_sel:[0,0,0] op_sel_hi:[0,1,1]
    v_pk_fma_f32 v[18:19], v[132:133], v[98:99], v[18:19] op_sel:[0,0,0] op_sel_hi:[0,1,1]
    v_pk_fma_f32 v[20:21], v[134:135], v[100:101], v[20:21] op_sel:[0,0,0] op_sel_hi:[0,1,1]
    v_pk_fma_f32 v[22:23], v[134:135], v[102:103], v[22:23] op_sel:[0,0,0] op_sel_hi:[0,1,1]
    s_set_gpr_idx_off
    v_lshlrev_b32_sdwa v138, v15, v116 dst_sel:DWORD dst_unused:UNUSED_PAD src0_sel:DWORD src1_sel:WORD_1
    s_waitcnt vmcnt(9)
    v_mfma_f32_4x4x4_16b_bf16 v[96:99], v[140:141], v[64:65], 0 cbsz:4 abid:14
    s_nop 0
    v_mfma_f32_4x4x4_16b_bf16 v[100:103], v[140:141], v[66:67], 0 cbsz:4 abid:14
    v_lshlrev_b32_sdwa v139, v15, v117 dst_sel:DWORD dst_unused:UNUSED_PAD src0_sel:DWORD src1_sel:WORD_1
    ds_read_u16_d16_hi v130, v138 offset:32768
    ds_read_u16_d16_hi v131, v139 offset:32768
    s_set_gpr_idx_on s55, 0xc
    v_pk_fma_f32 v[16:17], v[132:133], v[104:105], v[16:17] op_sel:[1,0,0] op_sel_hi:[1,1,1]
    v_pk_fma_f32 v[18:19], v[132:133], v[106:107], v[18:19] op_sel:[1,0,0] op_sel_hi:[1,1,1]
    v_pk_fma_f32 v[20:21], v[134:135], v[108:109], v[20:21] op_sel:[1,0,0] op_sel_hi:[1,1,1]
    v_pk_fma_f32 v[22:23], v[134:135], v[110:111], v[22:23] op_sel:[1,0,0] op_sel_hi:[1,1,1]
    s_set_gpr_idx_off
B_56:
    s_sub_u32 s32, s32, 4
    s_cbranch_scc1 MAIN_DONE
    v_mfma_f32_4x4x4_16b_bf16 v[124:127], v[172:173], v[178:179], 0 cbsz:4 abid:15
    v_lshlrev_b32_sdwa v136, v15, v114 dst_sel:DWORD dst_unused:UNUSED_PAD src0_sel:DWORD src1_sel:WORD_1
    s_waitcnt vmcnt(12)
    v_mfma_f32_4x4x4_16b_bf16 v[104:107], v[142:143], v[68:69], 0 cbsz:4 abid:14
    s_nop 0
    v_mfma_f32_4x4x4_16b_bf16 v[108:111], v[142:143], v[70:71], 0 cbsz:4 abid:14
    v_lshlrev_b32_sdwa v137, v15, v115 dst_sel:DWORD dst_unused:UNUSED_PAD src0_sel:DWORD src1_sel:WORD_1
    ds_read_u16_d16_hi v132, v136 offset:32768
    ds_read_u16_d16_hi v133, v137 offset:32768
    s_waitcnt lgkmcnt(2)
    s_set_gpr_idx_on s56, 0xc
    v_pk_fma_f32 v[16:17], v[128:129], v[96:97], v[16:17] op_sel:[0,0,0] op_sel_hi:[0,1,1]
    v_pk_fma_f32 v[18:19], v[128:129], v[98:99], v[18:19] op_sel:[0,0,0] op_sel_hi:[0,1,1]
    v_pk_fma_f32 v[20:21], v[130:131], v[100:101], v[20:21] op_sel:[0,0,0] op_sel_hi:[0,1,1]
    v_pk_fma_f32 v[22:23], v[130:131], v[102:103], v[22:23] op_sel:[0,0,0] op_sel_hi:[0,1,1]
    s_set_gpr_idx_off
    v_lshlrev_b32_sdwa v138, v15, v118 dst_sel:DWORD dst_unused:UNUSED_PAD src0_sel:DWORD src1_sel:WORD_1
    s_waitcnt vmcnt(11)
    v_mfma_f32_4x4x4_16b_bf16 v[96:99], v[144:145], v[72:73], 0 cbsz:4 abid:14
    s_nop 0
    v_mfma_f32_4x4x4_16b_bf16 v[100:103], v[144:145], v[74:75], 0 cbsz:4 abid:14
    v_lshlrev_b32_sdwa v139, v15, v119 dst_sel:DWORD dst_unused:UNUSED_PAD src0_sel:DWORD src1_sel:WORD_1
    ds_read_u16_d16_hi v134, v138 offset:32768
    ds_read_u16_d16_hi v135, v139 offset:32768
    s_set_gpr_idx_on s57, 0xc
    v_pk_fma_f32 v[16:17], v[128:129], v[104:105], v[16:17] op_sel:[1,0,0] op_sel_hi:[1,1,1]
    v_pk_fma_f32 v[18:19], v[128:129], v[106:107], v[18:19] op_sel:[1,0,0] op_sel_hi:[1,1,1]
    v_pk_fma_f32 v[20:21], v[130:131], v[108:109], v[20:21] op_sel:[1,0,0] op_sel_hi:[1,1,1]
    v_pk_fma_f32 v[22:23], v[130:131], v[110:111], v[22:23] op_sel:[1,0,0] op_sel_hi:[1,1,1]
    s_set_gpr_idx_off
    v_mov_b32 v172, v170
    v_mov_b32 v173, v171
    s_nop 1
    v_mfma_f32_4x4x4_16b_bf16 v[112:115], v[172:173], v[176:177], 0 cbsz:4 abid:0
    v_lshlrev_b32_sdwa v136, v15, v120 dst_sel:DWORD dst_unused:UNUSED_PAD src0_sel:DWORD src1_sel:WORD_1
    s_waitcnt vmcnt(10)
    v_mfma_f32_4x4x4_16b_bf16 v[104:107], v[146:147], v[76:77], 0 cbsz:4 abid:14
    s_nop 0
    v_mfma_f32_4x4x4_16b_bf16 v[108:111], v[146:147], v[78:79], 0 cbsz:4 abid:14
    v_lshlrev_b32_sdwa v137, v15, v121 dst_sel:DWORD dst_unused:UNUSED_PAD src0_sel:DWORD src1_sel:WORD_1
    ds_read_u16_d16_hi v128, v136 offset:32768
    ds_read_u16_d16_hi v129, v137 offset:32768
    s_waitcnt lgkmcnt(2)
    s_set_gpr_idx_on s58, 0xc
    v_pk_fma_f32 v[16:17], v[132:133], v[96:97], v[16:17] op_sel:[0,0,0] op_sel_hi:[0,1,1]
    v_pk_fma_f32 v[18:19], v[132:133], v[98:99], v[18:19] op_sel:[0,0,0] op_sel_hi:[0,1,1]
    v_pk_fma_f32 v[20:21], v[134:135], v[100:101], v[20:21] op_sel:[0,0,0] op_sel_hi:[0,1,1]
    v_pk_fma_f32 v[22:23], v[134:135], v[102:103], v[22:23] op_sel:[0,0,0] op_sel_hi:[0,1,1]
    s_set_gpr_idx_off
    v_lshlrev_b32_sdwa v138, v15, v124 dst_sel:DWORD dst_unused:UNUSED_PAD src0_sel:DWORD src1_sel:WORD_1
    s_waitcnt vmcnt(9)
    v_mfma_f32_4x4x4_16b_bf16 v[96:99], v[140:141], v[80:81], 0 cbsz:4 abid:15
    s_nop 0
    v_mfma_f32_4x4x4_16b_bf16 v[100:103], v[140:141], v[82:83], 0 cbsz:4 abid:15
    v_lshlrev_b32_sdwa v139, v15, v125 dst_sel:DWORD dst_unused:UNUSED_PAD src0_sel:DWORD src1_sel:WORD_1
    ds_read_u16_d16_hi v130, v138 offset:32768
    ds_read_u16_d16_hi v131, v139 offset:32768
    s_set_gpr_idx_on s59, 0xc
    v_pk_fma_f32 v[16:17], v[132:133], v[104:105], v[16:17] op_sel:[1,0,0] op_sel_hi:[1,1,1]
    v_pk_fma_f32 v[18:19], v[132:133], v[106:107], v[18:19] op_sel:[1,0,0] op_sel_hi:[1,1,1]
    v_pk_fma_f32 v[20:21], v[134:135], v[108:109], v[20:21] op_sel:[1,0,0] op_sel_hi:[1,1,1]
    v_pk_fma_f32 v[22:23], v[134:135], v[110:111], v[22:23] op_sel:[1,0,0] op_sel_hi:[1,1,1]
    s_set_gpr_idx_off
B_60:
    s_sub_u32 s32, s32, 4
    s_cbranch_scc1 MAIN_DONE
    v_mfma_f32_4x4x4_16b_bf16 v[116:119], v[172:173], v[178:179], 0 cbsz:4 abid:0
    v_lshlrev_b32_sdwa v136, v15, v122 dst_sel:DWORD dst_unused:UNUSED_PAD src0_sel:DWORD src1_sel:WORD_1
    s_waitcnt vmcnt(12)
    v_mfma_f32_4x4x4_16b_bf16 v[104:107], v[142:143], v[84:85], 0 cbsz:4 abid:15
    s_nop 0
    v_mfma_f32_4x4x4_16b_bf16 v[108:111], v[142:143], v[86:87], 0 cbsz:4 abid:15
    v_lshlrev_b32_sdwa v137, v15, v123 dst_sel:DWORD dst_unused:UNUSED_PAD src0_sel:DWORD src1_sel:WORD_1
    ds_read_u16_d16_hi v132, v136 offset:32768
    ds_read_u16_d16_hi v133, v137 offset:32768
    v_cvt_pk_bf16_f32 v140, v148, v152
    v_cvt_pk_bf16_f32 v141, v156, v160
    s_waitcnt lgkmcnt(2)
    s_set_gpr_idx_on s60, 0xc
    v_pk_fma_f32 v[16:17], v[128:129], v[96:97], v[16:17] op_sel:[0,0,0] op_sel_hi:[0,1,1]
    v_pk_fma_f32 v[18:19], v[128:129], v[98:99], v[18:19] op_sel:[0,0,0] op_sel_hi:[0,1,1]
    v_pk_fma_f32 v[20:21], v[130:131], v[100:101], v[20:21] op_sel:[0,0,0] op_sel_hi:[0,1,1]
    v_pk_fma_f32 v[22:23], v[130:131], v[102:103], v[22:23] op_sel:[0,0,0] op_sel_hi:[0,1,1]
    s_set_gpr_idx_off
    v_lshlrev_b32_sdwa v138, v15, v126 dst_sel:DWORD dst_unused:UNUSED_PAD src0_sel:DWORD src1_sel:WORD_1
    s_waitcnt vmcnt(11)
    v_mfma_f32_4x4x4_16b_bf16 v[96:99], v[144:145], v[88:89], 0 cbsz:4 abid:15
    s_nop 0
    v_mfma_f32_4x4x4_16b_bf16 v[100:103], v[144:145], v[90:91], 0 cbsz:4 abid:15
    v_lshlrev_b32_sdwa v139, v15, v127 dst_sel:DWORD dst_unused:UNUSED_PAD src0_sel:DWORD src1_sel:WORD_1
    ds_read_u16_d16_hi v134, v138 offset:32768
    ds_read_u16_d16_hi v135, v139 offset:32768
    v_cvt_pk_bf16_f32 v142, v149, v153
    v_cvt_pk_bf16_f32 v143, v157, v161
    s_set_gpr_idx_on s61, 0xc
    v_pk_fma_f32 v[16:17], v[128:129], v[104:105], v[16:17] op_sel:[1,0,0] op_sel_hi:[1,1,1]
    v_pk_fma_f32 v[18:19], v[128:129], v[106:107], v[18:19] op_sel:[1,0,0] op_sel_hi:[1,1,1]
    v_pk_fma_f32 v[20:21], v[130:131], v[108:109], v[20:21] op_sel:[1,0,0] op_sel_hi:[1,1,1]
    v_pk_fma_f32 v[22:23], v[130:131], v[110:111], v[22:23] op_sel:[1,0,0] op_sel_hi:[1,1,1]
    s_set_gpr_idx_off
    v_mfma_f32_4x4x4_16b_bf16 v[120:123], v[172:173], v[176:177], 0 cbsz:4 abid:1
    v_lshlrev_b32_sdwa v136, v15, v112 dst_sel:DWORD dst_unused:UNUSED_PAD src0_sel:DWORD src1_sel:WORD_1
    s_waitcnt vmcnt(10)
    v_mfma_f32_4x4x4_16b_bf16 v[104:107], v[146:147], v[92:93], 0 cbsz:4 abid:15
    s_nop 0
    v_mfma_f32_4x4x4_16b_bf16 v[108:111], v[146:147], v[94:95], 0 cbsz:4 abid:15
    v_lshlrev_b32_sdwa v137, v15, v113 dst_sel:DWORD dst_unused:UNUSED_PAD src0_sel:DWORD src1_sel:WORD_1
    ds_read_u16_d16_hi v128, v136 offset:32768
    ds_read_u16_d16_hi v129, v137 offset:32768
    v_cvt_pk_bf16_f32 v144, v150, v154
    v_cvt_pk_bf16_f32 v145, v158, v162
    s_waitcnt lgkmcnt(2)
    s_set_gpr_idx_on s62, 0xc
    v_pk_fma_f32 v[16:17], v[132:133], v[96:97], v[16:17] op_sel:[0,0,0] op_sel_hi:[0,1,1]
    v_pk_fma_f32 v[18:19], v[132:133], v[98:99], v[18:19] op_sel:[0,0,0] op_sel_hi:[0,1,1]
    v_pk_fma_f32 v[20:21], v[134:135], v[100:101], v[20:21] op_sel:[0,0,0] op_sel_hi:[0,1,1]
    v_pk_fma_f32 v[22:23], v[134:135], v[102:103], v[22:23] op_sel:[0,0,0] op_sel_hi:[0,1,1]
    s_set_gpr_idx_off
    v_lshlrev_b32_sdwa v138, v15, v116 dst_sel:DWORD dst_unused:UNUSED_PAD src0_sel:DWORD src1_sel:WORD_1
    s_waitcnt vmcnt(9)
    v_mfma_f32_4x4x4_16b_bf16 v[96:99], v[140:141], v[64:65], 0 cbsz:4 abid:0
    s_nop 0
    v_mfma_f32_4x4x4_16b_bf16 v[100:103], v[140:141], v[66:67], 0 cbsz:4 abid:0
    v_lshlrev_b32_sdwa v139, v15, v117 dst_sel:DWORD dst_unused:UNUSED_PAD src0_sel:DWORD src1_sel:WORD_1
    ds_read_u16_d16_hi v130, v138 offset:32768
    ds_read_u16_d16_hi v131, v139 offset:32768
    v_cvt_pk_bf16_f32 v146, v151, v155
    v_cvt_pk_bf16_f32 v147, v159, v163
    s_set_gpr_idx_on s63, 0xc
    v_pk_fma_f32 v[16:17], v[132:133], v[104:105], v[16:17] op_sel:[1,0,0] op_sel_hi:[1,1,1]
    v_pk_fma_f32 v[18:19], v[132:133], v[106:107], v[18:19] op_sel:[1,0,0] op_sel_hi:[1,1,1]
    v_pk_fma_f32 v[20:21], v[134:135], v[108:109], v[20:21] op_sel:[1,0,0] op_sel_hi:[1,1,1]
    v_pk_fma_f32 v[22:23], v[134:135], v[110:111], v[22:23] op_sel:[1,0,0] op_sel_hi:[1,1,1]
    s_set_gpr_idx_off
    v_mov_b32 v164, v165
    s_branch B_0
MAIN_DONE:
    s_waitcnt vmcnt(0) lgkmcnt(0)
    s_add_u32 s27, s27, 1472
    s_cmp_ge_u32 s27, s26
    s_cbranch_scc1 ALL_DONE
    v_lshlrev_b32 v11, 2, v0
    v_mov_b32 v12, 0
    v_cmp_gt_u32 vcc, 480, v0
    s_and_saveexec_b64 s[42:43], vcc
    ds_write_b32 v11, v12 offset:0
    s_mov_b64 exec, s[42:43]
    s_waitcnt lgkmcnt(0)
    s_barrier
    s_branch ROUND
ALL_DONE:
    v_cvt_pk_bf16_f32 v64, v16, v20
    v_cvt_pk_bf16_f32 v65, v17, v21
    v_cvt_pk_bf16_f32 v66, v18, v22
    v_cvt_pk_bf16_f32 v67, v19, v23
    v_cvt_pk_bf16_f32 v68, v24, v28
    v_cvt_pk_bf16_f32 v69, v25, v29
    v_cvt_pk_bf16_f32 v70, v26, v30
    v_cvt_pk_bf16_f32 v71, v27, v31
    v_cvt_pk_bf16_f32 v72, v32, v36
    v_cvt_pk_bf16_f32 v73, v33, v37
    v_cvt_pk_bf16_f32 v74, v34, v38
    v_cvt_pk_bf16_f32 v75, v35, v39
    v_cvt_pk_bf16_f32 v76, v40, v44
    v_cvt_pk_bf16_f32 v77, v41, v45
    v_cvt_pk_bf16_f32 v78, v42, v46
    v_cvt_pk_bf16_f32 v79, v43, v47
    v_cvt_pk_bf16_f32 v80, v48, v52
    v_cvt_pk_bf16_f32 v81, v49, v53
    v_cvt_pk_bf16_f32 v82, v50, v54
    v_cvt_pk_bf16_f32 v83, v51, v55
    v_lshrrev_b32 v8, 2, v1
    v_add_u32 v8, 32768, v8
    s_mul_i32 s42, s4, 1152
    v_add_u32 v96, s42, v8
    s_mul_i32 s42, s5, 1152
    v_add_u32 v97, s42, v8
    s_mul_i32 s42, s6, 1152
    v_add_u32 v98, s42, v8
    s_mul_i32 s42, s7, 1152
    v_add_u32 v99, s42, v8
    s_mul_i32 s42, s8, 1152
    v_add_u32 v100, s42, v8
    v_lshrrev_b32 v9, 4, v1
    v_and_b32 v10, 15, v9
    v_lshrrev_b32 v11, 4, v9
    s_lshr_b32 s42, s25, 2
    s_mul_i32 s43, s42, 23040
    s_add_u32 s43, s43, 32768
    v_mul_u32_u24 v8, 288, v10
    v_lshl_add_u32 v8, v11, 4, v8
    v_add_u32 v8, s43, v8
    s_mul_i32 s42, s42, 5242880
    s_lshl_b32 s43, s24, 10
    s_add_u32 s42, s42, s43
    s_and_b32 s43, s25, 3
    s_lshl_b32 s43, s43, 8
    s_add_u32 s42, s42, s43
    v_lshlrev_b32 v11, 18, v11
    v_lshl_add_u32 v11, v10, 4, v11
    v_add_u32 v11, s42, v11
    s_barrier
    ds_write_b32 v96, v64 offset:0
    ds_write_b32 v96, v65 offset:288
    ds_write_b32 v96, v66 offset:576
    ds_write_b32 v96, v67 offset:864
    ds_write_b32 v97, v68 offset:0
    ds_write_b32 v97, v69 offset:288
    ds_write_b32 v97, v70 offset:576
    ds_write_b32 v97, v71 offset:864
    ds_write_b32 v98, v72 offset:0
    ds_write_b32 v98, v73 offset:288
    ds_write_b32 v98, v74 offset:576
    ds_write_b32 v98, v75 offset:864
    ds_write_b32 v99, v76 offset:0
    ds_write_b32 v99, v77 offset:288
    ds_write_b32 v99, v78 offset:576
    ds_write_b32 v99, v79 offset:864
    ds_write_b32 v100, v80 offset:0
    ds_write_b32 v100, v81 offset:288
    ds_write_b32 v100, v82 offset:576
    ds_write_b32 v100, v83 offset:864
    s_waitcnt lgkmcnt(0)
    s_barrier
    ds_read_b128 v[64:67], v8 offset:0
    ds_read_b128 v[68:71], v8 offset:64
    ds_read_b128 v[72:75], v8 offset:128
    ds_read_b128 v[76:79], v8 offset:192
    ds_read_b128 v[80:83], v8 offset:4608
    ds_read_b128 v[84:87], v8 offset:4672
    ds_read_b128 v[88:91], v8 offset:4736
    ds_read_b128 v[92:95], v8 offset:4800
    s_waitcnt lgkmcnt(7)
    v_mfma_f32_16x16x32_bf16 v[16:19], v[64:67], v[188:191], 0
    v_mfma_f32_16x16x32_bf16 v[20:23], v[64:67], v[204:207], 0
    s_waitcnt lgkmcnt(6)
    v_mfma_f32_16x16x32_bf16 v[16:19], v[68:71], v[192:195], v[16:19]
    v_mfma_f32_16x16x32_bf16 v[20:23], v[68:71], v[208:211], v[20:23]
    s_waitcnt lgkmcnt(5)
    v_mfma_f32_16x16x32_bf16 v[16:19], v[72:75], v[196:199], v[16:19]
    v_mfma_f32_16x16x32_bf16 v[20:23], v[72:75], v[212:215], v[20:23]
    s_waitcnt lgkmcnt(4)
    v_mfma_f32_16x16x32_bf16 v[16:19], v[76:79], v[200:203], v[16:19]
    v_mfma_f32_16x16x32_bf16 v[20:23], v[76:79], v[216:219], v[20:23]
    ds_read_b128 v[64:67], v8 offset:9216
    ds_read_b128 v[68:71], v8 offset:9280
    ds_read_b128 v[72:75], v8 offset:9344
    ds_read_b128 v[76:79], v8 offset:9408
    s_waitcnt lgkmcnt(7)
    v_mfma_f32_16x16x32_bf16 v[24:27], v[80:83], v[188:191], 0
    v_mfma_f32_16x16x32_bf16 v[28:31], v[80:83], v[204:207], 0
    s_waitcnt lgkmcnt(6)
    v_mfma_f32_16x16x32_bf16 v[24:27], v[84:87], v[192:195], v[24:27]
    v_mfma_f32_16x16x32_bf16 v[28:31], v[84:87], v[208:211], v[28:31]
    s_waitcnt lgkmcnt(5)
    v_mfma_f32_16x16x32_bf16 v[24:27], v[88:91], v[196:199], v[24:27]
    v_mfma_f32_16x16x32_bf16 v[28:31], v[88:91], v[212:215], v[28:31]
    s_waitcnt lgkmcnt(4)
    v_mfma_f32_16x16x32_bf16 v[24:27], v[92:95], v[200:203], v[24:27]
    v_mfma_f32_16x16x32_bf16 v[28:31], v[92:95], v[216:219], v[28:31]
    v_cvt_pk_bf16_f32 v128, v16, v17
    v_cvt_pk_bf16_f32 v129, v18, v19
    v_cvt_pk_bf16_f32 v130, v20, v21
    v_cvt_pk_bf16_f32 v131, v22, v23
    buffer_store_dwordx4 v[128:131], v11, s[20:23], 0 offen sc0 sc1
    v_add_u32 v11, 1048576, v11
    ds_read_b128 v[80:83], v8 offset:13824
    ds_read_b128 v[84:87], v8 offset:13888
    ds_read_b128 v[88:91], v8 offset:13952
    ds_read_b128 v[92:95], v8 offset:14016
    s_waitcnt lgkmcnt(7)
    v_mfma_f32_16x16x32_bf16 v[32:35], v[64:67], v[188:191], 0
    v_mfma_f32_16x16x32_bf16 v[36:39], v[64:67], v[204:207], 0
    s_waitcnt lgkmcnt(6)
    v_mfma_f32_16x16x32_bf16 v[32:35], v[68:71], v[192:195], v[32:35]
    v_mfma_f32_16x16x32_bf16 v[36:39], v[68:71], v[208:211], v[36:39]
    s_waitcnt lgkmcnt(5)
    v_mfma_f32_16x16x32_bf16 v[32:35], v[72:75], v[196:199], v[32:35]
    v_mfma_f32_16x16x32_bf16 v[36:39], v[72:75], v[212:215], v[36:39]
    s_waitcnt lgkmcnt(4)
    v_mfma_f32_16x16x32_bf16 v[32:35], v[76:79], v[200:203], v[32:35]
    v_mfma_f32_16x16x32_bf16 v[36:39], v[76:79], v[216:219], v[36:39]
    v_cvt_pk_bf16_f32 v132, v24, v25
    v_cvt_pk_bf16_f32 v133, v26, v27
    v_cvt_pk_bf16_f32 v134, v28, v29
    v_cvt_pk_bf16_f32 v135, v30, v31
    buffer_store_dwordx4 v[132:135], v11, s[20:23], 0 offen sc0 sc1
    v_add_u32 v11, 1048576, v11
    ds_read_b128 v[64:67], v8 offset:18432
    ds_read_b128 v[68:71], v8 offset:18496
    ds_read_b128 v[72:75], v8 offset:18560
    ds_read_b128 v[76:79], v8 offset:18624
    s_waitcnt lgkmcnt(7)
    v_mfma_f32_16x16x32_bf16 v[40:43], v[80:83], v[188:191], 0
    v_mfma_f32_16x16x32_bf16 v[44:47], v[80:83], v[204:207], 0
    s_waitcnt lgkmcnt(6)
    v_mfma_f32_16x16x32_bf16 v[40:43], v[84:87], v[192:195], v[40:43]
    v_mfma_f32_16x16x32_bf16 v[44:47], v[84:87], v[208:211], v[44:47]
    s_waitcnt lgkmcnt(5)
    v_mfma_f32_16x16x32_bf16 v[40:43], v[88:91], v[196:199], v[40:43]
    v_mfma_f32_16x16x32_bf16 v[44:47], v[88:91], v[212:215], v[44:47]
    s_waitcnt lgkmcnt(4)
    v_mfma_f32_16x16x32_bf16 v[40:43], v[92:95], v[200:203], v[40:43]
    v_mfma_f32_16x16x32_bf16 v[44:47], v[92:95], v[216:219], v[44:47]
    v_cvt_pk_bf16_f32 v128, v32, v33
    v_cvt_pk_bf16_f32 v129, v34, v35
    v_cvt_pk_bf16_f32 v130, v36, v37
    v_cvt_pk_bf16_f32 v131, v38, v39
    buffer_store_dwordx4 v[128:131], v11, s[20:23], 0 offen sc0 sc1
    v_add_u32 v11, 1048576, v11
    s_waitcnt lgkmcnt(3)
    v_mfma_f32_16x16x32_bf16 v[48:51], v[64:67], v[188:191], 0
    v_mfma_f32_16x16x32_bf16 v[52:55], v[64:67], v[204:207], 0
    s_waitcnt lgkmcnt(2)
    v_mfma_f32_16x16x32_bf16 v[48:51], v[68:71], v[192:195], v[48:51]
    v_mfma_f32_16x16x32_bf16 v[52:55], v[68:71], v[208:211], v[52:55]
    s_waitcnt lgkmcnt(1)
    v_mfma_f32_16x16x32_bf16 v[48:51], v[72:75], v[196:199], v[48:51]
    v_mfma_f32_16x16x32_bf16 v[52:55], v[72:75], v[212:215], v[52:55]
    s_waitcnt lgkmcnt(0)
    v_mfma_f32_16x16x32_bf16 v[48:51], v[76:79], v[200:203], v[48:51]
    v_mfma_f32_16x16x32_bf16 v[52:55], v[76:79], v[216:219], v[52:55]
    v_cvt_pk_bf16_f32 v132, v40, v41
    v_cvt_pk_bf16_f32 v133, v42, v43
    v_cvt_pk_bf16_f32 v134, v44, v45
    v_cvt_pk_bf16_f32 v135, v46, v47
    buffer_store_dwordx4 v[132:135], v11, s[20:23], 0 offen sc0 sc1
    v_add_u32 v11, 1048576, v11
    s_nop 7
    v_cvt_pk_bf16_f32 v128, v48, v49
    v_cvt_pk_bf16_f32 v129, v50, v51
    v_cvt_pk_bf16_f32 v130, v52, v53
    v_cvt_pk_bf16_f32 v131, v54, v55
    buffer_store_dwordx4 v[128:131], v11, s[20:23], 0 offen sc0 sc1
END:
    s_endpgm
.section .rodata,"a"
.p2align 6
.amdhsa_kernel gather_scatter__tensor_product_equiv_tfn__graph_kernel
  .amdhsa_next_free_vgpr 220
  .amdhsa_next_free_sgpr 66
  .amdhsa_accum_offset 220
  .amdhsa_group_segment_fixed_size 0
  .amdhsa_kernarg_size 88
  .amdhsa_user_sgpr_count 2
  .amdhsa_user_sgpr_kernarg_segment_ptr 1
  .amdhsa_system_sgpr_workgroup_id_x 1
  .amdhsa_float_denorm_mode_32 3
.end_amdhsa_kernel
```

```asm
; @launch grid=(256,1,1) block=(512,1,1) lds=163840
.amdgcn_target "amdgcn-amd-amdhsa--gfx950"
.text
.globl gather_scatter__tensor_product_equiv_tfn__graph_kernel
.p2align 8
.type gather_scatter__tensor_product_equiv_tfn__graph_kernel,@function
gather_scatter__tensor_product_equiv_tfn__graph_kernel:
    s_cmp_ge_u32 s2, 256
    s_cbranch_scc1 END
    s_load_dwordx16 s[40:55], s[0:1], 0
    s_load_dwordx2 s[16:17], s[0:1], 80
    s_load_dwordx2 s[12:13], s[0:1], 0
    s_load_dwordx2 s[20:21], s[0:1], 64
    s_getpc_b64 s[6:7]
CODE_HERE:
    v_lshrrev_b32 v8, 6, v0
    s_lshr_b32 s5, s2, 3
    s_lshl_b32 s4, s5, 10
    v_readfirstlane_b32 s25, v8
    v_and_b32 v10, 7, v0
    v_lshl_add_u32 v10, v10, 7, s4
    v_min_u32 v10, END-CODE_HERE, v10
    s_cmp_lg_u32 s25, 7
    s_cbranch_scc1 NO_CODE_TOUCH
    global_load_dword v167, v10, s[6:7]
NO_CODE_TOUCH:
    s_mul_i32 s3, s2, 5120
    v_lshl_add_u32 v8, v0, 4, s3
    v_and_b32 v10, 63, v0
    v_lshlrev_b32 v1, 4, v10
    v_lshlrev_b32 v193, 2, v10
    s_cmp_ge_u32 s25, 5
    s_cselect_b32 s3, 250, s2
    s_cmp_ge_u32 s3, 250
    s_waitcnt lgkmcnt(0)
    s_cbranch_scc1 NO_EDGES
    s_setprio 1
    global_load_dwordx4 v[64:67], v8, s[44:45]
    global_load_dwordx4 v[68:71], v8, s[42:43]
NO_EDGES:
    global_load_dword v188, v193, s[50:51] offset:0
    global_load_dword v189, v193, s[50:51] offset:256
    global_load_dword v190, v193, s[50:51] offset:512
    global_load_dword v191, v193, s[50:51] offset:768
    v_and_b32 v193, 0x7f, v193
    global_load_dword v192, v193, s[52:53]
    s_and_b32 s3, s2, 0x87
    s_cmp_eq_u32 s3, 0
    s_cselect_b32 s3, 64, 0
    s_add_u32 s3, s3, DEAL_TABLE-CODE_HERE
    v_add_u32 v174, s3, v10
    global_load_ubyte v174, v174, s[6:7]
    v_lshlrev_b32 v9, 1, v8
    v_lshlrev_b32 v11, 3, v0
    v_mov_b32 v12, 0
    v_mov_b32 v13, 0
    ds_write_b64 v11, v[12:13]
    s_and_b32 s4, s2, 7
    s_lshl_b32 s4, s4, 5
    s_lshr_b32 s5, s2, 3
    s_or_b32 s24, s4, s5
    v_mov_b32 v15, 1
    s_mov_b32 s14, 10240000
    s_mov_b32 s15, 0x20000
    s_mov_b32 s18, 8650880
    s_mov_b32 s19, 0x20000
    s_mov_b32 s22, 10240000
    s_mov_b32 s23, 0x20000
    s_mov_b32 s34, 0xfffffc00
    s_mov_b32 s27, 0
    s_mov_b32 s10, 0xbfb8aa3b
    s_mov_b32 s11, 0xbfb8aa3b
    v_mul_u32_u24 v14, 52, v10
    v_lshrrev_b32 v14, 8, v14
    v_mul_u32_u24 v7, 5, v14
    v_sub_u32 v7, v10, v7
    v_lshlrev_b32 v14, 2, v14
    v_lshlrev_b32 v7, 2, v7
    s_mov_b32 s35, 2097152
    v_and_b32 v4, 0xff, v0
    s_lshl_b32 s3, s24, 3
    s_add_u32 s3, s3, 7864320
    v_lshl_add_u32 v6, v4, 11, s3
    s_and_b32 s3, s2, 7
    s_lshl_b32 s3, s3, 7
    s_add_u32 s3, s3, 8388608
    s_lshl_b32 s8, s25, 15
    s_add_u32 s3, s3, s8
    v_and_b32 v166, 31, v0
    v_lshl_add_u32 v166, v166, 10, s3
    v_mul_u32_u24 v4, 1280, v4
    v_mul_u32_u24 v138, 0x8000, v1
    v_lshl_add_u32 v138, v10, 3, v138
    v_pk_mov_b32 v[16:17], v[12:13], v[12:13]
    v_pk_mov_b32 v[18:19], v[12:13], v[12:13]
    v_pk_mov_b32 v[20:21], v[12:13], v[12:13]
    v_pk_mov_b32 v[22:23], v[12:13], v[12:13]
    v_pk_mov_b32 v[24:25], v[12:13], v[12:13]
    v_pk_mov_b32 v[26:27], v[12:13], v[12:13]
    v_pk_mov_b32 v[28:29], v[12:13], v[12:13]
    v_pk_mov_b32 v[30:31], v[12:13], v[12:13]
    v_pk_mov_b32 v[32:33], v[12:13], v[12:13]
    v_pk_mov_b32 v[34:35], v[12:13], v[12:13]
    v_pk_mov_b32 v[36:37], v[12:13], v[12:13]
    v_pk_mov_b32 v[38:39], v[12:13], v[12:13]
    v_pk_mov_b32 v[40:41], v[12:13], v[12:13]
    v_pk_mov_b32 v[42:43], v[12:13], v[12:13]
    v_pk_mov_b32 v[44:45], v[12:13], v[12:13]
    v_pk_mov_b32 v[46:47], v[12:13], v[12:13]
    v_pk_mov_b32 v[48:49], v[12:13], v[12:13]
    v_pk_mov_b32 v[50:51], v[12:13], v[12:13]
    v_pk_mov_b32 v[52:53], v[12:13], v[12:13]
    v_pk_mov_b32 v[54:55], v[12:13], v[12:13]
    v_pk_mov_b32 v[56:57], v[12:13], v[12:13]
    v_pk_mov_b32 v[58:59], v[12:13], v[12:13]
    v_pk_mov_b32 v[60:61], v[12:13], v[12:13]
    v_pk_mov_b32 v[62:63], v[12:13], v[12:13]
    s_waitcnt lgkmcnt(0)
    s_add_u32 s4, s16, 8650752
    s_addc_u32 s5, s17, 0
    s_load_dwordx2 s[64:65], s[4:5], 0
    s_barrier
    s_cmp_ge_u32 s25, 5
    s_cbranch_scc1 HELP
    s_add_u32 s62, s25, 1
LUTP_W0L:
    s_mul_i32 s3, s62, 33554944
    s_add_u32 s3, s3, 4286709632
    v_add_u32 v128, s3, v138
    s_lshl_b32 s3, s62, 10
    v_add_u32 v136, s3, v1
    v_add_u32 v129, 131074, v128
    v_add_u32 v130, 262148, v128
    v_add_u32 v131, 393222, v128
    v_add_u32 v137, 0x10000, v136
    v_or_b32 v132, 0x80008000, v128
    v_or_b32 v133, 0x80008000, v129
    v_or_b32 v134, 0x80008000, v130
    v_or_b32 v135, 0x80008000, v131
    ds_write_b128 v136, v[128:131] offset:32768
    ds_write_b128 v137, v[132:135] offset:32768
    s_add_u32 s62, s62, 5
    s_cmp_le_u32 s62, 5
    s_cbranch_scc1 LUTP_W0L
LUTP_END_W0:
    s_cmp_ge_u32 s2, 250
    s_cbranch_scc1 AUX_LOAD
    global_load_dwordx4 v[72:75], v9, s[46:47]
    global_load_dwordx4 v[76:79], v9, s[46:47] offset:16
    global_load_dwordx4 v[80:83], v9, s[48:49]
    global_load_dwordx4 v[84:87], v9, s[48:49] offset:16
LOADED:
    s_cmp_ge_u32 s2, 250
    s_cbranch_scc1 AUX
    s_waitcnt vmcnt(11)
    v_and_b32 v88, 0xff, v64
    v_lshlrev_b32 v88, 2, v88
    ds_add_rtn_u32 v92, v88, v15 offset:2304
    v_and_b32 v89, 0xff, v65
    v_lshlrev_b32 v89, 2, v89
    ds_add_rtn_u32 v93, v89, v15 offset:2304
    v_and_b32 v90, 0xff, v66
    v_lshlrev_b32 v90, 2, v90
    ds_add_rtn_u32 v94, v90, v15 offset:2304
    v_and_b32 v91, 0xff, v67
    v_lshlrev_b32 v91, 2, v91
    ds_add_rtn_u32 v95, v91, v15 offset:2304
    s_waitcnt vmcnt(10)
    v_lshrrev_b32 v64, 8, v64
    v_lshl_or_b32 v108, v68, 10, v64
    v_lshrrev_b32 v65, 8, v65
    v_lshl_or_b32 v110, v69, 10, v65
    v_lshrrev_b32 v66, 8, v66
    v_lshl_or_b32 v112, v70, 10, v66
    v_lshrrev_b32 v67, 8, v67
    v_lshl_or_b32 v114, v71, 10, v67
    s_mov_b32 s9, 87040
    s_waitcnt lgkmcnt(0)
    s_barrier
    ds_read_b128 v[96:99], v1 offset:2304
    s_add_u32 s64, s64, 1
    s_and_b32 s65, s65, 0x3ff
    v_mov_b32 v109, s64
    v_mov_b32 v111, s64
    v_mov_b32 v113, s64
    v_mov_b32 v115, s64
    s_waitcnt lgkmcnt(0)
    v_add_u32 v10, v96, v97
    v_add3_u32 v10, v10, v98, v99
    v_mov_b32 v11, v10
    s_nop 1
    v_add_u32_dpp v11, v11, v11 row_shr:1 row_mask:0xf bank_mask:0xf bound_ctrl:0
    s_nop 1
    v_add_u32_dpp v11, v11, v11 row_shr:2 row_mask:0xf bank_mask:0xf bound_ctrl:0
    s_nop 1
    v_add_u32_dpp v11, v11, v11 row_shr:4 row_mask:0xf bank_mask:0xf bound_ctrl:0
    s_nop 1
    v_add_u32_dpp v11, v11, v11 row_shr:8 row_mask:0xf bank_mask:0xf bound_ctrl:0
    s_nop 1
    v_add_u32_dpp v11, v11, v11 row_bcast:15 row_mask:0xa bank_mask:0xf
    s_nop 1
    v_add_u32_dpp v11, v11, v11 row_bcast:31 row_mask:0xc bank_mask:0xf
    v_sub_u32 v100, v11, v10
    v_add_u32 v101, v100, v96
    v_add_u32 v102, v101, v97
    v_add_u32 v103, v102, v98
    ds_write_b128 v1, v[100:103] offset:3328
    ds_read_b32 v96, v88 offset:3328
    ds_read_b32 v97, v89 offset:3328
    ds_read_b32 v98, v90 offset:3328
    ds_read_b32 v99, v91 offset:3328
    s_waitcnt lgkmcnt(3)
    v_add_u32 v92, v92, v96
    v_lshl_add_u32 v88, v92, 3, s9
    ds_write_b64 v88, v[108:109]
    s_waitcnt lgkmcnt(3)
    v_add_u32 v93, v93, v97
    v_lshl_add_u32 v89, v93, 3, s9
    ds_write_b64 v89, v[110:111]
    s_waitcnt lgkmcnt(3)
    v_add_u32 v94, v94, v98
    v_lshl_add_u32 v90, v94, 3, s9
    ds_write_b64 v90, v[112:113]
    s_waitcnt lgkmcnt(3)
    v_add_u32 v95, v95, v99
    v_lshl_add_u32 v91, v95, 3, s9
    ds_write_b64 v91, v[114:115]
    v_lshlrev_b32 v92, 4, v92
    v_add_u32 v92, 4352, v92
    v_lshlrev_b32 v93, 4, v93
    v_add_u32 v93, 4352, v93
    v_lshlrev_b32 v94, 4, v94
    v_add_u32 v94, 4352, v94
    v_lshlrev_b32 v95, 4, v95
    v_add_u32 v95, 4352, v95
    s_waitcnt lgkmcnt(0)
    s_barrier
    s_waitcnt vmcnt(0)
    ds_write2_b64 v92, v[72:73], v[80:81] offset0:0 offset1:1
    ds_write2_b64 v93, v[74:75], v[82:83] offset0:0 offset1:1
    ds_write2_b64 v94, v[76:77], v[84:85] offset0:0 offset1:1
    ds_write2_b64 v95, v[78:79], v[86:87] offset0:0 offset1:1
BINNED:
    s_setprio 0
    s_waitcnt lgkmcnt(0)
    s_barrier
    v_mov_b32 v2, 0
    s_call_b64 s[6:7], CONST_SUB
    s_cmp_gt_u32 s62, 24
    s_cbranch_scc1 LUTP_END_W
LUTP_WL:
    s_mul_i32 s3, s62, 33554944
    s_add_u32 s3, s3, 4286709632
    v_add_u32 v128, s3, v138
    s_lshl_b32 s3, s62, 10
    v_add_u32 v136, s3, v1
    v_add_u32 v129, 131074, v128
    v_add_u32 v130, 262148, v128
    v_add_u32 v131, 393222, v128
    v_add_u32 v137, 0x10000, v136
    v_or_b32 v132, 0x80008000, v128
    v_or_b32 v133, 0x80008000, v129
    v_or_b32 v134, 0x80008000, v130
    v_or_b32 v135, 0x80008000, v131
    ds_write_b128 v136, v[128:131] offset:32768
    ds_write_b128 v137, v[132:135] offset:32768
    s_add_u32 s62, s62, 5
    s_cmp_le_u32 s62, 24
    s_cbranch_scc1 LUTP_WL
LUTP_END_W:
    s_cmp_eq_u32 s25, 4
    s_cbranch_scc1 WAVE4
    s_add_u32 s62, s25, 34
    v_mov_b32 v132, 0x80008000
    v_mov_b32 v133, 0x80008000
    v_mov_b32 v134, 0x80008000
    v_mov_b32 v135, 0x80008000
LUTP_UH:
    s_mul_i32 s3, s62, 33554944
    s_add_u32 s3, s3, 131072
    v_add_u32 v128, s3, v138
    s_lshl_b32 s3, s62, 10
    v_add_u32 v136, s3, v1
    v_add_u32 v129, 131074, v128
    v_add_u32 v130, 262148, v128
    v_add_u32 v131, 393222, v128
    v_add_u32 v137, 0x10000, v136
    ds_write_b128 v136, v[128:131] offset:32768
    ds_write_b128 v137, v[132:135] offset:32768
    s_add_u32 s62, s62, 4
    s_cmp_le_u32 s62, 53
    s_cbranch_scc1 LUTP_UH
LUTP_END_U:
    buffer_load_dwordx2 v[2:3], v6, s[16:19], 0 offen sc1
    s_cmp_gt_u32 s62, 62
    s_cbranch_scc1 LUTP_END_V
LUTP_VH:
    s_mul_i32 s3, s62, 33554944
    s_add_u32 s3, s3, 131072
    v_add_u32 v128, s3, v138
    s_lshl_b32 s3, s62, 10
    v_add_u32 v136, s3, v1
    v_add_u32 v129, 131074, v128
    v_add_u32 v130, 262148, v128
    v_add_u32 v131, 393222, v128
    v_add_u32 v137, 0x10000, v136
    ds_write_b128 v136, v[128:131] offset:32768
    ds_write_b128 v137, v[132:135] offset:32768
    s_add_u32 s62, s62, 4
    s_cmp_le_u32 s62, 62
    s_cbranch_scc1 LUTP_VH
LUTP_END_V:
POLL_TAB:
    s_waitcnt vmcnt(0)
CHECK_TAB:
    v_lshrrev_b32 v11, 22, v2
    v_cmp_ne_u32 vcc, s64, v3
    v_cmp_ne_u32 s[42:43], s65, v11
    s_or_b64 vcc, vcc, s[42:43]
    s_and_b64 exec, exec, vcc
    s_cbranch_execz POLLED_TAB
    s_sub_u32 s35, s35, 1
    s_cbranch_scc1 END
    buffer_load_dwordx2 v[2:3], v6, s[16:19], 0 offen sc1
    s_branch POLL_TAB
POLLED_TAB:
    s_mov_b64 exec, -1
    s_branch TAB_DONE
LUT_SUB:
    s_lshl_b32 s3, s62, 25
    s_add_u32 s3, s3, 0x8000
    v_lshl_add_u32 v128, v1, 15, s3
    v_add_u32 v129, 0x10000, v128
    v_add_u32 v130, 0x10000, v129
    v_add_u32 v131, 0x10000, v130
    v_add_u32 v132, 0x10000, v131
    v_add_u32 v133, 0x10000, v132
    v_add_u32 v134, 0x10000, v133
    v_add_u32 v135, 0x10000, v134
    v_pk_mul_f32 v[136:137], v[128:129], s[10:11]
    v_pk_mul_f32 v[138:139], v[130:131], s[10:11]
    v_pk_mul_f32 v[140:141], v[132:133], s[10:11]
    v_pk_mul_f32 v[142:143], v[134:135], s[10:11]
    v_exp_f32 v136, v136
    v_exp_f32 v137, v137
    v_exp_f32 v138, v138
    v_exp_f32 v139, v139
    v_exp_f32 v140, v140
    v_exp_f32 v141, v141
    v_exp_f32 v142, v142
    v_exp_f32 v143, v143
    s_lshl_b32 s3, s62, 10
    v_pk_add_f32 v[144:145], v[136:137], 1.0 op_sel_hi:[1,0]
    v_pk_add_f32 v[146:147], v[138:139], 1.0 op_sel_hi:[1,0]
    v_pk_add_f32 v[148:149], v[140:141], 1.0 op_sel_hi:[1,0]
    v_pk_add_f32 v[150:151], v[142:143], 1.0 op_sel_hi:[1,0]
    v_rcp_f32 v144, v144
    v_rcp_f32 v145, v145
    v_rcp_f32 v146, v146
    v_rcp_f32 v147, v147
    v_rcp_f32 v148, v148
    v_rcp_f32 v149, v149
    v_rcp_f32 v150, v150
    v_rcp_f32 v151, v151
    v_add_u32 v160, s3, v1
    v_pk_mul_f32 v[128:129], v[128:129], v[144:145]
    v_pk_mul_f32 v[130:131], v[130:131], v[146:147]
    v_pk_mul_f32 v[132:133], v[132:133], v[148:149]
    v_pk_mul_f32 v[134:135], v[134:135], v[150:151]
    v_add_u32 v161, 0x10000, v160
    v_pk_mul_f32 v[136:137], v[128:129], v[136:137] neg_lo:[1,0] neg_hi:[1,0]
    v_pk_mul_f32 v[138:139], v[130:131], v[138:139] neg_lo:[1,0] neg_hi:[1,0]
    v_pk_mul_f32 v[140:141], v[132:133], v[140:141] neg_lo:[1,0] neg_hi:[1,0]
    v_pk_mul_f32 v[142:143], v[134:135], v[142:143] neg_lo:[1,0] neg_hi:[1,0]
    v_cvt_pk_bf16_f32 v152, v128, v129
    v_cvt_pk_bf16_f32 v153, v130, v131
    v_cvt_pk_bf16_f32 v154, v132, v133
    v_cvt_pk_bf16_f32 v155, v134, v135
    v_cvt_pk_bf16_f32 v156, v136, v137
    v_cvt_pk_bf16_f32 v157, v138, v139
    v_cvt_pk_bf16_f32 v158, v140, v141
    v_cvt_pk_bf16_f32 v159, v142, v143
    ds_write_b128 v160, v[152:155] offset:32768
    ds_write_b128 v161, v[156:159] offset:32768
    s_add_u32 s62, s62, 1
    s_sub_u32 s63, s63, 1
    s_cmp_lg_u32 s63, 0
    s_cbranch_scc1 LUT_SUB
    s_setpc_b64 s[6:7]
CONST_SUB:
    ds_write_b32 v193, v192 offset:31744
    v_lshrrev_b32 v193, 3, v1
    v_and_b32 v193, 24, v193
    s_mov_b32 s4, 0x05040100
    s_mov_b32 s5, 0x07060302
    ds_read_b64_tr_b16 v[180:181], v193 offset:31744
    ds_read_b64_tr_b16 v[182:183], v193 offset:31776
    ds_read_b64_tr_b16 v[184:185], v193 offset:31808
    ds_read_b64_tr_b16 v[186:187], v193 offset:31840
    v_perm_b32 v176, v189, v188, s4
    v_perm_b32 v178, v189, v188, s5
    v_perm_b32 v177, v191, v190, s4
    v_perm_b32 v179, v191, v190, s5
    s_setpc_b64 s[6:7]
HELP:
    s_cmp_eq_u32 s25, 6
    s_cselect_b32 s62, 25, 0
    s_cmp_eq_u32 s25, 7
    s_cselect_b32 s62, 63, s62
    s_mov_b32 s63, 1
    s_call_b64 s[6:7], LUT_SUB
    v_mov_b32 v10, 65280
    v_mov_b32 v11, 0x7f80
    s_cmp_lg_u32 s25, 7
    s_cbranch_scc1 NO_INF
    ds_write_b16 v10, v11 offset:32768
NO_INF:
    s_waitcnt vmcnt(0)
    s_call_b64 s[6:7], CONST_SUB
    s_sub_u32 s8, s25, 5
    s_mul_i32 s4, s8, 3072
    s_cmp_eq_u32 s8, 1
    s_cselect_b32 s4, 4096, s4
    s_mul_i32 s3, s2, 10240
    s_add_u32 s3, s3, s4
    v_add_u32 v8, s3, v1
    s_add_u32 s4, s4, 87040
    v_add_u32 v9, s4, v1
    s_mul_i32 s4, s8, 7168
    s_mul_i32 s3, s2, 20480
    s_add_u32 s3, s3, s4
    s_add_u32 s3, s3, 2621440
    v_add_u32 v12, s3, v1
    v_add_u32 v13, s4, v1
    s_waitcnt lgkmcnt(0)
    s_add_u32 s64, s64, 1
    s_and_b32 s65, s65, 0x3ff
    s_barrier
    s_cmp_lg_u32 s25, 6
    s_cbranch_scc1 NO_ROW
    v_lshrrev_b32 v117, 1, v1
    ds_read_b64 v[96:97], v117 offset:2304
    ds_read_b64 v[98:99], v117 offset:2816
    s_lshl_b32 s3, s2, 11
    s_add_u32 s3, s3, 7864320
    v_add_u32 v116, s3, v1
    s_lshl_b32 s3, s65, 22
    s_waitcnt lgkmcnt(0)
    v_add_u32 v10, v96, v97
    v_add_u32 v11, v98, v99
    v_mov_b32 v100, v10
    v_mov_b32 v102, v11
    s_nop 0
    v_add_u32_dpp v100, v100, v100 row_shr:1 row_mask:0xf bank_mask:0xf bound_ctrl:0
    v_add_u32_dpp v102, v102, v102 row_shr:1 row_mask:0xf bank_mask:0xf bound_ctrl:0
    s_nop 0
    v_add_u32_dpp v100, v100, v100 row_shr:2 row_mask:0xf bank_mask:0xf bound_ctrl:0
    v_add_u32_dpp v102, v102, v102 row_shr:2 row_mask:0xf bank_mask:0xf bound_ctrl:0
    s_nop 0
    v_add_u32_dpp v100, v100, v100 row_shr:4 row_mask:0xf bank_mask:0xf bound_ctrl:0
    v_add_u32_dpp v102, v102, v102 row_shr:4 row_mask:0xf bank_mask:0xf bound_ctrl:0
    s_nop 0
    v_add_u32_dpp v100, v100, v100 row_shr:8 row_mask:0xf bank_mask:0xf bound_ctrl:0
    v_add_u32_dpp v102, v102, v102 row_shr:8 row_mask:0xf bank_mask:0xf bound_ctrl:0
    s_nop 0
    v_add_u32_dpp v100, v100, v100 row_bcast:15 row_mask:0xa bank_mask:0xf
    v_add_u32_dpp v102, v102, v102 row_bcast:15 row_mask:0xa bank_mask:0xf
    s_nop 0
    v_add_u32_dpp v100, v100, v100 row_bcast:31 row_mask:0xc bank_mask:0xf
    v_add_u32_dpp v102, v102, v102 row_bcast:31 row_mask:0xc bank_mask:0xf
    v_sub_u32 v102, v102, v11
    v_readlane_b32 s4, v100, 63
    v_sub_u32 v100, v100, v10
    v_add_u32 v101, v100, v96
    v_add_u32 v102, s4, v102
    v_add_u32 v103, v102, v98
    v_lshl_or_b32 v108, v96, 11, v100
    v_or_b32 v108, s3, v108
    v_mov_b32 v109, s64
    v_lshl_or_b32 v110, v97, 11, v101
    v_or_b32 v110, s3, v110
    v_mov_b32 v111, s64
    v_lshl_or_b32 v112, v98, 11, v102
    v_or_b32 v112, s3, v112
    v_mov_b32 v113, s64
    v_lshl_or_b32 v114, v99, 11, v103
    v_or_b32 v114, s3, v114
    v_mov_b32 v115, s64
    global_store_dwordx4 v116, v[108:111], s[16:17] sc0 sc1
    global_store_dwordx4 v116, v[112:115], s[16:17] offset:1024 sc0 sc1
NO_ROW:
    s_barrier
    ds_read_b128 v[64:67], v9 offset:0
    ds_read_b128 v[68:71], v9 offset:1024
    ds_read_b128 v[72:75], v9 offset:2048
    ds_read_b128 v[76:79], v9 offset:3072
    s_waitcnt lgkmcnt(3)
    global_store_dwordx4 v8, v[64:67], s[16:17] offset:0 sc0 sc1
    s_waitcnt lgkmcnt(2)
    global_store_dwordx4 v8, v[68:71], s[16:17] offset:1024 sc0 sc1
    s_cmp_eq_u32 s8, 1
    s_cbranch_scc1 KEYS_STORED
    s_waitcnt lgkmcnt(1)
    global_store_dwordx4 v8, v[72:75], s[16:17] offset:2048 sc0 sc1
    s_waitcnt lgkmcnt(0)
    global_store_dwordx4 v8, v[76:79], s[16:17] offset:3072 sc0 sc1
KEYS_STORED:
    v_mov_b32 v2, 0
    s_waitcnt lgkmcnt(0)
    s_barrier
    s_cmp_ge_u32 s2, 250
    s_cbranch_scc1 TAB_DONE
    ds_read_b128 v[84:87], v13 offset:4352
    ds_read_b128 v[88:91], v13 offset:5376
    ds_read_b128 v[92:95], v13 offset:6400
    ds_read_b128 v[96:99], v13 offset:7424
    ds_read_b128 v[100:103], v13 offset:8448
    ds_read_b128 v[104:107], v13 offset:9472
    ds_read_b128 v[108:111], v13 offset:10496
    s_waitcnt lgkmcnt(6)
    global_store_dwordx4 v12, v[84:87], s[16:17] offset:0 sc0 sc1
    s_waitcnt lgkmcnt(5)
    global_store_dwordx4 v12, v[88:91], s[16:17] offset:1024 sc0 sc1
    s_waitcnt lgkmcnt(4)
    global_store_dwordx4 v12, v[92:95], s[16:17] offset:2048 sc0 sc1
    s_waitcnt lgkmcnt(3)
    global_store_dwordx4 v12, v[96:99], s[16:17] offset:3072 sc0 sc1
    v_add_u32 v12, 4096, v12
    s_waitcnt lgkmcnt(2)
    global_store_dwordx4 v12, v[100:103], s[16:17] offset:0 sc0 sc1
    s_waitcnt lgkmcnt(1)
    global_store_dwordx4 v12, v[104:107], s[16:17] offset:1024 sc0 sc1
    s_cmp_eq_u32 s8, 2
    s_cbranch_scc1 TAB_DONE
    s_waitcnt lgkmcnt(0)
    global_store_dwordx4 v12, v[108:111], s[16:17] offset:2048 sc0 sc1
    s_branch TAB_DONE
AUX_LOAD:
    s_cmp_ge_u32 s2, 254
    s_cbranch_scc1 LOADED
    s_cmp_ge_u32 s25, 4
    s_cbranch_scc1 LOADED
    s_sub_u32 s4, s2, 250
    s_lshl_b32 s5, s25, 13
    s_lshl_b32 s8, s4, 6
    s_add_u32 s5, s5, s8
    v_lshrrev_b32 v9, 8, v1
    v_lshlrev_b32 v9, 11, v9
    v_bfe_u32 v10, v1, 4, 4
    v_lshl_add_u32 v9, v10, 2, v9
    v_add_u32 v9, s5, v9
    s_lshl_b32 s5, s4, 13
    s_lshl_b32 s8, s25, 10
    s_add_u32 s5, s5, s8
    s_add_u32 s5, s5, 7802880
    v_add_u32 v10, s5, v1
    global_load_dword v64, v9, s[54:55] offset:0
    global_load_dword v65, v9, s[54:55] offset:256
    global_load_dword v66, v9, s[54:55] offset:512
    global_load_dword v67, v9, s[54:55] offset:768
    global_load_dword v68, v9, s[54:55] offset:1024
    global_load_dword v69, v9, s[54:55] offset:1280
    global_load_dword v70, v9, s[54:55] offset:1536
    global_load_dword v71, v9, s[54:55] offset:1792
    s_branch LOADED
AUX:
    s_waitcnt lgkmcnt(0)
    s_add_u32 s64, s64, 1
    s_and_b32 s65, s65, 0x3ff
    s_barrier
    s_cmp_ge_u32 s2, 254
    s_cbranch_scc1 AUX_DONE
    s_cmp_ge_u32 s25, 4
    s_cbranch_scc1 AUX_DONE
    s_mov_b32 s4, 0x05040100
    s_mov_b32 s5, 0x07060302
    s_waitcnt vmcnt(0)
    v_perm_b32 v72, v65, v64, s4
    v_perm_b32 v76, v65, v64, s5
    v_perm_b32 v73, v67, v66, s4
    v_perm_b32 v77, v67, v66, s5
    v_perm_b32 v74, v69, v68, s4
    v_perm_b32 v78, v69, v68, s5
    v_perm_b32 v75, v71, v70, s4
    v_perm_b32 v79, v71, v70, s5
    global_store_dwordx4 v10, v[72:75], s[16:17] sc0 sc1
    v_add_u32 v10, 4096, v10
    global_store_dwordx4 v10, v[76:79], s[16:17] sc0 sc1
AUX_DONE:
    s_barrier
    s_waitcnt vmcnt(0)
    s_branch BINNED
WAVE4:
    s_mov_b32 s62, 26
    s_mov_b32 s63, 2
    s_call_b64 s[6:7], LUT_SUB
TAB_DONE:
    s_cmp_ge_u32 s25, 4
    s_cbranch_scc1 NOT_POLLER
    v_and_b32 v13, 0x7ff, v2
    v_bfe_u32 v2, v2, 11, 11
    v_add_u32 v4, v4, v13
    v_mov_b32 v3, v2
    v_lshlrev_b32 v10, 3, v4
    buffer_load_dword v167, v10, s[16:19], 0 offen sc1
    s_nop 1
    v_add_u32_dpp v3, v3, v3 row_shr:1 row_mask:0xf bank_mask:0xf bound_ctrl:0
    s_nop 1
    v_add_u32_dpp v3, v3, v3 row_shr:2 row_mask:0xf bank_mask:0xf bound_ctrl:0
    s_nop 1
    v_add_u32_dpp v3, v3, v3 row_shr:4 row_mask:0xf bank_mask:0xf bound_ctrl:0
    s_nop 1
    v_add_u32_dpp v3, v3, v3 row_shr:8 row_mask:0xf bank_mask:0xf bound_ctrl:0
    s_nop 1
    v_add_u32_dpp v3, v3, v3 row_bcast:15 row_mask:0xa bank_mask:0xf
    s_nop 1
    v_add_u32_dpp v3, v3, v3 row_bcast:31 row_mask:0xc bank_mask:0xf
    s_lshl_b32 s3, s25, 2
    v_mov_b32 v10, s3
    v_add_u32 v11, 1, v3
    v_sub_u32 v3, v3, v2
    s_mov_b32 exec_lo, 0
    s_mov_b32 exec_hi, 0x80000000
    ds_write_b32 v10, v11 offset:2176
    s_mov_b64 exec, -1
    s_branch TOTALS
NOT_POLLER:
    s_cmp_eq_u32 s25, 4
    s_cbranch_scc1 TOTALS
    v_mov_b32 v10, 2240
    s_waitcnt vmcnt(0)
    s_mov_b64 exec, 1
    ds_add_rtn_u32 v10, v10, v15
    s_mov_b64 exec, -1
    s_waitcnt lgkmcnt(0)
    v_readfirstlane_b32 s3, v10
    s_cmp_lg_u32 s3, 2
    s_cbranch_scc1 TOTALS
    s_lshl_b32 s3, s2, 10
    s_add_u32 s3, s3, 8388608
    v_add_u32 v9, s3, v1
    v_mov_b32 v10, s64
    v_mov_b32 v11, s65
    v_mov_b32 v12, s64
    v_mov_b32 v13, s65
    global_store_dwordx4 v9, v[10:13], s[16:17] sc0 sc1
    s_nop 1
TOTALS:
    v_mov_b32 v10, 0
TOTALS_SPIN:
    ds_read_b128 v[64:67], v10 offset:2176
    s_waitcnt lgkmcnt(0)
    v_readfirstlane_b32 s4, v64
    v_readfirstlane_b32 s5, v65
    v_readfirstlane_b32 s6, v66
    v_readfirstlane_b32 s7, v67
    s_min_u32 s3, s4, s5
    s_min_u32 s8, s6, s7
    s_min_u32 s3, s3, s8
    s_cmp_eq_u32 s3, 0
    s_cbranch_scc0 TOTALS_OK
    s_sub_u32 s35, s35, 1
    s_cbranch_scc0 TOTALS_SPIN
    s_endpgm
TOTALS_OK:
    s_add_u32 s5, s5, s4
    s_add_u32 s6, s6, s5
    s_add_u32 s7, s7, s6
    s_sub_u32 s26, s7, 4
    s_cmp_eq_u32 s25, 1
    s_cselect_b32 s3, s4, 0
    s_cmp_eq_u32 s25, 2
    s_cselect_b32 s3, s5, s3
    s_cmp_eq_u32 s25, 3
    s_cselect_b32 s3, s6, s3
    s_sub_u32 s3, s3, s25
    v_add_u32 v3, s3, v3
    s_cmp_lg_u32 s25, 4
    s_cbranch_scc1 EPOCH_DONE
    s_cmp_lg_u32 s2, 0
    s_cbranch_scc1 EPOCH_DONE
    v_mov_b32 v12, s64
    v_mov_b32 v10, 8650752
    s_mov_b64 exec, 1
    global_store_dword v10, v12, s[16:17] sc0 sc1
    s_mov_b64 exec, -1
EPOCH_DONE:
    s_lshl_b32 s4, s2, 3
    s_add_u32 s4, s4, s25
    s_lshl_b32 s4, s4, 7
    s_add_u32 s4, s4, 0
    v_min_u32 v139, 240, v1
    v_lshl_add_u32 v139, v139, 14, s4
    buffer_load_dword v167, v139, s[12:15], 0 offen
NO_X_TOUCH_3:
ROUND:
    v_mov_b32 v8, 0
    v_subrev_u32 v9, s27, v3
    v_mov_b32 v10, v4
    s_mov_b32 s3, 1472
    s_cmp_gt_u32 s26, 1472
    s_cbranch_scc1 EXPAND
    v_lshlrev_b32 v11, 2, v3
    v_cmpx_lt_u32 vcc, 0, v2
    ds_write_b32 v11, v10 offset:2304
    v_add_u32 v10, 1, v10
    v_cmpx_lt_u32 vcc, 1, v2
    ds_write_b32 v11, v10 offset:2308
    v_add_u32 v10, 1, v10
    v_cmpx_lt_u32 vcc, 2, v2
    ds_write_b32 v11, v10 offset:2312
    v_add_u32 v10, 1, v10
    v_cmpx_lt_u32 vcc, 3, v2
    ds_write_b32 v11, v10 offset:2316
    v_add_u32 v10, 1, v10
    v_cmpx_lt_u32 vcc, 4, v2
    ds_write_b32 v11, v10 offset:2320
    v_add_u32 v10, 1, v10
    v_cmpx_lt_u32 vcc, 5, v2
    ds_write_b32 v11, v10 offset:2324
    v_add_u32 v10, 1, v10
    v_cmpx_lt_u32 vcc, 6, v2
    s_cbranch_execz EXPAND_DONE
    ds_write_b32 v11, v10 offset:2328
    v_add_u32 v10, 1, v10
    v_cmpx_lt_u32 vcc, 7, v2
    ds_write_b32 v11, v10 offset:2332
    v_add_u32 v10, 1, v10
    v_cmpx_lt_u32 vcc, 8, v2
    s_cbranch_execz EXPAND_DONE
    ds_write_b32 v11, v10 offset:2336
    v_add_u32 v10, 1, v10
    v_cmpx_lt_u32 vcc, 9, v2
    ds_write_b32 v11, v10 offset:2340
    v_add_u32 v10, 1, v10
    v_cmpx_lt_u32 vcc, 10, v2
    s_cbranch_execz EXPAND_DONE
    ds_write_b32 v11, v10 offset:2344
    v_add_u32 v10, 1, v10
    v_cmpx_lt_u32 vcc, 11, v2
    ds_write_b32 v11, v10 offset:2348
    v_add_u32 v10, 1, v10
    v_cmpx_lt_u32 vcc, 12, v2
    s_cbranch_execz EXPAND_DONE
    ds_write_b32 v11, v10 offset:2352
    v_add_u32 v10, 1, v10
    v_cmpx_lt_u32 vcc, 13, v2
    ds_write_b32 v11, v10 offset:2356
    v_add_u32 v10, 1, v10
    v_cmpx_lt_u32 vcc, 14, v2
    s_cbranch_execz EXPAND_DONE
    ds_write_b32 v11, v10 offset:2360
    v_add_u32 v10, 1, v10
    v_cmpx_lt_u32 vcc, 15, v2
    ds_write_b32 v11, v10 offset:2364
    v_add_u32 v10, 1, v10
    v_mov_b32 v8, 16
    v_add_u32 v9, 16, v9
EXPAND:
    v_cmp_lt_u32 vcc, v8, v2
    s_and_b64 exec, exec, vcc
    s_cbranch_execz EXPAND_DONE
    v_cmp_gt_u32 vcc, s3, v9
    v_lshlrev_b32 v11, 2, v9
    s_and_saveexec_b64 s[42:43], vcc
    ds_write_b32 v11, v10 offset:2304
    s_mov_b64 exec, s[42:43]
    v_add_u32 v8, 1, v8
    v_add_u32 v9, 1, v9
    v_add_u32 v10, 1, v10
    s_branch EXPAND
EXPAND_DONE:
    s_mov_b64 exec, -1
    s_sub_u32 s28, s26, s27
    s_min_u32 s28, s28, 1472
    v_lshlrev_b32 v8, 2, v0
    v_add_u32 v9, 0, v0
    v_cmp_gt_u32 s[36:37], s28, v9
    v_add_u32 v9, 512, v0
    v_cmp_gt_u32 s[38:39], s28, v9
    v_add_u32 v9, 1024, v0
    v_cmp_gt_u32 s[40:41], s28, v9
    s_waitcnt lgkmcnt(0)
    s_barrier
    ds_read_b32 v64, v8 offset:2304
    ds_read_b32 v65, v8 offset:4352
    ds_read_b32 v66, v8 offset:6400
    s_mov_b32 s44, 5033
    s_waitcnt lgkmcnt(0)
    v_lshlrev_b32 v68, 3, v64
    v_lshlrev_b32 v64, 4, v64
    v_lshlrev_b32 v69, 3, v65
    v_lshlrev_b32 v65, 4, v65
    v_lshlrev_b32 v70, 3, v66
    v_lshlrev_b32 v66, 4, v66
KEY_LOAD:
    s_mov_b64 exec, s[40:41]
    s_cbranch_execz SKIP3
    buffer_load_dwordx2 v[100:101], v70, s[16:19], 0 offen sc1
SKIP3:
    s_mov_b64 exec, s[36:37]
    buffer_load_dwordx2 v[96:97], v68, s[16:19], 0 offen sc1
    s_mov_b64 exec, s[38:39]
    buffer_load_dwordx2 v[98:99], v69, s[16:19], 0 offen sc1
    s_mov_b64 exec, -1
    s_cmp_lt_u32 s25, 2
    s_cbranch_scc1 NO_LAST_JOB
    s_mov_b32 s10, 0xbfb8aa3b
    s_mov_b32 s11, 0xbfb8aa3b
    s_add_u32 s62, s25, 26
    s_mov_b32 s63, 1
    s_call_b64 s[6:7], LUT_SUB
NO_LAST_JOB:
    s_waitcnt vmcnt(0)
    v_cmp_ne_u32 s[48:49], s64, v97
    v_cmp_ne_u32 s[50:51], s64, v99
    v_cmp_ne_u32 s[52:53], s64, v101
    s_and_b64 s[48:49], s[48:49], s[36:37]
    s_and_b64 s[50:51], s[50:51], s[38:39]
    s_and_b64 s[52:53], s[52:53], s[40:41]
    s_or_b64 s[48:49], s[48:49], s[50:51]
    s_or_b64 s[48:49], s[48:49], s[52:53]
    s_cbranch_scc0 KEYS_OK
    s_sub_u32 s35, s35, 1
    s_cbranch_scc0 KEY_LOAD
    s_endpgm
KEYS_OK:
    buffer_load_dwordx2 v[136:137], v166, s[16:19], 0 offen sc1
    v_mul_hi_u32 v9, s44, v96
    v_and_b32 v72, 63, v96
    v_mul_u32_u24 v72, 48, v72
    v_lshl_add_u32 v72, v9, 2, v72
    v_mul_hi_u32 v9, s44, v98
    v_and_b32 v73, 63, v98
    v_mul_u32_u24 v73, 48, v73
    v_lshl_add_u32 v73, v9, 2, v73
    v_mul_hi_u32 v9, s44, v100
    v_and_b32 v74, 63, v100
    v_mul_u32_u24 v74, 48, v74
    v_lshl_add_u32 v74, v9, 2, v74
    s_mov_b64 exec, s[36:37]
    ds_add_rtn_u32 v76, v72, v15 offset:0
    s_mov_b64 exec, s[38:39]
    ds_add_rtn_u32 v77, v73, v15 offset:0
    s_mov_b64 exec, s[40:41]
    ds_add_rtn_u32 v78, v74, v15 offset:0
    s_mov_b64 exec, -1
    v_add_u32 v9, 0, v0
    v_lshlrev_b32 v9, 21, v9
    v_lshrrev_b32 v80, 10, v96
    v_lshl_or_b32 v80, v80, 7, v9
    v_add_u32 v9, 512, v0
    v_lshlrev_b32 v9, 21, v9
    v_lshrrev_b32 v81, 10, v98
    v_lshl_or_b32 v81, v81, 7, v9
    v_add_u32 v9, 1024, v0
    v_lshlrev_b32 v9, 21, v9
    v_lshrrev_b32 v82, 10, v100
    v_lshl_or_b32 v82, v82, 7, v9
    v_lshrrev_b32 v8, 4, v1
    v_min_u32 v9, 39, v8
    v_mul_u32_u24 v9, 48, v9
    v_cmp_gt_u32 s[46:47], 40, v8
    v_sub_u32 v10, 63, v8
    s_mul_i32 s10, s25, 5
    s_lshl_b32 s3, s25, 10
    s_add_u32 s3, s3, 8192
    s_mov_b32 s9, 2621440
    s_waitcnt lgkmcnt(0)
    s_barrier
    ds_read_b128 v[84:87], v9 offset:0
    ds_read_b128 v[88:91], v9 offset:16
    ds_read_b128 v[92:95], v9 offset:32
    s_waitcnt lgkmcnt(1)
    v_add3_u32 v84, v84, v85, v86
    v_add3_u32 v87, v87, v88, v89
    v_add3_u32 v84, v84, v90, v91
    s_waitcnt lgkmcnt(0)
    v_add3_u32 v87, v87, v92, v93
    v_add3_u32 v84, v84, v94, v95
    v_add_u32 v84, v84, v87
    v_lshl_or_b32 v85, v84, 6, v10
    v_cndmask_b32 v85, 0, v85, s[46:47]
    s_cmp_lg_u32 s27, 0
    s_cbranch_scc1 DEALT
    v_readlane_b32 s4, v85, s10
    s_add_u32 s10, s10, 1
    v_readlane_b32 s5, v85, s10
    s_add_u32 s10, s10, 1
    v_readlane_b32 s6, v85, s10
    s_add_u32 s10, s10, 1
    v_readlane_b32 s7, v85, s10
    s_add_u32 s10, s10, 1
    v_readlane_b32 s8, v85, s10
    v_cmp_lt_u32 s[48:49], s4, v85
    v_cmp_lt_u32 s[50:51], s5, v85
    v_cmp_lt_u32 s[52:53], s6, v85
    v_cmp_lt_u32 s[54:55], s7, v85
    v_cmp_lt_u32 s[56:57], s8, v85
    s_bcnt1_i32_b64 s4, s[48:49]
    s_bcnt1_i32_b64 s5, s[50:51]
    s_bcnt1_i32_b64 s6, s[52:53]
    s_bcnt1_i32_b64 s7, s[54:55]
    s_bcnt1_i32_b64 s8, s[56:57]
    v_readlane_b32 s4, v174, s4
    v_readlane_b32 s5, v174, s5
    v_readlane_b32 s6, v174, s6
    v_readlane_b32 s7, v174, s7
    v_readlane_b32 s8, v174, s8
    s_sub_u32 s10, s10, 4
    v_add_u32 v10, s10, v8
    v_writelane_b32 v9, s4, 0
    v_writelane_b32 v9, s5, 1
    v_writelane_b32 v9, s6, 2
    v_writelane_b32 v9, s7, 3
    v_writelane_b32 v9, s8, 4
    s_mov_b64 exec, 0x1f
    ds_write_b32 v9, v10 offset:1920
    s_mov_b64 exec, -1
DEALT:
    s_lshl_b32 s11, s10, 2
    v_add_u32 v9, s11, v7
    v_lshlrev_b32 v13, 2, v8
POLL_REC:
    s_waitcnt vmcnt(0)
CHECK_REC:
    v_cmp_ne_u32 vcc, s64, v136
    v_cmp_ne_u32 s[42:43], s65, v137
    s_or_b64 vcc, vcc, s[42:43]
    s_and_b64 exec, exec, vcc
    s_cbranch_execz POLLED_REC
    s_sub_u32 s35, s35, 1
    s_cbranch_scc1 END
    buffer_load_dwordx2 v[136:137], v166, s[16:19], 0 offen sc1
    s_branch POLL_REC
POLLED_REC:
    s_mov_b64 exec, -1
    v_cmp_gt_u32 s[42:43], 60, v8
    s_waitcnt lgkmcnt(0)
    s_barrier
    ds_read_b32 v9, v9 offset:1920
    ds_read_b32 v13, v13 offset:1920
    v_lshlrev_b32 v12, 17, v7
    s_add_u32 m0, s3, 0
    s_mov_b64 exec, s[36:37]
    buffer_load_dwordx4 v64, s[16:19], s9 offen sc1 lds
    s_add_u32 m0, s3, 8192
    s_mov_b64 exec, s[38:39]
    buffer_load_dwordx4 v65, s[16:19], s9 offen sc1 lds
    s_add_u32 m0, s3, 16384
    s_mov_b64 exec, s[40:41]
    s_cbranch_execz SKIP3R
    buffer_load_dwordx4 v66, s[16:19], s9 offen sc1 lds
SKIP3R:
    s_mov_b64 exec, -1
    s_waitcnt lgkmcnt(1)
    v_mul_u32_u24 v10, 48, v9
    v_add_u32 v10, v10, v14
    ds_read_b32 v11, v10 offset:0
    s_waitcnt lgkmcnt(1)
    v_lshlrev_b32 v13, 2, v13
    ds_bpermute_b32 v86, v13, v84
    v_readlane_b32 s4, v9, 0
    v_readlane_b32 s5, v9, 1
    v_readlane_b32 s6, v9, 2
    v_readlane_b32 s7, v9, 3
    v_readlane_b32 s8, v9, 4
    s_waitcnt lgkmcnt(0)
    v_cndmask_b32 v11, 0, v11, s[42:43]
    v_cndmask_b32 v86, 0, v86, s[46:47]
    v_sub_u32 v12, v12, v11
    v_mov_b32 v87, v86
    s_nop 0
    v_add_u32_dpp v11, v11, v11 row_shr:1 row_mask:0xf bank_mask:0xf bound_ctrl:0
    v_add_u32_dpp v87, v87, v87 row_shr:1 row_mask:0xf bank_mask:0xf bound_ctrl:0
    s_nop 0
    v_add_u32_dpp v11, v11, v11 row_shr:2 row_mask:0xf bank_mask:0xf bound_ctrl:0
    v_add_u32_dpp v87, v87, v87 row_shr:2 row_mask:0xf bank_mask:0xf bound_ctrl:0
    s_nop 0
    v_add_u32_dpp v11, v11, v11 row_shr:4 row_mask:0xf bank_mask:0xf bound_ctrl:0
    v_add_u32_dpp v87, v87, v87 row_shr:4 row_mask:0xf bank_mask:0xf bound_ctrl:0
    s_nop 0
    v_add_u32_dpp v11, v11, v11 row_shr:8 row_mask:0xf bank_mask:0xf bound_ctrl:0
    v_add_u32_dpp v87, v87, v87 row_shr:8 row_mask:0xf bank_mask:0xf bound_ctrl:0
    s_nop 0
    v_add_u32_dpp v11, v11, v11 row_bcast:15 row_mask:0xa bank_mask:0xf
    v_add_u32_dpp v87, v87, v87 row_bcast:15 row_mask:0xa bank_mask:0xf
    s_nop 0
    v_add_u32_dpp v11, v11, v11 row_bcast:31 row_mask:0xc bank_mask:0xf
    v_add_u32_dpp v87, v87, v87 row_bcast:31 row_mask:0xc bank_mask:0xf
    v_sub_u32 v87, v87, v86
    v_add_u32 v12, v12, v11
    v_readlane_b32 s29, v87, s10
    v_readlane_b32 s30, v11, 63
    s_nop 0
    v_add_u32 v12, s29, v12
    s_mov_b64 exec, s[42:43]
    ds_write_b32 v10, v12 offset:0
    s_mov_b64 exec, -1
    v_add_u32 v6, s29, v8
    v_lshlrev_b32 v5, 2, v6
    v_add_u32 v5, 2304, v5
    s_max_u32 s10, s30, 6
    s_add_u32 s10, s10, -3
    s_and_b32 s31, s10, -4
    s_max_u32 s10, s30, s31
    s_sub_u32 s32, s10, s31
    s_add_u32 s30, s30, s29
    s_waitcnt lgkmcnt(0)
    s_barrier
    ds_read_b32 v72, v72 offset:0
    ds_read_b32 v73, v73 offset:0
    ds_read_b32 v74, v74 offset:0
    s_waitcnt lgkmcnt(2)
    v_lshrrev_b32 v9, 16, v72
    v_and_b32 v72, 0xffff, v72
    v_or_b32 v80, v80, v9
    v_add_lshl_u32 v72, v72, v76, 2
    s_waitcnt lgkmcnt(1)
    v_lshrrev_b32 v9, 16, v73
    v_and_b32 v73, 0xffff, v73
    v_or_b32 v81, v81, v9
    v_add_lshl_u32 v73, v73, v77, 2
    s_waitcnt lgkmcnt(0)
    v_lshrrev_b32 v9, 16, v74
    v_and_b32 v74, 0xffff, v74
    v_or_b32 v82, v82, v9
    v_add_lshl_u32 v74, v74, v78, 2
    s_mov_b64 exec, s[36:37]
    ds_write_b32 v72, v80 offset:2304
    s_mov_b64 exec, s[38:39]
    ds_write_b32 v73, v81 offset:2304
    s_mov_b64 exec, s[40:41]
    ds_write_b32 v74, v82 offset:2304
    s_mov_b64 exec, -1
    s_waitcnt lgkmcnt(0)
    s_barrier
    ds_read_b32 v165, v5
    s_and_b32 s10, s25, 3
    s_lshl_b32 s10, s10, 13
    s_add_u32 s10, s10, 7802880
    s_add_u32 s11, s10, 4096
    v_mov_b32 v128, 0
    v_mov_b32 v129, 0
    v_mov_b32 v130, 0
    v_mov_b32 v131, 0
    v_mov_b32 v132, 0
    v_mov_b32 v133, 0
    v_mov_b32 v134, 0
    v_mov_b32 v135, 0
    s_waitcnt lgkmcnt(0)
    v_cmp_gt_u32 vcc, s30, v6
    v_add_u32 v6, 64, v6
    v_add_u32 v5, 256, v5
    v_cndmask_b32 v165, 40, v165, vcc
    v_lshrrev_b32 v8, 21, v165
    v_lshlrev_b32 v8, 4, v8
    v_lshlrev_b32 v9, 3, v165
    v_and_b32 v9, 0xfffc00, v9
    v_and_or_b32 v165, v165, 56, v9
    s_nop 0
    v_readlane_b32 s48, v165, 0
    s_and_b32 s33, s48, s34
    buffer_load_dwordx4 v[64:67], v1, s[12:15], s33 offen
    v_readlane_b32 s49, v165, 1
    s_and_b32 s33, s49, s34
    buffer_load_dwordx4 v[68:71], v1, s[12:15], s33 offen
    s_waitcnt vmcnt(2)
    s_barrier
    ds_read_b128 v[168:171], v8 offset:8192
    v_readlane_b32 s50, v165, 2
    s_and_b32 s33, s50, s34
    buffer_load_dwordx4 v[72:75], v1, s[12:15], s33 offen
    v_readlane_b32 s51, v165, 3
    s_and_b32 s33, s51, s34
    buffer_load_dwordx4 v[76:79], v1, s[12:15], s33 offen
    v_readlane_b32 s52, v165, 4
    s_and_b32 s33, s52, s34
    buffer_load_dwordx4 v[80:83], v1, s[12:15], s33 offen
    v_readlane_b32 s53, v165, 5
    s_and_b32 s33, s53, s34
    buffer_load_dwordx4 v[84:87], v1, s[12:15], s33 offen
    v_mov_b32 v164, v165
    s_waitcnt lgkmcnt(0)
    v_mov_b32 v172, v170
    v_mov_b32 v173, v171
    v_mfma_f32_4x4x4_16b_bf16 v[148:151], v[168:169], v[180:181], 0
    v_mfma_f32_4x4x4_16b_bf16 v[152:155], v[168:169], v[182:183], 0
    v_mfma_f32_4x4x4_16b_bf16 v[156:159], v[168:169], v[184:185], 0
    v_mfma_f32_4x4x4_16b_bf16 v[160:163], v[168:169], v[186:187], 0
    v_mfma_f32_4x4x4_16b_bf16 v[112:115], v[172:173], v[176:177], 0 cbsz:4 abid:0
    v_mfma_f32_4x4x4_16b_bf16 v[116:119], v[172:173], v[178:179], 0 cbsz:4 abid:0
    v_mfma_f32_4x4x4_16b_bf16 v[120:123], v[172:173], v[176:177], 0 cbsz:4 abid:1
    s_nop 1
    v_cvt_pk_bf16_f32 v140, v148, v152
    v_cvt_pk_bf16_f32 v141, v156, v160
    v_cvt_pk_bf16_f32 v142, v149, v153
    v_cvt_pk_bf16_f32 v143, v157, v161
    v_cvt_pk_bf16_f32 v144, v150, v154
    v_cvt_pk_bf16_f32 v145, v158, v162
    v_cvt_pk_bf16_f32 v146, v151, v155
    v_cvt_pk_bf16_f32 v147, v159, v163
    v_lshlrev_b32_sdwa v136, v15, v112 dst_sel:DWORD dst_unused:UNUSED_PAD src0_sel:DWORD src1_sel:WORD_1
    v_lshlrev_b32_sdwa v137, v15, v113 dst_sel:DWORD dst_unused:UNUSED_PAD src0_sel:DWORD src1_sel:WORD_1
    ds_read_u16_d16_hi v128, v136 offset:32768
    ds_read_u16_d16_hi v129, v137 offset:32768
    v_lshlrev_b32_sdwa v138, v15, v116 dst_sel:DWORD dst_unused:UNUSED_PAD src0_sel:DWORD src1_sel:WORD_1
    v_lshlrev_b32_sdwa v139, v15, v117 dst_sel:DWORD dst_unused:UNUSED_PAD src0_sel:DWORD src1_sel:WORD_1
    ds_read_u16_d16_hi v130, v138 offset:32768
    ds_read_u16_d16_hi v131, v139 offset:32768
    s_waitcnt vmcnt(5)
    v_mfma_f32_4x4x4_16b_bf16 v[96:99], v[140:141], v[64:65], 0 cbsz:4 abid:0
    v_mfma_f32_4x4x4_16b_bf16 v[100:103], v[140:141], v[66:67], 0 cbsz:4 abid:0
A_0:
    s_sub_u32 s31, s31, 4
    s_cbranch_scc1 B_0
    v_mfma_f32_4x4x4_16b_bf16 v[124:127], v[172:173], v[178:179], 0 cbsz:4 abid:1
    v_lshlrev_b32_sdwa v136, v15, v114 dst_sel:DWORD dst_unused:UNUSED_PAD src0_sel:DWORD src1_sel:WORD_1
    s_waitcnt vmcnt(4)
    v_mfma_f32_4x4x4_16b_bf16 v[104:107], v[142:143], v[68:69], 0 cbsz:4 abid:0
    v_readlane_b32 s54, v164, 6
    v_mfma_f32_4x4x4_16b_bf16 v[108:111], v[142:143], v[70:71], 0 cbsz:4 abid:0
    v_lshlrev_b32_sdwa v137, v15, v115 dst_sel:DWORD dst_unused:UNUSED_PAD src0_sel:DWORD src1_sel:WORD_1
    ds_read_u16_d16_hi v132, v136 offset:32768
    ds_read_u16_d16_hi v133, v137 offset:32768
    s_and_b32 s33, s54, s34
    buffer_load_dwordx4 v[88:91], v1, s[12:15], s33 offen
    s_waitcnt lgkmcnt(2)
    s_set_gpr_idx_on s48, 0xc
    v_pk_fma_f32 v[16:17], v[128:129], v[96:97], v[16:17] op_sel:[0,0,0] op_sel_hi:[0,1,1]
    v_pk_fma_f32 v[18:19], v[128:129], v[98:99], v[18:19] op_sel:[0,0,0] op_sel_hi:[0,1,1]
    v_pk_fma_f32 v[20:21], v[130:131], v[100:101], v[20:21] op_sel:[0,0,0] op_sel_hi:[0,1,1]
    v_pk_fma_f32 v[22:23], v[130:131], v[102:103], v[22:23] op_sel:[0,0,0] op_sel_hi:[0,1,1]
    s_set_gpr_idx_off
    v_lshlrev_b32_sdwa v138, v15, v118 dst_sel:DWORD dst_unused:UNUSED_PAD src0_sel:DWORD src1_sel:WORD_1
    s_waitcnt vmcnt(4)
    v_mfma_f32_4x4x4_16b_bf16 v[96:99], v[144:145], v[72:73], 0 cbsz:4 abid:0
    v_readlane_b32 s55, v164, 7
    v_mfma_f32_4x4x4_16b_bf16 v[100:103], v[144:145], v[74:75], 0 cbsz:4 abid:0
    v_lshlrev_b32_sdwa v139, v15, v119 dst_sel:DWORD dst_unused:UNUSED_PAD src0_sel:DWORD src1_sel:WORD_1
    ds_read_u16_d16_hi v134, v138 offset:32768
    ds_read_u16_d16_hi v135, v139 offset:32768
    s_and_b32 s33, s55, s34
    buffer_load_dwordx4 v[92:95], v1, s[12:15], s33 offen
    s_set_gpr_idx_on s49, 0xc
    v_pk_fma_f32 v[16:17], v[128:129], v[104:105], v[16:17] op_sel:[1,0,0] op_sel_hi:[1,1,1]
    v_pk_fma_f32 v[18:19], v[128:129], v[106:107], v[18:19] op_sel:[1,0,0] op_sel_hi:[1,1,1]
    v_pk_fma_f32 v[20:21], v[130:131], v[108:109], v[20:21] op_sel:[1,0,0] op_sel_hi:[1,1,1]
    v_pk_fma_f32 v[22:23], v[130:131], v[110:111], v[22:23] op_sel:[1,0,0] op_sel_hi:[1,1,1]
    s_set_gpr_idx_off
    v_mfma_f32_4x4x4_16b_bf16 v[112:115], v[172:173], v[176:177], 0 cbsz:4 abid:2
    v_lshlrev_b32_sdwa v136, v15, v120 dst_sel:DWORD dst_unused:UNUSED_PAD src0_sel:DWORD src1_sel:WORD_1
    s_waitcnt vmcnt(4)
    v_mfma_f32_4x4x4_16b_bf16 v[104:107], v[146:147], v[76:77], 0 cbsz:4 abid:0
    v_readlane_b32 s56, v164, 8
    v_mfma_f32_4x4x4_16b_bf16 v[108:111], v[146:147], v[78:79], 0 cbsz:4 abid:0
    v_lshlrev_b32_sdwa v137, v15, v121 dst_sel:DWORD dst_unused:UNUSED_PAD src0_sel:DWORD src1_sel:WORD_1
    ds_read_u16_d16_hi v128, v136 offset:32768
    ds_read_u16_d16_hi v129, v137 offset:32768
    s_and_b32 s33, s56, s34
    buffer_load_dwordx4 v[64:67], v1, s[12:15], s33 offen
    s_waitcnt lgkmcnt(2)
    s_set_gpr_idx_on s50, 0xc
    v_pk_fma_f32 v[16:17], v[132:133], v[96:97], v[16:17] op_sel:[0,0,0] op_sel_hi:[0,1,1]
    v_pk_fma_f32 v[18:19], v[132:133], v[98:99], v[18:19] op_sel:[0,0,0] op_sel_hi:[0,1,1]
    v_pk_fma_f32 v[20:21], v[134:135], v[100:101], v[20:21] op_sel:[0,0,0] op_sel_hi:[0,1,1]
    v_pk_fma_f32 v[22:23], v[134:135], v[102:103], v[22:23] op_sel:[0,0,0] op_sel_hi:[0,1,1]
    s_set_gpr_idx_off
    v_lshlrev_b32_sdwa v138, v15, v124 dst_sel:DWORD dst_unused:UNUSED_PAD src0_sel:DWORD src1_sel:WORD_1
    s_waitcnt vmcnt(4)
    v_mfma_f32_4x4x4_16b_bf16 v[96:99], v[140:141], v[80:81], 0 cbsz:4 abid:1
    v_readlane_b32 s57, v164, 9
    v_mfma_f32_4x4x4_16b_bf16 v[100:103], v[140:141], v[82:83], 0 cbsz:4 abid:1
    v_lshlrev_b32_sdwa v139, v15, v125 dst_sel:DWORD dst_unused:UNUSED_PAD src0_sel:DWORD src1_sel:WORD_1
    ds_read_u16_d16_hi v130, v138 offset:32768
    ds_read_u16_d16_hi v131, v139 offset:32768
    s_and_b32 s33, s57, s34
    buffer_load_dwordx4 v[68:71], v1, s[12:15], s33 offen
    s_set_gpr_idx_on s51, 0xc
    v_pk_fma_f32 v[16:17], v[132:133], v[104:105], v[16:17] op_sel:[1,0,0] op_sel_hi:[1,1,1]
    v_pk_fma_f32 v[18:19], v[132:133], v[106:107], v[18:19] op_sel:[1,0,0] op_sel_hi:[1,1,1]
    v_pk_fma_f32 v[20:21], v[134:135], v[108:109], v[20:21] op_sel:[1,0,0] op_sel_hi:[1,1,1]
    v_pk_fma_f32 v[22:23], v[134:135], v[110:111], v[22:23] op_sel:[1,0,0] op_sel_hi:[1,1,1]
    s_set_gpr_idx_off
A_4:
    s_sub_u32 s31, s31, 4
    s_cbranch_scc1 B_4
    v_mfma_f32_4x4x4_16b_bf16 v[116:119], v[172:173], v[178:179], 0 cbsz:4 abid:2
    v_lshlrev_b32_sdwa v136, v15, v122 dst_sel:DWORD dst_unused:UNUSED_PAD src0_sel:DWORD src1_sel:WORD_1
    s_waitcnt vmcnt(4)
    v_mfma_f32_4x4x4_16b_bf16 v[104:107], v[142:143], v[84:85], 0 cbsz:4 abid:1
    v_readlane_b32 s58, v164, 10
    v_mfma_f32_4x4x4_16b_bf16 v[108:111], v[142:143], v[86:87], 0 cbsz:4 abid:1
    v_lshlrev_b32_sdwa v137, v15, v123 dst_sel:DWORD dst_unused:UNUSED_PAD src0_sel:DWORD src1_sel:WORD_1
    ds_read_u16_d16_hi v132, v136 offset:32768
    ds_read_u16_d16_hi v133, v137 offset:32768
    s_and_b32 s33, s58, s34
    buffer_load_dwordx4 v[72:75], v1, s[12:15], s33 offen
    s_waitcnt lgkmcnt(2)
    s_set_gpr_idx_on s52, 0xc
    v_pk_fma_f32 v[16:17], v[128:129], v[96:97], v[16:17] op_sel:[0,0,0] op_sel_hi:[0,1,1]
    v_pk_fma_f32 v[18:19], v[128:129], v[98:99], v[18:19] op_sel:[0,0,0] op_sel_hi:[0,1,1]
    v_pk_fma_f32 v[20:21], v[130:131], v[100:101], v[20:21] op_sel:[0,0,0] op_sel_hi:[0,1,1]
    v_pk_fma_f32 v[22:23], v[130:131], v[102:103], v[22:23] op_sel:[0,0,0] op_sel_hi:[0,1,1]
    s_set_gpr_idx_off
    v_lshlrev_b32_sdwa v138, v15, v126 dst_sel:DWORD dst_unused:UNUSED_PAD src0_sel:DWORD src1_sel:WORD_1
    s_waitcnt vmcnt(4)
    v_mfma_f32_4x4x4_16b_bf16 v[96:99], v[144:145], v[88:89], 0 cbsz:4 abid:1
    v_readlane_b32 s59, v164, 11
    v_mfma_f32_4x4x4_16b_bf16 v[100:103], v[144:145], v[90:91], 0 cbsz:4 abid:1
    v_lshlrev_b32_sdwa v139, v15, v127 dst_sel:DWORD dst_unused:UNUSED_PAD src0_sel:DWORD src1_sel:WORD_1
    ds_read_u16_d16_hi v134, v138 offset:32768
    ds_read_u16_d16_hi v135, v139 offset:32768
    s_and_b32 s33, s59, s34
    buffer_load_dwordx4 v[76:79], v1, s[12:15], s33 offen
    s_set_gpr_idx_on s53, 0xc
    v_pk_fma_f32 v[16:17], v[128:129], v[104:105], v[16:17] op_sel:[1,0,0] op_sel_hi:[1,1,1]
    v_pk_fma_f32 v[18:19], v[128:129], v[106:107], v[18:19] op_sel:[1,0,0] op_sel_hi:[1,1,1]
    v_pk_fma_f32 v[20:21], v[130:131], v[108:109], v[20:21] op_sel:[1,0,0] op_sel_hi:[1,1,1]
    v_pk_fma_f32 v[22:23], v[130:131], v[110:111], v[22:23] op_sel:[1,0,0] op_sel_hi:[1,1,1]
    s_set_gpr_idx_off
    v_mfma_f32_4x4x4_16b_bf16 v[120:123], v[172:173], v[176:177], 0 cbsz:4 abid:3
    v_lshlrev_b32_sdwa v136, v15, v112 dst_sel:DWORD dst_unused:UNUSED_PAD src0_sel:DWORD src1_sel:WORD_1
    s_waitcnt vmcnt(4)
    v_mfma_f32_4x4x4_16b_bf16 v[104:107], v[146:147], v[92:93], 0 cbsz:4 abid:1
    v_readlane_b32 s60, v164, 12
    v_mfma_f32_4x4x4_16b_bf16 v[108:111], v[146:147], v[94:95], 0 cbsz:4 abid:1
    v_lshlrev_b32_sdwa v137, v15, v113 dst_sel:DWORD dst_unused:UNUSED_PAD src0_sel:DWORD src1_sel:WORD_1
    ds_read_u16_d16_hi v128, v136 offset:32768
    ds_read_u16_d16_hi v129, v137 offset:32768
    s_and_b32 s33, s60, s34
    buffer_load_dwordx4 v[80:83], v1, s[12:15], s33 offen
    s_waitcnt lgkmcnt(2)
    s_set_gpr_idx_on s54, 0xc
    v_pk_fma_f32 v[16:17], v[132:133], v[96:97], v[16:17] op_sel:[0,0,0] op_sel_hi:[0,1,1]
    v_pk_fma_f32 v[18:19], v[132:133], v[98:99], v[18:19] op_sel:[0,0,0] op_sel_hi:[0,1,1]
    v_pk_fma_f32 v[20:21], v[134:135], v[100:101], v[20:21] op_sel:[0,0,0] op_sel_hi:[0,1,1]
    v_pk_fma_f32 v[22:23], v[134:135], v[102:103], v[22:23] op_sel:[0,0,0] op_sel_hi:[0,1,1]
    s_set_gpr_idx_off
    v_lshlrev_b32_sdwa v138, v15, v116 dst_sel:DWORD dst_unused:UNUSED_PAD src0_sel:DWORD src1_sel:WORD_1
    s_waitcnt vmcnt(4)
    v_mfma_f32_4x4x4_16b_bf16 v[96:99], v[140:141], v[64:65], 0 cbsz:4 abid:2
    v_readlane_b32 s61, v164, 13
    v_mfma_f32_4x4x4_16b_bf16 v[100:103], v[140:141], v[66:67], 0 cbsz:4 abid:2
    v_lshlrev_b32_sdwa v139, v15, v117 dst_sel:DWORD dst_unused:UNUSED_PAD src0_sel:DWORD src1_sel:WORD_1
    ds_read_u16_d16_hi v130, v138 offset:32768
    ds_read_u16_d16_hi v131, v139 offset:32768
    s_and_b32 s33, s61, s34
    buffer_load_dwordx4 v[84:87], v1, s[12:15], s33 offen
    s_set_gpr_idx_on s55, 0xc
    v_pk_fma_f32 v[16:17], v[132:133], v[104:105], v[16:17] op_sel:[1,0,0] op_sel_hi:[1,1,1]
    v_pk_fma_f32 v[18:19], v[132:133], v[106:107], v[18:19] op_sel:[1,0,0] op_sel_hi:[1,1,1]
    v_pk_fma_f32 v[20:21], v[134:135], v[108:109], v[20:21] op_sel:[1,0,0] op_sel_hi:[1,1,1]
    v_pk_fma_f32 v[22:23], v[134:135], v[110:111], v[22:23] op_sel:[1,0,0] op_sel_hi:[1,1,1]
    s_set_gpr_idx_off
A_8:
    s_sub_u32 s31, s31, 4
    s_cbranch_scc1 B_8
    v_mfma_f32_4x4x4_16b_bf16 v[124:127], v[172:173], v[178:179], 0 cbsz:4 abid:3
    v_lshlrev_b32_sdwa v136, v15, v114 dst_sel:DWORD dst_unused:UNUSED_PAD src0_sel:DWORD src1_sel:WORD_1
    s_waitcnt vmcnt(4)
    v_mfma_f32_4x4x4_16b_bf16 v[104:107], v[142:143], v[68:69], 0 cbsz:4 abid:2
    v_readlane_b32 s62, v164, 14
    v_mfma_f32_4x4x4_16b_bf16 v[108:111], v[142:143], v[70:71], 0 cbsz:4 abid:2
    v_lshlrev_b32_sdwa v137, v15, v115 dst_sel:DWORD dst_unused:UNUSED_PAD src0_sel:DWORD src1_sel:WORD_1
    ds_read_u16_d16_hi v132, v136 offset:32768
    ds_read_u16_d16_hi v133, v137 offset:32768
    s_and_b32 s33, s62, s34
    buffer_load_dwordx4 v[88:91], v1, s[12:15], s33 offen
    s_waitcnt lgkmcnt(2)
    s_set_gpr_idx_on s56, 0xc
    v_pk_fma_f32 v[16:17], v[128:129], v[96:97], v[16:17] op_sel:[0,0,0] op_sel_hi:[0,1,1]
    v_pk_fma_f32 v[18:19], v[128:129], v[98:99], v[18:19] op_sel:[0,0,0] op_sel_hi:[0,1,1]
    v_pk_fma_f32 v[20:21], v[130:131], v[100:101], v[20:21] op_sel:[0,0,0] op_sel_hi:[0,1,1]
    v_pk_fma_f32 v[22:23], v[130:131], v[102:103], v[22:23] op_sel:[0,0,0] op_sel_hi:[0,1,1]
    s_set_gpr_idx_off
    ds_read_b32 v165, v5
    v_lshlrev_b32_sdwa v138, v15, v118 dst_sel:DWORD dst_unused:UNUSED_PAD src0_sel:DWORD src1_sel:WORD_1
    s_waitcnt vmcnt(4)
    v_mfma_f32_4x4x4_16b_bf16 v[96:99], v[144:145], v[72:73], 0 cbsz:4 abid:2
    v_readlane_b32 s63, v164, 15
    v_mfma_f32_4x4x4_16b_bf16 v[100:103], v[144:145], v[74:75], 0 cbsz:4 abid:2
    v_lshlrev_b32_sdwa v139, v15, v119 dst_sel:DWORD dst_unused:UNUSED_PAD src0_sel:DWORD src1_sel:WORD_1
    ds_read_u16_d16_hi v134, v138 offset:32768
    ds_read_u16_d16_hi v135, v139 offset:32768
    s_and_b32 s33, s63, s34
    buffer_load_dwordx4 v[92:95], v1, s[12:15], s33 offen
    s_set_gpr_idx_on s57, 0xc
    v_pk_fma_f32 v[16:17], v[128:129], v[104:105], v[16:17] op_sel:[1,0,0] op_sel_hi:[1,1,1]
    v_pk_fma_f32 v[18:19], v[128:129], v[106:107], v[18:19] op_sel:[1,0,0] op_sel_hi:[1,1,1]
    v_pk_fma_f32 v[20:21], v[130:131], v[108:109], v[20:21] op_sel:[1,0,0] op_sel_hi:[1,1,1]
    v_pk_fma_f32 v[22:23], v[130:131], v[110:111], v[22:23] op_sel:[1,0,0] op_sel_hi:[1,1,1]
    s_set_gpr_idx_off
    v_mfma_f32_4x4x4_16b_bf16 v[112:115], v[172:173], v[176:177], 0 cbsz:4 abid:4
    v_lshlrev_b32_sdwa v136, v15, v120 dst_sel:DWORD dst_unused:UNUSED_PAD src0_sel:DWORD src1_sel:WORD_1
    s_waitcnt vmcnt(4)
    v_mfma_f32_4x4x4_16b_bf16 v[104:107], v[146:147], v[76:77], 0 cbsz:4 abid:2
    v_readlane_b32 s48, v164, 16
    v_mfma_f32_4x4x4_16b_bf16 v[108:111], v[146:147], v[78:79], 0 cbsz:4 abid:2
    v_lshlrev_b32_sdwa v137, v15, v121 dst_sel:DWORD dst_unused:UNUSED_PAD src0_sel:DWORD src1_sel:WORD_1
    ds_read_u16_d16_hi v128, v136 offset:32768
    ds_read_u16_d16_hi v129, v137 offset:32768
    s_and_b32 s33, s48, s34
    buffer_load_dwordx4 v[64:67], v1, s[12:15], s33 offen
    s_waitcnt lgkmcnt(2)
    s_set_gpr_idx_on s58, 0xc
    v_pk_fma_f32 v[16:17], v[132:133], v[96:97], v[16:17] op_sel:[0,0,0] op_sel_hi:[0,1,1]
    v_pk_fma_f32 v[18:19], v[132:133], v[98:99], v[18:19] op_sel:[0,0,0] op_sel_hi:[0,1,1]
    v_pk_fma_f32 v[20:21], v[134:135], v[100:101], v[20:21] op_sel:[0,0,0] op_sel_hi:[0,1,1]
    v_pk_fma_f32 v[22:23], v[134:135], v[102:103], v[22:23] op_sel:[0,0,0] op_sel_hi:[0,1,1]
    s_set_gpr_idx_off
    v_lshlrev_b32_sdwa v138, v15, v124 dst_sel:DWORD dst_unused:UNUSED_PAD src0_sel:DWORD src1_sel:WORD_1
    s_waitcnt vmcnt(4)
    v_mfma_f32_4x4x4_16b_bf16 v[96:99], v[140:141], v[80:81], 0 cbsz:4 abid:3
    v_readlane_b32 s49, v164, 17
    v_mfma_f32_4x4x4_16b_bf16 v[100:103], v[140:141], v[82:83], 0 cbsz:4 abid:3
    v_lshlrev_b32_sdwa v139, v15, v125 dst_sel:DWORD dst_unused:UNUSED_PAD src0_sel:DWORD src1_sel:WORD_1
    ds_read_u16_d16_hi v130, v138 offset:32768
    ds_read_u16_d16_hi v131, v139 offset:32768
    s_and_b32 s33, s49, s34
    buffer_load_dwordx4 v[68:71], v1, s[12:15], s33 offen
    s_set_gpr_idx_on s59, 0xc
    v_pk_fma_f32 v[16:17], v[132:133], v[104:105], v[16:17] op_sel:[1,0,0] op_sel_hi:[1,1,1]
    v_pk_fma_f32 v[18:19], v[132:133], v[106:107], v[18:19] op_sel:[1,0,0] op_sel_hi:[1,1,1]
    v_pk_fma_f32 v[20:21], v[134:135], v[108:109], v[20:21] op_sel:[1,0,0] op_sel_hi:[1,1,1]
    v_pk_fma_f32 v[22:23], v[134:135], v[110:111], v[22:23] op_sel:[1,0,0] op_sel_hi:[1,1,1]
    s_set_gpr_idx_off
A_12:
    s_sub_u32 s31, s31, 4
    s_cbranch_scc1 B_12
    v_mfma_f32_4x4x4_16b_bf16 v[116:119], v[172:173], v[178:179], 0 cbsz:4 abid:4
    v_lshlrev_b32_sdwa v136, v15, v122 dst_sel:DWORD dst_unused:UNUSED_PAD src0_sel:DWORD src1_sel:WORD_1
    s_waitcnt vmcnt(4)
    v_mfma_f32_4x4x4_16b_bf16 v[104:107], v[142:143], v[84:85], 0 cbsz:4 abid:3
    v_readlane_b32 s50, v164, 18
    v_mfma_f32_4x4x4_16b_bf16 v[108:111], v[142:143], v[86:87], 0 cbsz:4 abid:3
    v_lshlrev_b32_sdwa v137, v15, v123 dst_sel:DWORD dst_unused:UNUSED_PAD src0_sel:DWORD src1_sel:WORD_1
    ds_read_u16_d16_hi v132, v136 offset:32768
    ds_read_u16_d16_hi v133, v137 offset:32768
    s_and_b32 s33, s50, s34
    buffer_load_dwordx4 v[72:75], v1, s[12:15], s33 offen
    s_waitcnt lgkmcnt(2)
    s_set_gpr_idx_on s60, 0xc
    v_pk_fma_f32 v[16:17], v[128:129], v[96:97], v[16:17] op_sel:[0,0,0] op_sel_hi:[0,1,1]
    v_pk_fma_f32 v[18:19], v[128:129], v[98:99], v[18:19] op_sel:[0,0,0] op_sel_hi:[0,1,1]
    v_pk_fma_f32 v[20:21], v[130:131], v[100:101], v[20:21] op_sel:[0,0,0] op_sel_hi:[0,1,1]
    v_pk_fma_f32 v[22:23], v[130:131], v[102:103], v[22:23] op_sel:[0,0,0] op_sel_hi:[0,1,1]
    s_set_gpr_idx_off
    v_cmp_gt_u32 vcc, s30, v6
    v_add_u32 v6, 64, v6
    v_add_u32 v5, 256, v5
    v_cndmask_b32 v165, 40, v165, vcc
    v_lshrrev_b32 v8, 21, v165
    v_lshlrev_b32 v8, 4, v8
    v_lshlrev_b32 v9, 3, v165
    ds_read_b128 v[168:171], v8 offset:8192
    v_and_b32 v9, 0xfffc00, v9
    v_and_or_b32 v165, v165, 56, v9
    v_lshlrev_b32_sdwa v138, v15, v126 dst_sel:DWORD dst_unused:UNUSED_PAD src0_sel:DWORD src1_sel:WORD_1
    s_waitcnt vmcnt(4)
    v_mfma_f32_4x4x4_16b_bf16 v[96:99], v[144:145], v[88:89], 0 cbsz:4 abid:3
    v_readlane_b32 s51, v164, 19
    v_mfma_f32_4x4x4_16b_bf16 v[100:103], v[144:145], v[90:91], 0 cbsz:4 abid:3
    v_lshlrev_b32_sdwa v139, v15, v127 dst_sel:DWORD dst_unused:UNUSED_PAD src0_sel:DWORD src1_sel:WORD_1
    ds_read_u16_d16_hi v134, v138 offset:32768
    ds_read_u16_d16_hi v135, v139 offset:32768
    s_and_b32 s33, s51, s34
    buffer_load_dwordx4 v[76:79], v1, s[12:15], s33 offen
    s_set_gpr_idx_on s61, 0xc
    v_pk_fma_f32 v[16:17], v[128:129], v[104:105], v[16:17] op_sel:[1,0,0] op_sel_hi:[1,1,1]
    v_pk_fma_f32 v[18:19], v[128:129], v[106:107], v[18:19] op_sel:[1,0,0] op_sel_hi:[1,1,1]
    v_pk_fma_f32 v[20:21], v[130:131], v[108:109], v[20:21] op_sel:[1,0,0] op_sel_hi:[1,1,1]
    v_pk_fma_f32 v[22:23], v[130:131], v[110:111], v[22:23] op_sel:[1,0,0] op_sel_hi:[1,1,1]
    s_set_gpr_idx_off
    v_mfma_f32_4x4x4_16b_bf16 v[120:123], v[172:173], v[176:177], 0 cbsz:4 abid:5
    v_lshlrev_b32_sdwa v136, v15, v112 dst_sel:DWORD dst_unused:UNUSED_PAD src0_sel:DWORD src1_sel:WORD_1
    s_waitcnt vmcnt(4)
    v_mfma_f32_4x4x4_16b_bf16 v[104:107], v[146:147], v[92:93], 0 cbsz:4 abid:3
    v_readlane_b32 s52, v164, 20
    v_mfma_f32_4x4x4_16b_bf16 v[108:111], v[146:147], v[94:95], 0 cbsz:4 abid:3
    v_lshlrev_b32_sdwa v137, v15, v113 dst_sel:DWORD dst_unused:UNUSED_PAD src0_sel:DWORD src1_sel:WORD_1
    ds_read_u16_d16_hi v128, v136 offset:32768
    ds_read_u16_d16_hi v129, v137 offset:32768
    s_and_b32 s33, s52, s34
    buffer_load_dwordx4 v[80:83], v1, s[12:15], s33 offen
    s_waitcnt lgkmcnt(2)
    s_set_gpr_idx_on s62, 0xc
    v_pk_fma_f32 v[16:17], v[132:133], v[96:97], v[16:17] op_sel:[0,0,0] op_sel_hi:[0,1,1]
    v_pk_fma_f32 v[18:19], v[132:133], v[98:99], v[18:19] op_sel:[0,0,0] op_sel_hi:[0,1,1]
    v_pk_fma_f32 v[20:21], v[134:135], v[100:101], v[20:21] op_sel:[0,0,0] op_sel_hi:[0,1,1]
    v_pk_fma_f32 v[22:23], v[134:135], v[102:103], v[22:23] op_sel:[0,0,0] op_sel_hi:[0,1,1]
    s_set_gpr_idx_off
    v_lshlrev_b32_sdwa v138, v15, v116 dst_sel:DWORD dst_unused:UNUSED_PAD src0_sel:DWORD src1_sel:WORD_1
    s_waitcnt vmcnt(4)
    v_mfma_f32_4x4x4_16b_bf16 v[96:99], v[140:141], v[64:65], 0 cbsz:4 abid:4
    v_readlane_b32 s53, v164, 21
    v_mfma_f32_4x4x4_16b_bf16 v[100:103], v[140:141], v[66:67], 0 cbsz:4 abid:4
    v_lshlrev_b32_sdwa v139, v15, v117 dst_sel:DWORD dst_unused:UNUSED_PAD src0_sel:DWORD src1_sel:WORD_1
    ds_read_u16_d16_hi v130, v138 offset:32768
    ds_read_u16_d16_hi v131, v139 offset:32768
    s_and_b32 s33, s53, s34
    buffer_load_dwordx4 v[84:87], v1, s[12:15], s33 offen
    s_set_gpr_idx_on s63, 0xc
    v_pk_fma_f32 v[16:17], v[132:133], v[104:105], v[16:17] op_sel:[1,0,0] op_sel_hi:[1,1,1]
    v_pk_fma_f32 v[18:19], v[132:133], v[106:107], v[18:19] op_sel:[1,0,0] op_sel_hi:[1,1,1]
    v_pk_fma_f32 v[20:21], v[134:135], v[108:109], v[20:21] op_sel:[1,0,0] op_sel_hi:[1,1,1]
    v_pk_fma_f32 v[22:23], v[134:135], v[110:111], v[22:23] op_sel:[1,0,0] op_sel_hi:[1,1,1]
    s_set_gpr_idx_off
A_16:
    s_sub_u32 s31, s31, 4
    s_cbranch_scc1 B_16
    v_mfma_f32_4x4x4_16b_bf16 v[124:127], v[172:173], v[178:179], 0 cbsz:4 abid:5
    v_lshlrev_b32_sdwa v136, v15, v114 dst_sel:DWORD dst_unused:UNUSED_PAD src0_sel:DWORD src1_sel:WORD_1
    s_waitcnt vmcnt(4)
    v_mfma_f32_4x4x4_16b_bf16 v[104:107], v[142:143], v[68:69], 0 cbsz:4 abid:4
    v_readlane_b32 s54, v164, 22
    v_mfma_f32_4x4x4_16b_bf16 v[108:111], v[142:143], v[70:71], 0 cbsz:4 abid:4
    v_lshlrev_b32_sdwa v137, v15, v115 dst_sel:DWORD dst_unused:UNUSED_PAD src0_sel:DWORD src1_sel:WORD_1
    ds_read_u16_d16_hi v132, v136 offset:32768
    ds_read_u16_d16_hi v133, v137 offset:32768
    s_and_b32 s33, s54, s34
    buffer_load_dwordx4 v[88:91], v1, s[12:15], s33 offen
    s_waitcnt lgkmcnt(2)
    s_set_gpr_idx_on s48, 0xc
    v_pk_fma_f32 v[16:17], v[128:129], v[96:97], v[16:17] op_sel:[0,0,0] op_sel_hi:[0,1,1]
    v_pk_fma_f32 v[18:19], v[128:129], v[98:99], v[18:19] op_sel:[0,0,0] op_sel_hi:[0,1,1]
    v_pk_fma_f32 v[20:21], v[130:131], v[100:101], v[20:21] op_sel:[0,0,0] op_sel_hi:[0,1,1]
    v_pk_fma_f32 v[22:23], v[130:131], v[102:103], v[22:23] op_sel:[0,0,0] op_sel_hi:[0,1,1]
    s_set_gpr_idx_off
    v_lshlrev_b32_sdwa v138, v15, v118 dst_sel:DWORD dst_unused:UNUSED_PAD src0_sel:DWORD src1_sel:WORD_1
    s_waitcnt vmcnt(4)
    v_mfma_f32_4x4x4_16b_bf16 v[96:99], v[144:145], v[72:73], 0 cbsz:4 abid:4
    v_readlane_b32 s55, v164, 23
    v_mfma_f32_4x4x4_16b_bf16 v[100:103], v[144:145], v[74:75], 0 cbsz:4 abid:4
    v_lshlrev_b32_sdwa v139, v15, v119 dst_sel:DWORD dst_unused:UNUSED_PAD src0_sel:DWORD src1_sel:WORD_1
    ds_read_u16_d16_hi v134, v138 offset:32768
    ds_read_u16_d16_hi v135, v139 offset:32768
    s_and_b32 s33, s55, s34
    buffer_load_dwordx4 v[92:95], v1, s[12:15], s33 offen
    s_set_gpr_idx_on s49, 0xc
    v_pk_fma_f32 v[16:17], v[128:129], v[104:105], v[16:17] op_sel:[1,0,0] op_sel_hi:[1,1,1]
    v_pk_fma_f32 v[18:19], v[128:129], v[106:107], v[18:19] op_sel:[1,0,0] op_sel_hi:[1,1,1]
    v_pk_fma_f32 v[20:21], v[130:131], v[108:109], v[20:21] op_sel:[1,0,0] op_sel_hi:[1,1,1]
    v_pk_fma_f32 v[22:23], v[130:131], v[110:111], v[22:23] op_sel:[1,0,0] op_sel_hi:[1,1,1]
    s_set_gpr_idx_off
    v_mfma_f32_4x4x4_16b_bf16 v[112:115], v[172:173], v[176:177], 0 cbsz:4 abid:6
    v_lshlrev_b32_sdwa v136, v15, v120 dst_sel:DWORD dst_unused:UNUSED_PAD src0_sel:DWORD src1_sel:WORD_1
    s_waitcnt vmcnt(4)
    v_mfma_f32_4x4x4_16b_bf16 v[104:107], v[146:147], v[76:77], 0 cbsz:4 abid:4
    v_readlane_b32 s56, v164, 24
    v_mfma_f32_4x4x4_16b_bf16 v[108:111], v[146:147], v[78:79], 0 cbsz:4 abid:4
    v_lshlrev_b32_sdwa v137, v15, v121 dst_sel:DWORD dst_unused:UNUSED_PAD src0_sel:DWORD src1_sel:WORD_1
    ds_read_u16_d16_hi v128, v136 offset:32768
    ds_read_u16_d16_hi v129, v137 offset:32768
    s_and_b32 s33, s56, s34
    buffer_load_dwordx4 v[64:67], v1, s[12:15], s33 offen
    s_waitcnt lgkmcnt(2)
    s_set_gpr_idx_on s50, 0xc
    v_pk_fma_f32 v[16:17], v[132:133], v[96:97], v[16:17] op_sel:[0,0,0] op_sel_hi:[0,1,1]
    v_pk_fma_f32 v[18:19], v[132:133], v[98:99], v[18:19] op_sel:[0,0,0] op_sel_hi:[0,1,1]
    v_pk_fma_f32 v[20:21], v[134:135], v[100:101], v[20:21] op_sel:[0,0,0] op_sel_hi:[0,1,1]
    v_pk_fma_f32 v[22:23], v[134:135], v[102:103], v[22:23] op_sel:[0,0,0] op_sel_hi:[0,1,1]
    s_set_gpr_idx_off
    v_lshlrev_b32_sdwa v138, v15, v124 dst_sel:DWORD dst_unused:UNUSED_PAD src0_sel:DWORD src1_sel:WORD_1
    s_waitcnt vmcnt(4)
    v_mfma_f32_4x4x4_16b_bf16 v[96:99], v[140:141], v[80:81], 0 cbsz:4 abid:5
    v_readlane_b32 s57, v164, 25
    v_mfma_f32_4x4x4_16b_bf16 v[100:103], v[140:141], v[82:83], 0 cbsz:4 abid:5
    v_lshlrev_b32_sdwa v139, v15, v125 dst_sel:DWORD dst_unused:UNUSED_PAD src0_sel:DWORD src1_sel:WORD_1
    ds_read_u16_d16_hi v130, v138 offset:32768
    ds_read_u16_d16_hi v131, v139 offset:32768
    s_and_b32 s33, s57, s34
    buffer_load_dwordx4 v[68:71], v1, s[12:15], s33 offen
    s_set_gpr_idx_on s51, 0xc
    v_pk_fma_f32 v[16:17], v[132:133], v[104:105], v[16:17] op_sel:[1,0,0] op_sel_hi:[1,1,1]
    v_pk_fma_f32 v[18:19], v[132:133], v[106:107], v[18:19] op_sel:[1,0,0] op_sel_hi:[1,1,1]
    v_pk_fma_f32 v[20:21], v[134:135], v[108:109], v[20:21] op_sel:[1,0,0] op_sel_hi:[1,1,1]
    v_pk_fma_f32 v[22:23], v[134:135], v[110:111], v[22:23] op_sel:[1,0,0] op_sel_hi:[1,1,1]
    s_set_gpr_idx_off
A_20:
    s_sub_u32 s31, s31, 4
    s_cbranch_scc1 B_20
    v_mfma_f32_4x4x4_16b_bf16 v[116:119], v[172:173], v[178:179], 0 cbsz:4 abid:6
    v_lshlrev_b32_sdwa v136, v15, v122 dst_sel:DWORD dst_unused:UNUSED_PAD src0_sel:DWORD src1_sel:WORD_1
    s_waitcnt vmcnt(4)
    v_mfma_f32_4x4x4_16b_bf16 v[104:107], v[142:143], v[84:85], 0 cbsz:4 abid:5
    v_readlane_b32 s58, v164, 26
    v_mfma_f32_4x4x4_16b_bf16 v[108:111], v[142:143], v[86:87], 0 cbsz:4 abid:5
    v_lshlrev_b32_sdwa v137, v15, v123 dst_sel:DWORD dst_unused:UNUSED_PAD src0_sel:DWORD src1_sel:WORD_1
    ds_read_u16_d16_hi v132, v136 offset:32768
    ds_read_u16_d16_hi v133, v137 offset:32768
    s_and_b32 s33, s58, s34
    buffer_load_dwordx4 v[72:75], v1, s[12:15], s33 offen
    s_waitcnt lgkmcnt(2)
    s_set_gpr_idx_on s52, 0xc
    v_pk_fma_f32 v[16:17], v[128:129], v[96:97], v[16:17] op_sel:[0,0,0] op_sel_hi:[0,1,1]
    v_pk_fma_f32 v[18:19], v[128:129], v[98:99], v[18:19] op_sel:[0,0,0] op_sel_hi:[0,1,1]
    v_pk_fma_f32 v[20:21], v[130:131], v[100:101], v[20:21] op_sel:[0,0,0] op_sel_hi:[0,1,1]
    v_pk_fma_f32 v[22:23], v[130:131], v[102:103], v[22:23] op_sel:[0,0,0] op_sel_hi:[0,1,1]
    s_set_gpr_idx_off
    v_lshlrev_b32_sdwa v138, v15, v126 dst_sel:DWORD dst_unused:UNUSED_PAD src0_sel:DWORD src1_sel:WORD_1
    s_waitcnt vmcnt(4)
    v_mfma_f32_4x4x4_16b_bf16 v[96:99], v[144:145], v[88:89], 0 cbsz:4 abid:5
    v_readlane_b32 s59, v164, 27
    v_mfma_f32_4x4x4_16b_bf16 v[100:103], v[144:145], v[90:91], 0 cbsz:4 abid:5
    v_lshlrev_b32_sdwa v139, v15, v127 dst_sel:DWORD dst_unused:UNUSED_PAD src0_sel:DWORD src1_sel:WORD_1
    ds_read_u16_d16_hi v134, v138 offset:32768
    ds_read_u16_d16_hi v135, v139 offset:32768
    s_and_b32 s33, s59, s34
    buffer_load_dwordx4 v[76:79], v1, s[12:15], s33 offen
    s_set_gpr_idx_on s53, 0xc
    v_pk_fma_f32 v[16:17], v[128:129], v[104:105], v[16:17] op_sel:[1,0,0] op_sel_hi:[1,1,1]
    v_pk_fma_f32 v[18:19], v[128:129], v[106:107], v[18:19] op_sel:[1,0,0] op_sel_hi:[1,1,1]
    v_pk_fma_f32 v[20:21], v[130:131], v[108:109], v[20:21] op_sel:[1,0,0] op_sel_hi:[1,1,1]
    v_pk_fma_f32 v[22:23], v[130:131], v[110:111], v[22:23] op_sel:[1,0,0] op_sel_hi:[1,1,1]
    s_set_gpr_idx_off
    v_mfma_f32_4x4x4_16b_bf16 v[120:123], v[172:173], v[176:177], 0 cbsz:4 abid:7
    v_lshlrev_b32_sdwa v136, v15, v112 dst_sel:DWORD dst_unused:UNUSED_PAD src0_sel:DWORD src1_sel:WORD_1
    s_waitcnt vmcnt(4)
    v_mfma_f32_4x4x4_16b_bf16 v[104:107], v[146:147], v[92:93], 0 cbsz:4 abid:5
    v_readlane_b32 s60, v164, 28
    v_mfma_f32_4x4x4_16b_bf16 v[108:111], v[146:147], v[94:95], 0 cbsz:4 abid:5
    v_lshlrev_b32_sdwa v137, v15, v113 dst_sel:DWORD dst_unused:UNUSED_PAD src0_sel:DWORD src1_sel:WORD_1
    ds_read_u16_d16_hi v128, v136 offset:32768
    ds_read_u16_d16_hi v129, v137 offset:32768
    s_and_b32 s33, s60, s34
    buffer_load_dwordx4 v[80:83], v1, s[12:15], s33 offen
    s_waitcnt lgkmcnt(2)
    s_set_gpr_idx_on s54, 0xc
    v_pk_fma_f32 v[16:17], v[132:133], v[96:97], v[16:17] op_sel:[0,0,0] op_sel_hi:[0,1,1]
    v_pk_fma_f32 v[18:19], v[132:133], v[98:99], v[18:19] op_sel:[0,0,0] op_sel_hi:[0,1,1]
    v_pk_fma_f32 v[20:21], v[134:135], v[100:101], v[20:21] op_sel:[0,0,0] op_sel_hi:[0,1,1]
    v_pk_fma_f32 v[22:23], v[134:135], v[102:103], v[22:23] op_sel:[0,0,0] op_sel_hi:[0,1,1]
    s_set_gpr_idx_off
    v_lshlrev_b32_sdwa v138, v15, v116 dst_sel:DWORD dst_unused:UNUSED_PAD src0_sel:DWORD src1_sel:WORD_1
    s_waitcnt vmcnt(4)
    v_mfma_f32_4x4x4_16b_bf16 v[96:99], v[140:141], v[64:65], 0 cbsz:4 abid:6
    v_readlane_b32 s61, v164, 29
    v_mfma_f32_4x4x4_16b_bf16 v[100:103], v[140:141], v[66:67], 0 cbsz:4 abid:6
    v_lshlrev_b32_sdwa v139, v15, v117 dst_sel:DWORD dst_unused:UNUSED_PAD src0_sel:DWORD src1_sel:WORD_1
    ds_read_u16_d16_hi v130, v138 offset:32768
    ds_read_u16_d16_hi v131, v139 offset:32768
    s_and_b32 s33, s61, s34
    buffer_load_dwordx4 v[84:87], v1, s[12:15], s33 offen
    s_set_gpr_idx_on s55, 0xc
    v_pk_fma_f32 v[16:17], v[132:133], v[104:105], v[16:17] op_sel:[1,0,0] op_sel_hi:[1,1,1]
    v_pk_fma_f32 v[18:19], v[132:133], v[106:107], v[18:19] op_sel:[1,0,0] op_sel_hi:[1,1,1]
    v_pk_fma_f32 v[20:21], v[134:135], v[108:109], v[20:21] op_sel:[1,0,0] op_sel_hi:[1,1,1]
    v_pk_fma_f32 v[22:23], v[134:135], v[110:111], v[22:23] op_sel:[1,0,0] op_sel_hi:[1,1,1]
    s_set_gpr_idx_off
A_24:
    s_sub_u32 s31, s31, 4
    s_cbranch_scc1 B_24
    v_mfma_f32_4x4x4_16b_bf16 v[124:127], v[172:173], v[178:179], 0 cbsz:4 abid:7
    v_lshlrev_b32_sdwa v136, v15, v114 dst_sel:DWORD dst_unused:UNUSED_PAD src0_sel:DWORD src1_sel:WORD_1
    s_waitcnt vmcnt(4)
    v_mfma_f32_4x4x4_16b_bf16 v[104:107], v[142:143], v[68:69], 0 cbsz:4 abid:6
    v_readlane_b32 s62, v164, 30
    v_mfma_f32_4x4x4_16b_bf16 v[108:111], v[142:143], v[70:71], 0 cbsz:4 abid:6
    v_lshlrev_b32_sdwa v137, v15, v115 dst_sel:DWORD dst_unused:UNUSED_PAD src0_sel:DWORD src1_sel:WORD_1
    ds_read_u16_d16_hi v132, v136 offset:32768
    ds_read_u16_d16_hi v133, v137 offset:32768
    s_and_b32 s33, s62, s34
    buffer_load_dwordx4 v[88:91], v1, s[12:15], s33 offen
    s_waitcnt lgkmcnt(2)
    s_set_gpr_idx_on s56, 0xc
    v_pk_fma_f32 v[16:17], v[128:129], v[96:97], v[16:17] op_sel:[0,0,0] op_sel_hi:[0,1,1]
    v_pk_fma_f32 v[18:19], v[128:129], v[98:99], v[18:19] op_sel:[0,0,0] op_sel_hi:[0,1,1]
    v_pk_fma_f32 v[20:21], v[130:131], v[100:101], v[20:21] op_sel:[0,0,0] op_sel_hi:[0,1,1]
    v_pk_fma_f32 v[22:23], v[130:131], v[102:103], v[22:23] op_sel:[0,0,0] op_sel_hi:[0,1,1]
    s_set_gpr_idx_off
    v_lshlrev_b32_sdwa v138, v15, v118 dst_sel:DWORD dst_unused:UNUSED_PAD src0_sel:DWORD src1_sel:WORD_1
    s_waitcnt vmcnt(4)
    v_mfma_f32_4x4x4_16b_bf16 v[96:99], v[144:145], v[72:73], 0 cbsz:4 abid:6
    v_readlane_b32 s63, v164, 31
    v_mfma_f32_4x4x4_16b_bf16 v[100:103], v[144:145], v[74:75], 0 cbsz:4 abid:6
    v_lshlrev_b32_sdwa v139, v15, v119 dst_sel:DWORD dst_unused:UNUSED_PAD src0_sel:DWORD src1_sel:WORD_1
    ds_read_u16_d16_hi v134, v138 offset:32768
    ds_read_u16_d16_hi v135, v139 offset:32768
    s_and_b32 s33, s63, s34
    buffer_load_dwordx4 v[92:95], v1, s[12:15], s33 offen
    s_set_gpr_idx_on s57, 0xc
    v_pk_fma_f32 v[16:17], v[128:129], v[104:105], v[16:17] op_sel:[1,0,0] op_sel_hi:[1,1,1]
    v_pk_fma_f32 v[18:19], v[128:129], v[106:107], v[18:19] op_sel:[1,0,0] op_sel_hi:[1,1,1]
    v_pk_fma_f32 v[20:21], v[130:131], v[108:109], v[20:21] op_sel:[1,0,0] op_sel_hi:[1,1,1]
    v_pk_fma_f32 v[22:23], v[130:131], v[110:111], v[22:23] op_sel:[1,0,0] op_sel_hi:[1,1,1]
    s_set_gpr_idx_off
    v_mfma_f32_4x4x4_16b_bf16 v[112:115], v[172:173], v[176:177], 0 cbsz:4 abid:8
    v_lshlrev_b32_sdwa v136, v15, v120 dst_sel:DWORD dst_unused:UNUSED_PAD src0_sel:DWORD src1_sel:WORD_1
    s_waitcnt vmcnt(4)
    v_mfma_f32_4x4x4_16b_bf16 v[104:107], v[146:147], v[76:77], 0 cbsz:4 abid:6
    v_readlane_b32 s48, v164, 32
    v_mfma_f32_4x4x4_16b_bf16 v[108:111], v[146:147], v[78:79], 0 cbsz:4 abid:6
    v_lshlrev_b32_sdwa v137, v15, v121 dst_sel:DWORD dst_unused:UNUSED_PAD src0_sel:DWORD src1_sel:WORD_1
    ds_read_u16_d16_hi v128, v136 offset:32768
    ds_read_u16_d16_hi v129, v137 offset:32768
    s_and_b32 s33, s48, s34
    buffer_load_dwordx4 v[64:67], v1, s[12:15], s33 offen
    s_waitcnt lgkmcnt(2)
    s_set_gpr_idx_on s58, 0xc
    v_pk_fma_f32 v[16:17], v[132:133], v[96:97], v[16:17] op_sel:[0,0,0] op_sel_hi:[0,1,1]
    v_pk_fma_f32 v[18:19], v[132:133], v[98:99], v[18:19] op_sel:[0,0,0] op_sel_hi:[0,1,1]
    v_pk_fma_f32 v[20:21], v[134:135], v[100:101], v[20:21] op_sel:[0,0,0] op_sel_hi:[0,1,1]
    v_pk_fma_f32 v[22:23], v[134:135], v[102:103], v[22:23] op_sel:[0,0,0] op_sel_hi:[0,1,1]
    s_set_gpr_idx_off
    v_lshlrev_b32_sdwa v138, v15, v124 dst_sel:DWORD dst_unused:UNUSED_PAD src0_sel:DWORD src1_sel:WORD_1
    s_waitcnt vmcnt(4)
    v_mfma_f32_4x4x4_16b_bf16 v[96:99], v[140:141], v[80:81], 0 cbsz:4 abid:7
    v_readlane_b32 s49, v164, 33
    v_mfma_f32_4x4x4_16b_bf16 v[100:103], v[140:141], v[82:83], 0 cbsz:4 abid:7
    v_lshlrev_b32_sdwa v139, v15, v125 dst_sel:DWORD dst_unused:UNUSED_PAD src0_sel:DWORD src1_sel:WORD_1
    ds_read_u16_d16_hi v130, v138 offset:32768
    ds_read_u16_d16_hi v131, v139 offset:32768
    s_and_b32 s33, s49, s34
    buffer_load_dwordx4 v[68:71], v1, s[12:15], s33 offen
    s_set_gpr_idx_on s59, 0xc
    v_pk_fma_f32 v[16:17], v[132:133], v[104:105], v[16:17] op_sel:[1,0,0] op_sel_hi:[1,1,1]
    v_pk_fma_f32 v[18:19], v[132:133], v[106:107], v[18:19] op_sel:[1,0,0] op_sel_hi:[1,1,1]
    v_pk_fma_f32 v[20:21], v[134:135], v[108:109], v[20:21] op_sel:[1,0,0] op_sel_hi:[1,1,1]
    v_pk_fma_f32 v[22:23], v[134:135], v[110:111], v[22:23] op_sel:[1,0,0] op_sel_hi:[1,1,1]
    s_set_gpr_idx_off
A_28:
    s_sub_u32 s31, s31, 4
    s_cbranch_scc1 B_28
    v_mfma_f32_4x4x4_16b_bf16 v[116:119], v[172:173], v[178:179], 0 cbsz:4 abid:8
    v_lshlrev_b32_sdwa v136, v15, v122 dst_sel:DWORD dst_unused:UNUSED_PAD src0_sel:DWORD src1_sel:WORD_1
    s_waitcnt vmcnt(4)
    v_mfma_f32_4x4x4_16b_bf16 v[104:107], v[142:143], v[84:85], 0 cbsz:4 abid:7
    v_readlane_b32 s50, v164, 34
    v_mfma_f32_4x4x4_16b_bf16 v[108:111], v[142:143], v[86:87], 0 cbsz:4 abid:7
    v_lshlrev_b32_sdwa v137, v15, v123 dst_sel:DWORD dst_unused:UNUSED_PAD src0_sel:DWORD src1_sel:WORD_1
    ds_read_u16_d16_hi v132, v136 offset:32768
    ds_read_u16_d16_hi v133, v137 offset:32768
    s_and_b32 s33, s50, s34
    buffer_load_dwordx4 v[72:75], v1, s[12:15], s33 offen
    s_waitcnt lgkmcnt(2)
    s_set_gpr_idx_on s60, 0xc
    v_pk_fma_f32 v[16:17], v[128:129], v[96:97], v[16:17] op_sel:[0,0,0] op_sel_hi:[0,1,1]
    v_pk_fma_f32 v[18:19], v[128:129], v[98:99], v[18:19] op_sel:[0,0,0] op_sel_hi:[0,1,1]
    v_pk_fma_f32 v[20:21], v[130:131], v[100:101], v[20:21] op_sel:[0,0,0] op_sel_hi:[0,1,1]
    v_pk_fma_f32 v[22:23], v[130:131], v[102:103], v[22:23] op_sel:[0,0,0] op_sel_hi:[0,1,1]
    s_set_gpr_idx_off
    v_lshlrev_b32_sdwa v138, v15, v126 dst_sel:DWORD dst_unused:UNUSED_PAD src0_sel:DWORD src1_sel:WORD_1
    s_waitcnt vmcnt(4)
    v_mfma_f32_4x4x4_16b_bf16 v[96:99], v[144:145], v[88:89], 0 cbsz:4 abid:7
    v_readlane_b32 s51, v164, 35
    v_mfma_f32_4x4x4_16b_bf16 v[100:103], v[144:145], v[90:91], 0 cbsz:4 abid:7
    v_lshlrev_b32_sdwa v139, v15, v127 dst_sel:DWORD dst_unused:UNUSED_PAD src0_sel:DWORD src1_sel:WORD_1
    ds_read_u16_d16_hi v134, v138 offset:32768
    ds_read_u16_d16_hi v135, v139 offset:32768
    s_and_b32 s33, s51, s34
    buffer_load_dwordx4 v[76:79], v1, s[12:15], s33 offen
    s_set_gpr_idx_on s61, 0xc
    v_pk_fma_f32 v[16:17], v[128:129], v[104:105], v[16:17] op_sel:[1,0,0] op_sel_hi:[1,1,1]
    v_pk_fma_f32 v[18:19], v[128:129], v[106:107], v[18:19] op_sel:[1,0,0] op_sel_hi:[1,1,1]
    v_pk_fma_f32 v[20:21], v[130:131], v[108:109], v[20:21] op_sel:[1,0,0] op_sel_hi:[1,1,1]
    v_pk_fma_f32 v[22:23], v[130:131], v[110:111], v[22:23] op_sel:[1,0,0] op_sel_hi:[1,1,1]
    s_set_gpr_idx_off
    v_mfma_f32_4x4x4_16b_bf16 v[120:123], v[172:173], v[176:177], 0 cbsz:4 abid:9
    v_lshlrev_b32_sdwa v136, v15, v112 dst_sel:DWORD dst_unused:UNUSED_PAD src0_sel:DWORD src1_sel:WORD_1
    s_waitcnt vmcnt(4)
    v_mfma_f32_4x4x4_16b_bf16 v[104:107], v[146:147], v[92:93], 0 cbsz:4 abid:7
    v_readlane_b32 s52, v164, 36
    v_mfma_f32_4x4x4_16b_bf16 v[108:111], v[146:147], v[94:95], 0 cbsz:4 abid:7
    v_lshlrev_b32_sdwa v137, v15, v113 dst_sel:DWORD dst_unused:UNUSED_PAD src0_sel:DWORD src1_sel:WORD_1
    ds_read_u16_d16_hi v128, v136 offset:32768
    ds_read_u16_d16_hi v129, v137 offset:32768
    s_and_b32 s33, s52, s34
    buffer_load_dwordx4 v[80:83], v1, s[12:15], s33 offen
    s_waitcnt lgkmcnt(2)
    s_set_gpr_idx_on s62, 0xc
    v_pk_fma_f32 v[16:17], v[132:133], v[96:97], v[16:17] op_sel:[0,0,0] op_sel_hi:[0,1,1]
    v_pk_fma_f32 v[18:19], v[132:133], v[98:99], v[18:19] op_sel:[0,0,0] op_sel_hi:[0,1,1]
    v_pk_fma_f32 v[20:21], v[134:135], v[100:101], v[20:21] op_sel:[0,0,0] op_sel_hi:[0,1,1]
    v_pk_fma_f32 v[22:23], v[134:135], v[102:103], v[22:23] op_sel:[0,0,0] op_sel_hi:[0,1,1]
    s_set_gpr_idx_off
    v_lshlrev_b32_sdwa v138, v15, v116 dst_sel:DWORD dst_unused:UNUSED_PAD src0_sel:DWORD src1_sel:WORD_1
    s_waitcnt vmcnt(4)
    v_mfma_f32_4x4x4_16b_bf16 v[96:99], v[140:141], v[64:65], 0 cbsz:4 abid:8
    v_readlane_b32 s53, v164, 37
    v_mfma_f32_4x4x4_16b_bf16 v[100:103], v[140:141], v[66:67], 0 cbsz:4 abid:8
    v_lshlrev_b32_sdwa v139, v15, v117 dst_sel:DWORD dst_unused:UNUSED_PAD src0_sel:DWORD src1_sel:WORD_1
    ds_read_u16_d16_hi v130, v138 offset:32768
    ds_read_u16_d16_hi v131, v139 offset:32768
    s_and_b32 s33, s53, s34
    buffer_load_dwordx4 v[84:87], v1, s[12:15], s33 offen
    s_set_gpr_idx_on s63, 0xc
    v_pk_fma_f32 v[16:17], v[132:133], v[104:105], v[16:17] op_sel:[1,0,0] op_sel_hi:[1,1,1]
    v_pk_fma_f32 v[18:19], v[132:133], v[106:107], v[18:19] op_sel:[1,0,0] op_sel_hi:[1,1,1]
    v_pk_fma_f32 v[20:21], v[134:135], v[108:109], v[20:21] op_sel:[1,0,0] op_sel_hi:[1,1,1]
    v_pk_fma_f32 v[22:23], v[134:135], v[110:111], v[22:23] op_sel:[1,0,0] op_sel_hi:[1,1,1]
    s_set_gpr_idx_off
A_32:
    s_sub_u32 s31, s31, 4
    s_cbranch_scc1 B_32
    v_mfma_f32_4x4x4_16b_bf16 v[124:127], v[172:173], v[178:179], 0 cbsz:4 abid:9
    v_lshlrev_b32_sdwa v136, v15, v114 dst_sel:DWORD dst_unused:UNUSED_PAD src0_sel:DWORD src1_sel:WORD_1
    s_waitcnt vmcnt(4)
    v_mfma_f32_4x4x4_16b_bf16 v[104:107], v[142:143], v[68:69], 0 cbsz:4 abid:8
    v_readlane_b32 s54, v164, 38
    v_mfma_f32_4x4x4_16b_bf16 v[108:111], v[142:143], v[70:71], 0 cbsz:4 abid:8
    v_lshlrev_b32_sdwa v137, v15, v115 dst_sel:DWORD dst_unused:UNUSED_PAD src0_sel:DWORD src1_sel:WORD_1
    ds_read_u16_d16_hi v132, v136 offset:32768
    ds_read_u16_d16_hi v133, v137 offset:32768
    s_and_b32 s33, s54, s34
    buffer_load_dwordx4 v[88:91], v1, s[12:15], s33 offen
    s_waitcnt lgkmcnt(2)
    s_set_gpr_idx_on s48, 0xc
    v_pk_fma_f32 v[16:17], v[128:129], v[96:97], v[16:17] op_sel:[0,0,0] op_sel_hi:[0,1,1]
    v_pk_fma_f32 v[18:19], v[128:129], v[98:99], v[18:19] op_sel:[0,0,0] op_sel_hi:[0,1,1]
    v_pk_fma_f32 v[20:21], v[130:131], v[100:101], v[20:21] op_sel:[0,0,0] op_sel_hi:[0,1,1]
    v_pk_fma_f32 v[22:23], v[130:131], v[102:103], v[22:23] op_sel:[0,0,0] op_sel_hi:[0,1,1]
    s_set_gpr_idx_off
    v_lshlrev_b32_sdwa v138, v15, v118 dst_sel:DWORD dst_unused:UNUSED_PAD src0_sel:DWORD src1_sel:WORD_1
    s_waitcnt vmcnt(4)
    v_mfma_f32_4x4x4_16b_bf16 v[96:99], v[144:145], v[72:73], 0 cbsz:4 abid:8
    v_readlane_b32 s55, v164, 39
    v_mfma_f32_4x4x4_16b_bf16 v[100:103], v[144:145], v[74:75], 0 cbsz:4 abid:8
    v_lshlrev_b32_sdwa v139, v15, v119 dst_sel:DWORD dst_unused:UNUSED_PAD src0_sel:DWORD src1_sel:WORD_1
    ds_read_u16_d16_hi v134, v138 offset:32768
    ds_read_u16_d16_hi v135, v139 offset:32768
    s_and_b32 s33, s55, s34
    buffer_load_dwordx4 v[92:95], v1, s[12:15], s33 offen
    s_set_gpr_idx_on s49, 0xc
    v_pk_fma_f32 v[16:17], v[128:129], v[104:105], v[16:17] op_sel:[1,0,0] op_sel_hi:[1,1,1]
    v_pk_fma_f32 v[18:19], v[128:129], v[106:107], v[18:19] op_sel:[1,0,0] op_sel_hi:[1,1,1]
    v_pk_fma_f32 v[20:21], v[130:131], v[108:109], v[20:21] op_sel:[1,0,0] op_sel_hi:[1,1,1]
    v_pk_fma_f32 v[22:23], v[130:131], v[110:111], v[22:23] op_sel:[1,0,0] op_sel_hi:[1,1,1]
    s_set_gpr_idx_off
    v_mfma_f32_4x4x4_16b_bf16 v[112:115], v[172:173], v[176:177], 0 cbsz:4 abid:10
    v_lshlrev_b32_sdwa v136, v15, v120 dst_sel:DWORD dst_unused:UNUSED_PAD src0_sel:DWORD src1_sel:WORD_1
    s_waitcnt vmcnt(4)
    v_mfma_f32_4x4x4_16b_bf16 v[104:107], v[146:147], v[76:77], 0 cbsz:4 abid:8
    v_readlane_b32 s56, v164, 40
    v_mfma_f32_4x4x4_16b_bf16 v[108:111], v[146:147], v[78:79], 0 cbsz:4 abid:8
    v_lshlrev_b32_sdwa v137, v15, v121 dst_sel:DWORD dst_unused:UNUSED_PAD src0_sel:DWORD src1_sel:WORD_1
    ds_read_u16_d16_hi v128, v136 offset:32768
    ds_read_u16_d16_hi v129, v137 offset:32768
    s_and_b32 s33, s56, s34
    buffer_load_dwordx4 v[64:67], v1, s[12:15], s33 offen
    s_waitcnt lgkmcnt(2)
    s_set_gpr_idx_on s50, 0xc
    v_pk_fma_f32 v[16:17], v[132:133], v[96:97], v[16:17] op_sel:[0,0,0] op_sel_hi:[0,1,1]
    v_pk_fma_f32 v[18:19], v[132:133], v[98:99], v[18:19] op_sel:[0,0,0] op_sel_hi:[0,1,1]
    v_pk_fma_f32 v[20:21], v[134:135], v[100:101], v[20:21] op_sel:[0,0,0] op_sel_hi:[0,1,1]
    v_pk_fma_f32 v[22:23], v[134:135], v[102:103], v[22:23] op_sel:[0,0,0] op_sel_hi:[0,1,1]
    s_set_gpr_idx_off
    v_lshlrev_b32_sdwa v138, v15, v124 dst_sel:DWORD dst_unused:UNUSED_PAD src0_sel:DWORD src1_sel:WORD_1
    s_waitcnt vmcnt(4)
    v_mfma_f32_4x4x4_16b_bf16 v[96:99], v[140:141], v[80:81], 0 cbsz:4 abid:9
    v_readlane_b32 s57, v164, 41
    v_mfma_f32_4x4x4_16b_bf16 v[100:103], v[140:141], v[82:83], 0 cbsz:4 abid:9
    v_lshlrev_b32_sdwa v139, v15, v125 dst_sel:DWORD dst_unused:UNUSED_PAD src0_sel:DWORD src1_sel:WORD_1
    ds_read_u16_d16_hi v130, v138 offset:32768
    ds_read_u16_d16_hi v131, v139 offset:32768
    s_and_b32 s33, s57, s34
    buffer_load_dwordx4 v[68:71], v1, s[12:15], s33 offen
    s_set_gpr_idx_on s51, 0xc
    v_pk_fma_f32 v[16:17], v[132:133], v[104:105], v[16:17] op_sel:[1,0,0] op_sel_hi:[1,1,1]
    v_pk_fma_f32 v[18:19], v[132:133], v[106:107], v[18:19] op_sel:[1,0,0] op_sel_hi:[1,1,1]
    v_pk_fma_f32 v[20:21], v[134:135], v[108:109], v[20:21] op_sel:[1,0,0] op_sel_hi:[1,1,1]
    v_pk_fma_f32 v[22:23], v[134:135], v[110:111], v[22:23] op_sel:[1,0,0] op_sel_hi:[1,1,1]
    s_set_gpr_idx_off
A_36:
    s_sub_u32 s31, s31, 4
    s_cbranch_scc1 B_36
    v_mfma_f32_4x4x4_16b_bf16 v[116:119], v[172:173], v[178:179], 0 cbsz:4 abid:10
    v_lshlrev_b32_sdwa v136, v15, v122 dst_sel:DWORD dst_unused:UNUSED_PAD src0_sel:DWORD src1_sel:WORD_1
    s_waitcnt vmcnt(4)
    v_mfma_f32_4x4x4_16b_bf16 v[104:107], v[142:143], v[84:85], 0 cbsz:4 abid:9
    v_readlane_b32 s58, v164, 42
    v_mfma_f32_4x4x4_16b_bf16 v[108:111], v[142:143], v[86:87], 0 cbsz:4 abid:9
    v_lshlrev_b32_sdwa v137, v15, v123 dst_sel:DWORD dst_unused:UNUSED_PAD src0_sel:DWORD src1_sel:WORD_1
    ds_read_u16_d16_hi v132, v136 offset:32768
    ds_read_u16_d16_hi v133, v137 offset:32768
    s_and_b32 s33, s58, s34
    buffer_load_dwordx4 v[72:75], v1, s[12:15], s33 offen
    s_waitcnt lgkmcnt(2)
    s_set_gpr_idx_on s52, 0xc
    v_pk_fma_f32 v[16:17], v[128:129], v[96:97], v[16:17] op_sel:[0,0,0] op_sel_hi:[0,1,1]
    v_pk_fma_f32 v[18:19], v[128:129], v[98:99], v[18:19] op_sel:[0,0,0] op_sel_hi:[0,1,1]
    v_pk_fma_f32 v[20:21], v[130:131], v[100:101], v[20:21] op_sel:[0,0,0] op_sel_hi:[0,1,1]
    v_pk_fma_f32 v[22:23], v[130:131], v[102:103], v[22:23] op_sel:[0,0,0] op_sel_hi:[0,1,1]
    s_set_gpr_idx_off
    v_lshlrev_b32_sdwa v138, v15, v126 dst_sel:DWORD dst_unused:UNUSED_PAD src0_sel:DWORD src1_sel:WORD_1
    s_waitcnt vmcnt(4)
    v_mfma_f32_4x4x4_16b_bf16 v[96:99], v[144:145], v[88:89], 0 cbsz:4 abid:9
    v_readlane_b32 s59, v164, 43
    v_mfma_f32_4x4x4_16b_bf16 v[100:103], v[144:145], v[90:91], 0 cbsz:4 abid:9
    v_lshlrev_b32_sdwa v139, v15, v127 dst_sel:DWORD dst_unused:UNUSED_PAD src0_sel:DWORD src1_sel:WORD_1
    ds_read_u16_d16_hi v134, v138 offset:32768
    ds_read_u16_d16_hi v135, v139 offset:32768
    s_and_b32 s33, s59, s34
    buffer_load_dwordx4 v[76:79], v1, s[12:15], s33 offen
    s_set_gpr_idx_on s53, 0xc
    v_pk_fma_f32 v[16:17], v[128:129], v[104:105], v[16:17] op_sel:[1,0,0] op_sel_hi:[1,1,1]
    v_pk_fma_f32 v[18:19], v[128:129], v[106:107], v[18:19] op_sel:[1,0,0] op_sel_hi:[1,1,1]
    v_pk_fma_f32 v[20:21], v[130:131], v[108:109], v[20:21] op_sel:[1,0,0] op_sel_hi:[1,1,1]
    v_pk_fma_f32 v[22:23], v[130:131], v[110:111], v[22:23] op_sel:[1,0,0] op_sel_hi:[1,1,1]
    s_set_gpr_idx_off
    v_mfma_f32_4x4x4_16b_bf16 v[120:123], v[172:173], v[176:177], 0 cbsz:4 abid:11
    v_lshlrev_b32_sdwa v136, v15, v112 dst_sel:DWORD dst_unused:UNUSED_PAD src0_sel:DWORD src1_sel:WORD_1
    s_waitcnt vmcnt(4)
    v_mfma_f32_4x4x4_16b_bf16 v[104:107], v[146:147], v[92:93], 0 cbsz:4 abid:9
    v_readlane_b32 s60, v164, 44
    v_mfma_f32_4x4x4_16b_bf16 v[108:111], v[146:147], v[94:95], 0 cbsz:4 abid:9
    v_lshlrev_b32_sdwa v137, v15, v113 dst_sel:DWORD dst_unused:UNUSED_PAD src0_sel:DWORD src1_sel:WORD_1
    ds_read_u16_d16_hi v128, v136 offset:32768
    ds_read_u16_d16_hi v129, v137 offset:32768
    s_and_b32 s33, s60, s34
    buffer_load_dwordx4 v[80:83], v1, s[12:15], s33 offen
    s_waitcnt lgkmcnt(2)
    s_set_gpr_idx_on s54, 0xc
    v_pk_fma_f32 v[16:17], v[132:133], v[96:97], v[16:17] op_sel:[0,0,0] op_sel_hi:[0,1,1]
    v_pk_fma_f32 v[18:19], v[132:133], v[98:99], v[18:19] op_sel:[0,0,0] op_sel_hi:[0,1,1]
    v_pk_fma_f32 v[20:21], v[134:135], v[100:101], v[20:21] op_sel:[0,0,0] op_sel_hi:[0,1,1]
    v_pk_fma_f32 v[22:23], v[134:135], v[102:103], v[22:23] op_sel:[0,0,0] op_sel_hi:[0,1,1]
    s_set_gpr_idx_off
    v_lshlrev_b32_sdwa v138, v15, v116 dst_sel:DWORD dst_unused:UNUSED_PAD src0_sel:DWORD src1_sel:WORD_1
    s_waitcnt vmcnt(4)
    v_mfma_f32_4x4x4_16b_bf16 v[96:99], v[140:141], v[64:65], 0 cbsz:4 abid:10
    v_readlane_b32 s61, v164, 45
    v_mfma_f32_4x4x4_16b_bf16 v[100:103], v[140:141], v[66:67], 0 cbsz:4 abid:10
    v_lshlrev_b32_sdwa v139, v15, v117 dst_sel:DWORD dst_unused:UNUSED_PAD src0_sel:DWORD src1_sel:WORD_1
    ds_read_u16_d16_hi v130, v138 offset:32768
    ds_read_u16_d16_hi v131, v139 offset:32768
    s_and_b32 s33, s61, s34
    buffer_load_dwordx4 v[84:87], v1, s[12:15], s33 offen
    s_set_gpr_idx_on s55, 0xc
    v_pk_fma_f32 v[16:17], v[132:133], v[104:105], v[16:17] op_sel:[1,0,0] op_sel_hi:[1,1,1]
    v_pk_fma_f32 v[18:19], v[132:133], v[106:107], v[18:19] op_sel:[1,0,0] op_sel_hi:[1,1,1]
    v_pk_fma_f32 v[20:21], v[134:135], v[108:109], v[20:21] op_sel:[1,0,0] op_sel_hi:[1,1,1]
    v_pk_fma_f32 v[22:23], v[134:135], v[110:111], v[22:23] op_sel:[1,0,0] op_sel_hi:[1,1,1]
    s_set_gpr_idx_off
A_40:
    s_sub_u32 s31, s31, 4
    s_cbranch_scc1 B_40
    v_mfma_f32_4x4x4_16b_bf16 v[124:127], v[172:173], v[178:179], 0 cbsz:4 abid:11
    v_lshlrev_b32_sdwa v136, v15, v114 dst_sel:DWORD dst_unused:UNUSED_PAD src0_sel:DWORD src1_sel:WORD_1
    s_waitcnt vmcnt(4)
    v_mfma_f32_4x4x4_16b_bf16 v[104:107], v[142:143], v[68:69], 0 cbsz:4 abid:10
    v_readlane_b32 s62, v164, 46
    v_mfma_f32_4x4x4_16b_bf16 v[108:111], v[142:143], v[70:71], 0 cbsz:4 abid:10
    v_lshlrev_b32_sdwa v137, v15, v115 dst_sel:DWORD dst_unused:UNUSED_PAD src0_sel:DWORD src1_sel:WORD_1
    ds_read_u16_d16_hi v132, v136 offset:32768
    ds_read_u16_d16_hi v133, v137 offset:32768
    s_and_b32 s33, s62, s34
    buffer_load_dwordx4 v[88:91], v1, s[12:15], s33 offen
    s_waitcnt lgkmcnt(2)
    s_set_gpr_idx_on s56, 0xc
    v_pk_fma_f32 v[16:17], v[128:129], v[96:97], v[16:17] op_sel:[0,0,0] op_sel_hi:[0,1,1]
    v_pk_fma_f32 v[18:19], v[128:129], v[98:99], v[18:19] op_sel:[0,0,0] op_sel_hi:[0,1,1]
    v_pk_fma_f32 v[20:21], v[130:131], v[100:101], v[20:21] op_sel:[0,0,0] op_sel_hi:[0,1,1]
    v_pk_fma_f32 v[22:23], v[130:131], v[102:103], v[22:23] op_sel:[0,0,0] op_sel_hi:[0,1,1]
    s_set_gpr_idx_off
    v_mfma_f32_4x4x4_16b_bf16 v[148:151], v[168:169], v[180:181], 0
    v_lshlrev_b32_sdwa v138, v15, v118 dst_sel:DWORD dst_unused:UNUSED_PAD src0_sel:DWORD src1_sel:WORD_1
    s_waitcnt vmcnt(4)
    v_mfma_f32_4x4x4_16b_bf16 v[96:99], v[144:145], v[72:73], 0 cbsz:4 abid:10
    v_readlane_b32 s63, v164, 47
    v_mfma_f32_4x4x4_16b_bf16 v[100:103], v[144:145], v[74:75], 0 cbsz:4 abid:10
    v_lshlrev_b32_sdwa v139, v15, v119 dst_sel:DWORD dst_unused:UNUSED_PAD src0_sel:DWORD src1_sel:WORD_1
    ds_read_u16_d16_hi v134, v138 offset:32768
    ds_read_u16_d16_hi v135, v139 offset:32768
    s_and_b32 s33, s63, s34
    buffer_load_dwordx4 v[92:95], v1, s[12:15], s33 offen
    s_set_gpr_idx_on s57, 0xc
    v_pk_fma_f32 v[16:17], v[128:129], v[104:105], v[16:17] op_sel:[1,0,0] op_sel_hi:[1,1,1]
    v_pk_fma_f32 v[18:19], v[128:129], v[106:107], v[18:19] op_sel:[1,0,0] op_sel_hi:[1,1,1]
    v_pk_fma_f32 v[20:21], v[130:131], v[108:109], v[20:21] op_sel:[1,0,0] op_sel_hi:[1,1,1]
    v_pk_fma_f32 v[22:23], v[130:131], v[110:111], v[22:23] op_sel:[1,0,0] op_sel_hi:[1,1,1]
    s_set_gpr_idx_off
    v_mfma_f32_4x4x4_16b_bf16 v[112:115], v[172:173], v[176:177], 0 cbsz:4 abid:12
    v_lshlrev_b32_sdwa v136, v15, v120 dst_sel:DWORD dst_unused:UNUSED_PAD src0_sel:DWORD src1_sel:WORD_1
    s_waitcnt vmcnt(4)
    v_mfma_f32_4x4x4_16b_bf16 v[104:107], v[146:147], v[76:77], 0 cbsz:4 abid:10
    v_readlane_b32 s48, v164, 48
    v_mfma_f32_4x4x4_16b_bf16 v[108:111], v[146:147], v[78:79], 0 cbsz:4 abid:10
    v_lshlrev_b32_sdwa v137, v15, v121 dst_sel:DWORD dst_unused:UNUSED_PAD src0_sel:DWORD src1_sel:WORD_1
    ds_read_u16_d16_hi v128, v136 offset:32768
    ds_read_u16_d16_hi v129, v137 offset:32768
    s_and_b32 s33, s48, s34
    buffer_load_dwordx4 v[64:67], v1, s[12:15], s33 offen
    s_waitcnt lgkmcnt(2)
    s_set_gpr_idx_on s58, 0xc
    v_pk_fma_f32 v[16:17], v[132:133], v[96:97], v[16:17] op_sel:[0,0,0] op_sel_hi:[0,1,1]
    v_pk_fma_f32 v[18:19], v[132:133], v[98:99], v[18:19] op_sel:[0,0,0] op_sel_hi:[0,1,1]
    v_pk_fma_f32 v[20:21], v[134:135], v[100:101], v[20:21] op_sel:[0,0,0] op_sel_hi:[0,1,1]
    v_pk_fma_f32 v[22:23], v[134:135], v[102:103], v[22:23] op_sel:[0,0,0] op_sel_hi:[0,1,1]
    s_set_gpr_idx_off
    v_mfma_f32_4x4x4_16b_bf16 v[152:155], v[168:169], v[182:183], 0
    v_lshlrev_b32_sdwa v138, v15, v124 dst_sel:DWORD dst_unused:UNUSED_PAD src0_sel:DWORD src1_sel:WORD_1
    s_waitcnt vmcnt(4)
    v_mfma_f32_4x4x4_16b_bf16 v[96:99], v[140:141], v[80:81], 0 cbsz:4 abid:11
    v_readlane_b32 s49, v164, 49
    v_mfma_f32_4x4x4_16b_bf16 v[100:103], v[140:141], v[82:83], 0 cbsz:4 abid:11
    v_lshlrev_b32_sdwa v139, v15, v125 dst_sel:DWORD dst_unused:UNUSED_PAD src0_sel:DWORD src1_sel:WORD_1
    ds_read_u16_d16_hi v130, v138 offset:32768
    ds_read_u16_d16_hi v131, v139 offset:32768
    s_and_b32 s33, s49, s34
    buffer_load_dwordx4 v[68:71], v1, s[12:15], s33 offen
    s_set_gpr_idx_on s59, 0xc
    v_pk_fma_f32 v[16:17], v[132:133], v[104:105], v[16:17] op_sel:[1,0,0] op_sel_hi:[1,1,1]
    v_pk_fma_f32 v[18:19], v[132:133], v[106:107], v[18:19] op_sel:[1,0,0] op_sel_hi:[1,1,1]
    v_pk_fma_f32 v[20:21], v[134:135], v[108:109], v[20:21] op_sel:[1,0,0] op_sel_hi:[1,1,1]
    v_pk_fma_f32 v[22:23], v[134:135], v[110:111], v[22:23] op_sel:[1,0,0] op_sel_hi:[1,1,1]
    s_set_gpr_idx_off
A_44:
    s_sub_u32 s31, s31, 4
    s_cbranch_scc1 B_44
    v_mfma_f32_4x4x4_16b_bf16 v[116:119], v[172:173], v[178:179], 0 cbsz:4 abid:12
    v_lshlrev_b32_sdwa v136, v15, v122 dst_sel:DWORD dst_unused:UNUSED_PAD src0_sel:DWORD src1_sel:WORD_1
    s_waitcnt vmcnt(4)
    v_mfma_f32_4x4x4_16b_bf16 v[104:107], v[142:143], v[84:85], 0 cbsz:4 abid:11
    v_readlane_b32 s50, v164, 50
    v_mfma_f32_4x4x4_16b_bf16 v[108:111], v[142:143], v[86:87], 0 cbsz:4 abid:11
    v_lshlrev_b32_sdwa v137, v15, v123 dst_sel:DWORD dst_unused:UNUSED_PAD src0_sel:DWORD src1_sel:WORD_1
    ds_read_u16_d16_hi v132, v136 offset:32768
    ds_read_u16_d16_hi v133, v137 offset:32768
    s_and_b32 s33, s50, s34
    buffer_load_dwordx4 v[72:75], v1, s[12:15], s33 offen
    s_waitcnt lgkmcnt(2)
    s_set_gpr_idx_on s60, 0xc
    v_pk_fma_f32 v[16:17], v[128:129], v[96:97], v[16:17] op_sel:[0,0,0] op_sel_hi:[0,1,1]
    v_pk_fma_f32 v[18:19], v[128:129], v[98:99], v[18:19] op_sel:[0,0,0] op_sel_hi:[0,1,1]
    v_pk_fma_f32 v[20:21], v[130:131], v[100:101], v[20:21] op_sel:[0,0,0] op_sel_hi:[0,1,1]
    v_pk_fma_f32 v[22:23], v[130:131], v[102:103], v[22:23] op_sel:[0,0,0] op_sel_hi:[0,1,1]
    s_set_gpr_idx_off
    v_mfma_f32_4x4x4_16b_bf16 v[156:159], v[168:169], v[184:185], 0
    v_lshlrev_b32_sdwa v138, v15, v126 dst_sel:DWORD dst_unused:UNUSED_PAD src0_sel:DWORD src1_sel:WORD_1
    s_waitcnt vmcnt(4)
    v_mfma_f32_4x4x4_16b_bf16 v[96:99], v[144:145], v[88:89], 0 cbsz:4 abid:11
    v_readlane_b32 s51, v164, 51
    v_mfma_f32_4x4x4_16b_bf16 v[100:103], v[144:145], v[90:91], 0 cbsz:4 abid:11
    v_lshlrev_b32_sdwa v139, v15, v127 dst_sel:DWORD dst_unused:UNUSED_PAD src0_sel:DWORD src1_sel:WORD_1
    ds_read_u16_d16_hi v134, v138 offset:32768
    ds_read_u16_d16_hi v135, v139 offset:32768
    s_and_b32 s33, s51, s34
    buffer_load_dwordx4 v[76:79], v1, s[12:15], s33 offen
    s_set_gpr_idx_on s61, 0xc
    v_pk_fma_f32 v[16:17], v[128:129], v[104:105], v[16:17] op_sel:[1,0,0] op_sel_hi:[1,1,1]
    v_pk_fma_f32 v[18:19], v[128:129], v[106:107], v[18:19] op_sel:[1,0,0] op_sel_hi:[1,1,1]
    v_pk_fma_f32 v[20:21], v[130:131], v[108:109], v[20:21] op_sel:[1,0,0] op_sel_hi:[1,1,1]
    v_pk_fma_f32 v[22:23], v[130:131], v[110:111], v[22:23] op_sel:[1,0,0] op_sel_hi:[1,1,1]
    s_set_gpr_idx_off
    v_mfma_f32_4x4x4_16b_bf16 v[120:123], v[172:173], v[176:177], 0 cbsz:4 abid:13
    v_lshlrev_b32_sdwa v136, v15, v112 dst_sel:DWORD dst_unused:UNUSED_PAD src0_sel:DWORD src1_sel:WORD_1
    s_waitcnt vmcnt(4)
    v_mfma_f32_4x4x4_16b_bf16 v[104:107], v[146:147], v[92:93], 0 cbsz:4 abid:11
    v_readlane_b32 s52, v164, 52
    v_mfma_f32_4x4x4_16b_bf16 v[108:111], v[146:147], v[94:95], 0 cbsz:4 abid:11
    v_lshlrev_b32_sdwa v137, v15, v113 dst_sel:DWORD dst_unused:UNUSED_PAD src0_sel:DWORD src1_sel:WORD_1
    ds_read_u16_d16_hi v128, v136 offset:32768
    ds_read_u16_d16_hi v129, v137 offset:32768
    s_and_b32 s33, s52, s34
    buffer_load_dwordx4 v[80:83], v1, s[12:15], s33 offen
    s_waitcnt lgkmcnt(2)
    s_set_gpr_idx_on s62, 0xc
    v_pk_fma_f32 v[16:17], v[132:133], v[96:97], v[16:17] op_sel:[0,0,0] op_sel_hi:[0,1,1]
    v_pk_fma_f32 v[18:19], v[132:133], v[98:99], v[18:19] op_sel:[0,0,0] op_sel_hi:[0,1,1]
    v_pk_fma_f32 v[20:21], v[134:135], v[100:101], v[20:21] op_sel:[0,0,0] op_sel_hi:[0,1,1]
    v_pk_fma_f32 v[22:23], v[134:135], v[102:103], v[22:23] op_sel:[0,0,0] op_sel_hi:[0,1,1]
    s_set_gpr_idx_off
    v_mfma_f32_4x4x4_16b_bf16 v[160:163], v[168:169], v[186:187], 0
    v_lshlrev_b32_sdwa v138, v15, v116 dst_sel:DWORD dst_unused:UNUSED_PAD src0_sel:DWORD src1_sel:WORD_1
    s_waitcnt vmcnt(4)
    v_mfma_f32_4x4x4_16b_bf16 v[96:99], v[140:141], v[64:65], 0 cbsz:4 abid:12
    v_readlane_b32 s53, v164, 53
    v_mfma_f32_4x4x4_16b_bf16 v[100:103], v[140:141], v[66:67], 0 cbsz:4 abid:12
    v_lshlrev_b32_sdwa v139, v15, v117 dst_sel:DWORD dst_unused:UNUSED_PAD src0_sel:DWORD src1_sel:WORD_1
    ds_read_u16_d16_hi v130, v138 offset:32768
    ds_read_u16_d16_hi v131, v139 offset:32768
    s_and_b32 s33, s53, s34
    buffer_load_dwordx4 v[84:87], v1, s[12:15], s33 offen
    s_set_gpr_idx_on s63, 0xc
    v_pk_fma_f32 v[16:17], v[132:133], v[104:105], v[16:17] op_sel:[1,0,0] op_sel_hi:[1,1,1]
    v_pk_fma_f32 v[18:19], v[132:133], v[106:107], v[18:19] op_sel:[1,0,0] op_sel_hi:[1,1,1]
    v_pk_fma_f32 v[20:21], v[134:135], v[108:109], v[20:21] op_sel:[1,0,0] op_sel_hi:[1,1,1]
    v_pk_fma_f32 v[22:23], v[134:135], v[110:111], v[22:23] op_sel:[1,0,0] op_sel_hi:[1,1,1]
    s_set_gpr_idx_off
A_48:
    s_sub_u32 s31, s31, 4
    s_cbranch_scc1 B_48
    v_mfma_f32_4x4x4_16b_bf16 v[124:127], v[172:173], v[178:179], 0 cbsz:4 abid:13
    v_lshlrev_b32_sdwa v136, v15, v114 dst_sel:DWORD dst_unused:UNUSED_PAD src0_sel:DWORD src1_sel:WORD_1
    s_waitcnt vmcnt(4)
    v_mfma_f32_4x4x4_16b_bf16 v[104:107], v[142:143], v[68:69], 0 cbsz:4 abid:12
    v_readlane_b32 s54, v164, 54
    v_mfma_f32_4x4x4_16b_bf16 v[108:111], v[142:143], v[70:71], 0 cbsz:4 abid:12
    v_lshlrev_b32_sdwa v137, v15, v115 dst_sel:DWORD dst_unused:UNUSED_PAD src0_sel:DWORD src1_sel:WORD_1
    ds_read_u16_d16_hi v132, v136 offset:32768
    ds_read_u16_d16_hi v133, v137 offset:32768
    s_and_b32 s33, s54, s34
    buffer_load_dwordx4 v[88:91], v1, s[12:15], s33 offen
    s_waitcnt lgkmcnt(2)
    s_set_gpr_idx_on s48, 0xc
    v_pk_fma_f32 v[16:17], v[128:129], v[96:97], v[16:17] op_sel:[0,0,0] op_sel_hi:[0,1,1]
    v_pk_fma_f32 v[18:19], v[128:129], v[98:99], v[18:19] op_sel:[0,0,0] op_sel_hi:[0,1,1]
    v_pk_fma_f32 v[20:21], v[130:131], v[100:101], v[20:21] op_sel:[0,0,0] op_sel_hi:[0,1,1]
    v_pk_fma_f32 v[22:23], v[130:131], v[102:103], v[22:23] op_sel:[0,0,0] op_sel_hi:[0,1,1]
    s_set_gpr_idx_off
    v_lshlrev_b32_sdwa v138, v15, v118 dst_sel:DWORD dst_unused:UNUSED_PAD src0_sel:DWORD src1_sel:WORD_1
    s_waitcnt vmcnt(4)
    v_mfma_f32_4x4x4_16b_bf16 v[96:99], v[144:145], v[72:73], 0 cbsz:4 abid:12
    v_readlane_b32 s55, v164, 55
    v_mfma_f32_4x4x4_16b_bf16 v[100:103], v[144:145], v[74:75], 0 cbsz:4 abid:12
    v_lshlrev_b32_sdwa v139, v15, v119 dst_sel:DWORD dst_unused:UNUSED_PAD src0_sel:DWORD src1_sel:WORD_1
    ds_read_u16_d16_hi v134, v138 offset:32768
    ds_read_u16_d16_hi v135, v139 offset:32768
    s_and_b32 s33, s55, s34
    buffer_load_dwordx4 v[92:95], v1, s[12:15], s33 offen
    s_set_gpr_idx_on s49, 0xc
    v_pk_fma_f32 v[16:17], v[128:129], v[104:105], v[16:17] op_sel:[1,0,0] op_sel_hi:[1,1,1]
    v_pk_fma_f32 v[18:19], v[128:129], v[106:107], v[18:19] op_sel:[1,0,0] op_sel_hi:[1,1,1]
    v_pk_fma_f32 v[20:21], v[130:131], v[108:109], v[20:21] op_sel:[1,0,0] op_sel_hi:[1,1,1]
    v_pk_fma_f32 v[22:23], v[130:131], v[110:111], v[22:23] op_sel:[1,0,0] op_sel_hi:[1,1,1]
    s_set_gpr_idx_off
    v_mfma_f32_4x4x4_16b_bf16 v[112:115], v[172:173], v[176:177], 0 cbsz:4 abid:14
    v_lshlrev_b32_sdwa v136, v15, v120 dst_sel:DWORD dst_unused:UNUSED_PAD src0_sel:DWORD src1_sel:WORD_1
    s_waitcnt vmcnt(4)
    v_mfma_f32_4x4x4_16b_bf16 v[104:107], v[146:147], v[76:77], 0 cbsz:4 abid:12
    v_readlane_b32 s56, v164, 56
    v_mfma_f32_4x4x4_16b_bf16 v[108:111], v[146:147], v[78:79], 0 cbsz:4 abid:12
    v_lshlrev_b32_sdwa v137, v15, v121 dst_sel:DWORD dst_unused:UNUSED_PAD src0_sel:DWORD src1_sel:WORD_1
    ds_read_u16_d16_hi v128, v136 offset:32768
    ds_read_u16_d16_hi v129, v137 offset:32768
    s_and_b32 s33, s56, s34
    buffer_load_dwordx4 v[64:67], v1, s[12:15], s33 offen
    s_waitcnt lgkmcnt(2)
    s_set_gpr_idx_on s50, 0xc
    v_pk_fma_f32 v[16:17], v[132:133], v[96:97], v[16:17] op_sel:[0,0,0] op_sel_hi:[0,1,1]
    v_pk_fma_f32 v[18:19], v[132:133], v[98:99], v[18:19] op_sel:[0,0,0] op_sel_hi:[0,1,1]
    v_pk_fma_f32 v[20:21], v[134:135], v[100:101], v[20:21] op_sel:[0,0,0] op_sel_hi:[0,1,1]
    v_pk_fma_f32 v[22:23], v[134:135], v[102:103], v[22:23] op_sel:[0,0,0] op_sel_hi:[0,1,1]
    s_set_gpr_idx_off
    v_lshlrev_b32_sdwa v138, v15, v124 dst_sel:DWORD dst_unused:UNUSED_PAD src0_sel:DWORD src1_sel:WORD_1
    s_waitcnt vmcnt(4)
    v_mfma_f32_4x4x4_16b_bf16 v[96:99], v[140:141], v[80:81], 0 cbsz:4 abid:13
    v_readlane_b32 s57, v164, 57
    v_mfma_f32_4x4x4_16b_bf16 v[100:103], v[140:141], v[82:83], 0 cbsz:4 abid:13
    v_lshlrev_b32_sdwa v139, v15, v125 dst_sel:DWORD dst_unused:UNUSED_PAD src0_sel:DWORD src1_sel:WORD_1
    ds_read_u16_d16_hi v130, v138 offset:32768
    ds_read_u16_d16_hi v131, v139 offset:32768
    s_and_b32 s33, s57, s34
    buffer_load_dwordx4 v[68:71], v1, s[12:15], s33 offen
    s_set_gpr_idx_on s51, 0xc
    v_pk_fma_f32 v[16:17], v[132:133], v[104:105], v[16:17] op_sel:[1,0,0] op_sel_hi:[1,1,1]
    v_pk_fma_f32 v[18:19], v[132:133], v[106:107], v[18:19] op_sel:[1,0,0] op_sel_hi:[1,1,1]
    v_pk_fma_f32 v[20:21], v[134:135], v[108:109], v[20:21] op_sel:[1,0,0] op_sel_hi:[1,1,1]
    v_pk_fma_f32 v[22:23], v[134:135], v[110:111], v[22:23] op_sel:[1,0,0] op_sel_hi:[1,1,1]
    s_set_gpr_idx_off
A_52:
    s_sub_u32 s31, s31, 4
    s_cbranch_scc1 B_52
    v_mfma_f32_4x4x4_16b_bf16 v[116:119], v[172:173], v[178:179], 0 cbsz:4 abid:14
    v_lshlrev_b32_sdwa v136, v15, v122 dst_sel:DWORD dst_unused:UNUSED_PAD src0_sel:DWORD src1_sel:WORD_1
    s_waitcnt vmcnt(4)
    v_mfma_f32_4x4x4_16b_bf16 v[104:107], v[142:143], v[84:85], 0 cbsz:4 abid:13
    v_readlane_b32 s58, v164, 58
    v_mfma_f32_4x4x4_16b_bf16 v[108:111], v[142:143], v[86:87], 0 cbsz:4 abid:13
    v_lshlrev_b32_sdwa v137, v15, v123 dst_sel:DWORD dst_unused:UNUSED_PAD src0_sel:DWORD src1_sel:WORD_1
    ds_read_u16_d16_hi v132, v136 offset:32768
    ds_read_u16_d16_hi v133, v137 offset:32768
    s_and_b32 s33, s58, s34
    buffer_load_dwordx4 v[72:75], v1, s[12:15], s33 offen
    s_waitcnt lgkmcnt(2)
    s_set_gpr_idx_on s52, 0xc
    v_pk_fma_f32 v[16:17], v[128:129], v[96:97], v[16:17] op_sel:[0,0,0] op_sel_hi:[0,1,1]
    v_pk_fma_f32 v[18:19], v[128:129], v[98:99], v[18:19] op_sel:[0,0,0] op_sel_hi:[0,1,1]
    v_pk_fma_f32 v[20:21], v[130:131], v[100:101], v[20:21] op_sel:[0,0,0] op_sel_hi:[0,1,1]
    v_pk_fma_f32 v[22:23], v[130:131], v[102:103], v[22:23] op_sel:[0,0,0] op_sel_hi:[0,1,1]
    s_set_gpr_idx_off
    v_lshlrev_b32_sdwa v138, v15, v126 dst_sel:DWORD dst_unused:UNUSED_PAD src0_sel:DWORD src1_sel:WORD_1
    s_waitcnt vmcnt(4)
    v_mfma_f32_4x4x4_16b_bf16 v[96:99], v[144:145], v[88:89], 0 cbsz:4 abid:13
    v_readlane_b32 s59, v164, 59
    v_mfma_f32_4x4x4_16b_bf16 v[100:103], v[144:145], v[90:91], 0 cbsz:4 abid:13
    v_lshlrev_b32_sdwa v139, v15, v127 dst_sel:DWORD dst_unused:UNUSED_PAD src0_sel:DWORD src1_sel:WORD_1
    ds_read_u16_d16_hi v134, v138 offset:32768
    ds_read_u16_d16_hi v135, v139 offset:32768
    s_and_b32 s33, s59, s34
    buffer_load_dwordx4 v[76:79], v1, s[12:15], s33 offen
    s_set_gpr_idx_on s53, 0xc
    v_pk_fma_f32 v[16:17], v[128:129], v[104:105], v[16:17] op_sel:[1,0,0] op_sel_hi:[1,1,1]
    v_pk_fma_f32 v[18:19], v[128:129], v[106:107], v[18:19] op_sel:[1,0,0] op_sel_hi:[1,1,1]
    v_pk_fma_f32 v[20:21], v[130:131], v[108:109], v[20:21] op_sel:[1,0,0] op_sel_hi:[1,1,1]
    v_pk_fma_f32 v[22:23], v[130:131], v[110:111], v[22:23] op_sel:[1,0,0] op_sel_hi:[1,1,1]
    s_set_gpr_idx_off
    v_mfma_f32_4x4x4_16b_bf16 v[120:123], v[172:173], v[176:177], 0 cbsz:4 abid:15
    v_lshlrev_b32_sdwa v136, v15, v112 dst_sel:DWORD dst_unused:UNUSED_PAD src0_sel:DWORD src1_sel:WORD_1
    s_waitcnt vmcnt(4)
    v_mfma_f32_4x4x4_16b_bf16 v[104:107], v[146:147], v[92:93], 0 cbsz:4 abid:13
    v_readlane_b32 s60, v164, 60
    v_mfma_f32_4x4x4_16b_bf16 v[108:111], v[146:147], v[94:95], 0 cbsz:4 abid:13
    v_lshlrev_b32_sdwa v137, v15, v113 dst_sel:DWORD dst_unused:UNUSED_PAD src0_sel:DWORD src1_sel:WORD_1
    ds_read_u16_d16_hi v128, v136 offset:32768
    ds_read_u16_d16_hi v129, v137 offset:32768
    s_and_b32 s33, s60, s34
    buffer_load_dwordx4 v[80:83], v1, s[12:15], s33 offen
    s_waitcnt lgkmcnt(2)
    s_set_gpr_idx_on s54, 0xc
    v_pk_fma_f32 v[16:17], v[132:133], v[96:97], v[16:17] op_sel:[0,0,0] op_sel_hi:[0,1,1]
    v_pk_fma_f32 v[18:19], v[132:133], v[98:99], v[18:19] op_sel:[0,0,0] op_sel_hi:[0,1,1]
    v_pk_fma_f32 v[20:21], v[134:135], v[100:101], v[20:21] op_sel:[0,0,0] op_sel_hi:[0,1,1]
    v_pk_fma_f32 v[22:23], v[134:135], v[102:103], v[22:23] op_sel:[0,0,0] op_sel_hi:[0,1,1]
    s_set_gpr_idx_off
    v_lshlrev_b32_sdwa v138, v15, v116 dst_sel:DWORD dst_unused:UNUSED_PAD src0_sel:DWORD src1_sel:WORD_1
    s_waitcnt vmcnt(4)
    v_mfma_f32_4x4x4_16b_bf16 v[96:99], v[140:141], v[64:65], 0 cbsz:4 abid:14
    v_readlane_b32 s61, v164, 61
    v_mfma_f32_4x4x4_16b_bf16 v[100:103], v[140:141], v[66:67], 0 cbsz:4 abid:14
    v_lshlrev_b32_sdwa v139, v15, v117 dst_sel:DWORD dst_unused:UNUSED_PAD src0_sel:DWORD src1_sel:WORD_1
    ds_read_u16_d16_hi v130, v138 offset:32768
    ds_read_u16_d16_hi v131, v139 offset:32768
    s_and_b32 s33, s61, s34
    buffer_load_dwordx4 v[84:87], v1, s[12:15], s33 offen
    s_set_gpr_idx_on s55, 0xc
    v_pk_fma_f32 v[16:17], v[132:133], v[104:105], v[16:17] op_sel:[1,0,0] op_sel_hi:[1,1,1]
    v_pk_fma_f32 v[18:19], v[132:133], v[106:107], v[18:19] op_sel:[1,0,0] op_sel_hi:[1,1,1]
    v_pk_fma_f32 v[20:21], v[134:135], v[108:109], v[20:21] op_sel:[1,0,0] op_sel_hi:[1,1,1]
    v_pk_fma_f32 v[22:23], v[134:135], v[110:111], v[22:23] op_sel:[1,0,0] op_sel_hi:[1,1,1]
    s_set_gpr_idx_off
A_56:
    s_sub_u32 s31, s31, 4
    s_cbranch_scc1 B_56
    v_mfma_f32_4x4x4_16b_bf16 v[124:127], v[172:173], v[178:179], 0 cbsz:4 abid:15
    v_lshlrev_b32_sdwa v136, v15, v114 dst_sel:DWORD dst_unused:UNUSED_PAD src0_sel:DWORD src1_sel:WORD_1
    s_waitcnt vmcnt(4)
    v_mfma_f32_4x4x4_16b_bf16 v[104:107], v[142:143], v[68:69], 0 cbsz:4 abid:14
    v_readlane_b32 s62, v164, 62
    v_mfma_f32_4x4x4_16b_bf16 v[108:111], v[142:143], v[70:71], 0 cbsz:4 abid:14
    v_lshlrev_b32_sdwa v137, v15, v115 dst_sel:DWORD dst_unused:UNUSED_PAD src0_sel:DWORD src1_sel:WORD_1
    ds_read_u16_d16_hi v132, v136 offset:32768
    ds_read_u16_d16_hi v133, v137 offset:32768
    s_and_b32 s33, s62, s34
    buffer_load_dwordx4 v[88:91], v1, s[12:15], s33 offen
    s_waitcnt lgkmcnt(2)
    s_set_gpr_idx_on s56, 0xc
    v_pk_fma_f32 v[16:17], v[128:129], v[96:97], v[16:17] op_sel:[0,0,0] op_sel_hi:[0,1,1]
    v_pk_fma_f32 v[18:19], v[128:129], v[98:99], v[18:19] op_sel:[0,0,0] op_sel_hi:[0,1,1]
    v_pk_fma_f32 v[20:21], v[130:131], v[100:101], v[20:21] op_sel:[0,0,0] op_sel_hi:[0,1,1]
    v_pk_fma_f32 v[22:23], v[130:131], v[102:103], v[22:23] op_sel:[0,0,0] op_sel_hi:[0,1,1]
    s_set_gpr_idx_off
    v_lshlrev_b32_sdwa v138, v15, v118 dst_sel:DWORD dst_unused:UNUSED_PAD src0_sel:DWORD src1_sel:WORD_1
    s_waitcnt vmcnt(4)
    v_mfma_f32_4x4x4_16b_bf16 v[96:99], v[144:145], v[72:73], 0 cbsz:4 abid:14
    v_readlane_b32 s63, v164, 63
    v_mfma_f32_4x4x4_16b_bf16 v[100:103], v[144:145], v[74:75], 0 cbsz:4 abid:14
    v_lshlrev_b32_sdwa v139, v15, v119 dst_sel:DWORD dst_unused:UNUSED_PAD src0_sel:DWORD src1_sel:WORD_1
    ds_read_u16_d16_hi v134, v138 offset:32768
    ds_read_u16_d16_hi v135, v139 offset:32768
    s_and_b32 s33, s63, s34
    buffer_load_dwordx4 v[92:95], v1, s[12:15], s33 offen
    s_set_gpr_idx_on s57, 0xc
    v_pk_fma_f32 v[16:17], v[128:129], v[104:105], v[16:17] op_sel:[1,0,0] op_sel_hi:[1,1,1]
    v_pk_fma_f32 v[18:19], v[128:129], v[106:107], v[18:19] op_sel:[1,0,0] op_sel_hi:[1,1,1]
    v_pk_fma_f32 v[20:21], v[130:131], v[108:109], v[20:21] op_sel:[1,0,0] op_sel_hi:[1,1,1]
    v_pk_fma_f32 v[22:23], v[130:131], v[110:111], v[22:23] op_sel:[1,0,0] op_sel_hi:[1,1,1]
    s_set_gpr_idx_off
    v_mov_b32 v172, v170
    v_mov_b32 v173, v171
    s_nop 1
    v_mfma_f32_4x4x4_16b_bf16 v[112:115], v[172:173], v[176:177], 0 cbsz:4 abid:0
    v_lshlrev_b32_sdwa v136, v15, v120 dst_sel:DWORD dst_unused:UNUSED_PAD src0_sel:DWORD src1_sel:WORD_1
    s_waitcnt vmcnt(4)
    v_mfma_f32_4x4x4_16b_bf16 v[104:107], v[146:147], v[76:77], 0 cbsz:4 abid:14
    v_readlane_b32 s48, v165, 0
    v_mfma_f32_4x4x4_16b_bf16 v[108:111], v[146:147], v[78:79], 0 cbsz:4 abid:14
    v_lshlrev_b32_sdwa v137, v15, v121 dst_sel:DWORD dst_unused:UNUSED_PAD src0_sel:DWORD src1_sel:WORD_1
    ds_read_u16_d16_hi v128, v136 offset:32768
    ds_read_u16_d16_hi v129, v137 offset:32768
    s_and_b32 s33, s48, s34
    buffer_load_dwordx4 v[64:67], v1, s[12:15], s33 offen
    s_waitcnt lgkmcnt(2)
    s_set_gpr_idx_on s58, 0xc
    v_pk_fma_f32 v[16:17], v[132:133], v[96:97], v[16:17] op_sel:[0,0,0] op_sel_hi:[0,1,1]
    v_pk_fma_f32 v[18:19], v[132:133], v[98:99], v[18:19] op_sel:[0,0,0] op_sel_hi:[0,1,1]
    v_pk_fma_f32 v[20:21], v[134:135], v[100:101], v[20:21] op_sel:[0,0,0] op_sel_hi:[0,1,1]
    v_pk_fma_f32 v[22:23], v[134:135], v[102:103], v[22:23] op_sel:[0,0,0] op_sel_hi:[0,1,1]
    s_set_gpr_idx_off
    v_lshlrev_b32_sdwa v138, v15, v124 dst_sel:DWORD dst_unused:UNUSED_PAD src0_sel:DWORD src1_sel:WORD_1
    s_waitcnt vmcnt(4)
    v_mfma_f32_4x4x4_16b_bf16 v[96:99], v[140:141], v[80:81], 0 cbsz:4 abid:15
    v_readlane_b32 s49, v165, 1
    v_mfma_f32_4x4x4_16b_bf16 v[100:103], v[140:141], v[82:83], 0 cbsz:4 abid:15
    v_lshlrev_b32_sdwa v139, v15, v125 dst_sel:DWORD dst_unused:UNUSED_PAD src0_sel:DWORD src1_sel:WORD_1
    ds_read_u16_d16_hi v130, v138 offset:32768
    ds_read_u16_d16_hi v131, v139 offset:32768
    s_and_b32 s33, s49, s34
    buffer_load_dwordx4 v[68:71], v1, s[12:15], s33 offen
    s_set_gpr_idx_on s59, 0xc
    v_pk_fma_f32 v[16:17], v[132:133], v[104:105], v[16:17] op_sel:[1,0,0] op_sel_hi:[1,1,1]
    v_pk_fma_f32 v[18:19], v[132:133], v[106:107], v[18:19] op_sel:[1,0,0] op_sel_hi:[1,1,1]
    v_pk_fma_f32 v[20:21], v[134:135], v[108:109], v[20:21] op_sel:[1,0,0] op_sel_hi:[1,1,1]
    v_pk_fma_f32 v[22:23], v[134:135], v[110:111], v[22:23] op_sel:[1,0,0] op_sel_hi:[1,1,1]
    s_set_gpr_idx_off
A_60:
    s_sub_u32 s31, s31, 4
    s_cbranch_scc1 B_60
    v_mfma_f32_4x4x4_16b_bf16 v[116:119], v[172:173], v[178:179], 0 cbsz:4 abid:0
    v_lshlrev_b32_sdwa v136, v15, v122 dst_sel:DWORD dst_unused:UNUSED_PAD src0_sel:DWORD src1_sel:WORD_1
    s_waitcnt vmcnt(4)
    v_mfma_f32_4x4x4_16b_bf16 v[104:107], v[142:143], v[84:85], 0 cbsz:4 abid:15
    v_readlane_b32 s50, v165, 2
    v_mfma_f32_4x4x4_16b_bf16 v[108:111], v[142:143], v[86:87], 0 cbsz:4 abid:15
    v_lshlrev_b32_sdwa v137, v15, v123 dst_sel:DWORD dst_unused:UNUSED_PAD src0_sel:DWORD src1_sel:WORD_1
    ds_read_u16_d16_hi v132, v136 offset:32768
    ds_read_u16_d16_hi v133, v137 offset:32768
    v_cvt_pk_bf16_f32 v140, v148, v152
    v_cvt_pk_bf16_f32 v141, v156, v160
    s_and_b32 s33, s50, s34
    buffer_load_dwordx4 v[72:75], v1, s[12:15], s33 offen
    s_waitcnt lgkmcnt(2)
    s_set_gpr_idx_on s60, 0xc
    v_pk_fma_f32 v[16:17], v[128:129], v[96:97], v[16:17] op_sel:[0,0,0] op_sel_hi:[0,1,1]
    v_pk_fma_f32 v[18:19], v[128:129], v[98:99], v[18:19] op_sel:[0,0,0] op_sel_hi:[0,1,1]
    v_pk_fma_f32 v[20:21], v[130:131], v[100:101], v[20:21] op_sel:[0,0,0] op_sel_hi:[0,1,1]
    v_pk_fma_f32 v[22:23], v[130:131], v[102:103], v[22:23] op_sel:[0,0,0] op_sel_hi:[0,1,1]
    s_set_gpr_idx_off
    v_lshlrev_b32_sdwa v138, v15, v126 dst_sel:DWORD dst_unused:UNUSED_PAD src0_sel:DWORD src1_sel:WORD_1
    s_waitcnt vmcnt(4)
    v_mfma_f32_4x4x4_16b_bf16 v[96:99], v[144:145], v[88:89], 0 cbsz:4 abid:15
    v_readlane_b32 s51, v165, 3
    v_mfma_f32_4x4x4_16b_bf16 v[100:103], v[144:145], v[90:91], 0 cbsz:4 abid:15
    v_lshlrev_b32_sdwa v139, v15, v127 dst_sel:DWORD dst_unused:UNUSED_PAD src0_sel:DWORD src1_sel:WORD_1
    ds_read_u16_d16_hi v134, v138 offset:32768
    ds_read_u16_d16_hi v135, v139 offset:32768
    v_cvt_pk_bf16_f32 v142, v149, v153
    v_cvt_pk_bf16_f32 v143, v157, v161
    s_and_b32 s33, s51, s34
    buffer_load_dwordx4 v[76:79], v1, s[12:15], s33 offen
    s_set_gpr_idx_on s61, 0xc
    v_pk_fma_f32 v[16:17], v[128:129], v[104:105], v[16:17] op_sel:[1,0,0] op_sel_hi:[1,1,1]
    v_pk_fma_f32 v[18:19], v[128:129], v[106:107], v[18:19] op_sel:[1,0,0] op_sel_hi:[1,1,1]
    v_pk_fma_f32 v[20:21], v[130:131], v[108:109], v[20:21] op_sel:[1,0,0] op_sel_hi:[1,1,1]
    v_pk_fma_f32 v[22:23], v[130:131], v[110:111], v[22:23] op_sel:[1,0,0] op_sel_hi:[1,1,1]
    s_set_gpr_idx_off
    v_mfma_f32_4x4x4_16b_bf16 v[120:123], v[172:173], v[176:177], 0 cbsz:4 abid:1
    v_lshlrev_b32_sdwa v136, v15, v112 dst_sel:DWORD dst_unused:UNUSED_PAD src0_sel:DWORD src1_sel:WORD_1
    s_waitcnt vmcnt(4)
    v_mfma_f32_4x4x4_16b_bf16 v[104:107], v[146:147], v[92:93], 0 cbsz:4 abid:15
    v_readlane_b32 s52, v165, 4
    v_mfma_f32_4x4x4_16b_bf16 v[108:111], v[146:147], v[94:95], 0 cbsz:4 abid:15
    v_lshlrev_b32_sdwa v137, v15, v113 dst_sel:DWORD dst_unused:UNUSED_PAD src0_sel:DWORD src1_sel:WORD_1
    ds_read_u16_d16_hi v128, v136 offset:32768
    ds_read_u16_d16_hi v129, v137 offset:32768
    v_cvt_pk_bf16_f32 v144, v150, v154
    v_cvt_pk_bf16_f32 v145, v158, v162
    s_and_b32 s33, s52, s34
    buffer_load_dwordx4 v[80:83], v1, s[12:15], s33 offen
    s_waitcnt lgkmcnt(2)
    s_set_gpr_idx_on s62, 0xc
    v_pk_fma_f32 v[16:17], v[132:133], v[96:97], v[16:17] op_sel:[0,0,0] op_sel_hi:[0,1,1]
    v_pk_fma_f32 v[18:19], v[132:133], v[98:99], v[18:19] op_sel:[0,0,0] op_sel_hi:[0,1,1]
    v_pk_fma_f32 v[20:21], v[134:135], v[100:101], v[20:21] op_sel:[0,0,0] op_sel_hi:[0,1,1]
    v_pk_fma_f32 v[22:23], v[134:135], v[102:103], v[22:23] op_sel:[0,0,0] op_sel_hi:[0,1,1]
    s_set_gpr_idx_off
    v_lshlrev_b32_sdwa v138, v15, v116 dst_sel:DWORD dst_unused:UNUSED_PAD src0_sel:DWORD src1_sel:WORD_1
    s_waitcnt vmcnt(4)
    v_mfma_f32_4x4x4_16b_bf16 v[96:99], v[140:141], v[64:65], 0 cbsz:4 abid:0
    v_readlane_b32 s53, v165, 5
    v_mfma_f32_4x4x4_16b_bf16 v[100:103], v[140:141], v[66:67], 0 cbsz:4 abid:0
    v_lshlrev_b32_sdwa v139, v15, v117 dst_sel:DWORD dst_unused:UNUSED_PAD src0_sel:DWORD src1_sel:WORD_1
    ds_read_u16_d16_hi v130, v138 offset:32768
    ds_read_u16_d16_hi v131, v139 offset:32768
    v_cvt_pk_bf16_f32 v146, v151, v155
    v_cvt_pk_bf16_f32 v147, v159, v163
    s_and_b32 s33, s53, s34
    buffer_load_dwordx4 v[84:87], v1, s[12:15], s33 offen
    s_set_gpr_idx_on s63, 0xc
    v_pk_fma_f32 v[16:17], v[132:133], v[104:105], v[16:17] op_sel:[1,0,0] op_sel_hi:[1,1,1]
    v_pk_fma_f32 v[18:19], v[132:133], v[106:107], v[18:19] op_sel:[1,0,0] op_sel_hi:[1,1,1]
    v_pk_fma_f32 v[20:21], v[134:135], v[108:109], v[20:21] op_sel:[1,0,0] op_sel_hi:[1,1,1]
    v_pk_fma_f32 v[22:23], v[134:135], v[110:111], v[22:23] op_sel:[1,0,0] op_sel_hi:[1,1,1]
    s_set_gpr_idx_off
    v_mov_b32 v164, v165
    s_branch A_0
B_0:
    buffer_load_dwordx4 v[188:191], v1, s[16:19], s10 offen offset:0 sc1
    buffer_load_dwordx4 v[192:195], v1, s[16:19], s10 offen offset:1024 sc1
    buffer_load_dwordx4 v[196:199], v1, s[16:19], s10 offen offset:2048 sc1
    buffer_load_dwordx4 v[200:203], v1, s[16:19], s10 offen offset:3072 sc1
    buffer_load_dwordx4 v[204:207], v1, s[16:19], s11 offen offset:0 sc1
    buffer_load_dwordx4 v[208:211], v1, s[16:19], s11 offen offset:1024 sc1
    buffer_load_dwordx4 v[212:215], v1, s[16:19], s11 offen offset:2048 sc1
    buffer_load_dwordx4 v[216:219], v1, s[16:19], s11 offen offset:3072 sc1
    s_sub_u32 s32, s32, 1
    s_cbranch_scc1 MAIN_DONE
    v_mfma_f32_4x4x4_16b_bf16 v[124:127], v[172:173], v[178:179], 0 cbsz:4 abid:1
    v_lshlrev_b32_sdwa v136, v15, v114 dst_sel:DWORD dst_unused:UNUSED_PAD src0_sel:DWORD src1_sel:WORD_1
    s_waitcnt vmcnt(12)
    v_mfma_f32_4x4x4_16b_bf16 v[104:107], v[142:143], v[68:69], 0 cbsz:4 abid:0
    s_nop 0
    v_mfma_f32_4x4x4_16b_bf16 v[108:111], v[142:143], v[70:71], 0 cbsz:4 abid:0
    v_lshlrev_b32_sdwa v137, v15, v115 dst_sel:DWORD dst_unused:UNUSED_PAD src0_sel:DWORD src1_sel:WORD_1
    ds_read_u16_d16_hi v132, v136 offset:32768
    ds_read_u16_d16_hi v133, v137 offset:32768
    s_waitcnt lgkmcnt(2)
    s_set_gpr_idx_on s48, 0xc
    v_pk_fma_f32 v[16:17], v[128:129], v[96:97], v[16:17] op_sel:[0,0,0] op_sel_hi:[0,1,1]
    v_pk_fma_f32 v[18:19], v[128:129], v[98:99], v[18:19] op_sel:[0,0,0] op_sel_hi:[0,1,1]
    v_pk_fma_f32 v[20:21], v[130:131], v[100:101], v[20:21] op_sel:[0,0,0] op_sel_hi:[0,1,1]
    v_pk_fma_f32 v[22:23], v[130:131], v[102:103], v[22:23] op_sel:[0,0,0] op_sel_hi:[0,1,1]
    s_set_gpr_idx_off
    s_sub_u32 s32, s32, 1
    s_cbranch_scc1 MAIN_DONE
    v_lshlrev_b32_sdwa v138, v15, v118 dst_sel:DWORD dst_unused:UNUSED_PAD src0_sel:DWORD src1_sel:WORD_1
    s_waitcnt vmcnt(11)
    v_mfma_f32_4x4x4_16b_bf16 v[96:99], v[144:145], v[72:73], 0 cbsz:4 abid:0
    s_nop 0
    v_mfma_f32_4x4x4_16b_bf16 v[100:103], v[144:145], v[74:75], 0 cbsz:4 abid:0
    v_lshlrev_b32_sdwa v139, v15, v119 dst_sel:DWORD dst_unused:UNUSED_PAD src0_sel:DWORD src1_sel:WORD_1
    ds_read_u16_d16_hi v134, v138 offset:32768
    ds_read_u16_d16_hi v135, v139 offset:32768
    s_set_gpr_idx_on s49, 0xc
    v_pk_fma_f32 v[16:17], v[128:129], v[104:105], v[16:17] op_sel:[1,0,0] op_sel_hi:[1,1,1]
    v_pk_fma_f32 v[18:19], v[128:129], v[106:107], v[18:19] op_sel:[1,0,0] op_sel_hi:[1,1,1]
    v_pk_fma_f32 v[20:21], v[130:131], v[108:109], v[20:21] op_sel:[1,0,0] op_sel_hi:[1,1,1]
    v_pk_fma_f32 v[22:23], v[130:131], v[110:111], v[22:23] op_sel:[1,0,0] op_sel_hi:[1,1,1]
    s_set_gpr_idx_off
    s_sub_u32 s32, s32, 1
    s_cbranch_scc1 MAIN_DONE
    v_mfma_f32_4x4x4_16b_bf16 v[112:115], v[172:173], v[176:177], 0 cbsz:4 abid:2
    v_lshlrev_b32_sdwa v136, v15, v120 dst_sel:DWORD dst_unused:UNUSED_PAD src0_sel:DWORD src1_sel:WORD_1
    s_waitcnt vmcnt(10)
    v_mfma_f32_4x4x4_16b_bf16 v[104:107], v[146:147], v[76:77], 0 cbsz:4 abid:0
    s_nop 0
    v_mfma_f32_4x4x4_16b_bf16 v[108:111], v[146:147], v[78:79], 0 cbsz:4 abid:0
    v_lshlrev_b32_sdwa v137, v15, v121 dst_sel:DWORD dst_unused:UNUSED_PAD src0_sel:DWORD src1_sel:WORD_1
    ds_read_u16_d16_hi v128, v136 offset:32768
    ds_read_u16_d16_hi v129, v137 offset:32768
    s_waitcnt lgkmcnt(2)
    s_set_gpr_idx_on s50, 0xc
    v_pk_fma_f32 v[16:17], v[132:133], v[96:97], v[16:17] op_sel:[0,0,0] op_sel_hi:[0,1,1]
    v_pk_fma_f32 v[18:19], v[132:133], v[98:99], v[18:19] op_sel:[0,0,0] op_sel_hi:[0,1,1]
    v_pk_fma_f32 v[20:21], v[134:135], v[100:101], v[20:21] op_sel:[0,0,0] op_sel_hi:[0,1,1]
    v_pk_fma_f32 v[22:23], v[134:135], v[102:103], v[22:23] op_sel:[0,0,0] op_sel_hi:[0,1,1]
    s_set_gpr_idx_off
    s_sub_u32 s32, s32, 1
    s_cbranch_scc1 MAIN_DONE
    v_lshlrev_b32_sdwa v138, v15, v124 dst_sel:DWORD dst_unused:UNUSED_PAD src0_sel:DWORD src1_sel:WORD_1
    s_waitcnt vmcnt(9)
    v_mfma_f32_4x4x4_16b_bf16 v[96:99], v[140:141], v[80:81], 0 cbsz:4 abid:1
    s_nop 0
    v_mfma_f32_4x4x4_16b_bf16 v[100:103], v[140:141], v[82:83], 0 cbsz:4 abid:1
    v_lshlrev_b32_sdwa v139, v15, v125 dst_sel:DWORD dst_unused:UNUSED_PAD src0_sel:DWORD src1_sel:WORD_1
    ds_read_u16_d16_hi v130, v138 offset:32768
    ds_read_u16_d16_hi v131, v139 offset:32768
    s_set_gpr_idx_on s51, 0xc
    v_pk_fma_f32 v[16:17], v[132:133], v[104:105], v[16:17] op_sel:[1,0,0] op_sel_hi:[1,1,1]
    v_pk_fma_f32 v[18:19], v[132:133], v[106:107], v[18:19] op_sel:[1,0,0] op_sel_hi:[1,1,1]
    v_pk_fma_f32 v[20:21], v[134:135], v[108:109], v[20:21] op_sel:[1,0,0] op_sel_hi:[1,1,1]
    v_pk_fma_f32 v[22:23], v[134:135], v[110:111], v[22:23] op_sel:[1,0,0] op_sel_hi:[1,1,1]
    s_set_gpr_idx_off
    s_sub_u32 s32, s32, 1
    s_cbranch_scc1 MAIN_DONE
    v_mfma_f32_4x4x4_16b_bf16 v[116:119], v[172:173], v[178:179], 0 cbsz:4 abid:2
    v_lshlrev_b32_sdwa v136, v15, v122 dst_sel:DWORD dst_unused:UNUSED_PAD src0_sel:DWORD src1_sel:WORD_1
    s_waitcnt vmcnt(8)
    v_mfma_f32_4x4x4_16b_bf16 v[104:107], v[142:143], v[84:85], 0 cbsz:4 abid:1
    s_nop 0
    v_mfma_f32_4x4x4_16b_bf16 v[108:111], v[142:143], v[86:87], 0 cbsz:4 abid:1
    v_lshlrev_b32_sdwa v137, v15, v123 dst_sel:DWORD dst_unused:UNUSED_PAD src0_sel:DWORD src1_sel:WORD_1
    ds_read_u16_d16_hi v132, v136 offset:32768
    ds_read_u16_d16_hi v133, v137 offset:32768
    s_waitcnt lgkmcnt(2)
    s_set_gpr_idx_on s52, 0xc
    v_pk_fma_f32 v[16:17], v[128:129], v[96:97], v[16:17] op_sel:[0,0,0] op_sel_hi:[0,1,1]
    v_pk_fma_f32 v[18:19], v[128:129], v[98:99], v[18:19] op_sel:[0,0,0] op_sel_hi:[0,1,1]
    v_pk_fma_f32 v[20:21], v[130:131], v[100:101], v[20:21] op_sel:[0,0,0] op_sel_hi:[0,1,1]
    v_pk_fma_f32 v[22:23], v[130:131], v[102:103], v[22:23] op_sel:[0,0,0] op_sel_hi:[0,1,1]
    s_set_gpr_idx_off
    s_sub_u32 s32, s32, 1
    s_cbranch_scc1 MAIN_DONE
    v_lshlrev_b32_sdwa v138, v15, v126 dst_sel:DWORD dst_unused:UNUSED_PAD src0_sel:DWORD src1_sel:WORD_1
    v_mfma_f32_4x4x4_16b_bf16 v[96:99], v[144:145], v[88:89], 0 cbsz:4 abid:1
    s_nop 0
    v_mfma_f32_4x4x4_16b_bf16 v[100:103], v[144:145], v[90:91], 0 cbsz:4 abid:1
    v_lshlrev_b32_sdwa v139, v15, v127 dst_sel:DWORD dst_unused:UNUSED_PAD src0_sel:DWORD src1_sel:WORD_1
    ds_read_u16_d16_hi v134, v138 offset:32768
    ds_read_u16_d16_hi v135, v139 offset:32768
    s_set_gpr_idx_on s53, 0xc
    v_pk_fma_f32 v[16:17], v[128:129], v[104:105], v[16:17] op_sel:[1,0,0] op_sel_hi:[1,1,1]
    v_pk_fma_f32 v[18:19], v[128:129], v[106:107], v[18:19] op_sel:[1,0,0] op_sel_hi:[1,1,1]
    v_pk_fma_f32 v[20:21], v[130:131], v[108:109], v[20:21] op_sel:[1,0,0] op_sel_hi:[1,1,1]
    v_pk_fma_f32 v[22:23], v[130:131], v[110:111], v[22:23] op_sel:[1,0,0] op_sel_hi:[1,1,1]
    s_set_gpr_idx_off
    s_branch MAIN_DONE
B_4:
    buffer_load_dwordx4 v[188:191], v1, s[16:19], s10 offen offset:0 sc1
    buffer_load_dwordx4 v[192:195], v1, s[16:19], s10 offen offset:1024 sc1
    buffer_load_dwordx4 v[196:199], v1, s[16:19], s10 offen offset:2048 sc1
    buffer_load_dwordx4 v[200:203], v1, s[16:19], s10 offen offset:3072 sc1
    buffer_load_dwordx4 v[204:207], v1, s[16:19], s11 offen offset:0 sc1
    buffer_load_dwordx4 v[208:211], v1, s[16:19], s11 offen offset:1024 sc1
    buffer_load_dwordx4 v[212:215], v1, s[16:19], s11 offen offset:2048 sc1
    buffer_load_dwordx4 v[216:219], v1, s[16:19], s11 offen offset:3072 sc1
    s_sub_u32 s32, s32, 1
    s_cbranch_scc1 MAIN_DONE
    v_mfma_f32_4x4x4_16b_bf16 v[116:119], v[172:173], v[178:179], 0 cbsz:4 abid:2
    v_lshlrev_b32_sdwa v136, v15, v122 dst_sel:DWORD dst_unused:UNUSED_PAD src0_sel:DWORD src1_sel:WORD_1
    s_waitcnt vmcnt(12)
    v_mfma_f32_4x4x4_16b_bf16 v[104:107], v[142:143], v[84:85], 0 cbsz:4 abid:1
    s_nop 0
    v_mfma_f32_4x4x4_16b_bf16 v[108:111], v[142:143], v[86:87], 0 cbsz:4 abid:1
    v_lshlrev_b32_sdwa v137, v15, v123 dst_sel:DWORD dst_unused:UNUSED_PAD src0_sel:DWORD src1_sel:WORD_1
    ds_read_u16_d16_hi v132, v136 offset:32768
    ds_read_u16_d16_hi v133, v137 offset:32768
    s_waitcnt lgkmcnt(2)
    s_set_gpr_idx_on s52, 0xc
    v_pk_fma_f32 v[16:17], v[128:129], v[96:97], v[16:17] op_sel:[0,0,0] op_sel_hi:[0,1,1]
    v_pk_fma_f32 v[18:19], v[128:129], v[98:99], v[18:19] op_sel:[0,0,0] op_sel_hi:[0,1,1]
    v_pk_fma_f32 v[20:21], v[130:131], v[100:101], v[20:21] op_sel:[0,0,0] op_sel_hi:[0,1,1]
    v_pk_fma_f32 v[22:23], v[130:131], v[102:103], v[22:23] op_sel:[0,0,0] op_sel_hi:[0,1,1]
    s_set_gpr_idx_off
    s_sub_u32 s32, s32, 1
    s_cbranch_scc1 MAIN_DONE
    v_lshlrev_b32_sdwa v138, v15, v126 dst_sel:DWORD dst_unused:UNUSED_PAD src0_sel:DWORD src1_sel:WORD_1
    s_waitcnt vmcnt(11)
    v_mfma_f32_4x4x4_16b_bf16 v[96:99], v[144:145], v[88:89], 0 cbsz:4 abid:1
    s_nop 0
    v_mfma_f32_4x4x4_16b_bf16 v[100:103], v[144:145], v[90:91], 0 cbsz:4 abid:1
    v_lshlrev_b32_sdwa v139, v15, v127 dst_sel:DWORD dst_unused:UNUSED_PAD src0_sel:DWORD src1_sel:WORD_1
    ds_read_u16_d16_hi v134, v138 offset:32768
    ds_read_u16_d16_hi v135, v139 offset:32768
    s_set_gpr_idx_on s53, 0xc
    v_pk_fma_f32 v[16:17], v[128:129], v[104:105], v[16:17] op_sel:[1,0,0] op_sel_hi:[1,1,1]
    v_pk_fma_f32 v[18:19], v[128:129], v[106:107], v[18:19] op_sel:[1,0,0] op_sel_hi:[1,1,1]
    v_pk_fma_f32 v[20:21], v[130:131], v[108:109], v[20:21] op_sel:[1,0,0] op_sel_hi:[1,1,1]
    v_pk_fma_f32 v[22:23], v[130:131], v[110:111], v[22:23] op_sel:[1,0,0] op_sel_hi:[1,1,1]
    s_set_gpr_idx_off
    s_sub_u32 s32, s32, 1
    s_cbranch_scc1 MAIN_DONE
    v_mfma_f32_4x4x4_16b_bf16 v[120:123], v[172:173], v[176:177], 0 cbsz:4 abid:3
    v_lshlrev_b32_sdwa v136, v15, v112 dst_sel:DWORD dst_unused:UNUSED_PAD src0_sel:DWORD src1_sel:WORD_1
    s_waitcnt vmcnt(10)
    v_mfma_f32_4x4x4_16b_bf16 v[104:107], v[146:147], v[92:93], 0 cbsz:4 abid:1
    s_nop 0
    v_mfma_f32_4x4x4_16b_bf16 v[108:111], v[146:147], v[94:95], 0 cbsz:4 abid:1
    v_lshlrev_b32_sdwa v137, v15, v113 dst_sel:DWORD dst_unused:UNUSED_PAD src0_sel:DWORD src1_sel:WORD_1
    ds_read_u16_d16_hi v128, v136 offset:32768
    ds_read_u16_d16_hi v129, v137 offset:32768
    s_waitcnt lgkmcnt(2)
    s_set_gpr_idx_on s54, 0xc
    v_pk_fma_f32 v[16:17], v[132:133], v[96:97], v[16:17] op_sel:[0,0,0] op_sel_hi:[0,1,1]
    v_pk_fma_f32 v[18:19], v[132:133], v[98:99], v[18:19] op_sel:[0,0,0] op_sel_hi:[0,1,1]
    v_pk_fma_f32 v[20:21], v[134:135], v[100:101], v[20:21] op_sel:[0,0,0] op_sel_hi:[0,1,1]
    v_pk_fma_f32 v[22:23], v[134:135], v[102:103], v[22:23] op_sel:[0,0,0] op_sel_hi:[0,1,1]
    s_set_gpr_idx_off
    s_sub_u32 s32, s32, 1
    s_cbranch_scc1 MAIN_DONE
    v_lshlrev_b32_sdwa v138, v15, v116 dst_sel:DWORD dst_unused:UNUSED_PAD src0_sel:DWORD src1_sel:WORD_1
    s_waitcnt vmcnt(9)
    v_mfma_f32_4x4x4_16b_bf16 v[96:99], v[140:141], v[64:65], 0 cbsz:4 abid:2
    s_nop 0
    v_mfma_f32_4x4x4_16b_bf16 v[100:103], v[140:141], v[66:67], 0 cbsz:4 abid:2
    v_lshlrev_b32_sdwa v139, v15, v117 dst_sel:DWORD dst_unused:UNUSED_PAD src0_sel:DWORD src1_sel:WORD_1
    ds_read_u16_d16_hi v130, v138 offset:32768
    ds_read_u16_d16_hi v131, v139 offset:32768
    s_set_gpr_idx_on s55, 0xc
    v_pk_fma_f32 v[16:17], v[132:133], v[104:105], v[16:17] op_sel:[1,0,0] op_sel_hi:[1,1,1]
    v_pk_fma_f32 v[18:19], v[132:133], v[106:107], v[18:19] op_sel:[1,0,0] op_sel_hi:[1,1,1]
    v_pk_fma_f32 v[20:21], v[134:135], v[108:109], v[20:21] op_sel:[1,0,0] op_sel_hi:[1,1,1]
    v_pk_fma_f32 v[22:23], v[134:135], v[110:111], v[22:23] op_sel:[1,0,0] op_sel_hi:[1,1,1]
    s_set_gpr_idx_off
    s_sub_u32 s32, s32, 1
    s_cbranch_scc1 MAIN_DONE
    v_mfma_f32_4x4x4_16b_bf16 v[124:127], v[172:173], v[178:179], 0 cbsz:4 abid:3
    v_lshlrev_b32_sdwa v136, v15, v114 dst_sel:DWORD dst_unused:UNUSED_PAD src0_sel:DWORD src1_sel:WORD_1
    s_waitcnt vmcnt(8)
    v_mfma_f32_4x4x4_16b_bf16 v[104:107], v[142:143], v[68:69], 0 cbsz:4 abid:2
    s_nop 0
    v_mfma_f32_4x4x4_16b_bf16 v[108:111], v[142:143], v[70:71], 0 cbsz:4 abid:2
    v_lshlrev_b32_sdwa v137, v15, v115 dst_sel:DWORD dst_unused:UNUSED_PAD src0_sel:DWORD src1_sel:WORD_1
    ds_read_u16_d16_hi v132, v136 offset:32768
    ds_read_u16_d16_hi v133, v137 offset:32768
    s_waitcnt lgkmcnt(2)
    s_set_gpr_idx_on s56, 0xc
    v_pk_fma_f32 v[16:17], v[128:129], v[96:97], v[16:17] op_sel:[0,0,0] op_sel_hi:[0,1,1]
    v_pk_fma_f32 v[18:19], v[128:129], v[98:99], v[18:19] op_sel:[0,0,0] op_sel_hi:[0,1,1]
    v_pk_fma_f32 v[20:21], v[130:131], v[100:101], v[20:21] op_sel:[0,0,0] op_sel_hi:[0,1,1]
    v_pk_fma_f32 v[22:23], v[130:131], v[102:103], v[22:23] op_sel:[0,0,0] op_sel_hi:[0,1,1]
    s_set_gpr_idx_off
    s_sub_u32 s32, s32, 1
    s_cbranch_scc1 MAIN_DONE
    v_lshlrev_b32_sdwa v138, v15, v118 dst_sel:DWORD dst_unused:UNUSED_PAD src0_sel:DWORD src1_sel:WORD_1
    v_mfma_f32_4x4x4_16b_bf16 v[96:99], v[144:145], v[72:73], 0 cbsz:4 abid:2
    s_nop 0
    v_mfma_f32_4x4x4_16b_bf16 v[100:103], v[144:145], v[74:75], 0 cbsz:4 abid:2
    v_lshlrev_b32_sdwa v139, v15, v119 dst_sel:DWORD dst_unused:UNUSED_PAD src0_sel:DWORD src1_sel:WORD_1
    ds_read_u16_d16_hi v134, v138 offset:32768
    ds_read_u16_d16_hi v135, v139 offset:32768
    s_set_gpr_idx_on s57, 0xc
    v_pk_fma_f32 v[16:17], v[128:129], v[104:105], v[16:17] op_sel:[1,0,0] op_sel_hi:[1,1,1]
    v_pk_fma_f32 v[18:19], v[128:129], v[106:107], v[18:19] op_sel:[1,0,0] op_sel_hi:[1,1,1]
    v_pk_fma_f32 v[20:21], v[130:131], v[108:109], v[20:21] op_sel:[1,0,0] op_sel_hi:[1,1,1]
    v_pk_fma_f32 v[22:23], v[130:131], v[110:111], v[22:23] op_sel:[1,0,0] op_sel_hi:[1,1,1]
    s_set_gpr_idx_off
    s_branch MAIN_DONE
B_8:
    buffer_load_dwordx4 v[188:191], v1, s[16:19], s10 offen offset:0 sc1
    buffer_load_dwordx4 v[192:195], v1, s[16:19], s10 offen offset:1024 sc1
    buffer_load_dwordx4 v[196:199], v1, s[16:19], s10 offen offset:2048 sc1
    buffer_load_dwordx4 v[200:203], v1, s[16:19], s10 offen offset:3072 sc1
    buffer_load_dwordx4 v[204:207], v1, s[16:19], s11 offen offset:0 sc1
    buffer_load_dwordx4 v[208:211], v1, s[16:19], s11 offen offset:1024 sc1
    buffer_load_dwordx4 v[212:215], v1, s[16:19], s11 offen offset:2048 sc1
    buffer_load_dwordx4 v[216:219], v1, s[16:19], s11 offen offset:3072 sc1
    s_sub_u32 s32, s32, 1
    s_cbranch_scc1 MAIN_DONE
    v_mfma_f32_4x4x4_16b_bf16 v[124:127], v[172:173], v[178:179], 0 cbsz:4 abid:3
    v_lshlrev_b32_sdwa v136, v15, v114 dst_sel:DWORD dst_unused:UNUSED_PAD src0_sel:DWORD src1_sel:WORD_1
    s_waitcnt vmcnt(12)
    v_mfma_f32_4x4x4_16b_bf16 v[104:107], v[142:143], v[68:69], 0 cbsz:4 abid:2
    s_nop 0
    v_mfma_f32_4x4x4_16b_bf16 v[108:111], v[142:143], v[70:71], 0 cbsz:4 abid:2
    v_lshlrev_b32_sdwa v137, v15, v115 dst_sel:DWORD dst_unused:UNUSED_PAD src0_sel:DWORD src1_sel:WORD_1
    ds_read_u16_d16_hi v132, v136 offset:32768
    ds_read_u16_d16_hi v133, v137 offset:32768
    s_waitcnt lgkmcnt(2)
    s_set_gpr_idx_on s56, 0xc
    v_pk_fma_f32 v[16:17], v[128:129], v[96:97], v[16:17] op_sel:[0,0,0] op_sel_hi:[0,1,1]
    v_pk_fma_f32 v[18:19], v[128:129], v[98:99], v[18:19] op_sel:[0,0,0] op_sel_hi:[0,1,1]
    v_pk_fma_f32 v[20:21], v[130:131], v[100:101], v[20:21] op_sel:[0,0,0] op_sel_hi:[0,1,1]
    v_pk_fma_f32 v[22:23], v[130:131], v[102:103], v[22:23] op_sel:[0,0,0] op_sel_hi:[0,1,1]
    s_set_gpr_idx_off
    s_sub_u32 s32, s32, 1
    s_cbranch_scc1 MAIN_DONE
    v_lshlrev_b32_sdwa v138, v15, v118 dst_sel:DWORD dst_unused:UNUSED_PAD src0_sel:DWORD src1_sel:WORD_1
    s_waitcnt vmcnt(11)
    v_mfma_f32_4x4x4_16b_bf16 v[96:99], v[144:145], v[72:73], 0 cbsz:4 abid:2
    s_nop 0
    v_mfma_f32_4x4x4_16b_bf16 v[100:103], v[144:145], v[74:75], 0 cbsz:4 abid:2
    v_lshlrev_b32_sdwa v139, v15, v119 dst_sel:DWORD dst_unused:UNUSED_PAD src0_sel:DWORD src1_sel:WORD_1
    ds_read_u16_d16_hi v134, v138 offset:32768
    ds_read_u16_d16_hi v135, v139 offset:32768
    s_set_gpr_idx_on s57, 0xc
    v_pk_fma_f32 v[16:17], v[128:129], v[104:105], v[16:17] op_sel:[1,0,0] op_sel_hi:[1,1,1]
    v_pk_fma_f32 v[18:19], v[128:129], v[106:107], v[18:19] op_sel:[1,0,0] op_sel_hi:[1,1,1]
    v_pk_fma_f32 v[20:21], v[130:131], v[108:109], v[20:21] op_sel:[1,0,0] op_sel_hi:[1,1,1]
    v_pk_fma_f32 v[22:23], v[130:131], v[110:111], v[22:23] op_sel:[1,0,0] op_sel_hi:[1,1,1]
    s_set_gpr_idx_off
    s_sub_u32 s32, s32, 1
    s_cbranch_scc1 MAIN_DONE
    v_mfma_f32_4x4x4_16b_bf16 v[112:115], v[172:173], v[176:177], 0 cbsz:4 abid:4
    v_lshlrev_b32_sdwa v136, v15, v120 dst_sel:DWORD dst_unused:UNUSED_PAD src0_sel:DWORD src1_sel:WORD_1
    s_waitcnt vmcnt(10)
    v_mfma_f32_4x4x4_16b_bf16 v[104:107], v[146:147], v[76:77], 0 cbsz:4 abid:2
    s_nop 0
    v_mfma_f32_4x4x4_16b_bf16 v[108:111], v[146:147], v[78:79], 0 cbsz:4 abid:2
    v_lshlrev_b32_sdwa v137, v15, v121 dst_sel:DWORD dst_unused:UNUSED_PAD src0_sel:DWORD src1_sel:WORD_1
    ds_read_u16_d16_hi v128, v136 offset:32768
    ds_read_u16_d16_hi v129, v137 offset:32768
    s_waitcnt lgkmcnt(2)
    s_set_gpr_idx_on s58, 0xc
    v_pk_fma_f32 v[16:17], v[132:133], v[96:97], v[16:17] op_sel:[0,0,0] op_sel_hi:[0,1,1]
    v_pk_fma_f32 v[18:19], v[132:133], v[98:99], v[18:19] op_sel:[0,0,0] op_sel_hi:[0,1,1]
    v_pk_fma_f32 v[20:21], v[134:135], v[100:101], v[20:21] op_sel:[0,0,0] op_sel_hi:[0,1,1]
    v_pk_fma_f32 v[22:23], v[134:135], v[102:103], v[22:23] op_sel:[0,0,0] op_sel_hi:[0,1,1]
    s_set_gpr_idx_off
    s_sub_u32 s32, s32, 1
    s_cbranch_scc1 MAIN_DONE
    v_lshlrev_b32_sdwa v138, v15, v124 dst_sel:DWORD dst_unused:UNUSED_PAD src0_sel:DWORD src1_sel:WORD_1
    s_waitcnt vmcnt(9)
    v_mfma_f32_4x4x4_16b_bf16 v[96:99], v[140:141], v[80:81], 0 cbsz:4 abid:3
    s_nop 0
    v_mfma_f32_4x4x4_16b_bf16 v[100:103], v[140:141], v[82:83], 0 cbsz:4 abid:3
    v_lshlrev_b32_sdwa v139, v15, v125 dst_sel:DWORD dst_unused:UNUSED_PAD src0_sel:DWORD src1_sel:WORD_1
    ds_read_u16_d16_hi v130, v138 offset:32768
    ds_read_u16_d16_hi v131, v139 offset:32768
    s_set_gpr_idx_on s59, 0xc
    v_pk_fma_f32 v[16:17], v[132:133], v[104:105], v[16:17] op_sel:[1,0,0] op_sel_hi:[1,1,1]
    v_pk_fma_f32 v[18:19], v[132:133], v[106:107], v[18:19] op_sel:[1,0,0] op_sel_hi:[1,1,1]
    v_pk_fma_f32 v[20:21], v[134:135], v[108:109], v[20:21] op_sel:[1,0,0] op_sel_hi:[1,1,1]
    v_pk_fma_f32 v[22:23], v[134:135], v[110:111], v[22:23] op_sel:[1,0,0] op_sel_hi:[1,1,1]
    s_set_gpr_idx_off
    s_sub_u32 s32, s32, 1
    s_cbranch_scc1 MAIN_DONE
    v_mfma_f32_4x4x4_16b_bf16 v[116:119], v[172:173], v[178:179], 0 cbsz:4 abid:4
    v_lshlrev_b32_sdwa v136, v15, v122 dst_sel:DWORD dst_unused:UNUSED_PAD src0_sel:DWORD src1_sel:WORD_1
    s_waitcnt vmcnt(8)
    v_mfma_f32_4x4x4_16b_bf16 v[104:107], v[142:143], v[84:85], 0 cbsz:4 abid:3
    s_nop 0
    v_mfma_f32_4x4x4_16b_bf16 v[108:111], v[142:143], v[86:87], 0 cbsz:4 abid:3
    v_lshlrev_b32_sdwa v137, v15, v123 dst_sel:DWORD dst_unused:UNUSED_PAD src0_sel:DWORD src1_sel:WORD_1
    ds_read_u16_d16_hi v132, v136 offset:32768
    ds_read_u16_d16_hi v133, v137 offset:32768
    s_waitcnt lgkmcnt(2)
    s_set_gpr_idx_on s60, 0xc
    v_pk_fma_f32 v[16:17], v[128:129], v[96:97], v[16:17] op_sel:[0,0,0] op_sel_hi:[0,1,1]
    v_pk_fma_f32 v[18:19], v[128:129], v[98:99], v[18:19] op_sel:[0,0,0] op_sel_hi:[0,1,1]
    v_pk_fma_f32 v[20:21], v[130:131], v[100:101], v[20:21] op_sel:[0,0,0] op_sel_hi:[0,1,1]
    v_pk_fma_f32 v[22:23], v[130:131], v[102:103], v[22:23] op_sel:[0,0,0] op_sel_hi:[0,1,1]
    s_set_gpr_idx_off
    s_sub_u32 s32, s32, 1
    s_cbranch_scc1 MAIN_DONE
    v_lshlrev_b32_sdwa v138, v15, v126 dst_sel:DWORD dst_unused:UNUSED_PAD src0_sel:DWORD src1_sel:WORD_1
    v_mfma_f32_4x4x4_16b_bf16 v[96:99], v[144:145], v[88:89], 0 cbsz:4 abid:3
    s_nop 0
    v_mfma_f32_4x4x4_16b_bf16 v[100:103], v[144:145], v[90:91], 0 cbsz:4 abid:3
    v_lshlrev_b32_sdwa v139, v15, v127 dst_sel:DWORD dst_unused:UNUSED_PAD src0_sel:DWORD src1_sel:WORD_1
    ds_read_u16_d16_hi v134, v138 offset:32768
    ds_read_u16_d16_hi v135, v139 offset:32768
    s_set_gpr_idx_on s61, 0xc
    v_pk_fma_f32 v[16:17], v[128:129], v[104:105], v[16:17] op_sel:[1,0,0] op_sel_hi:[1,1,1]
    v_pk_fma_f32 v[18:19], v[128:129], v[106:107], v[18:19] op_sel:[1,0,0] op_sel_hi:[1,1,1]
    v_pk_fma_f32 v[20:21], v[130:131], v[108:109], v[20:21] op_sel:[1,0,0] op_sel_hi:[1,1,1]
    v_pk_fma_f32 v[22:23], v[130:131], v[110:111], v[22:23] op_sel:[1,0,0] op_sel_hi:[1,1,1]
    s_set_gpr_idx_off
    s_branch MAIN_DONE
B_12:
    buffer_load_dwordx4 v[188:191], v1, s[16:19], s10 offen offset:0 sc1
    buffer_load_dwordx4 v[192:195], v1, s[16:19], s10 offen offset:1024 sc1
    buffer_load_dwordx4 v[196:199], v1, s[16:19], s10 offen offset:2048 sc1
    buffer_load_dwordx4 v[200:203], v1, s[16:19], s10 offen offset:3072 sc1
    buffer_load_dwordx4 v[204:207], v1, s[16:19], s11 offen offset:0 sc1
    buffer_load_dwordx4 v[208:211], v1, s[16:19], s11 offen offset:1024 sc1
    buffer_load_dwordx4 v[212:215], v1, s[16:19], s11 offen offset:2048 sc1
    buffer_load_dwordx4 v[216:219], v1, s[16:19], s11 offen offset:3072 sc1
    s_sub_u32 s32, s32, 1
    s_cbranch_scc1 MAIN_DONE
    v_mfma_f32_4x4x4_16b_bf16 v[116:119], v[172:173], v[178:179], 0 cbsz:4 abid:4
    v_lshlrev_b32_sdwa v136, v15, v122 dst_sel:DWORD dst_unused:UNUSED_PAD src0_sel:DWORD src1_sel:WORD_1
    s_waitcnt vmcnt(12)
    v_mfma_f32_4x4x4_16b_bf16 v[104:107], v[142:143], v[84:85], 0 cbsz:4 abid:3
    s_nop 0
    v_mfma_f32_4x4x4_16b_bf16 v[108:111], v[142:143], v[86:87], 0 cbsz:4 abid:3
    v_lshlrev_b32_sdwa v137, v15, v123 dst_sel:DWORD dst_unused:UNUSED_PAD src0_sel:DWORD src1_sel:WORD_1
    ds_read_u16_d16_hi v132, v136 offset:32768
    ds_read_u16_d16_hi v133, v137 offset:32768
    s_waitcnt lgkmcnt(2)
    s_set_gpr_idx_on s60, 0xc
    v_pk_fma_f32 v[16:17], v[128:129], v[96:97], v[16:17] op_sel:[0,0,0] op_sel_hi:[0,1,1]
    v_pk_fma_f32 v[18:19], v[128:129], v[98:99], v[18:19] op_sel:[0,0,0] op_sel_hi:[0,1,1]
    v_pk_fma_f32 v[20:21], v[130:131], v[100:101], v[20:21] op_sel:[0,0,0] op_sel_hi:[0,1,1]
    v_pk_fma_f32 v[22:23], v[130:131], v[102:103], v[22:23] op_sel:[0,0,0] op_sel_hi:[0,1,1]
    s_set_gpr_idx_off
    s_sub_u32 s32, s32, 1
    s_cbranch_scc1 MAIN_DONE
    v_lshlrev_b32_sdwa v138, v15, v126 dst_sel:DWORD dst_unused:UNUSED_PAD src0_sel:DWORD src1_sel:WORD_1
    s_waitcnt vmcnt(11)
    v_mfma_f32_4x4x4_16b_bf16 v[96:99], v[144:145], v[88:89], 0 cbsz:4 abid:3
    s_nop 0
    v_mfma_f32_4x4x4_16b_bf16 v[100:103], v[144:145], v[90:91], 0 cbsz:4 abid:3
    v_lshlrev_b32_sdwa v139, v15, v127 dst_sel:DWORD dst_unused:UNUSED_PAD src0_sel:DWORD src1_sel:WORD_1
    ds_read_u16_d16_hi v134, v138 offset:32768
    ds_read_u16_d16_hi v135, v139 offset:32768
    s_set_gpr_idx_on s61, 0xc
    v_pk_fma_f32 v[16:17], v[128:129], v[104:105], v[16:17] op_sel:[1,0,0] op_sel_hi:[1,1,1]
    v_pk_fma_f32 v[18:19], v[128:129], v[106:107], v[18:19] op_sel:[1,0,0] op_sel_hi:[1,1,1]
    v_pk_fma_f32 v[20:21], v[130:131], v[108:109], v[20:21] op_sel:[1,0,0] op_sel_hi:[1,1,1]
    v_pk_fma_f32 v[22:23], v[130:131], v[110:111], v[22:23] op_sel:[1,0,0] op_sel_hi:[1,1,1]
    s_set_gpr_idx_off
    s_sub_u32 s32, s32, 1
    s_cbranch_scc1 MAIN_DONE
    v_mfma_f32_4x4x4_16b_bf16 v[120:123], v[172:173], v[176:177], 0 cbsz:4 abid:5
    v_lshlrev_b32_sdwa v136, v15, v112 dst_sel:DWORD dst_unused:UNUSED_PAD src0_sel:DWORD src1_sel:WORD_1
    s_waitcnt vmcnt(10)
    v_mfma_f32_4x4x4_16b_bf16 v[104:107], v[146:147], v[92:93], 0 cbsz:4 abid:3
    s_nop 0
    v_mfma_f32_4x4x4_16b_bf16 v[108:111], v[146:147], v[94:95], 0 cbsz:4 abid:3
    v_lshlrev_b32_sdwa v137, v15, v113 dst_sel:DWORD dst_unused:UNUSED_PAD src0_sel:DWORD src1_sel:WORD_1
    ds_read_u16_d16_hi v128, v136 offset:32768
    ds_read_u16_d16_hi v129, v137 offset:32768
    s_waitcnt lgkmcnt(2)
    s_set_gpr_idx_on s62, 0xc
    v_pk_fma_f32 v[16:17], v[132:133], v[96:97], v[16:17] op_sel:[0,0,0] op_sel_hi:[0,1,1]
    v_pk_fma_f32 v[18:19], v[132:133], v[98:99], v[18:19] op_sel:[0,0,0] op_sel_hi:[0,1,1]
    v_pk_fma_f32 v[20:21], v[134:135], v[100:101], v[20:21] op_sel:[0,0,0] op_sel_hi:[0,1,1]
    v_pk_fma_f32 v[22:23], v[134:135], v[102:103], v[22:23] op_sel:[0,0,0] op_sel_hi:[0,1,1]
    s_set_gpr_idx_off
    s_sub_u32 s32, s32, 1
    s_cbranch_scc1 MAIN_DONE
    v_lshlrev_b32_sdwa v138, v15, v116 dst_sel:DWORD dst_unused:UNUSED_PAD src0_sel:DWORD src1_sel:WORD_1
    s_waitcnt vmcnt(9)
    v_mfma_f32_4x4x4_16b_bf16 v[96:99], v[140:141], v[64:65], 0 cbsz:4 abid:4
    s_nop 0
    v_mfma_f32_4x4x4_16b_bf16 v[100:103], v[140:141], v[66:67], 0 cbsz:4 abid:4
    v_lshlrev_b32_sdwa v139, v15, v117 dst_sel:DWORD dst_unused:UNUSED_PAD src0_sel:DWORD src1_sel:WORD_1
    ds_read_u16_d16_hi v130, v138 offset:32768
    ds_read_u16_d16_hi v131, v139 offset:32768
    s_set_gpr_idx_on s63, 0xc
    v_pk_fma_f32 v[16:17], v[132:133], v[104:105], v[16:17] op_sel:[1,0,0] op_sel_hi:[1,1,1]
    v_pk_fma_f32 v[18:19], v[132:133], v[106:107], v[18:19] op_sel:[1,0,0] op_sel_hi:[1,1,1]
    v_pk_fma_f32 v[20:21], v[134:135], v[108:109], v[20:21] op_sel:[1,0,0] op_sel_hi:[1,1,1]
    v_pk_fma_f32 v[22:23], v[134:135], v[110:111], v[22:23] op_sel:[1,0,0] op_sel_hi:[1,1,1]
    s_set_gpr_idx_off
    s_sub_u32 s32, s32, 1
    s_cbranch_scc1 MAIN_DONE
    v_mfma_f32_4x4x4_16b_bf16 v[124:127], v[172:173], v[178:179], 0 cbsz:4 abid:5
    v_lshlrev_b32_sdwa v136, v15, v114 dst_sel:DWORD dst_unused:UNUSED_PAD src0_sel:DWORD src1_sel:WORD_1
    s_waitcnt vmcnt(8)
    v_mfma_f32_4x4x4_16b_bf16 v[104:107], v[142:143], v[68:69], 0 cbsz:4 abid:4
    s_nop 0
    v_mfma_f32_4x4x4_16b_bf16 v[108:111], v[142:143], v[70:71], 0 cbsz:4 abid:4
    v_lshlrev_b32_sdwa v137, v15, v115 dst_sel:DWORD dst_unused:UNUSED_PAD src0_sel:DWORD src1_sel:WORD_1
    ds_read_u16_d16_hi v132, v136 offset:32768
    ds_read_u16_d16_hi v133, v137 offset:32768
    s_waitcnt lgkmcnt(2)
    s_set_gpr_idx_on s48, 0xc
    v_pk_fma_f32 v[16:17], v[128:129], v[96:97], v[16:17] op_sel:[0,0,0] op_sel_hi:[0,1,1]
    v_pk_fma_f32 v[18:19], v[128:129], v[98:99], v[18:19] op_sel:[0,0,0] op_sel_hi:[0,1,1]
    v_pk_fma_f32 v[20:21], v[130:131], v[100:101], v[20:21] op_sel:[0,0,0] op_sel_hi:[0,1,1]
    v_pk_fma_f32 v[22:23], v[130:131], v[102:103], v[22:23] op_sel:[0,0,0] op_sel_hi:[0,1,1]
    s_set_gpr_idx_off
    s_sub_u32 s32, s32, 1
    s_cbranch_scc1 MAIN_DONE
    v_lshlrev_b32_sdwa v138, v15, v118 dst_sel:DWORD dst_unused:UNUSED_PAD src0_sel:DWORD src1_sel:WORD_1
    v_mfma_f32_4x4x4_16b_bf16 v[96:99], v[144:145], v[72:73], 0 cbsz:4 abid:4
    s_nop 0
    v_mfma_f32_4x4x4_16b_bf16 v[100:103], v[144:145], v[74:75], 0 cbsz:4 abid:4
    v_lshlrev_b32_sdwa v139, v15, v119 dst_sel:DWORD dst_unused:UNUSED_PAD src0_sel:DWORD src1_sel:WORD_1
    ds_read_u16_d16_hi v134, v138 offset:32768
    ds_read_u16_d16_hi v135, v139 offset:32768
    s_set_gpr_idx_on s49, 0xc
    v_pk_fma_f32 v[16:17], v[128:129], v[104:105], v[16:17] op_sel:[1,0,0] op_sel_hi:[1,1,1]
    v_pk_fma_f32 v[18:19], v[128:129], v[106:107], v[18:19] op_sel:[1,0,0] op_sel_hi:[1,1,1]
    v_pk_fma_f32 v[20:21], v[130:131], v[108:109], v[20:21] op_sel:[1,0,0] op_sel_hi:[1,1,1]
    v_pk_fma_f32 v[22:23], v[130:131], v[110:111], v[22:23] op_sel:[1,0,0] op_sel_hi:[1,1,1]
    s_set_gpr_idx_off
    s_branch MAIN_DONE
B_16:
    buffer_load_dwordx4 v[188:191], v1, s[16:19], s10 offen offset:0 sc1
    buffer_load_dwordx4 v[192:195], v1, s[16:19], s10 offen offset:1024 sc1
    buffer_load_dwordx4 v[196:199], v1, s[16:19], s10 offen offset:2048 sc1
    buffer_load_dwordx4 v[200:203], v1, s[16:19], s10 offen offset:3072 sc1
    buffer_load_dwordx4 v[204:207], v1, s[16:19], s11 offen offset:0 sc1
    buffer_load_dwordx4 v[208:211], v1, s[16:19], s11 offen offset:1024 sc1
    buffer_load_dwordx4 v[212:215], v1, s[16:19], s11 offen offset:2048 sc1
    buffer_load_dwordx4 v[216:219], v1, s[16:19], s11 offen offset:3072 sc1
    s_sub_u32 s32, s32, 1
    s_cbranch_scc1 MAIN_DONE
    v_mfma_f32_4x4x4_16b_bf16 v[124:127], v[172:173], v[178:179], 0 cbsz:4 abid:5
    v_lshlrev_b32_sdwa v136, v15, v114 dst_sel:DWORD dst_unused:UNUSED_PAD src0_sel:DWORD src1_sel:WORD_1
    s_waitcnt vmcnt(12)
    v_mfma_f32_4x4x4_16b_bf16 v[104:107], v[142:143], v[68:69], 0 cbsz:4 abid:4
    s_nop 0
    v_mfma_f32_4x4x4_16b_bf16 v[108:111], v[142:143], v[70:71], 0 cbsz:4 abid:4
    v_lshlrev_b32_sdwa v137, v15, v115 dst_sel:DWORD dst_unused:UNUSED_PAD src0_sel:DWORD src1_sel:WORD_1
    ds_read_u16_d16_hi v132, v136 offset:32768
    ds_read_u16_d16_hi v133, v137 offset:32768
    s_waitcnt lgkmcnt(2)
    s_set_gpr_idx_on s48, 0xc
    v_pk_fma_f32 v[16:17], v[128:129], v[96:97], v[16:17] op_sel:[0,0,0] op_sel_hi:[0,1,1]
    v_pk_fma_f32 v[18:19], v[128:129], v[98:99], v[18:19] op_sel:[0,0,0] op_sel_hi:[0,1,1]
    v_pk_fma_f32 v[20:21], v[130:131], v[100:101], v[20:21] op_sel:[0,0,0] op_sel_hi:[0,1,1]
    v_pk_fma_f32 v[22:23], v[130:131], v[102:103], v[22:23] op_sel:[0,0,0] op_sel_hi:[0,1,1]
    s_set_gpr_idx_off
    s_sub_u32 s32, s32, 1
    s_cbranch_scc1 MAIN_DONE
    v_lshlrev_b32_sdwa v138, v15, v118 dst_sel:DWORD dst_unused:UNUSED_PAD src0_sel:DWORD src1_sel:WORD_1
    s_waitcnt vmcnt(11)
    v_mfma_f32_4x4x4_16b_bf16 v[96:99], v[144:145], v[72:73], 0 cbsz:4 abid:4
    s_nop 0
    v_mfma_f32_4x4x4_16b_bf16 v[100:103], v[144:145], v[74:75], 0 cbsz:4 abid:4
    v_lshlrev_b32_sdwa v139, v15, v119 dst_sel:DWORD dst_unused:UNUSED_PAD src0_sel:DWORD src1_sel:WORD_1
    ds_read_u16_d16_hi v134, v138 offset:32768
    ds_read_u16_d16_hi v135, v139 offset:32768
    s_set_gpr_idx_on s49, 0xc
    v_pk_fma_f32 v[16:17], v[128:129], v[104:105], v[16:17] op_sel:[1,0,0] op_sel_hi:[1,1,1]
    v_pk_fma_f32 v[18:19], v[128:129], v[106:107], v[18:19] op_sel:[1,0,0] op_sel_hi:[1,1,1]
    v_pk_fma_f32 v[20:21], v[130:131], v[108:109], v[20:21] op_sel:[1,0,0] op_sel_hi:[1,1,1]
    v_pk_fma_f32 v[22:23], v[130:131], v[110:111], v[22:23] op_sel:[1,0,0] op_sel_hi:[1,1,1]
    s_set_gpr_idx_off
    s_sub_u32 s32, s32, 1
    s_cbranch_scc1 MAIN_DONE
    v_mfma_f32_4x4x4_16b_bf16 v[112:115], v[172:173], v[176:177], 0 cbsz:4 abid:6
    v_lshlrev_b32_sdwa v136, v15, v120 dst_sel:DWORD dst_unused:UNUSED_PAD src0_sel:DWORD src1_sel:WORD_1
    s_waitcnt vmcnt(10)
    v_mfma_f32_4x4x4_16b_bf16 v[104:107], v[146:147], v[76:77], 0 cbsz:4 abid:4
    s_nop 0
    v_mfma_f32_4x4x4_16b_bf16 v[108:111], v[146:147], v[78:79], 0 cbsz:4 abid:4
    v_lshlrev_b32_sdwa v137, v15, v121 dst_sel:DWORD dst_unused:UNUSED_PAD src0_sel:DWORD src1_sel:WORD_1
    ds_read_u16_d16_hi v128, v136 offset:32768
    ds_read_u16_d16_hi v129, v137 offset:32768
    s_waitcnt lgkmcnt(2)
    s_set_gpr_idx_on s50, 0xc
    v_pk_fma_f32 v[16:17], v[132:133], v[96:97], v[16:17] op_sel:[0,0,0] op_sel_hi:[0,1,1]
    v_pk_fma_f32 v[18:19], v[132:133], v[98:99], v[18:19] op_sel:[0,0,0] op_sel_hi:[0,1,1]
    v_pk_fma_f32 v[20:21], v[134:135], v[100:101], v[20:21] op_sel:[0,0,0] op_sel_hi:[0,1,1]
    v_pk_fma_f32 v[22:23], v[134:135], v[102:103], v[22:23] op_sel:[0,0,0] op_sel_hi:[0,1,1]
    s_set_gpr_idx_off
    s_sub_u32 s32, s32, 1
    s_cbranch_scc1 MAIN_DONE
    v_lshlrev_b32_sdwa v138, v15, v124 dst_sel:DWORD dst_unused:UNUSED_PAD src0_sel:DWORD src1_sel:WORD_1
    s_waitcnt vmcnt(9)
    v_mfma_f32_4x4x4_16b_bf16 v[96:99], v[140:141], v[80:81], 0 cbsz:4 abid:5
    s_nop 0
    v_mfma_f32_4x4x4_16b_bf16 v[100:103], v[140:141], v[82:83], 0 cbsz:4 abid:5
    v_lshlrev_b32_sdwa v139, v15, v125 dst_sel:DWORD dst_unused:UNUSED_PAD src0_sel:DWORD src1_sel:WORD_1
    ds_read_u16_d16_hi v130, v138 offset:32768
    ds_read_u16_d16_hi v131, v139 offset:32768
    s_set_gpr_idx_on s51, 0xc
    v_pk_fma_f32 v[16:17], v[132:133], v[104:105], v[16:17] op_sel:[1,0,0] op_sel_hi:[1,1,1]
    v_pk_fma_f32 v[18:19], v[132:133], v[106:107], v[18:19] op_sel:[1,0,0] op_sel_hi:[1,1,1]
    v_pk_fma_f32 v[20:21], v[134:135], v[108:109], v[20:21] op_sel:[1,0,0] op_sel_hi:[1,1,1]
    v_pk_fma_f32 v[22:23], v[134:135], v[110:111], v[22:23] op_sel:[1,0,0] op_sel_hi:[1,1,1]
    s_set_gpr_idx_off
    s_sub_u32 s32, s32, 1
    s_cbranch_scc1 MAIN_DONE
    v_mfma_f32_4x4x4_16b_bf16 v[116:119], v[172:173], v[178:179], 0 cbsz:4 abid:6
    v_lshlrev_b32_sdwa v136, v15, v122 dst_sel:DWORD dst_unused:UNUSED_PAD src0_sel:DWORD src1_sel:WORD_1
    s_waitcnt vmcnt(8)
    v_mfma_f32_4x4x4_16b_bf16 v[104:107], v[142:143], v[84:85], 0 cbsz:4 abid:5
    s_nop 0
    v_mfma_f32_4x4x4_16b_bf16 v[108:111], v[142:143], v[86:87], 0 cbsz:4 abid:5
    v_lshlrev_b32_sdwa v137, v15, v123 dst_sel:DWORD dst_unused:UNUSED_PAD src0_sel:DWORD src1_sel:WORD_1
    ds_read_u16_d16_hi v132, v136 offset:32768
    ds_read_u16_d16_hi v133, v137 offset:32768
    s_waitcnt lgkmcnt(2)
    s_set_gpr_idx_on s52, 0xc
    v_pk_fma_f32 v[16:17], v[128:129], v[96:97], v[16:17] op_sel:[0,0,0] op_sel_hi:[0,1,1]
    v_pk_fma_f32 v[18:19], v[128:129], v[98:99], v[18:19] op_sel:[0,0,0] op_sel_hi:[0,1,1]
    v_pk_fma_f32 v[20:21], v[130:131], v[100:101], v[20:21] op_sel:[0,0,0] op_sel_hi:[0,1,1]
    v_pk_fma_f32 v[22:23], v[130:131], v[102:103], v[22:23] op_sel:[0,0,0] op_sel_hi:[0,1,1]
    s_set_gpr_idx_off
    s_sub_u32 s32, s32, 1
    s_cbranch_scc1 MAIN_DONE
    v_lshlrev_b32_sdwa v138, v15, v126 dst_sel:DWORD dst_unused:UNUSED_PAD src0_sel:DWORD src1_sel:WORD_1
    v_mfma_f32_4x4x4_16b_bf16 v[96:99], v[144:145], v[88:89], 0 cbsz:4 abid:5
    s_nop 0
    v_mfma_f32_4x4x4_16b_bf16 v[100:103], v[144:145], v[90:91], 0 cbsz:4 abid:5
    v_lshlrev_b32_sdwa v139, v15, v127 dst_sel:DWORD dst_unused:UNUSED_PAD src0_sel:DWORD src1_sel:WORD_1
    ds_read_u16_d16_hi v134, v138 offset:32768
    ds_read_u16_d16_hi v135, v139 offset:32768
    s_set_gpr_idx_on s53, 0xc
    v_pk_fma_f32 v[16:17], v[128:129], v[104:105], v[16:17] op_sel:[1,0,0] op_sel_hi:[1,1,1]
    v_pk_fma_f32 v[18:19], v[128:129], v[106:107], v[18:19] op_sel:[1,0,0] op_sel_hi:[1,1,1]
    v_pk_fma_f32 v[20:21], v[130:131], v[108:109], v[20:21] op_sel:[1,0,0] op_sel_hi:[1,1,1]
    v_pk_fma_f32 v[22:23], v[130:131], v[110:111], v[22:23] op_sel:[1,0,0] op_sel_hi:[1,1,1]
    s_set_gpr_idx_off
    s_branch MAIN_DONE
B_20:
    buffer_load_dwordx4 v[188:191], v1, s[16:19], s10 offen offset:0 sc1
    buffer_load_dwordx4 v[192:195], v1, s[16:19], s10 offen offset:1024 sc1
    buffer_load_dwordx4 v[196:199], v1, s[16:19], s10 offen offset:2048 sc1
    buffer_load_dwordx4 v[200:203], v1, s[16:19], s10 offen offset:3072 sc1
    buffer_load_dwordx4 v[204:207], v1, s[16:19], s11 offen offset:0 sc1
    buffer_load_dwordx4 v[208:211], v1, s[16:19], s11 offen offset:1024 sc1
    buffer_load_dwordx4 v[212:215], v1, s[16:19], s11 offen offset:2048 sc1
    buffer_load_dwordx4 v[216:219], v1, s[16:19], s11 offen offset:3072 sc1
    s_sub_u32 s32, s32, 1
    s_cbranch_scc1 MAIN_DONE
    v_mfma_f32_4x4x4_16b_bf16 v[116:119], v[172:173], v[178:179], 0 cbsz:4 abid:6
    v_lshlrev_b32_sdwa v136, v15, v122 dst_sel:DWORD dst_unused:UNUSED_PAD src0_sel:DWORD src1_sel:WORD_1
    s_waitcnt vmcnt(12)
    v_mfma_f32_4x4x4_16b_bf16 v[104:107], v[142:143], v[84:85], 0 cbsz:4 abid:5
    s_nop 0
    v_mfma_f32_4x4x4_16b_bf16 v[108:111], v[142:143], v[86:87], 0 cbsz:4 abid:5
    v_lshlrev_b32_sdwa v137, v15, v123 dst_sel:DWORD dst_unused:UNUSED_PAD src0_sel:DWORD src1_sel:WORD_1
    ds_read_u16_d16_hi v132, v136 offset:32768
    ds_read_u16_d16_hi v133, v137 offset:32768
    s_waitcnt lgkmcnt(2)
    s_set_gpr_idx_on s52, 0xc
    v_pk_fma_f32 v[16:17], v[128:129], v[96:97], v[16:17] op_sel:[0,0,0] op_sel_hi:[0,1,1]
    v_pk_fma_f32 v[18:19], v[128:129], v[98:99], v[18:19] op_sel:[0,0,0] op_sel_hi:[0,1,1]
    v_pk_fma_f32 v[20:21], v[130:131], v[100:101], v[20:21] op_sel:[0,0,0] op_sel_hi:[0,1,1]
    v_pk_fma_f32 v[22:23], v[130:131], v[102:103], v[22:23] op_sel:[0,0,0] op_sel_hi:[0,1,1]
    s_set_gpr_idx_off
    s_sub_u32 s32, s32, 1
    s_cbranch_scc1 MAIN_DONE
    v_lshlrev_b32_sdwa v138, v15, v126 dst_sel:DWORD dst_unused:UNUSED_PAD src0_sel:DWORD src1_sel:WORD_1
    s_waitcnt vmcnt(11)
    v_mfma_f32_4x4x4_16b_bf16 v[96:99], v[144:145], v[88:89], 0 cbsz:4 abid:5
    s_nop 0
    v_mfma_f32_4x4x4_16b_bf16 v[100:103], v[144:145], v[90:91], 0 cbsz:4 abid:5
    v_lshlrev_b32_sdwa v139, v15, v127 dst_sel:DWORD dst_unused:UNUSED_PAD src0_sel:DWORD src1_sel:WORD_1
    ds_read_u16_d16_hi v134, v138 offset:32768
    ds_read_u16_d16_hi v135, v139 offset:32768
    s_set_gpr_idx_on s53, 0xc
    v_pk_fma_f32 v[16:17], v[128:129], v[104:105], v[16:17] op_sel:[1,0,0] op_sel_hi:[1,1,1]
    v_pk_fma_f32 v[18:19], v[128:129], v[106:107], v[18:19] op_sel:[1,0,0] op_sel_hi:[1,1,1]
    v_pk_fma_f32 v[20:21], v[130:131], v[108:109], v[20:21] op_sel:[1,0,0] op_sel_hi:[1,1,1]
    v_pk_fma_f32 v[22:23], v[130:131], v[110:111], v[22:23] op_sel:[1,0,0] op_sel_hi:[1,1,1]
    s_set_gpr_idx_off
    s_sub_u32 s32, s32, 1
    s_cbranch_scc1 MAIN_DONE
    v_mfma_f32_4x4x4_16b_bf16 v[120:123], v[172:173], v[176:177], 0 cbsz:4 abid:7
    v_lshlrev_b32_sdwa v136, v15, v112 dst_sel:DWORD dst_unused:UNUSED_PAD src0_sel:DWORD src1_sel:WORD_1
    s_waitcnt vmcnt(10)
    v_mfma_f32_4x4x4_16b_bf16 v[104:107], v[146:147], v[92:93], 0 cbsz:4 abid:5
    s_nop 0
    v_mfma_f32_4x4x4_16b_bf16 v[108:111], v[146:147], v[94:95], 0 cbsz:4 abid:5
    v_lshlrev_b32_sdwa v137, v15, v113 dst_sel:DWORD dst_unused:UNUSED_PAD src0_sel:DWORD src1_sel:WORD_1
    ds_read_u16_d16_hi v128, v136 offset:32768
    ds_read_u16_d16_hi v129, v137 offset:32768
    s_waitcnt lgkmcnt(2)
    s_set_gpr_idx_on s54, 0xc
    v_pk_fma_f32 v[16:17], v[132:133], v[96:97], v[16:17] op_sel:[0,0,0] op_sel_hi:[0,1,1]
    v_pk_fma_f32 v[18:19], v[132:133], v[98:99], v[18:19] op_sel:[0,0,0] op_sel_hi:[0,1,1]
    v_pk_fma_f32 v[20:21], v[134:135], v[100:101], v[20:21] op_sel:[0,0,0] op_sel_hi:[0,1,1]
    v_pk_fma_f32 v[22:23], v[134:135], v[102:103], v[22:23] op_sel:[0,0,0] op_sel_hi:[0,1,1]
    s_set_gpr_idx_off
    s_sub_u32 s32, s32, 1
    s_cbranch_scc1 MAIN_DONE
    v_lshlrev_b32_sdwa v138, v15, v116 dst_sel:DWORD dst_unused:UNUSED_PAD src0_sel:DWORD src1_sel:WORD_1
    s_waitcnt vmcnt(9)
    v_mfma_f32_4x4x4_16b_bf16 v[96:99], v[140:141], v[64:65], 0 cbsz:4 abid:6
    s_nop 0
    v_mfma_f32_4x4x4_16b_bf16 v[100:103], v[140:141], v[66:67], 0 cbsz:4 abid:6
    v_lshlrev_b32_sdwa v139, v15, v117 dst_sel:DWORD dst_unused:UNUSED_PAD src0_sel:DWORD src1_sel:WORD_1
    ds_read_u16_d16_hi v130, v138 offset:32768
    ds_read_u16_d16_hi v131, v139 offset:32768
    s_set_gpr_idx_on s55, 0xc
    v_pk_fma_f32 v[16:17], v[132:133], v[104:105], v[16:17] op_sel:[1,0,0] op_sel_hi:[1,1,1]
    v_pk_fma_f32 v[18:19], v[132:133], v[106:107], v[18:19] op_sel:[1,0,0] op_sel_hi:[1,1,1]
    v_pk_fma_f32 v[20:21], v[134:135], v[108:109], v[20:21] op_sel:[1,0,0] op_sel_hi:[1,1,1]
    v_pk_fma_f32 v[22:23], v[134:135], v[110:111], v[22:23] op_sel:[1,0,0] op_sel_hi:[1,1,1]
    s_set_gpr_idx_off
    s_sub_u32 s32, s32, 1
    s_cbranch_scc1 MAIN_DONE
    v_mfma_f32_4x4x4_16b_bf16 v[124:127], v[172:173], v[178:179], 0 cbsz:4 abid:7
    v_lshlrev_b32_sdwa v136, v15, v114 dst_sel:DWORD dst_unused:UNUSED_PAD src0_sel:DWORD src1_sel:WORD_1
    s_waitcnt vmcnt(8)
    v_mfma_f32_4x4x4_16b_bf16 v[104:107], v[142:143], v[68:69], 0 cbsz:4 abid:6
    s_nop 0
    v_mfma_f32_4x4x4_16b_bf16 v[108:111], v[142:143], v[70:71], 0 cbsz:4 abid:6
    v_lshlrev_b32_sdwa v137, v15, v115 dst_sel:DWORD dst_unused:UNUSED_PAD src0_sel:DWORD src1_sel:WORD_1
    ds_read_u16_d16_hi v132, v136 offset:32768
    ds_read_u16_d16_hi v133, v137 offset:32768
    s_waitcnt lgkmcnt(2)
    s_set_gpr_idx_on s56, 0xc
    v_pk_fma_f32 v[16:17], v[128:129], v[96:97], v[16:17] op_sel:[0,0,0] op_sel_hi:[0,1,1]
    v_pk_fma_f32 v[18:19], v[128:129], v[98:99], v[18:19] op_sel:[0,0,0] op_sel_hi:[0,1,1]
    v_pk_fma_f32 v[20:21], v[130:131], v[100:101], v[20:21] op_sel:[0,0,0] op_sel_hi:[0,1,1]
    v_pk_fma_f32 v[22:23], v[130:131], v[102:103], v[22:23] op_sel:[0,0,0] op_sel_hi:[0,1,1]
    s_set_gpr_idx_off
    s_sub_u32 s32, s32, 1
    s_cbranch_scc1 MAIN_DONE
    v_lshlrev_b32_sdwa v138, v15, v118 dst_sel:DWORD dst_unused:UNUSED_PAD src0_sel:DWORD src1_sel:WORD_1
    v_mfma_f32_4x4x4_16b_bf16 v[96:99], v[144:145], v[72:73], 0 cbsz:4 abid:6
    s_nop 0
    v_mfma_f32_4x4x4_16b_bf16 v[100:103], v[144:145], v[74:75], 0 cbsz:4 abid:6
    v_lshlrev_b32_sdwa v139, v15, v119 dst_sel:DWORD dst_unused:UNUSED_PAD src0_sel:DWORD src1_sel:WORD_1
    ds_read_u16_d16_hi v134, v138 offset:32768
    ds_read_u16_d16_hi v135, v139 offset:32768
    s_set_gpr_idx_on s57, 0xc
    v_pk_fma_f32 v[16:17], v[128:129], v[104:105], v[16:17] op_sel:[1,0,0] op_sel_hi:[1,1,1]
    v_pk_fma_f32 v[18:19], v[128:129], v[106:107], v[18:19] op_sel:[1,0,0] op_sel_hi:[1,1,1]
    v_pk_fma_f32 v[20:21], v[130:131], v[108:109], v[20:21] op_sel:[1,0,0] op_sel_hi:[1,1,1]
    v_pk_fma_f32 v[22:23], v[130:131], v[110:111], v[22:23] op_sel:[1,0,0] op_sel_hi:[1,1,1]
    s_set_gpr_idx_off
    s_branch MAIN_DONE
B_24:
    buffer_load_dwordx4 v[188:191], v1, s[16:19], s10 offen offset:0 sc1
    buffer_load_dwordx4 v[192:195], v1, s[16:19], s10 offen offset:1024 sc1
    buffer_load_dwordx4 v[196:199], v1, s[16:19], s10 offen offset:2048 sc1
    buffer_load_dwordx4 v[200:203], v1, s[16:19], s10 offen offset:3072 sc1
    buffer_load_dwordx4 v[204:207], v1, s[16:19], s11 offen offset:0 sc1
    buffer_load_dwordx4 v[208:211], v1, s[16:19], s11 offen offset:1024 sc1
    buffer_load_dwordx4 v[212:215], v1, s[16:19], s11 offen offset:2048 sc1
    buffer_load_dwordx4 v[216:219], v1, s[16:19], s11 offen offset:3072 sc1
    s_sub_u32 s32, s32, 1
    s_cbranch_scc1 MAIN_DONE
    v_mfma_f32_4x4x4_16b_bf16 v[124:127], v[172:173], v[178:179], 0 cbsz:4 abid:7
    v_lshlrev_b32_sdwa v136, v15, v114 dst_sel:DWORD dst_unused:UNUSED_PAD src0_sel:DWORD src1_sel:WORD_1
    s_waitcnt vmcnt(12)
    v_mfma_f32_4x4x4_16b_bf16 v[104:107], v[142:143], v[68:69], 0 cbsz:4 abid:6
    s_nop 0
    v_mfma_f32_4x4x4_16b_bf16 v[108:111], v[142:143], v[70:71], 0 cbsz:4 abid:6
    v_lshlrev_b32_sdwa v137, v15, v115 dst_sel:DWORD dst_unused:UNUSED_PAD src0_sel:DWORD src1_sel:WORD_1
    ds_read_u16_d16_hi v132, v136 offset:32768
    ds_read_u16_d16_hi v133, v137 offset:32768
    s_waitcnt lgkmcnt(2)
    s_set_gpr_idx_on s56, 0xc
    v_pk_fma_f32 v[16:17], v[128:129], v[96:97], v[16:17] op_sel:[0,0,0] op_sel_hi:[0,1,1]
    v_pk_fma_f32 v[18:19], v[128:129], v[98:99], v[18:19] op_sel:[0,0,0] op_sel_hi:[0,1,1]
    v_pk_fma_f32 v[20:21], v[130:131], v[100:101], v[20:21] op_sel:[0,0,0] op_sel_hi:[0,1,1]
    v_pk_fma_f32 v[22:23], v[130:131], v[102:103], v[22:23] op_sel:[0,0,0] op_sel_hi:[0,1,1]
    s_set_gpr_idx_off
    s_sub_u32 s32, s32, 1
    s_cbranch_scc1 MAIN_DONE
    v_lshlrev_b32_sdwa v138, v15, v118 dst_sel:DWORD dst_unused:UNUSED_PAD src0_sel:DWORD src1_sel:WORD_1
    s_waitcnt vmcnt(11)
    v_mfma_f32_4x4x4_16b_bf16 v[96:99], v[144:145], v[72:73], 0 cbsz:4 abid:6
    s_nop 0
    v_mfma_f32_4x4x4_16b_bf16 v[100:103], v[144:145], v[74:75], 0 cbsz:4 abid:6
    v_lshlrev_b32_sdwa v139, v15, v119 dst_sel:DWORD dst_unused:UNUSED_PAD src0_sel:DWORD src1_sel:WORD_1
    ds_read_u16_d16_hi v134, v138 offset:32768
    ds_read_u16_d16_hi v135, v139 offset:32768
    s_set_gpr_idx_on s57, 0xc
    v_pk_fma_f32 v[16:17], v[128:129], v[104:105], v[16:17] op_sel:[1,0,0] op_sel_hi:[1,1,1]
    v_pk_fma_f32 v[18:19], v[128:129], v[106:107], v[18:19] op_sel:[1,0,0] op_sel_hi:[1,1,1]
    v_pk_fma_f32 v[20:21], v[130:131], v[108:109], v[20:21] op_sel:[1,0,0] op_sel_hi:[1,1,1]
    v_pk_fma_f32 v[22:23], v[130:131], v[110:111], v[22:23] op_sel:[1,0,0] op_sel_hi:[1,1,1]
    s_set_gpr_idx_off
    s_sub_u32 s32, s32, 1
    s_cbranch_scc1 MAIN_DONE
    v_mfma_f32_4x4x4_16b_bf16 v[112:115], v[172:173], v[176:177], 0 cbsz:4 abid:8
    v_lshlrev_b32_sdwa v136, v15, v120 dst_sel:DWORD dst_unused:UNUSED_PAD src0_sel:DWORD src1_sel:WORD_1
    s_waitcnt vmcnt(10)
    v_mfma_f32_4x4x4_16b_bf16 v[104:107], v[146:147], v[76:77], 0 cbsz:4 abid:6
    s_nop 0
    v_mfma_f32_4x4x4_16b_bf16 v[108:111], v[146:147], v[78:79], 0 cbsz:4 abid:6
    v_lshlrev_b32_sdwa v137, v15, v121 dst_sel:DWORD dst_unused:UNUSED_PAD src0_sel:DWORD src1_sel:WORD_1
    ds_read_u16_d16_hi v128, v136 offset:32768
    ds_read_u16_d16_hi v129, v137 offset:32768
    s_waitcnt lgkmcnt(2)
    s_set_gpr_idx_on s58, 0xc
    v_pk_fma_f32 v[16:17], v[132:133], v[96:97], v[16:17] op_sel:[0,0,0] op_sel_hi:[0,1,1]
    v_pk_fma_f32 v[18:19], v[132:133], v[98:99], v[18:19] op_sel:[0,0,0] op_sel_hi:[0,1,1]
    v_pk_fma_f32 v[20:21], v[134:135], v[100:101], v[20:21] op_sel:[0,0,0] op_sel_hi:[0,1,1]
    v_pk_fma_f32 v[22:23], v[134:135], v[102:103], v[22:23] op_sel:[0,0,0] op_sel_hi:[0,1,1]
    s_set_gpr_idx_off
    s_sub_u32 s32, s32, 1
    s_cbranch_scc1 MAIN_DONE
    v_lshlrev_b32_sdwa v138, v15, v124 dst_sel:DWORD dst_unused:UNUSED_PAD src0_sel:DWORD src1_sel:WORD_1
    s_waitcnt vmcnt(9)
    v_mfma_f32_4x4x4_16b_bf16 v[96:99], v[140:141], v[80:81], 0 cbsz:4 abid:7
    s_nop 0
    v_mfma_f32_4x4x4_16b_bf16 v[100:103], v[140:141], v[82:83], 0 cbsz:4 abid:7
    v_lshlrev_b32_sdwa v139, v15, v125 dst_sel:DWORD dst_unused:UNUSED_PAD src0_sel:DWORD src1_sel:WORD_1
    ds_read_u16_d16_hi v130, v138 offset:32768
    ds_read_u16_d16_hi v131, v139 offset:32768
    s_set_gpr_idx_on s59, 0xc
    v_pk_fma_f32 v[16:17], v[132:133], v[104:105], v[16:17] op_sel:[1,0,0] op_sel_hi:[1,1,1]
    v_pk_fma_f32 v[18:19], v[132:133], v[106:107], v[18:19] op_sel:[1,0,0] op_sel_hi:[1,1,1]
    v_pk_fma_f32 v[20:21], v[134:135], v[108:109], v[20:21] op_sel:[1,0,0] op_sel_hi:[1,1,1]
    v_pk_fma_f32 v[22:23], v[134:135], v[110:111], v[22:23] op_sel:[1,0,0] op_sel_hi:[1,1,1]
    s_set_gpr_idx_off
    s_sub_u32 s32, s32, 1
    s_cbranch_scc1 MAIN_DONE
    v_mfma_f32_4x4x4_16b_bf16 v[116:119], v[172:173], v[178:179], 0 cbsz:4 abid:8
    v_lshlrev_b32_sdwa v136, v15, v122 dst_sel:DWORD dst_unused:UNUSED_PAD src0_sel:DWORD src1_sel:WORD_1
    s_waitcnt vmcnt(8)
    v_mfma_f32_4x4x4_16b_bf16 v[104:107], v[142:143], v[84:85], 0 cbsz:4 abid:7
    s_nop 0
    v_mfma_f32_4x4x4_16b_bf16 v[108:111], v[142:143], v[86:87], 0 cbsz:4 abid:7
    v_lshlrev_b32_sdwa v137, v15, v123 dst_sel:DWORD dst_unused:UNUSED_PAD src0_sel:DWORD src1_sel:WORD_1
    ds_read_u16_d16_hi v132, v136 offset:32768
    ds_read_u16_d16_hi v133, v137 offset:32768
    s_waitcnt lgkmcnt(2)
    s_set_gpr_idx_on s60, 0xc
    v_pk_fma_f32 v[16:17], v[128:129], v[96:97], v[16:17] op_sel:[0,0,0] op_sel_hi:[0,1,1]
    v_pk_fma_f32 v[18:19], v[128:129], v[98:99], v[18:19] op_sel:[0,0,0] op_sel_hi:[0,1,1]
    v_pk_fma_f32 v[20:21], v[130:131], v[100:101], v[20:21] op_sel:[0,0,0] op_sel_hi:[0,1,1]
    v_pk_fma_f32 v[22:23], v[130:131], v[102:103], v[22:23] op_sel:[0,0,0] op_sel_hi:[0,1,1]
    s_set_gpr_idx_off
    s_sub_u32 s32, s32, 1
    s_cbranch_scc1 MAIN_DONE
    v_lshlrev_b32_sdwa v138, v15, v126 dst_sel:DWORD dst_unused:UNUSED_PAD src0_sel:DWORD src1_sel:WORD_1
    v_mfma_f32_4x4x4_16b_bf16 v[96:99], v[144:145], v[88:89], 0 cbsz:4 abid:7
    s_nop 0
    v_mfma_f32_4x4x4_16b_bf16 v[100:103], v[144:145], v[90:91], 0 cbsz:4 abid:7
    v_lshlrev_b32_sdwa v139, v15, v127 dst_sel:DWORD dst_unused:UNUSED_PAD src0_sel:DWORD src1_sel:WORD_1
    ds_read_u16_d16_hi v134, v138 offset:32768
    ds_read_u16_d16_hi v135, v139 offset:32768
    s_set_gpr_idx_on s61, 0xc
    v_pk_fma_f32 v[16:17], v[128:129], v[104:105], v[16:17] op_sel:[1,0,0] op_sel_hi:[1,1,1]
    v_pk_fma_f32 v[18:19], v[128:129], v[106:107], v[18:19] op_sel:[1,0,0] op_sel_hi:[1,1,1]
    v_pk_fma_f32 v[20:21], v[130:131], v[108:109], v[20:21] op_sel:[1,0,0] op_sel_hi:[1,1,1]
    v_pk_fma_f32 v[22:23], v[130:131], v[110:111], v[22:23] op_sel:[1,0,0] op_sel_hi:[1,1,1]
    s_set_gpr_idx_off
    s_branch MAIN_DONE
B_28:
    buffer_load_dwordx4 v[188:191], v1, s[16:19], s10 offen offset:0 sc1
    buffer_load_dwordx4 v[192:195], v1, s[16:19], s10 offen offset:1024 sc1
    buffer_load_dwordx4 v[196:199], v1, s[16:19], s10 offen offset:2048 sc1
    buffer_load_dwordx4 v[200:203], v1, s[16:19], s10 offen offset:3072 sc1
    buffer_load_dwordx4 v[204:207], v1, s[16:19], s11 offen offset:0 sc1
    buffer_load_dwordx4 v[208:211], v1, s[16:19], s11 offen offset:1024 sc1
    buffer_load_dwordx4 v[212:215], v1, s[16:19], s11 offen offset:2048 sc1
    buffer_load_dwordx4 v[216:219], v1, s[16:19], s11 offen offset:3072 sc1
    s_sub_u32 s32, s32, 1
    s_cbranch_scc1 MAIN_DONE
    v_mfma_f32_4x4x4_16b_bf16 v[116:119], v[172:173], v[178:179], 0 cbsz:4 abid:8
    v_lshlrev_b32_sdwa v136, v15, v122 dst_sel:DWORD dst_unused:UNUSED_PAD src0_sel:DWORD src1_sel:WORD_1
    s_waitcnt vmcnt(12)
    v_mfma_f32_4x4x4_16b_bf16 v[104:107], v[142:143], v[84:85], 0 cbsz:4 abid:7
    s_nop 0
    v_mfma_f32_4x4x4_16b_bf16 v[108:111], v[142:143], v[86:87], 0 cbsz:4 abid:7
    v_lshlrev_b32_sdwa v137, v15, v123 dst_sel:DWORD dst_unused:UNUSED_PAD src0_sel:DWORD src1_sel:WORD_1
    ds_read_u16_d16_hi v132, v136 offset:32768
    ds_read_u16_d16_hi v133, v137 offset:32768
    s_waitcnt lgkmcnt(2)
    s_set_gpr_idx_on s60, 0xc
    v_pk_fma_f32 v[16:17], v[128:129], v[96:97], v[16:17] op_sel:[0,0,0] op_sel_hi:[0,1,1]
    v_pk_fma_f32 v[18:19], v[128:129], v[98:99], v[18:19] op_sel:[0,0,0] op_sel_hi:[0,1,1]
    v_pk_fma_f32 v[20:21], v[130:131], v[100:101], v[20:21] op_sel:[0,0,0] op_sel_hi:[0,1,1]
    v_pk_fma_f32 v[22:23], v[130:131], v[102:103], v[22:23] op_sel:[0,0,0] op_sel_hi:[0,1,1]
    s_set_gpr_idx_off
    s_sub_u32 s32, s32, 1
    s_cbranch_scc1 MAIN_DONE
    v_lshlrev_b32_sdwa v138, v15, v126 dst_sel:DWORD dst_unused:UNUSED_PAD src0_sel:DWORD src1_sel:WORD_1
    s_waitcnt vmcnt(11)
    v_mfma_f32_4x4x4_16b_bf16 v[96:99], v[144:145], v[88:89], 0 cbsz:4 abid:7
    s_nop 0
    v_mfma_f32_4x4x4_16b_bf16 v[100:103], v[144:145], v[90:91], 0 cbsz:4 abid:7
    v_lshlrev_b32_sdwa v139, v15, v127 dst_sel:DWORD dst_unused:UNUSED_PAD src0_sel:DWORD src1_sel:WORD_1
    ds_read_u16_d16_hi v134, v138 offset:32768
    ds_read_u16_d16_hi v135, v139 offset:32768
    s_set_gpr_idx_on s61, 0xc
    v_pk_fma_f32 v[16:17], v[128:129], v[104:105], v[16:17] op_sel:[1,0,0] op_sel_hi:[1,1,1]
    v_pk_fma_f32 v[18:19], v[128:129], v[106:107], v[18:19] op_sel:[1,0,0] op_sel_hi:[1,1,1]
    v_pk_fma_f32 v[20:21], v[130:131], v[108:109], v[20:21] op_sel:[1,0,0] op_sel_hi:[1,1,1]
    v_pk_fma_f32 v[22:23], v[130:131], v[110:111], v[22:23] op_sel:[1,0,0] op_sel_hi:[1,1,1]
    s_set_gpr_idx_off
    s_sub_u32 s32, s32, 1
    s_cbranch_scc1 MAIN_DONE
    v_mfma_f32_4x4x4_16b_bf16 v[120:123], v[172:173], v[176:177], 0 cbsz:4 abid:9
    v_lshlrev_b32_sdwa v136, v15, v112 dst_sel:DWORD dst_unused:UNUSED_PAD src0_sel:DWORD src1_sel:WORD_1
    s_waitcnt vmcnt(10)
    v_mfma_f32_4x4x4_16b_bf16 v[104:107], v[146:147], v[92:93], 0 cbsz:4 abid:7
    s_nop 0
    v_mfma_f32_4x4x4_16b_bf16 v[108:111], v[146:147], v[94:95], 0 cbsz:4 abid:7
    v_lshlrev_b32_sdwa v137, v15, v113 dst_sel:DWORD dst_unused:UNUSED_PAD src0_sel:DWORD src1_sel:WORD_1
    ds_read_u16_d16_hi v128, v136 offset:32768
    ds_read_u16_d16_hi v129, v137 offset:32768
    s_waitcnt lgkmcnt(2)
    s_set_gpr_idx_on s62, 0xc
    v_pk_fma_f32 v[16:17], v[132:133], v[96:97], v[16:17] op_sel:[0,0,0] op_sel_hi:[0,1,1]
    v_pk_fma_f32 v[18:19], v[132:133], v[98:99], v[18:19] op_sel:[0,0,0] op_sel_hi:[0,1,1]
    v_pk_fma_f32 v[20:21], v[134:135], v[100:101], v[20:21] op_sel:[0,0,0] op_sel_hi:[0,1,1]
    v_pk_fma_f32 v[22:23], v[134:135], v[102:103], v[22:23] op_sel:[0,0,0] op_sel_hi:[0,1,1]
    s_set_gpr_idx_off
    s_sub_u32 s32, s32, 1
    s_cbranch_scc1 MAIN_DONE
    v_lshlrev_b32_sdwa v138, v15, v116 dst_sel:DWORD dst_unused:UNUSED_PAD src0_sel:DWORD src1_sel:WORD_1
    s_waitcnt vmcnt(9)
    v_mfma_f32_4x4x4_16b_bf16 v[96:99], v[140:141], v[64:65], 0 cbsz:4 abid:8
    s_nop 0
    v_mfma_f32_4x4x4_16b_bf16 v[100:103], v[140:141], v[66:67], 0 cbsz:4 abid:8
    v_lshlrev_b32_sdwa v139, v15, v117 dst_sel:DWORD dst_unused:UNUSED_PAD src0_sel:DWORD src1_sel:WORD_1
    ds_read_u16_d16_hi v130, v138 offset:32768
    ds_read_u16_d16_hi v131, v139 offset:32768
    s_set_gpr_idx_on s63, 0xc
    v_pk_fma_f32 v[16:17], v[132:133], v[104:105], v[16:17] op_sel:[1,0,0] op_sel_hi:[1,1,1]
    v_pk_fma_f32 v[18:19], v[132:133], v[106:107], v[18:19] op_sel:[1,0,0] op_sel_hi:[1,1,1]
    v_pk_fma_f32 v[20:21], v[134:135], v[108:109], v[20:21] op_sel:[1,0,0] op_sel_hi:[1,1,1]
    v_pk_fma_f32 v[22:23], v[134:135], v[110:111], v[22:23] op_sel:[1,0,0] op_sel_hi:[1,1,1]
    s_set_gpr_idx_off
    s_sub_u32 s32, s32, 1
    s_cbranch_scc1 MAIN_DONE
    v_mfma_f32_4x4x4_16b_bf16 v[124:127], v[172:173], v[178:179], 0 cbsz:4 abid:9
    v_lshlrev_b32_sdwa v136, v15, v114 dst_sel:DWORD dst_unused:UNUSED_PAD src0_sel:DWORD src1_sel:WORD_1
    s_waitcnt vmcnt(8)
    v_mfma_f32_4x4x4_16b_bf16 v[104:107], v[142:143], v[68:69], 0 cbsz:4 abid:8
    s_nop 0
    v_mfma_f32_4x4x4_16b_bf16 v[108:111], v[142:143], v[70:71], 0 cbsz:4 abid:8
    v_lshlrev_b32_sdwa v137, v15, v115 dst_sel:DWORD dst_unused:UNUSED_PAD src0_sel:DWORD src1_sel:WORD_1
    ds_read_u16_d16_hi v132, v136 offset:32768
    ds_read_u16_d16_hi v133, v137 offset:32768
    s_waitcnt lgkmcnt(2)
    s_set_gpr_idx_on s48, 0xc
    v_pk_fma_f32 v[16:17], v[128:129], v[96:97], v[16:17] op_sel:[0,0,0] op_sel_hi:[0,1,1]
    v_pk_fma_f32 v[18:19], v[128:129], v[98:99], v[18:19] op_sel:[0,0,0] op_sel_hi:[0,1,1]
    v_pk_fma_f32 v[20:21], v[130:131], v[100:101], v[20:21] op_sel:[0,0,0] op_sel_hi:[0,1,1]
    v_pk_fma_f32 v[22:23], v[130:131], v[102:103], v[22:23] op_sel:[0,0,0] op_sel_hi:[0,1,1]
    s_set_gpr_idx_off
    s_sub_u32 s32, s32, 1
    s_cbranch_scc1 MAIN_DONE
    v_lshlrev_b32_sdwa v138, v15, v118 dst_sel:DWORD dst_unused:UNUSED_PAD src0_sel:DWORD src1_sel:WORD_1
    v_mfma_f32_4x4x4_16b_bf16 v[96:99], v[144:145], v[72:73], 0 cbsz:4 abid:8
    s_nop 0
    v_mfma_f32_4x4x4_16b_bf16 v[100:103], v[144:145], v[74:75], 0 cbsz:4 abid:8
    v_lshlrev_b32_sdwa v139, v15, v119 dst_sel:DWORD dst_unused:UNUSED_PAD src0_sel:DWORD src1_sel:WORD_1
    ds_read_u16_d16_hi v134, v138 offset:32768
    ds_read_u16_d16_hi v135, v139 offset:32768
    s_set_gpr_idx_on s49, 0xc
    v_pk_fma_f32 v[16:17], v[128:129], v[104:105], v[16:17] op_sel:[1,0,0] op_sel_hi:[1,1,1]
    v_pk_fma_f32 v[18:19], v[128:129], v[106:107], v[18:19] op_sel:[1,0,0] op_sel_hi:[1,1,1]
    v_pk_fma_f32 v[20:21], v[130:131], v[108:109], v[20:21] op_sel:[1,0,0] op_sel_hi:[1,1,1]
    v_pk_fma_f32 v[22:23], v[130:131], v[110:111], v[22:23] op_sel:[1,0,0] op_sel_hi:[1,1,1]
    s_set_gpr_idx_off
    s_branch MAIN_DONE
B_32:
    buffer_load_dwordx4 v[188:191], v1, s[16:19], s10 offen offset:0 sc1
    buffer_load_dwordx4 v[192:195], v1, s[16:19], s10 offen offset:1024 sc1
    buffer_load_dwordx4 v[196:199], v1, s[16:19], s10 offen offset:2048 sc1
    buffer_load_dwordx4 v[200:203], v1, s[16:19], s10 offen offset:3072 sc1
    buffer_load_dwordx4 v[204:207], v1, s[16:19], s11 offen offset:0 sc1
    buffer_load_dwordx4 v[208:211], v1, s[16:19], s11 offen offset:1024 sc1
    buffer_load_dwordx4 v[212:215], v1, s[16:19], s11 offen offset:2048 sc1
    buffer_load_dwordx4 v[216:219], v1, s[16:19], s11 offen offset:3072 sc1
    s_sub_u32 s32, s32, 1
    s_cbranch_scc1 MAIN_DONE
    v_mfma_f32_4x4x4_16b_bf16 v[124:127], v[172:173], v[178:179], 0 cbsz:4 abid:9
    v_lshlrev_b32_sdwa v136, v15, v114 dst_sel:DWORD dst_unused:UNUSED_PAD src0_sel:DWORD src1_sel:WORD_1
    s_waitcnt vmcnt(12)
    v_mfma_f32_4x4x4_16b_bf16 v[104:107], v[142:143], v[68:69], 0 cbsz:4 abid:8
    s_nop 0
    v_mfma_f32_4x4x4_16b_bf16 v[108:111], v[142:143], v[70:71], 0 cbsz:4 abid:8
    v_lshlrev_b32_sdwa v137, v15, v115 dst_sel:DWORD dst_unused:UNUSED_PAD src0_sel:DWORD src1_sel:WORD_1
    ds_read_u16_d16_hi v132, v136 offset:32768
    ds_read_u16_d16_hi v133, v137 offset:32768
    s_waitcnt lgkmcnt(2)
    s_set_gpr_idx_on s48, 0xc
    v_pk_fma_f32 v[16:17], v[128:129], v[96:97], v[16:17] op_sel:[0,0,0] op_sel_hi:[0,1,1]
    v_pk_fma_f32 v[18:19], v[128:129], v[98:99], v[18:19] op_sel:[0,0,0] op_sel_hi:[0,1,1]
    v_pk_fma_f32 v[20:21], v[130:131], v[100:101], v[20:21] op_sel:[0,0,0] op_sel_hi:[0,1,1]
    v_pk_fma_f32 v[22:23], v[130:131], v[102:103], v[22:23] op_sel:[0,0,0] op_sel_hi:[0,1,1]
    s_set_gpr_idx_off
    s_sub_u32 s32, s32, 1
    s_cbranch_scc1 MAIN_DONE
    v_lshlrev_b32_sdwa v138, v15, v118 dst_sel:DWORD dst_unused:UNUSED_PAD src0_sel:DWORD src1_sel:WORD_1
    s_waitcnt vmcnt(11)
    v_mfma_f32_4x4x4_16b_bf16 v[96:99], v[144:145], v[72:73], 0 cbsz:4 abid:8
    s_nop 0
    v_mfma_f32_4x4x4_16b_bf16 v[100:103], v[144:145], v[74:75], 0 cbsz:4 abid:8
    v_lshlrev_b32_sdwa v139, v15, v119 dst_sel:DWORD dst_unused:UNUSED_PAD src0_sel:DWORD src1_sel:WORD_1
    ds_read_u16_d16_hi v134, v138 offset:32768
    ds_read_u16_d16_hi v135, v139 offset:32768
    s_set_gpr_idx_on s49, 0xc
    v_pk_fma_f32 v[16:17], v[128:129], v[104:105], v[16:17] op_sel:[1,0,0] op_sel_hi:[1,1,1]
    v_pk_fma_f32 v[18:19], v[128:129], v[106:107], v[18:19] op_sel:[1,0,0] op_sel_hi:[1,1,1]
    v_pk_fma_f32 v[20:21], v[130:131], v[108:109], v[20:21] op_sel:[1,0,0] op_sel_hi:[1,1,1]
    v_pk_fma_f32 v[22:23], v[130:131], v[110:111], v[22:23] op_sel:[1,0,0] op_sel_hi:[1,1,1]
    s_set_gpr_idx_off
    s_sub_u32 s32, s32, 1
    s_cbranch_scc1 MAIN_DONE
    v_mfma_f32_4x4x4_16b_bf16 v[112:115], v[172:173], v[176:177], 0 cbsz:4 abid:10
    v_lshlrev_b32_sdwa v136, v15, v120 dst_sel:DWORD dst_unused:UNUSED_PAD src0_sel:DWORD src1_sel:WORD_1
    s_waitcnt vmcnt(10)
    v_mfma_f32_4x4x4_16b_bf16 v[104:107], v[146:147], v[76:77], 0 cbsz:4 abid:8
    s_nop 0
    v_mfma_f32_4x4x4_16b_bf16 v[108:111], v[146:147], v[78:79], 0 cbsz:4 abid:8
    v_lshlrev_b32_sdwa v137, v15, v121 dst_sel:DWORD dst_unused:UNUSED_PAD src0_sel:DWORD src1_sel:WORD_1
    ds_read_u16_d16_hi v128, v136 offset:32768
    ds_read_u16_d16_hi v129, v137 offset:32768
    s_waitcnt lgkmcnt(2)
    s_set_gpr_idx_on s50, 0xc
    v_pk_fma_f32 v[16:17], v[132:133], v[96:97], v[16:17] op_sel:[0,0,0] op_sel_hi:[0,1,1]
    v_pk_fma_f32 v[18:19], v[132:133], v[98:99], v[18:19] op_sel:[0,0,0] op_sel_hi:[0,1,1]
    v_pk_fma_f32 v[20:21], v[134:135], v[100:101], v[20:21] op_sel:[0,0,0] op_sel_hi:[0,1,1]
    v_pk_fma_f32 v[22:23], v[134:135], v[102:103], v[22:23] op_sel:[0,0,0] op_sel_hi:[0,1,1]
    s_set_gpr_idx_off
    s_sub_u32 s32, s32, 1
    s_cbranch_scc1 MAIN_DONE
    v_lshlrev_b32_sdwa v138, v15, v124 dst_sel:DWORD dst_unused:UNUSED_PAD src0_sel:DWORD src1_sel:WORD_1
    s_waitcnt vmcnt(9)
    v_mfma_f32_4x4x4_16b_bf16 v[96:99], v[140:141], v[80:81], 0 cbsz:4 abid:9
    s_nop 0
    v_mfma_f32_4x4x4_16b_bf16 v[100:103], v[140:141], v[82:83], 0 cbsz:4 abid:9
    v_lshlrev_b32_sdwa v139, v15, v125 dst_sel:DWORD dst_unused:UNUSED_PAD src0_sel:DWORD src1_sel:WORD_1
    ds_read_u16_d16_hi v130, v138 offset:32768
    ds_read_u16_d16_hi v131, v139 offset:32768
    s_set_gpr_idx_on s51, 0xc
    v_pk_fma_f32 v[16:17], v[132:133], v[104:105], v[16:17] op_sel:[1,0,0] op_sel_hi:[1,1,1]
    v_pk_fma_f32 v[18:19], v[132:133], v[106:107], v[18:19] op_sel:[1,0,0] op_sel_hi:[1,1,1]
    v_pk_fma_f32 v[20:21], v[134:135], v[108:109], v[20:21] op_sel:[1,0,0] op_sel_hi:[1,1,1]
    v_pk_fma_f32 v[22:23], v[134:135], v[110:111], v[22:23] op_sel:[1,0,0] op_sel_hi:[1,1,1]
    s_set_gpr_idx_off
    s_sub_u32 s32, s32, 1
    s_cbranch_scc1 MAIN_DONE
    v_mfma_f32_4x4x4_16b_bf16 v[116:119], v[172:173], v[178:179], 0 cbsz:4 abid:10
    v_lshlrev_b32_sdwa v136, v15, v122 dst_sel:DWORD dst_unused:UNUSED_PAD src0_sel:DWORD src1_sel:WORD_1
    s_waitcnt vmcnt(8)
    v_mfma_f32_4x4x4_16b_bf16 v[104:107], v[142:143], v[84:85], 0 cbsz:4 abid:9
    s_nop 0
    v_mfma_f32_4x4x4_16b_bf16 v[108:111], v[142:143], v[86:87], 0 cbsz:4 abid:9
    v_lshlrev_b32_sdwa v137, v15, v123 dst_sel:DWORD dst_unused:UNUSED_PAD src0_sel:DWORD src1_sel:WORD_1
    ds_read_u16_d16_hi v132, v136 offset:32768
    ds_read_u16_d16_hi v133, v137 offset:32768
    s_waitcnt lgkmcnt(2)
    s_set_gpr_idx_on s52, 0xc
    v_pk_fma_f32 v[16:17], v[128:129], v[96:97], v[16:17] op_sel:[0,0,0] op_sel_hi:[0,1,1]
    v_pk_fma_f32 v[18:19], v[128:129], v[98:99], v[18:19] op_sel:[0,0,0] op_sel_hi:[0,1,1]
    v_pk_fma_f32 v[20:21], v[130:131], v[100:101], v[20:21] op_sel:[0,0,0] op_sel_hi:[0,1,1]
    v_pk_fma_f32 v[22:23], v[130:131], v[102:103], v[22:23] op_sel:[0,0,0] op_sel_hi:[0,1,1]
    s_set_gpr_idx_off
    s_sub_u32 s32, s32, 1
    s_cbranch_scc1 MAIN_DONE
    v_lshlrev_b32_sdwa v138, v15, v126 dst_sel:DWORD dst_unused:UNUSED_PAD src0_sel:DWORD src1_sel:WORD_1
    v_mfma_f32_4x4x4_16b_bf16 v[96:99], v[144:145], v[88:89], 0 cbsz:4 abid:9
    s_nop 0
    v_mfma_f32_4x4x4_16b_bf16 v[100:103], v[144:145], v[90:91], 0 cbsz:4 abid:9
    v_lshlrev_b32_sdwa v139, v15, v127 dst_sel:DWORD dst_unused:UNUSED_PAD src0_sel:DWORD src1_sel:WORD_1
    ds_read_u16_d16_hi v134, v138 offset:32768
    ds_read_u16_d16_hi v135, v139 offset:32768
    s_set_gpr_idx_on s53, 0xc
    v_pk_fma_f32 v[16:17], v[128:129], v[104:105], v[16:17] op_sel:[1,0,0] op_sel_hi:[1,1,1]
    v_pk_fma_f32 v[18:19], v[128:129], v[106:107], v[18:19] op_sel:[1,0,0] op_sel_hi:[1,1,1]
    v_pk_fma_f32 v[20:21], v[130:131], v[108:109], v[20:21] op_sel:[1,0,0] op_sel_hi:[1,1,1]
    v_pk_fma_f32 v[22:23], v[130:131], v[110:111], v[22:23] op_sel:[1,0,0] op_sel_hi:[1,1,1]
    s_set_gpr_idx_off
    s_branch MAIN_DONE
B_36:
    buffer_load_dwordx4 v[188:191], v1, s[16:19], s10 offen offset:0 sc1
    buffer_load_dwordx4 v[192:195], v1, s[16:19], s10 offen offset:1024 sc1
    buffer_load_dwordx4 v[196:199], v1, s[16:19], s10 offen offset:2048 sc1
    buffer_load_dwordx4 v[200:203], v1, s[16:19], s10 offen offset:3072 sc1
    buffer_load_dwordx4 v[204:207], v1, s[16:19], s11 offen offset:0 sc1
    buffer_load_dwordx4 v[208:211], v1, s[16:19], s11 offen offset:1024 sc1
    buffer_load_dwordx4 v[212:215], v1, s[16:19], s11 offen offset:2048 sc1
    buffer_load_dwordx4 v[216:219], v1, s[16:19], s11 offen offset:3072 sc1
    s_sub_u32 s32, s32, 1
    s_cbranch_scc1 MAIN_DONE
    v_mfma_f32_4x4x4_16b_bf16 v[116:119], v[172:173], v[178:179], 0 cbsz:4 abid:10
    v_lshlrev_b32_sdwa v136, v15, v122 dst_sel:DWORD dst_unused:UNUSED_PAD src0_sel:DWORD src1_sel:WORD_1
    s_waitcnt vmcnt(12)
    v_mfma_f32_4x4x4_16b_bf16 v[104:107], v[142:143], v[84:85], 0 cbsz:4 abid:9
    s_nop 0
    v_mfma_f32_4x4x4_16b_bf16 v[108:111], v[142:143], v[86:87], 0 cbsz:4 abid:9
    v_lshlrev_b32_sdwa v137, v15, v123 dst_sel:DWORD dst_unused:UNUSED_PAD src0_sel:DWORD src1_sel:WORD_1
    ds_read_u16_d16_hi v132, v136 offset:32768
    ds_read_u16_d16_hi v133, v137 offset:32768
    s_waitcnt lgkmcnt(2)
    s_set_gpr_idx_on s52, 0xc
    v_pk_fma_f32 v[16:17], v[128:129], v[96:97], v[16:17] op_sel:[0,0,0] op_sel_hi:[0,1,1]
    v_pk_fma_f32 v[18:19], v[128:129], v[98:99], v[18:19] op_sel:[0,0,0] op_sel_hi:[0,1,1]
    v_pk_fma_f32 v[20:21], v[130:131], v[100:101], v[20:21] op_sel:[0,0,0] op_sel_hi:[0,1,1]
    v_pk_fma_f32 v[22:23], v[130:131], v[102:103], v[22:23] op_sel:[0,0,0] op_sel_hi:[0,1,1]
    s_set_gpr_idx_off
    s_sub_u32 s32, s32, 1
    s_cbranch_scc1 MAIN_DONE
    v_lshlrev_b32_sdwa v138, v15, v126 dst_sel:DWORD dst_unused:UNUSED_PAD src0_sel:DWORD src1_sel:WORD_1
    s_waitcnt vmcnt(11)
    v_mfma_f32_4x4x4_16b_bf16 v[96:99], v[144:145], v[88:89], 0 cbsz:4 abid:9
    s_nop 0
    v_mfma_f32_4x4x4_16b_bf16 v[100:103], v[144:145], v[90:91], 0 cbsz:4 abid:9
    v_lshlrev_b32_sdwa v139, v15, v127 dst_sel:DWORD dst_unused:UNUSED_PAD src0_sel:DWORD src1_sel:WORD_1
    ds_read_u16_d16_hi v134, v138 offset:32768
    ds_read_u16_d16_hi v135, v139 offset:32768
    s_set_gpr_idx_on s53, 0xc
    v_pk_fma_f32 v[16:17], v[128:129], v[104:105], v[16:17] op_sel:[1,0,0] op_sel_hi:[1,1,1]
    v_pk_fma_f32 v[18:19], v[128:129], v[106:107], v[18:19] op_sel:[1,0,0] op_sel_hi:[1,1,1]
    v_pk_fma_f32 v[20:21], v[130:131], v[108:109], v[20:21] op_sel:[1,0,0] op_sel_hi:[1,1,1]
    v_pk_fma_f32 v[22:23], v[130:131], v[110:111], v[22:23] op_sel:[1,0,0] op_sel_hi:[1,1,1]
    s_set_gpr_idx_off
    s_sub_u32 s32, s32, 1
    s_cbranch_scc1 MAIN_DONE
    v_mfma_f32_4x4x4_16b_bf16 v[120:123], v[172:173], v[176:177], 0 cbsz:4 abid:11
    v_lshlrev_b32_sdwa v136, v15, v112 dst_sel:DWORD dst_unused:UNUSED_PAD src0_sel:DWORD src1_sel:WORD_1
    s_waitcnt vmcnt(10)
    v_mfma_f32_4x4x4_16b_bf16 v[104:107], v[146:147], v[92:93], 0 cbsz:4 abid:9
    s_nop 0
    v_mfma_f32_4x4x4_16b_bf16 v[108:111], v[146:147], v[94:95], 0 cbsz:4 abid:9
    v_lshlrev_b32_sdwa v137, v15, v113 dst_sel:DWORD dst_unused:UNUSED_PAD src0_sel:DWORD src1_sel:WORD_1
    ds_read_u16_d16_hi v128, v136 offset:32768
    ds_read_u16_d16_hi v129, v137 offset:32768
    s_waitcnt lgkmcnt(2)
    s_set_gpr_idx_on s54, 0xc
    v_pk_fma_f32 v[16:17], v[132:133], v[96:97], v[16:17] op_sel:[0,0,0] op_sel_hi:[0,1,1]
    v_pk_fma_f32 v[18:19], v[132:133], v[98:99], v[18:19] op_sel:[0,0,0] op_sel_hi:[0,1,1]
    v_pk_fma_f32 v[20:21], v[134:135], v[100:101], v[20:21] op_sel:[0,0,0] op_sel_hi:[0,1,1]
    v_pk_fma_f32 v[22:23], v[134:135], v[102:103], v[22:23] op_sel:[0,0,0] op_sel_hi:[0,1,1]
    s_set_gpr_idx_off
    s_sub_u32 s32, s32, 1
    s_cbranch_scc1 MAIN_DONE
    v_lshlrev_b32_sdwa v138, v15, v116 dst_sel:DWORD dst_unused:UNUSED_PAD src0_sel:DWORD src1_sel:WORD_1
    s_waitcnt vmcnt(9)
    v_mfma_f32_4x4x4_16b_bf16 v[96:99], v[140:141], v[64:65], 0 cbsz:4 abid:10
    s_nop 0
    v_mfma_f32_4x4x4_16b_bf16 v[100:103], v[140:141], v[66:67], 0 cbsz:4 abid:10
    v_lshlrev_b32_sdwa v139, v15, v117 dst_sel:DWORD dst_unused:UNUSED_PAD src0_sel:DWORD src1_sel:WORD_1
    ds_read_u16_d16_hi v130, v138 offset:32768
    ds_read_u16_d16_hi v131, v139 offset:32768
    s_set_gpr_idx_on s55, 0xc
    v_pk_fma_f32 v[16:17], v[132:133], v[104:105], v[16:17] op_sel:[1,0,0] op_sel_hi:[1,1,1]
    v_pk_fma_f32 v[18:19], v[132:133], v[106:107], v[18:19] op_sel:[1,0,0] op_sel_hi:[1,1,1]
    v_pk_fma_f32 v[20:21], v[134:135], v[108:109], v[20:21] op_sel:[1,0,0] op_sel_hi:[1,1,1]
    v_pk_fma_f32 v[22:23], v[134:135], v[110:111], v[22:23] op_sel:[1,0,0] op_sel_hi:[1,1,1]
    s_set_gpr_idx_off
    s_sub_u32 s32, s32, 1
    s_cbranch_scc1 MAIN_DONE
    v_mfma_f32_4x4x4_16b_bf16 v[124:127], v[172:173], v[178:179], 0 cbsz:4 abid:11
    v_lshlrev_b32_sdwa v136, v15, v114 dst_sel:DWORD dst_unused:UNUSED_PAD src0_sel:DWORD src1_sel:WORD_1
    s_waitcnt vmcnt(8)
    v_mfma_f32_4x4x4_16b_bf16 v[104:107], v[142:143], v[68:69], 0 cbsz:4 abid:10
    s_nop 0
    v_mfma_f32_4x4x4_16b_bf16 v[108:111], v[142:143], v[70:71], 0 cbsz:4 abid:10
    v_lshlrev_b32_sdwa v137, v15, v115 dst_sel:DWORD dst_unused:UNUSED_PAD src0_sel:DWORD src1_sel:WORD_1
    ds_read_u16_d16_hi v132, v136 offset:32768
    ds_read_u16_d16_hi v133, v137 offset:32768
    s_waitcnt lgkmcnt(2)
    s_set_gpr_idx_on s56, 0xc
    v_pk_fma_f32 v[16:17], v[128:129], v[96:97], v[16:17] op_sel:[0,0,0] op_sel_hi:[0,1,1]
    v_pk_fma_f32 v[18:19], v[128:129], v[98:99], v[18:19] op_sel:[0,0,0] op_sel_hi:[0,1,1]
    v_pk_fma_f32 v[20:21], v[130:131], v[100:101], v[20:21] op_sel:[0,0,0] op_sel_hi:[0,1,1]
    v_pk_fma_f32 v[22:23], v[130:131], v[102:103], v[22:23] op_sel:[0,0,0] op_sel_hi:[0,1,1]
    s_set_gpr_idx_off
    s_sub_u32 s32, s32, 1
    s_cbranch_scc1 MAIN_DONE
    v_mfma_f32_4x4x4_16b_bf16 v[148:151], v[168:169], v[180:181], 0
    v_lshlrev_b32_sdwa v138, v15, v118 dst_sel:DWORD dst_unused:UNUSED_PAD src0_sel:DWORD src1_sel:WORD_1
    v_mfma_f32_4x4x4_16b_bf16 v[96:99], v[144:145], v[72:73], 0 cbsz:4 abid:10
    s_nop 0
    v_mfma_f32_4x4x4_16b_bf16 v[100:103], v[144:145], v[74:75], 0 cbsz:4 abid:10
    v_lshlrev_b32_sdwa v139, v15, v119 dst_sel:DWORD dst_unused:UNUSED_PAD src0_sel:DWORD src1_sel:WORD_1
    ds_read_u16_d16_hi v134, v138 offset:32768
    ds_read_u16_d16_hi v135, v139 offset:32768
    s_set_gpr_idx_on s57, 0xc
    v_pk_fma_f32 v[16:17], v[128:129], v[104:105], v[16:17] op_sel:[1,0,0] op_sel_hi:[1,1,1]
    v_pk_fma_f32 v[18:19], v[128:129], v[106:107], v[18:19] op_sel:[1,0,0] op_sel_hi:[1,1,1]
    v_pk_fma_f32 v[20:21], v[130:131], v[108:109], v[20:21] op_sel:[1,0,0] op_sel_hi:[1,1,1]
    v_pk_fma_f32 v[22:23], v[130:131], v[110:111], v[22:23] op_sel:[1,0,0] op_sel_hi:[1,1,1]
    s_set_gpr_idx_off
    s_branch MAIN_DONE
B_40:
    buffer_load_dwordx4 v[188:191], v1, s[16:19], s10 offen offset:0 sc1
    buffer_load_dwordx4 v[192:195], v1, s[16:19], s10 offen offset:1024 sc1
    buffer_load_dwordx4 v[196:199], v1, s[16:19], s10 offen offset:2048 sc1
    buffer_load_dwordx4 v[200:203], v1, s[16:19], s10 offen offset:3072 sc1
    buffer_load_dwordx4 v[204:207], v1, s[16:19], s11 offen offset:0 sc1
    buffer_load_dwordx4 v[208:211], v1, s[16:19], s11 offen offset:1024 sc1
    buffer_load_dwordx4 v[212:215], v1, s[16:19], s11 offen offset:2048 sc1
    buffer_load_dwordx4 v[216:219], v1, s[16:19], s11 offen offset:3072 sc1
    s_sub_u32 s32, s32, 1
    s_cbranch_scc1 MAIN_DONE
    v_mfma_f32_4x4x4_16b_bf16 v[124:127], v[172:173], v[178:179], 0 cbsz:4 abid:11
    v_lshlrev_b32_sdwa v136, v15, v114 dst_sel:DWORD dst_unused:UNUSED_PAD src0_sel:DWORD src1_sel:WORD_1
    s_waitcnt vmcnt(12)
    v_mfma_f32_4x4x4_16b_bf16 v[104:107], v[142:143], v[68:69], 0 cbsz:4 abid:10
    s_nop 0
    v_mfma_f32_4x4x4_16b_bf16 v[108:111], v[142:143], v[70:71], 0 cbsz:4 abid:10
    v_lshlrev_b32_sdwa v137, v15, v115 dst_sel:DWORD dst_unused:UNUSED_PAD src0_sel:DWORD src1_sel:WORD_1
    ds_read_u16_d16_hi v132, v136 offset:32768
    ds_read_u16_d16_hi v133, v137 offset:32768
    s_waitcnt lgkmcnt(2)
    s_set_gpr_idx_on s56, 0xc
    v_pk_fma_f32 v[16:17], v[128:129], v[96:97], v[16:17] op_sel:[0,0,0] op_sel_hi:[0,1,1]
    v_pk_fma_f32 v[18:19], v[128:129], v[98:99], v[18:19] op_sel:[0,0,0] op_sel_hi:[0,1,1]
    v_pk_fma_f32 v[20:21], v[130:131], v[100:101], v[20:21] op_sel:[0,0,0] op_sel_hi:[0,1,1]
    v_pk_fma_f32 v[22:23], v[130:131], v[102:103], v[22:23] op_sel:[0,0,0] op_sel_hi:[0,1,1]
    s_set_gpr_idx_off
    s_sub_u32 s32, s32, 1
    s_cbranch_scc1 MAIN_DONE
    v_mfma_f32_4x4x4_16b_bf16 v[148:151], v[168:169], v[180:181], 0
    v_lshlrev_b32_sdwa v138, v15, v118 dst_sel:DWORD dst_unused:UNUSED_PAD src0_sel:DWORD src1_sel:WORD_1
    s_waitcnt vmcnt(11)
    v_mfma_f32_4x4x4_16b_bf16 v[96:99], v[144:145], v[72:73], 0 cbsz:4 abid:10
    s_nop 0
    v_mfma_f32_4x4x4_16b_bf16 v[100:103], v[144:145], v[74:75], 0 cbsz:4 abid:10
    v_lshlrev_b32_sdwa v139, v15, v119 dst_sel:DWORD dst_unused:UNUSED_PAD src0_sel:DWORD src1_sel:WORD_1
    ds_read_u16_d16_hi v134, v138 offset:32768
    ds_read_u16_d16_hi v135, v139 offset:32768
    s_set_gpr_idx_on s57, 0xc
    v_pk_fma_f32 v[16:17], v[128:129], v[104:105], v[16:17] op_sel:[1,0,0] op_sel_hi:[1,1,1]
    v_pk_fma_f32 v[18:19], v[128:129], v[106:107], v[18:19] op_sel:[1,0,0] op_sel_hi:[1,1,1]
    v_pk_fma_f32 v[20:21], v[130:131], v[108:109], v[20:21] op_sel:[1,0,0] op_sel_hi:[1,1,1]
    v_pk_fma_f32 v[22:23], v[130:131], v[110:111], v[22:23] op_sel:[1,0,0] op_sel_hi:[1,1,1]
    s_set_gpr_idx_off
    s_sub_u32 s32, s32, 1
    s_cbranch_scc1 MAIN_DONE
    v_mfma_f32_4x4x4_16b_bf16 v[112:115], v[172:173], v[176:177], 0 cbsz:4 abid:12
    v_lshlrev_b32_sdwa v136, v15, v120 dst_sel:DWORD dst_unused:UNUSED_PAD src0_sel:DWORD src1_sel:WORD_1
    s_waitcnt vmcnt(10)
    v_mfma_f32_4x4x4_16b_bf16 v[104:107], v[146:147], v[76:77], 0 cbsz:4 abid:10
    s_nop 0
    v_mfma_f32_4x4x4_16b_bf16 v[108:111], v[146:147], v[78:79], 0 cbsz:4 abid:10
    v_lshlrev_b32_sdwa v137, v15, v121 dst_sel:DWORD dst_unused:UNUSED_PAD src0_sel:DWORD src1_sel:WORD_1
    ds_read_u16_d16_hi v128, v136 offset:32768
    ds_read_u16_d16_hi v129, v137 offset:32768
    s_waitcnt lgkmcnt(2)
    s_set_gpr_idx_on s58, 0xc
    v_pk_fma_f32 v[16:17], v[132:133], v[96:97], v[16:17] op_sel:[0,0,0] op_sel_hi:[0,1,1]
    v_pk_fma_f32 v[18:19], v[132:133], v[98:99], v[18:19] op_sel:[0,0,0] op_sel_hi:[0,1,1]
    v_pk_fma_f32 v[20:21], v[134:135], v[100:101], v[20:21] op_sel:[0,0,0] op_sel_hi:[0,1,1]
    v_pk_fma_f32 v[22:23], v[134:135], v[102:103], v[22:23] op_sel:[0,0,0] op_sel_hi:[0,1,1]
    s_set_gpr_idx_off
    s_sub_u32 s32, s32, 1
    s_cbranch_scc1 MAIN_DONE
    v_mfma_f32_4x4x4_16b_bf16 v[152:155], v[168:169], v[182:183], 0
    v_lshlrev_b32_sdwa v138, v15, v124 dst_sel:DWORD dst_unused:UNUSED_PAD src0_sel:DWORD src1_sel:WORD_1
    s_waitcnt vmcnt(9)
    v_mfma_f32_4x4x4_16b_bf16 v[96:99], v[140:141], v[80:81], 0 cbsz:4 abid:11
    s_nop 0
    v_mfma_f32_4x4x4_16b_bf16 v[100:103], v[140:141], v[82:83], 0 cbsz:4 abid:11
    v_lshlrev_b32_sdwa v139, v15, v125 dst_sel:DWORD dst_unused:UNUSED_PAD src0_sel:DWORD src1_sel:WORD_1
    ds_read_u16_d16_hi v130, v138 offset:32768
    ds_read_u16_d16_hi v131, v139 offset:32768
    s_set_gpr_idx_on s59, 0xc
    v_pk_fma_f32 v[16:17], v[132:133], v[104:105], v[16:17] op_sel:[1,0,0] op_sel_hi:[1,1,1]
    v_pk_fma_f32 v[18:19], v[132:133], v[106:107], v[18:19] op_sel:[1,0,0] op_sel_hi:[1,1,1]
    v_pk_fma_f32 v[20:21], v[134:135], v[108:109], v[20:21] op_sel:[1,0,0] op_sel_hi:[1,1,1]
    v_pk_fma_f32 v[22:23], v[134:135], v[110:111], v[22:23] op_sel:[1,0,0] op_sel_hi:[1,1,1]
    s_set_gpr_idx_off
    s_sub_u32 s32, s32, 1
    s_cbranch_scc1 MAIN_DONE
    v_mfma_f32_4x4x4_16b_bf16 v[116:119], v[172:173], v[178:179], 0 cbsz:4 abid:12
    v_lshlrev_b32_sdwa v136, v15, v122 dst_sel:DWORD dst_unused:UNUSED_PAD src0_sel:DWORD src1_sel:WORD_1
    s_waitcnt vmcnt(8)
    v_mfma_f32_4x4x4_16b_bf16 v[104:107], v[142:143], v[84:85], 0 cbsz:4 abid:11
    s_nop 0
    v_mfma_f32_4x4x4_16b_bf16 v[108:111], v[142:143], v[86:87], 0 cbsz:4 abid:11
    v_lshlrev_b32_sdwa v137, v15, v123 dst_sel:DWORD dst_unused:UNUSED_PAD src0_sel:DWORD src1_sel:WORD_1
    ds_read_u16_d16_hi v132, v136 offset:32768
    ds_read_u16_d16_hi v133, v137 offset:32768
    s_waitcnt lgkmcnt(2)
    s_set_gpr_idx_on s60, 0xc
    v_pk_fma_f32 v[16:17], v[128:129], v[96:97], v[16:17] op_sel:[0,0,0] op_sel_hi:[0,1,1]
    v_pk_fma_f32 v[18:19], v[128:129], v[98:99], v[18:19] op_sel:[0,0,0] op_sel_hi:[0,1,1]
    v_pk_fma_f32 v[20:21], v[130:131], v[100:101], v[20:21] op_sel:[0,0,0] op_sel_hi:[0,1,1]
    v_pk_fma_f32 v[22:23], v[130:131], v[102:103], v[22:23] op_sel:[0,0,0] op_sel_hi:[0,1,1]
    s_set_gpr_idx_off
    s_sub_u32 s32, s32, 1
    s_cbranch_scc1 MAIN_DONE
    v_mfma_f32_4x4x4_16b_bf16 v[156:159], v[168:169], v[184:185], 0
    v_lshlrev_b32_sdwa v138, v15, v126 dst_sel:DWORD dst_unused:UNUSED_PAD src0_sel:DWORD src1_sel:WORD_1
    v_mfma_f32_4x4x4_16b_bf16 v[96:99], v[144:145], v[88:89], 0 cbsz:4 abid:11
    s_nop 0
    v_mfma_f32_4x4x4_16b_bf16 v[100:103], v[144:145], v[90:91], 0 cbsz:4 abid:11
    v_lshlrev_b32_sdwa v139, v15, v127 dst_sel:DWORD dst_unused:UNUSED_PAD src0_sel:DWORD src1_sel:WORD_1
    ds_read_u16_d16_hi v134, v138 offset:32768
    ds_read_u16_d16_hi v135, v139 offset:32768
    s_set_gpr_idx_on s61, 0xc
    v_pk_fma_f32 v[16:17], v[128:129], v[104:105], v[16:17] op_sel:[1,0,0] op_sel_hi:[1,1,1]
    v_pk_fma_f32 v[18:19], v[128:129], v[106:107], v[18:19] op_sel:[1,0,0] op_sel_hi:[1,1,1]
    v_pk_fma_f32 v[20:21], v[130:131], v[108:109], v[20:21] op_sel:[1,0,0] op_sel_hi:[1,1,1]
    v_pk_fma_f32 v[22:23], v[130:131], v[110:111], v[22:23] op_sel:[1,0,0] op_sel_hi:[1,1,1]
    s_set_gpr_idx_off
    s_branch MAIN_DONE
B_44:
    buffer_load_dwordx4 v[188:191], v1, s[16:19], s10 offen offset:0 sc1
    buffer_load_dwordx4 v[192:195], v1, s[16:19], s10 offen offset:1024 sc1
    buffer_load_dwordx4 v[196:199], v1, s[16:19], s10 offen offset:2048 sc1
    buffer_load_dwordx4 v[200:203], v1, s[16:19], s10 offen offset:3072 sc1
    buffer_load_dwordx4 v[204:207], v1, s[16:19], s11 offen offset:0 sc1
    buffer_load_dwordx4 v[208:211], v1, s[16:19], s11 offen offset:1024 sc1
    buffer_load_dwordx4 v[212:215], v1, s[16:19], s11 offen offset:2048 sc1
    buffer_load_dwordx4 v[216:219], v1, s[16:19], s11 offen offset:3072 sc1
    s_sub_u32 s32, s32, 1
    s_cbranch_scc1 MAIN_DONE
    v_mfma_f32_4x4x4_16b_bf16 v[116:119], v[172:173], v[178:179], 0 cbsz:4 abid:12
    v_lshlrev_b32_sdwa v136, v15, v122 dst_sel:DWORD dst_unused:UNUSED_PAD src0_sel:DWORD src1_sel:WORD_1
    s_waitcnt vmcnt(12)
    v_mfma_f32_4x4x4_16b_bf16 v[104:107], v[142:143], v[84:85], 0 cbsz:4 abid:11
    s_nop 0
    v_mfma_f32_4x4x4_16b_bf16 v[108:111], v[142:143], v[86:87], 0 cbsz:4 abid:11
    v_lshlrev_b32_sdwa v137, v15, v123 dst_sel:DWORD dst_unused:UNUSED_PAD src0_sel:DWORD src1_sel:WORD_1
    ds_read_u16_d16_hi v132, v136 offset:32768
    ds_read_u16_d16_hi v133, v137 offset:32768
    s_waitcnt lgkmcnt(2)
    s_set_gpr_idx_on s60, 0xc
    v_pk_fma_f32 v[16:17], v[128:129], v[96:97], v[16:17] op_sel:[0,0,0] op_sel_hi:[0,1,1]
    v_pk_fma_f32 v[18:19], v[128:129], v[98:99], v[18:19] op_sel:[0,0,0] op_sel_hi:[0,1,1]
    v_pk_fma_f32 v[20:21], v[130:131], v[100:101], v[20:21] op_sel:[0,0,0] op_sel_hi:[0,1,1]
    v_pk_fma_f32 v[22:23], v[130:131], v[102:103], v[22:23] op_sel:[0,0,0] op_sel_hi:[0,1,1]
    s_set_gpr_idx_off
    s_sub_u32 s32, s32, 1
    s_cbranch_scc1 MAIN_DONE
    v_mfma_f32_4x4x4_16b_bf16 v[156:159], v[168:169], v[184:185], 0
    v_lshlrev_b32_sdwa v138, v15, v126 dst_sel:DWORD dst_unused:UNUSED_PAD src0_sel:DWORD src1_sel:WORD_1
    s_waitcnt vmcnt(11)
    v_mfma_f32_4x4x4_16b_bf16 v[96:99], v[144:145], v[88:89], 0 cbsz:4 abid:11
    s_nop 0
    v_mfma_f32_4x4x4_16b_bf16 v[100:103], v[144:145], v[90:91], 0 cbsz:4 abid:11
    v_lshlrev_b32_sdwa v139, v15, v127 dst_sel:DWORD dst_unused:UNUSED_PAD src0_sel:DWORD src1_sel:WORD_1
    ds_read_u16_d16_hi v134, v138 offset:32768
    ds_read_u16_d16_hi v135, v139 offset:32768
    s_set_gpr_idx_on s61, 0xc
    v_pk_fma_f32 v[16:17], v[128:129], v[104:105], v[16:17] op_sel:[1,0,0] op_sel_hi:[1,1,1]
    v_pk_fma_f32 v[18:19], v[128:129], v[106:107], v[18:19] op_sel:[1,0,0] op_sel_hi:[1,1,1]
    v_pk_fma_f32 v[20:21], v[130:131], v[108:109], v[20:21] op_sel:[1,0,0] op_sel_hi:[1,1,1]
    v_pk_fma_f32 v[22:23], v[130:131], v[110:111], v[22:23] op_sel:[1,0,0] op_sel_hi:[1,1,1]
    s_set_gpr_idx_off
    s_sub_u32 s32, s32, 1
    s_cbranch_scc1 MAIN_DONE
    v_mfma_f32_4x4x4_16b_bf16 v[120:123], v[172:173], v[176:177], 0 cbsz:4 abid:13
    v_lshlrev_b32_sdwa v136, v15, v112 dst_sel:DWORD dst_unused:UNUSED_PAD src0_sel:DWORD src1_sel:WORD_1
    s_waitcnt vmcnt(10)
    v_mfma_f32_4x4x4_16b_bf16 v[104:107], v[146:147], v[92:93], 0 cbsz:4 abid:11
    s_nop 0
    v_mfma_f32_4x4x4_16b_bf16 v[108:111], v[146:147], v[94:95], 0 cbsz:4 abid:11
    v_lshlrev_b32_sdwa v137, v15, v113 dst_sel:DWORD dst_unused:UNUSED_PAD src0_sel:DWORD src1_sel:WORD_1
    ds_read_u16_d16_hi v128, v136 offset:32768
    ds_read_u16_d16_hi v129, v137 offset:32768
    s_waitcnt lgkmcnt(2)
    s_set_gpr_idx_on s62, 0xc
    v_pk_fma_f32 v[16:17], v[132:133], v[96:97], v[16:17] op_sel:[0,0,0] op_sel_hi:[0,1,1]
    v_pk_fma_f32 v[18:19], v[132:133], v[98:99], v[18:19] op_sel:[0,0,0] op_sel_hi:[0,1,1]
    v_pk_fma_f32 v[20:21], v[134:135], v[100:101], v[20:21] op_sel:[0,0,0] op_sel_hi:[0,1,1]
    v_pk_fma_f32 v[22:23], v[134:135], v[102:103], v[22:23] op_sel:[0,0,0] op_sel_hi:[0,1,1]
    s_set_gpr_idx_off
    s_sub_u32 s32, s32, 1
    s_cbranch_scc1 MAIN_DONE
    v_mfma_f32_4x4x4_16b_bf16 v[160:163], v[168:169], v[186:187], 0
    v_lshlrev_b32_sdwa v138, v15, v116 dst_sel:DWORD dst_unused:UNUSED_PAD src0_sel:DWORD src1_sel:WORD_1
    s_waitcnt vmcnt(9)
    v_mfma_f32_4x4x4_16b_bf16 v[96:99], v[140:141], v[64:65], 0 cbsz:4 abid:12
    s_nop 0
    v_mfma_f32_4x4x4_16b_bf16 v[100:103], v[140:141], v[66:67], 0 cbsz:4 abid:12
    v_lshlrev_b32_sdwa v139, v15, v117 dst_sel:DWORD dst_unused:UNUSED_PAD src0_sel:DWORD src1_sel:WORD_1
    ds_read_u16_d16_hi v130, v138 offset:32768
    ds_read_u16_d16_hi v131, v139 offset:32768
    s_set_gpr_idx_on s63, 0xc
    v_pk_fma_f32 v[16:17], v[132:133], v[104:105], v[16:17] op_sel:[1,0,0] op_sel_hi:[1,1,1]
    v_pk_fma_f32 v[18:19], v[132:133], v[106:107], v[18:19] op_sel:[1,0,0] op_sel_hi:[1,1,1]
    v_pk_fma_f32 v[20:21], v[134:135], v[108:109], v[20:21] op_sel:[1,0,0] op_sel_hi:[1,1,1]
    v_pk_fma_f32 v[22:23], v[134:135], v[110:111], v[22:23] op_sel:[1,0,0] op_sel_hi:[1,1,1]
    s_set_gpr_idx_off
    s_sub_u32 s32, s32, 1
    s_cbranch_scc1 MAIN_DONE
    v_mfma_f32_4x4x4_16b_bf16 v[124:127], v[172:173], v[178:179], 0 cbsz:4 abid:13
    v_lshlrev_b32_sdwa v136, v15, v114 dst_sel:DWORD dst_unused:UNUSED_PAD src0_sel:DWORD src1_sel:WORD_1
    s_waitcnt vmcnt(8)
    v_mfma_f32_4x4x4_16b_bf16 v[104:107], v[142:143], v[68:69], 0 cbsz:4 abid:12
    s_nop 0
    v_mfma_f32_4x4x4_16b_bf16 v[108:111], v[142:143], v[70:71], 0 cbsz:4 abid:12
    v_lshlrev_b32_sdwa v137, v15, v115 dst_sel:DWORD dst_unused:UNUSED_PAD src0_sel:DWORD src1_sel:WORD_1
    ds_read_u16_d16_hi v132, v136 offset:32768
    ds_read_u16_d16_hi v133, v137 offset:32768
    s_waitcnt lgkmcnt(2)
    s_set_gpr_idx_on s48, 0xc
    v_pk_fma_f32 v[16:17], v[128:129], v[96:97], v[16:17] op_sel:[0,0,0] op_sel_hi:[0,1,1]
    v_pk_fma_f32 v[18:19], v[128:129], v[98:99], v[18:19] op_sel:[0,0,0] op_sel_hi:[0,1,1]
    v_pk_fma_f32 v[20:21], v[130:131], v[100:101], v[20:21] op_sel:[0,0,0] op_sel_hi:[0,1,1]
    v_pk_fma_f32 v[22:23], v[130:131], v[102:103], v[22:23] op_sel:[0,0,0] op_sel_hi:[0,1,1]
    s_set_gpr_idx_off
    s_sub_u32 s32, s32, 1
    s_cbranch_scc1 MAIN_DONE
    v_lshlrev_b32_sdwa v138, v15, v118 dst_sel:DWORD dst_unused:UNUSED_PAD src0_sel:DWORD src1_sel:WORD_1
    v_mfma_f32_4x4x4_16b_bf16 v[96:99], v[144:145], v[72:73], 0 cbsz:4 abid:12
    s_nop 0
    v_mfma_f32_4x4x4_16b_bf16 v[100:103], v[144:145], v[74:75], 0 cbsz:4 abid:12
    v_lshlrev_b32_sdwa v139, v15, v119 dst_sel:DWORD dst_unused:UNUSED_PAD src0_sel:DWORD src1_sel:WORD_1
    ds_read_u16_d16_hi v134, v138 offset:32768
    ds_read_u16_d16_hi v135, v139 offset:32768
    s_set_gpr_idx_on s49, 0xc
    v_pk_fma_f32 v[16:17], v[128:129], v[104:105], v[16:17] op_sel:[1,0,0] op_sel_hi:[1,1,1]
    v_pk_fma_f32 v[18:19], v[128:129], v[106:107], v[18:19] op_sel:[1,0,0] op_sel_hi:[1,1,1]
    v_pk_fma_f32 v[20:21], v[130:131], v[108:109], v[20:21] op_sel:[1,0,0] op_sel_hi:[1,1,1]
    v_pk_fma_f32 v[22:23], v[130:131], v[110:111], v[22:23] op_sel:[1,0,0] op_sel_hi:[1,1,1]
    s_set_gpr_idx_off
    s_branch MAIN_DONE
B_48:
    buffer_load_dwordx4 v[188:191], v1, s[16:19], s10 offen offset:0 sc1
    buffer_load_dwordx4 v[192:195], v1, s[16:19], s10 offen offset:1024 sc1
    buffer_load_dwordx4 v[196:199], v1, s[16:19], s10 offen offset:2048 sc1
    buffer_load_dwordx4 v[200:203], v1, s[16:19], s10 offen offset:3072 sc1
    buffer_load_dwordx4 v[204:207], v1, s[16:19], s11 offen offset:0 sc1
    buffer_load_dwordx4 v[208:211], v1, s[16:19], s11 offen offset:1024 sc1
    buffer_load_dwordx4 v[212:215], v1, s[16:19], s11 offen offset:2048 sc1
    buffer_load_dwordx4 v[216:219], v1, s[16:19], s11 offen offset:3072 sc1
    s_sub_u32 s32, s32, 1
    s_cbranch_scc1 MAIN_DONE
    v_mfma_f32_4x4x4_16b_bf16 v[124:127], v[172:173], v[178:179], 0 cbsz:4 abid:13
    v_lshlrev_b32_sdwa v136, v15, v114 dst_sel:DWORD dst_unused:UNUSED_PAD src0_sel:DWORD src1_sel:WORD_1
    s_waitcnt vmcnt(12)
    v_mfma_f32_4x4x4_16b_bf16 v[104:107], v[142:143], v[68:69], 0 cbsz:4 abid:12
    s_nop 0
    v_mfma_f32_4x4x4_16b_bf16 v[108:111], v[142:143], v[70:71], 0 cbsz:4 abid:12
    v_lshlrev_b32_sdwa v137, v15, v115 dst_sel:DWORD dst_unused:UNUSED_PAD src0_sel:DWORD src1_sel:WORD_1
    ds_read_u16_d16_hi v132, v136 offset:32768
    ds_read_u16_d16_hi v133, v137 offset:32768
    s_waitcnt lgkmcnt(2)
    s_set_gpr_idx_on s48, 0xc
    v_pk_fma_f32 v[16:17], v[128:129], v[96:97], v[16:17] op_sel:[0,0,0] op_sel_hi:[0,1,1]
    v_pk_fma_f32 v[18:19], v[128:129], v[98:99], v[18:19] op_sel:[0,0,0] op_sel_hi:[0,1,1]
    v_pk_fma_f32 v[20:21], v[130:131], v[100:101], v[20:21] op_sel:[0,0,0] op_sel_hi:[0,1,1]
    v_pk_fma_f32 v[22:23], v[130:131], v[102:103], v[22:23] op_sel:[0,0,0] op_sel_hi:[0,1,1]
    s_set_gpr_idx_off
    s_sub_u32 s32, s32, 1
    s_cbranch_scc1 MAIN_DONE
    v_lshlrev_b32_sdwa v138, v15, v118 dst_sel:DWORD dst_unused:UNUSED_PAD src0_sel:DWORD src1_sel:WORD_1
    s_waitcnt vmcnt(11)
    v_mfma_f32_4x4x4_16b_bf16 v[96:99], v[144:145], v[72:73], 0 cbsz:4 abid:12
    s_nop 0
    v_mfma_f32_4x4x4_16b_bf16 v[100:103], v[144:145], v[74:75], 0 cbsz:4 abid:12
    v_lshlrev_b32_sdwa v139, v15, v119 dst_sel:DWORD dst_unused:UNUSED_PAD src0_sel:DWORD src1_sel:WORD_1
    ds_read_u16_d16_hi v134, v138 offset:32768
    ds_read_u16_d16_hi v135, v139 offset:32768
    s_set_gpr_idx_on s49, 0xc
    v_pk_fma_f32 v[16:17], v[128:129], v[104:105], v[16:17] op_sel:[1,0,0] op_sel_hi:[1,1,1]
    v_pk_fma_f32 v[18:19], v[128:129], v[106:107], v[18:19] op_sel:[1,0,0] op_sel_hi:[1,1,1]
    v_pk_fma_f32 v[20:21], v[130:131], v[108:109], v[20:21] op_sel:[1,0,0] op_sel_hi:[1,1,1]
    v_pk_fma_f32 v[22:23], v[130:131], v[110:111], v[22:23] op_sel:[1,0,0] op_sel_hi:[1,1,1]
    s_set_gpr_idx_off
    s_sub_u32 s32, s32, 1
    s_cbranch_scc1 MAIN_DONE
    v_mfma_f32_4x4x4_16b_bf16 v[112:115], v[172:173], v[176:177], 0 cbsz:4 abid:14
    v_lshlrev_b32_sdwa v136, v15, v120 dst_sel:DWORD dst_unused:UNUSED_PAD src0_sel:DWORD src1_sel:WORD_1
    s_waitcnt vmcnt(10)
    v_mfma_f32_4x4x4_16b_bf16 v[104:107], v[146:147], v[76:77], 0 cbsz:4 abid:12
    s_nop 0
    v_mfma_f32_4x4x4_16b_bf16 v[108:111], v[146:147], v[78:79], 0 cbsz:4 abid:12
    v_lshlrev_b32_sdwa v137, v15, v121 dst_sel:DWORD dst_unused:UNUSED_PAD src0_sel:DWORD src1_sel:WORD_1
    ds_read_u16_d16_hi v128, v136 offset:32768
    ds_read_u16_d16_hi v129, v137 offset:32768
    s_waitcnt lgkmcnt(2)
    s_set_gpr_idx_on s50, 0xc
    v_pk_fma_f32 v[16:17], v[132:133], v[96:97], v[16:17] op_sel:[0,0,0] op_sel_hi:[0,1,1]
    v_pk_fma_f32 v[18:19], v[132:133], v[98:99], v[18:19] op_sel:[0,0,0] op_sel_hi:[0,1,1]
    v_pk_fma_f32 v[20:21], v[134:135], v[100:101], v[20:21] op_sel:[0,0,0] op_sel_hi:[0,1,1]
    v_pk_fma_f32 v[22:23], v[134:135], v[102:103], v[22:23] op_sel:[0,0,0] op_sel_hi:[0,1,1]
    s_set_gpr_idx_off
    s_sub_u32 s32, s32, 1
    s_cbranch_scc1 MAIN_DONE
    v_lshlrev_b32_sdwa v138, v15, v124 dst_sel:DWORD dst_unused:UNUSED_PAD src0_sel:DWORD src1_sel:WORD_1
    s_waitcnt vmcnt(9)
    v_mfma_f32_4x4x4_16b_bf16 v[96:99], v[140:141], v[80:81], 0 cbsz:4 abid:13
    s_nop 0
    v_mfma_f32_4x4x4_16b_bf16 v[100:103], v[140:141], v[82:83], 0 cbsz:4 abid:13
    v_lshlrev_b32_sdwa v139, v15, v125 dst_sel:DWORD dst_unused:UNUSED_PAD src0_sel:DWORD src1_sel:WORD_1
    ds_read_u16_d16_hi v130, v138 offset:32768
    ds_read_u16_d16_hi v131, v139 offset:32768
    s_set_gpr_idx_on s51, 0xc
    v_pk_fma_f32 v[16:17], v[132:133], v[104:105], v[16:17] op_sel:[1,0,0] op_sel_hi:[1,1,1]
    v_pk_fma_f32 v[18:19], v[132:133], v[106:107], v[18:19] op_sel:[1,0,0] op_sel_hi:[1,1,1]
    v_pk_fma_f32 v[20:21], v[134:135], v[108:109], v[20:21] op_sel:[1,0,0] op_sel_hi:[1,1,1]
    v_pk_fma_f32 v[22:23], v[134:135], v[110:111], v[22:23] op_sel:[1,0,0] op_sel_hi:[1,1,1]
    s_set_gpr_idx_off
    s_sub_u32 s32, s32, 1
    s_cbranch_scc1 MAIN_DONE
    v_mfma_f32_4x4x4_16b_bf16 v[116:119], v[172:173], v[178:179], 0 cbsz:4 abid:14
    v_lshlrev_b32_sdwa v136, v15, v122 dst_sel:DWORD dst_unused:UNUSED_PAD src0_sel:DWORD src1_sel:WORD_1
    s_waitcnt vmcnt(8)
    v_mfma_f32_4x4x4_16b_bf16 v[104:107], v[142:143], v[84:85], 0 cbsz:4 abid:13
    s_nop 0
    v_mfma_f32_4x4x4_16b_bf16 v[108:111], v[142:143], v[86:87], 0 cbsz:4 abid:13
    v_lshlrev_b32_sdwa v137, v15, v123 dst_sel:DWORD dst_unused:UNUSED_PAD src0_sel:DWORD src1_sel:WORD_1
    ds_read_u16_d16_hi v132, v136 offset:32768
    ds_read_u16_d16_hi v133, v137 offset:32768
    s_waitcnt lgkmcnt(2)
    s_set_gpr_idx_on s52, 0xc
    v_pk_fma_f32 v[16:17], v[128:129], v[96:97], v[16:17] op_sel:[0,0,0] op_sel_hi:[0,1,1]
    v_pk_fma_f32 v[18:19], v[128:129], v[98:99], v[18:19] op_sel:[0,0,0] op_sel_hi:[0,1,1]
    v_pk_fma_f32 v[20:21], v[130:131], v[100:101], v[20:21] op_sel:[0,0,0] op_sel_hi:[0,1,1]
    v_pk_fma_f32 v[22:23], v[130:131], v[102:103], v[22:23] op_sel:[0,0,0] op_sel_hi:[0,1,1]
    s_set_gpr_idx_off
    s_sub_u32 s32, s32, 1
    s_cbranch_scc1 MAIN_DONE
    v_lshlrev_b32_sdwa v138, v15, v126 dst_sel:DWORD dst_unused:UNUSED_PAD src0_sel:DWORD src1_sel:WORD_1
    v_mfma_f32_4x4x4_16b_bf16 v[96:99], v[144:145], v[88:89], 0 cbsz:4 abid:13
    s_nop 0
    v_mfma_f32_4x4x4_16b_bf16 v[100:103], v[144:145], v[90:91], 0 cbsz:4 abid:13
    v_lshlrev_b32_sdwa v139, v15, v127 dst_sel:DWORD dst_unused:UNUSED_PAD src0_sel:DWORD src1_sel:WORD_1
    ds_read_u16_d16_hi v134, v138 offset:32768
    ds_read_u16_d16_hi v135, v139 offset:32768
    s_set_gpr_idx_on s53, 0xc
    v_pk_fma_f32 v[16:17], v[128:129], v[104:105], v[16:17] op_sel:[1,0,0] op_sel_hi:[1,1,1]
    v_pk_fma_f32 v[18:19], v[128:129], v[106:107], v[18:19] op_sel:[1,0,0] op_sel_hi:[1,1,1]
    v_pk_fma_f32 v[20:21], v[130:131], v[108:109], v[20:21] op_sel:[1,0,0] op_sel_hi:[1,1,1]
    v_pk_fma_f32 v[22:23], v[130:131], v[110:111], v[22:23] op_sel:[1,0,0] op_sel_hi:[1,1,1]
    s_set_gpr_idx_off
    s_branch MAIN_DONE
B_52:
    buffer_load_dwordx4 v[188:191], v1, s[16:19], s10 offen offset:0 sc1
    buffer_load_dwordx4 v[192:195], v1, s[16:19], s10 offen offset:1024 sc1
    buffer_load_dwordx4 v[196:199], v1, s[16:19], s10 offen offset:2048 sc1
    buffer_load_dwordx4 v[200:203], v1, s[16:19], s10 offen offset:3072 sc1
    buffer_load_dwordx4 v[204:207], v1, s[16:19], s11 offen offset:0 sc1
    buffer_load_dwordx4 v[208:211], v1, s[16:19], s11 offen offset:1024 sc1
    buffer_load_dwordx4 v[212:215], v1, s[16:19], s11 offen offset:2048 sc1
    buffer_load_dwordx4 v[216:219], v1, s[16:19], s11 offen offset:3072 sc1
    s_sub_u32 s32, s32, 1
    s_cbranch_scc1 MAIN_DONE
    v_mfma_f32_4x4x4_16b_bf16 v[116:119], v[172:173], v[178:179], 0 cbsz:4 abid:14
    v_lshlrev_b32_sdwa v136, v15, v122 dst_sel:DWORD dst_unused:UNUSED_PAD src0_sel:DWORD src1_sel:WORD_1
    s_waitcnt vmcnt(12)
    v_mfma_f32_4x4x4_16b_bf16 v[104:107], v[142:143], v[84:85], 0 cbsz:4 abid:13
    s_nop 0
    v_mfma_f32_4x4x4_16b_bf16 v[108:111], v[142:143], v[86:87], 0 cbsz:4 abid:13
    v_lshlrev_b32_sdwa v137, v15, v123 dst_sel:DWORD dst_unused:UNUSED_PAD src0_sel:DWORD src1_sel:WORD_1
    ds_read_u16_d16_hi v132, v136 offset:32768
    ds_read_u16_d16_hi v133, v137 offset:32768
    s_waitcnt lgkmcnt(2)
    s_set_gpr_idx_on s52, 0xc
    v_pk_fma_f32 v[16:17], v[128:129], v[96:97], v[16:17] op_sel:[0,0,0] op_sel_hi:[0,1,1]
    v_pk_fma_f32 v[18:19], v[128:129], v[98:99], v[18:19] op_sel:[0,0,0] op_sel_hi:[0,1,1]
    v_pk_fma_f32 v[20:21], v[130:131], v[100:101], v[20:21] op_sel:[0,0,0] op_sel_hi:[0,1,1]
    v_pk_fma_f32 v[22:23], v[130:131], v[102:103], v[22:23] op_sel:[0,0,0] op_sel_hi:[0,1,1]
    s_set_gpr_idx_off
    s_sub_u32 s32, s32, 1
    s_cbranch_scc1 MAIN_DONE
    v_lshlrev_b32_sdwa v138, v15, v126 dst_sel:DWORD dst_unused:UNUSED_PAD src0_sel:DWORD src1_sel:WORD_1
    s_waitcnt vmcnt(11)
    v_mfma_f32_4x4x4_16b_bf16 v[96:99], v[144:145], v[88:89], 0 cbsz:4 abid:13
    s_nop 0
    v_mfma_f32_4x4x4_16b_bf16 v[100:103], v[144:145], v[90:91], 0 cbsz:4 abid:13
    v_lshlrev_b32_sdwa v139, v15, v127 dst_sel:DWORD dst_unused:UNUSED_PAD src0_sel:DWORD src1_sel:WORD_1
    ds_read_u16_d16_hi v134, v138 offset:32768
    ds_read_u16_d16_hi v135, v139 offset:32768
    s_set_gpr_idx_on s53, 0xc
    v_pk_fma_f32 v[16:17], v[128:129], v[104:105], v[16:17] op_sel:[1,0,0] op_sel_hi:[1,1,1]
    v_pk_fma_f32 v[18:19], v[128:129], v[106:107], v[18:19] op_sel:[1,0,0] op_sel_hi:[1,1,1]
    v_pk_fma_f32 v[20:21], v[130:131], v[108:109], v[20:21] op_sel:[1,0,0] op_sel_hi:[1,1,1]
    v_pk_fma_f32 v[22:23], v[130:131], v[110:111], v[22:23] op_sel:[1,0,0] op_sel_hi:[1,1,1]
    s_set_gpr_idx_off
    s_sub_u32 s32, s32, 1
    s_cbranch_scc1 MAIN_DONE
    v_mfma_f32_4x4x4_16b_bf16 v[120:123], v[172:173], v[176:177], 0 cbsz:4 abid:15
    v_lshlrev_b32_sdwa v136, v15, v112 dst_sel:DWORD dst_unused:UNUSED_PAD src0_sel:DWORD src1_sel:WORD_1
    s_waitcnt vmcnt(10)
    v_mfma_f32_4x4x4_16b_bf16 v[104:107], v[146:147], v[92:93], 0 cbsz:4 abid:13
    s_nop 0
    v_mfma_f32_4x4x4_16b_bf16 v[108:111], v[146:147], v[94:95], 0 cbsz:4 abid:13
    v_lshlrev_b32_sdwa v137, v15, v113 dst_sel:DWORD dst_unused:UNUSED_PAD src0_sel:DWORD src1_sel:WORD_1
    ds_read_u16_d16_hi v128, v136 offset:32768
    ds_read_u16_d16_hi v129, v137 offset:32768
    s_waitcnt lgkmcnt(2)
    s_set_gpr_idx_on s54, 0xc
    v_pk_fma_f32 v[16:17], v[132:133], v[96:97], v[16:17] op_sel:[0,0,0] op_sel_hi:[0,1,1]
    v_pk_fma_f32 v[18:19], v[132:133], v[98:99], v[18:19] op_sel:[0,0,0] op_sel_hi:[0,1,1]
    v_pk_fma_f32 v[20:21], v[134:135], v[100:101], v[20:21] op_sel:[0,0,0] op_sel_hi:[0,1,1]
    v_pk_fma_f32 v[22:23], v[134:135], v[102:103], v[22:23] op_sel:[0,0,0] op_sel_hi:[0,1,1]
    s_set_gpr_idx_off
    s_sub_u32 s32, s32, 1
    s_cbranch_scc1 MAIN_DONE
    v_lshlrev_b32_sdwa v138, v15, v116 dst_sel:DWORD dst_unused:UNUSED_PAD src0_sel:DWORD src1_sel:WORD_1
    s_waitcnt vmcnt(9)
    v_mfma_f32_4x4x4_16b_bf16 v[96:99], v[140:141], v[64:65], 0 cbsz:4 abid:14
    s_nop 0
    v_mfma_f32_4x4x4_16b_bf16 v[100:103], v[140:141], v[66:67], 0 cbsz:4 abid:14
    v_lshlrev_b32_sdwa v139, v15, v117 dst_sel:DWORD dst_unused:UNUSED_PAD src0_sel:DWORD src1_sel:WORD_1
    ds_read_u16_d16_hi v130, v138 offset:32768
    ds_read_u16_d16_hi v131, v139 offset:32768
    s_set_gpr_idx_on s55, 0xc
    v_pk_fma_f32 v[16:17], v[132:133], v[104:105], v[16:17] op_sel:[1,0,0] op_sel_hi:[1,1,1]
    v_pk_fma_f32 v[18:19], v[132:133], v[106:107], v[18:19] op_sel:[1,0,0] op_sel_hi:[1,1,1]
    v_pk_fma_f32 v[20:21], v[134:135], v[108:109], v[20:21] op_sel:[1,0,0] op_sel_hi:[1,1,1]
    v_pk_fma_f32 v[22:23], v[134:135], v[110:111], v[22:23] op_sel:[1,0,0] op_sel_hi:[1,1,1]
    s_set_gpr_idx_off
    s_sub_u32 s32, s32, 1
    s_cbranch_scc1 MAIN_DONE
    v_mfma_f32_4x4x4_16b_bf16 v[124:127], v[172:173], v[178:179], 0 cbsz:4 abid:15
    v_lshlrev_b32_sdwa v136, v15, v114 dst_sel:DWORD dst_unused:UNUSED_PAD src0_sel:DWORD src1_sel:WORD_1
    s_waitcnt vmcnt(8)
    v_mfma_f32_4x4x4_16b_bf16 v[104:107], v[142:143], v[68:69], 0 cbsz:4 abid:14
    s_nop 0
    v_mfma_f32_4x4x4_16b_bf16 v[108:111], v[142:143], v[70:71], 0 cbsz:4 abid:14
    v_lshlrev_b32_sdwa v137, v15, v115 dst_sel:DWORD dst_unused:UNUSED_PAD src0_sel:DWORD src1_sel:WORD_1
    ds_read_u16_d16_hi v132, v136 offset:32768
    ds_read_u16_d16_hi v133, v137 offset:32768
    s_waitcnt lgkmcnt(2)
    s_set_gpr_idx_on s56, 0xc
    v_pk_fma_f32 v[16:17], v[128:129], v[96:97], v[16:17] op_sel:[0,0,0] op_sel_hi:[0,1,1]
    v_pk_fma_f32 v[18:19], v[128:129], v[98:99], v[18:19] op_sel:[0,0,0] op_sel_hi:[0,1,1]
    v_pk_fma_f32 v[20:21], v[130:131], v[100:101], v[20:21] op_sel:[0,0,0] op_sel_hi:[0,1,1]
    v_pk_fma_f32 v[22:23], v[130:131], v[102:103], v[22:23] op_sel:[0,0,0] op_sel_hi:[0,1,1]
    s_set_gpr_idx_off
    s_sub_u32 s32, s32, 1
    s_cbranch_scc1 MAIN_DONE
    v_lshlrev_b32_sdwa v138, v15, v118 dst_sel:DWORD dst_unused:UNUSED_PAD src0_sel:DWORD src1_sel:WORD_1
    v_mfma_f32_4x4x4_16b_bf16 v[96:99], v[144:145], v[72:73], 0 cbsz:4 abid:14
    s_nop 0
    v_mfma_f32_4x4x4_16b_bf16 v[100:103], v[144:145], v[74:75], 0 cbsz:4 abid:14
    v_lshlrev_b32_sdwa v139, v15, v119 dst_sel:DWORD dst_unused:UNUSED_PAD src0_sel:DWORD src1_sel:WORD_1
    ds_read_u16_d16_hi v134, v138 offset:32768
    ds_read_u16_d16_hi v135, v139 offset:32768
    s_set_gpr_idx_on s57, 0xc
    v_pk_fma_f32 v[16:17], v[128:129], v[104:105], v[16:17] op_sel:[1,0,0] op_sel_hi:[1,1,1]
    v_pk_fma_f32 v[18:19], v[128:129], v[106:107], v[18:19] op_sel:[1,0,0] op_sel_hi:[1,1,1]
    v_pk_fma_f32 v[20:21], v[130:131], v[108:109], v[20:21] op_sel:[1,0,0] op_sel_hi:[1,1,1]
    v_pk_fma_f32 v[22:23], v[130:131], v[110:111], v[22:23] op_sel:[1,0,0] op_sel_hi:[1,1,1]
    s_set_gpr_idx_off
    v_mov_b32 v172, v170
    v_mov_b32 v173, v171
    s_nop 1
    s_branch MAIN_DONE
B_56:
    buffer_load_dwordx4 v[188:191], v1, s[16:19], s10 offen offset:0 sc1
    buffer_load_dwordx4 v[192:195], v1, s[16:19], s10 offen offset:1024 sc1
    buffer_load_dwordx4 v[196:199], v1, s[16:19], s10 offen offset:2048 sc1
    buffer_load_dwordx4 v[200:203], v1, s[16:19], s10 offen offset:3072 sc1
    buffer_load_dwordx4 v[204:207], v1, s[16:19], s11 offen offset:0 sc1
    buffer_load_dwordx4 v[208:211], v1, s[16:19], s11 offen offset:1024 sc1
    buffer_load_dwordx4 v[212:215], v1, s[16:19], s11 offen offset:2048 sc1
    buffer_load_dwordx4 v[216:219], v1, s[16:19], s11 offen offset:3072 sc1
    s_sub_u32 s32, s32, 1
    s_cbranch_scc1 MAIN_DONE
    v_mfma_f32_4x4x4_16b_bf16 v[124:127], v[172:173], v[178:179], 0 cbsz:4 abid:15
    v_lshlrev_b32_sdwa v136, v15, v114 dst_sel:DWORD dst_unused:UNUSED_PAD src0_sel:DWORD src1_sel:WORD_1
    s_waitcnt vmcnt(12)
    v_mfma_f32_4x4x4_16b_bf16 v[104:107], v[142:143], v[68:69], 0 cbsz:4 abid:14
    s_nop 0
    v_mfma_f32_4x4x4_16b_bf16 v[108:111], v[142:143], v[70:71], 0 cbsz:4 abid:14
    v_lshlrev_b32_sdwa v137, v15, v115 dst_sel:DWORD dst_unused:UNUSED_PAD src0_sel:DWORD src1_sel:WORD_1
    ds_read_u16_d16_hi v132, v136 offset:32768
    ds_read_u16_d16_hi v133, v137 offset:32768
    s_waitcnt lgkmcnt(2)
    s_set_gpr_idx_on s56, 0xc
    v_pk_fma_f32 v[16:17], v[128:129], v[96:97], v[16:17] op_sel:[0,0,0] op_sel_hi:[0,1,1]
    v_pk_fma_f32 v[18:19], v[128:129], v[98:99], v[18:19] op_sel:[0,0,0] op_sel_hi:[0,1,1]
    v_pk_fma_f32 v[20:21], v[130:131], v[100:101], v[20:21] op_sel:[0,0,0] op_sel_hi:[0,1,1]
    v_pk_fma_f32 v[22:23], v[130:131], v[102:103], v[22:23] op_sel:[0,0,0] op_sel_hi:[0,1,1]
    s_set_gpr_idx_off
    s_sub_u32 s32, s32, 1
    s_cbranch_scc1 MAIN_DONE
    v_lshlrev_b32_sdwa v138, v15, v118 dst_sel:DWORD dst_unused:UNUSED_PAD src0_sel:DWORD src1_sel:WORD_1
    s_waitcnt vmcnt(11)
    v_mfma_f32_4x4x4_16b_bf16 v[96:99], v[144:145], v[72:73], 0 cbsz:4 abid:14
    s_nop 0
    v_mfma_f32_4x4x4_16b_bf16 v[100:103], v[144:145], v[74:75], 0 cbsz:4 abid:14
    v_lshlrev_b32_sdwa v139, v15, v119 dst_sel:DWORD dst_unused:UNUSED_PAD src0_sel:DWORD src1_sel:WORD_1
    ds_read_u16_d16_hi v134, v138 offset:32768
    ds_read_u16_d16_hi v135, v139 offset:32768
    s_set_gpr_idx_on s57, 0xc
    v_pk_fma_f32 v[16:17], v[128:129], v[104:105], v[16:17] op_sel:[1,0,0] op_sel_hi:[1,1,1]
    v_pk_fma_f32 v[18:19], v[128:129], v[106:107], v[18:19] op_sel:[1,0,0] op_sel_hi:[1,1,1]
    v_pk_fma_f32 v[20:21], v[130:131], v[108:109], v[20:21] op_sel:[1,0,0] op_sel_hi:[1,1,1]
    v_pk_fma_f32 v[22:23], v[130:131], v[110:111], v[22:23] op_sel:[1,0,0] op_sel_hi:[1,1,1]
    s_set_gpr_idx_off
    v_mov_b32 v172, v170
    v_mov_b32 v173, v171
    s_nop 1
    s_sub_u32 s32, s32, 1
    s_cbranch_scc1 MAIN_DONE
    v_mfma_f32_4x4x4_16b_bf16 v[112:115], v[172:173], v[176:177], 0 cbsz:4 abid:0
    v_lshlrev_b32_sdwa v136, v15, v120 dst_sel:DWORD dst_unused:UNUSED_PAD src0_sel:DWORD src1_sel:WORD_1
    s_waitcnt vmcnt(10)
    v_mfma_f32_4x4x4_16b_bf16 v[104:107], v[146:147], v[76:77], 0 cbsz:4 abid:14
    s_nop 0
    v_mfma_f32_4x4x4_16b_bf16 v[108:111], v[146:147], v[78:79], 0 cbsz:4 abid:14
    v_lshlrev_b32_sdwa v137, v15, v121 dst_sel:DWORD dst_unused:UNUSED_PAD src0_sel:DWORD src1_sel:WORD_1
    ds_read_u16_d16_hi v128, v136 offset:32768
    ds_read_u16_d16_hi v129, v137 offset:32768
    s_waitcnt lgkmcnt(2)
    s_set_gpr_idx_on s58, 0xc
    v_pk_fma_f32 v[16:17], v[132:133], v[96:97], v[16:17] op_sel:[0,0,0] op_sel_hi:[0,1,1]
    v_pk_fma_f32 v[18:19], v[132:133], v[98:99], v[18:19] op_sel:[0,0,0] op_sel_hi:[0,1,1]
    v_pk_fma_f32 v[20:21], v[134:135], v[100:101], v[20:21] op_sel:[0,0,0] op_sel_hi:[0,1,1]
    v_pk_fma_f32 v[22:23], v[134:135], v[102:103], v[22:23] op_sel:[0,0,0] op_sel_hi:[0,1,1]
    s_set_gpr_idx_off
    s_sub_u32 s32, s32, 1
    s_cbranch_scc1 MAIN_DONE
    v_lshlrev_b32_sdwa v138, v15, v124 dst_sel:DWORD dst_unused:UNUSED_PAD src0_sel:DWORD src1_sel:WORD_1
    s_waitcnt vmcnt(9)
    v_mfma_f32_4x4x4_16b_bf16 v[96:99], v[140:141], v[80:81], 0 cbsz:4 abid:15
    s_nop 0
    v_mfma_f32_4x4x4_16b_bf16 v[100:103], v[140:141], v[82:83], 0 cbsz:4 abid:15
    v_lshlrev_b32_sdwa v139, v15, v125 dst_sel:DWORD dst_unused:UNUSED_PAD src0_sel:DWORD src1_sel:WORD_1
    ds_read_u16_d16_hi v130, v138 offset:32768
    ds_read_u16_d16_hi v131, v139 offset:32768
    s_set_gpr_idx_on s59, 0xc
    v_pk_fma_f32 v[16:17], v[132:133], v[104:105], v[16:17] op_sel:[1,0,0] op_sel_hi:[1,1,1]
    v_pk_fma_f32 v[18:19], v[132:133], v[106:107], v[18:19] op_sel:[1,0,0] op_sel_hi:[1,1,1]
    v_pk_fma_f32 v[20:21], v[134:135], v[108:109], v[20:21] op_sel:[1,0,0] op_sel_hi:[1,1,1]
    v_pk_fma_f32 v[22:23], v[134:135], v[110:111], v[22:23] op_sel:[1,0,0] op_sel_hi:[1,1,1]
    s_set_gpr_idx_off
    s_sub_u32 s32, s32, 1
    s_cbranch_scc1 MAIN_DONE
    v_mfma_f32_4x4x4_16b_bf16 v[116:119], v[172:173], v[178:179], 0 cbsz:4 abid:0
    v_lshlrev_b32_sdwa v136, v15, v122 dst_sel:DWORD dst_unused:UNUSED_PAD src0_sel:DWORD src1_sel:WORD_1
    s_waitcnt vmcnt(8)
    v_mfma_f32_4x4x4_16b_bf16 v[104:107], v[142:143], v[84:85], 0 cbsz:4 abid:15
    s_nop 0
    v_mfma_f32_4x4x4_16b_bf16 v[108:111], v[142:143], v[86:87], 0 cbsz:4 abid:15
    v_lshlrev_b32_sdwa v137, v15, v123 dst_sel:DWORD dst_unused:UNUSED_PAD src0_sel:DWORD src1_sel:WORD_1
    ds_read_u16_d16_hi v132, v136 offset:32768
    ds_read_u16_d16_hi v133, v137 offset:32768
    v_cvt_pk_bf16_f32 v140, v148, v152
    v_cvt_pk_bf16_f32 v141, v156, v160
    s_waitcnt lgkmcnt(2)
    s_set_gpr_idx_on s60, 0xc
    v_pk_fma_f32 v[16:17], v[128:129], v[96:97], v[16:17] op_sel:[0,0,0] op_sel_hi:[0,1,1]
    v_pk_fma_f32 v[18:19], v[128:129], v[98:99], v[18:19] op_sel:[0,0,0] op_sel_hi:[0,1,1]
    v_pk_fma_f32 v[20:21], v[130:131], v[100:101], v[20:21] op_sel:[0,0,0] op_sel_hi:[0,1,1]
    v_pk_fma_f32 v[22:23], v[130:131], v[102:103], v[22:23] op_sel:[0,0,0] op_sel_hi:[0,1,1]
    s_set_gpr_idx_off
    s_sub_u32 s32, s32, 1
    s_cbranch_scc1 MAIN_DONE
    v_lshlrev_b32_sdwa v138, v15, v126 dst_sel:DWORD dst_unused:UNUSED_PAD src0_sel:DWORD src1_sel:WORD_1
    v_mfma_f32_4x4x4_16b_bf16 v[96:99], v[144:145], v[88:89], 0 cbsz:4 abid:15
    s_nop 0
    v_mfma_f32_4x4x4_16b_bf16 v[100:103], v[144:145], v[90:91], 0 cbsz:4 abid:15
    v_lshlrev_b32_sdwa v139, v15, v127 dst_sel:DWORD dst_unused:UNUSED_PAD src0_sel:DWORD src1_sel:WORD_1
    ds_read_u16_d16_hi v134, v138 offset:32768
    ds_read_u16_d16_hi v135, v139 offset:32768
    v_cvt_pk_bf16_f32 v142, v149, v153
    v_cvt_pk_bf16_f32 v143, v157, v161
    s_set_gpr_idx_on s61, 0xc
    v_pk_fma_f32 v[16:17], v[128:129], v[104:105], v[16:17] op_sel:[1,0,0] op_sel_hi:[1,1,1]
    v_pk_fma_f32 v[18:19], v[128:129], v[106:107], v[18:19] op_sel:[1,0,0] op_sel_hi:[1,1,1]
    v_pk_fma_f32 v[20:21], v[130:131], v[108:109], v[20:21] op_sel:[1,0,0] op_sel_hi:[1,1,1]
    v_pk_fma_f32 v[22:23], v[130:131], v[110:111], v[22:23] op_sel:[1,0,0] op_sel_hi:[1,1,1]
    s_set_gpr_idx_off
    s_branch MAIN_DONE
B_60:
    buffer_load_dwordx4 v[188:191], v1, s[16:19], s10 offen offset:0 sc1
    buffer_load_dwordx4 v[192:195], v1, s[16:19], s10 offen offset:1024 sc1
    buffer_load_dwordx4 v[196:199], v1, s[16:19], s10 offen offset:2048 sc1
    buffer_load_dwordx4 v[200:203], v1, s[16:19], s10 offen offset:3072 sc1
    buffer_load_dwordx4 v[204:207], v1, s[16:19], s11 offen offset:0 sc1
    buffer_load_dwordx4 v[208:211], v1, s[16:19], s11 offen offset:1024 sc1
    buffer_load_dwordx4 v[212:215], v1, s[16:19], s11 offen offset:2048 sc1
    buffer_load_dwordx4 v[216:219], v1, s[16:19], s11 offen offset:3072 sc1
    s_sub_u32 s32, s32, 1
    s_cbranch_scc1 MAIN_DONE
    v_mfma_f32_4x4x4_16b_bf16 v[116:119], v[172:173], v[178:179], 0 cbsz:4 abid:0
    v_lshlrev_b32_sdwa v136, v15, v122 dst_sel:DWORD dst_unused:UNUSED_PAD src0_sel:DWORD src1_sel:WORD_1
    s_waitcnt vmcnt(12)
    v_mfma_f32_4x4x4_16b_bf16 v[104:107], v[142:143], v[84:85], 0 cbsz:4 abid:15
    s_nop 0
    v_mfma_f32_4x4x4_16b_bf16 v[108:111], v[142:143], v[86:87], 0 cbsz:4 abid:15
    v_lshlrev_b32_sdwa v137, v15, v123 dst_sel:DWORD dst_unused:UNUSED_PAD src0_sel:DWORD src1_sel:WORD_1
    ds_read_u16_d16_hi v132, v136 offset:32768
    ds_read_u16_d16_hi v133, v137 offset:32768
    v_cvt_pk_bf16_f32 v140, v148, v152
    v_cvt_pk_bf16_f32 v141, v156, v160
    s_waitcnt lgkmcnt(2)
    s_set_gpr_idx_on s60, 0xc
    v_pk_fma_f32 v[16:17], v[128:129], v[96:97], v[16:17] op_sel:[0,0,0] op_sel_hi:[0,1,1]
    v_pk_fma_f32 v[18:19], v[128:129], v[98:99], v[18:19] op_sel:[0,0,0] op_sel_hi:[0,1,1]
    v_pk_fma_f32 v[20:21], v[130:131], v[100:101], v[20:21] op_sel:[0,0,0] op_sel_hi:[0,1,1]
    v_pk_fma_f32 v[22:23], v[130:131], v[102:103], v[22:23] op_sel:[0,0,0] op_sel_hi:[0,1,1]
    s_set_gpr_idx_off
    s_sub_u32 s32, s32, 1
    s_cbranch_scc1 MAIN_DONE
    v_lshlrev_b32_sdwa v138, v15, v126 dst_sel:DWORD dst_unused:UNUSED_PAD src0_sel:DWORD src1_sel:WORD_1
    s_waitcnt vmcnt(11)
    v_mfma_f32_4x4x4_16b_bf16 v[96:99], v[144:145], v[88:89], 0 cbsz:4 abid:15
    s_nop 0
    v_mfma_f32_4x4x4_16b_bf16 v[100:103], v[144:145], v[90:91], 0 cbsz:4 abid:15
    v_lshlrev_b32_sdwa v139, v15, v127 dst_sel:DWORD dst_unused:UNUSED_PAD src0_sel:DWORD src1_sel:WORD_1
    ds_read_u16_d16_hi v134, v138 offset:32768
    ds_read_u16_d16_hi v135, v139 offset:32768
    v_cvt_pk_bf16_f32 v142, v149, v153
    v_cvt_pk_bf16_f32 v143, v157, v161
    s_set_gpr_idx_on s61, 0xc
    v_pk_fma_f32 v[16:17], v[128:129], v[104:105], v[16:17] op_sel:[1,0,0] op_sel_hi:[1,1,1]
    v_pk_fma_f32 v[18:19], v[128:129], v[106:107], v[18:19] op_sel:[1,0,0] op_sel_hi:[1,1,1]
    v_pk_fma_f32 v[20:21], v[130:131], v[108:109], v[20:21] op_sel:[1,0,0] op_sel_hi:[1,1,1]
    v_pk_fma_f32 v[22:23], v[130:131], v[110:111], v[22:23] op_sel:[1,0,0] op_sel_hi:[1,1,1]
    s_set_gpr_idx_off
    s_sub_u32 s32, s32, 1
    s_cbranch_scc1 MAIN_DONE
    v_mfma_f32_4x4x4_16b_bf16 v[120:123], v[172:173], v[176:177], 0 cbsz:4 abid:1
    v_lshlrev_b32_sdwa v136, v15, v112 dst_sel:DWORD dst_unused:UNUSED_PAD src0_sel:DWORD src1_sel:WORD_1
    s_waitcnt vmcnt(10)
    v_mfma_f32_4x4x4_16b_bf16 v[104:107], v[146:147], v[92:93], 0 cbsz:4 abid:15
    s_nop 0
    v_mfma_f32_4x4x4_16b_bf16 v[108:111], v[146:147], v[94:95], 0 cbsz:4 abid:15
    v_lshlrev_b32_sdwa v137, v15, v113 dst_sel:DWORD dst_unused:UNUSED_PAD src0_sel:DWORD src1_sel:WORD_1
    ds_read_u16_d16_hi v128, v136 offset:32768
    ds_read_u16_d16_hi v129, v137 offset:32768
    v_cvt_pk_bf16_f32 v144, v150, v154
    v_cvt_pk_bf16_f32 v145, v158, v162
    s_waitcnt lgkmcnt(2)
    s_set_gpr_idx_on s62, 0xc
    v_pk_fma_f32 v[16:17], v[132:133], v[96:97], v[16:17] op_sel:[0,0,0] op_sel_hi:[0,1,1]
    v_pk_fma_f32 v[18:19], v[132:133], v[98:99], v[18:19] op_sel:[0,0,0] op_sel_hi:[0,1,1]
    v_pk_fma_f32 v[20:21], v[134:135], v[100:101], v[20:21] op_sel:[0,0,0] op_sel_hi:[0,1,1]
    v_pk_fma_f32 v[22:23], v[134:135], v[102:103], v[22:23] op_sel:[0,0,0] op_sel_hi:[0,1,1]
    s_set_gpr_idx_off
    s_sub_u32 s32, s32, 1
    s_cbranch_scc1 MAIN_DONE
    v_lshlrev_b32_sdwa v138, v15, v116 dst_sel:DWORD dst_unused:UNUSED_PAD src0_sel:DWORD src1_sel:WORD_1
    s_waitcnt vmcnt(9)
    v_mfma_f32_4x4x4_16b_bf16 v[96:99], v[140:141], v[64:65], 0 cbsz:4 abid:0
    s_nop 0
    v_mfma_f32_4x4x4_16b_bf16 v[100:103], v[140:141], v[66:67], 0 cbsz:4 abid:0
    v_lshlrev_b32_sdwa v139, v15, v117 dst_sel:DWORD dst_unused:UNUSED_PAD src0_sel:DWORD src1_sel:WORD_1
    ds_read_u16_d16_hi v130, v138 offset:32768
    ds_read_u16_d16_hi v131, v139 offset:32768
    v_cvt_pk_bf16_f32 v146, v151, v155
    v_cvt_pk_bf16_f32 v147, v159, v163
    s_set_gpr_idx_on s63, 0xc
    v_pk_fma_f32 v[16:17], v[132:133], v[104:105], v[16:17] op_sel:[1,0,0] op_sel_hi:[1,1,1]
    v_pk_fma_f32 v[18:19], v[132:133], v[106:107], v[18:19] op_sel:[1,0,0] op_sel_hi:[1,1,1]
    v_pk_fma_f32 v[20:21], v[134:135], v[108:109], v[20:21] op_sel:[1,0,0] op_sel_hi:[1,1,1]
    v_pk_fma_f32 v[22:23], v[134:135], v[110:111], v[22:23] op_sel:[1,0,0] op_sel_hi:[1,1,1]
    s_set_gpr_idx_off
    s_sub_u32 s32, s32, 1
    s_cbranch_scc1 MAIN_DONE
    v_mfma_f32_4x4x4_16b_bf16 v[124:127], v[172:173], v[178:179], 0 cbsz:4 abid:1
    v_lshlrev_b32_sdwa v136, v15, v114 dst_sel:DWORD dst_unused:UNUSED_PAD src0_sel:DWORD src1_sel:WORD_1
    s_waitcnt vmcnt(8)
    v_mfma_f32_4x4x4_16b_bf16 v[104:107], v[142:143], v[68:69], 0 cbsz:4 abid:0
    s_nop 0
    v_mfma_f32_4x4x4_16b_bf16 v[108:111], v[142:143], v[70:71], 0 cbsz:4 abid:0
    v_lshlrev_b32_sdwa v137, v15, v115 dst_sel:DWORD dst_unused:UNUSED_PAD src0_sel:DWORD src1_sel:WORD_1
    ds_read_u16_d16_hi v132, v136 offset:32768
    ds_read_u16_d16_hi v133, v137 offset:32768
    s_waitcnt lgkmcnt(2)
    s_set_gpr_idx_on s48, 0xc
    v_pk_fma_f32 v[16:17], v[128:129], v[96:97], v[16:17] op_sel:[0,0,0] op_sel_hi:[0,1,1]
    v_pk_fma_f32 v[18:19], v[128:129], v[98:99], v[18:19] op_sel:[0,0,0] op_sel_hi:[0,1,1]
    v_pk_fma_f32 v[20:21], v[130:131], v[100:101], v[20:21] op_sel:[0,0,0] op_sel_hi:[0,1,1]
    v_pk_fma_f32 v[22:23], v[130:131], v[102:103], v[22:23] op_sel:[0,0,0] op_sel_hi:[0,1,1]
    s_set_gpr_idx_off
    s_sub_u32 s32, s32, 1
    s_cbranch_scc1 MAIN_DONE
    v_lshlrev_b32_sdwa v138, v15, v118 dst_sel:DWORD dst_unused:UNUSED_PAD src0_sel:DWORD src1_sel:WORD_1
    v_mfma_f32_4x4x4_16b_bf16 v[96:99], v[144:145], v[72:73], 0 cbsz:4 abid:0
    s_nop 0
    v_mfma_f32_4x4x4_16b_bf16 v[100:103], v[144:145], v[74:75], 0 cbsz:4 abid:0
    v_lshlrev_b32_sdwa v139, v15, v119 dst_sel:DWORD dst_unused:UNUSED_PAD src0_sel:DWORD src1_sel:WORD_1
    ds_read_u16_d16_hi v134, v138 offset:32768
    ds_read_u16_d16_hi v135, v139 offset:32768
    s_set_gpr_idx_on s49, 0xc
    v_pk_fma_f32 v[16:17], v[128:129], v[104:105], v[16:17] op_sel:[1,0,0] op_sel_hi:[1,1,1]
    v_pk_fma_f32 v[18:19], v[128:129], v[106:107], v[18:19] op_sel:[1,0,0] op_sel_hi:[1,1,1]
    v_pk_fma_f32 v[20:21], v[130:131], v[108:109], v[20:21] op_sel:[1,0,0] op_sel_hi:[1,1,1]
    v_pk_fma_f32 v[22:23], v[130:131], v[110:111], v[22:23] op_sel:[1,0,0] op_sel_hi:[1,1,1]
    s_set_gpr_idx_off
    s_branch MAIN_DONE
MAIN_DONE:
    s_add_u32 s27, s27, 1472
    s_cmp_ge_u32 s27, s26
    s_cbranch_scc1 ALL_DONE
    s_waitcnt vmcnt(0) lgkmcnt(0)
    v_lshlrev_b32 v11, 2, v0
    v_mov_b32 v12, 0
    v_cmp_gt_u32 vcc, 480, v0
    s_and_saveexec_b64 s[42:43], vcc
    ds_write_b32 v11, v12 offset:0
    s_mov_b64 exec, s[42:43]
    s_waitcnt lgkmcnt(0)
    s_barrier
    s_branch ROUND
ALL_DONE:
    v_cvt_pk_bf16_f32 v140, v16, v20
    v_cvt_pk_bf16_f32 v141, v17, v21
    v_cvt_pk_bf16_f32 v142, v18, v22
    v_cvt_pk_bf16_f32 v143, v19, v23
    v_cvt_pk_bf16_f32 v144, v24, v28
    v_cvt_pk_bf16_f32 v145, v25, v29
    v_cvt_pk_bf16_f32 v146, v26, v30
    v_cvt_pk_bf16_f32 v147, v27, v31
    v_cvt_pk_bf16_f32 v148, v32, v36
    v_cvt_pk_bf16_f32 v149, v33, v37
    v_cvt_pk_bf16_f32 v150, v34, v38
    v_cvt_pk_bf16_f32 v151, v35, v39
    v_cvt_pk_bf16_f32 v152, v40, v44
    v_cvt_pk_bf16_f32 v153, v41, v45
    v_cvt_pk_bf16_f32 v154, v42, v46
    v_cvt_pk_bf16_f32 v155, v43, v47
    v_cvt_pk_bf16_f32 v156, v48, v52
    v_cvt_pk_bf16_f32 v157, v49, v53
    v_cvt_pk_bf16_f32 v158, v50, v54
    v_cvt_pk_bf16_f32 v159, v51, v55
    v_lshrrev_b32 v8, 2, v1
    v_add_u32 v8, 32768, v8
    s_mul_i32 s42, s4, 1152
    v_add_u32 v112, s42, v8
    s_mul_i32 s42, s5, 1152
    v_add_u32 v113, s42, v8
    s_mul_i32 s42, s6, 1152
    v_add_u32 v114, s42, v8
    s_mul_i32 s42, s7, 1152
    v_add_u32 v115, s42, v8
    s_mul_i32 s42, s8, 1152
    v_add_u32 v116, s42, v8
    v_lshrrev_b32 v9, 4, v1
    v_and_b32 v10, 15, v9
    v_lshrrev_b32 v11, 4, v9
    s_lshr_b32 s42, s25, 2
    s_mul_i32 s43, s42, 23040
    s_add_u32 s43, s43, 32768
    v_mul_u32_u24 v8, 288, v10
    v_lshl_add_u32 v8, v11, 4, v8
    v_add_u32 v8, s43, v8
    s_mul_i32 s42, s42, 5242880
    s_lshl_b32 s43, s24, 10
    s_add_u32 s42, s42, s43
    s_and_b32 s43, s25, 3
    s_lshl_b32 s43, s43, 8
    s_add_u32 s42, s42, s43
    v_lshlrev_b32 v11, 18, v11
    v_lshl_add_u32 v11, v10, 4, v11
    v_add_u32 v11, s42, v11
    s_waitcnt lgkmcnt(0)
    s_barrier
    ds_write_b32 v112, v140 offset:0
    ds_write_b32 v112, v141 offset:288
    ds_write_b32 v112, v142 offset:576
    ds_write_b32 v112, v143 offset:864
    ds_write_b32 v113, v144 offset:0
    ds_write_b32 v113, v145 offset:288
    ds_write_b32 v113, v146 offset:576
    ds_write_b32 v113, v147 offset:864
    ds_write_b32 v114, v148 offset:0
    ds_write_b32 v114, v149 offset:288
    ds_write_b32 v114, v150 offset:576
    ds_write_b32 v114, v151 offset:864
    ds_write_b32 v115, v152 offset:0
    ds_write_b32 v115, v153 offset:288
    ds_write_b32 v115, v154 offset:576
    ds_write_b32 v115, v155 offset:864
    ds_write_b32 v116, v156 offset:0
    ds_write_b32 v116, v157 offset:288
    ds_write_b32 v116, v158 offset:576
    ds_write_b32 v116, v159 offset:864
    s_waitcnt vmcnt(0) lgkmcnt(0)
    s_barrier
    ds_read_b128 v[64:67], v8 offset:0
    ds_read_b128 v[68:71], v8 offset:64
    ds_read_b128 v[72:75], v8 offset:128
    ds_read_b128 v[76:79], v8 offset:192
    ds_read_b128 v[80:83], v8 offset:4608
    ds_read_b128 v[84:87], v8 offset:4672
    ds_read_b128 v[88:91], v8 offset:4736
    ds_read_b128 v[92:95], v8 offset:4800
    s_waitcnt lgkmcnt(7)
    v_mfma_f32_16x16x32_bf16 v[16:19], v[64:67], v[188:191], 0
    v_mfma_f32_16x16x32_bf16 v[20:23], v[64:67], v[204:207], 0
    s_waitcnt lgkmcnt(6)
    v_mfma_f32_16x16x32_bf16 v[16:19], v[68:71], v[192:195], v[16:19]
    v_mfma_f32_16x16x32_bf16 v[20:23], v[68:71], v[208:211], v[20:23]
    s_waitcnt lgkmcnt(5)
    v_mfma_f32_16x16x32_bf16 v[16:19], v[72:75], v[196:199], v[16:19]
    v_mfma_f32_16x16x32_bf16 v[20:23], v[72:75], v[212:215], v[20:23]
    s_waitcnt lgkmcnt(4)
    v_mfma_f32_16x16x32_bf16 v[16:19], v[76:79], v[200:203], v[16:19]
    v_mfma_f32_16x16x32_bf16 v[20:23], v[76:79], v[216:219], v[20:23]
    ds_read_b128 v[64:67], v8 offset:9216
    ds_read_b128 v[68:71], v8 offset:9280
    ds_read_b128 v[72:75], v8 offset:9344
    ds_read_b128 v[76:79], v8 offset:9408
    s_waitcnt lgkmcnt(7)
    v_mfma_f32_16x16x32_bf16 v[24:27], v[80:83], v[188:191], 0
    v_mfma_f32_16x16x32_bf16 v[28:31], v[80:83], v[204:207], 0
    s_waitcnt lgkmcnt(6)
    v_mfma_f32_16x16x32_bf16 v[24:27], v[84:87], v[192:195], v[24:27]
    v_mfma_f32_16x16x32_bf16 v[28:31], v[84:87], v[208:211], v[28:31]
    s_waitcnt lgkmcnt(5)
    v_mfma_f32_16x16x32_bf16 v[24:27], v[88:91], v[196:199], v[24:27]
    v_mfma_f32_16x16x32_bf16 v[28:31], v[88:91], v[212:215], v[28:31]
    s_waitcnt lgkmcnt(4)
    v_mfma_f32_16x16x32_bf16 v[24:27], v[92:95], v[200:203], v[24:27]
    v_mfma_f32_16x16x32_bf16 v[28:31], v[92:95], v[216:219], v[28:31]
    v_cvt_pk_bf16_f32 v128, v16, v17
    v_cvt_pk_bf16_f32 v129, v18, v19
    v_cvt_pk_bf16_f32 v130, v20, v21
    v_cvt_pk_bf16_f32 v131, v22, v23
    buffer_store_dwordx4 v[128:131], v11, s[20:23], 0 offen sc0 sc1
    v_add_u32 v11, 1048576, v11
    ds_read_b128 v[80:83], v8 offset:13824
    ds_read_b128 v[84:87], v8 offset:13888
    ds_read_b128 v[88:91], v8 offset:13952
    ds_read_b128 v[92:95], v8 offset:14016
    s_waitcnt lgkmcnt(7)
    v_mfma_f32_16x16x32_bf16 v[32:35], v[64:67], v[188:191], 0
    v_mfma_f32_16x16x32_bf16 v[36:39], v[64:67], v[204:207], 0
    s_waitcnt lgkmcnt(6)
    v_mfma_f32_16x16x32_bf16 v[32:35], v[68:71], v[192:195], v[32:35]
    v_mfma_f32_16x16x32_bf16 v[36:39], v[68:71], v[208:211], v[36:39]
    s_waitcnt lgkmcnt(5)
    v_mfma_f32_16x16x32_bf16 v[32:35], v[72:75], v[196:199], v[32:35]
    v_mfma_f32_16x16x32_bf16 v[36:39], v[72:75], v[212:215], v[36:39]
    s_waitcnt lgkmcnt(4)
    v_mfma_f32_16x16x32_bf16 v[32:35], v[76:79], v[200:203], v[32:35]
    v_mfma_f32_16x16x32_bf16 v[36:39], v[76:79], v[216:219], v[36:39]
    v_cvt_pk_bf16_f32 v132, v24, v25
    v_cvt_pk_bf16_f32 v133, v26, v27
    v_cvt_pk_bf16_f32 v134, v28, v29
    v_cvt_pk_bf16_f32 v135, v30, v31
    buffer_store_dwordx4 v[132:135], v11, s[20:23], 0 offen sc0 sc1
    v_add_u32 v11, 1048576, v11
    ds_read_b128 v[64:67], v8 offset:18432
    ds_read_b128 v[68:71], v8 offset:18496
    ds_read_b128 v[72:75], v8 offset:18560
    ds_read_b128 v[76:79], v8 offset:18624
    s_waitcnt lgkmcnt(7)
    v_mfma_f32_16x16x32_bf16 v[40:43], v[80:83], v[188:191], 0
    v_mfma_f32_16x16x32_bf16 v[44:47], v[80:83], v[204:207], 0
    s_waitcnt lgkmcnt(6)
    v_mfma_f32_16x16x32_bf16 v[40:43], v[84:87], v[192:195], v[40:43]
    v_mfma_f32_16x16x32_bf16 v[44:47], v[84:87], v[208:211], v[44:47]
    s_waitcnt lgkmcnt(5)
    v_mfma_f32_16x16x32_bf16 v[40:43], v[88:91], v[196:199], v[40:43]
    v_mfma_f32_16x16x32_bf16 v[44:47], v[88:91], v[212:215], v[44:47]
    s_waitcnt lgkmcnt(4)
    v_mfma_f32_16x16x32_bf16 v[40:43], v[92:95], v[200:203], v[40:43]
    v_mfma_f32_16x16x32_bf16 v[44:47], v[92:95], v[216:219], v[44:47]
    v_cvt_pk_bf16_f32 v128, v32, v33
    v_cvt_pk_bf16_f32 v129, v34, v35
    v_cvt_pk_bf16_f32 v130, v36, v37
    v_cvt_pk_bf16_f32 v131, v38, v39
    buffer_store_dwordx4 v[128:131], v11, s[20:23], 0 offen sc0 sc1
    v_add_u32 v11, 1048576, v11
    s_waitcnt lgkmcnt(3)
    v_mfma_f32_16x16x32_bf16 v[48:51], v[64:67], v[188:191], 0
    v_mfma_f32_16x16x32_bf16 v[52:55], v[64:67], v[204:207], 0
    s_waitcnt lgkmcnt(2)
    v_mfma_f32_16x16x32_bf16 v[48:51], v[68:71], v[192:195], v[48:51]
    v_mfma_f32_16x16x32_bf16 v[52:55], v[68:71], v[208:211], v[52:55]
    s_waitcnt lgkmcnt(1)
    v_mfma_f32_16x16x32_bf16 v[48:51], v[72:75], v[196:199], v[48:51]
    v_mfma_f32_16x16x32_bf16 v[52:55], v[72:75], v[212:215], v[52:55]
    s_waitcnt lgkmcnt(0)
    v_mfma_f32_16x16x32_bf16 v[48:51], v[76:79], v[200:203], v[48:51]
    v_mfma_f32_16x16x32_bf16 v[52:55], v[76:79], v[216:219], v[52:55]
    v_cvt_pk_bf16_f32 v132, v40, v41
    v_cvt_pk_bf16_f32 v133, v42, v43
    v_cvt_pk_bf16_f32 v134, v44, v45
    v_cvt_pk_bf16_f32 v135, v46, v47
    buffer_store_dwordx4 v[132:135], v11, s[20:23], 0 offen sc0 sc1
    v_add_u32 v11, 1048576, v11
    s_nop 7
    v_cvt_pk_bf16_f32 v128, v48, v49
    v_cvt_pk_bf16_f32 v129, v50, v51
    v_cvt_pk_bf16_f32 v130, v52, v53
    v_cvt_pk_bf16_f32 v131, v54, v55
    buffer_store_dwordx4 v[128:131], v11, s[20:23], 0 offen sc0 sc1
END:
    s_endpgm
    .p2align 6
    .type DEAL_TABLE,@object
DEAL_TABLE:
    .byte 80, 40, 84, 140, 120, 60, 20, 100, 0, 88, 44, 124, 24, 144, 64, 104, 4, 92, 148, 68, 8, 28, 108, 128, 48, 112, 12, 32, 132, 152, 72, 52, 16, 116, 76, 36, 136, 156, 56, 96, 0, 0, 0, 0, 0, 0, 0, 0, 0, 0, 0, 0, 0, 0, 0, 0, 0, 0, 0, 0, 0, 0, 0, 0, 0, 40, 140, 20, 80, 120, 100, 60, 124, 64, 24, 144, 84, 4, 44, 104, 88, 68, 108, 128, 148, 28, 8, 48, 152, 112, 52, 92, 72, 132, 12, 32, 116, 36, 76, 136, 96, 56, 156, 16, 0, 0, 0, 0, 0, 0, 0, 0, 0, 0, 0, 0, 0, 0, 0, 0, 0, 0, 0, 0, 0, 0, 0, 0
    .size DEAL_TABLE, 128
.section .rodata,"a"
.p2align 6
.amdhsa_kernel gather_scatter__tensor_product_equiv_tfn__graph_kernel
  .amdhsa_next_free_vgpr 220
  .amdhsa_next_free_sgpr 66
  .amdhsa_accum_offset 220
  .amdhsa_group_segment_fixed_size 0
  .amdhsa_kernarg_size 88
  .amdhsa_user_sgpr_count 2
  .amdhsa_user_sgpr_kernarg_segment_ptr 1
  .amdhsa_system_sgpr_workgroup_id_x 1
  .amdhsa_float_denorm_mode_32 3
.end_amdhsa_kernel
```

```asm
; @launch grid=(256,1,1) block=(512,1,1) lds=163840
.amdgcn_target "amdgcn-amd-amdhsa--gfx950"
.text
.globl gather_scatter__tensor_product_equiv_tfn__graph_kernel
.p2align 8
.type gather_scatter__tensor_product_equiv_tfn__graph_kernel,@function
gather_scatter__tensor_product_equiv_tfn__graph_kernel:
    s_cmp_ge_u32 s2, 256
    s_cbranch_scc1 END
    s_load_dwordx16 s[40:55], s[0:1], 0
    s_load_dwordx2 s[16:17], s[0:1], 80
    s_load_dwordx2 s[12:13], s[0:1], 0
    s_load_dwordx2 s[20:21], s[0:1], 64
    s_getpc_b64 s[6:7]
CODE_HERE:
    v_lshrrev_b32 v8, 6, v0
    s_lshr_b32 s5, s2, 3
    s_lshl_b32 s4, s5, 10
    v_readfirstlane_b32 s25, v8
    v_and_b32 v10, 7, v0
    v_lshl_add_u32 v10, v10, 7, s4
    v_min_u32 v10, END-CODE_HERE, v10
    s_cmp_lg_u32 s25, 7
    s_cbranch_scc1 NO_CODE_TOUCH
    global_load_dword v167, v10, s[6:7]
NO_CODE_TOUCH:
    s_mul_i32 s3, s2, 5120
    v_lshl_add_u32 v8, v0, 4, s3
    v_and_b32 v10, 63, v0
    v_lshlrev_b32 v1, 4, v10
    v_lshlrev_b32 v193, 2, v10
    s_cmp_ge_u32 s25, 5
    s_cselect_b32 s3, 250, s2
    s_cmp_ge_u32 s3, 250
    s_waitcnt lgkmcnt(0)
    s_cbranch_scc1 NO_EDGES
    s_setprio 1
    global_load_dwordx4 v[64:67], v8, s[44:45]
    global_load_dwordx4 v[68:71], v8, s[42:43]
NO_EDGES:
    global_load_dword v188, v193, s[50:51] offset:0
    global_load_dword v189, v193, s[50:51] offset:256
    global_load_dword v190, v193, s[50:51] offset:512
    global_load_dword v191, v193, s[50:51] offset:768
    v_and_b32 v193, 0x7f, v193
    global_load_dword v192, v193, s[52:53]
    s_and_b32 s3, s2, 0x87
    s_cmp_eq_u32 s3, 0
    s_cselect_b32 s3, 64, 0
    s_add_u32 s3, s3, DEAL_TABLE-CODE_HERE
    v_add_u32 v174, s3, v10
    global_load_ubyte v174, v174, s[6:7]
    v_lshlrev_b32 v9, 1, v8
    v_lshlrev_b32 v11, 3, v0
    v_mov_b32 v12, 0
    v_mov_b32 v13, 0
    ds_write_b64 v11, v[12:13]
    s_and_b32 s4, s2, 7
    s_lshl_b32 s4, s4, 5
    s_lshr_b32 s5, s2, 3
    s_or_b32 s24, s4, s5
    v_mov_b32 v15, 1
    s_mov_b32 s14, 10240000
    s_mov_b32 s15, 0x20000
    s_mov_b32 s18, 8650880
    s_mov_b32 s19, 0x20000
    s_mov_b32 s22, 10240000
    s_mov_b32 s23, 0x20000
    s_mov_b32 s34, 0xfffffc00
    s_mov_b32 s27, 0
    s_mov_b32 s10, 0xbfb8aa3b
    s_mov_b32 s11, 0xbfb8aa3b
    v_mul_u32_u24 v14, 52, v10
    v_lshrrev_b32 v14, 8, v14
    v_mul_u32_u24 v7, 5, v14
    v_sub_u32 v7, v10, v7
    v_lshlrev_b32 v14, 2, v14
    v_lshlrev_b32 v7, 2, v7
    s_mov_b32 s35, 2097152
    v_and_b32 v4, 0xff, v0
    s_lshl_b32 s3, s24, 3
    s_add_u32 s3, s3, 7864320
    v_lshl_add_u32 v6, v4, 11, s3
    s_and_b32 s3, s2, 7
    s_lshl_b32 s3, s3, 7
    s_add_u32 s3, s3, 8388608
    s_lshl_b32 s8, s25, 15
    s_add_u32 s3, s3, s8
    v_and_b32 v166, 31, v0
    v_lshl_add_u32 v166, v166, 10, s3
    v_mul_u32_u24 v4, 1280, v4
    v_mul_u32_u24 v138, 0x8000, v1
    v_lshl_add_u32 v138, v10, 3, v138
    v_pk_mov_b32 v[16:17], v[12:13], v[12:13]
    v_pk_mov_b32 v[18:19], v[12:13], v[12:13]
    v_pk_mov_b32 v[20:21], v[12:13], v[12:13]
    v_pk_mov_b32 v[22:23], v[12:13], v[12:13]
    v_pk_mov_b32 v[24:25], v[12:13], v[12:13]
    v_pk_mov_b32 v[26:27], v[12:13], v[12:13]
    v_pk_mov_b32 v[28:29], v[12:13], v[12:13]
    v_pk_mov_b32 v[30:31], v[12:13], v[12:13]
    v_pk_mov_b32 v[32:33], v[12:13], v[12:13]
    v_pk_mov_b32 v[34:35], v[12:13], v[12:13]
    v_pk_mov_b32 v[36:37], v[12:13], v[12:13]
    v_pk_mov_b32 v[38:39], v[12:13], v[12:13]
    v_pk_mov_b32 v[40:41], v[12:13], v[12:13]
    v_pk_mov_b32 v[42:43], v[12:13], v[12:13]
    v_pk_mov_b32 v[44:45], v[12:13], v[12:13]
    v_pk_mov_b32 v[46:47], v[12:13], v[12:13]
    v_pk_mov_b32 v[48:49], v[12:13], v[12:13]
    v_pk_mov_b32 v[50:51], v[12:13], v[12:13]
    v_pk_mov_b32 v[52:53], v[12:13], v[12:13]
    v_pk_mov_b32 v[54:55], v[12:13], v[12:13]
    v_pk_mov_b32 v[56:57], v[12:13], v[12:13]
    v_pk_mov_b32 v[58:59], v[12:13], v[12:13]
    v_pk_mov_b32 v[60:61], v[12:13], v[12:13]
    v_pk_mov_b32 v[62:63], v[12:13], v[12:13]
    s_waitcnt lgkmcnt(0)
    s_add_u32 s4, s16, 8650752
    s_addc_u32 s5, s17, 0
    s_load_dwordx2 s[64:65], s[4:5], 0
    s_barrier
    s_cmp_ge_u32 s25, 5
    s_cbranch_scc1 HELP
    s_add_u32 s62, s25, 1
LUTP_W0L:
    s_mul_i32 s3, s62, 33554944
    s_add_u32 s3, s3, 4286709632
    v_add_u32 v128, s3, v138
    s_lshl_b32 s3, s62, 10
    v_add_u32 v136, s3, v1
    v_add_u32 v129, 131074, v128
    v_add_u32 v130, 262148, v128
    v_add_u32 v131, 393222, v128
    v_add_u32 v137, 0x10000, v136
    v_or_b32 v132, 0x80008000, v128
    v_or_b32 v133, 0x80008000, v129
    v_or_b32 v134, 0x80008000, v130
    v_or_b32 v135, 0x80008000, v131
    ds_write_b128 v136, v[128:131] offset:32768
    ds_write_b128 v137, v[132:135] offset:32768
    s_add_u32 s62, s62, 5
    s_cmp_le_u32 s62, 5
    s_cbranch_scc1 LUTP_W0L
LUTP_END_W0:
    s_cmp_ge_u32 s2, 250
    s_cbranch_scc1 AUX_LOAD
    global_load_dwordx4 v[72:75], v9, s[46:47]
    global_load_dwordx4 v[76:79], v9, s[46:47] offset:16
    global_load_dwordx4 v[80:83], v9, s[48:49]
    global_load_dwordx4 v[84:87], v9, s[48:49] offset:16
LOADED:
    s_cmp_ge_u32 s2, 250
    s_cbranch_scc1 AUX
    s_waitcnt vmcnt(11)
    v_and_b32 v88, 0xff, v64
    v_lshlrev_b32 v88, 2, v88
    ds_add_rtn_u32 v92, v88, v15 offset:2304
    v_and_b32 v89, 0xff, v65
    v_lshlrev_b32 v89, 2, v89
    ds_add_rtn_u32 v93, v89, v15 offset:2304
    v_and_b32 v90, 0xff, v66
    v_lshlrev_b32 v90, 2, v90
    ds_add_rtn_u32 v94, v90, v15 offset:2304
    v_and_b32 v91, 0xff, v67
    v_lshlrev_b32 v91, 2, v91
    ds_add_rtn_u32 v95, v91, v15 offset:2304
    s_waitcnt vmcnt(10)
    v_lshrrev_b32 v64, 8, v64
    v_lshl_or_b32 v108, v68, 10, v64
    v_lshrrev_b32 v65, 8, v65
    v_lshl_or_b32 v110, v69, 10, v65
    v_lshrrev_b32 v66, 8, v66
    v_lshl_or_b32 v112, v70, 10, v66
    v_lshrrev_b32 v67, 8, v67
    v_lshl_or_b32 v114, v71, 10, v67
    s_mov_b32 s9, 87040
    s_waitcnt lgkmcnt(0)
    s_barrier
    ds_read_b128 v[96:99], v1 offset:2304
    s_add_u32 s64, s64, 1
    s_and_b32 s65, s65, 0x3ff
    v_mov_b32 v109, s64
    v_mov_b32 v111, s64
    v_mov_b32 v113, s64
    v_mov_b32 v115, s64
    s_waitcnt lgkmcnt(0)
    v_add_u32 v10, v96, v97
    v_add3_u32 v10, v10, v98, v99
    v_mov_b32 v11, v10
    s_nop 1
    v_add_u32_dpp v11, v11, v11 row_shr:1 row_mask:0xf bank_mask:0xf bound_ctrl:0
    s_nop 1
    v_add_u32_dpp v11, v11, v11 row_shr:2 row_mask:0xf bank_mask:0xf bound_ctrl:0
    s_nop 1
    v_add_u32_dpp v11, v11, v11 row_shr:4 row_mask:0xf bank_mask:0xf bound_ctrl:0
    s_nop 1
    v_add_u32_dpp v11, v11, v11 row_shr:8 row_mask:0xf bank_mask:0xf bound_ctrl:0
    s_nop 1
    v_add_u32_dpp v11, v11, v11 row_bcast:15 row_mask:0xa bank_mask:0xf
    s_nop 1
    v_add_u32_dpp v11, v11, v11 row_bcast:31 row_mask:0xc bank_mask:0xf
    v_sub_u32 v100, v11, v10
    v_add_u32 v101, v100, v96
    v_add_u32 v102, v101, v97
    v_add_u32 v103, v102, v98
    ds_write_b128 v1, v[100:103] offset:3328
    ds_read_b32 v96, v88 offset:3328
    ds_read_b32 v97, v89 offset:3328
    ds_read_b32 v98, v90 offset:3328
    ds_read_b32 v99, v91 offset:3328
    s_waitcnt lgkmcnt(3)
    v_add_u32 v92, v92, v96
    v_lshl_add_u32 v88, v92, 3, s9
    ds_write_b64 v88, v[108:109]
    s_waitcnt lgkmcnt(3)
    v_add_u32 v93, v93, v97
    v_lshl_add_u32 v89, v93, 3, s9
    ds_write_b64 v89, v[110:111]
    s_waitcnt lgkmcnt(3)
    v_add_u32 v94, v94, v98
    v_lshl_add_u32 v90, v94, 3, s9
    ds_write_b64 v90, v[112:113]
    s_waitcnt lgkmcnt(3)
    v_add_u32 v95, v95, v99
    v_lshl_add_u32 v91, v95, 3, s9
    ds_write_b64 v91, v[114:115]
    v_lshlrev_b32 v92, 4, v92
    v_add_u32 v92, 4352, v92
    v_lshlrev_b32 v93, 4, v93
    v_add_u32 v93, 4352, v93
    v_lshlrev_b32 v94, 4, v94
    v_add_u32 v94, 4352, v94
    v_lshlrev_b32 v95, 4, v95
    v_add_u32 v95, 4352, v95
    s_waitcnt lgkmcnt(0)
    s_barrier
    s_waitcnt vmcnt(0)
    ds_write2_b64 v92, v[72:73], v[80:81] offset0:0 offset1:1
    ds_write2_b64 v93, v[74:75], v[82:83] offset0:0 offset1:1
    ds_write2_b64 v94, v[76:77], v[84:85] offset0:0 offset1:1
    ds_write2_b64 v95, v[78:79], v[86:87] offset0:0 offset1:1
BINNED:
    s_setprio 0
    s_waitcnt lgkmcnt(0)
    s_barrier
    v_mov_b32 v2, 0
    s_call_b64 s[6:7], CONST_SUB
    s_cmp_gt_u32 s62, 24
    s_cbranch_scc1 LUTP_END_W
LUTP_WL:
    s_mul_i32 s3, s62, 33554944
    s_add_u32 s3, s3, 4286709632
    v_add_u32 v128, s3, v138
    s_lshl_b32 s3, s62, 10
    v_add_u32 v136, s3, v1
    v_add_u32 v129, 131074, v128
    v_add_u32 v130, 262148, v128
    v_add_u32 v131, 393222, v128
    v_add_u32 v137, 0x10000, v136
    v_or_b32 v132, 0x80008000, v128
    v_or_b32 v133, 0x80008000, v129
    v_or_b32 v134, 0x80008000, v130
    v_or_b32 v135, 0x80008000, v131
    ds_write_b128 v136, v[128:131] offset:32768
    ds_write_b128 v137, v[132:135] offset:32768
    s_add_u32 s62, s62, 5
    s_cmp_le_u32 s62, 24
    s_cbranch_scc1 LUTP_WL
LUTP_END_W:
    s_cmp_eq_u32 s25, 4
    s_cbranch_scc1 WAVE4
    s_add_u32 s62, s25, 34
    v_mov_b32 v132, 0x80008000
    v_mov_b32 v133, 0x80008000
    v_mov_b32 v134, 0x80008000
    v_mov_b32 v135, 0x80008000
LUTP_UH:
    s_mul_i32 s3, s62, 33554944
    s_add_u32 s3, s3, 131072
    v_add_u32 v128, s3, v138
    s_lshl_b32 s3, s62, 10
    v_add_u32 v136, s3, v1
    v_add_u32 v129, 131074, v128
    v_add_u32 v130, 262148, v128
    v_add_u32 v131, 393222, v128
    v_add_u32 v137, 0x10000, v136
    ds_write_b128 v136, v[128:131] offset:32768
    ds_write_b128 v137, v[132:135] offset:32768
    s_add_u32 s62, s62, 4
    s_cmp_le_u32 s62, 62
    s_cbranch_scc1 LUTP_UH
LUTP_END_U:
    buffer_load_dwordx2 v[2:3], v6, s[16:19], 0 offen sc1
    s_cmp_gt_u32 s62, 62
    s_cbranch_scc1 LUTP_END_V
LUTP_VH:
    s_mul_i32 s3, s62, 33554944
    s_add_u32 s3, s3, 131072
    v_add_u32 v128, s3, v138
    s_lshl_b32 s3, s62, 10
    v_add_u32 v136, s3, v1
    v_add_u32 v129, 131074, v128
    v_add_u32 v130, 262148, v128
    v_add_u32 v131, 393222, v128
    v_add_u32 v137, 0x10000, v136
    ds_write_b128 v136, v[128:131] offset:32768
    ds_write_b128 v137, v[132:135] offset:32768
    s_add_u32 s62, s62, 4
    s_cmp_le_u32 s62, 62
    s_cbranch_scc1 LUTP_VH
LUTP_END_V:
POLL_TAB:
    s_waitcnt vmcnt(0)
CHECK_TAB:
    v_lshrrev_b32 v11, 22, v2
    v_cmp_ne_u32 vcc, s64, v3
    v_cmp_ne_u32 s[42:43], s65, v11
    s_or_b64 vcc, vcc, s[42:43]
    s_and_b64 exec, exec, vcc
    s_cbranch_execz POLLED_TAB
    s_sub_u32 s35, s35, 1
    s_cbranch_scc1 END
    buffer_load_dwordx2 v[2:3], v6, s[16:19], 0 offen sc1
    s_branch POLL_TAB
POLLED_TAB:
    s_mov_b64 exec, -1
    s_branch TAB_DONE
LUT_SUB:
    s_lshl_b32 s3, s62, 25
    s_add_u32 s3, s3, 0x8000
    v_lshl_add_u32 v128, v1, 15, s3
    v_add_u32 v129, 0x10000, v128
    v_add_u32 v130, 0x10000, v129
    v_add_u32 v131, 0x10000, v130
    v_add_u32 v132, 0x10000, v131
    v_add_u32 v133, 0x10000, v132
    v_add_u32 v134, 0x10000, v133
    v_add_u32 v135, 0x10000, v134
    v_pk_mul_f32 v[136:137], v[128:129], s[10:11]
    v_pk_mul_f32 v[138:139], v[130:131], s[10:11]
    v_pk_mul_f32 v[140:141], v[132:133], s[10:11]
    v_pk_mul_f32 v[142:143], v[134:135], s[10:11]
    v_exp_f32 v136, v136
    v_exp_f32 v137, v137
    v_exp_f32 v138, v138
    v_exp_f32 v139, v139
    v_exp_f32 v140, v140
    v_exp_f32 v141, v141
    v_exp_f32 v142, v142
    v_exp_f32 v143, v143
    s_lshl_b32 s3, s62, 10
    v_pk_add_f32 v[144:145], v[136:137], 1.0 op_sel_hi:[1,0]
    v_pk_add_f32 v[146:147], v[138:139], 1.0 op_sel_hi:[1,0]
    v_pk_add_f32 v[148:149], v[140:141], 1.0 op_sel_hi:[1,0]
    v_pk_add_f32 v[150:151], v[142:143], 1.0 op_sel_hi:[1,0]
    v_rcp_f32 v144, v144
    v_rcp_f32 v145, v145
    v_rcp_f32 v146, v146
    v_rcp_f32 v147, v147
    v_rcp_f32 v148, v148
    v_rcp_f32 v149, v149
    v_rcp_f32 v150, v150
    v_rcp_f32 v151, v151
    v_add_u32 v160, s3, v1
    v_pk_mul_f32 v[128:129], v[128:129], v[144:145]
    v_pk_mul_f32 v[130:131], v[130:131], v[146:147]
    v_pk_mul_f32 v[132:133], v[132:133], v[148:149]
    v_pk_mul_f32 v[134:135], v[134:135], v[150:151]
    v_add_u32 v161, 0x10000, v160
    v_pk_mul_f32 v[136:137], v[128:129], v[136:137] neg_lo:[1,0] neg_hi:[1,0]
    v_pk_mul_f32 v[138:139], v[130:131], v[138:139] neg_lo:[1,0] neg_hi:[1,0]
    v_pk_mul_f32 v[140:141], v[132:133], v[140:141] neg_lo:[1,0] neg_hi:[1,0]
    v_pk_mul_f32 v[142:143], v[134:135], v[142:143] neg_lo:[1,0] neg_hi:[1,0]
    v_cvt_pk_bf16_f32 v152, v128, v129
    v_cvt_pk_bf16_f32 v153, v130, v131
    v_cvt_pk_bf16_f32 v154, v132, v133
    v_cvt_pk_bf16_f32 v155, v134, v135
    v_cvt_pk_bf16_f32 v156, v136, v137
    v_cvt_pk_bf16_f32 v157, v138, v139
    v_cvt_pk_bf16_f32 v158, v140, v141
    v_cvt_pk_bf16_f32 v159, v142, v143
    ds_write_b128 v160, v[152:155] offset:32768
    ds_write_b128 v161, v[156:159] offset:32768
    s_add_u32 s62, s62, 1
    s_sub_u32 s63, s63, 1
    s_cmp_lg_u32 s63, 0
    s_cbranch_scc1 LUT_SUB
    s_setpc_b64 s[6:7]
CONST_SUB:
    ds_write_b32 v193, v192 offset:31744
    v_lshrrev_b32 v193, 3, v1
    v_and_b32 v193, 24, v193
    s_mov_b32 s4, 0x05040100
    s_mov_b32 s5, 0x07060302
    ds_read_b64_tr_b16 v[180:181], v193 offset:31744
    ds_read_b64_tr_b16 v[182:183], v193 offset:31776
    ds_read_b64_tr_b16 v[184:185], v193 offset:31808
    ds_read_b64_tr_b16 v[186:187], v193 offset:31840
    v_perm_b32 v176, v189, v188, s4
    v_perm_b32 v178, v189, v188, s5
    v_perm_b32 v177, v191, v190, s4
    v_perm_b32 v179, v191, v190, s5
    s_setpc_b64 s[6:7]
HELP:
    s_sub_u32 s8, s25, 5
    s_mul_i32 s4, s8, 3072
    s_cmp_eq_u32 s8, 1
    s_cselect_b32 s4, 4096, s4
    s_mul_i32 s3, s2, 10240
    s_add_u32 s3, s3, s4
    v_add_u32 v8, s3, v1
    s_add_u32 s4, s4, 87040
    v_add_u32 v9, s4, v1
    s_mul_i32 s4, s8, 7168
    s_mul_i32 s3, s2, 20480
    s_add_u32 s3, s3, s4
    s_add_u32 s3, s3, 2621440
    v_add_u32 v12, s3, v1
    v_add_u32 v13, s4, v1
    s_waitcnt lgkmcnt(0)
    s_add_u32 s64, s64, 1
    s_and_b32 s65, s65, 0x3ff
    s_barrier
    s_cmp_eq_u32 s25, 6
    s_cbranch_scc1 ROW
    s_cmp_eq_u32 s25, 7
    s_cselect_b32 s62, 63, 0
    s_mov_b32 s63, 1
    s_call_b64 s[6:7], LUT_SUB
    s_waitcnt vmcnt(0)
    s_call_b64 s[6:7], CONST_SUB
    v_mov_b32 v10, 65280
    v_mov_b32 v11, 0x7f80
    s_cmp_lg_u32 s25, 7
    s_cbranch_scc1 NO_ROW
    ds_write_b16 v10, v11 offset:32768
    s_branch NO_ROW
ROW:
    v_lshrrev_b32 v117, 1, v1
    ds_read_b64 v[96:97], v117 offset:2304
    ds_read_b64 v[98:99], v117 offset:2816
    s_lshl_b32 s3, s2, 11
    s_add_u32 s3, s3, 7864320
    v_add_u32 v116, s3, v1
    s_lshl_b32 s3, s65, 22
    s_waitcnt lgkmcnt(0)
    v_add_u32 v10, v96, v97
    v_add_u32 v11, v98, v99
    v_mov_b32 v100, v10
    v_mov_b32 v102, v11
    s_nop 0
    v_add_u32_dpp v100, v100, v100 row_shr:1 row_mask:0xf bank_mask:0xf bound_ctrl:0
    v_add_u32_dpp v102, v102, v102 row_shr:1 row_mask:0xf bank_mask:0xf bound_ctrl:0
    s_nop 0
    v_add_u32_dpp v100, v100, v100 row_shr:2 row_mask:0xf bank_mask:0xf bound_ctrl:0
    v_add_u32_dpp v102, v102, v102 row_shr:2 row_mask:0xf bank_mask:0xf bound_ctrl:0
    s_nop 0
    v_add_u32_dpp v100, v100, v100 row_shr:4 row_mask:0xf bank_mask:0xf bound_ctrl:0
    v_add_u32_dpp v102, v102, v102 row_shr:4 row_mask:0xf bank_mask:0xf bound_ctrl:0
    s_nop 0
    v_add_u32_dpp v100, v100, v100 row_shr:8 row_mask:0xf bank_mask:0xf bound_ctrl:0
    v_add_u32_dpp v102, v102, v102 row_shr:8 row_mask:0xf bank_mask:0xf bound_ctrl:0
    s_nop 0
    v_add_u32_dpp v100, v100, v100 row_bcast:15 row_mask:0xa bank_mask:0xf
    v_add_u32_dpp v102, v102, v102 row_bcast:15 row_mask:0xa bank_mask:0xf
    s_nop 0
    v_add_u32_dpp v100, v100, v100 row_bcast:31 row_mask:0xc bank_mask:0xf
    v_add_u32_dpp v102, v102, v102 row_bcast:31 row_mask:0xc bank_mask:0xf
    v_sub_u32 v102, v102, v11
    v_readlane_b32 s4, v100, 63
    v_sub_u32 v100, v100, v10
    v_add_u32 v101, v100, v96
    v_add_u32 v102, s4, v102
    v_add_u32 v103, v102, v98
    v_lshl_or_b32 v108, v96, 11, v100
    v_or_b32 v108, s3, v108
    v_mov_b32 v109, s64
    v_lshl_or_b32 v110, v97, 11, v101
    v_or_b32 v110, s3, v110
    v_mov_b32 v111, s64
    v_lshl_or_b32 v112, v98, 11, v102
    v_or_b32 v112, s3, v112
    v_mov_b32 v113, s64
    v_lshl_or_b32 v114, v99, 11, v103
    v_or_b32 v114, s3, v114
    v_mov_b32 v115, s64
    global_store_dwordx4 v116, v[108:111], s[16:17] sc0 sc1
    global_store_dwordx4 v116, v[112:115], s[16:17] offset:1024 sc0 sc1
    s_waitcnt vmcnt(2)
    s_call_b64 s[6:7], CONST_SUB
NO_ROW:
    s_barrier
    ds_read_b128 v[64:67], v9 offset:0
    ds_read_b128 v[68:71], v9 offset:1024
    ds_read_b128 v[72:75], v9 offset:2048
    ds_read_b128 v[76:79], v9 offset:3072
    s_waitcnt lgkmcnt(3)
    global_store_dwordx4 v8, v[64:67], s[16:17] offset:0 sc0 sc1
    s_waitcnt lgkmcnt(2)
    global_store_dwordx4 v8, v[68:71], s[16:17] offset:1024 sc0 sc1
    s_cmp_eq_u32 s8, 1
    s_cbranch_scc1 KEYS_STORED
    s_waitcnt lgkmcnt(1)
    global_store_dwordx4 v8, v[72:75], s[16:17] offset:2048 sc0 sc1
    s_waitcnt lgkmcnt(0)
    global_store_dwordx4 v8, v[76:79], s[16:17] offset:3072 sc0 sc1
KEYS_STORED:
    v_mov_b32 v2, 0
    s_waitcnt lgkmcnt(0)
    s_barrier
    s_cmp_ge_u32 s2, 250
    s_cbranch_scc1 TAB_DONE
    ds_read_b128 v[84:87], v13 offset:4352
    ds_read_b128 v[88:91], v13 offset:5376
    ds_read_b128 v[92:95], v13 offset:6400
    ds_read_b128 v[96:99], v13 offset:7424
    ds_read_b128 v[100:103], v13 offset:8448
    ds_read_b128 v[104:107], v13 offset:9472
    ds_read_b128 v[108:111], v13 offset:10496
    s_waitcnt lgkmcnt(6)
    global_store_dwordx4 v12, v[84:87], s[16:17] offset:0 sc0 sc1
    s_waitcnt lgkmcnt(5)
    global_store_dwordx4 v12, v[88:91], s[16:17] offset:1024 sc0 sc1
    s_waitcnt lgkmcnt(4)
    global_store_dwordx4 v12, v[92:95], s[16:17] offset:2048 sc0 sc1
    s_waitcnt lgkmcnt(3)
    global_store_dwordx4 v12, v[96:99], s[16:17] offset:3072 sc0 sc1
    v_add_u32 v12, 4096, v12
    s_waitcnt lgkmcnt(2)
    global_store_dwordx4 v12, v[100:103], s[16:17] offset:0 sc0 sc1
    s_waitcnt lgkmcnt(1)
    global_store_dwordx4 v12, v[104:107], s[16:17] offset:1024 sc0 sc1
    s_cmp_eq_u32 s8, 2
    s_cbranch_scc1 TAB_DONE
    s_waitcnt lgkmcnt(0)
    global_store_dwordx4 v12, v[108:111], s[16:17] offset:2048 sc0 sc1
    s_branch TAB_DONE
AUX_LOAD:
    s_cmp_ge_u32 s2, 254
    s_cbranch_scc1 LOADED
    s_cmp_ge_u32 s25, 4
    s_cbranch_scc1 LOADED
    s_sub_u32 s4, s2, 250
    s_lshl_b32 s5, s25, 13
    s_lshl_b32 s8, s4, 6
    s_add_u32 s5, s5, s8
    v_lshrrev_b32 v9, 8, v1
    v_lshlrev_b32 v9, 11, v9
    v_bfe_u32 v10, v1, 4, 4
    v_lshl_add_u32 v9, v10, 2, v9
    v_add_u32 v9, s5, v9
    s_lshl_b32 s5, s4, 13
    s_lshl_b32 s8, s25, 10
    s_add_u32 s5, s5, s8
    s_add_u32 s5, s5, 7802880
    v_add_u32 v10, s5, v1
    global_load_dword v64, v9, s[54:55] offset:0
    global_load_dword v65, v9, s[54:55] offset:256
    global_load_dword v66, v9, s[54:55] offset:512
    global_load_dword v67, v9, s[54:55] offset:768
    global_load_dword v68, v9, s[54:55] offset:1024
    global_load_dword v69, v9, s[54:55] offset:1280
    global_load_dword v70, v9, s[54:55] offset:1536
    global_load_dword v71, v9, s[54:55] offset:1792
    s_branch LOADED
AUX:
    s_waitcnt lgkmcnt(0)
    s_add_u32 s64, s64, 1
    s_and_b32 s65, s65, 0x3ff
    s_barrier
    s_cmp_ge_u32 s2, 254
    s_cbranch_scc1 AUX_DONE
    s_cmp_ge_u32 s25, 4
    s_cbranch_scc1 AUX_DONE
    s_mov_b32 s4, 0x05040100
    s_mov_b32 s5, 0x07060302
    s_waitcnt vmcnt(0)
    v_perm_b32 v72, v65, v64, s4
    v_perm_b32 v76, v65, v64, s5
    v_perm_b32 v73, v67, v66, s4
    v_perm_b32 v77, v67, v66, s5
    v_perm_b32 v74, v69, v68, s4
    v_perm_b32 v78, v69, v68, s5
    v_perm_b32 v75, v71, v70, s4
    v_perm_b32 v79, v71, v70, s5
    global_store_dwordx4 v10, v[72:75], s[16:17] sc0 sc1
    v_add_u32 v10, 4096, v10
    global_store_dwordx4 v10, v[76:79], s[16:17] sc0 sc1
AUX_DONE:
    s_barrier
    s_waitcnt vmcnt(0)
    s_branch BINNED
WAVE4:
    s_mov_b32 s62, 25
    s_mov_b32 s63, 2
    s_call_b64 s[6:7], LUT_SUB
TAB_DONE:
    s_cmp_ge_u32 s25, 4
    s_cbranch_scc1 NOT_POLLER
    v_and_b32 v13, 0x7ff, v2
    v_bfe_u32 v2, v2, 11, 11
    v_add_u32 v4, v4, v13
    v_mov_b32 v3, v2
    v_lshlrev_b32 v10, 3, v4
    buffer_load_dword v167, v10, s[16:19], 0 offen sc1
    s_nop 1
    v_add_u32_dpp v3, v3, v3 row_shr:1 row_mask:0xf bank_mask:0xf bound_ctrl:0
    s_nop 1
    v_add_u32_dpp v3, v3, v3 row_shr:2 row_mask:0xf bank_mask:0xf bound_ctrl:0
    s_nop 1
    v_add_u32_dpp v3, v3, v3 row_shr:4 row_mask:0xf bank_mask:0xf bound_ctrl:0
    s_nop 1
    v_add_u32_dpp v3, v3, v3 row_shr:8 row_mask:0xf bank_mask:0xf bound_ctrl:0
    s_nop 1
    v_add_u32_dpp v3, v3, v3 row_bcast:15 row_mask:0xa bank_mask:0xf
    s_nop 1
    v_add_u32_dpp v3, v3, v3 row_bcast:31 row_mask:0xc bank_mask:0xf
    s_lshl_b32 s3, s25, 2
    v_mov_b32 v10, s3
    v_add_u32 v11, 1, v3
    v_sub_u32 v3, v3, v2
    s_mov_b32 exec_lo, 0
    s_mov_b32 exec_hi, 0x80000000
    ds_write_b32 v10, v11 offset:2176
    s_mov_b64 exec, -1
    s_branch TOTALS
NOT_POLLER:
    s_cmp_eq_u32 s25, 4
    s_cbranch_scc1 TOTALS
    v_mov_b32 v10, 2240
    s_waitcnt vmcnt(0)
    s_mov_b64 exec, 1
    ds_add_rtn_u32 v10, v10, v15
    s_mov_b64 exec, -1
    s_waitcnt lgkmcnt(0)
    v_readfirstlane_b32 s3, v10
    s_cmp_lg_u32 s3, 2
    s_cbranch_scc1 TOTALS
    s_lshl_b32 s3, s2, 10
    s_add_u32 s3, s3, 8388608
    v_add_u32 v9, s3, v1
    v_mov_b32 v10, s64
    v_mov_b32 v11, s65
    v_mov_b32 v12, s64
    v_mov_b32 v13, s65
    global_store_dwordx4 v9, v[10:13], s[16:17] sc0 sc1
    s_nop 1
TOTALS:
    v_mov_b32 v10, 0
TOTALS_SPIN:
    ds_read_b128 v[64:67], v10 offset:2176
    s_waitcnt lgkmcnt(0)
    v_readfirstlane_b32 s4, v64
    v_readfirstlane_b32 s5, v65
    v_readfirstlane_b32 s6, v66
    v_readfirstlane_b32 s7, v67
    s_min_u32 s3, s4, s5
    s_min_u32 s8, s6, s7
    s_min_u32 s3, s3, s8
    s_cmp_eq_u32 s3, 0
    s_cbranch_scc0 TOTALS_OK
    s_sub_u32 s35, s35, 1
    s_cbranch_scc0 TOTALS_SPIN
    s_endpgm
TOTALS_OK:
    s_add_u32 s5, s5, s4
    s_add_u32 s6, s6, s5
    s_add_u32 s7, s7, s6
    s_sub_u32 s26, s7, 4
    s_cmp_eq_u32 s25, 1
    s_cselect_b32 s3, s4, 0
    s_cmp_eq_u32 s25, 2
    s_cselect_b32 s3, s5, s3
    s_cmp_eq_u32 s25, 3
    s_cselect_b32 s3, s6, s3
    s_sub_u32 s3, s3, s25
    v_add_u32 v3, s3, v3
    s_cmp_lg_u32 s25, 4
    s_cbranch_scc1 EPOCH_DONE
    s_cmp_lg_u32 s2, 0
    s_cbranch_scc1 EPOCH_DONE
    v_mov_b32 v12, s64
    v_mov_b32 v10, 8650752
    s_mov_b64 exec, 1
    global_store_dword v10, v12, s[16:17] sc0 sc1
    s_mov_b64 exec, -1
EPOCH_DONE:
    s_lshl_b32 s33, s2, 3
    s_add_u32 s33, s33, s25
    s_lshl_b32 s33, s33, 7
    s_add_u32 s33, s33, 0
    v_min_u32 v9, 304, v1
    v_lshl_add_u32 v9, v9, 14, s33
    buffer_load_dword v167, v9, s[12:15], 0 offen
NO_X_TOUCH_3:
ROUND:
    v_mov_b32 v8, 0
    v_subrev_u32 v9, s27, v3
    v_mov_b32 v10, v4
    s_mov_b32 s3, 1472
    s_cmp_gt_u32 s26, 1472
    s_cbranch_scc1 EXPAND
    v_lshlrev_b32 v11, 2, v3
    v_cmpx_lt_u32 vcc, 0, v2
    ds_write_b32 v11, v10 offset:2304
    v_add_u32 v10, 1, v10
    v_cmpx_lt_u32 vcc, 1, v2
    ds_write_b32 v11, v10 offset:2308
    v_add_u32 v10, 1, v10
    v_cmpx_lt_u32 vcc, 2, v2
    ds_write_b32 v11, v10 offset:2312
    v_add_u32 v10, 1, v10
    v_cmpx_lt_u32 vcc, 3, v2
    ds_write_b32 v11, v10 offset:2316
    v_add_u32 v10, 1, v10
    v_cmpx_lt_u32 vcc, 4, v2
    ds_write_b32 v11, v10 offset:2320
    v_add_u32 v10, 1, v10
    v_cmpx_lt_u32 vcc, 5, v2
    ds_write_b32 v11, v10 offset:2324
    v_add_u32 v10, 1, v10
    v_cmpx_lt_u32 vcc, 6, v2
    s_cbranch_execz EXPAND_DONE
    ds_write_b32 v11, v10 offset:2328
    v_add_u32 v10, 1, v10
    v_cmpx_lt_u32 vcc, 7, v2
    ds_write_b32 v11, v10 offset:2332
    v_add_u32 v10, 1, v10
    v_cmpx_lt_u32 vcc, 8, v2
    s_cbranch_execz EXPAND_DONE
    ds_write_b32 v11, v10 offset:2336
    v_add_u32 v10, 1, v10
    v_cmpx_lt_u32 vcc, 9, v2
    ds_write_b32 v11, v10 offset:2340
    v_add_u32 v10, 1, v10
    v_cmpx_lt_u32 vcc, 10, v2
    s_cbranch_execz EXPAND_DONE
    ds_write_b32 v11, v10 offset:2344
    v_add_u32 v10, 1, v10
    v_cmpx_lt_u32 vcc, 11, v2
    ds_write_b32 v11, v10 offset:2348
    v_add_u32 v10, 1, v10
    v_cmpx_lt_u32 vcc, 12, v2
    s_cbranch_execz EXPAND_DONE
    ds_write_b32 v11, v10 offset:2352
    v_add_u32 v10, 1, v10
    v_cmpx_lt_u32 vcc, 13, v2
    ds_write_b32 v11, v10 offset:2356
    v_add_u32 v10, 1, v10
    v_cmpx_lt_u32 vcc, 14, v2
    s_cbranch_execz EXPAND_DONE
    ds_write_b32 v11, v10 offset:2360
    v_add_u32 v10, 1, v10
    v_cmpx_lt_u32 vcc, 15, v2
    ds_write_b32 v11, v10 offset:2364
    v_add_u32 v10, 1, v10
    v_mov_b32 v8, 16
    v_add_u32 v9, 16, v9
EXPAND:
    v_cmp_lt_u32 vcc, v8, v2
    s_and_b64 exec, exec, vcc
    s_cbranch_execz EXPAND_DONE
    v_cmp_gt_u32 vcc, s3, v9
    v_lshlrev_b32 v11, 2, v9
    s_and_saveexec_b64 s[42:43], vcc
    ds_write_b32 v11, v10 offset:2304
    s_mov_b64 exec, s[42:43]
    v_add_u32 v8, 1, v8
    v_add_u32 v9, 1, v9
    v_add_u32 v10, 1, v10
    s_branch EXPAND
EXPAND_DONE:
    s_mov_b64 exec, -1
    s_sub_u32 s28, s26, s27
    s_min_u32 s28, s28, 1472
    v_lshlrev_b32 v8, 2, v0
    v_add_u32 v9, 0, v0
    v_cmp_gt_u32 s[36:37], s28, v9
    v_add_u32 v9, 512, v0
    v_cmp_gt_u32 s[38:39], s28, v9
    v_add_u32 v9, 1024, v0
    v_cmp_gt_u32 s[40:41], s28, v9
    s_waitcnt lgkmcnt(0)
    s_barrier
    ds_read_b32 v64, v8 offset:2304
    ds_read_b32 v65, v8 offset:4352
    ds_read_b32 v66, v8 offset:6400
    s_mov_b32 s44, 5033
    s_waitcnt lgkmcnt(0)
    v_lshlrev_b32 v68, 3, v64
    v_lshlrev_b32 v64, 4, v64
    v_lshlrev_b32 v69, 3, v65
    v_lshlrev_b32 v65, 4, v65
    v_lshlrev_b32 v70, 3, v66
    v_lshlrev_b32 v66, 4, v66
KEY_LOAD:
    s_mov_b64 exec, s[40:41]
    s_cbranch_execz SKIP3
    buffer_load_dwordx2 v[100:101], v70, s[16:19], 0 offen sc1
SKIP3:
    s_mov_b64 exec, s[36:37]
    buffer_load_dwordx2 v[96:97], v68, s[16:19], 0 offen sc1
    s_mov_b64 exec, s[38:39]
    buffer_load_dwordx2 v[98:99], v69, s[16:19], 0 offen sc1
    s_mov_b64 exec, -1
    s_cmp_lt_u32 s25, 1
    s_cbranch_scc1 NO_LAST_JOB
    s_mov_b32 s10, 0xbfb8aa3b
    s_mov_b32 s11, 0xbfb8aa3b
    s_add_u32 s62, s25, 26
    s_mov_b32 s63, 1
    s_call_b64 s[6:7], LUT_SUB
NO_LAST_JOB:
    s_waitcnt vmcnt(0)
    v_cmp_ne_u32 s[48:49], s64, v97
    v_cmp_ne_u32 s[50:51], s64, v99
    v_cmp_ne_u32 s[52:53], s64, v101
    s_and_b64 s[48:49], s[48:49], s[36:37]
    s_and_b64 s[50:51], s[50:51], s[38:39]
    s_and_b64 s[52:53], s[52:53], s[40:41]
    s_or_b64 s[48:49], s[48:49], s[50:51]
    s_or_b64 s[48:49], s[48:49], s[52:53]
    s_cbranch_scc0 KEYS_OK
    s_sub_u32 s35, s35, 1
    s_cbranch_scc0 KEY_LOAD
    s_endpgm
KEYS_OK:
    buffer_load_dwordx2 v[136:137], v166, s[16:19], 0 offen sc1
    v_mul_hi_u32 v9, s44, v96
    v_and_b32 v72, 63, v96
    v_mul_u32_u24 v72, 48, v72
    v_lshl_add_u32 v72, v9, 2, v72
    v_mul_hi_u32 v9, s44, v98
    v_and_b32 v73, 63, v98
    v_mul_u32_u24 v73, 48, v73
    v_lshl_add_u32 v73, v9, 2, v73
    v_mul_hi_u32 v9, s44, v100
    v_and_b32 v74, 63, v100
    v_mul_u32_u24 v74, 48, v74
    v_lshl_add_u32 v74, v9, 2, v74
    s_mov_b64 exec, s[36:37]
    ds_add_rtn_u32 v76, v72, v15 offset:0
    s_mov_b64 exec, s[38:39]
    ds_add_rtn_u32 v77, v73, v15 offset:0
    s_mov_b64 exec, s[40:41]
    ds_add_rtn_u32 v78, v74, v15 offset:0
    s_mov_b64 exec, -1
    v_add_u32 v9, 0, v0
    v_lshlrev_b32 v9, 21, v9
    v_lshrrev_b32 v80, 10, v96
    v_lshl_or_b32 v80, v80, 7, v9
    v_add_u32 v9, 512, v0
    v_lshlrev_b32 v9, 21, v9
    v_lshrrev_b32 v81, 10, v98
    v_lshl_or_b32 v81, v81, 7, v9
    v_add_u32 v9, 1024, v0
    v_lshlrev_b32 v9, 21, v9
    v_lshrrev_b32 v82, 10, v100
    v_lshl_or_b32 v82, v82, 7, v9
    v_lshrrev_b32 v8, 4, v1
    v_min_u32 v9, 39, v8
    v_mul_u32_u24 v9, 48, v9
    v_cmp_gt_u32 s[46:47], 40, v8
    v_sub_u32 v10, 63, v8
    s_mul_i32 s10, s25, 5
    s_lshl_b32 s3, s25, 10
    s_add_u32 s3, s3, 8192
    s_mov_b32 s9, 2621440
    s_waitcnt lgkmcnt(0)
    s_barrier
    ds_read_b128 v[84:87], v9 offset:0
    ds_read_b128 v[88:91], v9 offset:16
    ds_read_b128 v[92:95], v9 offset:32
    s_waitcnt lgkmcnt(1)
    v_add3_u32 v84, v84, v85, v86
    v_add3_u32 v87, v87, v88, v89
    v_add3_u32 v84, v84, v90, v91
    s_waitcnt lgkmcnt(0)
    v_add3_u32 v87, v87, v92, v93
    v_add3_u32 v84, v84, v94, v95
    v_add_u32 v84, v84, v87
    v_lshl_or_b32 v85, v84, 6, v10
    v_cndmask_b32 v85, 0, v85, s[46:47]
    s_cmp_lg_u32 s27, 0
    s_cbranch_scc1 DEALT
    v_readlane_b32 s4, v85, s10
    s_add_u32 s10, s10, 1
    v_readlane_b32 s5, v85, s10
    s_add_u32 s10, s10, 1
    v_readlane_b32 s6, v85, s10
    s_add_u32 s10, s10, 1
    v_readlane_b32 s7, v85, s10
    s_add_u32 s10, s10, 1
    v_readlane_b32 s8, v85, s10
    v_cmp_lt_u32 s[48:49], s4, v85
    v_cmp_lt_u32 s[50:51], s5, v85
    v_cmp_lt_u32 s[52:53], s6, v85
    v_cmp_lt_u32 s[54:55], s7, v85
    v_cmp_lt_u32 s[56:57], s8, v85
    s_bcnt1_i32_b64 s4, s[48:49]
    s_bcnt1_i32_b64 s5, s[50:51]
    s_bcnt1_i32_b64 s6, s[52:53]
    s_bcnt1_i32_b64 s7, s[54:55]
    s_bcnt1_i32_b64 s8, s[56:57]
    v_readlane_b32 s4, v174, s4
    v_readlane_b32 s5, v174, s5
    v_readlane_b32 s6, v174, s6
    v_readlane_b32 s7, v174, s7
    v_readlane_b32 s8, v174, s8
    s_sub_u32 s10, s10, 4
    v_add_u32 v10, s10, v8
    v_writelane_b32 v9, s4, 0
    v_writelane_b32 v9, s5, 1
    v_writelane_b32 v9, s6, 2
    v_writelane_b32 v9, s7, 3
    v_writelane_b32 v9, s8, 4
    s_mov_b64 exec, 0x1f
    ds_write_b32 v9, v10 offset:1920
    s_mov_b64 exec, -1
DEALT:
    s_lshl_b32 s11, s10, 2
    v_add_u32 v9, s11, v7
    v_lshlrev_b32 v13, 2, v8
POLL_REC:
    s_waitcnt vmcnt(0)
CHECK_REC:
    v_cmp_ne_u32 vcc, s64, v136
    v_cmp_ne_u32 s[42:43], s65, v137
    s_or_b64 vcc, vcc, s[42:43]
    s_and_b64 exec, exec, vcc
    s_cbranch_execz POLLED_REC
    s_sub_u32 s35, s35, 1
    s_cbranch_scc1 END
    buffer_load_dwordx2 v[136:137], v166, s[16:19], 0 offen sc1
    s_branch POLL_REC
POLLED_REC:
    s_mov_b64 exec, -1
    v_cmp_gt_u32 s[42:43], 60, v8
    s_waitcnt lgkmcnt(0)
    s_barrier
    ds_read_b32 v9, v9 offset:1920
    ds_read_b32 v13, v13 offset:1920
    v_lshlrev_b32 v12, 17, v7
    s_add_u32 m0, s3, 0
    s_mov_b64 exec, s[36:37]
    buffer_load_dwordx4 v64, s[16:19], s9 offen sc1 lds
    s_add_u32 m0, s3, 8192
    s_mov_b64 exec, s[38:39]
    buffer_load_dwordx4 v65, s[16:19], s9 offen sc1 lds
    s_add_u32 m0, s3, 16384
    s_mov_b64 exec, s[40:41]
    s_cbranch_execz SKIP3R
    buffer_load_dwordx4 v66, s[16:19], s9 offen sc1 lds
SKIP3R:
    s_mov_b64 exec, -1
    s_waitcnt lgkmcnt(1)
    v_mul_u32_u24 v10, 48, v9
    v_add_u32 v10, v10, v14
    ds_read_b32 v11, v10 offset:0
    s_waitcnt lgkmcnt(1)
    v_lshlrev_b32 v13, 2, v13
    ds_bpermute_b32 v86, v13, v84
    v_readlane_b32 s4, v9, 0
    v_readlane_b32 s5, v9, 1
    v_readlane_b32 s6, v9, 2
    v_readlane_b32 s7, v9, 3
    v_readlane_b32 s8, v9, 4
    s_waitcnt lgkmcnt(0)
    v_cndmask_b32 v11, 0, v11, s[42:43]
    v_cndmask_b32 v86, 0, v86, s[46:47]
    v_sub_u32 v12, v12, v11
    v_mov_b32 v87, v86
    s_nop 0
    v_add_u32_dpp v11, v11, v11 row_shr:1 row_mask:0xf bank_mask:0xf bound_ctrl:0
    v_add_u32_dpp v87, v87, v87 row_shr:1 row_mask:0xf bank_mask:0xf bound_ctrl:0
    s_nop 0
    v_add_u32_dpp v11, v11, v11 row_shr:2 row_mask:0xf bank_mask:0xf bound_ctrl:0
    v_add_u32_dpp v87, v87, v87 row_shr:2 row_mask:0xf bank_mask:0xf bound_ctrl:0
    s_nop 0
    v_add_u32_dpp v11, v11, v11 row_shr:4 row_mask:0xf bank_mask:0xf bound_ctrl:0
    v_add_u32_dpp v87, v87, v87 row_shr:4 row_mask:0xf bank_mask:0xf bound_ctrl:0
    s_nop 0
    v_add_u32_dpp v11, v11, v11 row_shr:8 row_mask:0xf bank_mask:0xf bound_ctrl:0
    v_add_u32_dpp v87, v87, v87 row_shr:8 row_mask:0xf bank_mask:0xf bound_ctrl:0
    s_nop 0
    v_add_u32_dpp v11, v11, v11 row_bcast:15 row_mask:0xa bank_mask:0xf
    v_add_u32_dpp v87, v87, v87 row_bcast:15 row_mask:0xa bank_mask:0xf
    s_nop 0
    v_add_u32_dpp v11, v11, v11 row_bcast:31 row_mask:0xc bank_mask:0xf
    v_add_u32_dpp v87, v87, v87 row_bcast:31 row_mask:0xc bank_mask:0xf
    v_sub_u32 v87, v87, v86
    v_add_u32 v12, v12, v11
    v_readlane_b32 s29, v87, s10
    v_readlane_b32 s30, v11, 63
    s_nop 0
    v_add_u32 v12, s29, v12
    s_mov_b64 exec, s[42:43]
    ds_write_b32 v10, v12 offset:0
    s_mov_b64 exec, -1
    v_add_u32 v6, s29, v8
    v_lshlrev_b32 v5, 2, v6
    v_add_u32 v5, 2304, v5
    s_max_u32 s10, s30, 6
    s_add_u32 s10, s10, -3
    s_and_b32 s31, s10, -4
    s_max_u32 s10, s30, s31
    s_sub_u32 s32, s10, s31
    s_add_u32 s30, s30, s29
    s_waitcnt lgkmcnt(0)
    s_barrier
    ds_read_b32 v72, v72 offset:0
    ds_read_b32 v73, v73 offset:0
    ds_read_b32 v74, v74 offset:0
    s_waitcnt lgkmcnt(2)
    v_lshrrev_b32 v9, 16, v72
    v_and_b32 v72, 0xffff, v72
    v_or_b32 v80, v80, v9
    v_add_lshl_u32 v72, v72, v76, 2
    s_waitcnt lgkmcnt(1)
    v_lshrrev_b32 v9, 16, v73
    v_and_b32 v73, 0xffff, v73
    v_or_b32 v81, v81, v9
    v_add_lshl_u32 v73, v73, v77, 2
    s_waitcnt lgkmcnt(0)
    v_lshrrev_b32 v9, 16, v74
    v_and_b32 v74, 0xffff, v74
    v_or_b32 v82, v82, v9
    v_add_lshl_u32 v74, v74, v78, 2
    s_mov_b64 exec, s[36:37]
    ds_write_b32 v72, v80 offset:2304
    s_mov_b64 exec, s[38:39]
    ds_write_b32 v73, v81 offset:2304
    s_mov_b64 exec, s[40:41]
    ds_write_b32 v74, v82 offset:2304
    s_mov_b64 exec, -1
    s_waitcnt lgkmcnt(0)
    s_barrier
    ds_read_b32 v165, v5
    s_mov_b32 s3, 0
    s_and_b32 s10, s25, 3
    s_lshl_b32 s10, s10, 13
    s_add_u32 s10, s10, 7802880
    s_add_u32 s11, s10, 4096
    v_mov_b32 v128, 0
    v_mov_b32 v129, 0
    v_mov_b32 v130, 0
    v_mov_b32 v131, 0
    v_mov_b32 v132, 0
    v_mov_b32 v133, 0
    v_mov_b32 v134, 0
    v_mov_b32 v135, 0
    s_waitcnt lgkmcnt(0)
    v_cmp_gt_u32 vcc, s30, v6
    v_add_u32 v6, 64, v6
    v_add_u32 v5, 256, v5
    v_cndmask_b32 v165, 40, v165, vcc
    v_lshrrev_b32 v8, 21, v165
    v_lshlrev_b32 v8, 4, v8
    v_lshlrev_b32 v9, 3, v165
    v_and_b32 v9, 0xfffc00, v9
    v_and_or_b32 v165, v165, 56, v9
    s_nop 0
    v_readlane_b32 s48, v165, 0
    s_and_b32 s33, s48, s34
    buffer_load_dwordx4 v[64:67], v1, s[12:15], s33 offen
    v_readlane_b32 s49, v165, 1
    s_and_b32 s33, s49, s34
    buffer_load_dwordx4 v[68:71], v1, s[12:15], s33 offen
    s_waitcnt vmcnt(2)
    s_barrier
    ds_read_b128 v[168:171], v8 offset:8192
    v_readlane_b32 s50, v165, 2
    s_and_b32 s33, s50, s34
    buffer_load_dwordx4 v[72:75], v1, s[12:15], s33 offen
    v_readlane_b32 s51, v165, 3
    s_and_b32 s33, s51, s34
    buffer_load_dwordx4 v[76:79], v1, s[12:15], s33 offen
    v_readlane_b32 s52, v165, 4
    s_and_b32 s33, s52, s34
    buffer_load_dwordx4 v[80:83], v1, s[12:15], s33 offen
    v_readlane_b32 s53, v165, 5
    s_and_b32 s33, s53, s34
    buffer_load_dwordx4 v[84:87], v1, s[12:15], s33 offen
    v_mov_b32 v164, v165
    s_waitcnt lgkmcnt(0)
    v_mov_b32 v172, v170
    v_mov_b32 v173, v171
    v_mfma_f32_4x4x4_16b_bf16 v[148:151], v[168:169], v[180:181], 0
    v_mfma_f32_4x4x4_16b_bf16 v[152:155], v[168:169], v[182:183], 0
    v_mfma_f32_4x4x4_16b_bf16 v[156:159], v[168:169], v[184:185], 0
    v_mfma_f32_4x4x4_16b_bf16 v[160:163], v[168:169], v[186:187], 0
    v_mfma_f32_4x4x4_16b_bf16 v[112:115], v[172:173], v[176:177], 0 cbsz:4 abid:0
    v_mfma_f32_4x4x4_16b_bf16 v[116:119], v[172:173], v[178:179], 0 cbsz:4 abid:0
    v_mfma_f32_4x4x4_16b_bf16 v[120:123], v[172:173], v[176:177], 0 cbsz:4 abid:1
    s_nop 1
    v_cvt_pk_bf16_f32 v140, v148, v152
    v_cvt_pk_bf16_f32 v141, v156, v160
    v_cvt_pk_bf16_f32 v142, v149, v153
    v_cvt_pk_bf16_f32 v143, v157, v161
    v_cvt_pk_bf16_f32 v144, v150, v154
    v_cvt_pk_bf16_f32 v145, v158, v162
    v_cvt_pk_bf16_f32 v146, v151, v155
    v_cvt_pk_bf16_f32 v147, v159, v163
    v_lshlrev_b32_sdwa v136, v15, v112 dst_sel:DWORD dst_unused:UNUSED_PAD src0_sel:DWORD src1_sel:WORD_1
    v_lshlrev_b32_sdwa v137, v15, v113 dst_sel:DWORD dst_unused:UNUSED_PAD src0_sel:DWORD src1_sel:WORD_1
    ds_read_u16_d16_hi v128, v136 offset:32768
    ds_read_u16_d16_hi v129, v137 offset:32768
    v_lshlrev_b32_sdwa v138, v15, v116 dst_sel:DWORD dst_unused:UNUSED_PAD src0_sel:DWORD src1_sel:WORD_1
    v_lshlrev_b32_sdwa v139, v15, v117 dst_sel:DWORD dst_unused:UNUSED_PAD src0_sel:DWORD src1_sel:WORD_1
    ds_read_u16_d16_hi v130, v138 offset:32768
    ds_read_u16_d16_hi v131, v139 offset:32768
    s_waitcnt vmcnt(5)
    v_mfma_f32_4x4x4_16b_bf16 v[96:99], v[140:141], v[64:65], 0 cbsz:4 abid:0
    v_mfma_f32_4x4x4_16b_bf16 v[100:103], v[140:141], v[66:67], 0 cbsz:4 abid:0
A_0:
    s_sub_u32 s31, s31, 4
    s_cbranch_scc1 B_0
    v_mfma_f32_4x4x4_16b_bf16 v[124:127], v[172:173], v[178:179], 0 cbsz:4 abid:1
    v_lshlrev_b32_sdwa v136, v15, v114 dst_sel:DWORD dst_unused:UNUSED_PAD src0_sel:DWORD src1_sel:WORD_1
    s_waitcnt vmcnt(4)
    v_mfma_f32_4x4x4_16b_bf16 v[104:107], v[142:143], v[68:69], 0 cbsz:4 abid:0
    v_readlane_b32 s54, v164, 6
    v_mfma_f32_4x4x4_16b_bf16 v[108:111], v[142:143], v[70:71], 0 cbsz:4 abid:0
    v_lshlrev_b32_sdwa v137, v15, v115 dst_sel:DWORD dst_unused:UNUSED_PAD src0_sel:DWORD src1_sel:WORD_1
    ds_read_u16_d16_hi v132, v136 offset:32768
    ds_read_u16_d16_hi v133, v137 offset:32768
    s_and_b32 s33, s54, s34
    buffer_load_dwordx4 v[88:91], v1, s[12:15], s33 offen
    s_waitcnt lgkmcnt(2)
    s_set_gpr_idx_on s48, 0xc
    v_pk_fma_f32 v[16:17], v[128:129], v[96:97], v[16:17] op_sel:[0,0,0] op_sel_hi:[0,1,1]
    v_pk_fma_f32 v[18:19], v[128:129], v[98:99], v[18:19] op_sel:[0,0,0] op_sel_hi:[0,1,1]
    v_pk_fma_f32 v[20:21], v[130:131], v[100:101], v[20:21] op_sel:[0,0,0] op_sel_hi:[0,1,1]
    v_pk_fma_f32 v[22:23], v[130:131], v[102:103], v[22:23] op_sel:[0,0,0] op_sel_hi:[0,1,1]
    s_set_gpr_idx_off
    v_lshlrev_b32_sdwa v138, v15, v118 dst_sel:DWORD dst_unused:UNUSED_PAD src0_sel:DWORD src1_sel:WORD_1
    s_waitcnt vmcnt(4)
    v_mfma_f32_4x4x4_16b_bf16 v[96:99], v[144:145], v[72:73], 0 cbsz:4 abid:0
    v_readlane_b32 s55, v164, 7
    v_mfma_f32_4x4x4_16b_bf16 v[100:103], v[144:145], v[74:75], 0 cbsz:4 abid:0
    v_lshlrev_b32_sdwa v139, v15, v119 dst_sel:DWORD dst_unused:UNUSED_PAD src0_sel:DWORD src1_sel:WORD_1
    ds_read_u16_d16_hi v134, v138 offset:32768
    ds_read_u16_d16_hi v135, v139 offset:32768
    s_and_b32 s33, s55, s34
    buffer_load_dwordx4 v[92:95], v1, s[12:15], s33 offen
    s_set_gpr_idx_on s49, 0xc
    v_pk_fma_f32 v[16:17], v[128:129], v[104:105], v[16:17] op_sel:[1,0,0] op_sel_hi:[1,1,1]
    v_pk_fma_f32 v[18:19], v[128:129], v[106:107], v[18:19] op_sel:[1,0,0] op_sel_hi:[1,1,1]
    v_pk_fma_f32 v[20:21], v[130:131], v[108:109], v[20:21] op_sel:[1,0,0] op_sel_hi:[1,1,1]
    v_pk_fma_f32 v[22:23], v[130:131], v[110:111], v[22:23] op_sel:[1,0,0] op_sel_hi:[1,1,1]
    s_set_gpr_idx_off
    v_mfma_f32_4x4x4_16b_bf16 v[112:115], v[172:173], v[176:177], 0 cbsz:4 abid:2
    v_lshlrev_b32_sdwa v136, v15, v120 dst_sel:DWORD dst_unused:UNUSED_PAD src0_sel:DWORD src1_sel:WORD_1
    s_waitcnt vmcnt(4)
    v_mfma_f32_4x4x4_16b_bf16 v[104:107], v[146:147], v[76:77], 0 cbsz:4 abid:0
    v_readlane_b32 s56, v164, 8
    v_mfma_f32_4x4x4_16b_bf16 v[108:111], v[146:147], v[78:79], 0 cbsz:4 abid:0
    v_lshlrev_b32_sdwa v137, v15, v121 dst_sel:DWORD dst_unused:UNUSED_PAD src0_sel:DWORD src1_sel:WORD_1
    ds_read_u16_d16_hi v128, v136 offset:32768
    ds_read_u16_d16_hi v129, v137 offset:32768
    s_and_b32 s33, s56, s34
    buffer_load_dwordx4 v[64:67], v1, s[12:15], s33 offen
    s_waitcnt lgkmcnt(2)
    s_set_gpr_idx_on s50, 0xc
    v_pk_fma_f32 v[16:17], v[132:133], v[96:97], v[16:17] op_sel:[0,0,0] op_sel_hi:[0,1,1]
    v_pk_fma_f32 v[18:19], v[132:133], v[98:99], v[18:19] op_sel:[0,0,0] op_sel_hi:[0,1,1]
    v_pk_fma_f32 v[20:21], v[134:135], v[100:101], v[20:21] op_sel:[0,0,0] op_sel_hi:[0,1,1]
    v_pk_fma_f32 v[22:23], v[134:135], v[102:103], v[22:23] op_sel:[0,0,0] op_sel_hi:[0,1,1]
    s_set_gpr_idx_off
    v_lshlrev_b32_sdwa v138, v15, v124 dst_sel:DWORD dst_unused:UNUSED_PAD src0_sel:DWORD src1_sel:WORD_1
    s_waitcnt vmcnt(4)
    v_mfma_f32_4x4x4_16b_bf16 v[96:99], v[140:141], v[80:81], 0 cbsz:4 abid:1
    v_readlane_b32 s57, v164, 9
    v_mfma_f32_4x4x4_16b_bf16 v[100:103], v[140:141], v[82:83], 0 cbsz:4 abid:1
    v_lshlrev_b32_sdwa v139, v15, v125 dst_sel:DWORD dst_unused:UNUSED_PAD src0_sel:DWORD src1_sel:WORD_1
    ds_read_u16_d16_hi v130, v138 offset:32768
    ds_read_u16_d16_hi v131, v139 offset:32768
    s_and_b32 s33, s57, s34
    buffer_load_dwordx4 v[68:71], v1, s[12:15], s33 offen
    s_set_gpr_idx_on s51, 0xc
    v_pk_fma_f32 v[16:17], v[132:133], v[104:105], v[16:17] op_sel:[1,0,0] op_sel_hi:[1,1,1]
    v_pk_fma_f32 v[18:19], v[132:133], v[106:107], v[18:19] op_sel:[1,0,0] op_sel_hi:[1,1,1]
    v_pk_fma_f32 v[20:21], v[134:135], v[108:109], v[20:21] op_sel:[1,0,0] op_sel_hi:[1,1,1]
    v_pk_fma_f32 v[22:23], v[134:135], v[110:111], v[22:23] op_sel:[1,0,0] op_sel_hi:[1,1,1]
    s_set_gpr_idx_off
A_4:
    s_sub_u32 s31, s31, 4
    s_cbranch_scc1 B_4
    v_mfma_f32_4x4x4_16b_bf16 v[116:119], v[172:173], v[178:179], 0 cbsz:4 abid:2
    v_lshlrev_b32_sdwa v136, v15, v122 dst_sel:DWORD dst_unused:UNUSED_PAD src0_sel:DWORD src1_sel:WORD_1
    s_waitcnt vmcnt(4)
    v_mfma_f32_4x4x4_16b_bf16 v[104:107], v[142:143], v[84:85], 0 cbsz:4 abid:1
    v_readlane_b32 s58, v164, 10
    v_mfma_f32_4x4x4_16b_bf16 v[108:111], v[142:143], v[86:87], 0 cbsz:4 abid:1
    v_lshlrev_b32_sdwa v137, v15, v123 dst_sel:DWORD dst_unused:UNUSED_PAD src0_sel:DWORD src1_sel:WORD_1
    ds_read_u16_d16_hi v132, v136 offset:32768
    ds_read_u16_d16_hi v133, v137 offset:32768
    s_and_b32 s33, s58, s34
    buffer_load_dwordx4 v[72:75], v1, s[12:15], s33 offen
    s_waitcnt lgkmcnt(2)
    s_set_gpr_idx_on s52, 0xc
    v_pk_fma_f32 v[16:17], v[128:129], v[96:97], v[16:17] op_sel:[0,0,0] op_sel_hi:[0,1,1]
    v_pk_fma_f32 v[18:19], v[128:129], v[98:99], v[18:19] op_sel:[0,0,0] op_sel_hi:[0,1,1]
    v_pk_fma_f32 v[20:21], v[130:131], v[100:101], v[20:21] op_sel:[0,0,0] op_sel_hi:[0,1,1]
    v_pk_fma_f32 v[22:23], v[130:131], v[102:103], v[22:23] op_sel:[0,0,0] op_sel_hi:[0,1,1]
    s_set_gpr_idx_off
    v_lshlrev_b32_sdwa v138, v15, v126 dst_sel:DWORD dst_unused:UNUSED_PAD src0_sel:DWORD src1_sel:WORD_1
    s_waitcnt vmcnt(4)
    v_mfma_f32_4x4x4_16b_bf16 v[96:99], v[144:145], v[88:89], 0 cbsz:4 abid:1
    v_readlane_b32 s59, v164, 11
    v_mfma_f32_4x4x4_16b_bf16 v[100:103], v[144:145], v[90:91], 0 cbsz:4 abid:1
    v_lshlrev_b32_sdwa v139, v15, v127 dst_sel:DWORD dst_unused:UNUSED_PAD src0_sel:DWORD src1_sel:WORD_1
    ds_read_u16_d16_hi v134, v138 offset:32768
    ds_read_u16_d16_hi v135, v139 offset:32768
    s_and_b32 s33, s59, s34
    buffer_load_dwordx4 v[76:79], v1, s[12:15], s33 offen
    s_set_gpr_idx_on s53, 0xc
    v_pk_fma_f32 v[16:17], v[128:129], v[104:105], v[16:17] op_sel:[1,0,0] op_sel_hi:[1,1,1]
    v_pk_fma_f32 v[18:19], v[128:129], v[106:107], v[18:19] op_sel:[1,0,0] op_sel_hi:[1,1,1]
    v_pk_fma_f32 v[20:21], v[130:131], v[108:109], v[20:21] op_sel:[1,0,0] op_sel_hi:[1,1,1]
    v_pk_fma_f32 v[22:23], v[130:131], v[110:111], v[22:23] op_sel:[1,0,0] op_sel_hi:[1,1,1]
    s_set_gpr_idx_off
    v_mfma_f32_4x4x4_16b_bf16 v[120:123], v[172:173], v[176:177], 0 cbsz:4 abid:3
    v_lshlrev_b32_sdwa v136, v15, v112 dst_sel:DWORD dst_unused:UNUSED_PAD src0_sel:DWORD src1_sel:WORD_1
    s_waitcnt vmcnt(4)
    v_mfma_f32_4x4x4_16b_bf16 v[104:107], v[146:147], v[92:93], 0 cbsz:4 abid:1
    v_readlane_b32 s60, v164, 12
    v_mfma_f32_4x4x4_16b_bf16 v[108:111], v[146:147], v[94:95], 0 cbsz:4 abid:1
    v_lshlrev_b32_sdwa v137, v15, v113 dst_sel:DWORD dst_unused:UNUSED_PAD src0_sel:DWORD src1_sel:WORD_1
    ds_read_u16_d16_hi v128, v136 offset:32768
    ds_read_u16_d16_hi v129, v137 offset:32768
    s_and_b32 s33, s60, s34
    buffer_load_dwordx4 v[80:83], v1, s[12:15], s33 offen
    s_waitcnt lgkmcnt(2)
    s_set_gpr_idx_on s54, 0xc
    v_pk_fma_f32 v[16:17], v[132:133], v[96:97], v[16:17] op_sel:[0,0,0] op_sel_hi:[0,1,1]
    v_pk_fma_f32 v[18:19], v[132:133], v[98:99], v[18:19] op_sel:[0,0,0] op_sel_hi:[0,1,1]
    v_pk_fma_f32 v[20:21], v[134:135], v[100:101], v[20:21] op_sel:[0,0,0] op_sel_hi:[0,1,1]
    v_pk_fma_f32 v[22:23], v[134:135], v[102:103], v[22:23] op_sel:[0,0,0] op_sel_hi:[0,1,1]
    s_set_gpr_idx_off
    v_lshlrev_b32_sdwa v138, v15, v116 dst_sel:DWORD dst_unused:UNUSED_PAD src0_sel:DWORD src1_sel:WORD_1
    s_waitcnt vmcnt(4)
    v_mfma_f32_4x4x4_16b_bf16 v[96:99], v[140:141], v[64:65], 0 cbsz:4 abid:2
    v_readlane_b32 s61, v164, 13
    v_mfma_f32_4x4x4_16b_bf16 v[100:103], v[140:141], v[66:67], 0 cbsz:4 abid:2
    v_lshlrev_b32_sdwa v139, v15, v117 dst_sel:DWORD dst_unused:UNUSED_PAD src0_sel:DWORD src1_sel:WORD_1
    ds_read_u16_d16_hi v130, v138 offset:32768
    ds_read_u16_d16_hi v131, v139 offset:32768
    s_and_b32 s33, s61, s34
    buffer_load_dwordx4 v[84:87], v1, s[12:15], s33 offen
    s_set_gpr_idx_on s55, 0xc
    v_pk_fma_f32 v[16:17], v[132:133], v[104:105], v[16:17] op_sel:[1,0,0] op_sel_hi:[1,1,1]
    v_pk_fma_f32 v[18:19], v[132:133], v[106:107], v[18:19] op_sel:[1,0,0] op_sel_hi:[1,1,1]
    v_pk_fma_f32 v[20:21], v[134:135], v[108:109], v[20:21] op_sel:[1,0,0] op_sel_hi:[1,1,1]
    v_pk_fma_f32 v[22:23], v[134:135], v[110:111], v[22:23] op_sel:[1,0,0] op_sel_hi:[1,1,1]
    s_set_gpr_idx_off
A_8:
    s_sub_u32 s31, s31, 4
    s_cbranch_scc1 B_8
    v_mfma_f32_4x4x4_16b_bf16 v[124:127], v[172:173], v[178:179], 0 cbsz:4 abid:3
    v_lshlrev_b32_sdwa v136, v15, v114 dst_sel:DWORD dst_unused:UNUSED_PAD src0_sel:DWORD src1_sel:WORD_1
    s_waitcnt vmcnt(4)
    v_mfma_f32_4x4x4_16b_bf16 v[104:107], v[142:143], v[68:69], 0 cbsz:4 abid:2
    v_readlane_b32 s62, v164, 14
    v_mfma_f32_4x4x4_16b_bf16 v[108:111], v[142:143], v[70:71], 0 cbsz:4 abid:2
    v_lshlrev_b32_sdwa v137, v15, v115 dst_sel:DWORD dst_unused:UNUSED_PAD src0_sel:DWORD src1_sel:WORD_1
    ds_read_u16_d16_hi v132, v136 offset:32768
    ds_read_u16_d16_hi v133, v137 offset:32768
    s_and_b32 s33, s62, s34
    buffer_load_dwordx4 v[88:91], v1, s[12:15], s33 offen
    s_waitcnt lgkmcnt(2)
    s_set_gpr_idx_on s56, 0xc
    v_pk_fma_f32 v[16:17], v[128:129], v[96:97], v[16:17] op_sel:[0,0,0] op_sel_hi:[0,1,1]
    v_pk_fma_f32 v[18:19], v[128:129], v[98:99], v[18:19] op_sel:[0,0,0] op_sel_hi:[0,1,1]
    v_pk_fma_f32 v[20:21], v[130:131], v[100:101], v[20:21] op_sel:[0,0,0] op_sel_hi:[0,1,1]
    v_pk_fma_f32 v[22:23], v[130:131], v[102:103], v[22:23] op_sel:[0,0,0] op_sel_hi:[0,1,1]
    s_set_gpr_idx_off
    ds_read_b32 v165, v5
    v_lshlrev_b32_sdwa v138, v15, v118 dst_sel:DWORD dst_unused:UNUSED_PAD src0_sel:DWORD src1_sel:WORD_1
    s_waitcnt vmcnt(4)
    v_mfma_f32_4x4x4_16b_bf16 v[96:99], v[144:145], v[72:73], 0 cbsz:4 abid:2
    v_readlane_b32 s63, v164, 15
    v_mfma_f32_4x4x4_16b_bf16 v[100:103], v[144:145], v[74:75], 0 cbsz:4 abid:2
    v_lshlrev_b32_sdwa v139, v15, v119 dst_sel:DWORD dst_unused:UNUSED_PAD src0_sel:DWORD src1_sel:WORD_1
    ds_read_u16_d16_hi v134, v138 offset:32768
    ds_read_u16_d16_hi v135, v139 offset:32768
    s_and_b32 s33, s63, s34
    buffer_load_dwordx4 v[92:95], v1, s[12:15], s33 offen
    s_set_gpr_idx_on s57, 0xc
    v_pk_fma_f32 v[16:17], v[128:129], v[104:105], v[16:17] op_sel:[1,0,0] op_sel_hi:[1,1,1]
    v_pk_fma_f32 v[18:19], v[128:129], v[106:107], v[18:19] op_sel:[1,0,0] op_sel_hi:[1,1,1]
    v_pk_fma_f32 v[20:21], v[130:131], v[108:109], v[20:21] op_sel:[1,0,0] op_sel_hi:[1,1,1]
    v_pk_fma_f32 v[22:23], v[130:131], v[110:111], v[22:23] op_sel:[1,0,0] op_sel_hi:[1,1,1]
    s_set_gpr_idx_off
    v_mfma_f32_4x4x4_16b_bf16 v[112:115], v[172:173], v[176:177], 0 cbsz:4 abid:4
    v_lshlrev_b32_sdwa v136, v15, v120 dst_sel:DWORD dst_unused:UNUSED_PAD src0_sel:DWORD src1_sel:WORD_1
    s_waitcnt vmcnt(4)
    v_mfma_f32_4x4x4_16b_bf16 v[104:107], v[146:147], v[76:77], 0 cbsz:4 abid:2
    v_readlane_b32 s48, v164, 16
    v_mfma_f32_4x4x4_16b_bf16 v[108:111], v[146:147], v[78:79], 0 cbsz:4 abid:2
    v_lshlrev_b32_sdwa v137, v15, v121 dst_sel:DWORD dst_unused:UNUSED_PAD src0_sel:DWORD src1_sel:WORD_1
    ds_read_u16_d16_hi v128, v136 offset:32768
    ds_read_u16_d16_hi v129, v137 offset:32768
    s_and_b32 s33, s48, s34
    buffer_load_dwordx4 v[64:67], v1, s[12:15], s33 offen
    s_waitcnt lgkmcnt(2)
    s_set_gpr_idx_on s58, 0xc
    v_pk_fma_f32 v[16:17], v[132:133], v[96:97], v[16:17] op_sel:[0,0,0] op_sel_hi:[0,1,1]
    v_pk_fma_f32 v[18:19], v[132:133], v[98:99], v[18:19] op_sel:[0,0,0] op_sel_hi:[0,1,1]
    v_pk_fma_f32 v[20:21], v[134:135], v[100:101], v[20:21] op_sel:[0,0,0] op_sel_hi:[0,1,1]
    v_pk_fma_f32 v[22:23], v[134:135], v[102:103], v[22:23] op_sel:[0,0,0] op_sel_hi:[0,1,1]
    s_set_gpr_idx_off
    v_lshlrev_b32_sdwa v138, v15, v124 dst_sel:DWORD dst_unused:UNUSED_PAD src0_sel:DWORD src1_sel:WORD_1
    s_waitcnt vmcnt(4)
    v_mfma_f32_4x4x4_16b_bf16 v[96:99], v[140:141], v[80:81], 0 cbsz:4 abid:3
    v_readlane_b32 s49, v164, 17
    v_mfma_f32_4x4x4_16b_bf16 v[100:103], v[140:141], v[82:83], 0 cbsz:4 abid:3
    v_lshlrev_b32_sdwa v139, v15, v125 dst_sel:DWORD dst_unused:UNUSED_PAD src0_sel:DWORD src1_sel:WORD_1
    ds_read_u16_d16_hi v130, v138 offset:32768
    ds_read_u16_d16_hi v131, v139 offset:32768
    s_and_b32 s33, s49, s34
    buffer_load_dwordx4 v[68:71], v1, s[12:15], s33 offen
    s_set_gpr_idx_on s59, 0xc
    v_pk_fma_f32 v[16:17], v[132:133], v[104:105], v[16:17] op_sel:[1,0,0] op_sel_hi:[1,1,1]
    v_pk_fma_f32 v[18:19], v[132:133], v[106:107], v[18:19] op_sel:[1,0,0] op_sel_hi:[1,1,1]
    v_pk_fma_f32 v[20:21], v[134:135], v[108:109], v[20:21] op_sel:[1,0,0] op_sel_hi:[1,1,1]
    v_pk_fma_f32 v[22:23], v[134:135], v[110:111], v[22:23] op_sel:[1,0,0] op_sel_hi:[1,1,1]
    s_set_gpr_idx_off
A_12:
    s_sub_u32 s31, s31, 4
    s_cbranch_scc1 B_12
    v_mfma_f32_4x4x4_16b_bf16 v[116:119], v[172:173], v[178:179], 0 cbsz:4 abid:4
    v_lshlrev_b32_sdwa v136, v15, v122 dst_sel:DWORD dst_unused:UNUSED_PAD src0_sel:DWORD src1_sel:WORD_1
    s_waitcnt vmcnt(4)
    v_mfma_f32_4x4x4_16b_bf16 v[104:107], v[142:143], v[84:85], 0 cbsz:4 abid:3
    v_readlane_b32 s50, v164, 18
    v_mfma_f32_4x4x4_16b_bf16 v[108:111], v[142:143], v[86:87], 0 cbsz:4 abid:3
    v_lshlrev_b32_sdwa v137, v15, v123 dst_sel:DWORD dst_unused:UNUSED_PAD src0_sel:DWORD src1_sel:WORD_1
    ds_read_u16_d16_hi v132, v136 offset:32768
    ds_read_u16_d16_hi v133, v137 offset:32768
    s_and_b32 s33, s50, s34
    buffer_load_dwordx4 v[72:75], v1, s[12:15], s33 offen
    s_waitcnt lgkmcnt(2)
    s_set_gpr_idx_on s60, 0xc
    v_pk_fma_f32 v[16:17], v[128:129], v[96:97], v[16:17] op_sel:[0,0,0] op_sel_hi:[0,1,1]
    v_pk_fma_f32 v[18:19], v[128:129], v[98:99], v[18:19] op_sel:[0,0,0] op_sel_hi:[0,1,1]
    v_pk_fma_f32 v[20:21], v[130:131], v[100:101], v[20:21] op_sel:[0,0,0] op_sel_hi:[0,1,1]
    v_pk_fma_f32 v[22:23], v[130:131], v[102:103], v[22:23] op_sel:[0,0,0] op_sel_hi:[0,1,1]
    s_set_gpr_idx_off
    v_cmp_gt_u32 vcc, s30, v6
    v_add_u32 v6, 64, v6
    v_add_u32 v5, 256, v5
    v_cndmask_b32 v165, 40, v165, vcc
    v_lshrrev_b32 v8, 21, v165
    v_lshlrev_b32 v8, 4, v8
    v_lshlrev_b32 v9, 3, v165
    ds_read_b128 v[168:171], v8 offset:8192
    v_and_b32 v9, 0xfffc00, v9
    v_and_or_b32 v165, v165, 56, v9
    v_lshlrev_b32_sdwa v138, v15, v126 dst_sel:DWORD dst_unused:UNUSED_PAD src0_sel:DWORD src1_sel:WORD_1
    s_waitcnt vmcnt(4)
    v_mfma_f32_4x4x4_16b_bf16 v[96:99], v[144:145], v[88:89], 0 cbsz:4 abid:3
    v_readlane_b32 s51, v164, 19
    v_mfma_f32_4x4x4_16b_bf16 v[100:103], v[144:145], v[90:91], 0 cbsz:4 abid:3
    v_lshlrev_b32_sdwa v139, v15, v127 dst_sel:DWORD dst_unused:UNUSED_PAD src0_sel:DWORD src1_sel:WORD_1
    ds_read_u16_d16_hi v134, v138 offset:32768
    ds_read_u16_d16_hi v135, v139 offset:32768
    s_and_b32 s33, s51, s34
    buffer_load_dwordx4 v[76:79], v1, s[12:15], s33 offen
    s_set_gpr_idx_on s61, 0xc
    v_pk_fma_f32 v[16:17], v[128:129], v[104:105], v[16:17] op_sel:[1,0,0] op_sel_hi:[1,1,1]
    v_pk_fma_f32 v[18:19], v[128:129], v[106:107], v[18:19] op_sel:[1,0,0] op_sel_hi:[1,1,1]
    v_pk_fma_f32 v[20:21], v[130:131], v[108:109], v[20:21] op_sel:[1,0,0] op_sel_hi:[1,1,1]
    v_pk_fma_f32 v[22:23], v[130:131], v[110:111], v[22:23] op_sel:[1,0,0] op_sel_hi:[1,1,1]
    s_set_gpr_idx_off
    v_mfma_f32_4x4x4_16b_bf16 v[120:123], v[172:173], v[176:177], 0 cbsz:4 abid:5
    v_lshlrev_b32_sdwa v136, v15, v112 dst_sel:DWORD dst_unused:UNUSED_PAD src0_sel:DWORD src1_sel:WORD_1
    s_waitcnt vmcnt(4)
    v_mfma_f32_4x4x4_16b_bf16 v[104:107], v[146:147], v[92:93], 0 cbsz:4 abid:3
    v_readlane_b32 s52, v164, 20
    v_mfma_f32_4x4x4_16b_bf16 v[108:111], v[146:147], v[94:95], 0 cbsz:4 abid:3
    v_lshlrev_b32_sdwa v137, v15, v113 dst_sel:DWORD dst_unused:UNUSED_PAD src0_sel:DWORD src1_sel:WORD_1
    ds_read_u16_d16_hi v128, v136 offset:32768
    ds_read_u16_d16_hi v129, v137 offset:32768
    s_and_b32 s33, s52, s34
    buffer_load_dwordx4 v[80:83], v1, s[12:15], s33 offen
    s_waitcnt lgkmcnt(2)
    s_set_gpr_idx_on s62, 0xc
    v_pk_fma_f32 v[16:17], v[132:133], v[96:97], v[16:17] op_sel:[0,0,0] op_sel_hi:[0,1,1]
    v_pk_fma_f32 v[18:19], v[132:133], v[98:99], v[18:19] op_sel:[0,0,0] op_sel_hi:[0,1,1]
    v_pk_fma_f32 v[20:21], v[134:135], v[100:101], v[20:21] op_sel:[0,0,0] op_sel_hi:[0,1,1]
    v_pk_fma_f32 v[22:23], v[134:135], v[102:103], v[22:23] op_sel:[0,0,0] op_sel_hi:[0,1,1]
    s_set_gpr_idx_off
    v_lshlrev_b32_sdwa v138, v15, v116 dst_sel:DWORD dst_unused:UNUSED_PAD src0_sel:DWORD src1_sel:WORD_1
    s_waitcnt vmcnt(4)
    v_mfma_f32_4x4x4_16b_bf16 v[96:99], v[140:141], v[64:65], 0 cbsz:4 abid:4
    v_readlane_b32 s53, v164, 21
    v_mfma_f32_4x4x4_16b_bf16 v[100:103], v[140:141], v[66:67], 0 cbsz:4 abid:4
    v_lshlrev_b32_sdwa v139, v15, v117 dst_sel:DWORD dst_unused:UNUSED_PAD src0_sel:DWORD src1_sel:WORD_1
    ds_read_u16_d16_hi v130, v138 offset:32768
    ds_read_u16_d16_hi v131, v139 offset:32768
    s_and_b32 s33, s53, s34
    buffer_load_dwordx4 v[84:87], v1, s[12:15], s33 offen
    s_set_gpr_idx_on s63, 0xc
    v_pk_fma_f32 v[16:17], v[132:133], v[104:105], v[16:17] op_sel:[1,0,0] op_sel_hi:[1,1,1]
    v_pk_fma_f32 v[18:19], v[132:133], v[106:107], v[18:19] op_sel:[1,0,0] op_sel_hi:[1,1,1]
    v_pk_fma_f32 v[20:21], v[134:135], v[108:109], v[20:21] op_sel:[1,0,0] op_sel_hi:[1,1,1]
    v_pk_fma_f32 v[22:23], v[134:135], v[110:111], v[22:23] op_sel:[1,0,0] op_sel_hi:[1,1,1]
    s_set_gpr_idx_off
A_16:
    s_sub_u32 s31, s31, 4
    s_cbranch_scc1 B_16
    v_mfma_f32_4x4x4_16b_bf16 v[124:127], v[172:173], v[178:179], 0 cbsz:4 abid:5
    v_lshlrev_b32_sdwa v136, v15, v114 dst_sel:DWORD dst_unused:UNUSED_PAD src0_sel:DWORD src1_sel:WORD_1
    s_waitcnt vmcnt(4)
    v_mfma_f32_4x4x4_16b_bf16 v[104:107], v[142:143], v[68:69], 0 cbsz:4 abid:4
    v_readlane_b32 s54, v164, 22
    v_mfma_f32_4x4x4_16b_bf16 v[108:111], v[142:143], v[70:71], 0 cbsz:4 abid:4
    v_lshlrev_b32_sdwa v137, v15, v115 dst_sel:DWORD dst_unused:UNUSED_PAD src0_sel:DWORD src1_sel:WORD_1
    ds_read_u16_d16_hi v132, v136 offset:32768
    ds_read_u16_d16_hi v133, v137 offset:32768
    s_and_b32 s33, s54, s34
    buffer_load_dwordx4 v[88:91], v1, s[12:15], s33 offen
    s_waitcnt lgkmcnt(2)
    s_set_gpr_idx_on s48, 0xc
    v_pk_fma_f32 v[16:17], v[128:129], v[96:97], v[16:17] op_sel:[0,0,0] op_sel_hi:[0,1,1]
    v_pk_fma_f32 v[18:19], v[128:129], v[98:99], v[18:19] op_sel:[0,0,0] op_sel_hi:[0,1,1]
    v_pk_fma_f32 v[20:21], v[130:131], v[100:101], v[20:21] op_sel:[0,0,0] op_sel_hi:[0,1,1]
    v_pk_fma_f32 v[22:23], v[130:131], v[102:103], v[22:23] op_sel:[0,0,0] op_sel_hi:[0,1,1]
    s_set_gpr_idx_off
    v_lshlrev_b32_sdwa v138, v15, v118 dst_sel:DWORD dst_unused:UNUSED_PAD src0_sel:DWORD src1_sel:WORD_1
    s_waitcnt vmcnt(4)
    v_mfma_f32_4x4x4_16b_bf16 v[96:99], v[144:145], v[72:73], 0 cbsz:4 abid:4
    v_readlane_b32 s55, v164, 23
    v_mfma_f32_4x4x4_16b_bf16 v[100:103], v[144:145], v[74:75], 0 cbsz:4 abid:4
    v_lshlrev_b32_sdwa v139, v15, v119 dst_sel:DWORD dst_unused:UNUSED_PAD src0_sel:DWORD src1_sel:WORD_1
    ds_read_u16_d16_hi v134, v138 offset:32768
    ds_read_u16_d16_hi v135, v139 offset:32768
    s_and_b32 s33, s55, s34
    buffer_load_dwordx4 v[92:95], v1, s[12:15], s33 offen
    s_set_gpr_idx_on s49, 0xc
    v_pk_fma_f32 v[16:17], v[128:129], v[104:105], v[16:17] op_sel:[1,0,0] op_sel_hi:[1,1,1]
    v_pk_fma_f32 v[18:19], v[128:129], v[106:107], v[18:19] op_sel:[1,0,0] op_sel_hi:[1,1,1]
    v_pk_fma_f32 v[20:21], v[130:131], v[108:109], v[20:21] op_sel:[1,0,0] op_sel_hi:[1,1,1]
    v_pk_fma_f32 v[22:23], v[130:131], v[110:111], v[22:23] op_sel:[1,0,0] op_sel_hi:[1,1,1]
    s_set_gpr_idx_off
    v_mfma_f32_4x4x4_16b_bf16 v[112:115], v[172:173], v[176:177], 0 cbsz:4 abid:6
    v_lshlrev_b32_sdwa v136, v15, v120 dst_sel:DWORD dst_unused:UNUSED_PAD src0_sel:DWORD src1_sel:WORD_1
    s_waitcnt vmcnt(4)
    v_mfma_f32_4x4x4_16b_bf16 v[104:107], v[146:147], v[76:77], 0 cbsz:4 abid:4
    v_readlane_b32 s56, v164, 24
    v_mfma_f32_4x4x4_16b_bf16 v[108:111], v[146:147], v[78:79], 0 cbsz:4 abid:4
    v_lshlrev_b32_sdwa v137, v15, v121 dst_sel:DWORD dst_unused:UNUSED_PAD src0_sel:DWORD src1_sel:WORD_1
    ds_read_u16_d16_hi v128, v136 offset:32768
    ds_read_u16_d16_hi v129, v137 offset:32768
    s_and_b32 s33, s56, s34
    buffer_load_dwordx4 v[64:67], v1, s[12:15], s33 offen
    s_waitcnt lgkmcnt(2)
    s_set_gpr_idx_on s50, 0xc
    v_pk_fma_f32 v[16:17], v[132:133], v[96:97], v[16:17] op_sel:[0,0,0] op_sel_hi:[0,1,1]
    v_pk_fma_f32 v[18:19], v[132:133], v[98:99], v[18:19] op_sel:[0,0,0] op_sel_hi:[0,1,1]
    v_pk_fma_f32 v[20:21], v[134:135], v[100:101], v[20:21] op_sel:[0,0,0] op_sel_hi:[0,1,1]
    v_pk_fma_f32 v[22:23], v[134:135], v[102:103], v[22:23] op_sel:[0,0,0] op_sel_hi:[0,1,1]
    s_set_gpr_idx_off
    v_lshlrev_b32_sdwa v138, v15, v124 dst_sel:DWORD dst_unused:UNUSED_PAD src0_sel:DWORD src1_sel:WORD_1
    s_waitcnt vmcnt(4)
    v_mfma_f32_4x4x4_16b_bf16 v[96:99], v[140:141], v[80:81], 0 cbsz:4 abid:5
    v_readlane_b32 s57, v164, 25
    v_mfma_f32_4x4x4_16b_bf16 v[100:103], v[140:141], v[82:83], 0 cbsz:4 abid:5
    v_lshlrev_b32_sdwa v139, v15, v125 dst_sel:DWORD dst_unused:UNUSED_PAD src0_sel:DWORD src1_sel:WORD_1
    ds_read_u16_d16_hi v130, v138 offset:32768
    ds_read_u16_d16_hi v131, v139 offset:32768
    s_and_b32 s33, s57, s34
    buffer_load_dwordx4 v[68:71], v1, s[12:15], s33 offen
    s_set_gpr_idx_on s51, 0xc
    v_pk_fma_f32 v[16:17], v[132:133], v[104:105], v[16:17] op_sel:[1,0,0] op_sel_hi:[1,1,1]
    v_pk_fma_f32 v[18:19], v[132:133], v[106:107], v[18:19] op_sel:[1,0,0] op_sel_hi:[1,1,1]
    v_pk_fma_f32 v[20:21], v[134:135], v[108:109], v[20:21] op_sel:[1,0,0] op_sel_hi:[1,1,1]
    v_pk_fma_f32 v[22:23], v[134:135], v[110:111], v[22:23] op_sel:[1,0,0] op_sel_hi:[1,1,1]
    s_set_gpr_idx_off
A_20:
    s_sub_u32 s31, s31, 4
    s_cbranch_scc1 B_20
    v_mfma_f32_4x4x4_16b_bf16 v[116:119], v[172:173], v[178:179], 0 cbsz:4 abid:6
    v_lshlrev_b32_sdwa v136, v15, v122 dst_sel:DWORD dst_unused:UNUSED_PAD src0_sel:DWORD src1_sel:WORD_1
    s_waitcnt vmcnt(4)
    v_mfma_f32_4x4x4_16b_bf16 v[104:107], v[142:143], v[84:85], 0 cbsz:4 abid:5
    v_readlane_b32 s58, v164, 26
    v_mfma_f32_4x4x4_16b_bf16 v[108:111], v[142:143], v[86:87], 0 cbsz:4 abid:5
    v_lshlrev_b32_sdwa v137, v15, v123 dst_sel:DWORD dst_unused:UNUSED_PAD src0_sel:DWORD src1_sel:WORD_1
    ds_read_u16_d16_hi v132, v136 offset:32768
    ds_read_u16_d16_hi v133, v137 offset:32768
    s_and_b32 s33, s58, s34
    buffer_load_dwordx4 v[72:75], v1, s[12:15], s33 offen
    s_waitcnt lgkmcnt(2)
    s_set_gpr_idx_on s52, 0xc
    v_pk_fma_f32 v[16:17], v[128:129], v[96:97], v[16:17] op_sel:[0,0,0] op_sel_hi:[0,1,1]
    v_pk_fma_f32 v[18:19], v[128:129], v[98:99], v[18:19] op_sel:[0,0,0] op_sel_hi:[0,1,1]
    v_pk_fma_f32 v[20:21], v[130:131], v[100:101], v[20:21] op_sel:[0,0,0] op_sel_hi:[0,1,1]
    v_pk_fma_f32 v[22:23], v[130:131], v[102:103], v[22:23] op_sel:[0,0,0] op_sel_hi:[0,1,1]
    s_set_gpr_idx_off
    v_lshlrev_b32_sdwa v138, v15, v126 dst_sel:DWORD dst_unused:UNUSED_PAD src0_sel:DWORD src1_sel:WORD_1
    s_waitcnt vmcnt(4)
    v_mfma_f32_4x4x4_16b_bf16 v[96:99], v[144:145], v[88:89], 0 cbsz:4 abid:5
    v_readlane_b32 s59, v164, 27
    v_mfma_f32_4x4x4_16b_bf16 v[100:103], v[144:145], v[90:91], 0 cbsz:4 abid:5
    v_lshlrev_b32_sdwa v139, v15, v127 dst_sel:DWORD dst_unused:UNUSED_PAD src0_sel:DWORD src1_sel:WORD_1
    ds_read_u16_d16_hi v134, v138 offset:32768
    ds_read_u16_d16_hi v135, v139 offset:32768
    s_and_b32 s33, s59, s34
    buffer_load_dwordx4 v[76:79], v1, s[12:15], s33 offen
    s_set_gpr_idx_on s53, 0xc
    v_pk_fma_f32 v[16:17], v[128:129], v[104:105], v[16:17] op_sel:[1,0,0] op_sel_hi:[1,1,1]
    v_pk_fma_f32 v[18:19], v[128:129], v[106:107], v[18:19] op_sel:[1,0,0] op_sel_hi:[1,1,1]
    v_pk_fma_f32 v[20:21], v[130:131], v[108:109], v[20:21] op_sel:[1,0,0] op_sel_hi:[1,1,1]
    v_pk_fma_f32 v[22:23], v[130:131], v[110:111], v[22:23] op_sel:[1,0,0] op_sel_hi:[1,1,1]
    s_set_gpr_idx_off
    v_mfma_f32_4x4x4_16b_bf16 v[120:123], v[172:173], v[176:177], 0 cbsz:4 abid:7
    v_lshlrev_b32_sdwa v136, v15, v112 dst_sel:DWORD dst_unused:UNUSED_PAD src0_sel:DWORD src1_sel:WORD_1
    s_waitcnt vmcnt(4)
    v_mfma_f32_4x4x4_16b_bf16 v[104:107], v[146:147], v[92:93], 0 cbsz:4 abid:5
    v_readlane_b32 s60, v164, 28
    v_mfma_f32_4x4x4_16b_bf16 v[108:111], v[146:147], v[94:95], 0 cbsz:4 abid:5
    v_lshlrev_b32_sdwa v137, v15, v113 dst_sel:DWORD dst_unused:UNUSED_PAD src0_sel:DWORD src1_sel:WORD_1
    ds_read_u16_d16_hi v128, v136 offset:32768
    ds_read_u16_d16_hi v129, v137 offset:32768
    s_and_b32 s33, s60, s34
    buffer_load_dwordx4 v[80:83], v1, s[12:15], s33 offen
    s_waitcnt lgkmcnt(2)
    s_set_gpr_idx_on s54, 0xc
    v_pk_fma_f32 v[16:17], v[132:133], v[96:97], v[16:17] op_sel:[0,0,0] op_sel_hi:[0,1,1]
    v_pk_fma_f32 v[18:19], v[132:133], v[98:99], v[18:19] op_sel:[0,0,0] op_sel_hi:[0,1,1]
    v_pk_fma_f32 v[20:21], v[134:135], v[100:101], v[20:21] op_sel:[0,0,0] op_sel_hi:[0,1,1]
    v_pk_fma_f32 v[22:23], v[134:135], v[102:103], v[22:23] op_sel:[0,0,0] op_sel_hi:[0,1,1]
    s_set_gpr_idx_off
    v_lshlrev_b32_sdwa v138, v15, v116 dst_sel:DWORD dst_unused:UNUSED_PAD src0_sel:DWORD src1_sel:WORD_1
    s_waitcnt vmcnt(4)
    v_mfma_f32_4x4x4_16b_bf16 v[96:99], v[140:141], v[64:65], 0 cbsz:4 abid:6
    v_readlane_b32 s61, v164, 29
    v_mfma_f32_4x4x4_16b_bf16 v[100:103], v[140:141], v[66:67], 0 cbsz:4 abid:6
    v_lshlrev_b32_sdwa v139, v15, v117 dst_sel:DWORD dst_unused:UNUSED_PAD src0_sel:DWORD src1_sel:WORD_1
    ds_read_u16_d16_hi v130, v138 offset:32768
    ds_read_u16_d16_hi v131, v139 offset:32768
    s_and_b32 s33, s61, s34
    buffer_load_dwordx4 v[84:87], v1, s[12:15], s33 offen
    s_set_gpr_idx_on s55, 0xc
    v_pk_fma_f32 v[16:17], v[132:133], v[104:105], v[16:17] op_sel:[1,0,0] op_sel_hi:[1,1,1]
    v_pk_fma_f32 v[18:19], v[132:133], v[106:107], v[18:19] op_sel:[1,0,0] op_sel_hi:[1,1,1]
    v_pk_fma_f32 v[20:21], v[134:135], v[108:109], v[20:21] op_sel:[1,0,0] op_sel_hi:[1,1,1]
    v_pk_fma_f32 v[22:23], v[134:135], v[110:111], v[22:23] op_sel:[1,0,0] op_sel_hi:[1,1,1]
    s_set_gpr_idx_off
A_24:
    s_sub_u32 s31, s31, 4
    s_cbranch_scc1 B_24
    v_mfma_f32_4x4x4_16b_bf16 v[124:127], v[172:173], v[178:179], 0 cbsz:4 abid:7
    v_lshlrev_b32_sdwa v136, v15, v114 dst_sel:DWORD dst_unused:UNUSED_PAD src0_sel:DWORD src1_sel:WORD_1
    s_waitcnt vmcnt(4)
    v_mfma_f32_4x4x4_16b_bf16 v[104:107], v[142:143], v[68:69], 0 cbsz:4 abid:6
    v_readlane_b32 s62, v164, 30
    v_mfma_f32_4x4x4_16b_bf16 v[108:111], v[142:143], v[70:71], 0 cbsz:4 abid:6
    v_lshlrev_b32_sdwa v137, v15, v115 dst_sel:DWORD dst_unused:UNUSED_PAD src0_sel:DWORD src1_sel:WORD_1
    ds_read_u16_d16_hi v132, v136 offset:32768
    ds_read_u16_d16_hi v133, v137 offset:32768
    s_and_b32 s33, s62, s34
    buffer_load_dwordx4 v[88:91], v1, s[12:15], s33 offen
    s_waitcnt lgkmcnt(2)
    s_set_gpr_idx_on s56, 0xc
    v_pk_fma_f32 v[16:17], v[128:129], v[96:97], v[16:17] op_sel:[0,0,0] op_sel_hi:[0,1,1]
    v_pk_fma_f32 v[18:19], v[128:129], v[98:99], v[18:19] op_sel:[0,0,0] op_sel_hi:[0,1,1]
    v_pk_fma_f32 v[20:21], v[130:131], v[100:101], v[20:21] op_sel:[0,0,0] op_sel_hi:[0,1,1]
    v_pk_fma_f32 v[22:23], v[130:131], v[102:103], v[22:23] op_sel:[0,0,0] op_sel_hi:[0,1,1]
    s_set_gpr_idx_off
    v_lshlrev_b32_sdwa v138, v15, v118 dst_sel:DWORD dst_unused:UNUSED_PAD src0_sel:DWORD src1_sel:WORD_1
    s_waitcnt vmcnt(4)
    v_mfma_f32_4x4x4_16b_bf16 v[96:99], v[144:145], v[72:73], 0 cbsz:4 abid:6
    v_readlane_b32 s63, v164, 31
    v_mfma_f32_4x4x4_16b_bf16 v[100:103], v[144:145], v[74:75], 0 cbsz:4 abid:6
    v_lshlrev_b32_sdwa v139, v15, v119 dst_sel:DWORD dst_unused:UNUSED_PAD src0_sel:DWORD src1_sel:WORD_1
    ds_read_u16_d16_hi v134, v138 offset:32768
    ds_read_u16_d16_hi v135, v139 offset:32768
    s_and_b32 s33, s63, s34
    buffer_load_dwordx4 v[92:95], v1, s[12:15], s33 offen
    s_set_gpr_idx_on s57, 0xc
    v_pk_fma_f32 v[16:17], v[128:129], v[104:105], v[16:17] op_sel:[1,0,0] op_sel_hi:[1,1,1]
    v_pk_fma_f32 v[18:19], v[128:129], v[106:107], v[18:19] op_sel:[1,0,0] op_sel_hi:[1,1,1]
    v_pk_fma_f32 v[20:21], v[130:131], v[108:109], v[20:21] op_sel:[1,0,0] op_sel_hi:[1,1,1]
    v_pk_fma_f32 v[22:23], v[130:131], v[110:111], v[22:23] op_sel:[1,0,0] op_sel_hi:[1,1,1]
    s_set_gpr_idx_off
    v_mfma_f32_4x4x4_16b_bf16 v[112:115], v[172:173], v[176:177], 0 cbsz:4 abid:8
    v_lshlrev_b32_sdwa v136, v15, v120 dst_sel:DWORD dst_unused:UNUSED_PAD src0_sel:DWORD src1_sel:WORD_1
    s_waitcnt vmcnt(4)
    v_mfma_f32_4x4x4_16b_bf16 v[104:107], v[146:147], v[76:77], 0 cbsz:4 abid:6
    v_readlane_b32 s48, v164, 32
    v_mfma_f32_4x4x4_16b_bf16 v[108:111], v[146:147], v[78:79], 0 cbsz:4 abid:6
    v_lshlrev_b32_sdwa v137, v15, v121 dst_sel:DWORD dst_unused:UNUSED_PAD src0_sel:DWORD src1_sel:WORD_1
    ds_read_u16_d16_hi v128, v136 offset:32768
    ds_read_u16_d16_hi v129, v137 offset:32768
    s_and_b32 s33, s48, s34
    buffer_load_dwordx4 v[64:67], v1, s[12:15], s33 offen
    s_waitcnt lgkmcnt(2)
    s_set_gpr_idx_on s58, 0xc
    v_pk_fma_f32 v[16:17], v[132:133], v[96:97], v[16:17] op_sel:[0,0,0] op_sel_hi:[0,1,1]
    v_pk_fma_f32 v[18:19], v[132:133], v[98:99], v[18:19] op_sel:[0,0,0] op_sel_hi:[0,1,1]
    v_pk_fma_f32 v[20:21], v[134:135], v[100:101], v[20:21] op_sel:[0,0,0] op_sel_hi:[0,1,1]
    v_pk_fma_f32 v[22:23], v[134:135], v[102:103], v[22:23] op_sel:[0,0,0] op_sel_hi:[0,1,1]
    s_set_gpr_idx_off
    v_lshlrev_b32_sdwa v138, v15, v124 dst_sel:DWORD dst_unused:UNUSED_PAD src0_sel:DWORD src1_sel:WORD_1
    s_waitcnt vmcnt(4)
    v_mfma_f32_4x4x4_16b_bf16 v[96:99], v[140:141], v[80:81], 0 cbsz:4 abid:7
    v_readlane_b32 s49, v164, 33
    v_mfma_f32_4x4x4_16b_bf16 v[100:103], v[140:141], v[82:83], 0 cbsz:4 abid:7
    v_lshlrev_b32_sdwa v139, v15, v125 dst_sel:DWORD dst_unused:UNUSED_PAD src0_sel:DWORD src1_sel:WORD_1
    ds_read_u16_d16_hi v130, v138 offset:32768
    ds_read_u16_d16_hi v131, v139 offset:32768
    s_and_b32 s33, s49, s34
    buffer_load_dwordx4 v[68:71], v1, s[12:15], s33 offen
    s_set_gpr_idx_on s59, 0xc
    v_pk_fma_f32 v[16:17], v[132:133], v[104:105], v[16:17] op_sel:[1,0,0] op_sel_hi:[1,1,1]
    v_pk_fma_f32 v[18:19], v[132:133], v[106:107], v[18:19] op_sel:[1,0,0] op_sel_hi:[1,1,1]
    v_pk_fma_f32 v[20:21], v[134:135], v[108:109], v[20:21] op_sel:[1,0,0] op_sel_hi:[1,1,1]
    v_pk_fma_f32 v[22:23], v[134:135], v[110:111], v[22:23] op_sel:[1,0,0] op_sel_hi:[1,1,1]
    s_set_gpr_idx_off
A_28:
    s_sub_u32 s31, s31, 4
    s_cbranch_scc1 B_28
    v_mfma_f32_4x4x4_16b_bf16 v[116:119], v[172:173], v[178:179], 0 cbsz:4 abid:8
    v_lshlrev_b32_sdwa v136, v15, v122 dst_sel:DWORD dst_unused:UNUSED_PAD src0_sel:DWORD src1_sel:WORD_1
    s_waitcnt vmcnt(4)
    v_mfma_f32_4x4x4_16b_bf16 v[104:107], v[142:143], v[84:85], 0 cbsz:4 abid:7
    v_readlane_b32 s50, v164, 34
    v_mfma_f32_4x4x4_16b_bf16 v[108:111], v[142:143], v[86:87], 0 cbsz:4 abid:7
    v_lshlrev_b32_sdwa v137, v15, v123 dst_sel:DWORD dst_unused:UNUSED_PAD src0_sel:DWORD src1_sel:WORD_1
    ds_read_u16_d16_hi v132, v136 offset:32768
    ds_read_u16_d16_hi v133, v137 offset:32768
    s_and_b32 s33, s50, s34
    buffer_load_dwordx4 v[72:75], v1, s[12:15], s33 offen
    s_waitcnt lgkmcnt(2)
    s_set_gpr_idx_on s60, 0xc
    v_pk_fma_f32 v[16:17], v[128:129], v[96:97], v[16:17] op_sel:[0,0,0] op_sel_hi:[0,1,1]
    v_pk_fma_f32 v[18:19], v[128:129], v[98:99], v[18:19] op_sel:[0,0,0] op_sel_hi:[0,1,1]
    v_pk_fma_f32 v[20:21], v[130:131], v[100:101], v[20:21] op_sel:[0,0,0] op_sel_hi:[0,1,1]
    v_pk_fma_f32 v[22:23], v[130:131], v[102:103], v[22:23] op_sel:[0,0,0] op_sel_hi:[0,1,1]
    s_set_gpr_idx_off
    v_lshlrev_b32_sdwa v138, v15, v126 dst_sel:DWORD dst_unused:UNUSED_PAD src0_sel:DWORD src1_sel:WORD_1
    s_waitcnt vmcnt(4)
    v_mfma_f32_4x4x4_16b_bf16 v[96:99], v[144:145], v[88:89], 0 cbsz:4 abid:7
    v_readlane_b32 s51, v164, 35
    v_mfma_f32_4x4x4_16b_bf16 v[100:103], v[144:145], v[90:91], 0 cbsz:4 abid:7
    v_lshlrev_b32_sdwa v139, v15, v127 dst_sel:DWORD dst_unused:UNUSED_PAD src0_sel:DWORD src1_sel:WORD_1
    ds_read_u16_d16_hi v134, v138 offset:32768
    ds_read_u16_d16_hi v135, v139 offset:32768
    s_and_b32 s33, s51, s34
    buffer_load_dwordx4 v[76:79], v1, s[12:15], s33 offen
    s_set_gpr_idx_on s61, 0xc
    v_pk_fma_f32 v[16:17], v[128:129], v[104:105], v[16:17] op_sel:[1,0,0] op_sel_hi:[1,1,1]
    v_pk_fma_f32 v[18:19], v[128:129], v[106:107], v[18:19] op_sel:[1,0,0] op_sel_hi:[1,1,1]
    v_pk_fma_f32 v[20:21], v[130:131], v[108:109], v[20:21] op_sel:[1,0,0] op_sel_hi:[1,1,1]
    v_pk_fma_f32 v[22:23], v[130:131], v[110:111], v[22:23] op_sel:[1,0,0] op_sel_hi:[1,1,1]
    s_set_gpr_idx_off
    v_mfma_f32_4x4x4_16b_bf16 v[120:123], v[172:173], v[176:177], 0 cbsz:4 abid:9
    v_lshlrev_b32_sdwa v136, v15, v112 dst_sel:DWORD dst_unused:UNUSED_PAD src0_sel:DWORD src1_sel:WORD_1
    s_waitcnt vmcnt(4)
    v_mfma_f32_4x4x4_16b_bf16 v[104:107], v[146:147], v[92:93], 0 cbsz:4 abid:7
    v_readlane_b32 s52, v164, 36
    v_mfma_f32_4x4x4_16b_bf16 v[108:111], v[146:147], v[94:95], 0 cbsz:4 abid:7
    v_lshlrev_b32_sdwa v137, v15, v113 dst_sel:DWORD dst_unused:UNUSED_PAD src0_sel:DWORD src1_sel:WORD_1
    ds_read_u16_d16_hi v128, v136 offset:32768
    ds_read_u16_d16_hi v129, v137 offset:32768
    s_and_b32 s33, s52, s34
    buffer_load_dwordx4 v[80:83], v1, s[12:15], s33 offen
    s_waitcnt lgkmcnt(2)
    s_set_gpr_idx_on s62, 0xc
    v_pk_fma_f32 v[16:17], v[132:133], v[96:97], v[16:17] op_sel:[0,0,0] op_sel_hi:[0,1,1]
    v_pk_fma_f32 v[18:19], v[132:133], v[98:99], v[18:19] op_sel:[0,0,0] op_sel_hi:[0,1,1]
    v_pk_fma_f32 v[20:21], v[134:135], v[100:101], v[20:21] op_sel:[0,0,0] op_sel_hi:[0,1,1]
    v_pk_fma_f32 v[22:23], v[134:135], v[102:103], v[22:23] op_sel:[0,0,0] op_sel_hi:[0,1,1]
    s_set_gpr_idx_off
    v_lshlrev_b32_sdwa v138, v15, v116 dst_sel:DWORD dst_unused:UNUSED_PAD src0_sel:DWORD src1_sel:WORD_1
    s_waitcnt vmcnt(4)
    v_mfma_f32_4x4x4_16b_bf16 v[96:99], v[140:141], v[64:65], 0 cbsz:4 abid:8
    v_readlane_b32 s53, v164, 37
    v_mfma_f32_4x4x4_16b_bf16 v[100:103], v[140:141], v[66:67], 0 cbsz:4 abid:8
    v_lshlrev_b32_sdwa v139, v15, v117 dst_sel:DWORD dst_unused:UNUSED_PAD src0_sel:DWORD src1_sel:WORD_1
    ds_read_u16_d16_hi v130, v138 offset:32768
    ds_read_u16_d16_hi v131, v139 offset:32768
    s_and_b32 s33, s53, s34
    buffer_load_dwordx4 v[84:87], v1, s[12:15], s33 offen
    s_set_gpr_idx_on s63, 0xc
    v_pk_fma_f32 v[16:17], v[132:133], v[104:105], v[16:17] op_sel:[1,0,0] op_sel_hi:[1,1,1]
    v_pk_fma_f32 v[18:19], v[132:133], v[106:107], v[18:19] op_sel:[1,0,0] op_sel_hi:[1,1,1]
    v_pk_fma_f32 v[20:21], v[134:135], v[108:109], v[20:21] op_sel:[1,0,0] op_sel_hi:[1,1,1]
    v_pk_fma_f32 v[22:23], v[134:135], v[110:111], v[22:23] op_sel:[1,0,0] op_sel_hi:[1,1,1]
    s_set_gpr_idx_off
A_32:
    s_sub_u32 s31, s31, 4
    s_cbranch_scc1 B_32
    v_mfma_f32_4x4x4_16b_bf16 v[124:127], v[172:173], v[178:179], 0 cbsz:4 abid:9
    v_lshlrev_b32_sdwa v136, v15, v114 dst_sel:DWORD dst_unused:UNUSED_PAD src0_sel:DWORD src1_sel:WORD_1
    s_waitcnt vmcnt(4)
    v_mfma_f32_4x4x4_16b_bf16 v[104:107], v[142:143], v[68:69], 0 cbsz:4 abid:8
    v_readlane_b32 s54, v164, 38
    v_mfma_f32_4x4x4_16b_bf16 v[108:111], v[142:143], v[70:71], 0 cbsz:4 abid:8
    v_lshlrev_b32_sdwa v137, v15, v115 dst_sel:DWORD dst_unused:UNUSED_PAD src0_sel:DWORD src1_sel:WORD_1
    ds_read_u16_d16_hi v132, v136 offset:32768
    ds_read_u16_d16_hi v133, v137 offset:32768
    s_and_b32 s33, s54, s34
    buffer_load_dwordx4 v[88:91], v1, s[12:15], s33 offen
    s_waitcnt lgkmcnt(2)
    s_set_gpr_idx_on s48, 0xc
    v_pk_fma_f32 v[16:17], v[128:129], v[96:97], v[16:17] op_sel:[0,0,0] op_sel_hi:[0,1,1]
    v_pk_fma_f32 v[18:19], v[128:129], v[98:99], v[18:19] op_sel:[0,0,0] op_sel_hi:[0,1,1]
    v_pk_fma_f32 v[20:21], v[130:131], v[100:101], v[20:21] op_sel:[0,0,0] op_sel_hi:[0,1,1]
    v_pk_fma_f32 v[22:23], v[130:131], v[102:103], v[22:23] op_sel:[0,0,0] op_sel_hi:[0,1,1]
    s_set_gpr_idx_off
    v_lshlrev_b32_sdwa v138, v15, v118 dst_sel:DWORD dst_unused:UNUSED_PAD src0_sel:DWORD src1_sel:WORD_1
    s_waitcnt vmcnt(4)
    v_mfma_f32_4x4x4_16b_bf16 v[96:99], v[144:145], v[72:73], 0 cbsz:4 abid:8
    v_readlane_b32 s55, v164, 39
    v_mfma_f32_4x4x4_16b_bf16 v[100:103], v[144:145], v[74:75], 0 cbsz:4 abid:8
    v_lshlrev_b32_sdwa v139, v15, v119 dst_sel:DWORD dst_unused:UNUSED_PAD src0_sel:DWORD src1_sel:WORD_1
    ds_read_u16_d16_hi v134, v138 offset:32768
    ds_read_u16_d16_hi v135, v139 offset:32768
    s_and_b32 s33, s55, s34
    buffer_load_dwordx4 v[92:95], v1, s[12:15], s33 offen
    s_set_gpr_idx_on s49, 0xc
    v_pk_fma_f32 v[16:17], v[128:129], v[104:105], v[16:17] op_sel:[1,0,0] op_sel_hi:[1,1,1]
    v_pk_fma_f32 v[18:19], v[128:129], v[106:107], v[18:19] op_sel:[1,0,0] op_sel_hi:[1,1,1]
    v_pk_fma_f32 v[20:21], v[130:131], v[108:109], v[20:21] op_sel:[1,0,0] op_sel_hi:[1,1,1]
    v_pk_fma_f32 v[22:23], v[130:131], v[110:111], v[22:23] op_sel:[1,0,0] op_sel_hi:[1,1,1]
    s_set_gpr_idx_off
    v_mfma_f32_4x4x4_16b_bf16 v[112:115], v[172:173], v[176:177], 0 cbsz:4 abid:10
    v_lshlrev_b32_sdwa v136, v15, v120 dst_sel:DWORD dst_unused:UNUSED_PAD src0_sel:DWORD src1_sel:WORD_1
    s_waitcnt vmcnt(4)
    v_mfma_f32_4x4x4_16b_bf16 v[104:107], v[146:147], v[76:77], 0 cbsz:4 abid:8
    v_readlane_b32 s56, v164, 40
    v_mfma_f32_4x4x4_16b_bf16 v[108:111], v[146:147], v[78:79], 0 cbsz:4 abid:8
    v_lshlrev_b32_sdwa v137, v15, v121 dst_sel:DWORD dst_unused:UNUSED_PAD src0_sel:DWORD src1_sel:WORD_1
    ds_read_u16_d16_hi v128, v136 offset:32768
    ds_read_u16_d16_hi v129, v137 offset:32768
    s_and_b32 s33, s56, s34
    buffer_load_dwordx4 v[64:67], v1, s[12:15], s33 offen
    s_waitcnt lgkmcnt(2)
    s_set_gpr_idx_on s50, 0xc
    v_pk_fma_f32 v[16:17], v[132:133], v[96:97], v[16:17] op_sel:[0,0,0] op_sel_hi:[0,1,1]
    v_pk_fma_f32 v[18:19], v[132:133], v[98:99], v[18:19] op_sel:[0,0,0] op_sel_hi:[0,1,1]
    v_pk_fma_f32 v[20:21], v[134:135], v[100:101], v[20:21] op_sel:[0,0,0] op_sel_hi:[0,1,1]
    v_pk_fma_f32 v[22:23], v[134:135], v[102:103], v[22:23] op_sel:[0,0,0] op_sel_hi:[0,1,1]
    s_set_gpr_idx_off
    v_lshlrev_b32_sdwa v138, v15, v124 dst_sel:DWORD dst_unused:UNUSED_PAD src0_sel:DWORD src1_sel:WORD_1
    s_waitcnt vmcnt(4)
    v_mfma_f32_4x4x4_16b_bf16 v[96:99], v[140:141], v[80:81], 0 cbsz:4 abid:9
    v_readlane_b32 s57, v164, 41
    v_mfma_f32_4x4x4_16b_bf16 v[100:103], v[140:141], v[82:83], 0 cbsz:4 abid:9
    v_lshlrev_b32_sdwa v139, v15, v125 dst_sel:DWORD dst_unused:UNUSED_PAD src0_sel:DWORD src1_sel:WORD_1
    ds_read_u16_d16_hi v130, v138 offset:32768
    ds_read_u16_d16_hi v131, v139 offset:32768
    s_and_b32 s33, s57, s34
    buffer_load_dwordx4 v[68:71], v1, s[12:15], s33 offen
    s_set_gpr_idx_on s51, 0xc
    v_pk_fma_f32 v[16:17], v[132:133], v[104:105], v[16:17] op_sel:[1,0,0] op_sel_hi:[1,1,1]
    v_pk_fma_f32 v[18:19], v[132:133], v[106:107], v[18:19] op_sel:[1,0,0] op_sel_hi:[1,1,1]
    v_pk_fma_f32 v[20:21], v[134:135], v[108:109], v[20:21] op_sel:[1,0,0] op_sel_hi:[1,1,1]
    v_pk_fma_f32 v[22:23], v[134:135], v[110:111], v[22:23] op_sel:[1,0,0] op_sel_hi:[1,1,1]
    s_set_gpr_idx_off
A_36:
    s_sub_u32 s31, s31, 4
    s_cbranch_scc1 B_36
    v_mfma_f32_4x4x4_16b_bf16 v[116:119], v[172:173], v[178:179], 0 cbsz:4 abid:10
    v_lshlrev_b32_sdwa v136, v15, v122 dst_sel:DWORD dst_unused:UNUSED_PAD src0_sel:DWORD src1_sel:WORD_1
    s_waitcnt vmcnt(4)
    v_mfma_f32_4x4x4_16b_bf16 v[104:107], v[142:143], v[84:85], 0 cbsz:4 abid:9
    v_readlane_b32 s58, v164, 42
    v_mfma_f32_4x4x4_16b_bf16 v[108:111], v[142:143], v[86:87], 0 cbsz:4 abid:9
    v_lshlrev_b32_sdwa v137, v15, v123 dst_sel:DWORD dst_unused:UNUSED_PAD src0_sel:DWORD src1_sel:WORD_1
    ds_read_u16_d16_hi v132, v136 offset:32768
    ds_read_u16_d16_hi v133, v137 offset:32768
    s_and_b32 s33, s58, s34
    buffer_load_dwordx4 v[72:75], v1, s[12:15], s33 offen
    s_waitcnt lgkmcnt(2)
    s_set_gpr_idx_on s52, 0xc
    v_pk_fma_f32 v[16:17], v[128:129], v[96:97], v[16:17] op_sel:[0,0,0] op_sel_hi:[0,1,1]
    v_pk_fma_f32 v[18:19], v[128:129], v[98:99], v[18:19] op_sel:[0,0,0] op_sel_hi:[0,1,1]
    v_pk_fma_f32 v[20:21], v[130:131], v[100:101], v[20:21] op_sel:[0,0,0] op_sel_hi:[0,1,1]
    v_pk_fma_f32 v[22:23], v[130:131], v[102:103], v[22:23] op_sel:[0,0,0] op_sel_hi:[0,1,1]
    s_set_gpr_idx_off
    v_lshlrev_b32_sdwa v138, v15, v126 dst_sel:DWORD dst_unused:UNUSED_PAD src0_sel:DWORD src1_sel:WORD_1
    s_waitcnt vmcnt(4)
    v_mfma_f32_4x4x4_16b_bf16 v[96:99], v[144:145], v[88:89], 0 cbsz:4 abid:9
    v_readlane_b32 s59, v164, 43
    v_mfma_f32_4x4x4_16b_bf16 v[100:103], v[144:145], v[90:91], 0 cbsz:4 abid:9
    v_lshlrev_b32_sdwa v139, v15, v127 dst_sel:DWORD dst_unused:UNUSED_PAD src0_sel:DWORD src1_sel:WORD_1
    ds_read_u16_d16_hi v134, v138 offset:32768
    ds_read_u16_d16_hi v135, v139 offset:32768
    s_and_b32 s33, s59, s34
    buffer_load_dwordx4 v[76:79], v1, s[12:15], s33 offen
    s_set_gpr_idx_on s53, 0xc
    v_pk_fma_f32 v[16:17], v[128:129], v[104:105], v[16:17] op_sel:[1,0,0] op_sel_hi:[1,1,1]
    v_pk_fma_f32 v[18:19], v[128:129], v[106:107], v[18:19] op_sel:[1,0,0] op_sel_hi:[1,1,1]
    v_pk_fma_f32 v[20:21], v[130:131], v[108:109], v[20:21] op_sel:[1,0,0] op_sel_hi:[1,1,1]
    v_pk_fma_f32 v[22:23], v[130:131], v[110:111], v[22:23] op_sel:[1,0,0] op_sel_hi:[1,1,1]
    s_set_gpr_idx_off
    v_mfma_f32_4x4x4_16b_bf16 v[120:123], v[172:173], v[176:177], 0 cbsz:4 abid:11
    v_lshlrev_b32_sdwa v136, v15, v112 dst_sel:DWORD dst_unused:UNUSED_PAD src0_sel:DWORD src1_sel:WORD_1
    s_waitcnt vmcnt(4)
    v_mfma_f32_4x4x4_16b_bf16 v[104:107], v[146:147], v[92:93], 0 cbsz:4 abid:9
    v_readlane_b32 s60, v164, 44
    v_mfma_f32_4x4x4_16b_bf16 v[108:111], v[146:147], v[94:95], 0 cbsz:4 abid:9
    v_lshlrev_b32_sdwa v137, v15, v113 dst_sel:DWORD dst_unused:UNUSED_PAD src0_sel:DWORD src1_sel:WORD_1
    ds_read_u16_d16_hi v128, v136 offset:32768
    ds_read_u16_d16_hi v129, v137 offset:32768
    s_and_b32 s33, s60, s34
    buffer_load_dwordx4 v[80:83], v1, s[12:15], s33 offen
    s_waitcnt lgkmcnt(2)
    s_set_gpr_idx_on s54, 0xc
    v_pk_fma_f32 v[16:17], v[132:133], v[96:97], v[16:17] op_sel:[0,0,0] op_sel_hi:[0,1,1]
    v_pk_fma_f32 v[18:19], v[132:133], v[98:99], v[18:19] op_sel:[0,0,0] op_sel_hi:[0,1,1]
    v_pk_fma_f32 v[20:21], v[134:135], v[100:101], v[20:21] op_sel:[0,0,0] op_sel_hi:[0,1,1]
    v_pk_fma_f32 v[22:23], v[134:135], v[102:103], v[22:23] op_sel:[0,0,0] op_sel_hi:[0,1,1]
    s_set_gpr_idx_off
    v_lshlrev_b32_sdwa v138, v15, v116 dst_sel:DWORD dst_unused:UNUSED_PAD src0_sel:DWORD src1_sel:WORD_1
    s_waitcnt vmcnt(4)
    v_mfma_f32_4x4x4_16b_bf16 v[96:99], v[140:141], v[64:65], 0 cbsz:4 abid:10
    v_readlane_b32 s61, v164, 45
    v_mfma_f32_4x4x4_16b_bf16 v[100:103], v[140:141], v[66:67], 0 cbsz:4 abid:10
    v_lshlrev_b32_sdwa v139, v15, v117 dst_sel:DWORD dst_unused:UNUSED_PAD src0_sel:DWORD src1_sel:WORD_1
    ds_read_u16_d16_hi v130, v138 offset:32768
    ds_read_u16_d16_hi v131, v139 offset:32768
    s_and_b32 s33, s61, s34
    buffer_load_dwordx4 v[84:87], v1, s[12:15], s33 offen
    s_set_gpr_idx_on s55, 0xc
    v_pk_fma_f32 v[16:17], v[132:133], v[104:105], v[16:17] op_sel:[1,0,0] op_sel_hi:[1,1,1]
    v_pk_fma_f32 v[18:19], v[132:133], v[106:107], v[18:19] op_sel:[1,0,0] op_sel_hi:[1,1,1]
    v_pk_fma_f32 v[20:21], v[134:135], v[108:109], v[20:21] op_sel:[1,0,0] op_sel_hi:[1,1,1]
    v_pk_fma_f32 v[22:23], v[134:135], v[110:111], v[22:23] op_sel:[1,0,0] op_sel_hi:[1,1,1]
    s_set_gpr_idx_off
A_40:
    s_sub_u32 s31, s31, 4
    s_cbranch_scc1 B_40
    v_mfma_f32_4x4x4_16b_bf16 v[124:127], v[172:173], v[178:179], 0 cbsz:4 abid:11
    v_lshlrev_b32_sdwa v136, v15, v114 dst_sel:DWORD dst_unused:UNUSED_PAD src0_sel:DWORD src1_sel:WORD_1
    s_waitcnt vmcnt(4)
    v_mfma_f32_4x4x4_16b_bf16 v[104:107], v[142:143], v[68:69], 0 cbsz:4 abid:10
    v_readlane_b32 s62, v164, 46
    v_mfma_f32_4x4x4_16b_bf16 v[108:111], v[142:143], v[70:71], 0 cbsz:4 abid:10
    v_lshlrev_b32_sdwa v137, v15, v115 dst_sel:DWORD dst_unused:UNUSED_PAD src0_sel:DWORD src1_sel:WORD_1
    ds_read_u16_d16_hi v132, v136 offset:32768
    ds_read_u16_d16_hi v133, v137 offset:32768
    s_and_b32 s33, s62, s34
    buffer_load_dwordx4 v[88:91], v1, s[12:15], s33 offen
    s_waitcnt lgkmcnt(2)
    s_set_gpr_idx_on s56, 0xc
    v_pk_fma_f32 v[16:17], v[128:129], v[96:97], v[16:17] op_sel:[0,0,0] op_sel_hi:[0,1,1]
    v_pk_fma_f32 v[18:19], v[128:129], v[98:99], v[18:19] op_sel:[0,0,0] op_sel_hi:[0,1,1]
    v_pk_fma_f32 v[20:21], v[130:131], v[100:101], v[20:21] op_sel:[0,0,0] op_sel_hi:[0,1,1]
    v_pk_fma_f32 v[22:23], v[130:131], v[102:103], v[22:23] op_sel:[0,0,0] op_sel_hi:[0,1,1]
    s_set_gpr_idx_off
    v_mfma_f32_4x4x4_16b_bf16 v[148:151], v[168:169], v[180:181], 0
    v_lshlrev_b32_sdwa v138, v15, v118 dst_sel:DWORD dst_unused:UNUSED_PAD src0_sel:DWORD src1_sel:WORD_1
    s_waitcnt vmcnt(4)
    v_mfma_f32_4x4x4_16b_bf16 v[96:99], v[144:145], v[72:73], 0 cbsz:4 abid:10
    v_readlane_b32 s63, v164, 47
    v_mfma_f32_4x4x4_16b_bf16 v[100:103], v[144:145], v[74:75], 0 cbsz:4 abid:10
    v_lshlrev_b32_sdwa v139, v15, v119 dst_sel:DWORD dst_unused:UNUSED_PAD src0_sel:DWORD src1_sel:WORD_1
    ds_read_u16_d16_hi v134, v138 offset:32768
    ds_read_u16_d16_hi v135, v139 offset:32768
    s_and_b32 s33, s63, s34
    buffer_load_dwordx4 v[92:95], v1, s[12:15], s33 offen
    s_set_gpr_idx_on s57, 0xc
    v_pk_fma_f32 v[16:17], v[128:129], v[104:105], v[16:17] op_sel:[1,0,0] op_sel_hi:[1,1,1]
    v_pk_fma_f32 v[18:19], v[128:129], v[106:107], v[18:19] op_sel:[1,0,0] op_sel_hi:[1,1,1]
    v_pk_fma_f32 v[20:21], v[130:131], v[108:109], v[20:21] op_sel:[1,0,0] op_sel_hi:[1,1,1]
    v_pk_fma_f32 v[22:23], v[130:131], v[110:111], v[22:23] op_sel:[1,0,0] op_sel_hi:[1,1,1]
    s_set_gpr_idx_off
    v_mfma_f32_4x4x4_16b_bf16 v[112:115], v[172:173], v[176:177], 0 cbsz:4 abid:12
    v_lshlrev_b32_sdwa v136, v15, v120 dst_sel:DWORD dst_unused:UNUSED_PAD src0_sel:DWORD src1_sel:WORD_1
    s_waitcnt vmcnt(4)
    v_mfma_f32_4x4x4_16b_bf16 v[104:107], v[146:147], v[76:77], 0 cbsz:4 abid:10
    v_readlane_b32 s48, v164, 48
    v_mfma_f32_4x4x4_16b_bf16 v[108:111], v[146:147], v[78:79], 0 cbsz:4 abid:10
    v_lshlrev_b32_sdwa v137, v15, v121 dst_sel:DWORD dst_unused:UNUSED_PAD src0_sel:DWORD src1_sel:WORD_1
    ds_read_u16_d16_hi v128, v136 offset:32768
    ds_read_u16_d16_hi v129, v137 offset:32768
    s_and_b32 s33, s48, s34
    buffer_load_dwordx4 v[64:67], v1, s[12:15], s33 offen
    s_waitcnt lgkmcnt(2)
    s_set_gpr_idx_on s58, 0xc
    v_pk_fma_f32 v[16:17], v[132:133], v[96:97], v[16:17] op_sel:[0,0,0] op_sel_hi:[0,1,1]
    v_pk_fma_f32 v[18:19], v[132:133], v[98:99], v[18:19] op_sel:[0,0,0] op_sel_hi:[0,1,1]
    v_pk_fma_f32 v[20:21], v[134:135], v[100:101], v[20:21] op_sel:[0,0,0] op_sel_hi:[0,1,1]
    v_pk_fma_f32 v[22:23], v[134:135], v[102:103], v[22:23] op_sel:[0,0,0] op_sel_hi:[0,1,1]
    s_set_gpr_idx_off
    v_mfma_f32_4x4x4_16b_bf16 v[152:155], v[168:169], v[182:183], 0
    v_lshlrev_b32_sdwa v138, v15, v124 dst_sel:DWORD dst_unused:UNUSED_PAD src0_sel:DWORD src1_sel:WORD_1
    s_waitcnt vmcnt(4)
    v_mfma_f32_4x4x4_16b_bf16 v[96:99], v[140:141], v[80:81], 0 cbsz:4 abid:11
    v_readlane_b32 s49, v164, 49
    v_mfma_f32_4x4x4_16b_bf16 v[100:103], v[140:141], v[82:83], 0 cbsz:4 abid:11
    v_lshlrev_b32_sdwa v139, v15, v125 dst_sel:DWORD dst_unused:UNUSED_PAD src0_sel:DWORD src1_sel:WORD_1
    ds_read_u16_d16_hi v130, v138 offset:32768
    ds_read_u16_d16_hi v131, v139 offset:32768
    s_and_b32 s33, s49, s34
    buffer_load_dwordx4 v[68:71], v1, s[12:15], s33 offen
    s_set_gpr_idx_on s59, 0xc
    v_pk_fma_f32 v[16:17], v[132:133], v[104:105], v[16:17] op_sel:[1,0,0] op_sel_hi:[1,1,1]
    v_pk_fma_f32 v[18:19], v[132:133], v[106:107], v[18:19] op_sel:[1,0,0] op_sel_hi:[1,1,1]
    v_pk_fma_f32 v[20:21], v[134:135], v[108:109], v[20:21] op_sel:[1,0,0] op_sel_hi:[1,1,1]
    v_pk_fma_f32 v[22:23], v[134:135], v[110:111], v[22:23] op_sel:[1,0,0] op_sel_hi:[1,1,1]
    s_set_gpr_idx_off
A_44:
    s_sub_u32 s31, s31, 4
    s_cbranch_scc1 B_44
    v_mfma_f32_4x4x4_16b_bf16 v[116:119], v[172:173], v[178:179], 0 cbsz:4 abid:12
    v_lshlrev_b32_sdwa v136, v15, v122 dst_sel:DWORD dst_unused:UNUSED_PAD src0_sel:DWORD src1_sel:WORD_1
    s_waitcnt vmcnt(4)
    v_mfma_f32_4x4x4_16b_bf16 v[104:107], v[142:143], v[84:85], 0 cbsz:4 abid:11
    v_readlane_b32 s50, v164, 50
    v_mfma_f32_4x4x4_16b_bf16 v[108:111], v[142:143], v[86:87], 0 cbsz:4 abid:11
    v_lshlrev_b32_sdwa v137, v15, v123 dst_sel:DWORD dst_unused:UNUSED_PAD src0_sel:DWORD src1_sel:WORD_1
    ds_read_u16_d16_hi v132, v136 offset:32768
    ds_read_u16_d16_hi v133, v137 offset:32768
    s_and_b32 s33, s50, s34
    buffer_load_dwordx4 v[72:75], v1, s[12:15], s33 offen
    s_waitcnt lgkmcnt(2)
    s_set_gpr_idx_on s60, 0xc
    v_pk_fma_f32 v[16:17], v[128:129], v[96:97], v[16:17] op_sel:[0,0,0] op_sel_hi:[0,1,1]
    v_pk_fma_f32 v[18:19], v[128:129], v[98:99], v[18:19] op_sel:[0,0,0] op_sel_hi:[0,1,1]
    v_pk_fma_f32 v[20:21], v[130:131], v[100:101], v[20:21] op_sel:[0,0,0] op_sel_hi:[0,1,1]
    v_pk_fma_f32 v[22:23], v[130:131], v[102:103], v[22:23] op_sel:[0,0,0] op_sel_hi:[0,1,1]
    s_set_gpr_idx_off
    v_mfma_f32_4x4x4_16b_bf16 v[156:159], v[168:169], v[184:185], 0
    v_lshlrev_b32_sdwa v138, v15, v126 dst_sel:DWORD dst_unused:UNUSED_PAD src0_sel:DWORD src1_sel:WORD_1
    s_waitcnt vmcnt(4)
    v_mfma_f32_4x4x4_16b_bf16 v[96:99], v[144:145], v[88:89], 0 cbsz:4 abid:11
    v_readlane_b32 s51, v164, 51
    v_mfma_f32_4x4x4_16b_bf16 v[100:103], v[144:145], v[90:91], 0 cbsz:4 abid:11
    v_lshlrev_b32_sdwa v139, v15, v127 dst_sel:DWORD dst_unused:UNUSED_PAD src0_sel:DWORD src1_sel:WORD_1
    ds_read_u16_d16_hi v134, v138 offset:32768
    ds_read_u16_d16_hi v135, v139 offset:32768
    s_and_b32 s33, s51, s34
    buffer_load_dwordx4 v[76:79], v1, s[12:15], s33 offen
    s_set_gpr_idx_on s61, 0xc
    v_pk_fma_f32 v[16:17], v[128:129], v[104:105], v[16:17] op_sel:[1,0,0] op_sel_hi:[1,1,1]
    v_pk_fma_f32 v[18:19], v[128:129], v[106:107], v[18:19] op_sel:[1,0,0] op_sel_hi:[1,1,1]
    v_pk_fma_f32 v[20:21], v[130:131], v[108:109], v[20:21] op_sel:[1,0,0] op_sel_hi:[1,1,1]
    v_pk_fma_f32 v[22:23], v[130:131], v[110:111], v[22:23] op_sel:[1,0,0] op_sel_hi:[1,1,1]
    s_set_gpr_idx_off
    v_mfma_f32_4x4x4_16b_bf16 v[120:123], v[172:173], v[176:177], 0 cbsz:4 abid:13
    v_lshlrev_b32_sdwa v136, v15, v112 dst_sel:DWORD dst_unused:UNUSED_PAD src0_sel:DWORD src1_sel:WORD_1
    s_waitcnt vmcnt(4)
    v_mfma_f32_4x4x4_16b_bf16 v[104:107], v[146:147], v[92:93], 0 cbsz:4 abid:11
    v_readlane_b32 s52, v164, 52
    v_mfma_f32_4x4x4_16b_bf16 v[108:111], v[146:147], v[94:95], 0 cbsz:4 abid:11
    v_lshlrev_b32_sdwa v137, v15, v113 dst_sel:DWORD dst_unused:UNUSED_PAD src0_sel:DWORD src1_sel:WORD_1
    ds_read_u16_d16_hi v128, v136 offset:32768
    ds_read_u16_d16_hi v129, v137 offset:32768
    s_and_b32 s33, s52, s34
    buffer_load_dwordx4 v[80:83], v1, s[12:15], s33 offen
    s_waitcnt lgkmcnt(2)
    s_set_gpr_idx_on s62, 0xc
    v_pk_fma_f32 v[16:17], v[132:133], v[96:97], v[16:17] op_sel:[0,0,0] op_sel_hi:[0,1,1]
    v_pk_fma_f32 v[18:19], v[132:133], v[98:99], v[18:19] op_sel:[0,0,0] op_sel_hi:[0,1,1]
    v_pk_fma_f32 v[20:21], v[134:135], v[100:101], v[20:21] op_sel:[0,0,0] op_sel_hi:[0,1,1]
    v_pk_fma_f32 v[22:23], v[134:135], v[102:103], v[22:23] op_sel:[0,0,0] op_sel_hi:[0,1,1]
    s_set_gpr_idx_off
    v_mfma_f32_4x4x4_16b_bf16 v[160:163], v[168:169], v[186:187], 0
    v_lshlrev_b32_sdwa v138, v15, v116 dst_sel:DWORD dst_unused:UNUSED_PAD src0_sel:DWORD src1_sel:WORD_1
    s_waitcnt vmcnt(4)
    v_mfma_f32_4x4x4_16b_bf16 v[96:99], v[140:141], v[64:65], 0 cbsz:4 abid:12
    v_readlane_b32 s53, v164, 53
    v_mfma_f32_4x4x4_16b_bf16 v[100:103], v[140:141], v[66:67], 0 cbsz:4 abid:12
    v_lshlrev_b32_sdwa v139, v15, v117 dst_sel:DWORD dst_unused:UNUSED_PAD src0_sel:DWORD src1_sel:WORD_1
    ds_read_u16_d16_hi v130, v138 offset:32768
    ds_read_u16_d16_hi v131, v139 offset:32768
    s_and_b32 s33, s53, s34
    buffer_load_dwordx4 v[84:87], v1, s[12:15], s33 offen
    s_set_gpr_idx_on s63, 0xc
    v_pk_fma_f32 v[16:17], v[132:133], v[104:105], v[16:17] op_sel:[1,0,0] op_sel_hi:[1,1,1]
    v_pk_fma_f32 v[18:19], v[132:133], v[106:107], v[18:19] op_sel:[1,0,0] op_sel_hi:[1,1,1]
    v_pk_fma_f32 v[20:21], v[134:135], v[108:109], v[20:21] op_sel:[1,0,0] op_sel_hi:[1,1,1]
    v_pk_fma_f32 v[22:23], v[134:135], v[110:111], v[22:23] op_sel:[1,0,0] op_sel_hi:[1,1,1]
    s_set_gpr_idx_off
A_48:
    s_sub_u32 s31, s31, 4
    s_cbranch_scc1 B_48
    v_mfma_f32_4x4x4_16b_bf16 v[124:127], v[172:173], v[178:179], 0 cbsz:4 abid:13
    v_lshlrev_b32_sdwa v136, v15, v114 dst_sel:DWORD dst_unused:UNUSED_PAD src0_sel:DWORD src1_sel:WORD_1
    s_waitcnt vmcnt(4)
    v_mfma_f32_4x4x4_16b_bf16 v[104:107], v[142:143], v[68:69], 0 cbsz:4 abid:12
    v_readlane_b32 s54, v164, 54
    v_mfma_f32_4x4x4_16b_bf16 v[108:111], v[142:143], v[70:71], 0 cbsz:4 abid:12
    v_lshlrev_b32_sdwa v137, v15, v115 dst_sel:DWORD dst_unused:UNUSED_PAD src0_sel:DWORD src1_sel:WORD_1
    ds_read_u16_d16_hi v132, v136 offset:32768
    ds_read_u16_d16_hi v133, v137 offset:32768
    s_and_b32 s33, s54, s34
    buffer_load_dwordx4 v[88:91], v1, s[12:15], s33 offen
    s_waitcnt lgkmcnt(2)
    s_set_gpr_idx_on s48, 0xc
    v_pk_fma_f32 v[16:17], v[128:129], v[96:97], v[16:17] op_sel:[0,0,0] op_sel_hi:[0,1,1]
    v_pk_fma_f32 v[18:19], v[128:129], v[98:99], v[18:19] op_sel:[0,0,0] op_sel_hi:[0,1,1]
    v_pk_fma_f32 v[20:21], v[130:131], v[100:101], v[20:21] op_sel:[0,0,0] op_sel_hi:[0,1,1]
    v_pk_fma_f32 v[22:23], v[130:131], v[102:103], v[22:23] op_sel:[0,0,0] op_sel_hi:[0,1,1]
    s_set_gpr_idx_off
    v_lshlrev_b32_sdwa v138, v15, v118 dst_sel:DWORD dst_unused:UNUSED_PAD src0_sel:DWORD src1_sel:WORD_1
    s_waitcnt vmcnt(4)
    v_mfma_f32_4x4x4_16b_bf16 v[96:99], v[144:145], v[72:73], 0 cbsz:4 abid:12
    v_readlane_b32 s55, v164, 55
    v_mfma_f32_4x4x4_16b_bf16 v[100:103], v[144:145], v[74:75], 0 cbsz:4 abid:12
    v_lshlrev_b32_sdwa v139, v15, v119 dst_sel:DWORD dst_unused:UNUSED_PAD src0_sel:DWORD src1_sel:WORD_1
    ds_read_u16_d16_hi v134, v138 offset:32768
    ds_read_u16_d16_hi v135, v139 offset:32768
    s_and_b32 s33, s55, s34
    buffer_load_dwordx4 v[92:95], v1, s[12:15], s33 offen
    s_set_gpr_idx_on s49, 0xc
    v_pk_fma_f32 v[16:17], v[128:129], v[104:105], v[16:17] op_sel:[1,0,0] op_sel_hi:[1,1,1]
    v_pk_fma_f32 v[18:19], v[128:129], v[106:107], v[18:19] op_sel:[1,0,0] op_sel_hi:[1,1,1]
    v_pk_fma_f32 v[20:21], v[130:131], v[108:109], v[20:21] op_sel:[1,0,0] op_sel_hi:[1,1,1]
    v_pk_fma_f32 v[22:23], v[130:131], v[110:111], v[22:23] op_sel:[1,0,0] op_sel_hi:[1,1,1]
    s_set_gpr_idx_off
    v_mfma_f32_4x4x4_16b_bf16 v[112:115], v[172:173], v[176:177], 0 cbsz:4 abid:14
    v_lshlrev_b32_sdwa v136, v15, v120 dst_sel:DWORD dst_unused:UNUSED_PAD src0_sel:DWORD src1_sel:WORD_1
    s_waitcnt vmcnt(4)
    v_mfma_f32_4x4x4_16b_bf16 v[104:107], v[146:147], v[76:77], 0 cbsz:4 abid:12
    v_readlane_b32 s56, v164, 56
    v_mfma_f32_4x4x4_16b_bf16 v[108:111], v[146:147], v[78:79], 0 cbsz:4 abid:12
    v_lshlrev_b32_sdwa v137, v15, v121 dst_sel:DWORD dst_unused:UNUSED_PAD src0_sel:DWORD src1_sel:WORD_1
    ds_read_u16_d16_hi v128, v136 offset:32768
    ds_read_u16_d16_hi v129, v137 offset:32768
    s_and_b32 s33, s56, s34
    buffer_load_dwordx4 v[64:67], v1, s[12:15], s33 offen
    s_waitcnt lgkmcnt(2)
    s_set_gpr_idx_on s50, 0xc
    v_pk_fma_f32 v[16:17], v[132:133], v[96:97], v[16:17] op_sel:[0,0,0] op_sel_hi:[0,1,1]
    v_pk_fma_f32 v[18:19], v[132:133], v[98:99], v[18:19] op_sel:[0,0,0] op_sel_hi:[0,1,1]
    v_pk_fma_f32 v[20:21], v[134:135], v[100:101], v[20:21] op_sel:[0,0,0] op_sel_hi:[0,1,1]
    v_pk_fma_f32 v[22:23], v[134:135], v[102:103], v[22:23] op_sel:[0,0,0] op_sel_hi:[0,1,1]
    s_set_gpr_idx_off
    v_lshlrev_b32_sdwa v138, v15, v124 dst_sel:DWORD dst_unused:UNUSED_PAD src0_sel:DWORD src1_sel:WORD_1
    s_waitcnt vmcnt(4)
    v_mfma_f32_4x4x4_16b_bf16 v[96:99], v[140:141], v[80:81], 0 cbsz:4 abid:13
    v_readlane_b32 s57, v164, 57
    v_mfma_f32_4x4x4_16b_bf16 v[100:103], v[140:141], v[82:83], 0 cbsz:4 abid:13
    v_lshlrev_b32_sdwa v139, v15, v125 dst_sel:DWORD dst_unused:UNUSED_PAD src0_sel:DWORD src1_sel:WORD_1
    ds_read_u16_d16_hi v130, v138 offset:32768
    ds_read_u16_d16_hi v131, v139 offset:32768
    s_and_b32 s33, s57, s34
    buffer_load_dwordx4 v[68:71], v1, s[12:15], s33 offen
    s_set_gpr_idx_on s51, 0xc
    v_pk_fma_f32 v[16:17], v[132:133], v[104:105], v[16:17] op_sel:[1,0,0] op_sel_hi:[1,1,1]
    v_pk_fma_f32 v[18:19], v[132:133], v[106:107], v[18:19] op_sel:[1,0,0] op_sel_hi:[1,1,1]
    v_pk_fma_f32 v[20:21], v[134:135], v[108:109], v[20:21] op_sel:[1,0,0] op_sel_hi:[1,1,1]
    v_pk_fma_f32 v[22:23], v[134:135], v[110:111], v[22:23] op_sel:[1,0,0] op_sel_hi:[1,1,1]
    s_set_gpr_idx_off
A_52:
    s_sub_u32 s31, s31, 4
    s_cbranch_scc1 B_52
    v_mfma_f32_4x4x4_16b_bf16 v[116:119], v[172:173], v[178:179], 0 cbsz:4 abid:14
    v_lshlrev_b32_sdwa v136, v15, v122 dst_sel:DWORD dst_unused:UNUSED_PAD src0_sel:DWORD src1_sel:WORD_1
    s_waitcnt vmcnt(4)
    v_mfma_f32_4x4x4_16b_bf16 v[104:107], v[142:143], v[84:85], 0 cbsz:4 abid:13
    v_readlane_b32 s58, v164, 58
    v_mfma_f32_4x4x4_16b_bf16 v[108:111], v[142:143], v[86:87], 0 cbsz:4 abid:13
    v_lshlrev_b32_sdwa v137, v15, v123 dst_sel:DWORD dst_unused:UNUSED_PAD src0_sel:DWORD src1_sel:WORD_1
    ds_read_u16_d16_hi v132, v136 offset:32768
    ds_read_u16_d16_hi v133, v137 offset:32768
    s_and_b32 s33, s58, s34
    buffer_load_dwordx4 v[72:75], v1, s[12:15], s33 offen
    s_waitcnt lgkmcnt(2)
    s_set_gpr_idx_on s52, 0xc
    v_pk_fma_f32 v[16:17], v[128:129], v[96:97], v[16:17] op_sel:[0,0,0] op_sel_hi:[0,1,1]
    v_pk_fma_f32 v[18:19], v[128:129], v[98:99], v[18:19] op_sel:[0,0,0] op_sel_hi:[0,1,1]
    v_pk_fma_f32 v[20:21], v[130:131], v[100:101], v[20:21] op_sel:[0,0,0] op_sel_hi:[0,1,1]
    v_pk_fma_f32 v[22:23], v[130:131], v[102:103], v[22:23] op_sel:[0,0,0] op_sel_hi:[0,1,1]
    s_set_gpr_idx_off
    v_lshlrev_b32_sdwa v138, v15, v126 dst_sel:DWORD dst_unused:UNUSED_PAD src0_sel:DWORD src1_sel:WORD_1
    s_waitcnt vmcnt(4)
    v_mfma_f32_4x4x4_16b_bf16 v[96:99], v[144:145], v[88:89], 0 cbsz:4 abid:13
    v_readlane_b32 s59, v164, 59
    v_mfma_f32_4x4x4_16b_bf16 v[100:103], v[144:145], v[90:91], 0 cbsz:4 abid:13
    v_lshlrev_b32_sdwa v139, v15, v127 dst_sel:DWORD dst_unused:UNUSED_PAD src0_sel:DWORD src1_sel:WORD_1
    ds_read_u16_d16_hi v134, v138 offset:32768
    ds_read_u16_d16_hi v135, v139 offset:32768
    s_and_b32 s33, s59, s34
    buffer_load_dwordx4 v[76:79], v1, s[12:15], s33 offen
    s_set_gpr_idx_on s53, 0xc
    v_pk_fma_f32 v[16:17], v[128:129], v[104:105], v[16:17] op_sel:[1,0,0] op_sel_hi:[1,1,1]
    v_pk_fma_f32 v[18:19], v[128:129], v[106:107], v[18:19] op_sel:[1,0,0] op_sel_hi:[1,1,1]
    v_pk_fma_f32 v[20:21], v[130:131], v[108:109], v[20:21] op_sel:[1,0,0] op_sel_hi:[1,1,1]
    v_pk_fma_f32 v[22:23], v[130:131], v[110:111], v[22:23] op_sel:[1,0,0] op_sel_hi:[1,1,1]
    s_set_gpr_idx_off
    v_mfma_f32_4x4x4_16b_bf16 v[120:123], v[172:173], v[176:177], 0 cbsz:4 abid:15
    v_lshlrev_b32_sdwa v136, v15, v112 dst_sel:DWORD dst_unused:UNUSED_PAD src0_sel:DWORD src1_sel:WORD_1
    s_waitcnt vmcnt(4)
    v_mfma_f32_4x4x4_16b_bf16 v[104:107], v[146:147], v[92:93], 0 cbsz:4 abid:13
    v_readlane_b32 s60, v164, 60
    v_mfma_f32_4x4x4_16b_bf16 v[108:111], v[146:147], v[94:95], 0 cbsz:4 abid:13
    v_lshlrev_b32_sdwa v137, v15, v113 dst_sel:DWORD dst_unused:UNUSED_PAD src0_sel:DWORD src1_sel:WORD_1
    ds_read_u16_d16_hi v128, v136 offset:32768
    ds_read_u16_d16_hi v129, v137 offset:32768
    s_and_b32 s33, s60, s34
    buffer_load_dwordx4 v[80:83], v1, s[12:15], s33 offen
    s_waitcnt lgkmcnt(2)
    s_set_gpr_idx_on s54, 0xc
    v_pk_fma_f32 v[16:17], v[132:133], v[96:97], v[16:17] op_sel:[0,0,0] op_sel_hi:[0,1,1]
    v_pk_fma_f32 v[18:19], v[132:133], v[98:99], v[18:19] op_sel:[0,0,0] op_sel_hi:[0,1,1]
    v_pk_fma_f32 v[20:21], v[134:135], v[100:101], v[20:21] op_sel:[0,0,0] op_sel_hi:[0,1,1]
    v_pk_fma_f32 v[22:23], v[134:135], v[102:103], v[22:23] op_sel:[0,0,0] op_sel_hi:[0,1,1]
    s_set_gpr_idx_off
    v_lshlrev_b32_sdwa v138, v15, v116 dst_sel:DWORD dst_unused:UNUSED_PAD src0_sel:DWORD src1_sel:WORD_1
    s_waitcnt vmcnt(4)
    v_mfma_f32_4x4x4_16b_bf16 v[96:99], v[140:141], v[64:65], 0 cbsz:4 abid:14
    v_readlane_b32 s61, v164, 61
    v_mfma_f32_4x4x4_16b_bf16 v[100:103], v[140:141], v[66:67], 0 cbsz:4 abid:14
    v_lshlrev_b32_sdwa v139, v15, v117 dst_sel:DWORD dst_unused:UNUSED_PAD src0_sel:DWORD src1_sel:WORD_1
    ds_read_u16_d16_hi v130, v138 offset:32768
    ds_read_u16_d16_hi v131, v139 offset:32768
    s_and_b32 s33, s61, s34
    buffer_load_dwordx4 v[84:87], v1, s[12:15], s33 offen
    s_set_gpr_idx_on s55, 0xc
    v_pk_fma_f32 v[16:17], v[132:133], v[104:105], v[16:17] op_sel:[1,0,0] op_sel_hi:[1,1,1]
    v_pk_fma_f32 v[18:19], v[132:133], v[106:107], v[18:19] op_sel:[1,0,0] op_sel_hi:[1,1,1]
    v_pk_fma_f32 v[20:21], v[134:135], v[108:109], v[20:21] op_sel:[1,0,0] op_sel_hi:[1,1,1]
    v_pk_fma_f32 v[22:23], v[134:135], v[110:111], v[22:23] op_sel:[1,0,0] op_sel_hi:[1,1,1]
    s_set_gpr_idx_off
A_56:
    s_sub_u32 s31, s31, 4
    s_cbranch_scc1 B_56
    v_mfma_f32_4x4x4_16b_bf16 v[124:127], v[172:173], v[178:179], 0 cbsz:4 abid:15
    v_lshlrev_b32_sdwa v136, v15, v114 dst_sel:DWORD dst_unused:UNUSED_PAD src0_sel:DWORD src1_sel:WORD_1
    s_waitcnt vmcnt(4)
    v_mfma_f32_4x4x4_16b_bf16 v[104:107], v[142:143], v[68:69], 0 cbsz:4 abid:14
    v_readlane_b32 s62, v164, 62
    v_mfma_f32_4x4x4_16b_bf16 v[108:111], v[142:143], v[70:71], 0 cbsz:4 abid:14
    v_lshlrev_b32_sdwa v137, v15, v115 dst_sel:DWORD dst_unused:UNUSED_PAD src0_sel:DWORD src1_sel:WORD_1
    ds_read_u16_d16_hi v132, v136 offset:32768
    ds_read_u16_d16_hi v133, v137 offset:32768
    s_and_b32 s33, s62, s34
    buffer_load_dwordx4 v[88:91], v1, s[12:15], s33 offen
    s_waitcnt lgkmcnt(2)
    s_set_gpr_idx_on s56, 0xc
    v_pk_fma_f32 v[16:17], v[128:129], v[96:97], v[16:17] op_sel:[0,0,0] op_sel_hi:[0,1,1]
    v_pk_fma_f32 v[18:19], v[128:129], v[98:99], v[18:19] op_sel:[0,0,0] op_sel_hi:[0,1,1]
    v_pk_fma_f32 v[20:21], v[130:131], v[100:101], v[20:21] op_sel:[0,0,0] op_sel_hi:[0,1,1]
    v_pk_fma_f32 v[22:23], v[130:131], v[102:103], v[22:23] op_sel:[0,0,0] op_sel_hi:[0,1,1]
    s_set_gpr_idx_off
    v_lshlrev_b32_sdwa v138, v15, v118 dst_sel:DWORD dst_unused:UNUSED_PAD src0_sel:DWORD src1_sel:WORD_1
    s_waitcnt vmcnt(4)
    v_mfma_f32_4x4x4_16b_bf16 v[96:99], v[144:145], v[72:73], 0 cbsz:4 abid:14
    v_readlane_b32 s63, v164, 63
    v_mfma_f32_4x4x4_16b_bf16 v[100:103], v[144:145], v[74:75], 0 cbsz:4 abid:14
    v_lshlrev_b32_sdwa v139, v15, v119 dst_sel:DWORD dst_unused:UNUSED_PAD src0_sel:DWORD src1_sel:WORD_1
    ds_read_u16_d16_hi v134, v138 offset:32768
    ds_read_u16_d16_hi v135, v139 offset:32768
    s_and_b32 s33, s63, s34
    buffer_load_dwordx4 v[92:95], v1, s[12:15], s33 offen
    s_set_gpr_idx_on s57, 0xc
    v_pk_fma_f32 v[16:17], v[128:129], v[104:105], v[16:17] op_sel:[1,0,0] op_sel_hi:[1,1,1]
    v_pk_fma_f32 v[18:19], v[128:129], v[106:107], v[18:19] op_sel:[1,0,0] op_sel_hi:[1,1,1]
    v_pk_fma_f32 v[20:21], v[130:131], v[108:109], v[20:21] op_sel:[1,0,0] op_sel_hi:[1,1,1]
    v_pk_fma_f32 v[22:23], v[130:131], v[110:111], v[22:23] op_sel:[1,0,0] op_sel_hi:[1,1,1]
    s_set_gpr_idx_off
    v_mov_b32 v172, v170
    v_mov_b32 v173, v171
    s_nop 1
    v_mfma_f32_4x4x4_16b_bf16 v[112:115], v[172:173], v[176:177], 0 cbsz:4 abid:0
    v_lshlrev_b32_sdwa v136, v15, v120 dst_sel:DWORD dst_unused:UNUSED_PAD src0_sel:DWORD src1_sel:WORD_1
    s_waitcnt vmcnt(4)
    v_mfma_f32_4x4x4_16b_bf16 v[104:107], v[146:147], v[76:77], 0 cbsz:4 abid:14
    v_readlane_b32 s48, v165, 0
    v_mfma_f32_4x4x4_16b_bf16 v[108:111], v[146:147], v[78:79], 0 cbsz:4 abid:14
    v_lshlrev_b32_sdwa v137, v15, v121 dst_sel:DWORD dst_unused:UNUSED_PAD src0_sel:DWORD src1_sel:WORD_1
    ds_read_u16_d16_hi v128, v136 offset:32768
    ds_read_u16_d16_hi v129, v137 offset:32768
    s_and_b32 s33, s48, s34
    buffer_load_dwordx4 v[64:67], v1, s[12:15], s33 offen
    s_waitcnt lgkmcnt(2)
    s_set_gpr_idx_on s58, 0xc
    v_pk_fma_f32 v[16:17], v[132:133], v[96:97], v[16:17] op_sel:[0,0,0] op_sel_hi:[0,1,1]
    v_pk_fma_f32 v[18:19], v[132:133], v[98:99], v[18:19] op_sel:[0,0,0] op_sel_hi:[0,1,1]
    v_pk_fma_f32 v[20:21], v[134:135], v[100:101], v[20:21] op_sel:[0,0,0] op_sel_hi:[0,1,1]
    v_pk_fma_f32 v[22:23], v[134:135], v[102:103], v[22:23] op_sel:[0,0,0] op_sel_hi:[0,1,1]
    s_set_gpr_idx_off
    v_lshlrev_b32_sdwa v138, v15, v124 dst_sel:DWORD dst_unused:UNUSED_PAD src0_sel:DWORD src1_sel:WORD_1
    s_waitcnt vmcnt(4)
    v_mfma_f32_4x4x4_16b_bf16 v[96:99], v[140:141], v[80:81], 0 cbsz:4 abid:15
    v_readlane_b32 s49, v165, 1
    v_mfma_f32_4x4x4_16b_bf16 v[100:103], v[140:141], v[82:83], 0 cbsz:4 abid:15
    v_lshlrev_b32_sdwa v139, v15, v125 dst_sel:DWORD dst_unused:UNUSED_PAD src0_sel:DWORD src1_sel:WORD_1
    ds_read_u16_d16_hi v130, v138 offset:32768
    ds_read_u16_d16_hi v131, v139 offset:32768
    s_and_b32 s33, s49, s34
    buffer_load_dwordx4 v[68:71], v1, s[12:15], s33 offen
    s_set_gpr_idx_on s59, 0xc
    v_pk_fma_f32 v[16:17], v[132:133], v[104:105], v[16:17] op_sel:[1,0,0] op_sel_hi:[1,1,1]
    v_pk_fma_f32 v[18:19], v[132:133], v[106:107], v[18:19] op_sel:[1,0,0] op_sel_hi:[1,1,1]
    v_pk_fma_f32 v[20:21], v[134:135], v[108:109], v[20:21] op_sel:[1,0,0] op_sel_hi:[1,1,1]
    v_pk_fma_f32 v[22:23], v[134:135], v[110:111], v[22:23] op_sel:[1,0,0] op_sel_hi:[1,1,1]
    s_set_gpr_idx_off
A_60:
    s_sub_u32 s31, s31, 4
    s_cbranch_scc1 B_60
    v_mfma_f32_4x4x4_16b_bf16 v[116:119], v[172:173], v[178:179], 0 cbsz:4 abid:0
    v_lshlrev_b32_sdwa v136, v15, v122 dst_sel:DWORD dst_unused:UNUSED_PAD src0_sel:DWORD src1_sel:WORD_1
    s_waitcnt vmcnt(4)
    v_mfma_f32_4x4x4_16b_bf16 v[104:107], v[142:143], v[84:85], 0 cbsz:4 abid:15
    v_readlane_b32 s50, v165, 2
    v_mfma_f32_4x4x4_16b_bf16 v[108:111], v[142:143], v[86:87], 0 cbsz:4 abid:15
    v_lshlrev_b32_sdwa v137, v15, v123 dst_sel:DWORD dst_unused:UNUSED_PAD src0_sel:DWORD src1_sel:WORD_1
    ds_read_u16_d16_hi v132, v136 offset:32768
    ds_read_u16_d16_hi v133, v137 offset:32768
    v_cvt_pk_bf16_f32 v140, v148, v152
    v_cvt_pk_bf16_f32 v141, v156, v160
    s_and_b32 s33, s50, s34
    buffer_load_dwordx4 v[72:75], v1, s[12:15], s33 offen
    s_waitcnt lgkmcnt(2)
    s_set_gpr_idx_on s60, 0xc
    v_pk_fma_f32 v[16:17], v[128:129], v[96:97], v[16:17] op_sel:[0,0,0] op_sel_hi:[0,1,1]
    v_pk_fma_f32 v[18:19], v[128:129], v[98:99], v[18:19] op_sel:[0,0,0] op_sel_hi:[0,1,1]
    v_pk_fma_f32 v[20:21], v[130:131], v[100:101], v[20:21] op_sel:[0,0,0] op_sel_hi:[0,1,1]
    v_pk_fma_f32 v[22:23], v[130:131], v[102:103], v[22:23] op_sel:[0,0,0] op_sel_hi:[0,1,1]
    s_set_gpr_idx_off
    v_lshlrev_b32_sdwa v138, v15, v126 dst_sel:DWORD dst_unused:UNUSED_PAD src0_sel:DWORD src1_sel:WORD_1
    s_waitcnt vmcnt(4)
    v_mfma_f32_4x4x4_16b_bf16 v[96:99], v[144:145], v[88:89], 0 cbsz:4 abid:15
    v_readlane_b32 s51, v165, 3
    v_mfma_f32_4x4x4_16b_bf16 v[100:103], v[144:145], v[90:91], 0 cbsz:4 abid:15
    v_lshlrev_b32_sdwa v139, v15, v127 dst_sel:DWORD dst_unused:UNUSED_PAD src0_sel:DWORD src1_sel:WORD_1
    ds_read_u16_d16_hi v134, v138 offset:32768
    ds_read_u16_d16_hi v135, v139 offset:32768
    v_cvt_pk_bf16_f32 v142, v149, v153
    v_cvt_pk_bf16_f32 v143, v157, v161
    s_and_b32 s33, s51, s34
    buffer_load_dwordx4 v[76:79], v1, s[12:15], s33 offen
    s_set_gpr_idx_on s61, 0xc
    v_pk_fma_f32 v[16:17], v[128:129], v[104:105], v[16:17] op_sel:[1,0,0] op_sel_hi:[1,1,1]
    v_pk_fma_f32 v[18:19], v[128:129], v[106:107], v[18:19] op_sel:[1,0,0] op_sel_hi:[1,1,1]
    v_pk_fma_f32 v[20:21], v[130:131], v[108:109], v[20:21] op_sel:[1,0,0] op_sel_hi:[1,1,1]
    v_pk_fma_f32 v[22:23], v[130:131], v[110:111], v[22:23] op_sel:[1,0,0] op_sel_hi:[1,1,1]
    s_set_gpr_idx_off
    v_mfma_f32_4x4x4_16b_bf16 v[120:123], v[172:173], v[176:177], 0 cbsz:4 abid:1
    v_lshlrev_b32_sdwa v136, v15, v112 dst_sel:DWORD dst_unused:UNUSED_PAD src0_sel:DWORD src1_sel:WORD_1
    s_waitcnt vmcnt(4)
    v_mfma_f32_4x4x4_16b_bf16 v[104:107], v[146:147], v[92:93], 0 cbsz:4 abid:15
    v_readlane_b32 s52, v165, 4
    v_mfma_f32_4x4x4_16b_bf16 v[108:111], v[146:147], v[94:95], 0 cbsz:4 abid:15
    v_lshlrev_b32_sdwa v137, v15, v113 dst_sel:DWORD dst_unused:UNUSED_PAD src0_sel:DWORD src1_sel:WORD_1
    ds_read_u16_d16_hi v128, v136 offset:32768
    ds_read_u16_d16_hi v129, v137 offset:32768
    v_cvt_pk_bf16_f32 v144, v150, v154
    v_cvt_pk_bf16_f32 v145, v158, v162
    s_and_b32 s33, s52, s34
    buffer_load_dwordx4 v[80:83], v1, s[12:15], s33 offen
    s_waitcnt lgkmcnt(2)
    s_set_gpr_idx_on s62, 0xc
    v_pk_fma_f32 v[16:17], v[132:133], v[96:97], v[16:17] op_sel:[0,0,0] op_sel_hi:[0,1,1]
    v_pk_fma_f32 v[18:19], v[132:133], v[98:99], v[18:19] op_sel:[0,0,0] op_sel_hi:[0,1,1]
    v_pk_fma_f32 v[20:21], v[134:135], v[100:101], v[20:21] op_sel:[0,0,0] op_sel_hi:[0,1,1]
    v_pk_fma_f32 v[22:23], v[134:135], v[102:103], v[22:23] op_sel:[0,0,0] op_sel_hi:[0,1,1]
    s_set_gpr_idx_off
    v_lshlrev_b32_sdwa v138, v15, v116 dst_sel:DWORD dst_unused:UNUSED_PAD src0_sel:DWORD src1_sel:WORD_1
    s_waitcnt vmcnt(4)
    v_mfma_f32_4x4x4_16b_bf16 v[96:99], v[140:141], v[64:65], 0 cbsz:4 abid:0
    v_readlane_b32 s53, v165, 5
    v_mfma_f32_4x4x4_16b_bf16 v[100:103], v[140:141], v[66:67], 0 cbsz:4 abid:0
    v_lshlrev_b32_sdwa v139, v15, v117 dst_sel:DWORD dst_unused:UNUSED_PAD src0_sel:DWORD src1_sel:WORD_1
    ds_read_u16_d16_hi v130, v138 offset:32768
    ds_read_u16_d16_hi v131, v139 offset:32768
    v_cvt_pk_bf16_f32 v146, v151, v155
    v_cvt_pk_bf16_f32 v147, v159, v163
    s_and_b32 s33, s53, s34
    buffer_load_dwordx4 v[84:87], v1, s[12:15], s33 offen
    s_set_gpr_idx_on s63, 0xc
    v_pk_fma_f32 v[16:17], v[132:133], v[104:105], v[16:17] op_sel:[1,0,0] op_sel_hi:[1,1,1]
    v_pk_fma_f32 v[18:19], v[132:133], v[106:107], v[18:19] op_sel:[1,0,0] op_sel_hi:[1,1,1]
    v_pk_fma_f32 v[20:21], v[134:135], v[108:109], v[20:21] op_sel:[1,0,0] op_sel_hi:[1,1,1]
    v_pk_fma_f32 v[22:23], v[134:135], v[110:111], v[22:23] op_sel:[1,0,0] op_sel_hi:[1,1,1]
    s_set_gpr_idx_off
    v_mov_b32 v164, v165
    s_branch A_0
B_0:
    buffer_load_dwordx4 v[188:191], v1, s[16:19], s10 offen offset:0 sc1
    buffer_load_dwordx4 v[192:195], v1, s[16:19], s10 offen offset:1024 sc1
    buffer_load_dwordx4 v[196:199], v1, s[16:19], s10 offen offset:2048 sc1
    buffer_load_dwordx4 v[200:203], v1, s[16:19], s10 offen offset:3072 sc1
    buffer_load_dwordx4 v[204:207], v1, s[16:19], s11 offen offset:0 sc1
    buffer_load_dwordx4 v[208:211], v1, s[16:19], s11 offen offset:1024 sc1
    buffer_load_dwordx4 v[212:215], v1, s[16:19], s11 offen offset:2048 sc1
    buffer_load_dwordx4 v[216:219], v1, s[16:19], s11 offen offset:3072 sc1
    s_sub_u32 s32, s32, 1
    s_cbranch_scc1 MAIN_DONE
    v_mfma_f32_4x4x4_16b_bf16 v[124:127], v[172:173], v[178:179], 0 cbsz:4 abid:1
    v_lshlrev_b32_sdwa v136, v15, v114 dst_sel:DWORD dst_unused:UNUSED_PAD src0_sel:DWORD src1_sel:WORD_1
    s_waitcnt vmcnt(12)
    v_mfma_f32_4x4x4_16b_bf16 v[104:107], v[142:143], v[68:69], 0 cbsz:4 abid:0
    s_nop 0
    v_mfma_f32_4x4x4_16b_bf16 v[108:111], v[142:143], v[70:71], 0 cbsz:4 abid:0
    v_lshlrev_b32_sdwa v137, v15, v115 dst_sel:DWORD dst_unused:UNUSED_PAD src0_sel:DWORD src1_sel:WORD_1
    ds_read_u16_d16_hi v132, v136 offset:32768
    ds_read_u16_d16_hi v133, v137 offset:32768
    s_waitcnt lgkmcnt(2)
    s_set_gpr_idx_on s48, 0xc
    v_pk_fma_f32 v[16:17], v[128:129], v[96:97], v[16:17] op_sel:[0,0,0] op_sel_hi:[0,1,1]
    v_pk_fma_f32 v[18:19], v[128:129], v[98:99], v[18:19] op_sel:[0,0,0] op_sel_hi:[0,1,1]
    v_pk_fma_f32 v[20:21], v[130:131], v[100:101], v[20:21] op_sel:[0,0,0] op_sel_hi:[0,1,1]
    v_pk_fma_f32 v[22:23], v[130:131], v[102:103], v[22:23] op_sel:[0,0,0] op_sel_hi:[0,1,1]
    s_set_gpr_idx_off
    s_sub_u32 s32, s32, 1
    s_cbranch_scc1 MAIN_DONE
    v_lshlrev_b32_sdwa v138, v15, v118 dst_sel:DWORD dst_unused:UNUSED_PAD src0_sel:DWORD src1_sel:WORD_1
    s_waitcnt vmcnt(11)
    v_mfma_f32_4x4x4_16b_bf16 v[96:99], v[144:145], v[72:73], 0 cbsz:4 abid:0
    s_nop 0
    v_mfma_f32_4x4x4_16b_bf16 v[100:103], v[144:145], v[74:75], 0 cbsz:4 abid:0
    v_lshlrev_b32_sdwa v139, v15, v119 dst_sel:DWORD dst_unused:UNUSED_PAD src0_sel:DWORD src1_sel:WORD_1
    ds_read_u16_d16_hi v134, v138 offset:32768
    ds_read_u16_d16_hi v135, v139 offset:32768
    s_set_gpr_idx_on s49, 0xc
    v_pk_fma_f32 v[16:17], v[128:129], v[104:105], v[16:17] op_sel:[1,0,0] op_sel_hi:[1,1,1]
    v_pk_fma_f32 v[18:19], v[128:129], v[106:107], v[18:19] op_sel:[1,0,0] op_sel_hi:[1,1,1]
    v_pk_fma_f32 v[20:21], v[130:131], v[108:109], v[20:21] op_sel:[1,0,0] op_sel_hi:[1,1,1]
    v_pk_fma_f32 v[22:23], v[130:131], v[110:111], v[22:23] op_sel:[1,0,0] op_sel_hi:[1,1,1]
    s_set_gpr_idx_off
    s_sub_u32 s32, s32, 1
    s_cbranch_scc1 MAIN_DONE
    v_mfma_f32_4x4x4_16b_bf16 v[112:115], v[172:173], v[176:177], 0 cbsz:4 abid:2
    v_lshlrev_b32_sdwa v136, v15, v120 dst_sel:DWORD dst_unused:UNUSED_PAD src0_sel:DWORD src1_sel:WORD_1
    s_waitcnt vmcnt(10)
    v_mfma_f32_4x4x4_16b_bf16 v[104:107], v[146:147], v[76:77], 0 cbsz:4 abid:0
    s_nop 0
    v_mfma_f32_4x4x4_16b_bf16 v[108:111], v[146:147], v[78:79], 0 cbsz:4 abid:0
    v_lshlrev_b32_sdwa v137, v15, v121 dst_sel:DWORD dst_unused:UNUSED_PAD src0_sel:DWORD src1_sel:WORD_1
    ds_read_u16_d16_hi v128, v136 offset:32768
    ds_read_u16_d16_hi v129, v137 offset:32768
    s_waitcnt lgkmcnt(2)
    s_set_gpr_idx_on s50, 0xc
    v_pk_fma_f32 v[16:17], v[132:133], v[96:97], v[16:17] op_sel:[0,0,0] op_sel_hi:[0,1,1]
    v_pk_fma_f32 v[18:19], v[132:133], v[98:99], v[18:19] op_sel:[0,0,0] op_sel_hi:[0,1,1]
    v_pk_fma_f32 v[20:21], v[134:135], v[100:101], v[20:21] op_sel:[0,0,0] op_sel_hi:[0,1,1]
    v_pk_fma_f32 v[22:23], v[134:135], v[102:103], v[22:23] op_sel:[0,0,0] op_sel_hi:[0,1,1]
    s_set_gpr_idx_off
    s_sub_u32 s32, s32, 1
    s_cbranch_scc1 MAIN_DONE
    v_lshlrev_b32_sdwa v138, v15, v124 dst_sel:DWORD dst_unused:UNUSED_PAD src0_sel:DWORD src1_sel:WORD_1
    s_waitcnt vmcnt(9)
    v_mfma_f32_4x4x4_16b_bf16 v[96:99], v[140:141], v[80:81], 0 cbsz:4 abid:1
    s_nop 0
    v_mfma_f32_4x4x4_16b_bf16 v[100:103], v[140:141], v[82:83], 0 cbsz:4 abid:1
    v_lshlrev_b32_sdwa v139, v15, v125 dst_sel:DWORD dst_unused:UNUSED_PAD src0_sel:DWORD src1_sel:WORD_1
    ds_read_u16_d16_hi v130, v138 offset:32768
    ds_read_u16_d16_hi v131, v139 offset:32768
    s_set_gpr_idx_on s51, 0xc
    v_pk_fma_f32 v[16:17], v[132:133], v[104:105], v[16:17] op_sel:[1,0,0] op_sel_hi:[1,1,1]
    v_pk_fma_f32 v[18:19], v[132:133], v[106:107], v[18:19] op_sel:[1,0,0] op_sel_hi:[1,1,1]
    v_pk_fma_f32 v[20:21], v[134:135], v[108:109], v[20:21] op_sel:[1,0,0] op_sel_hi:[1,1,1]
    v_pk_fma_f32 v[22:23], v[134:135], v[110:111], v[22:23] op_sel:[1,0,0] op_sel_hi:[1,1,1]
    s_set_gpr_idx_off
    s_sub_u32 s32, s32, 1
    s_cbranch_scc1 MAIN_DONE
    v_mfma_f32_4x4x4_16b_bf16 v[116:119], v[172:173], v[178:179], 0 cbsz:4 abid:2
    v_lshlrev_b32_sdwa v136, v15, v122 dst_sel:DWORD dst_unused:UNUSED_PAD src0_sel:DWORD src1_sel:WORD_1
    s_waitcnt vmcnt(8)
    v_mfma_f32_4x4x4_16b_bf16 v[104:107], v[142:143], v[84:85], 0 cbsz:4 abid:1
    s_nop 0
    v_mfma_f32_4x4x4_16b_bf16 v[108:111], v[142:143], v[86:87], 0 cbsz:4 abid:1
    v_lshlrev_b32_sdwa v137, v15, v123 dst_sel:DWORD dst_unused:UNUSED_PAD src0_sel:DWORD src1_sel:WORD_1
    ds_read_u16_d16_hi v132, v136 offset:32768
    ds_read_u16_d16_hi v133, v137 offset:32768
    s_waitcnt lgkmcnt(2)
    s_set_gpr_idx_on s52, 0xc
    v_pk_fma_f32 v[16:17], v[128:129], v[96:97], v[16:17] op_sel:[0,0,0] op_sel_hi:[0,1,1]
    v_pk_fma_f32 v[18:19], v[128:129], v[98:99], v[18:19] op_sel:[0,0,0] op_sel_hi:[0,1,1]
    v_pk_fma_f32 v[20:21], v[130:131], v[100:101], v[20:21] op_sel:[0,0,0] op_sel_hi:[0,1,1]
    v_pk_fma_f32 v[22:23], v[130:131], v[102:103], v[22:23] op_sel:[0,0,0] op_sel_hi:[0,1,1]
    s_set_gpr_idx_off
    s_sub_u32 s32, s32, 1
    s_cbranch_scc1 MAIN_DONE
    v_lshlrev_b32_sdwa v138, v15, v126 dst_sel:DWORD dst_unused:UNUSED_PAD src0_sel:DWORD src1_sel:WORD_1
    v_mfma_f32_4x4x4_16b_bf16 v[96:99], v[144:145], v[88:89], 0 cbsz:4 abid:1
    s_nop 0
    v_mfma_f32_4x4x4_16b_bf16 v[100:103], v[144:145], v[90:91], 0 cbsz:4 abid:1
    v_lshlrev_b32_sdwa v139, v15, v127 dst_sel:DWORD dst_unused:UNUSED_PAD src0_sel:DWORD src1_sel:WORD_1
    ds_read_u16_d16_hi v134, v138 offset:32768
    ds_read_u16_d16_hi v135, v139 offset:32768
    s_set_gpr_idx_on s53, 0xc
    v_pk_fma_f32 v[16:17], v[128:129], v[104:105], v[16:17] op_sel:[1,0,0] op_sel_hi:[1,1,1]
    v_pk_fma_f32 v[18:19], v[128:129], v[106:107], v[18:19] op_sel:[1,0,0] op_sel_hi:[1,1,1]
    v_pk_fma_f32 v[20:21], v[130:131], v[108:109], v[20:21] op_sel:[1,0,0] op_sel_hi:[1,1,1]
    v_pk_fma_f32 v[22:23], v[130:131], v[110:111], v[22:23] op_sel:[1,0,0] op_sel_hi:[1,1,1]
    s_set_gpr_idx_off
    s_branch MAIN_DONE
B_4:
    buffer_load_dwordx4 v[188:191], v1, s[16:19], s10 offen offset:0 sc1
    buffer_load_dwordx4 v[192:195], v1, s[16:19], s10 offen offset:1024 sc1
    buffer_load_dwordx4 v[196:199], v1, s[16:19], s10 offen offset:2048 sc1
    buffer_load_dwordx4 v[200:203], v1, s[16:19], s10 offen offset:3072 sc1
    buffer_load_dwordx4 v[204:207], v1, s[16:19], s11 offen offset:0 sc1
    buffer_load_dwordx4 v[208:211], v1, s[16:19], s11 offen offset:1024 sc1
    buffer_load_dwordx4 v[212:215], v1, s[16:19], s11 offen offset:2048 sc1
    buffer_load_dwordx4 v[216:219], v1, s[16:19], s11 offen offset:3072 sc1
    s_sub_u32 s32, s32, 1
    s_cbranch_scc1 MAIN_DONE
    v_mfma_f32_4x4x4_16b_bf16 v[116:119], v[172:173], v[178:179], 0 cbsz:4 abid:2
    v_lshlrev_b32_sdwa v136, v15, v122 dst_sel:DWORD dst_unused:UNUSED_PAD src0_sel:DWORD src1_sel:WORD_1
    s_waitcnt vmcnt(12)
    v_mfma_f32_4x4x4_16b_bf16 v[104:107], v[142:143], v[84:85], 0 cbsz:4 abid:1
    s_nop 0
    v_mfma_f32_4x4x4_16b_bf16 v[108:111], v[142:143], v[86:87], 0 cbsz:4 abid:1
    v_lshlrev_b32_sdwa v137, v15, v123 dst_sel:DWORD dst_unused:UNUSED_PAD src0_sel:DWORD src1_sel:WORD_1
    ds_read_u16_d16_hi v132, v136 offset:32768
    ds_read_u16_d16_hi v133, v137 offset:32768
    s_waitcnt lgkmcnt(2)
    s_set_gpr_idx_on s52, 0xc
    v_pk_fma_f32 v[16:17], v[128:129], v[96:97], v[16:17] op_sel:[0,0,0] op_sel_hi:[0,1,1]
    v_pk_fma_f32 v[18:19], v[128:129], v[98:99], v[18:19] op_sel:[0,0,0] op_sel_hi:[0,1,1]
    v_pk_fma_f32 v[20:21], v[130:131], v[100:101], v[20:21] op_sel:[0,0,0] op_sel_hi:[0,1,1]
    v_pk_fma_f32 v[22:23], v[130:131], v[102:103], v[22:23] op_sel:[0,0,0] op_sel_hi:[0,1,1]
    s_set_gpr_idx_off
    s_sub_u32 s32, s32, 1
    s_cbranch_scc1 MAIN_DONE
    v_lshlrev_b32_sdwa v138, v15, v126 dst_sel:DWORD dst_unused:UNUSED_PAD src0_sel:DWORD src1_sel:WORD_1
    s_waitcnt vmcnt(11)
    v_mfma_f32_4x4x4_16b_bf16 v[96:99], v[144:145], v[88:89], 0 cbsz:4 abid:1
    s_nop 0
    v_mfma_f32_4x4x4_16b_bf16 v[100:103], v[144:145], v[90:91], 0 cbsz:4 abid:1
    v_lshlrev_b32_sdwa v139, v15, v127 dst_sel:DWORD dst_unused:UNUSED_PAD src0_sel:DWORD src1_sel:WORD_1
    ds_read_u16_d16_hi v134, v138 offset:32768
    ds_read_u16_d16_hi v135, v139 offset:32768
    s_set_gpr_idx_on s53, 0xc
    v_pk_fma_f32 v[16:17], v[128:129], v[104:105], v[16:17] op_sel:[1,0,0] op_sel_hi:[1,1,1]
    v_pk_fma_f32 v[18:19], v[128:129], v[106:107], v[18:19] op_sel:[1,0,0] op_sel_hi:[1,1,1]
    v_pk_fma_f32 v[20:21], v[130:131], v[108:109], v[20:21] op_sel:[1,0,0] op_sel_hi:[1,1,1]
    v_pk_fma_f32 v[22:23], v[130:131], v[110:111], v[22:23] op_sel:[1,0,0] op_sel_hi:[1,1,1]
    s_set_gpr_idx_off
    s_sub_u32 s32, s32, 1
    s_cbranch_scc1 MAIN_DONE
    v_mfma_f32_4x4x4_16b_bf16 v[120:123], v[172:173], v[176:177], 0 cbsz:4 abid:3
    v_lshlrev_b32_sdwa v136, v15, v112 dst_sel:DWORD dst_unused:UNUSED_PAD src0_sel:DWORD src1_sel:WORD_1
    s_waitcnt vmcnt(10)
    v_mfma_f32_4x4x4_16b_bf16 v[104:107], v[146:147], v[92:93], 0 cbsz:4 abid:1
    s_nop 0
    v_mfma_f32_4x4x4_16b_bf16 v[108:111], v[146:147], v[94:95], 0 cbsz:4 abid:1
    v_lshlrev_b32_sdwa v137, v15, v113 dst_sel:DWORD dst_unused:UNUSED_PAD src0_sel:DWORD src1_sel:WORD_1
    ds_read_u16_d16_hi v128, v136 offset:32768
    ds_read_u16_d16_hi v129, v137 offset:32768
    s_waitcnt lgkmcnt(2)
    s_set_gpr_idx_on s54, 0xc
    v_pk_fma_f32 v[16:17], v[132:133], v[96:97], v[16:17] op_sel:[0,0,0] op_sel_hi:[0,1,1]
    v_pk_fma_f32 v[18:19], v[132:133], v[98:99], v[18:19] op_sel:[0,0,0] op_sel_hi:[0,1,1]
    v_pk_fma_f32 v[20:21], v[134:135], v[100:101], v[20:21] op_sel:[0,0,0] op_sel_hi:[0,1,1]
    v_pk_fma_f32 v[22:23], v[134:135], v[102:103], v[22:23] op_sel:[0,0,0] op_sel_hi:[0,1,1]
    s_set_gpr_idx_off
    s_sub_u32 s32, s32, 1
    s_cbranch_scc1 MAIN_DONE
    v_lshlrev_b32_sdwa v138, v15, v116 dst_sel:DWORD dst_unused:UNUSED_PAD src0_sel:DWORD src1_sel:WORD_1
    s_waitcnt vmcnt(9)
    v_mfma_f32_4x4x4_16b_bf16 v[96:99], v[140:141], v[64:65], 0 cbsz:4 abid:2
    s_nop 0
    v_mfma_f32_4x4x4_16b_bf16 v[100:103], v[140:141], v[66:67], 0 cbsz:4 abid:2
    v_lshlrev_b32_sdwa v139, v15, v117 dst_sel:DWORD dst_unused:UNUSED_PAD src0_sel:DWORD src1_sel:WORD_1
    ds_read_u16_d16_hi v130, v138 offset:32768
    ds_read_u16_d16_hi v131, v139 offset:32768
    s_set_gpr_idx_on s55, 0xc
    v_pk_fma_f32 v[16:17], v[132:133], v[104:105], v[16:17] op_sel:[1,0,0] op_sel_hi:[1,1,1]
    v_pk_fma_f32 v[18:19], v[132:133], v[106:107], v[18:19] op_sel:[1,0,0] op_sel_hi:[1,1,1]
    v_pk_fma_f32 v[20:21], v[134:135], v[108:109], v[20:21] op_sel:[1,0,0] op_sel_hi:[1,1,1]
    v_pk_fma_f32 v[22:23], v[134:135], v[110:111], v[22:23] op_sel:[1,0,0] op_sel_hi:[1,1,1]
    s_set_gpr_idx_off
    s_sub_u32 s32, s32, 1
    s_cbranch_scc1 MAIN_DONE
    v_mfma_f32_4x4x4_16b_bf16 v[124:127], v[172:173], v[178:179], 0 cbsz:4 abid:3
    v_lshlrev_b32_sdwa v136, v15, v114 dst_sel:DWORD dst_unused:UNUSED_PAD src0_sel:DWORD src1_sel:WORD_1
    s_waitcnt vmcnt(8)
    v_mfma_f32_4x4x4_16b_bf16 v[104:107], v[142:143], v[68:69], 0 cbsz:4 abid:2
    s_nop 0
    v_mfma_f32_4x4x4_16b_bf16 v[108:111], v[142:143], v[70:71], 0 cbsz:4 abid:2
    v_lshlrev_b32_sdwa v137, v15, v115 dst_sel:DWORD dst_unused:UNUSED_PAD src0_sel:DWORD src1_sel:WORD_1
    ds_read_u16_d16_hi v132, v136 offset:32768
    ds_read_u16_d16_hi v133, v137 offset:32768
    s_waitcnt lgkmcnt(2)
    s_set_gpr_idx_on s56, 0xc
    v_pk_fma_f32 v[16:17], v[128:129], v[96:97], v[16:17] op_sel:[0,0,0] op_sel_hi:[0,1,1]
    v_pk_fma_f32 v[18:19], v[128:129], v[98:99], v[18:19] op_sel:[0,0,0] op_sel_hi:[0,1,1]
    v_pk_fma_f32 v[20:21], v[130:131], v[100:101], v[20:21] op_sel:[0,0,0] op_sel_hi:[0,1,1]
    v_pk_fma_f32 v[22:23], v[130:131], v[102:103], v[22:23] op_sel:[0,0,0] op_sel_hi:[0,1,1]
    s_set_gpr_idx_off
    s_sub_u32 s32, s32, 1
    s_cbranch_scc1 MAIN_DONE
    v_lshlrev_b32_sdwa v138, v15, v118 dst_sel:DWORD dst_unused:UNUSED_PAD src0_sel:DWORD src1_sel:WORD_1
    v_mfma_f32_4x4x4_16b_bf16 v[96:99], v[144:145], v[72:73], 0 cbsz:4 abid:2
    s_nop 0
    v_mfma_f32_4x4x4_16b_bf16 v[100:103], v[144:145], v[74:75], 0 cbsz:4 abid:2
    v_lshlrev_b32_sdwa v139, v15, v119 dst_sel:DWORD dst_unused:UNUSED_PAD src0_sel:DWORD src1_sel:WORD_1
    ds_read_u16_d16_hi v134, v138 offset:32768
    ds_read_u16_d16_hi v135, v139 offset:32768
    s_set_gpr_idx_on s57, 0xc
    v_pk_fma_f32 v[16:17], v[128:129], v[104:105], v[16:17] op_sel:[1,0,0] op_sel_hi:[1,1,1]
    v_pk_fma_f32 v[18:19], v[128:129], v[106:107], v[18:19] op_sel:[1,0,0] op_sel_hi:[1,1,1]
    v_pk_fma_f32 v[20:21], v[130:131], v[108:109], v[20:21] op_sel:[1,0,0] op_sel_hi:[1,1,1]
    v_pk_fma_f32 v[22:23], v[130:131], v[110:111], v[22:23] op_sel:[1,0,0] op_sel_hi:[1,1,1]
    s_set_gpr_idx_off
    s_branch MAIN_DONE
B_8:
    buffer_load_dwordx4 v[188:191], v1, s[16:19], s10 offen offset:0 sc1
    buffer_load_dwordx4 v[192:195], v1, s[16:19], s10 offen offset:1024 sc1
    buffer_load_dwordx4 v[196:199], v1, s[16:19], s10 offen offset:2048 sc1
    buffer_load_dwordx4 v[200:203], v1, s[16:19], s10 offen offset:3072 sc1
    buffer_load_dwordx4 v[204:207], v1, s[16:19], s11 offen offset:0 sc1
    buffer_load_dwordx4 v[208:211], v1, s[16:19], s11 offen offset:1024 sc1
    buffer_load_dwordx4 v[212:215], v1, s[16:19], s11 offen offset:2048 sc1
    buffer_load_dwordx4 v[216:219], v1, s[16:19], s11 offen offset:3072 sc1
    s_sub_u32 s32, s32, 1
    s_cbranch_scc1 MAIN_DONE
    v_mfma_f32_4x4x4_16b_bf16 v[124:127], v[172:173], v[178:179], 0 cbsz:4 abid:3
    v_lshlrev_b32_sdwa v136, v15, v114 dst_sel:DWORD dst_unused:UNUSED_PAD src0_sel:DWORD src1_sel:WORD_1
    s_waitcnt vmcnt(12)
    v_mfma_f32_4x4x4_16b_bf16 v[104:107], v[142:143], v[68:69], 0 cbsz:4 abid:2
    s_nop 0
    v_mfma_f32_4x4x4_16b_bf16 v[108:111], v[142:143], v[70:71], 0 cbsz:4 abid:2
    v_lshlrev_b32_sdwa v137, v15, v115 dst_sel:DWORD dst_unused:UNUSED_PAD src0_sel:DWORD src1_sel:WORD_1
    ds_read_u16_d16_hi v132, v136 offset:32768
    ds_read_u16_d16_hi v133, v137 offset:32768
    s_waitcnt lgkmcnt(2)
    s_set_gpr_idx_on s56, 0xc
    v_pk_fma_f32 v[16:17], v[128:129], v[96:97], v[16:17] op_sel:[0,0,0] op_sel_hi:[0,1,1]
    v_pk_fma_f32 v[18:19], v[128:129], v[98:99], v[18:19] op_sel:[0,0,0] op_sel_hi:[0,1,1]
    v_pk_fma_f32 v[20:21], v[130:131], v[100:101], v[20:21] op_sel:[0,0,0] op_sel_hi:[0,1,1]
    v_pk_fma_f32 v[22:23], v[130:131], v[102:103], v[22:23] op_sel:[0,0,0] op_sel_hi:[0,1,1]
    s_set_gpr_idx_off
    s_sub_u32 s32, s32, 1
    s_cbranch_scc1 MAIN_DONE
    v_lshlrev_b32_sdwa v138, v15, v118 dst_sel:DWORD dst_unused:UNUSED_PAD src0_sel:DWORD src1_sel:WORD_1
    s_waitcnt vmcnt(11)
    v_mfma_f32_4x4x4_16b_bf16 v[96:99], v[144:145], v[72:73], 0 cbsz:4 abid:2
    s_nop 0
    v_mfma_f32_4x4x4_16b_bf16 v[100:103], v[144:145], v[74:75], 0 cbsz:4 abid:2
    v_lshlrev_b32_sdwa v139, v15, v119 dst_sel:DWORD dst_unused:UNUSED_PAD src0_sel:DWORD src1_sel:WORD_1
    ds_read_u16_d16_hi v134, v138 offset:32768
    ds_read_u16_d16_hi v135, v139 offset:32768
    s_set_gpr_idx_on s57, 0xc
    v_pk_fma_f32 v[16:17], v[128:129], v[104:105], v[16:17] op_sel:[1,0,0] op_sel_hi:[1,1,1]
    v_pk_fma_f32 v[18:19], v[128:129], v[106:107], v[18:19] op_sel:[1,0,0] op_sel_hi:[1,1,1]
    v_pk_fma_f32 v[20:21], v[130:131], v[108:109], v[20:21] op_sel:[1,0,0] op_sel_hi:[1,1,1]
    v_pk_fma_f32 v[22:23], v[130:131], v[110:111], v[22:23] op_sel:[1,0,0] op_sel_hi:[1,1,1]
    s_set_gpr_idx_off
    s_sub_u32 s32, s32, 1
    s_cbranch_scc1 MAIN_DONE
    v_mfma_f32_4x4x4_16b_bf16 v[112:115], v[172:173], v[176:177], 0 cbsz:4 abid:4
    v_lshlrev_b32_sdwa v136, v15, v120 dst_sel:DWORD dst_unused:UNUSED_PAD src0_sel:DWORD src1_sel:WORD_1
    s_waitcnt vmcnt(10)
    v_mfma_f32_4x4x4_16b_bf16 v[104:107], v[146:147], v[76:77], 0 cbsz:4 abid:2
    s_nop 0
    v_mfma_f32_4x4x4_16b_bf16 v[108:111], v[146:147], v[78:79], 0 cbsz:4 abid:2
    v_lshlrev_b32_sdwa v137, v15, v121 dst_sel:DWORD dst_unused:UNUSED_PAD src0_sel:DWORD src1_sel:WORD_1
    ds_read_u16_d16_hi v128, v136 offset:32768
    ds_read_u16_d16_hi v129, v137 offset:32768
    s_waitcnt lgkmcnt(2)
    s_set_gpr_idx_on s58, 0xc
    v_pk_fma_f32 v[16:17], v[132:133], v[96:97], v[16:17] op_sel:[0,0,0] op_sel_hi:[0,1,1]
    v_pk_fma_f32 v[18:19], v[132:133], v[98:99], v[18:19] op_sel:[0,0,0] op_sel_hi:[0,1,1]
    v_pk_fma_f32 v[20:21], v[134:135], v[100:101], v[20:21] op_sel:[0,0,0] op_sel_hi:[0,1,1]
    v_pk_fma_f32 v[22:23], v[134:135], v[102:103], v[22:23] op_sel:[0,0,0] op_sel_hi:[0,1,1]
    s_set_gpr_idx_off
    s_sub_u32 s32, s32, 1
    s_cbranch_scc1 MAIN_DONE
    v_lshlrev_b32_sdwa v138, v15, v124 dst_sel:DWORD dst_unused:UNUSED_PAD src0_sel:DWORD src1_sel:WORD_1
    s_waitcnt vmcnt(9)
    v_mfma_f32_4x4x4_16b_bf16 v[96:99], v[140:141], v[80:81], 0 cbsz:4 abid:3
    s_nop 0
    v_mfma_f32_4x4x4_16b_bf16 v[100:103], v[140:141], v[82:83], 0 cbsz:4 abid:3
    v_lshlrev_b32_sdwa v139, v15, v125 dst_sel:DWORD dst_unused:UNUSED_PAD src0_sel:DWORD src1_sel:WORD_1
    ds_read_u16_d16_hi v130, v138 offset:32768
    ds_read_u16_d16_hi v131, v139 offset:32768
    s_set_gpr_idx_on s59, 0xc
    v_pk_fma_f32 v[16:17], v[132:133], v[104:105], v[16:17] op_sel:[1,0,0] op_sel_hi:[1,1,1]
    v_pk_fma_f32 v[18:19], v[132:133], v[106:107], v[18:19] op_sel:[1,0,0] op_sel_hi:[1,1,1]
    v_pk_fma_f32 v[20:21], v[134:135], v[108:109], v[20:21] op_sel:[1,0,0] op_sel_hi:[1,1,1]
    v_pk_fma_f32 v[22:23], v[134:135], v[110:111], v[22:23] op_sel:[1,0,0] op_sel_hi:[1,1,1]
    s_set_gpr_idx_off
    s_sub_u32 s32, s32, 1
    s_cbranch_scc1 MAIN_DONE
    v_mfma_f32_4x4x4_16b_bf16 v[116:119], v[172:173], v[178:179], 0 cbsz:4 abid:4
    v_lshlrev_b32_sdwa v136, v15, v122 dst_sel:DWORD dst_unused:UNUSED_PAD src0_sel:DWORD src1_sel:WORD_1
    s_waitcnt vmcnt(8)
    v_mfma_f32_4x4x4_16b_bf16 v[104:107], v[142:143], v[84:85], 0 cbsz:4 abid:3
    s_nop 0
    v_mfma_f32_4x4x4_16b_bf16 v[108:111], v[142:143], v[86:87], 0 cbsz:4 abid:3
    v_lshlrev_b32_sdwa v137, v15, v123 dst_sel:DWORD dst_unused:UNUSED_PAD src0_sel:DWORD src1_sel:WORD_1
    ds_read_u16_d16_hi v132, v136 offset:32768
    ds_read_u16_d16_hi v133, v137 offset:32768
    s_waitcnt lgkmcnt(2)
    s_set_gpr_idx_on s60, 0xc
    v_pk_fma_f32 v[16:17], v[128:129], v[96:97], v[16:17] op_sel:[0,0,0] op_sel_hi:[0,1,1]
    v_pk_fma_f32 v[18:19], v[128:129], v[98:99], v[18:19] op_sel:[0,0,0] op_sel_hi:[0,1,1]
    v_pk_fma_f32 v[20:21], v[130:131], v[100:101], v[20:21] op_sel:[0,0,0] op_sel_hi:[0,1,1]
    v_pk_fma_f32 v[22:23], v[130:131], v[102:103], v[22:23] op_sel:[0,0,0] op_sel_hi:[0,1,1]
    s_set_gpr_idx_off
    s_sub_u32 s32, s32, 1
    s_cbranch_scc1 MAIN_DONE
    v_lshlrev_b32_sdwa v138, v15, v126 dst_sel:DWORD dst_unused:UNUSED_PAD src0_sel:DWORD src1_sel:WORD_1
    v_mfma_f32_4x4x4_16b_bf16 v[96:99], v[144:145], v[88:89], 0 cbsz:4 abid:3
    s_nop 0
    v_mfma_f32_4x4x4_16b_bf16 v[100:103], v[144:145], v[90:91], 0 cbsz:4 abid:3
    v_lshlrev_b32_sdwa v139, v15, v127 dst_sel:DWORD dst_unused:UNUSED_PAD src0_sel:DWORD src1_sel:WORD_1
    ds_read_u16_d16_hi v134, v138 offset:32768
    ds_read_u16_d16_hi v135, v139 offset:32768
    s_set_gpr_idx_on s61, 0xc
    v_pk_fma_f32 v[16:17], v[128:129], v[104:105], v[16:17] op_sel:[1,0,0] op_sel_hi:[1,1,1]
    v_pk_fma_f32 v[18:19], v[128:129], v[106:107], v[18:19] op_sel:[1,0,0] op_sel_hi:[1,1,1]
    v_pk_fma_f32 v[20:21], v[130:131], v[108:109], v[20:21] op_sel:[1,0,0] op_sel_hi:[1,1,1]
    v_pk_fma_f32 v[22:23], v[130:131], v[110:111], v[22:23] op_sel:[1,0,0] op_sel_hi:[1,1,1]
    s_set_gpr_idx_off
    s_branch MAIN_DONE
B_12:
    buffer_load_dwordx4 v[188:191], v1, s[16:19], s10 offen offset:0 sc1
    buffer_load_dwordx4 v[192:195], v1, s[16:19], s10 offen offset:1024 sc1
    buffer_load_dwordx4 v[196:199], v1, s[16:19], s10 offen offset:2048 sc1
    buffer_load_dwordx4 v[200:203], v1, s[16:19], s10 offen offset:3072 sc1
    buffer_load_dwordx4 v[204:207], v1, s[16:19], s11 offen offset:0 sc1
    buffer_load_dwordx4 v[208:211], v1, s[16:19], s11 offen offset:1024 sc1
    buffer_load_dwordx4 v[212:215], v1, s[16:19], s11 offen offset:2048 sc1
    buffer_load_dwordx4 v[216:219], v1, s[16:19], s11 offen offset:3072 sc1
    s_sub_u32 s32, s32, 1
    s_cbranch_scc1 MAIN_DONE
    v_mfma_f32_4x4x4_16b_bf16 v[116:119], v[172:173], v[178:179], 0 cbsz:4 abid:4
    v_lshlrev_b32_sdwa v136, v15, v122 dst_sel:DWORD dst_unused:UNUSED_PAD src0_sel:DWORD src1_sel:WORD_1
    s_waitcnt vmcnt(12)
    v_mfma_f32_4x4x4_16b_bf16 v[104:107], v[142:143], v[84:85], 0 cbsz:4 abid:3
    s_nop 0
    v_mfma_f32_4x4x4_16b_bf16 v[108:111], v[142:143], v[86:87], 0 cbsz:4 abid:3
    v_lshlrev_b32_sdwa v137, v15, v123 dst_sel:DWORD dst_unused:UNUSED_PAD src0_sel:DWORD src1_sel:WORD_1
    ds_read_u16_d16_hi v132, v136 offset:32768
    ds_read_u16_d16_hi v133, v137 offset:32768
    s_waitcnt lgkmcnt(2)
    s_set_gpr_idx_on s60, 0xc
    v_pk_fma_f32 v[16:17], v[128:129], v[96:97], v[16:17] op_sel:[0,0,0] op_sel_hi:[0,1,1]
    v_pk_fma_f32 v[18:19], v[128:129], v[98:99], v[18:19] op_sel:[0,0,0] op_sel_hi:[0,1,1]
    v_pk_fma_f32 v[20:21], v[130:131], v[100:101], v[20:21] op_sel:[0,0,0] op_sel_hi:[0,1,1]
    v_pk_fma_f32 v[22:23], v[130:131], v[102:103], v[22:23] op_sel:[0,0,0] op_sel_hi:[0,1,1]
    s_set_gpr_idx_off
    s_sub_u32 s32, s32, 1
    s_cbranch_scc1 MAIN_DONE
    v_lshlrev_b32_sdwa v138, v15, v126 dst_sel:DWORD dst_unused:UNUSED_PAD src0_sel:DWORD src1_sel:WORD_1
    s_waitcnt vmcnt(11)
    v_mfma_f32_4x4x4_16b_bf16 v[96:99], v[144:145], v[88:89], 0 cbsz:4 abid:3
    s_nop 0
    v_mfma_f32_4x4x4_16b_bf16 v[100:103], v[144:145], v[90:91], 0 cbsz:4 abid:3
    v_lshlrev_b32_sdwa v139, v15, v127 dst_sel:DWORD dst_unused:UNUSED_PAD src0_sel:DWORD src1_sel:WORD_1
    ds_read_u16_d16_hi v134, v138 offset:32768
    ds_read_u16_d16_hi v135, v139 offset:32768
    s_set_gpr_idx_on s61, 0xc
    v_pk_fma_f32 v[16:17], v[128:129], v[104:105], v[16:17] op_sel:[1,0,0] op_sel_hi:[1,1,1]
    v_pk_fma_f32 v[18:19], v[128:129], v[106:107], v[18:19] op_sel:[1,0,0] op_sel_hi:[1,1,1]
    v_pk_fma_f32 v[20:21], v[130:131], v[108:109], v[20:21] op_sel:[1,0,0] op_sel_hi:[1,1,1]
    v_pk_fma_f32 v[22:23], v[130:131], v[110:111], v[22:23] op_sel:[1,0,0] op_sel_hi:[1,1,1]
    s_set_gpr_idx_off
    s_sub_u32 s32, s32, 1
    s_cbranch_scc1 MAIN_DONE
    v_mfma_f32_4x4x4_16b_bf16 v[120:123], v[172:173], v[176:177], 0 cbsz:4 abid:5
    v_lshlrev_b32_sdwa v136, v15, v112 dst_sel:DWORD dst_unused:UNUSED_PAD src0_sel:DWORD src1_sel:WORD_1
    s_waitcnt vmcnt(10)
    v_mfma_f32_4x4x4_16b_bf16 v[104:107], v[146:147], v[92:93], 0 cbsz:4 abid:3
    s_nop 0
    v_mfma_f32_4x4x4_16b_bf16 v[108:111], v[146:147], v[94:95], 0 cbsz:4 abid:3
    v_lshlrev_b32_sdwa v137, v15, v113 dst_sel:DWORD dst_unused:UNUSED_PAD src0_sel:DWORD src1_sel:WORD_1
    ds_read_u16_d16_hi v128, v136 offset:32768
    ds_read_u16_d16_hi v129, v137 offset:32768
    s_waitcnt lgkmcnt(2)
    s_set_gpr_idx_on s62, 0xc
    v_pk_fma_f32 v[16:17], v[132:133], v[96:97], v[16:17] op_sel:[0,0,0] op_sel_hi:[0,1,1]
    v_pk_fma_f32 v[18:19], v[132:133], v[98:99], v[18:19] op_sel:[0,0,0] op_sel_hi:[0,1,1]
    v_pk_fma_f32 v[20:21], v[134:135], v[100:101], v[20:21] op_sel:[0,0,0] op_sel_hi:[0,1,1]
    v_pk_fma_f32 v[22:23], v[134:135], v[102:103], v[22:23] op_sel:[0,0,0] op_sel_hi:[0,1,1]
    s_set_gpr_idx_off
    s_sub_u32 s32, s32, 1
    s_cbranch_scc1 MAIN_DONE
    v_lshlrev_b32_sdwa v138, v15, v116 dst_sel:DWORD dst_unused:UNUSED_PAD src0_sel:DWORD src1_sel:WORD_1
    s_waitcnt vmcnt(9)
    v_mfma_f32_4x4x4_16b_bf16 v[96:99], v[140:141], v[64:65], 0 cbsz:4 abid:4
    s_nop 0
    v_mfma_f32_4x4x4_16b_bf16 v[100:103], v[140:141], v[66:67], 0 cbsz:4 abid:4
    v_lshlrev_b32_sdwa v139, v15, v117 dst_sel:DWORD dst_unused:UNUSED_PAD src0_sel:DWORD src1_sel:WORD_1
    ds_read_u16_d16_hi v130, v138 offset:32768
    ds_read_u16_d16_hi v131, v139 offset:32768
    s_set_gpr_idx_on s63, 0xc
    v_pk_fma_f32 v[16:17], v[132:133], v[104:105], v[16:17] op_sel:[1,0,0] op_sel_hi:[1,1,1]
    v_pk_fma_f32 v[18:19], v[132:133], v[106:107], v[18:19] op_sel:[1,0,0] op_sel_hi:[1,1,1]
    v_pk_fma_f32 v[20:21], v[134:135], v[108:109], v[20:21] op_sel:[1,0,0] op_sel_hi:[1,1,1]
    v_pk_fma_f32 v[22:23], v[134:135], v[110:111], v[22:23] op_sel:[1,0,0] op_sel_hi:[1,1,1]
    s_set_gpr_idx_off
    s_sub_u32 s32, s32, 1
    s_cbranch_scc1 MAIN_DONE
    v_mfma_f32_4x4x4_16b_bf16 v[124:127], v[172:173], v[178:179], 0 cbsz:4 abid:5
    v_lshlrev_b32_sdwa v136, v15, v114 dst_sel:DWORD dst_unused:UNUSED_PAD src0_sel:DWORD src1_sel:WORD_1
    s_waitcnt vmcnt(8)
    v_mfma_f32_4x4x4_16b_bf16 v[104:107], v[142:143], v[68:69], 0 cbsz:4 abid:4
    s_nop 0
    v_mfma_f32_4x4x4_16b_bf16 v[108:111], v[142:143], v[70:71], 0 cbsz:4 abid:4
    v_lshlrev_b32_sdwa v137, v15, v115 dst_sel:DWORD dst_unused:UNUSED_PAD src0_sel:DWORD src1_sel:WORD_1
    ds_read_u16_d16_hi v132, v136 offset:32768
    ds_read_u16_d16_hi v133, v137 offset:32768
    s_waitcnt lgkmcnt(2)
    s_set_gpr_idx_on s48, 0xc
    v_pk_fma_f32 v[16:17], v[128:129], v[96:97], v[16:17] op_sel:[0,0,0] op_sel_hi:[0,1,1]
    v_pk_fma_f32 v[18:19], v[128:129], v[98:99], v[18:19] op_sel:[0,0,0] op_sel_hi:[0,1,1]
    v_pk_fma_f32 v[20:21], v[130:131], v[100:101], v[20:21] op_sel:[0,0,0] op_sel_hi:[0,1,1]
    v_pk_fma_f32 v[22:23], v[130:131], v[102:103], v[22:23] op_sel:[0,0,0] op_sel_hi:[0,1,1]
    s_set_gpr_idx_off
    s_sub_u32 s32, s32, 1
    s_cbranch_scc1 MAIN_DONE
    v_lshlrev_b32_sdwa v138, v15, v118 dst_sel:DWORD dst_unused:UNUSED_PAD src0_sel:DWORD src1_sel:WORD_1
    v_mfma_f32_4x4x4_16b_bf16 v[96:99], v[144:145], v[72:73], 0 cbsz:4 abid:4
    s_nop 0
    v_mfma_f32_4x4x4_16b_bf16 v[100:103], v[144:145], v[74:75], 0 cbsz:4 abid:4
    v_lshlrev_b32_sdwa v139, v15, v119 dst_sel:DWORD dst_unused:UNUSED_PAD src0_sel:DWORD src1_sel:WORD_1
    ds_read_u16_d16_hi v134, v138 offset:32768
    ds_read_u16_d16_hi v135, v139 offset:32768
    s_set_gpr_idx_on s49, 0xc
    v_pk_fma_f32 v[16:17], v[128:129], v[104:105], v[16:17] op_sel:[1,0,0] op_sel_hi:[1,1,1]
    v_pk_fma_f32 v[18:19], v[128:129], v[106:107], v[18:19] op_sel:[1,0,0] op_sel_hi:[1,1,1]
    v_pk_fma_f32 v[20:21], v[130:131], v[108:109], v[20:21] op_sel:[1,0,0] op_sel_hi:[1,1,1]
    v_pk_fma_f32 v[22:23], v[130:131], v[110:111], v[22:23] op_sel:[1,0,0] op_sel_hi:[1,1,1]
    s_set_gpr_idx_off
    s_branch MAIN_DONE
B_16:
    buffer_load_dwordx4 v[188:191], v1, s[16:19], s10 offen offset:0 sc1
    buffer_load_dwordx4 v[192:195], v1, s[16:19], s10 offen offset:1024 sc1
    buffer_load_dwordx4 v[196:199], v1, s[16:19], s10 offen offset:2048 sc1
    buffer_load_dwordx4 v[200:203], v1, s[16:19], s10 offen offset:3072 sc1
    buffer_load_dwordx4 v[204:207], v1, s[16:19], s11 offen offset:0 sc1
    buffer_load_dwordx4 v[208:211], v1, s[16:19], s11 offen offset:1024 sc1
    buffer_load_dwordx4 v[212:215], v1, s[16:19], s11 offen offset:2048 sc1
    buffer_load_dwordx4 v[216:219], v1, s[16:19], s11 offen offset:3072 sc1
    s_sub_u32 s32, s32, 1
    s_cbranch_scc1 MAIN_DONE
    v_mfma_f32_4x4x4_16b_bf16 v[124:127], v[172:173], v[178:179], 0 cbsz:4 abid:5
    v_lshlrev_b32_sdwa v136, v15, v114 dst_sel:DWORD dst_unused:UNUSED_PAD src0_sel:DWORD src1_sel:WORD_1
    s_waitcnt vmcnt(12)
    v_mfma_f32_4x4x4_16b_bf16 v[104:107], v[142:143], v[68:69], 0 cbsz:4 abid:4
    s_nop 0
    v_mfma_f32_4x4x4_16b_bf16 v[108:111], v[142:143], v[70:71], 0 cbsz:4 abid:4
    v_lshlrev_b32_sdwa v137, v15, v115 dst_sel:DWORD dst_unused:UNUSED_PAD src0_sel:DWORD src1_sel:WORD_1
    ds_read_u16_d16_hi v132, v136 offset:32768
    ds_read_u16_d16_hi v133, v137 offset:32768
    s_waitcnt lgkmcnt(2)
    s_set_gpr_idx_on s48, 0xc
    v_pk_fma_f32 v[16:17], v[128:129], v[96:97], v[16:17] op_sel:[0,0,0] op_sel_hi:[0,1,1]
    v_pk_fma_f32 v[18:19], v[128:129], v[98:99], v[18:19] op_sel:[0,0,0] op_sel_hi:[0,1,1]
    v_pk_fma_f32 v[20:21], v[130:131], v[100:101], v[20:21] op_sel:[0,0,0] op_sel_hi:[0,1,1]
    v_pk_fma_f32 v[22:23], v[130:131], v[102:103], v[22:23] op_sel:[0,0,0] op_sel_hi:[0,1,1]
    s_set_gpr_idx_off
    s_sub_u32 s32, s32, 1
    s_cbranch_scc1 MAIN_DONE
    v_lshlrev_b32_sdwa v138, v15, v118 dst_sel:DWORD dst_unused:UNUSED_PAD src0_sel:DWORD src1_sel:WORD_1
    s_waitcnt vmcnt(11)
    v_mfma_f32_4x4x4_16b_bf16 v[96:99], v[144:145], v[72:73], 0 cbsz:4 abid:4
    s_nop 0
    v_mfma_f32_4x4x4_16b_bf16 v[100:103], v[144:145], v[74:75], 0 cbsz:4 abid:4
    v_lshlrev_b32_sdwa v139, v15, v119 dst_sel:DWORD dst_unused:UNUSED_PAD src0_sel:DWORD src1_sel:WORD_1
    ds_read_u16_d16_hi v134, v138 offset:32768
    ds_read_u16_d16_hi v135, v139 offset:32768
    s_set_gpr_idx_on s49, 0xc
    v_pk_fma_f32 v[16:17], v[128:129], v[104:105], v[16:17] op_sel:[1,0,0] op_sel_hi:[1,1,1]
    v_pk_fma_f32 v[18:19], v[128:129], v[106:107], v[18:19] op_sel:[1,0,0] op_sel_hi:[1,1,1]
    v_pk_fma_f32 v[20:21], v[130:131], v[108:109], v[20:21] op_sel:[1,0,0] op_sel_hi:[1,1,1]
    v_pk_fma_f32 v[22:23], v[130:131], v[110:111], v[22:23] op_sel:[1,0,0] op_sel_hi:[1,1,1]
    s_set_gpr_idx_off
    s_sub_u32 s32, s32, 1
    s_cbranch_scc1 MAIN_DONE
    v_mfma_f32_4x4x4_16b_bf16 v[112:115], v[172:173], v[176:177], 0 cbsz:4 abid:6
    v_lshlrev_b32_sdwa v136, v15, v120 dst_sel:DWORD dst_unused:UNUSED_PAD src0_sel:DWORD src1_sel:WORD_1
    s_waitcnt vmcnt(10)
    v_mfma_f32_4x4x4_16b_bf16 v[104:107], v[146:147], v[76:77], 0 cbsz:4 abid:4
    s_nop 0
    v_mfma_f32_4x4x4_16b_bf16 v[108:111], v[146:147], v[78:79], 0 cbsz:4 abid:4
    v_lshlrev_b32_sdwa v137, v15, v121 dst_sel:DWORD dst_unused:UNUSED_PAD src0_sel:DWORD src1_sel:WORD_1
    ds_read_u16_d16_hi v128, v136 offset:32768
    ds_read_u16_d16_hi v129, v137 offset:32768
    s_waitcnt lgkmcnt(2)
    s_set_gpr_idx_on s50, 0xc
    v_pk_fma_f32 v[16:17], v[132:133], v[96:97], v[16:17] op_sel:[0,0,0] op_sel_hi:[0,1,1]
    v_pk_fma_f32 v[18:19], v[132:133], v[98:99], v[18:19] op_sel:[0,0,0] op_sel_hi:[0,1,1]
    v_pk_fma_f32 v[20:21], v[134:135], v[100:101], v[20:21] op_sel:[0,0,0] op_sel_hi:[0,1,1]
    v_pk_fma_f32 v[22:23], v[134:135], v[102:103], v[22:23] op_sel:[0,0,0] op_sel_hi:[0,1,1]
    s_set_gpr_idx_off
    s_sub_u32 s32, s32, 1
    s_cbranch_scc1 MAIN_DONE
    v_lshlrev_b32_sdwa v138, v15, v124 dst_sel:DWORD dst_unused:UNUSED_PAD src0_sel:DWORD src1_sel:WORD_1
    s_waitcnt vmcnt(9)
    v_mfma_f32_4x4x4_16b_bf16 v[96:99], v[140:141], v[80:81], 0 cbsz:4 abid:5
    s_nop 0
    v_mfma_f32_4x4x4_16b_bf16 v[100:103], v[140:141], v[82:83], 0 cbsz:4 abid:5
    v_lshlrev_b32_sdwa v139, v15, v125 dst_sel:DWORD dst_unused:UNUSED_PAD src0_sel:DWORD src1_sel:WORD_1
    ds_read_u16_d16_hi v130, v138 offset:32768
    ds_read_u16_d16_hi v131, v139 offset:32768
    s_set_gpr_idx_on s51, 0xc
    v_pk_fma_f32 v[16:17], v[132:133], v[104:105], v[16:17] op_sel:[1,0,0] op_sel_hi:[1,1,1]
    v_pk_fma_f32 v[18:19], v[132:133], v[106:107], v[18:19] op_sel:[1,0,0] op_sel_hi:[1,1,1]
    v_pk_fma_f32 v[20:21], v[134:135], v[108:109], v[20:21] op_sel:[1,0,0] op_sel_hi:[1,1,1]
    v_pk_fma_f32 v[22:23], v[134:135], v[110:111], v[22:23] op_sel:[1,0,0] op_sel_hi:[1,1,1]
    s_set_gpr_idx_off
    s_sub_u32 s32, s32, 1
    s_cbranch_scc1 MAIN_DONE
    v_mfma_f32_4x4x4_16b_bf16 v[116:119], v[172:173], v[178:179], 0 cbsz:4 abid:6
    v_lshlrev_b32_sdwa v136, v15, v122 dst_sel:DWORD dst_unused:UNUSED_PAD src0_sel:DWORD src1_sel:WORD_1
    s_waitcnt vmcnt(8)
    v_mfma_f32_4x4x4_16b_bf16 v[104:107], v[142:143], v[84:85], 0 cbsz:4 abid:5
    s_nop 0
    v_mfma_f32_4x4x4_16b_bf16 v[108:111], v[142:143], v[86:87], 0 cbsz:4 abid:5
    v_lshlrev_b32_sdwa v137, v15, v123 dst_sel:DWORD dst_unused:UNUSED_PAD src0_sel:DWORD src1_sel:WORD_1
    ds_read_u16_d16_hi v132, v136 offset:32768
    ds_read_u16_d16_hi v133, v137 offset:32768
    s_waitcnt lgkmcnt(2)
    s_set_gpr_idx_on s52, 0xc
    v_pk_fma_f32 v[16:17], v[128:129], v[96:97], v[16:17] op_sel:[0,0,0] op_sel_hi:[0,1,1]
    v_pk_fma_f32 v[18:19], v[128:129], v[98:99], v[18:19] op_sel:[0,0,0] op_sel_hi:[0,1,1]
    v_pk_fma_f32 v[20:21], v[130:131], v[100:101], v[20:21] op_sel:[0,0,0] op_sel_hi:[0,1,1]
    v_pk_fma_f32 v[22:23], v[130:131], v[102:103], v[22:23] op_sel:[0,0,0] op_sel_hi:[0,1,1]
    s_set_gpr_idx_off
    s_sub_u32 s32, s32, 1
    s_cbranch_scc1 MAIN_DONE
    v_lshlrev_b32_sdwa v138, v15, v126 dst_sel:DWORD dst_unused:UNUSED_PAD src0_sel:DWORD src1_sel:WORD_1
    v_mfma_f32_4x4x4_16b_bf16 v[96:99], v[144:145], v[88:89], 0 cbsz:4 abid:5
    s_nop 0
    v_mfma_f32_4x4x4_16b_bf16 v[100:103], v[144:145], v[90:91], 0 cbsz:4 abid:5
    v_lshlrev_b32_sdwa v139, v15, v127 dst_sel:DWORD dst_unused:UNUSED_PAD src0_sel:DWORD src1_sel:WORD_1
    ds_read_u16_d16_hi v134, v138 offset:32768
    ds_read_u16_d16_hi v135, v139 offset:32768
    s_set_gpr_idx_on s53, 0xc
    v_pk_fma_f32 v[16:17], v[128:129], v[104:105], v[16:17] op_sel:[1,0,0] op_sel_hi:[1,1,1]
    v_pk_fma_f32 v[18:19], v[128:129], v[106:107], v[18:19] op_sel:[1,0,0] op_sel_hi:[1,1,1]
    v_pk_fma_f32 v[20:21], v[130:131], v[108:109], v[20:21] op_sel:[1,0,0] op_sel_hi:[1,1,1]
    v_pk_fma_f32 v[22:23], v[130:131], v[110:111], v[22:23] op_sel:[1,0,0] op_sel_hi:[1,1,1]
    s_set_gpr_idx_off
    s_branch MAIN_DONE
B_20:
    buffer_load_dwordx4 v[188:191], v1, s[16:19], s10 offen offset:0 sc1
    buffer_load_dwordx4 v[192:195], v1, s[16:19], s10 offen offset:1024 sc1
    buffer_load_dwordx4 v[196:199], v1, s[16:19], s10 offen offset:2048 sc1
    buffer_load_dwordx4 v[200:203], v1, s[16:19], s10 offen offset:3072 sc1
    buffer_load_dwordx4 v[204:207], v1, s[16:19], s11 offen offset:0 sc1
    buffer_load_dwordx4 v[208:211], v1, s[16:19], s11 offen offset:1024 sc1
    buffer_load_dwordx4 v[212:215], v1, s[16:19], s11 offen offset:2048 sc1
    buffer_load_dwordx4 v[216:219], v1, s[16:19], s11 offen offset:3072 sc1
    s_sub_u32 s32, s32, 1
    s_cbranch_scc1 MAIN_DONE
    v_mfma_f32_4x4x4_16b_bf16 v[116:119], v[172:173], v[178:179], 0 cbsz:4 abid:6
    v_lshlrev_b32_sdwa v136, v15, v122 dst_sel:DWORD dst_unused:UNUSED_PAD src0_sel:DWORD src1_sel:WORD_1
    s_waitcnt vmcnt(12)
    v_mfma_f32_4x4x4_16b_bf16 v[104:107], v[142:143], v[84:85], 0 cbsz:4 abid:5
    s_nop 0
    v_mfma_f32_4x4x4_16b_bf16 v[108:111], v[142:143], v[86:87], 0 cbsz:4 abid:5
    v_lshlrev_b32_sdwa v137, v15, v123 dst_sel:DWORD dst_unused:UNUSED_PAD src0_sel:DWORD src1_sel:WORD_1
    ds_read_u16_d16_hi v132, v136 offset:32768
    ds_read_u16_d16_hi v133, v137 offset:32768
    s_waitcnt lgkmcnt(2)
    s_set_gpr_idx_on s52, 0xc
    v_pk_fma_f32 v[16:17], v[128:129], v[96:97], v[16:17] op_sel:[0,0,0] op_sel_hi:[0,1,1]
    v_pk_fma_f32 v[18:19], v[128:129], v[98:99], v[18:19] op_sel:[0,0,0] op_sel_hi:[0,1,1]
    v_pk_fma_f32 v[20:21], v[130:131], v[100:101], v[20:21] op_sel:[0,0,0] op_sel_hi:[0,1,1]
    v_pk_fma_f32 v[22:23], v[130:131], v[102:103], v[22:23] op_sel:[0,0,0] op_sel_hi:[0,1,1]
    s_set_gpr_idx_off
    s_sub_u32 s32, s32, 1
    s_cbranch_scc1 MAIN_DONE
    v_lshlrev_b32_sdwa v138, v15, v126 dst_sel:DWORD dst_unused:UNUSED_PAD src0_sel:DWORD src1_sel:WORD_1
    s_waitcnt vmcnt(11)
    v_mfma_f32_4x4x4_16b_bf16 v[96:99], v[144:145], v[88:89], 0 cbsz:4 abid:5
    s_nop 0
    v_mfma_f32_4x4x4_16b_bf16 v[100:103], v[144:145], v[90:91], 0 cbsz:4 abid:5
    v_lshlrev_b32_sdwa v139, v15, v127 dst_sel:DWORD dst_unused:UNUSED_PAD src0_sel:DWORD src1_sel:WORD_1
    ds_read_u16_d16_hi v134, v138 offset:32768
    ds_read_u16_d16_hi v135, v139 offset:32768
    s_set_gpr_idx_on s53, 0xc
    v_pk_fma_f32 v[16:17], v[128:129], v[104:105], v[16:17] op_sel:[1,0,0] op_sel_hi:[1,1,1]
    v_pk_fma_f32 v[18:19], v[128:129], v[106:107], v[18:19] op_sel:[1,0,0] op_sel_hi:[1,1,1]
    v_pk_fma_f32 v[20:21], v[130:131], v[108:109], v[20:21] op_sel:[1,0,0] op_sel_hi:[1,1,1]
    v_pk_fma_f32 v[22:23], v[130:131], v[110:111], v[22:23] op_sel:[1,0,0] op_sel_hi:[1,1,1]
    s_set_gpr_idx_off
    s_sub_u32 s32, s32, 1
    s_cbranch_scc1 MAIN_DONE
    v_mfma_f32_4x4x4_16b_bf16 v[120:123], v[172:173], v[176:177], 0 cbsz:4 abid:7
    v_lshlrev_b32_sdwa v136, v15, v112 dst_sel:DWORD dst_unused:UNUSED_PAD src0_sel:DWORD src1_sel:WORD_1
    s_waitcnt vmcnt(10)
    v_mfma_f32_4x4x4_16b_bf16 v[104:107], v[146:147], v[92:93], 0 cbsz:4 abid:5
    s_nop 0
    v_mfma_f32_4x4x4_16b_bf16 v[108:111], v[146:147], v[94:95], 0 cbsz:4 abid:5
    v_lshlrev_b32_sdwa v137, v15, v113 dst_sel:DWORD dst_unused:UNUSED_PAD src0_sel:DWORD src1_sel:WORD_1
    ds_read_u16_d16_hi v128, v136 offset:32768
    ds_read_u16_d16_hi v129, v137 offset:32768
    s_waitcnt lgkmcnt(2)
    s_set_gpr_idx_on s54, 0xc
    v_pk_fma_f32 v[16:17], v[132:133], v[96:97], v[16:17] op_sel:[0,0,0] op_sel_hi:[0,1,1]
    v_pk_fma_f32 v[18:19], v[132:133], v[98:99], v[18:19] op_sel:[0,0,0] op_sel_hi:[0,1,1]
    v_pk_fma_f32 v[20:21], v[134:135], v[100:101], v[20:21] op_sel:[0,0,0] op_sel_hi:[0,1,1]
    v_pk_fma_f32 v[22:23], v[134:135], v[102:103], v[22:23] op_sel:[0,0,0] op_sel_hi:[0,1,1]
    s_set_gpr_idx_off
    s_sub_u32 s32, s32, 1
    s_cbranch_scc1 MAIN_DONE
    v_lshlrev_b32_sdwa v138, v15, v116 dst_sel:DWORD dst_unused:UNUSED_PAD src0_sel:DWORD src1_sel:WORD_1
    s_waitcnt vmcnt(9)
    v_mfma_f32_4x4x4_16b_bf16 v[96:99], v[140:141], v[64:65], 0 cbsz:4 abid:6
    s_nop 0
    v_mfma_f32_4x4x4_16b_bf16 v[100:103], v[140:141], v[66:67], 0 cbsz:4 abid:6
    v_lshlrev_b32_sdwa v139, v15, v117 dst_sel:DWORD dst_unused:UNUSED_PAD src0_sel:DWORD src1_sel:WORD_1
    ds_read_u16_d16_hi v130, v138 offset:32768
    ds_read_u16_d16_hi v131, v139 offset:32768
    s_set_gpr_idx_on s55, 0xc
    v_pk_fma_f32 v[16:17], v[132:133], v[104:105], v[16:17] op_sel:[1,0,0] op_sel_hi:[1,1,1]
    v_pk_fma_f32 v[18:19], v[132:133], v[106:107], v[18:19] op_sel:[1,0,0] op_sel_hi:[1,1,1]
    v_pk_fma_f32 v[20:21], v[134:135], v[108:109], v[20:21] op_sel:[1,0,0] op_sel_hi:[1,1,1]
    v_pk_fma_f32 v[22:23], v[134:135], v[110:111], v[22:23] op_sel:[1,0,0] op_sel_hi:[1,1,1]
    s_set_gpr_idx_off
    s_sub_u32 s32, s32, 1
    s_cbranch_scc1 MAIN_DONE
    v_mfma_f32_4x4x4_16b_bf16 v[124:127], v[172:173], v[178:179], 0 cbsz:4 abid:7
    v_lshlrev_b32_sdwa v136, v15, v114 dst_sel:DWORD dst_unused:UNUSED_PAD src0_sel:DWORD src1_sel:WORD_1
    s_waitcnt vmcnt(8)
    v_mfma_f32_4x4x4_16b_bf16 v[104:107], v[142:143], v[68:69], 0 cbsz:4 abid:6
    s_nop 0
    v_mfma_f32_4x4x4_16b_bf16 v[108:111], v[142:143], v[70:71], 0 cbsz:4 abid:6
    v_lshlrev_b32_sdwa v137, v15, v115 dst_sel:DWORD dst_unused:UNUSED_PAD src0_sel:DWORD src1_sel:WORD_1
    ds_read_u16_d16_hi v132, v136 offset:32768
    ds_read_u16_d16_hi v133, v137 offset:32768
    s_waitcnt lgkmcnt(2)
    s_set_gpr_idx_on s56, 0xc
    v_pk_fma_f32 v[16:17], v[128:129], v[96:97], v[16:17] op_sel:[0,0,0] op_sel_hi:[0,1,1]
    v_pk_fma_f32 v[18:19], v[128:129], v[98:99], v[18:19] op_sel:[0,0,0] op_sel_hi:[0,1,1]
    v_pk_fma_f32 v[20:21], v[130:131], v[100:101], v[20:21] op_sel:[0,0,0] op_sel_hi:[0,1,1]
    v_pk_fma_f32 v[22:23], v[130:131], v[102:103], v[22:23] op_sel:[0,0,0] op_sel_hi:[0,1,1]
    s_set_gpr_idx_off
    s_sub_u32 s32, s32, 1
    s_cbranch_scc1 MAIN_DONE
    v_lshlrev_b32_sdwa v138, v15, v118 dst_sel:DWORD dst_unused:UNUSED_PAD src0_sel:DWORD src1_sel:WORD_1
    v_mfma_f32_4x4x4_16b_bf16 v[96:99], v[144:145], v[72:73], 0 cbsz:4 abid:6
    s_nop 0
    v_mfma_f32_4x4x4_16b_bf16 v[100:103], v[144:145], v[74:75], 0 cbsz:4 abid:6
    v_lshlrev_b32_sdwa v139, v15, v119 dst_sel:DWORD dst_unused:UNUSED_PAD src0_sel:DWORD src1_sel:WORD_1
    ds_read_u16_d16_hi v134, v138 offset:32768
    ds_read_u16_d16_hi v135, v139 offset:32768
    s_set_gpr_idx_on s57, 0xc
    v_pk_fma_f32 v[16:17], v[128:129], v[104:105], v[16:17] op_sel:[1,0,0] op_sel_hi:[1,1,1]
    v_pk_fma_f32 v[18:19], v[128:129], v[106:107], v[18:19] op_sel:[1,0,0] op_sel_hi:[1,1,1]
    v_pk_fma_f32 v[20:21], v[130:131], v[108:109], v[20:21] op_sel:[1,0,0] op_sel_hi:[1,1,1]
    v_pk_fma_f32 v[22:23], v[130:131], v[110:111], v[22:23] op_sel:[1,0,0] op_sel_hi:[1,1,1]
    s_set_gpr_idx_off
    s_branch MAIN_DONE
B_24:
    buffer_load_dwordx4 v[188:191], v1, s[16:19], s10 offen offset:0 sc1
    buffer_load_dwordx4 v[192:195], v1, s[16:19], s10 offen offset:1024 sc1
    buffer_load_dwordx4 v[196:199], v1, s[16:19], s10 offen offset:2048 sc1
    buffer_load_dwordx4 v[200:203], v1, s[16:19], s10 offen offset:3072 sc1
    buffer_load_dwordx4 v[204:207], v1, s[16:19], s11 offen offset:0 sc1
    buffer_load_dwordx4 v[208:211], v1, s[16:19], s11 offen offset:1024 sc1
    buffer_load_dwordx4 v[212:215], v1, s[16:19], s11 offen offset:2048 sc1
    buffer_load_dwordx4 v[216:219], v1, s[16:19], s11 offen offset:3072 sc1
    s_sub_u32 s32, s32, 1
    s_cbranch_scc1 MAIN_DONE
    v_mfma_f32_4x4x4_16b_bf16 v[124:127], v[172:173], v[178:179], 0 cbsz:4 abid:7
    v_lshlrev_b32_sdwa v136, v15, v114 dst_sel:DWORD dst_unused:UNUSED_PAD src0_sel:DWORD src1_sel:WORD_1
    s_waitcnt vmcnt(12)
    v_mfma_f32_4x4x4_16b_bf16 v[104:107], v[142:143], v[68:69], 0 cbsz:4 abid:6
    s_nop 0
    v_mfma_f32_4x4x4_16b_bf16 v[108:111], v[142:143], v[70:71], 0 cbsz:4 abid:6
    v_lshlrev_b32_sdwa v137, v15, v115 dst_sel:DWORD dst_unused:UNUSED_PAD src0_sel:DWORD src1_sel:WORD_1
    ds_read_u16_d16_hi v132, v136 offset:32768
    ds_read_u16_d16_hi v133, v137 offset:32768
    s_waitcnt lgkmcnt(2)
    s_set_gpr_idx_on s56, 0xc
    v_pk_fma_f32 v[16:17], v[128:129], v[96:97], v[16:17] op_sel:[0,0,0] op_sel_hi:[0,1,1]
    v_pk_fma_f32 v[18:19], v[128:129], v[98:99], v[18:19] op_sel:[0,0,0] op_sel_hi:[0,1,1]
    v_pk_fma_f32 v[20:21], v[130:131], v[100:101], v[20:21] op_sel:[0,0,0] op_sel_hi:[0,1,1]
    v_pk_fma_f32 v[22:23], v[130:131], v[102:103], v[22:23] op_sel:[0,0,0] op_sel_hi:[0,1,1]
    s_set_gpr_idx_off
    s_sub_u32 s32, s32, 1
    s_cbranch_scc1 MAIN_DONE
    v_lshlrev_b32_sdwa v138, v15, v118 dst_sel:DWORD dst_unused:UNUSED_PAD src0_sel:DWORD src1_sel:WORD_1
    s_waitcnt vmcnt(11)
    v_mfma_f32_4x4x4_16b_bf16 v[96:99], v[144:145], v[72:73], 0 cbsz:4 abid:6
    s_nop 0
    v_mfma_f32_4x4x4_16b_bf16 v[100:103], v[144:145], v[74:75], 0 cbsz:4 abid:6
    v_lshlrev_b32_sdwa v139, v15, v119 dst_sel:DWORD dst_unused:UNUSED_PAD src0_sel:DWORD src1_sel:WORD_1
    ds_read_u16_d16_hi v134, v138 offset:32768
    ds_read_u16_d16_hi v135, v139 offset:32768
    s_set_gpr_idx_on s57, 0xc
    v_pk_fma_f32 v[16:17], v[128:129], v[104:105], v[16:17] op_sel:[1,0,0] op_sel_hi:[1,1,1]
    v_pk_fma_f32 v[18:19], v[128:129], v[106:107], v[18:19] op_sel:[1,0,0] op_sel_hi:[1,1,1]
    v_pk_fma_f32 v[20:21], v[130:131], v[108:109], v[20:21] op_sel:[1,0,0] op_sel_hi:[1,1,1]
    v_pk_fma_f32 v[22:23], v[130:131], v[110:111], v[22:23] op_sel:[1,0,0] op_sel_hi:[1,1,1]
    s_set_gpr_idx_off
    s_sub_u32 s32, s32, 1
    s_cbranch_scc1 MAIN_DONE
    v_mfma_f32_4x4x4_16b_bf16 v[112:115], v[172:173], v[176:177], 0 cbsz:4 abid:8
    v_lshlrev_b32_sdwa v136, v15, v120 dst_sel:DWORD dst_unused:UNUSED_PAD src0_sel:DWORD src1_sel:WORD_1
    s_waitcnt vmcnt(10)
    v_mfma_f32_4x4x4_16b_bf16 v[104:107], v[146:147], v[76:77], 0 cbsz:4 abid:6
    s_nop 0
    v_mfma_f32_4x4x4_16b_bf16 v[108:111], v[146:147], v[78:79], 0 cbsz:4 abid:6
    v_lshlrev_b32_sdwa v137, v15, v121 dst_sel:DWORD dst_unused:UNUSED_PAD src0_sel:DWORD src1_sel:WORD_1
    ds_read_u16_d16_hi v128, v136 offset:32768
    ds_read_u16_d16_hi v129, v137 offset:32768
    s_waitcnt lgkmcnt(2)
    s_set_gpr_idx_on s58, 0xc
    v_pk_fma_f32 v[16:17], v[132:133], v[96:97], v[16:17] op_sel:[0,0,0] op_sel_hi:[0,1,1]
    v_pk_fma_f32 v[18:19], v[132:133], v[98:99], v[18:19] op_sel:[0,0,0] op_sel_hi:[0,1,1]
    v_pk_fma_f32 v[20:21], v[134:135], v[100:101], v[20:21] op_sel:[0,0,0] op_sel_hi:[0,1,1]
    v_pk_fma_f32 v[22:23], v[134:135], v[102:103], v[22:23] op_sel:[0,0,0] op_sel_hi:[0,1,1]
    s_set_gpr_idx_off
    s_sub_u32 s32, s32, 1
    s_cbranch_scc1 MAIN_DONE
    v_lshlrev_b32_sdwa v138, v15, v124 dst_sel:DWORD dst_unused:UNUSED_PAD src0_sel:DWORD src1_sel:WORD_1
    s_waitcnt vmcnt(9)
    v_mfma_f32_4x4x4_16b_bf16 v[96:99], v[140:141], v[80:81], 0 cbsz:4 abid:7
    s_nop 0
    v_mfma_f32_4x4x4_16b_bf16 v[100:103], v[140:141], v[82:83], 0 cbsz:4 abid:7
    v_lshlrev_b32_sdwa v139, v15, v125 dst_sel:DWORD dst_unused:UNUSED_PAD src0_sel:DWORD src1_sel:WORD_1
    ds_read_u16_d16_hi v130, v138 offset:32768
    ds_read_u16_d16_hi v131, v139 offset:32768
    s_set_gpr_idx_on s59, 0xc
    v_pk_fma_f32 v[16:17], v[132:133], v[104:105], v[16:17] op_sel:[1,0,0] op_sel_hi:[1,1,1]
    v_pk_fma_f32 v[18:19], v[132:133], v[106:107], v[18:19] op_sel:[1,0,0] op_sel_hi:[1,1,1]
    v_pk_fma_f32 v[20:21], v[134:135], v[108:109], v[20:21] op_sel:[1,0,0] op_sel_hi:[1,1,1]
    v_pk_fma_f32 v[22:23], v[134:135], v[110:111], v[22:23] op_sel:[1,0,0] op_sel_hi:[1,1,1]
    s_set_gpr_idx_off
    s_sub_u32 s32, s32, 1
    s_cbranch_scc1 MAIN_DONE
    v_mfma_f32_4x4x4_16b_bf16 v[116:119], v[172:173], v[178:179], 0 cbsz:4 abid:8
    v_lshlrev_b32_sdwa v136, v15, v122 dst_sel:DWORD dst_unused:UNUSED_PAD src0_sel:DWORD src1_sel:WORD_1
    s_waitcnt vmcnt(8)
    v_mfma_f32_4x4x4_16b_bf16 v[104:107], v[142:143], v[84:85], 0 cbsz:4 abid:7
    s_nop 0
    v_mfma_f32_4x4x4_16b_bf16 v[108:111], v[142:143], v[86:87], 0 cbsz:4 abid:7
    v_lshlrev_b32_sdwa v137, v15, v123 dst_sel:DWORD dst_unused:UNUSED_PAD src0_sel:DWORD src1_sel:WORD_1
    ds_read_u16_d16_hi v132, v136 offset:32768
    ds_read_u16_d16_hi v133, v137 offset:32768
    s_waitcnt lgkmcnt(2)
    s_set_gpr_idx_on s60, 0xc
    v_pk_fma_f32 v[16:17], v[128:129], v[96:97], v[16:17] op_sel:[0,0,0] op_sel_hi:[0,1,1]
    v_pk_fma_f32 v[18:19], v[128:129], v[98:99], v[18:19] op_sel:[0,0,0] op_sel_hi:[0,1,1]
    v_pk_fma_f32 v[20:21], v[130:131], v[100:101], v[20:21] op_sel:[0,0,0] op_sel_hi:[0,1,1]
    v_pk_fma_f32 v[22:23], v[130:131], v[102:103], v[22:23] op_sel:[0,0,0] op_sel_hi:[0,1,1]
    s_set_gpr_idx_off
    s_sub_u32 s32, s32, 1
    s_cbranch_scc1 MAIN_DONE
    v_lshlrev_b32_sdwa v138, v15, v126 dst_sel:DWORD dst_unused:UNUSED_PAD src0_sel:DWORD src1_sel:WORD_1
    v_mfma_f32_4x4x4_16b_bf16 v[96:99], v[144:145], v[88:89], 0 cbsz:4 abid:7
    s_nop 0
    v_mfma_f32_4x4x4_16b_bf16 v[100:103], v[144:145], v[90:91], 0 cbsz:4 abid:7
    v_lshlrev_b32_sdwa v139, v15, v127 dst_sel:DWORD dst_unused:UNUSED_PAD src0_sel:DWORD src1_sel:WORD_1
    ds_read_u16_d16_hi v134, v138 offset:32768
    ds_read_u16_d16_hi v135, v139 offset:32768
    s_set_gpr_idx_on s61, 0xc
    v_pk_fma_f32 v[16:17], v[128:129], v[104:105], v[16:17] op_sel:[1,0,0] op_sel_hi:[1,1,1]
    v_pk_fma_f32 v[18:19], v[128:129], v[106:107], v[18:19] op_sel:[1,0,0] op_sel_hi:[1,1,1]
    v_pk_fma_f32 v[20:21], v[130:131], v[108:109], v[20:21] op_sel:[1,0,0] op_sel_hi:[1,1,1]
    v_pk_fma_f32 v[22:23], v[130:131], v[110:111], v[22:23] op_sel:[1,0,0] op_sel_hi:[1,1,1]
    s_set_gpr_idx_off
    s_branch MAIN_DONE
B_28:
    buffer_load_dwordx4 v[188:191], v1, s[16:19], s10 offen offset:0 sc1
    buffer_load_dwordx4 v[192:195], v1, s[16:19], s10 offen offset:1024 sc1
    buffer_load_dwordx4 v[196:199], v1, s[16:19], s10 offen offset:2048 sc1
    buffer_load_dwordx4 v[200:203], v1, s[16:19], s10 offen offset:3072 sc1
    buffer_load_dwordx4 v[204:207], v1, s[16:19], s11 offen offset:0 sc1
    buffer_load_dwordx4 v[208:211], v1, s[16:19], s11 offen offset:1024 sc1
    buffer_load_dwordx4 v[212:215], v1, s[16:19], s11 offen offset:2048 sc1
    buffer_load_dwordx4 v[216:219], v1, s[16:19], s11 offen offset:3072 sc1
    s_sub_u32 s32, s32, 1
    s_cbranch_scc1 MAIN_DONE
    v_mfma_f32_4x4x4_16b_bf16 v[116:119], v[172:173], v[178:179], 0 cbsz:4 abid:8
    v_lshlrev_b32_sdwa v136, v15, v122 dst_sel:DWORD dst_unused:UNUSED_PAD src0_sel:DWORD src1_sel:WORD_1
    s_waitcnt vmcnt(12)
    v_mfma_f32_4x4x4_16b_bf16 v[104:107], v[142:143], v[84:85], 0 cbsz:4 abid:7
    s_nop 0
    v_mfma_f32_4x4x4_16b_bf16 v[108:111], v[142:143], v[86:87], 0 cbsz:4 abid:7
    v_lshlrev_b32_sdwa v137, v15, v123 dst_sel:DWORD dst_unused:UNUSED_PAD src0_sel:DWORD src1_sel:WORD_1
    ds_read_u16_d16_hi v132, v136 offset:32768
    ds_read_u16_d16_hi v133, v137 offset:32768
    s_waitcnt lgkmcnt(2)
    s_set_gpr_idx_on s60, 0xc
    v_pk_fma_f32 v[16:17], v[128:129], v[96:97], v[16:17] op_sel:[0,0,0] op_sel_hi:[0,1,1]
    v_pk_fma_f32 v[18:19], v[128:129], v[98:99], v[18:19] op_sel:[0,0,0] op_sel_hi:[0,1,1]
    v_pk_fma_f32 v[20:21], v[130:131], v[100:101], v[20:21] op_sel:[0,0,0] op_sel_hi:[0,1,1]
    v_pk_fma_f32 v[22:23], v[130:131], v[102:103], v[22:23] op_sel:[0,0,0] op_sel_hi:[0,1,1]
    s_set_gpr_idx_off
    s_sub_u32 s32, s32, 1
    s_cbranch_scc1 MAIN_DONE
    v_lshlrev_b32_sdwa v138, v15, v126 dst_sel:DWORD dst_unused:UNUSED_PAD src0_sel:DWORD src1_sel:WORD_1
    s_waitcnt vmcnt(11)
    v_mfma_f32_4x4x4_16b_bf16 v[96:99], v[144:145], v[88:89], 0 cbsz:4 abid:7
    s_nop 0
    v_mfma_f32_4x4x4_16b_bf16 v[100:103], v[144:145], v[90:91], 0 cbsz:4 abid:7
    v_lshlrev_b32_sdwa v139, v15, v127 dst_sel:DWORD dst_unused:UNUSED_PAD src0_sel:DWORD src1_sel:WORD_1
    ds_read_u16_d16_hi v134, v138 offset:32768
    ds_read_u16_d16_hi v135, v139 offset:32768
    s_set_gpr_idx_on s61, 0xc
    v_pk_fma_f32 v[16:17], v[128:129], v[104:105], v[16:17] op_sel:[1,0,0] op_sel_hi:[1,1,1]
    v_pk_fma_f32 v[18:19], v[128:129], v[106:107], v[18:19] op_sel:[1,0,0] op_sel_hi:[1,1,1]
    v_pk_fma_f32 v[20:21], v[130:131], v[108:109], v[20:21] op_sel:[1,0,0] op_sel_hi:[1,1,1]
    v_pk_fma_f32 v[22:23], v[130:131], v[110:111], v[22:23] op_sel:[1,0,0] op_sel_hi:[1,1,1]
    s_set_gpr_idx_off
    s_sub_u32 s32, s32, 1
    s_cbranch_scc1 MAIN_DONE
    v_mfma_f32_4x4x4_16b_bf16 v[120:123], v[172:173], v[176:177], 0 cbsz:4 abid:9
    v_lshlrev_b32_sdwa v136, v15, v112 dst_sel:DWORD dst_unused:UNUSED_PAD src0_sel:DWORD src1_sel:WORD_1
    s_waitcnt vmcnt(10)
    v_mfma_f32_4x4x4_16b_bf16 v[104:107], v[146:147], v[92:93], 0 cbsz:4 abid:7
    s_nop 0
    v_mfma_f32_4x4x4_16b_bf16 v[108:111], v[146:147], v[94:95], 0 cbsz:4 abid:7
    v_lshlrev_b32_sdwa v137, v15, v113 dst_sel:DWORD dst_unused:UNUSED_PAD src0_sel:DWORD src1_sel:WORD_1
    ds_read_u16_d16_hi v128, v136 offset:32768
    ds_read_u16_d16_hi v129, v137 offset:32768
    s_waitcnt lgkmcnt(2)
    s_set_gpr_idx_on s62, 0xc
    v_pk_fma_f32 v[16:17], v[132:133], v[96:97], v[16:17] op_sel:[0,0,0] op_sel_hi:[0,1,1]
    v_pk_fma_f32 v[18:19], v[132:133], v[98:99], v[18:19] op_sel:[0,0,0] op_sel_hi:[0,1,1]
    v_pk_fma_f32 v[20:21], v[134:135], v[100:101], v[20:21] op_sel:[0,0,0] op_sel_hi:[0,1,1]
    v_pk_fma_f32 v[22:23], v[134:135], v[102:103], v[22:23] op_sel:[0,0,0] op_sel_hi:[0,1,1]
    s_set_gpr_idx_off
    s_sub_u32 s32, s32, 1
    s_cbranch_scc1 MAIN_DONE
    v_lshlrev_b32_sdwa v138, v15, v116 dst_sel:DWORD dst_unused:UNUSED_PAD src0_sel:DWORD src1_sel:WORD_1
    s_waitcnt vmcnt(9)
    v_mfma_f32_4x4x4_16b_bf16 v[96:99], v[140:141], v[64:65], 0 cbsz:4 abid:8
    s_nop 0
    v_mfma_f32_4x4x4_16b_bf16 v[100:103], v[140:141], v[66:67], 0 cbsz:4 abid:8
    v_lshlrev_b32_sdwa v139, v15, v117 dst_sel:DWORD dst_unused:UNUSED_PAD src0_sel:DWORD src1_sel:WORD_1
    ds_read_u16_d16_hi v130, v138 offset:32768
    ds_read_u16_d16_hi v131, v139 offset:32768
    s_set_gpr_idx_on s63, 0xc
    v_pk_fma_f32 v[16:17], v[132:133], v[104:105], v[16:17] op_sel:[1,0,0] op_sel_hi:[1,1,1]
    v_pk_fma_f32 v[18:19], v[132:133], v[106:107], v[18:19] op_sel:[1,0,0] op_sel_hi:[1,1,1]
    v_pk_fma_f32 v[20:21], v[134:135], v[108:109], v[20:21] op_sel:[1,0,0] op_sel_hi:[1,1,1]
    v_pk_fma_f32 v[22:23], v[134:135], v[110:111], v[22:23] op_sel:[1,0,0] op_sel_hi:[1,1,1]
    s_set_gpr_idx_off
    s_sub_u32 s32, s32, 1
    s_cbranch_scc1 MAIN_DONE
    v_mfma_f32_4x4x4_16b_bf16 v[124:127], v[172:173], v[178:179], 0 cbsz:4 abid:9
    v_lshlrev_b32_sdwa v136, v15, v114 dst_sel:DWORD dst_unused:UNUSED_PAD src0_sel:DWORD src1_sel:WORD_1
    s_waitcnt vmcnt(8)
    v_mfma_f32_4x4x4_16b_bf16 v[104:107], v[142:143], v[68:69], 0 cbsz:4 abid:8
    s_nop 0
    v_mfma_f32_4x4x4_16b_bf16 v[108:111], v[142:143], v[70:71], 0 cbsz:4 abid:8
    v_lshlrev_b32_sdwa v137, v15, v115 dst_sel:DWORD dst_unused:UNUSED_PAD src0_sel:DWORD src1_sel:WORD_1
    ds_read_u16_d16_hi v132, v136 offset:32768
    ds_read_u16_d16_hi v133, v137 offset:32768
    s_waitcnt lgkmcnt(2)
    s_set_gpr_idx_on s48, 0xc
    v_pk_fma_f32 v[16:17], v[128:129], v[96:97], v[16:17] op_sel:[0,0,0] op_sel_hi:[0,1,1]
    v_pk_fma_f32 v[18:19], v[128:129], v[98:99], v[18:19] op_sel:[0,0,0] op_sel_hi:[0,1,1]
    v_pk_fma_f32 v[20:21], v[130:131], v[100:101], v[20:21] op_sel:[0,0,0] op_sel_hi:[0,1,1]
    v_pk_fma_f32 v[22:23], v[130:131], v[102:103], v[22:23] op_sel:[0,0,0] op_sel_hi:[0,1,1]
    s_set_gpr_idx_off
    s_sub_u32 s32, s32, 1
    s_cbranch_scc1 MAIN_DONE
    v_lshlrev_b32_sdwa v138, v15, v118 dst_sel:DWORD dst_unused:UNUSED_PAD src0_sel:DWORD src1_sel:WORD_1
    v_mfma_f32_4x4x4_16b_bf16 v[96:99], v[144:145], v[72:73], 0 cbsz:4 abid:8
    s_nop 0
    v_mfma_f32_4x4x4_16b_bf16 v[100:103], v[144:145], v[74:75], 0 cbsz:4 abid:8
    v_lshlrev_b32_sdwa v139, v15, v119 dst_sel:DWORD dst_unused:UNUSED_PAD src0_sel:DWORD src1_sel:WORD_1
    ds_read_u16_d16_hi v134, v138 offset:32768
    ds_read_u16_d16_hi v135, v139 offset:32768
    s_set_gpr_idx_on s49, 0xc
    v_pk_fma_f32 v[16:17], v[128:129], v[104:105], v[16:17] op_sel:[1,0,0] op_sel_hi:[1,1,1]
    v_pk_fma_f32 v[18:19], v[128:129], v[106:107], v[18:19] op_sel:[1,0,0] op_sel_hi:[1,1,1]
    v_pk_fma_f32 v[20:21], v[130:131], v[108:109], v[20:21] op_sel:[1,0,0] op_sel_hi:[1,1,1]
    v_pk_fma_f32 v[22:23], v[130:131], v[110:111], v[22:23] op_sel:[1,0,0] op_sel_hi:[1,1,1]
    s_set_gpr_idx_off
    s_branch MAIN_DONE
B_32:
    buffer_load_dwordx4 v[188:191], v1, s[16:19], s10 offen offset:0 sc1
    buffer_load_dwordx4 v[192:195], v1, s[16:19], s10 offen offset:1024 sc1
    buffer_load_dwordx4 v[196:199], v1, s[16:19], s10 offen offset:2048 sc1
    buffer_load_dwordx4 v[200:203], v1, s[16:19], s10 offen offset:3072 sc1
    buffer_load_dwordx4 v[204:207], v1, s[16:19], s11 offen offset:0 sc1
    buffer_load_dwordx4 v[208:211], v1, s[16:19], s11 offen offset:1024 sc1
    buffer_load_dwordx4 v[212:215], v1, s[16:19], s11 offen offset:2048 sc1
    buffer_load_dwordx4 v[216:219], v1, s[16:19], s11 offen offset:3072 sc1
    s_sub_u32 s32, s32, 1
    s_cbranch_scc1 MAIN_DONE
    v_mfma_f32_4x4x4_16b_bf16 v[124:127], v[172:173], v[178:179], 0 cbsz:4 abid:9
    v_lshlrev_b32_sdwa v136, v15, v114 dst_sel:DWORD dst_unused:UNUSED_PAD src0_sel:DWORD src1_sel:WORD_1
    s_waitcnt vmcnt(12)
    v_mfma_f32_4x4x4_16b_bf16 v[104:107], v[142:143], v[68:69], 0 cbsz:4 abid:8
    s_nop 0
    v_mfma_f32_4x4x4_16b_bf16 v[108:111], v[142:143], v[70:71], 0 cbsz:4 abid:8
    v_lshlrev_b32_sdwa v137, v15, v115 dst_sel:DWORD dst_unused:UNUSED_PAD src0_sel:DWORD src1_sel:WORD_1
    ds_read_u16_d16_hi v132, v136 offset:32768
    ds_read_u16_d16_hi v133, v137 offset:32768
    s_waitcnt lgkmcnt(2)
    s_set_gpr_idx_on s48, 0xc
    v_pk_fma_f32 v[16:17], v[128:129], v[96:97], v[16:17] op_sel:[0,0,0] op_sel_hi:[0,1,1]
    v_pk_fma_f32 v[18:19], v[128:129], v[98:99], v[18:19] op_sel:[0,0,0] op_sel_hi:[0,1,1]
    v_pk_fma_f32 v[20:21], v[130:131], v[100:101], v[20:21] op_sel:[0,0,0] op_sel_hi:[0,1,1]
    v_pk_fma_f32 v[22:23], v[130:131], v[102:103], v[22:23] op_sel:[0,0,0] op_sel_hi:[0,1,1]
    s_set_gpr_idx_off
    s_sub_u32 s32, s32, 1
    s_cbranch_scc1 MAIN_DONE
    v_lshlrev_b32_sdwa v138, v15, v118 dst_sel:DWORD dst_unused:UNUSED_PAD src0_sel:DWORD src1_sel:WORD_1
    s_waitcnt vmcnt(11)
    v_mfma_f32_4x4x4_16b_bf16 v[96:99], v[144:145], v[72:73], 0 cbsz:4 abid:8
    s_nop 0
    v_mfma_f32_4x4x4_16b_bf16 v[100:103], v[144:145], v[74:75], 0 cbsz:4 abid:8
    v_lshlrev_b32_sdwa v139, v15, v119 dst_sel:DWORD dst_unused:UNUSED_PAD src0_sel:DWORD src1_sel:WORD_1
    ds_read_u16_d16_hi v134, v138 offset:32768
    ds_read_u16_d16_hi v135, v139 offset:32768
    s_set_gpr_idx_on s49, 0xc
    v_pk_fma_f32 v[16:17], v[128:129], v[104:105], v[16:17] op_sel:[1,0,0] op_sel_hi:[1,1,1]
    v_pk_fma_f32 v[18:19], v[128:129], v[106:107], v[18:19] op_sel:[1,0,0] op_sel_hi:[1,1,1]
    v_pk_fma_f32 v[20:21], v[130:131], v[108:109], v[20:21] op_sel:[1,0,0] op_sel_hi:[1,1,1]
    v_pk_fma_f32 v[22:23], v[130:131], v[110:111], v[22:23] op_sel:[1,0,0] op_sel_hi:[1,1,1]
    s_set_gpr_idx_off
    s_sub_u32 s32, s32, 1
    s_cbranch_scc1 MAIN_DONE
    v_mfma_f32_4x4x4_16b_bf16 v[112:115], v[172:173], v[176:177], 0 cbsz:4 abid:10
    v_lshlrev_b32_sdwa v136, v15, v120 dst_sel:DWORD dst_unused:UNUSED_PAD src0_sel:DWORD src1_sel:WORD_1
    s_waitcnt vmcnt(10)
    v_mfma_f32_4x4x4_16b_bf16 v[104:107], v[146:147], v[76:77], 0 cbsz:4 abid:8
    s_nop 0
    v_mfma_f32_4x4x4_16b_bf16 v[108:111], v[146:147], v[78:79], 0 cbsz:4 abid:8
    v_lshlrev_b32_sdwa v137, v15, v121 dst_sel:DWORD dst_unused:UNUSED_PAD src0_sel:DWORD src1_sel:WORD_1
    ds_read_u16_d16_hi v128, v136 offset:32768
    ds_read_u16_d16_hi v129, v137 offset:32768
    s_waitcnt lgkmcnt(2)
    s_set_gpr_idx_on s50, 0xc
    v_pk_fma_f32 v[16:17], v[132:133], v[96:97], v[16:17] op_sel:[0,0,0] op_sel_hi:[0,1,1]
    v_pk_fma_f32 v[18:19], v[132:133], v[98:99], v[18:19] op_sel:[0,0,0] op_sel_hi:[0,1,1]
    v_pk_fma_f32 v[20:21], v[134:135], v[100:101], v[20:21] op_sel:[0,0,0] op_sel_hi:[0,1,1]
    v_pk_fma_f32 v[22:23], v[134:135], v[102:103], v[22:23] op_sel:[0,0,0] op_sel_hi:[0,1,1]
    s_set_gpr_idx_off
    s_sub_u32 s32, s32, 1
    s_cbranch_scc1 MAIN_DONE
    v_lshlrev_b32_sdwa v138, v15, v124 dst_sel:DWORD dst_unused:UNUSED_PAD src0_sel:DWORD src1_sel:WORD_1
    s_waitcnt vmcnt(9)
    v_mfma_f32_4x4x4_16b_bf16 v[96:99], v[140:141], v[80:81], 0 cbsz:4 abid:9
    s_nop 0
    v_mfma_f32_4x4x4_16b_bf16 v[100:103], v[140:141], v[82:83], 0 cbsz:4 abid:9
    v_lshlrev_b32_sdwa v139, v15, v125 dst_sel:DWORD dst_unused:UNUSED_PAD src0_sel:DWORD src1_sel:WORD_1
    ds_read_u16_d16_hi v130, v138 offset:32768
    ds_read_u16_d16_hi v131, v139 offset:32768
    s_set_gpr_idx_on s51, 0xc
    v_pk_fma_f32 v[16:17], v[132:133], v[104:105], v[16:17] op_sel:[1,0,0] op_sel_hi:[1,1,1]
    v_pk_fma_f32 v[18:19], v[132:133], v[106:107], v[18:19] op_sel:[1,0,0] op_sel_hi:[1,1,1]
    v_pk_fma_f32 v[20:21], v[134:135], v[108:109], v[20:21] op_sel:[1,0,0] op_sel_hi:[1,1,1]
    v_pk_fma_f32 v[22:23], v[134:135], v[110:111], v[22:23] op_sel:[1,0,0] op_sel_hi:[1,1,1]
    s_set_gpr_idx_off
    s_sub_u32 s32, s32, 1
    s_cbranch_scc1 MAIN_DONE
    v_mfma_f32_4x4x4_16b_bf16 v[116:119], v[172:173], v[178:179], 0 cbsz:4 abid:10
    v_lshlrev_b32_sdwa v136, v15, v122 dst_sel:DWORD dst_unused:UNUSED_PAD src0_sel:DWORD src1_sel:WORD_1
    s_waitcnt vmcnt(8)
    v_mfma_f32_4x4x4_16b_bf16 v[104:107], v[142:143], v[84:85], 0 cbsz:4 abid:9
    s_nop 0
    v_mfma_f32_4x4x4_16b_bf16 v[108:111], v[142:143], v[86:87], 0 cbsz:4 abid:9
    v_lshlrev_b32_sdwa v137, v15, v123 dst_sel:DWORD dst_unused:UNUSED_PAD src0_sel:DWORD src1_sel:WORD_1
    ds_read_u16_d16_hi v132, v136 offset:32768
    ds_read_u16_d16_hi v133, v137 offset:32768
    s_waitcnt lgkmcnt(2)
    s_set_gpr_idx_on s52, 0xc
    v_pk_fma_f32 v[16:17], v[128:129], v[96:97], v[16:17] op_sel:[0,0,0] op_sel_hi:[0,1,1]
    v_pk_fma_f32 v[18:19], v[128:129], v[98:99], v[18:19] op_sel:[0,0,0] op_sel_hi:[0,1,1]
    v_pk_fma_f32 v[20:21], v[130:131], v[100:101], v[20:21] op_sel:[0,0,0] op_sel_hi:[0,1,1]
    v_pk_fma_f32 v[22:23], v[130:131], v[102:103], v[22:23] op_sel:[0,0,0] op_sel_hi:[0,1,1]
    s_set_gpr_idx_off
    s_sub_u32 s32, s32, 1
    s_cbranch_scc1 MAIN_DONE
    v_lshlrev_b32_sdwa v138, v15, v126 dst_sel:DWORD dst_unused:UNUSED_PAD src0_sel:DWORD src1_sel:WORD_1
    v_mfma_f32_4x4x4_16b_bf16 v[96:99], v[144:145], v[88:89], 0 cbsz:4 abid:9
    s_nop 0
    v_mfma_f32_4x4x4_16b_bf16 v[100:103], v[144:145], v[90:91], 0 cbsz:4 abid:9
    v_lshlrev_b32_sdwa v139, v15, v127 dst_sel:DWORD dst_unused:UNUSED_PAD src0_sel:DWORD src1_sel:WORD_1
    ds_read_u16_d16_hi v134, v138 offset:32768
    ds_read_u16_d16_hi v135, v139 offset:32768
    s_set_gpr_idx_on s53, 0xc
    v_pk_fma_f32 v[16:17], v[128:129], v[104:105], v[16:17] op_sel:[1,0,0] op_sel_hi:[1,1,1]
    v_pk_fma_f32 v[18:19], v[128:129], v[106:107], v[18:19] op_sel:[1,0,0] op_sel_hi:[1,1,1]
    v_pk_fma_f32 v[20:21], v[130:131], v[108:109], v[20:21] op_sel:[1,0,0] op_sel_hi:[1,1,1]
    v_pk_fma_f32 v[22:23], v[130:131], v[110:111], v[22:23] op_sel:[1,0,0] op_sel_hi:[1,1,1]
    s_set_gpr_idx_off
    s_branch MAIN_DONE
B_36:
    buffer_load_dwordx4 v[188:191], v1, s[16:19], s10 offen offset:0 sc1
    buffer_load_dwordx4 v[192:195], v1, s[16:19], s10 offen offset:1024 sc1
    buffer_load_dwordx4 v[196:199], v1, s[16:19], s10 offen offset:2048 sc1
    buffer_load_dwordx4 v[200:203], v1, s[16:19], s10 offen offset:3072 sc1
    buffer_load_dwordx4 v[204:207], v1, s[16:19], s11 offen offset:0 sc1
    buffer_load_dwordx4 v[208:211], v1, s[16:19], s11 offen offset:1024 sc1
    buffer_load_dwordx4 v[212:215], v1, s[16:19], s11 offen offset:2048 sc1
    buffer_load_dwordx4 v[216:219], v1, s[16:19], s11 offen offset:3072 sc1
    s_sub_u32 s32, s32, 1
    s_cbranch_scc1 MAIN_DONE
    v_mfma_f32_4x4x4_16b_bf16 v[116:119], v[172:173], v[178:179], 0 cbsz:4 abid:10
    v_lshlrev_b32_sdwa v136, v15, v122 dst_sel:DWORD dst_unused:UNUSED_PAD src0_sel:DWORD src1_sel:WORD_1
    s_waitcnt vmcnt(12)
    v_mfma_f32_4x4x4_16b_bf16 v[104:107], v[142:143], v[84:85], 0 cbsz:4 abid:9
    s_nop 0
    v_mfma_f32_4x4x4_16b_bf16 v[108:111], v[142:143], v[86:87], 0 cbsz:4 abid:9
    v_lshlrev_b32_sdwa v137, v15, v123 dst_sel:DWORD dst_unused:UNUSED_PAD src0_sel:DWORD src1_sel:WORD_1
    ds_read_u16_d16_hi v132, v136 offset:32768
    ds_read_u16_d16_hi v133, v137 offset:32768
    s_waitcnt lgkmcnt(2)
    s_set_gpr_idx_on s52, 0xc
    v_pk_fma_f32 v[16:17], v[128:129], v[96:97], v[16:17] op_sel:[0,0,0] op_sel_hi:[0,1,1]
    v_pk_fma_f32 v[18:19], v[128:129], v[98:99], v[18:19] op_sel:[0,0,0] op_sel_hi:[0,1,1]
    v_pk_fma_f32 v[20:21], v[130:131], v[100:101], v[20:21] op_sel:[0,0,0] op_sel_hi:[0,1,1]
    v_pk_fma_f32 v[22:23], v[130:131], v[102:103], v[22:23] op_sel:[0,0,0] op_sel_hi:[0,1,1]
    s_set_gpr_idx_off
    s_sub_u32 s32, s32, 1
    s_cbranch_scc1 MAIN_DONE
    v_lshlrev_b32_sdwa v138, v15, v126 dst_sel:DWORD dst_unused:UNUSED_PAD src0_sel:DWORD src1_sel:WORD_1
    s_waitcnt vmcnt(11)
    v_mfma_f32_4x4x4_16b_bf16 v[96:99], v[144:145], v[88:89], 0 cbsz:4 abid:9
    s_nop 0
    v_mfma_f32_4x4x4_16b_bf16 v[100:103], v[144:145], v[90:91], 0 cbsz:4 abid:9
    v_lshlrev_b32_sdwa v139, v15, v127 dst_sel:DWORD dst_unused:UNUSED_PAD src0_sel:DWORD src1_sel:WORD_1
    ds_read_u16_d16_hi v134, v138 offset:32768
    ds_read_u16_d16_hi v135, v139 offset:32768
    s_set_gpr_idx_on s53, 0xc
    v_pk_fma_f32 v[16:17], v[128:129], v[104:105], v[16:17] op_sel:[1,0,0] op_sel_hi:[1,1,1]
    v_pk_fma_f32 v[18:19], v[128:129], v[106:107], v[18:19] op_sel:[1,0,0] op_sel_hi:[1,1,1]
    v_pk_fma_f32 v[20:21], v[130:131], v[108:109], v[20:21] op_sel:[1,0,0] op_sel_hi:[1,1,1]
    v_pk_fma_f32 v[22:23], v[130:131], v[110:111], v[22:23] op_sel:[1,0,0] op_sel_hi:[1,1,1]
    s_set_gpr_idx_off
    s_sub_u32 s32, s32, 1
    s_cbranch_scc1 MAIN_DONE
    v_mfma_f32_4x4x4_16b_bf16 v[120:123], v[172:173], v[176:177], 0 cbsz:4 abid:11
    v_lshlrev_b32_sdwa v136, v15, v112 dst_sel:DWORD dst_unused:UNUSED_PAD src0_sel:DWORD src1_sel:WORD_1
    s_waitcnt vmcnt(10)
    v_mfma_f32_4x4x4_16b_bf16 v[104:107], v[146:147], v[92:93], 0 cbsz:4 abid:9
    s_nop 0
    v_mfma_f32_4x4x4_16b_bf16 v[108:111], v[146:147], v[94:95], 0 cbsz:4 abid:9
    v_lshlrev_b32_sdwa v137, v15, v113 dst_sel:DWORD dst_unused:UNUSED_PAD src0_sel:DWORD src1_sel:WORD_1
    ds_read_u16_d16_hi v128, v136 offset:32768
    ds_read_u16_d16_hi v129, v137 offset:32768
    s_waitcnt lgkmcnt(2)
    s_set_gpr_idx_on s54, 0xc
    v_pk_fma_f32 v[16:17], v[132:133], v[96:97], v[16:17] op_sel:[0,0,0] op_sel_hi:[0,1,1]
    v_pk_fma_f32 v[18:19], v[132:133], v[98:99], v[18:19] op_sel:[0,0,0] op_sel_hi:[0,1,1]
    v_pk_fma_f32 v[20:21], v[134:135], v[100:101], v[20:21] op_sel:[0,0,0] op_sel_hi:[0,1,1]
    v_pk_fma_f32 v[22:23], v[134:135], v[102:103], v[22:23] op_sel:[0,0,0] op_sel_hi:[0,1,1]
    s_set_gpr_idx_off
    s_sub_u32 s32, s32, 1
    s_cbranch_scc1 MAIN_DONE
    v_lshlrev_b32_sdwa v138, v15, v116 dst_sel:DWORD dst_unused:UNUSED_PAD src0_sel:DWORD src1_sel:WORD_1
    s_waitcnt vmcnt(9)
    v_mfma_f32_4x4x4_16b_bf16 v[96:99], v[140:141], v[64:65], 0 cbsz:4 abid:10
    s_nop 0
    v_mfma_f32_4x4x4_16b_bf16 v[100:103], v[140:141], v[66:67], 0 cbsz:4 abid:10
    v_lshlrev_b32_sdwa v139, v15, v117 dst_sel:DWORD dst_unused:UNUSED_PAD src0_sel:DWORD src1_sel:WORD_1
    ds_read_u16_d16_hi v130, v138 offset:32768
    ds_read_u16_d16_hi v131, v139 offset:32768
    s_set_gpr_idx_on s55, 0xc
    v_pk_fma_f32 v[16:17], v[132:133], v[104:105], v[16:17] op_sel:[1,0,0] op_sel_hi:[1,1,1]
    v_pk_fma_f32 v[18:19], v[132:133], v[106:107], v[18:19] op_sel:[1,0,0] op_sel_hi:[1,1,1]
    v_pk_fma_f32 v[20:21], v[134:135], v[108:109], v[20:21] op_sel:[1,0,0] op_sel_hi:[1,1,1]
    v_pk_fma_f32 v[22:23], v[134:135], v[110:111], v[22:23] op_sel:[1,0,0] op_sel_hi:[1,1,1]
    s_set_gpr_idx_off
    s_sub_u32 s32, s32, 1
    s_cbranch_scc1 MAIN_DONE
    v_mfma_f32_4x4x4_16b_bf16 v[124:127], v[172:173], v[178:179], 0 cbsz:4 abid:11
    v_lshlrev_b32_sdwa v136, v15, v114 dst_sel:DWORD dst_unused:UNUSED_PAD src0_sel:DWORD src1_sel:WORD_1
    s_waitcnt vmcnt(8)
    v_mfma_f32_4x4x4_16b_bf16 v[104:107], v[142:143], v[68:69], 0 cbsz:4 abid:10
    s_nop 0
    v_mfma_f32_4x4x4_16b_bf16 v[108:111], v[142:143], v[70:71], 0 cbsz:4 abid:10
    v_lshlrev_b32_sdwa v137, v15, v115 dst_sel:DWORD dst_unused:UNUSED_PAD src0_sel:DWORD src1_sel:WORD_1
    ds_read_u16_d16_hi v132, v136 offset:32768
    ds_read_u16_d16_hi v133, v137 offset:32768
    s_waitcnt lgkmcnt(2)
    s_set_gpr_idx_on s56, 0xc
    v_pk_fma_f32 v[16:17], v[128:129], v[96:97], v[16:17] op_sel:[0,0,0] op_sel_hi:[0,1,1]
    v_pk_fma_f32 v[18:19], v[128:129], v[98:99], v[18:19] op_sel:[0,0,0] op_sel_hi:[0,1,1]
    v_pk_fma_f32 v[20:21], v[130:131], v[100:101], v[20:21] op_sel:[0,0,0] op_sel_hi:[0,1,1]
    v_pk_fma_f32 v[22:23], v[130:131], v[102:103], v[22:23] op_sel:[0,0,0] op_sel_hi:[0,1,1]
    s_set_gpr_idx_off
    s_sub_u32 s32, s32, 1
    s_cbranch_scc1 MAIN_DONE
    v_mfma_f32_4x4x4_16b_bf16 v[148:151], v[168:169], v[180:181], 0
    v_lshlrev_b32_sdwa v138, v15, v118 dst_sel:DWORD dst_unused:UNUSED_PAD src0_sel:DWORD src1_sel:WORD_1
    v_mfma_f32_4x4x4_16b_bf16 v[96:99], v[144:145], v[72:73], 0 cbsz:4 abid:10
    s_nop 0
    v_mfma_f32_4x4x4_16b_bf16 v[100:103], v[144:145], v[74:75], 0 cbsz:4 abid:10
    v_lshlrev_b32_sdwa v139, v15, v119 dst_sel:DWORD dst_unused:UNUSED_PAD src0_sel:DWORD src1_sel:WORD_1
    ds_read_u16_d16_hi v134, v138 offset:32768
    ds_read_u16_d16_hi v135, v139 offset:32768
    s_set_gpr_idx_on s57, 0xc
    v_pk_fma_f32 v[16:17], v[128:129], v[104:105], v[16:17] op_sel:[1,0,0] op_sel_hi:[1,1,1]
    v_pk_fma_f32 v[18:19], v[128:129], v[106:107], v[18:19] op_sel:[1,0,0] op_sel_hi:[1,1,1]
    v_pk_fma_f32 v[20:21], v[130:131], v[108:109], v[20:21] op_sel:[1,0,0] op_sel_hi:[1,1,1]
    v_pk_fma_f32 v[22:23], v[130:131], v[110:111], v[22:23] op_sel:[1,0,0] op_sel_hi:[1,1,1]
    s_set_gpr_idx_off
    s_branch MAIN_DONE
B_40:
    buffer_load_dwordx4 v[188:191], v1, s[16:19], s10 offen offset:0 sc1
    buffer_load_dwordx4 v[192:195], v1, s[16:19], s10 offen offset:1024 sc1
    buffer_load_dwordx4 v[196:199], v1, s[16:19], s10 offen offset:2048 sc1
    buffer_load_dwordx4 v[200:203], v1, s[16:19], s10 offen offset:3072 sc1
    buffer_load_dwordx4 v[204:207], v1, s[16:19], s11 offen offset:0 sc1
    buffer_load_dwordx4 v[208:211], v1, s[16:19], s11 offen offset:1024 sc1
    buffer_load_dwordx4 v[212:215], v1, s[16:19], s11 offen offset:2048 sc1
    buffer_load_dwordx4 v[216:219], v1, s[16:19], s11 offen offset:3072 sc1
    s_sub_u32 s32, s32, 1
    s_cbranch_scc1 MAIN_DONE
    v_mfma_f32_4x4x4_16b_bf16 v[124:127], v[172:173], v[178:179], 0 cbsz:4 abid:11
    v_lshlrev_b32_sdwa v136, v15, v114 dst_sel:DWORD dst_unused:UNUSED_PAD src0_sel:DWORD src1_sel:WORD_1
    s_waitcnt vmcnt(12)
    v_mfma_f32_4x4x4_16b_bf16 v[104:107], v[142:143], v[68:69], 0 cbsz:4 abid:10
    s_nop 0
    v_mfma_f32_4x4x4_16b_bf16 v[108:111], v[142:143], v[70:71], 0 cbsz:4 abid:10
    v_lshlrev_b32_sdwa v137, v15, v115 dst_sel:DWORD dst_unused:UNUSED_PAD src0_sel:DWORD src1_sel:WORD_1
    ds_read_u16_d16_hi v132, v136 offset:32768
    ds_read_u16_d16_hi v133, v137 offset:32768
    s_waitcnt lgkmcnt(2)
    s_set_gpr_idx_on s56, 0xc
    v_pk_fma_f32 v[16:17], v[128:129], v[96:97], v[16:17] op_sel:[0,0,0] op_sel_hi:[0,1,1]
    v_pk_fma_f32 v[18:19], v[128:129], v[98:99], v[18:19] op_sel:[0,0,0] op_sel_hi:[0,1,1]
    v_pk_fma_f32 v[20:21], v[130:131], v[100:101], v[20:21] op_sel:[0,0,0] op_sel_hi:[0,1,1]
    v_pk_fma_f32 v[22:23], v[130:131], v[102:103], v[22:23] op_sel:[0,0,0] op_sel_hi:[0,1,1]
    s_set_gpr_idx_off
    s_sub_u32 s32, s32, 1
    s_cbranch_scc1 MAIN_DONE
    v_mfma_f32_4x4x4_16b_bf16 v[148:151], v[168:169], v[180:181], 0
    v_lshlrev_b32_sdwa v138, v15, v118 dst_sel:DWORD dst_unused:UNUSED_PAD src0_sel:DWORD src1_sel:WORD_1
    s_waitcnt vmcnt(11)
    v_mfma_f32_4x4x4_16b_bf16 v[96:99], v[144:145], v[72:73], 0 cbsz:4 abid:10
    s_nop 0
    v_mfma_f32_4x4x4_16b_bf16 v[100:103], v[144:145], v[74:75], 0 cbsz:4 abid:10
    v_lshlrev_b32_sdwa v139, v15, v119 dst_sel:DWORD dst_unused:UNUSED_PAD src0_sel:DWORD src1_sel:WORD_1
    ds_read_u16_d16_hi v134, v138 offset:32768
    ds_read_u16_d16_hi v135, v139 offset:32768
    s_set_gpr_idx_on s57, 0xc
    v_pk_fma_f32 v[16:17], v[128:129], v[104:105], v[16:17] op_sel:[1,0,0] op_sel_hi:[1,1,1]
    v_pk_fma_f32 v[18:19], v[128:129], v[106:107], v[18:19] op_sel:[1,0,0] op_sel_hi:[1,1,1]
    v_pk_fma_f32 v[20:21], v[130:131], v[108:109], v[20:21] op_sel:[1,0,0] op_sel_hi:[1,1,1]
    v_pk_fma_f32 v[22:23], v[130:131], v[110:111], v[22:23] op_sel:[1,0,0] op_sel_hi:[1,1,1]
    s_set_gpr_idx_off
    s_sub_u32 s32, s32, 1
    s_cbranch_scc1 MAIN_DONE
    v_mfma_f32_4x4x4_16b_bf16 v[112:115], v[172:173], v[176:177], 0 cbsz:4 abid:12
    v_lshlrev_b32_sdwa v136, v15, v120 dst_sel:DWORD dst_unused:UNUSED_PAD src0_sel:DWORD src1_sel:WORD_1
    s_waitcnt vmcnt(10)
    v_mfma_f32_4x4x4_16b_bf16 v[104:107], v[146:147], v[76:77], 0 cbsz:4 abid:10
    s_nop 0
    v_mfma_f32_4x4x4_16b_bf16 v[108:111], v[146:147], v[78:79], 0 cbsz:4 abid:10
    v_lshlrev_b32_sdwa v137, v15, v121 dst_sel:DWORD dst_unused:UNUSED_PAD src0_sel:DWORD src1_sel:WORD_1
    ds_read_u16_d16_hi v128, v136 offset:32768
    ds_read_u16_d16_hi v129, v137 offset:32768
    s_waitcnt lgkmcnt(2)
    s_set_gpr_idx_on s58, 0xc
    v_pk_fma_f32 v[16:17], v[132:133], v[96:97], v[16:17] op_sel:[0,0,0] op_sel_hi:[0,1,1]
    v_pk_fma_f32 v[18:19], v[132:133], v[98:99], v[18:19] op_sel:[0,0,0] op_sel_hi:[0,1,1]
    v_pk_fma_f32 v[20:21], v[134:135], v[100:101], v[20:21] op_sel:[0,0,0] op_sel_hi:[0,1,1]
    v_pk_fma_f32 v[22:23], v[134:135], v[102:103], v[22:23] op_sel:[0,0,0] op_sel_hi:[0,1,1]
    s_set_gpr_idx_off
    s_sub_u32 s32, s32, 1
    s_cbranch_scc1 MAIN_DONE
    v_mfma_f32_4x4x4_16b_bf16 v[152:155], v[168:169], v[182:183], 0
    v_lshlrev_b32_sdwa v138, v15, v124 dst_sel:DWORD dst_unused:UNUSED_PAD src0_sel:DWORD src1_sel:WORD_1
    s_waitcnt vmcnt(9)
    v_mfma_f32_4x4x4_16b_bf16 v[96:99], v[140:141], v[80:81], 0 cbsz:4 abid:11
    s_nop 0
    v_mfma_f32_4x4x4_16b_bf16 v[100:103], v[140:141], v[82:83], 0 cbsz:4 abid:11
    v_lshlrev_b32_sdwa v139, v15, v125 dst_sel:DWORD dst_unused:UNUSED_PAD src0_sel:DWORD src1_sel:WORD_1
    ds_read_u16_d16_hi v130, v138 offset:32768
    ds_read_u16_d16_hi v131, v139 offset:32768
    s_set_gpr_idx_on s59, 0xc
    v_pk_fma_f32 v[16:17], v[132:133], v[104:105], v[16:17] op_sel:[1,0,0] op_sel_hi:[1,1,1]
    v_pk_fma_f32 v[18:19], v[132:133], v[106:107], v[18:19] op_sel:[1,0,0] op_sel_hi:[1,1,1]
    v_pk_fma_f32 v[20:21], v[134:135], v[108:109], v[20:21] op_sel:[1,0,0] op_sel_hi:[1,1,1]
    v_pk_fma_f32 v[22:23], v[134:135], v[110:111], v[22:23] op_sel:[1,0,0] op_sel_hi:[1,1,1]
    s_set_gpr_idx_off
    s_sub_u32 s32, s32, 1
    s_cbranch_scc1 MAIN_DONE
    v_mfma_f32_4x4x4_16b_bf16 v[116:119], v[172:173], v[178:179], 0 cbsz:4 abid:12
    v_lshlrev_b32_sdwa v136, v15, v122 dst_sel:DWORD dst_unused:UNUSED_PAD src0_sel:DWORD src1_sel:WORD_1
    s_waitcnt vmcnt(8)
    v_mfma_f32_4x4x4_16b_bf16 v[104:107], v[142:143], v[84:85], 0 cbsz:4 abid:11
    s_nop 0
    v_mfma_f32_4x4x4_16b_bf16 v[108:111], v[142:143], v[86:87], 0 cbsz:4 abid:11
    v_lshlrev_b32_sdwa v137, v15, v123 dst_sel:DWORD dst_unused:UNUSED_PAD src0_sel:DWORD src1_sel:WORD_1
    ds_read_u16_d16_hi v132, v136 offset:32768
    ds_read_u16_d16_hi v133, v137 offset:32768
    s_waitcnt lgkmcnt(2)
    s_set_gpr_idx_on s60, 0xc
    v_pk_fma_f32 v[16:17], v[128:129], v[96:97], v[16:17] op_sel:[0,0,0] op_sel_hi:[0,1,1]
    v_pk_fma_f32 v[18:19], v[128:129], v[98:99], v[18:19] op_sel:[0,0,0] op_sel_hi:[0,1,1]
    v_pk_fma_f32 v[20:21], v[130:131], v[100:101], v[20:21] op_sel:[0,0,0] op_sel_hi:[0,1,1]
    v_pk_fma_f32 v[22:23], v[130:131], v[102:103], v[22:23] op_sel:[0,0,0] op_sel_hi:[0,1,1]
    s_set_gpr_idx_off
    s_sub_u32 s32, s32, 1
    s_cbranch_scc1 MAIN_DONE
    v_mfma_f32_4x4x4_16b_bf16 v[156:159], v[168:169], v[184:185], 0
    v_lshlrev_b32_sdwa v138, v15, v126 dst_sel:DWORD dst_unused:UNUSED_PAD src0_sel:DWORD src1_sel:WORD_1
    v_mfma_f32_4x4x4_16b_bf16 v[96:99], v[144:145], v[88:89], 0 cbsz:4 abid:11
    s_nop 0
    v_mfma_f32_4x4x4_16b_bf16 v[100:103], v[144:145], v[90:91], 0 cbsz:4 abid:11
    v_lshlrev_b32_sdwa v139, v15, v127 dst_sel:DWORD dst_unused:UNUSED_PAD src0_sel:DWORD src1_sel:WORD_1
    ds_read_u16_d16_hi v134, v138 offset:32768
    ds_read_u16_d16_hi v135, v139 offset:32768
    s_set_gpr_idx_on s61, 0xc
    v_pk_fma_f32 v[16:17], v[128:129], v[104:105], v[16:17] op_sel:[1,0,0] op_sel_hi:[1,1,1]
    v_pk_fma_f32 v[18:19], v[128:129], v[106:107], v[18:19] op_sel:[1,0,0] op_sel_hi:[1,1,1]
    v_pk_fma_f32 v[20:21], v[130:131], v[108:109], v[20:21] op_sel:[1,0,0] op_sel_hi:[1,1,1]
    v_pk_fma_f32 v[22:23], v[130:131], v[110:111], v[22:23] op_sel:[1,0,0] op_sel_hi:[1,1,1]
    s_set_gpr_idx_off
    s_branch MAIN_DONE
B_44:
    buffer_load_dwordx4 v[188:191], v1, s[16:19], s10 offen offset:0 sc1
    buffer_load_dwordx4 v[192:195], v1, s[16:19], s10 offen offset:1024 sc1
    buffer_load_dwordx4 v[196:199], v1, s[16:19], s10 offen offset:2048 sc1
    buffer_load_dwordx4 v[200:203], v1, s[16:19], s10 offen offset:3072 sc1
    buffer_load_dwordx4 v[204:207], v1, s[16:19], s11 offen offset:0 sc1
    buffer_load_dwordx4 v[208:211], v1, s[16:19], s11 offen offset:1024 sc1
    buffer_load_dwordx4 v[212:215], v1, s[16:19], s11 offen offset:2048 sc1
    buffer_load_dwordx4 v[216:219], v1, s[16:19], s11 offen offset:3072 sc1
    s_sub_u32 s32, s32, 1
    s_cbranch_scc1 MAIN_DONE
    v_mfma_f32_4x4x4_16b_bf16 v[116:119], v[172:173], v[178:179], 0 cbsz:4 abid:12
    v_lshlrev_b32_sdwa v136, v15, v122 dst_sel:DWORD dst_unused:UNUSED_PAD src0_sel:DWORD src1_sel:WORD_1
    s_waitcnt vmcnt(12)
    v_mfma_f32_4x4x4_16b_bf16 v[104:107], v[142:143], v[84:85], 0 cbsz:4 abid:11
    s_nop 0
    v_mfma_f32_4x4x4_16b_bf16 v[108:111], v[142:143], v[86:87], 0 cbsz:4 abid:11
    v_lshlrev_b32_sdwa v137, v15, v123 dst_sel:DWORD dst_unused:UNUSED_PAD src0_sel:DWORD src1_sel:WORD_1
    ds_read_u16_d16_hi v132, v136 offset:32768
    ds_read_u16_d16_hi v133, v137 offset:32768
    s_waitcnt lgkmcnt(2)
    s_set_gpr_idx_on s60, 0xc
    v_pk_fma_f32 v[16:17], v[128:129], v[96:97], v[16:17] op_sel:[0,0,0] op_sel_hi:[0,1,1]
    v_pk_fma_f32 v[18:19], v[128:129], v[98:99], v[18:19] op_sel:[0,0,0] op_sel_hi:[0,1,1]
    v_pk_fma_f32 v[20:21], v[130:131], v[100:101], v[20:21] op_sel:[0,0,0] op_sel_hi:[0,1,1]
    v_pk_fma_f32 v[22:23], v[130:131], v[102:103], v[22:23] op_sel:[0,0,0] op_sel_hi:[0,1,1]
    s_set_gpr_idx_off
    s_sub_u32 s32, s32, 1
    s_cbranch_scc1 MAIN_DONE
    v_mfma_f32_4x4x4_16b_bf16 v[156:159], v[168:169], v[184:185], 0
    v_lshlrev_b32_sdwa v138, v15, v126 dst_sel:DWORD dst_unused:UNUSED_PAD src0_sel:DWORD src1_sel:WORD_1
    s_waitcnt vmcnt(11)
    v_mfma_f32_4x4x4_16b_bf16 v[96:99], v[144:145], v[88:89], 0 cbsz:4 abid:11
    s_nop 0
    v_mfma_f32_4x4x4_16b_bf16 v[100:103], v[144:145], v[90:91], 0 cbsz:4 abid:11
    v_lshlrev_b32_sdwa v139, v15, v127 dst_sel:DWORD dst_unused:UNUSED_PAD src0_sel:DWORD src1_sel:WORD_1
    ds_read_u16_d16_hi v134, v138 offset:32768
    ds_read_u16_d16_hi v135, v139 offset:32768
    s_set_gpr_idx_on s61, 0xc
    v_pk_fma_f32 v[16:17], v[128:129], v[104:105], v[16:17] op_sel:[1,0,0] op_sel_hi:[1,1,1]
    v_pk_fma_f32 v[18:19], v[128:129], v[106:107], v[18:19] op_sel:[1,0,0] op_sel_hi:[1,1,1]
    v_pk_fma_f32 v[20:21], v[130:131], v[108:109], v[20:21] op_sel:[1,0,0] op_sel_hi:[1,1,1]
    v_pk_fma_f32 v[22:23], v[130:131], v[110:111], v[22:23] op_sel:[1,0,0] op_sel_hi:[1,1,1]
    s_set_gpr_idx_off
    s_sub_u32 s32, s32, 1
    s_cbranch_scc1 MAIN_DONE
    v_mfma_f32_4x4x4_16b_bf16 v[120:123], v[172:173], v[176:177], 0 cbsz:4 abid:13
    v_lshlrev_b32_sdwa v136, v15, v112 dst_sel:DWORD dst_unused:UNUSED_PAD src0_sel:DWORD src1_sel:WORD_1
    s_waitcnt vmcnt(10)
    v_mfma_f32_4x4x4_16b_bf16 v[104:107], v[146:147], v[92:93], 0 cbsz:4 abid:11
    s_nop 0
    v_mfma_f32_4x4x4_16b_bf16 v[108:111], v[146:147], v[94:95], 0 cbsz:4 abid:11
    v_lshlrev_b32_sdwa v137, v15, v113 dst_sel:DWORD dst_unused:UNUSED_PAD src0_sel:DWORD src1_sel:WORD_1
    ds_read_u16_d16_hi v128, v136 offset:32768
    ds_read_u16_d16_hi v129, v137 offset:32768
    s_waitcnt lgkmcnt(2)
    s_set_gpr_idx_on s62, 0xc
    v_pk_fma_f32 v[16:17], v[132:133], v[96:97], v[16:17] op_sel:[0,0,0] op_sel_hi:[0,1,1]
    v_pk_fma_f32 v[18:19], v[132:133], v[98:99], v[18:19] op_sel:[0,0,0] op_sel_hi:[0,1,1]
    v_pk_fma_f32 v[20:21], v[134:135], v[100:101], v[20:21] op_sel:[0,0,0] op_sel_hi:[0,1,1]
    v_pk_fma_f32 v[22:23], v[134:135], v[102:103], v[22:23] op_sel:[0,0,0] op_sel_hi:[0,1,1]
    s_set_gpr_idx_off
    s_sub_u32 s32, s32, 1
    s_cbranch_scc1 MAIN_DONE
    v_mfma_f32_4x4x4_16b_bf16 v[160:163], v[168:169], v[186:187], 0
    v_lshlrev_b32_sdwa v138, v15, v116 dst_sel:DWORD dst_unused:UNUSED_PAD src0_sel:DWORD src1_sel:WORD_1
    s_waitcnt vmcnt(9)
    v_mfma_f32_4x4x4_16b_bf16 v[96:99], v[140:141], v[64:65], 0 cbsz:4 abid:12
    s_nop 0
    v_mfma_f32_4x4x4_16b_bf16 v[100:103], v[140:141], v[66:67], 0 cbsz:4 abid:12
    v_lshlrev_b32_sdwa v139, v15, v117 dst_sel:DWORD dst_unused:UNUSED_PAD src0_sel:DWORD src1_sel:WORD_1
    ds_read_u16_d16_hi v130, v138 offset:32768
    ds_read_u16_d16_hi v131, v139 offset:32768
    s_set_gpr_idx_on s63, 0xc
    v_pk_fma_f32 v[16:17], v[132:133], v[104:105], v[16:17] op_sel:[1,0,0] op_sel_hi:[1,1,1]
    v_pk_fma_f32 v[18:19], v[132:133], v[106:107], v[18:19] op_sel:[1,0,0] op_sel_hi:[1,1,1]
    v_pk_fma_f32 v[20:21], v[134:135], v[108:109], v[20:21] op_sel:[1,0,0] op_sel_hi:[1,1,1]
    v_pk_fma_f32 v[22:23], v[134:135], v[110:111], v[22:23] op_sel:[1,0,0] op_sel_hi:[1,1,1]
    s_set_gpr_idx_off
    s_sub_u32 s32, s32, 1
    s_cbranch_scc1 MAIN_DONE
    v_mfma_f32_4x4x4_16b_bf16 v[124:127], v[172:173], v[178:179], 0 cbsz:4 abid:13
    v_lshlrev_b32_sdwa v136, v15, v114 dst_sel:DWORD dst_unused:UNUSED_PAD src0_sel:DWORD src1_sel:WORD_1
    s_waitcnt vmcnt(8)
    v_mfma_f32_4x4x4_16b_bf16 v[104:107], v[142:143], v[68:69], 0 cbsz:4 abid:12
    s_nop 0
    v_mfma_f32_4x4x4_16b_bf16 v[108:111], v[142:143], v[70:71], 0 cbsz:4 abid:12
    v_lshlrev_b32_sdwa v137, v15, v115 dst_sel:DWORD dst_unused:UNUSED_PAD src0_sel:DWORD src1_sel:WORD_1
    ds_read_u16_d16_hi v132, v136 offset:32768
    ds_read_u16_d16_hi v133, v137 offset:32768
    s_waitcnt lgkmcnt(2)
    s_set_gpr_idx_on s48, 0xc
    v_pk_fma_f32 v[16:17], v[128:129], v[96:97], v[16:17] op_sel:[0,0,0] op_sel_hi:[0,1,1]
    v_pk_fma_f32 v[18:19], v[128:129], v[98:99], v[18:19] op_sel:[0,0,0] op_sel_hi:[0,1,1]
    v_pk_fma_f32 v[20:21], v[130:131], v[100:101], v[20:21] op_sel:[0,0,0] op_sel_hi:[0,1,1]
    v_pk_fma_f32 v[22:23], v[130:131], v[102:103], v[22:23] op_sel:[0,0,0] op_sel_hi:[0,1,1]
    s_set_gpr_idx_off
    s_sub_u32 s32, s32, 1
    s_cbranch_scc1 MAIN_DONE
    v_lshlrev_b32_sdwa v138, v15, v118 dst_sel:DWORD dst_unused:UNUSED_PAD src0_sel:DWORD src1_sel:WORD_1
    v_mfma_f32_4x4x4_16b_bf16 v[96:99], v[144:145], v[72:73], 0 cbsz:4 abid:12
    s_nop 0
    v_mfma_f32_4x4x4_16b_bf16 v[100:103], v[144:145], v[74:75], 0 cbsz:4 abid:12
    v_lshlrev_b32_sdwa v139, v15, v119 dst_sel:DWORD dst_unused:UNUSED_PAD src0_sel:DWORD src1_sel:WORD_1
    ds_read_u16_d16_hi v134, v138 offset:32768
    ds_read_u16_d16_hi v135, v139 offset:32768
    s_set_gpr_idx_on s49, 0xc
    v_pk_fma_f32 v[16:17], v[128:129], v[104:105], v[16:17] op_sel:[1,0,0] op_sel_hi:[1,1,1]
    v_pk_fma_f32 v[18:19], v[128:129], v[106:107], v[18:19] op_sel:[1,0,0] op_sel_hi:[1,1,1]
    v_pk_fma_f32 v[20:21], v[130:131], v[108:109], v[20:21] op_sel:[1,0,0] op_sel_hi:[1,1,1]
    v_pk_fma_f32 v[22:23], v[130:131], v[110:111], v[22:23] op_sel:[1,0,0] op_sel_hi:[1,1,1]
    s_set_gpr_idx_off
    s_branch MAIN_DONE
B_48:
    buffer_load_dwordx4 v[188:191], v1, s[16:19], s10 offen offset:0 sc1
    buffer_load_dwordx4 v[192:195], v1, s[16:19], s10 offen offset:1024 sc1
    buffer_load_dwordx4 v[196:199], v1, s[16:19], s10 offen offset:2048 sc1
    buffer_load_dwordx4 v[200:203], v1, s[16:19], s10 offen offset:3072 sc1
    buffer_load_dwordx4 v[204:207], v1, s[16:19], s11 offen offset:0 sc1
    buffer_load_dwordx4 v[208:211], v1, s[16:19], s11 offen offset:1024 sc1
    buffer_load_dwordx4 v[212:215], v1, s[16:19], s11 offen offset:2048 sc1
    buffer_load_dwordx4 v[216:219], v1, s[16:19], s11 offen offset:3072 sc1
    s_sub_u32 s32, s32, 1
    s_cbranch_scc1 MAIN_DONE
    v_mfma_f32_4x4x4_16b_bf16 v[124:127], v[172:173], v[178:179], 0 cbsz:4 abid:13
    v_lshlrev_b32_sdwa v136, v15, v114 dst_sel:DWORD dst_unused:UNUSED_PAD src0_sel:DWORD src1_sel:WORD_1
    s_waitcnt vmcnt(12)
    v_mfma_f32_4x4x4_16b_bf16 v[104:107], v[142:143], v[68:69], 0 cbsz:4 abid:12
    s_nop 0
    v_mfma_f32_4x4x4_16b_bf16 v[108:111], v[142:143], v[70:71], 0 cbsz:4 abid:12
    v_lshlrev_b32_sdwa v137, v15, v115 dst_sel:DWORD dst_unused:UNUSED_PAD src0_sel:DWORD src1_sel:WORD_1
    ds_read_u16_d16_hi v132, v136 offset:32768
    ds_read_u16_d16_hi v133, v137 offset:32768
    s_waitcnt lgkmcnt(2)
    s_set_gpr_idx_on s48, 0xc
    v_pk_fma_f32 v[16:17], v[128:129], v[96:97], v[16:17] op_sel:[0,0,0] op_sel_hi:[0,1,1]
    v_pk_fma_f32 v[18:19], v[128:129], v[98:99], v[18:19] op_sel:[0,0,0] op_sel_hi:[0,1,1]
    v_pk_fma_f32 v[20:21], v[130:131], v[100:101], v[20:21] op_sel:[0,0,0] op_sel_hi:[0,1,1]
    v_pk_fma_f32 v[22:23], v[130:131], v[102:103], v[22:23] op_sel:[0,0,0] op_sel_hi:[0,1,1]
    s_set_gpr_idx_off
    s_sub_u32 s32, s32, 1
    s_cbranch_scc1 MAIN_DONE
    v_lshlrev_b32_sdwa v138, v15, v118 dst_sel:DWORD dst_unused:UNUSED_PAD src0_sel:DWORD src1_sel:WORD_1
    s_waitcnt vmcnt(11)
    v_mfma_f32_4x4x4_16b_bf16 v[96:99], v[144:145], v[72:73], 0 cbsz:4 abid:12
    s_nop 0
    v_mfma_f32_4x4x4_16b_bf16 v[100:103], v[144:145], v[74:75], 0 cbsz:4 abid:12
    v_lshlrev_b32_sdwa v139, v15, v119 dst_sel:DWORD dst_unused:UNUSED_PAD src0_sel:DWORD src1_sel:WORD_1
    ds_read_u16_d16_hi v134, v138 offset:32768
    ds_read_u16_d16_hi v135, v139 offset:32768
    s_set_gpr_idx_on s49, 0xc
    v_pk_fma_f32 v[16:17], v[128:129], v[104:105], v[16:17] op_sel:[1,0,0] op_sel_hi:[1,1,1]
    v_pk_fma_f32 v[18:19], v[128:129], v[106:107], v[18:19] op_sel:[1,0,0] op_sel_hi:[1,1,1]
    v_pk_fma_f32 v[20:21], v[130:131], v[108:109], v[20:21] op_sel:[1,0,0] op_sel_hi:[1,1,1]
    v_pk_fma_f32 v[22:23], v[130:131], v[110:111], v[22:23] op_sel:[1,0,0] op_sel_hi:[1,1,1]
    s_set_gpr_idx_off
    s_sub_u32 s32, s32, 1
    s_cbranch_scc1 MAIN_DONE
    v_mfma_f32_4x4x4_16b_bf16 v[112:115], v[172:173], v[176:177], 0 cbsz:4 abid:14
    v_lshlrev_b32_sdwa v136, v15, v120 dst_sel:DWORD dst_unused:UNUSED_PAD src0_sel:DWORD src1_sel:WORD_1
    s_waitcnt vmcnt(10)
    v_mfma_f32_4x4x4_16b_bf16 v[104:107], v[146:147], v[76:77], 0 cbsz:4 abid:12
    s_nop 0
    v_mfma_f32_4x4x4_16b_bf16 v[108:111], v[146:147], v[78:79], 0 cbsz:4 abid:12
    v_lshlrev_b32_sdwa v137, v15, v121 dst_sel:DWORD dst_unused:UNUSED_PAD src0_sel:DWORD src1_sel:WORD_1
    ds_read_u16_d16_hi v128, v136 offset:32768
    ds_read_u16_d16_hi v129, v137 offset:32768
    s_waitcnt lgkmcnt(2)
    s_set_gpr_idx_on s50, 0xc
    v_pk_fma_f32 v[16:17], v[132:133], v[96:97], v[16:17] op_sel:[0,0,0] op_sel_hi:[0,1,1]
    v_pk_fma_f32 v[18:19], v[132:133], v[98:99], v[18:19] op_sel:[0,0,0] op_sel_hi:[0,1,1]
    v_pk_fma_f32 v[20:21], v[134:135], v[100:101], v[20:21] op_sel:[0,0,0] op_sel_hi:[0,1,1]
    v_pk_fma_f32 v[22:23], v[134:135], v[102:103], v[22:23] op_sel:[0,0,0] op_sel_hi:[0,1,1]
    s_set_gpr_idx_off
    s_sub_u32 s32, s32, 1
    s_cbranch_scc1 MAIN_DONE
    v_lshlrev_b32_sdwa v138, v15, v124 dst_sel:DWORD dst_unused:UNUSED_PAD src0_sel:DWORD src1_sel:WORD_1
    s_waitcnt vmcnt(9)
    v_mfma_f32_4x4x4_16b_bf16 v[96:99], v[140:141], v[80:81], 0 cbsz:4 abid:13
    s_nop 0
    v_mfma_f32_4x4x4_16b_bf16 v[100:103], v[140:141], v[82:83], 0 cbsz:4 abid:13
    v_lshlrev_b32_sdwa v139, v15, v125 dst_sel:DWORD dst_unused:UNUSED_PAD src0_sel:DWORD src1_sel:WORD_1
    ds_read_u16_d16_hi v130, v138 offset:32768
    ds_read_u16_d16_hi v131, v139 offset:32768
    s_set_gpr_idx_on s51, 0xc
    v_pk_fma_f32 v[16:17], v[132:133], v[104:105], v[16:17] op_sel:[1,0,0] op_sel_hi:[1,1,1]
    v_pk_fma_f32 v[18:19], v[132:133], v[106:107], v[18:19] op_sel:[1,0,0] op_sel_hi:[1,1,1]
    v_pk_fma_f32 v[20:21], v[134:135], v[108:109], v[20:21] op_sel:[1,0,0] op_sel_hi:[1,1,1]
    v_pk_fma_f32 v[22:23], v[134:135], v[110:111], v[22:23] op_sel:[1,0,0] op_sel_hi:[1,1,1]
    s_set_gpr_idx_off
    s_sub_u32 s32, s32, 1
    s_cbranch_scc1 MAIN_DONE
    v_mfma_f32_4x4x4_16b_bf16 v[116:119], v[172:173], v[178:179], 0 cbsz:4 abid:14
    v_lshlrev_b32_sdwa v136, v15, v122 dst_sel:DWORD dst_unused:UNUSED_PAD src0_sel:DWORD src1_sel:WORD_1
    s_waitcnt vmcnt(8)
    v_mfma_f32_4x4x4_16b_bf16 v[104:107], v[142:143], v[84:85], 0 cbsz:4 abid:13
    s_nop 0
    v_mfma_f32_4x4x4_16b_bf16 v[108:111], v[142:143], v[86:87], 0 cbsz:4 abid:13
    v_lshlrev_b32_sdwa v137, v15, v123 dst_sel:DWORD dst_unused:UNUSED_PAD src0_sel:DWORD src1_sel:WORD_1
    ds_read_u16_d16_hi v132, v136 offset:32768
    ds_read_u16_d16_hi v133, v137 offset:32768
    s_waitcnt lgkmcnt(2)
    s_set_gpr_idx_on s52, 0xc
    v_pk_fma_f32 v[16:17], v[128:129], v[96:97], v[16:17] op_sel:[0,0,0] op_sel_hi:[0,1,1]
    v_pk_fma_f32 v[18:19], v[128:129], v[98:99], v[18:19] op_sel:[0,0,0] op_sel_hi:[0,1,1]
    v_pk_fma_f32 v[20:21], v[130:131], v[100:101], v[20:21] op_sel:[0,0,0] op_sel_hi:[0,1,1]
    v_pk_fma_f32 v[22:23], v[130:131], v[102:103], v[22:23] op_sel:[0,0,0] op_sel_hi:[0,1,1]
    s_set_gpr_idx_off
    s_sub_u32 s32, s32, 1
    s_cbranch_scc1 MAIN_DONE
    v_lshlrev_b32_sdwa v138, v15, v126 dst_sel:DWORD dst_unused:UNUSED_PAD src0_sel:DWORD src1_sel:WORD_1
    v_mfma_f32_4x4x4_16b_bf16 v[96:99], v[144:145], v[88:89], 0 cbsz:4 abid:13
    s_nop 0
    v_mfma_f32_4x4x4_16b_bf16 v[100:103], v[144:145], v[90:91], 0 cbsz:4 abid:13
    v_lshlrev_b32_sdwa v139, v15, v127 dst_sel:DWORD dst_unused:UNUSED_PAD src0_sel:DWORD src1_sel:WORD_1
    ds_read_u16_d16_hi v134, v138 offset:32768
    ds_read_u16_d16_hi v135, v139 offset:32768
    s_set_gpr_idx_on s53, 0xc
    v_pk_fma_f32 v[16:17], v[128:129], v[104:105], v[16:17] op_sel:[1,0,0] op_sel_hi:[1,1,1]
    v_pk_fma_f32 v[18:19], v[128:129], v[106:107], v[18:19] op_sel:[1,0,0] op_sel_hi:[1,1,1]
    v_pk_fma_f32 v[20:21], v[130:131], v[108:109], v[20:21] op_sel:[1,0,0] op_sel_hi:[1,1,1]
    v_pk_fma_f32 v[22:23], v[130:131], v[110:111], v[22:23] op_sel:[1,0,0] op_sel_hi:[1,1,1]
    s_set_gpr_idx_off
    s_branch MAIN_DONE
B_52:
    buffer_load_dwordx4 v[188:191], v1, s[16:19], s10 offen offset:0 sc1
    buffer_load_dwordx4 v[192:195], v1, s[16:19], s10 offen offset:1024 sc1
    buffer_load_dwordx4 v[196:199], v1, s[16:19], s10 offen offset:2048 sc1
    buffer_load_dwordx4 v[200:203], v1, s[16:19], s10 offen offset:3072 sc1
    buffer_load_dwordx4 v[204:207], v1, s[16:19], s11 offen offset:0 sc1
    buffer_load_dwordx4 v[208:211], v1, s[16:19], s11 offen offset:1024 sc1
    buffer_load_dwordx4 v[212:215], v1, s[16:19], s11 offen offset:2048 sc1
    buffer_load_dwordx4 v[216:219], v1, s[16:19], s11 offen offset:3072 sc1
    s_sub_u32 s32, s32, 1
    s_cbranch_scc1 MAIN_DONE
    v_mfma_f32_4x4x4_16b_bf16 v[116:119], v[172:173], v[178:179], 0 cbsz:4 abid:14
    v_lshlrev_b32_sdwa v136, v15, v122 dst_sel:DWORD dst_unused:UNUSED_PAD src0_sel:DWORD src1_sel:WORD_1
    s_waitcnt vmcnt(12)
    v_mfma_f32_4x4x4_16b_bf16 v[104:107], v[142:143], v[84:85], 0 cbsz:4 abid:13
    s_nop 0
    v_mfma_f32_4x4x4_16b_bf16 v[108:111], v[142:143], v[86:87], 0 cbsz:4 abid:13
    v_lshlrev_b32_sdwa v137, v15, v123 dst_sel:DWORD dst_unused:UNUSED_PAD src0_sel:DWORD src1_sel:WORD_1
    ds_read_u16_d16_hi v132, v136 offset:32768
    ds_read_u16_d16_hi v133, v137 offset:32768
    s_waitcnt lgkmcnt(2)
    s_set_gpr_idx_on s52, 0xc
    v_pk_fma_f32 v[16:17], v[128:129], v[96:97], v[16:17] op_sel:[0,0,0] op_sel_hi:[0,1,1]
    v_pk_fma_f32 v[18:19], v[128:129], v[98:99], v[18:19] op_sel:[0,0,0] op_sel_hi:[0,1,1]
    v_pk_fma_f32 v[20:21], v[130:131], v[100:101], v[20:21] op_sel:[0,0,0] op_sel_hi:[0,1,1]
    v_pk_fma_f32 v[22:23], v[130:131], v[102:103], v[22:23] op_sel:[0,0,0] op_sel_hi:[0,1,1]
    s_set_gpr_idx_off
    s_sub_u32 s32, s32, 1
    s_cbranch_scc1 MAIN_DONE
    v_lshlrev_b32_sdwa v138, v15, v126 dst_sel:DWORD dst_unused:UNUSED_PAD src0_sel:DWORD src1_sel:WORD_1
    s_waitcnt vmcnt(11)
    v_mfma_f32_4x4x4_16b_bf16 v[96:99], v[144:145], v[88:89], 0 cbsz:4 abid:13
    s_nop 0
    v_mfma_f32_4x4x4_16b_bf16 v[100:103], v[144:145], v[90:91], 0 cbsz:4 abid:13
    v_lshlrev_b32_sdwa v139, v15, v127 dst_sel:DWORD dst_unused:UNUSED_PAD src0_sel:DWORD src1_sel:WORD_1
    ds_read_u16_d16_hi v134, v138 offset:32768
    ds_read_u16_d16_hi v135, v139 offset:32768
    s_set_gpr_idx_on s53, 0xc
    v_pk_fma_f32 v[16:17], v[128:129], v[104:105], v[16:17] op_sel:[1,0,0] op_sel_hi:[1,1,1]
    v_pk_fma_f32 v[18:19], v[128:129], v[106:107], v[18:19] op_sel:[1,0,0] op_sel_hi:[1,1,1]
    v_pk_fma_f32 v[20:21], v[130:131], v[108:109], v[20:21] op_sel:[1,0,0] op_sel_hi:[1,1,1]
    v_pk_fma_f32 v[22:23], v[130:131], v[110:111], v[22:23] op_sel:[1,0,0] op_sel_hi:[1,1,1]
    s_set_gpr_idx_off
    s_sub_u32 s32, s32, 1
    s_cbranch_scc1 MAIN_DONE
    v_mfma_f32_4x4x4_16b_bf16 v[120:123], v[172:173], v[176:177], 0 cbsz:4 abid:15
    v_lshlrev_b32_sdwa v136, v15, v112 dst_sel:DWORD dst_unused:UNUSED_PAD src0_sel:DWORD src1_sel:WORD_1
    s_waitcnt vmcnt(10)
    v_mfma_f32_4x4x4_16b_bf16 v[104:107], v[146:147], v[92:93], 0 cbsz:4 abid:13
    s_nop 0
    v_mfma_f32_4x4x4_16b_bf16 v[108:111], v[146:147], v[94:95], 0 cbsz:4 abid:13
    v_lshlrev_b32_sdwa v137, v15, v113 dst_sel:DWORD dst_unused:UNUSED_PAD src0_sel:DWORD src1_sel:WORD_1
    ds_read_u16_d16_hi v128, v136 offset:32768
    ds_read_u16_d16_hi v129, v137 offset:32768
    s_waitcnt lgkmcnt(2)
    s_set_gpr_idx_on s54, 0xc
    v_pk_fma_f32 v[16:17], v[132:133], v[96:97], v[16:17] op_sel:[0,0,0] op_sel_hi:[0,1,1]
    v_pk_fma_f32 v[18:19], v[132:133], v[98:99], v[18:19] op_sel:[0,0,0] op_sel_hi:[0,1,1]
    v_pk_fma_f32 v[20:21], v[134:135], v[100:101], v[20:21] op_sel:[0,0,0] op_sel_hi:[0,1,1]
    v_pk_fma_f32 v[22:23], v[134:135], v[102:103], v[22:23] op_sel:[0,0,0] op_sel_hi:[0,1,1]
    s_set_gpr_idx_off
    s_sub_u32 s32, s32, 1
    s_cbranch_scc1 MAIN_DONE
    v_lshlrev_b32_sdwa v138, v15, v116 dst_sel:DWORD dst_unused:UNUSED_PAD src0_sel:DWORD src1_sel:WORD_1
    s_waitcnt vmcnt(9)
    v_mfma_f32_4x4x4_16b_bf16 v[96:99], v[140:141], v[64:65], 0 cbsz:4 abid:14
    s_nop 0
    v_mfma_f32_4x4x4_16b_bf16 v[100:103], v[140:141], v[66:67], 0 cbsz:4 abid:14
    v_lshlrev_b32_sdwa v139, v15, v117 dst_sel:DWORD dst_unused:UNUSED_PAD src0_sel:DWORD src1_sel:WORD_1
    ds_read_u16_d16_hi v130, v138 offset:32768
    ds_read_u16_d16_hi v131, v139 offset:32768
    s_set_gpr_idx_on s55, 0xc
    v_pk_fma_f32 v[16:17], v[132:133], v[104:105], v[16:17] op_sel:[1,0,0] op_sel_hi:[1,1,1]
    v_pk_fma_f32 v[18:19], v[132:133], v[106:107], v[18:19] op_sel:[1,0,0] op_sel_hi:[1,1,1]
    v_pk_fma_f32 v[20:21], v[134:135], v[108:109], v[20:21] op_sel:[1,0,0] op_sel_hi:[1,1,1]
    v_pk_fma_f32 v[22:23], v[134:135], v[110:111], v[22:23] op_sel:[1,0,0] op_sel_hi:[1,1,1]
    s_set_gpr_idx_off
    s_sub_u32 s32, s32, 1
    s_cbranch_scc1 MAIN_DONE
    v_mfma_f32_4x4x4_16b_bf16 v[124:127], v[172:173], v[178:179], 0 cbsz:4 abid:15
    v_lshlrev_b32_sdwa v136, v15, v114 dst_sel:DWORD dst_unused:UNUSED_PAD src0_sel:DWORD src1_sel:WORD_1
    s_waitcnt vmcnt(8)
    v_mfma_f32_4x4x4_16b_bf16 v[104:107], v[142:143], v[68:69], 0 cbsz:4 abid:14
    s_nop 0
    v_mfma_f32_4x4x4_16b_bf16 v[108:111], v[142:143], v[70:71], 0 cbsz:4 abid:14
    v_lshlrev_b32_sdwa v137, v15, v115 dst_sel:DWORD dst_unused:UNUSED_PAD src0_sel:DWORD src1_sel:WORD_1
    ds_read_u16_d16_hi v132, v136 offset:32768
    ds_read_u16_d16_hi v133, v137 offset:32768
    s_waitcnt lgkmcnt(2)
    s_set_gpr_idx_on s56, 0xc
    v_pk_fma_f32 v[16:17], v[128:129], v[96:97], v[16:17] op_sel:[0,0,0] op_sel_hi:[0,1,1]
    v_pk_fma_f32 v[18:19], v[128:129], v[98:99], v[18:19] op_sel:[0,0,0] op_sel_hi:[0,1,1]
    v_pk_fma_f32 v[20:21], v[130:131], v[100:101], v[20:21] op_sel:[0,0,0] op_sel_hi:[0,1,1]
    v_pk_fma_f32 v[22:23], v[130:131], v[102:103], v[22:23] op_sel:[0,0,0] op_sel_hi:[0,1,1]
    s_set_gpr_idx_off
    s_sub_u32 s32, s32, 1
    s_cbranch_scc1 MAIN_DONE
    v_lshlrev_b32_sdwa v138, v15, v118 dst_sel:DWORD dst_unused:UNUSED_PAD src0_sel:DWORD src1_sel:WORD_1
    v_mfma_f32_4x4x4_16b_bf16 v[96:99], v[144:145], v[72:73], 0 cbsz:4 abid:14
    s_nop 0
    v_mfma_f32_4x4x4_16b_bf16 v[100:103], v[144:145], v[74:75], 0 cbsz:4 abid:14
    v_lshlrev_b32_sdwa v139, v15, v119 dst_sel:DWORD dst_unused:UNUSED_PAD src0_sel:DWORD src1_sel:WORD_1
    ds_read_u16_d16_hi v134, v138 offset:32768
    ds_read_u16_d16_hi v135, v139 offset:32768
    s_set_gpr_idx_on s57, 0xc
    v_pk_fma_f32 v[16:17], v[128:129], v[104:105], v[16:17] op_sel:[1,0,0] op_sel_hi:[1,1,1]
    v_pk_fma_f32 v[18:19], v[128:129], v[106:107], v[18:19] op_sel:[1,0,0] op_sel_hi:[1,1,1]
    v_pk_fma_f32 v[20:21], v[130:131], v[108:109], v[20:21] op_sel:[1,0,0] op_sel_hi:[1,1,1]
    v_pk_fma_f32 v[22:23], v[130:131], v[110:111], v[22:23] op_sel:[1,0,0] op_sel_hi:[1,1,1]
    s_set_gpr_idx_off
    v_mov_b32 v172, v170
    v_mov_b32 v173, v171
    s_nop 1
    s_branch MAIN_DONE
B_56:
    buffer_load_dwordx4 v[188:191], v1, s[16:19], s10 offen offset:0 sc1
    buffer_load_dwordx4 v[192:195], v1, s[16:19], s10 offen offset:1024 sc1
    buffer_load_dwordx4 v[196:199], v1, s[16:19], s10 offen offset:2048 sc1
    buffer_load_dwordx4 v[200:203], v1, s[16:19], s10 offen offset:3072 sc1
    buffer_load_dwordx4 v[204:207], v1, s[16:19], s11 offen offset:0 sc1
    buffer_load_dwordx4 v[208:211], v1, s[16:19], s11 offen offset:1024 sc1
    buffer_load_dwordx4 v[212:215], v1, s[16:19], s11 offen offset:2048 sc1
    buffer_load_dwordx4 v[216:219], v1, s[16:19], s11 offen offset:3072 sc1
    s_sub_u32 s32, s32, 1
    s_cbranch_scc1 MAIN_DONE
    v_mfma_f32_4x4x4_16b_bf16 v[124:127], v[172:173], v[178:179], 0 cbsz:4 abid:15
    v_lshlrev_b32_sdwa v136, v15, v114 dst_sel:DWORD dst_unused:UNUSED_PAD src0_sel:DWORD src1_sel:WORD_1
    s_waitcnt vmcnt(12)
    v_mfma_f32_4x4x4_16b_bf16 v[104:107], v[142:143], v[68:69], 0 cbsz:4 abid:14
    s_nop 0
    v_mfma_f32_4x4x4_16b_bf16 v[108:111], v[142:143], v[70:71], 0 cbsz:4 abid:14
    v_lshlrev_b32_sdwa v137, v15, v115 dst_sel:DWORD dst_unused:UNUSED_PAD src0_sel:DWORD src1_sel:WORD_1
    ds_read_u16_d16_hi v132, v136 offset:32768
    ds_read_u16_d16_hi v133, v137 offset:32768
    s_waitcnt lgkmcnt(2)
    s_set_gpr_idx_on s56, 0xc
    v_pk_fma_f32 v[16:17], v[128:129], v[96:97], v[16:17] op_sel:[0,0,0] op_sel_hi:[0,1,1]
    v_pk_fma_f32 v[18:19], v[128:129], v[98:99], v[18:19] op_sel:[0,0,0] op_sel_hi:[0,1,1]
    v_pk_fma_f32 v[20:21], v[130:131], v[100:101], v[20:21] op_sel:[0,0,0] op_sel_hi:[0,1,1]
    v_pk_fma_f32 v[22:23], v[130:131], v[102:103], v[22:23] op_sel:[0,0,0] op_sel_hi:[0,1,1]
    s_set_gpr_idx_off
    s_sub_u32 s32, s32, 1
    s_cbranch_scc1 MAIN_DONE
    v_lshlrev_b32_sdwa v138, v15, v118 dst_sel:DWORD dst_unused:UNUSED_PAD src0_sel:DWORD src1_sel:WORD_1
    s_waitcnt vmcnt(11)
    v_mfma_f32_4x4x4_16b_bf16 v[96:99], v[144:145], v[72:73], 0 cbsz:4 abid:14
    s_nop 0
    v_mfma_f32_4x4x4_16b_bf16 v[100:103], v[144:145], v[74:75], 0 cbsz:4 abid:14
    v_lshlrev_b32_sdwa v139, v15, v119 dst_sel:DWORD dst_unused:UNUSED_PAD src0_sel:DWORD src1_sel:WORD_1
    ds_read_u16_d16_hi v134, v138 offset:32768
    ds_read_u16_d16_hi v135, v139 offset:32768
    s_set_gpr_idx_on s57, 0xc
    v_pk_fma_f32 v[16:17], v[128:129], v[104:105], v[16:17] op_sel:[1,0,0] op_sel_hi:[1,1,1]
    v_pk_fma_f32 v[18:19], v[128:129], v[106:107], v[18:19] op_sel:[1,0,0] op_sel_hi:[1,1,1]
    v_pk_fma_f32 v[20:21], v[130:131], v[108:109], v[20:21] op_sel:[1,0,0] op_sel_hi:[1,1,1]
    v_pk_fma_f32 v[22:23], v[130:131], v[110:111], v[22:23] op_sel:[1,0,0] op_sel_hi:[1,1,1]
    s_set_gpr_idx_off
    v_mov_b32 v172, v170
    v_mov_b32 v173, v171
    s_nop 1
    s_sub_u32 s32, s32, 1
    s_cbranch_scc1 MAIN_DONE
    v_mfma_f32_4x4x4_16b_bf16 v[112:115], v[172:173], v[176:177], 0 cbsz:4 abid:0
    v_lshlrev_b32_sdwa v136, v15, v120 dst_sel:DWORD dst_unused:UNUSED_PAD src0_sel:DWORD src1_sel:WORD_1
    s_waitcnt vmcnt(10)
    v_mfma_f32_4x4x4_16b_bf16 v[104:107], v[146:147], v[76:77], 0 cbsz:4 abid:14
    s_nop 0
    v_mfma_f32_4x4x4_16b_bf16 v[108:111], v[146:147], v[78:79], 0 cbsz:4 abid:14
    v_lshlrev_b32_sdwa v137, v15, v121 dst_sel:DWORD dst_unused:UNUSED_PAD src0_sel:DWORD src1_sel:WORD_1
    ds_read_u16_d16_hi v128, v136 offset:32768
    ds_read_u16_d16_hi v129, v137 offset:32768
    s_waitcnt lgkmcnt(2)
    s_set_gpr_idx_on s58, 0xc
    v_pk_fma_f32 v[16:17], v[132:133], v[96:97], v[16:17] op_sel:[0,0,0] op_sel_hi:[0,1,1]
    v_pk_fma_f32 v[18:19], v[132:133], v[98:99], v[18:19] op_sel:[0,0,0] op_sel_hi:[0,1,1]
    v_pk_fma_f32 v[20:21], v[134:135], v[100:101], v[20:21] op_sel:[0,0,0] op_sel_hi:[0,1,1]
    v_pk_fma_f32 v[22:23], v[134:135], v[102:103], v[22:23] op_sel:[0,0,0] op_sel_hi:[0,1,1]
    s_set_gpr_idx_off
    s_sub_u32 s32, s32, 1
    s_cbranch_scc1 MAIN_DONE
    v_lshlrev_b32_sdwa v138, v15, v124 dst_sel:DWORD dst_unused:UNUSED_PAD src0_sel:DWORD src1_sel:WORD_1
    s_waitcnt vmcnt(9)
    v_mfma_f32_4x4x4_16b_bf16 v[96:99], v[140:141], v[80:81], 0 cbsz:4 abid:15
    s_nop 0
    v_mfma_f32_4x4x4_16b_bf16 v[100:103], v[140:141], v[82:83], 0 cbsz:4 abid:15
    v_lshlrev_b32_sdwa v139, v15, v125 dst_sel:DWORD dst_unused:UNUSED_PAD src0_sel:DWORD src1_sel:WORD_1
    ds_read_u16_d16_hi v130, v138 offset:32768
    ds_read_u16_d16_hi v131, v139 offset:32768
    s_set_gpr_idx_on s59, 0xc
    v_pk_fma_f32 v[16:17], v[132:133], v[104:105], v[16:17] op_sel:[1,0,0] op_sel_hi:[1,1,1]
    v_pk_fma_f32 v[18:19], v[132:133], v[106:107], v[18:19] op_sel:[1,0,0] op_sel_hi:[1,1,1]
    v_pk_fma_f32 v[20:21], v[134:135], v[108:109], v[20:21] op_sel:[1,0,0] op_sel_hi:[1,1,1]
    v_pk_fma_f32 v[22:23], v[134:135], v[110:111], v[22:23] op_sel:[1,0,0] op_sel_hi:[1,1,1]
    s_set_gpr_idx_off
    s_sub_u32 s32, s32, 1
    s_cbranch_scc1 MAIN_DONE
    v_mfma_f32_4x4x4_16b_bf16 v[116:119], v[172:173], v[178:179], 0 cbsz:4 abid:0
    v_lshlrev_b32_sdwa v136, v15, v122 dst_sel:DWORD dst_unused:UNUSED_PAD src0_sel:DWORD src1_sel:WORD_1
    s_waitcnt vmcnt(8)
    v_mfma_f32_4x4x4_16b_bf16 v[104:107], v[142:143], v[84:85], 0 cbsz:4 abid:15
    s_nop 0
    v_mfma_f32_4x4x4_16b_bf16 v[108:111], v[142:143], v[86:87], 0 cbsz:4 abid:15
    v_lshlrev_b32_sdwa v137, v15, v123 dst_sel:DWORD dst_unused:UNUSED_PAD src0_sel:DWORD src1_sel:WORD_1
    ds_read_u16_d16_hi v132, v136 offset:32768
    ds_read_u16_d16_hi v133, v137 offset:32768
    v_cvt_pk_bf16_f32 v140, v148, v152
    v_cvt_pk_bf16_f32 v141, v156, v160
    s_waitcnt lgkmcnt(2)
    s_set_gpr_idx_on s60, 0xc
    v_pk_fma_f32 v[16:17], v[128:129], v[96:97], v[16:17] op_sel:[0,0,0] op_sel_hi:[0,1,1]
    v_pk_fma_f32 v[18:19], v[128:129], v[98:99], v[18:19] op_sel:[0,0,0] op_sel_hi:[0,1,1]
    v_pk_fma_f32 v[20:21], v[130:131], v[100:101], v[20:21] op_sel:[0,0,0] op_sel_hi:[0,1,1]
    v_pk_fma_f32 v[22:23], v[130:131], v[102:103], v[22:23] op_sel:[0,0,0] op_sel_hi:[0,1,1]
    s_set_gpr_idx_off
    s_sub_u32 s32, s32, 1
    s_cbranch_scc1 MAIN_DONE
    v_lshlrev_b32_sdwa v138, v15, v126 dst_sel:DWORD dst_unused:UNUSED_PAD src0_sel:DWORD src1_sel:WORD_1
    v_mfma_f32_4x4x4_16b_bf16 v[96:99], v[144:145], v[88:89], 0 cbsz:4 abid:15
    s_nop 0
    v_mfma_f32_4x4x4_16b_bf16 v[100:103], v[144:145], v[90:91], 0 cbsz:4 abid:15
    v_lshlrev_b32_sdwa v139, v15, v127 dst_sel:DWORD dst_unused:UNUSED_PAD src0_sel:DWORD src1_sel:WORD_1
    ds_read_u16_d16_hi v134, v138 offset:32768
    ds_read_u16_d16_hi v135, v139 offset:32768
    v_cvt_pk_bf16_f32 v142, v149, v153
    v_cvt_pk_bf16_f32 v143, v157, v161
    s_set_gpr_idx_on s61, 0xc
    v_pk_fma_f32 v[16:17], v[128:129], v[104:105], v[16:17] op_sel:[1,0,0] op_sel_hi:[1,1,1]
    v_pk_fma_f32 v[18:19], v[128:129], v[106:107], v[18:19] op_sel:[1,0,0] op_sel_hi:[1,1,1]
    v_pk_fma_f32 v[20:21], v[130:131], v[108:109], v[20:21] op_sel:[1,0,0] op_sel_hi:[1,1,1]
    v_pk_fma_f32 v[22:23], v[130:131], v[110:111], v[22:23] op_sel:[1,0,0] op_sel_hi:[1,1,1]
    s_set_gpr_idx_off
    s_branch MAIN_DONE
B_60:
    buffer_load_dwordx4 v[188:191], v1, s[16:19], s10 offen offset:0 sc1
    buffer_load_dwordx4 v[192:195], v1, s[16:19], s10 offen offset:1024 sc1
    buffer_load_dwordx4 v[196:199], v1, s[16:19], s10 offen offset:2048 sc1
    buffer_load_dwordx4 v[200:203], v1, s[16:19], s10 offen offset:3072 sc1
    buffer_load_dwordx4 v[204:207], v1, s[16:19], s11 offen offset:0 sc1
    buffer_load_dwordx4 v[208:211], v1, s[16:19], s11 offen offset:1024 sc1
    buffer_load_dwordx4 v[212:215], v1, s[16:19], s11 offen offset:2048 sc1
    buffer_load_dwordx4 v[216:219], v1, s[16:19], s11 offen offset:3072 sc1
    s_sub_u32 s32, s32, 1
    s_cbranch_scc1 MAIN_DONE
    v_mfma_f32_4x4x4_16b_bf16 v[116:119], v[172:173], v[178:179], 0 cbsz:4 abid:0
    v_lshlrev_b32_sdwa v136, v15, v122 dst_sel:DWORD dst_unused:UNUSED_PAD src0_sel:DWORD src1_sel:WORD_1
    s_waitcnt vmcnt(12)
    v_mfma_f32_4x4x4_16b_bf16 v[104:107], v[142:143], v[84:85], 0 cbsz:4 abid:15
    s_nop 0
    v_mfma_f32_4x4x4_16b_bf16 v[108:111], v[142:143], v[86:87], 0 cbsz:4 abid:15
    v_lshlrev_b32_sdwa v137, v15, v123 dst_sel:DWORD dst_unused:UNUSED_PAD src0_sel:DWORD src1_sel:WORD_1
    ds_read_u16_d16_hi v132, v136 offset:32768
    ds_read_u16_d16_hi v133, v137 offset:32768
    v_cvt_pk_bf16_f32 v140, v148, v152
    v_cvt_pk_bf16_f32 v141, v156, v160
    s_waitcnt lgkmcnt(2)
    s_set_gpr_idx_on s60, 0xc
    v_pk_fma_f32 v[16:17], v[128:129], v[96:97], v[16:17] op_sel:[0,0,0] op_sel_hi:[0,1,1]
    v_pk_fma_f32 v[18:19], v[128:129], v[98:99], v[18:19] op_sel:[0,0,0] op_sel_hi:[0,1,1]
    v_pk_fma_f32 v[20:21], v[130:131], v[100:101], v[20:21] op_sel:[0,0,0] op_sel_hi:[0,1,1]
    v_pk_fma_f32 v[22:23], v[130:131], v[102:103], v[22:23] op_sel:[0,0,0] op_sel_hi:[0,1,1]
    s_set_gpr_idx_off
    s_sub_u32 s32, s32, 1
    s_cbranch_scc1 MAIN_DONE
    v_lshlrev_b32_sdwa v138, v15, v126 dst_sel:DWORD dst_unused:UNUSED_PAD src0_sel:DWORD src1_sel:WORD_1
    s_waitcnt vmcnt(11)
    v_mfma_f32_4x4x4_16b_bf16 v[96:99], v[144:145], v[88:89], 0 cbsz:4 abid:15
    s_nop 0
    v_mfma_f32_4x4x4_16b_bf16 v[100:103], v[144:145], v[90:91], 0 cbsz:4 abid:15
    v_lshlrev_b32_sdwa v139, v15, v127 dst_sel:DWORD dst_unused:UNUSED_PAD src0_sel:DWORD src1_sel:WORD_1
    ds_read_u16_d16_hi v134, v138 offset:32768
    ds_read_u16_d16_hi v135, v139 offset:32768
    v_cvt_pk_bf16_f32 v142, v149, v153
    v_cvt_pk_bf16_f32 v143, v157, v161
    s_set_gpr_idx_on s61, 0xc
    v_pk_fma_f32 v[16:17], v[128:129], v[104:105], v[16:17] op_sel:[1,0,0] op_sel_hi:[1,1,1]
    v_pk_fma_f32 v[18:19], v[128:129], v[106:107], v[18:19] op_sel:[1,0,0] op_sel_hi:[1,1,1]
    v_pk_fma_f32 v[20:21], v[130:131], v[108:109], v[20:21] op_sel:[1,0,0] op_sel_hi:[1,1,1]
    v_pk_fma_f32 v[22:23], v[130:131], v[110:111], v[22:23] op_sel:[1,0,0] op_sel_hi:[1,1,1]
    s_set_gpr_idx_off
    s_sub_u32 s32, s32, 1
    s_cbranch_scc1 MAIN_DONE
    v_mfma_f32_4x4x4_16b_bf16 v[120:123], v[172:173], v[176:177], 0 cbsz:4 abid:1
    v_lshlrev_b32_sdwa v136, v15, v112 dst_sel:DWORD dst_unused:UNUSED_PAD src0_sel:DWORD src1_sel:WORD_1
    s_waitcnt vmcnt(10)
    v_mfma_f32_4x4x4_16b_bf16 v[104:107], v[146:147], v[92:93], 0 cbsz:4 abid:15
    s_nop 0
    v_mfma_f32_4x4x4_16b_bf16 v[108:111], v[146:147], v[94:95], 0 cbsz:4 abid:15
    v_lshlrev_b32_sdwa v137, v15, v113 dst_sel:DWORD dst_unused:UNUSED_PAD src0_sel:DWORD src1_sel:WORD_1
    ds_read_u16_d16_hi v128, v136 offset:32768
    ds_read_u16_d16_hi v129, v137 offset:32768
    v_cvt_pk_bf16_f32 v144, v150, v154
    v_cvt_pk_bf16_f32 v145, v158, v162
    s_waitcnt lgkmcnt(2)
    s_set_gpr_idx_on s62, 0xc
    v_pk_fma_f32 v[16:17], v[132:133], v[96:97], v[16:17] op_sel:[0,0,0] op_sel_hi:[0,1,1]
    v_pk_fma_f32 v[18:19], v[132:133], v[98:99], v[18:19] op_sel:[0,0,0] op_sel_hi:[0,1,1]
    v_pk_fma_f32 v[20:21], v[134:135], v[100:101], v[20:21] op_sel:[0,0,0] op_sel_hi:[0,1,1]
    v_pk_fma_f32 v[22:23], v[134:135], v[102:103], v[22:23] op_sel:[0,0,0] op_sel_hi:[0,1,1]
    s_set_gpr_idx_off
    s_sub_u32 s32, s32, 1
    s_cbranch_scc1 MAIN_DONE
    v_lshlrev_b32_sdwa v138, v15, v116 dst_sel:DWORD dst_unused:UNUSED_PAD src0_sel:DWORD src1_sel:WORD_1
    s_waitcnt vmcnt(9)
    v_mfma_f32_4x4x4_16b_bf16 v[96:99], v[140:141], v[64:65], 0 cbsz:4 abid:0
    s_nop 0
    v_mfma_f32_4x4x4_16b_bf16 v[100:103], v[140:141], v[66:67], 0 cbsz:4 abid:0
    v_lshlrev_b32_sdwa v139, v15, v117 dst_sel:DWORD dst_unused:UNUSED_PAD src0_sel:DWORD src1_sel:WORD_1
    ds_read_u16_d16_hi v130, v138 offset:32768
    ds_read_u16_d16_hi v131, v139 offset:32768
    v_cvt_pk_bf16_f32 v146, v151, v155
    v_cvt_pk_bf16_f32 v147, v159, v163
    s_set_gpr_idx_on s63, 0xc
    v_pk_fma_f32 v[16:17], v[132:133], v[104:105], v[16:17] op_sel:[1,0,0] op_sel_hi:[1,1,1]
    v_pk_fma_f32 v[18:19], v[132:133], v[106:107], v[18:19] op_sel:[1,0,0] op_sel_hi:[1,1,1]
    v_pk_fma_f32 v[20:21], v[134:135], v[108:109], v[20:21] op_sel:[1,0,0] op_sel_hi:[1,1,1]
    v_pk_fma_f32 v[22:23], v[134:135], v[110:111], v[22:23] op_sel:[1,0,0] op_sel_hi:[1,1,1]
    s_set_gpr_idx_off
    s_sub_u32 s32, s32, 1
    s_cbranch_scc1 MAIN_DONE
    v_mfma_f32_4x4x4_16b_bf16 v[124:127], v[172:173], v[178:179], 0 cbsz:4 abid:1
    v_lshlrev_b32_sdwa v136, v15, v114 dst_sel:DWORD dst_unused:UNUSED_PAD src0_sel:DWORD src1_sel:WORD_1
    s_waitcnt vmcnt(8)
    v_mfma_f32_4x4x4_16b_bf16 v[104:107], v[142:143], v[68:69], 0 cbsz:4 abid:0
    s_nop 0
    v_mfma_f32_4x4x4_16b_bf16 v[108:111], v[142:143], v[70:71], 0 cbsz:4 abid:0
    v_lshlrev_b32_sdwa v137, v15, v115 dst_sel:DWORD dst_unused:UNUSED_PAD src0_sel:DWORD src1_sel:WORD_1
    ds_read_u16_d16_hi v132, v136 offset:32768
    ds_read_u16_d16_hi v133, v137 offset:32768
    s_waitcnt lgkmcnt(2)
    s_set_gpr_idx_on s48, 0xc
    v_pk_fma_f32 v[16:17], v[128:129], v[96:97], v[16:17] op_sel:[0,0,0] op_sel_hi:[0,1,1]
    v_pk_fma_f32 v[18:19], v[128:129], v[98:99], v[18:19] op_sel:[0,0,0] op_sel_hi:[0,1,1]
    v_pk_fma_f32 v[20:21], v[130:131], v[100:101], v[20:21] op_sel:[0,0,0] op_sel_hi:[0,1,1]
    v_pk_fma_f32 v[22:23], v[130:131], v[102:103], v[22:23] op_sel:[0,0,0] op_sel_hi:[0,1,1]
    s_set_gpr_idx_off
    s_sub_u32 s32, s32, 1
    s_cbranch_scc1 MAIN_DONE
    v_lshlrev_b32_sdwa v138, v15, v118 dst_sel:DWORD dst_unused:UNUSED_PAD src0_sel:DWORD src1_sel:WORD_1
    v_mfma_f32_4x4x4_16b_bf16 v[96:99], v[144:145], v[72:73], 0 cbsz:4 abid:0
    s_nop 0
    v_mfma_f32_4x4x4_16b_bf16 v[100:103], v[144:145], v[74:75], 0 cbsz:4 abid:0
    v_lshlrev_b32_sdwa v139, v15, v119 dst_sel:DWORD dst_unused:UNUSED_PAD src0_sel:DWORD src1_sel:WORD_1
    ds_read_u16_d16_hi v134, v138 offset:32768
    ds_read_u16_d16_hi v135, v139 offset:32768
    s_set_gpr_idx_on s49, 0xc
    v_pk_fma_f32 v[16:17], v[128:129], v[104:105], v[16:17] op_sel:[1,0,0] op_sel_hi:[1,1,1]
    v_pk_fma_f32 v[18:19], v[128:129], v[106:107], v[18:19] op_sel:[1,0,0] op_sel_hi:[1,1,1]
    v_pk_fma_f32 v[20:21], v[130:131], v[108:109], v[20:21] op_sel:[1,0,0] op_sel_hi:[1,1,1]
    v_pk_fma_f32 v[22:23], v[130:131], v[110:111], v[22:23] op_sel:[1,0,0] op_sel_hi:[1,1,1]
    s_set_gpr_idx_off
    s_branch MAIN_DONE
MAIN_DONE:
    s_add_u32 s27, s27, 1472
    s_cmp_ge_u32 s27, s26
    s_cbranch_scc1 ALL_DONE
    s_waitcnt vmcnt(0) lgkmcnt(0)
    v_lshlrev_b32 v11, 2, v0
    v_mov_b32 v12, 0
    v_cmp_gt_u32 vcc, 480, v0
    s_and_saveexec_b64 s[42:43], vcc
    ds_write_b32 v11, v12 offset:0
    s_mov_b64 exec, s[42:43]
    s_waitcnt lgkmcnt(0)
    s_barrier
    s_branch ROUND
ALL_DONE:
    v_lshrrev_b32 v11, 8, v1
    s_lshr_b32 s42, s25, 2
    s_mul_i32 s43, s42, 80
    v_mul_u32_u24 v9, 20, v11
    v_add_u32 v9, s43, v9
    ds_read_b32 v112, v9 offset:1920
    ds_read_b32 v113, v9 offset:1924
    ds_read_b32 v114, v9 offset:1928
    ds_read_b32 v115, v9 offset:1932
    ds_read_b32 v116, v9 offset:1936
    v_cvt_pk_bf16_f32 v140, v16, v20
    v_cvt_pk_bf16_f32 v141, v17, v21
    v_cvt_pk_bf16_f32 v142, v18, v22
    v_cvt_pk_bf16_f32 v143, v19, v23
    v_cvt_pk_bf16_f32 v144, v24, v28
    v_cvt_pk_bf16_f32 v145, v25, v29
    v_cvt_pk_bf16_f32 v146, v26, v30
    v_cvt_pk_bf16_f32 v147, v27, v31
    v_cvt_pk_bf16_f32 v148, v32, v36
    v_cvt_pk_bf16_f32 v149, v33, v37
    v_cvt_pk_bf16_f32 v150, v34, v38
    v_cvt_pk_bf16_f32 v151, v35, v39
    v_cvt_pk_bf16_f32 v152, v40, v44
    v_cvt_pk_bf16_f32 v153, v41, v45
    v_cvt_pk_bf16_f32 v154, v42, v46
    v_cvt_pk_bf16_f32 v155, v43, v47
    v_cvt_pk_bf16_f32 v156, v48, v52
    v_cvt_pk_bf16_f32 v157, v49, v53
    v_cvt_pk_bf16_f32 v158, v50, v54
    v_cvt_pk_bf16_f32 v159, v51, v55
    s_mul_i32 s43, s25, 1152
    s_add_u32 s43, s43, 32768
    v_lshrrev_b32 v12, 2, v1
    v_add_u32 v12, s43, v12
    v_bfe_u32 v10, v1, 4, 4
    s_mul_i32 s43, s42, 4608
    s_add_u32 s43, s43, 32768
    v_mul_u32_u24 v8, 288, v10
    v_lshl_add_u32 v8, v11, 4, v8
    v_add_u32 v8, s43, v8
    s_lshl_b32 s42, s24, 10
    s_and_b32 s43, s25, 3
    s_lshl_b32 s43, s43, 8
    s_add_u32 s42, s42, s43
    v_lshl_add_u32 v10, v10, 4, s42
    s_waitcnt lgkmcnt(0)
    v_lshl_add_u32 v112, v112, 18, v10
    v_lshl_add_u32 v113, v113, 18, v10
    v_lshl_add_u32 v114, v114, 18, v10
    v_lshl_add_u32 v115, v115, 18, v10
    v_lshl_add_u32 v116, v116, 18, v10
    s_barrier
    ds_write_b32 v12, v140 offset:0
    ds_write_b32 v12, v141 offset:288
    ds_write_b32 v12, v142 offset:576
    ds_write_b32 v12, v143 offset:864
    ds_write_b32 v12, v144 offset:9216
    ds_write_b32 v12, v145 offset:9504
    ds_write_b32 v12, v146 offset:9792
    ds_write_b32 v12, v147 offset:10080
    s_waitcnt vmcnt(0) lgkmcnt(0)
    s_barrier
    ds_read_b128 v[64:67], v8 offset:0
    ds_read_b128 v[68:71], v8 offset:64
    ds_read_b128 v[72:75], v8 offset:128
    ds_read_b128 v[76:79], v8 offset:192
    ds_read_b128 v[80:83], v8 offset:9216
    ds_read_b128 v[84:87], v8 offset:9280
    ds_read_b128 v[88:91], v8 offset:9344
    ds_read_b128 v[92:95], v8 offset:9408
    s_waitcnt lgkmcnt(4)
    ds_write_b32 v12, v148 offset:18432
    ds_write_b32 v12, v149 offset:18720
    ds_write_b32 v12, v150 offset:19008
    ds_write_b32 v12, v151 offset:19296
    ds_write_b32 v12, v152 offset:27648
    ds_write_b32 v12, v153 offset:27936
    ds_write_b32 v12, v154 offset:28224
    ds_write_b32 v12, v155 offset:28512
    v_mfma_f32_16x16x32_bf16 v[16:19], v[64:67], v[188:191], 0
    v_mfma_f32_16x16x32_bf16 v[20:23], v[64:67], v[204:207], 0
    v_mfma_f32_16x16x32_bf16 v[16:19], v[68:71], v[192:195], v[16:19]
    v_mfma_f32_16x16x32_bf16 v[20:23], v[68:71], v[208:211], v[20:23]
    v_mfma_f32_16x16x32_bf16 v[16:19], v[72:75], v[196:199], v[16:19]
    v_mfma_f32_16x16x32_bf16 v[20:23], v[72:75], v[212:215], v[20:23]
    v_mfma_f32_16x16x32_bf16 v[16:19], v[76:79], v[200:203], v[16:19]
    v_mfma_f32_16x16x32_bf16 v[20:23], v[76:79], v[216:219], v[20:23]
    ds_write_b32 v12, v156 offset:36864
    ds_write_b32 v12, v157 offset:37152
    ds_write_b32 v12, v158 offset:37440
    ds_write_b32 v12, v159 offset:37728
    s_waitcnt lgkmcnt(0)
    s_barrier
    ds_read_b128 v[64:67], v8 offset:18432
    ds_read_b128 v[68:71], v8 offset:18496
    ds_read_b128 v[72:75], v8 offset:18560
    ds_read_b128 v[76:79], v8 offset:18624
    v_mfma_f32_16x16x32_bf16 v[24:27], v[80:83], v[188:191], 0
    v_mfma_f32_16x16x32_bf16 v[28:31], v[80:83], v[204:207], 0
    v_mfma_f32_16x16x32_bf16 v[24:27], v[84:87], v[192:195], v[24:27]
    v_mfma_f32_16x16x32_bf16 v[28:31], v[84:87], v[208:211], v[28:31]
    v_mfma_f32_16x16x32_bf16 v[24:27], v[88:91], v[196:199], v[24:27]
    v_mfma_f32_16x16x32_bf16 v[28:31], v[88:91], v[212:215], v[28:31]
    v_mfma_f32_16x16x32_bf16 v[24:27], v[92:95], v[200:203], v[24:27]
    v_mfma_f32_16x16x32_bf16 v[28:31], v[92:95], v[216:219], v[28:31]
    v_cvt_pk_bf16_f32 v128, v16, v17
    v_cvt_pk_bf16_f32 v129, v18, v19
    v_cvt_pk_bf16_f32 v130, v20, v21
    v_cvt_pk_bf16_f32 v131, v22, v23
    buffer_store_dwordx4 v[128:131], v112, s[20:23], 0 offen sc0 sc1
    ds_read_b128 v[80:83], v8 offset:27648
    ds_read_b128 v[84:87], v8 offset:27712
    ds_read_b128 v[88:91], v8 offset:27776
    ds_read_b128 v[92:95], v8 offset:27840
    s_waitcnt lgkmcnt(7)
    v_mfma_f32_16x16x32_bf16 v[32:35], v[64:67], v[188:191], 0
    v_mfma_f32_16x16x32_bf16 v[36:39], v[64:67], v[204:207], 0
    s_waitcnt lgkmcnt(6)
    v_mfma_f32_16x16x32_bf16 v[32:35], v[68:71], v[192:195], v[32:35]
    v_mfma_f32_16x16x32_bf16 v[36:39], v[68:71], v[208:211], v[36:39]
    s_waitcnt lgkmcnt(5)
    v_mfma_f32_16x16x32_bf16 v[32:35], v[72:75], v[196:199], v[32:35]
    v_mfma_f32_16x16x32_bf16 v[36:39], v[72:75], v[212:215], v[36:39]
    s_waitcnt lgkmcnt(4)
    v_mfma_f32_16x16x32_bf16 v[32:35], v[76:79], v[200:203], v[32:35]
    v_mfma_f32_16x16x32_bf16 v[36:39], v[76:79], v[216:219], v[36:39]
    v_cvt_pk_bf16_f32 v132, v24, v25
    v_cvt_pk_bf16_f32 v133, v26, v27
    v_cvt_pk_bf16_f32 v134, v28, v29
    v_cvt_pk_bf16_f32 v135, v30, v31
    buffer_store_dwordx4 v[132:135], v113, s[20:23], 0 offen sc0 sc1
    ds_read_b128 v[64:67], v8 offset:36864
    ds_read_b128 v[68:71], v8 offset:36928
    ds_read_b128 v[72:75], v8 offset:36992
    ds_read_b128 v[76:79], v8 offset:37056
    s_waitcnt lgkmcnt(7)
    v_mfma_f32_16x16x32_bf16 v[40:43], v[80:83], v[188:191], 0
    v_mfma_f32_16x16x32_bf16 v[44:47], v[80:83], v[204:207], 0
    s_waitcnt lgkmcnt(6)
    v_mfma_f32_16x16x32_bf16 v[40:43], v[84:87], v[192:195], v[40:43]
    v_mfma_f32_16x16x32_bf16 v[44:47], v[84:87], v[208:211], v[44:47]
    s_waitcnt lgkmcnt(5)
    v_mfma_f32_16x16x32_bf16 v[40:43], v[88:91], v[196:199], v[40:43]
    v_mfma_f32_16x16x32_bf16 v[44:47], v[88:91], v[212:215], v[44:47]
    s_waitcnt lgkmcnt(4)
    v_mfma_f32_16x16x32_bf16 v[40:43], v[92:95], v[200:203], v[40:43]
    v_mfma_f32_16x16x32_bf16 v[44:47], v[92:95], v[216:219], v[44:47]
    v_cvt_pk_bf16_f32 v128, v32, v33
    v_cvt_pk_bf16_f32 v129, v34, v35
    v_cvt_pk_bf16_f32 v130, v36, v37
    v_cvt_pk_bf16_f32 v131, v38, v39
    buffer_store_dwordx4 v[128:131], v114, s[20:23], 0 offen sc0 sc1
    s_waitcnt lgkmcnt(3)
    v_mfma_f32_16x16x32_bf16 v[48:51], v[64:67], v[188:191], 0
    v_mfma_f32_16x16x32_bf16 v[52:55], v[64:67], v[204:207], 0
    s_waitcnt lgkmcnt(2)
    v_mfma_f32_16x16x32_bf16 v[48:51], v[68:71], v[192:195], v[48:51]
    v_mfma_f32_16x16x32_bf16 v[52:55], v[68:71], v[208:211], v[52:55]
    s_waitcnt lgkmcnt(1)
    v_mfma_f32_16x16x32_bf16 v[48:51], v[72:75], v[196:199], v[48:51]
    v_mfma_f32_16x16x32_bf16 v[52:55], v[72:75], v[212:215], v[52:55]
    s_waitcnt lgkmcnt(0)
    v_mfma_f32_16x16x32_bf16 v[48:51], v[76:79], v[200:203], v[48:51]
    v_mfma_f32_16x16x32_bf16 v[52:55], v[76:79], v[216:219], v[52:55]
    v_cvt_pk_bf16_f32 v132, v40, v41
    v_cvt_pk_bf16_f32 v133, v42, v43
    v_cvt_pk_bf16_f32 v134, v44, v45
    v_cvt_pk_bf16_f32 v135, v46, v47
    buffer_store_dwordx4 v[132:135], v115, s[20:23], 0 offen sc0 sc1
    s_nop 3
    v_cvt_pk_bf16_f32 v128, v48, v49
    v_cvt_pk_bf16_f32 v129, v50, v51
    v_cvt_pk_bf16_f32 v130, v52, v53
    v_cvt_pk_bf16_f32 v131, v54, v55
    buffer_store_dwordx4 v[128:131], v116, s[20:23], 0 offen sc0 sc1
END:
    s_endpgm
    .p2align 6
    .type DEAL_TABLE,@object
DEAL_TABLE:
    .byte 80, 40, 84, 140, 120, 60, 20, 100, 0, 88, 44, 124, 24, 144, 64, 104, 4, 92, 148, 68, 8, 28, 108, 128, 48, 112, 12, 32, 132, 152, 72, 52, 16, 116, 76, 36, 136, 156, 56, 96, 0, 0, 0, 0, 0, 0, 0, 0, 0, 0, 0, 0, 0, 0, 0, 0, 0, 0, 0, 0, 0, 0, 0, 0, 0, 40, 140, 20, 80, 120, 100, 60, 124, 64, 24, 144, 84, 4, 44, 104, 88, 68, 108, 128, 148, 28, 8, 48, 152, 112, 52, 92, 72, 132, 12, 32, 116, 36, 76, 136, 96, 56, 156, 16, 0, 0, 0, 0, 0, 0, 0, 0, 0, 0, 0, 0, 0, 0, 0, 0, 0, 0, 0, 0, 0, 0, 0, 0
    .size DEAL_TABLE, 128
.section .rodata,"a"
.p2align 6
.amdhsa_kernel gather_scatter__tensor_product_equiv_tfn__graph_kernel
  .amdhsa_next_free_vgpr 220
  .amdhsa_next_free_sgpr 66
  .amdhsa_accum_offset 220
  .amdhsa_group_segment_fixed_size 0
  .amdhsa_kernarg_size 88
  .amdhsa_user_sgpr_count 2
  .amdhsa_user_sgpr_kernarg_segment_ptr 1
  .amdhsa_system_sgpr_workgroup_id_x 1
  .amdhsa_float_denorm_mode_32 3
.end_amdhsa_kernel
```

```asm
; @launch grid=(256,1,1) block=(512,1,1) lds=163840
.amdgcn_target "amdgcn-amd-amdhsa--gfx950"
.text
.globl gather_scatter__tensor_product_equiv_tfn__graph_kernel
.p2align 8
.type gather_scatter__tensor_product_equiv_tfn__graph_kernel,@function
gather_scatter__tensor_product_equiv_tfn__graph_kernel:
    s_cmp_ge_u32 s2, 256
    s_cbranch_scc1 END
    s_load_dwordx16 s[40:55], s[0:1], 0
    s_load_dwordx2 s[16:17], s[0:1], 80
    s_load_dwordx2 s[12:13], s[0:1], 0
    s_load_dwordx2 s[20:21], s[0:1], 64
    s_getpc_b64 s[6:7]
CODE_HERE:
    v_lshrrev_b32 v8, 6, v0
    s_lshr_b32 s5, s2, 3
    s_lshl_b32 s4, s5, 10
    v_readfirstlane_b32 s25, v8
    v_and_b32 v10, 7, v0
    v_lshl_add_u32 v10, v10, 7, s4
    v_min_u32 v10, END-CODE_HERE, v10
    s_cmp_lg_u32 s25, 7
    s_cbranch_scc1 NO_CODE_TOUCH
    global_load_dword v167, v10, s[6:7]
NO_CODE_TOUCH:
    s_mul_i32 s3, s2, 5120
    v_lshl_add_u32 v8, v0, 4, s3
    v_and_b32 v10, 63, v0
    v_lshlrev_b32 v1, 4, v10
    v_lshlrev_b32 v193, 2, v10
    s_cmp_ge_u32 s25, 5
    s_waitcnt lgkmcnt(0)
    s_cbranch_scc1 NO_EDGES
    s_cmp_ge_u32 s2, 250
    s_cbranch_scc1 AUX_LOAD
    s_setprio 1
    global_load_dwordx4 v[64:67], v8, s[44:45]
    global_load_dwordx4 v[68:71], v8, s[42:43]
NO_EDGES:
    global_load_dword v188, v193, s[50:51] offset:0
    global_load_dword v189, v193, s[50:51] offset:256
    global_load_dword v190, v193, s[50:51] offset:512
    global_load_dword v191, v193, s[50:51] offset:768
    v_and_b32 v193, 0x7f, v193
    global_load_dword v192, v193, s[52:53]
    s_and_b32 s3, s2, 0x87
    s_cmp_eq_u32 s3, 0
    s_cselect_b32 s3, 128, 0
    s_add_u32 s3, s3, DEAL_TABLE-CODE_HERE
    v_lshl_add_u32 v174, v10, 1, s3
    global_load_ushort v174, v174, s[6:7]
    s_mov_b32 s14, 10240000
    s_mov_b32 s15, 0x20000
    v_lshlrev_b32 v9, 1, v8
    v_lshlrev_b32 v11, 4, v0
    v_mov_b32 v12, 0
    v_mov_b32 v13, 0
    v_pk_mov_b32 v[16:17], v[12:13], v[12:13]
    v_pk_mov_b32 v[18:19], v[12:13], v[12:13]
    ds_write_b128 v11, v[16:19]
    s_and_b32 s4, s2, 7
    s_lshl_b32 s4, s4, 5
    s_lshr_b32 s5, s2, 3
    s_or_b32 s24, s4, s5
    v_mov_b32 v15, 1
    s_mov_b32 s18, 8913024
    s_mov_b32 s19, 0x20000
    s_mov_b32 s22, 10240000
    s_mov_b32 s23, 0x20000
    s_mov_b32 s34, 0xfffffc00
    s_mov_b32 s27, 0
    s_mov_b32 s10, 0xbfb8aa3b
    s_mov_b32 s11, 0xbfb8aa3b
    s_mov_b32 s35, 2097152
    v_and_b32 v4, 0xff, v0
    s_lshl_b32 s3, s24, 4
    s_add_u32 s3, s3, 7864320
    v_lshl_add_u32 v6, v4, 12, s3
    v_mul_u32_u24 v4, 1280, v4
    v_mul_u32_u24 v138, 0x8000, v1
    v_lshl_add_u32 v138, v10, 3, v138
    v_pk_mov_b32 v[20:21], v[12:13], v[12:13]
    v_pk_mov_b32 v[22:23], v[12:13], v[12:13]
    v_pk_mov_b32 v[24:25], v[12:13], v[12:13]
    v_pk_mov_b32 v[26:27], v[12:13], v[12:13]
    v_pk_mov_b32 v[28:29], v[12:13], v[12:13]
    v_pk_mov_b32 v[30:31], v[12:13], v[12:13]
    v_pk_mov_b32 v[32:33], v[12:13], v[12:13]
    v_pk_mov_b32 v[34:35], v[12:13], v[12:13]
    v_pk_mov_b32 v[36:37], v[12:13], v[12:13]
    v_pk_mov_b32 v[38:39], v[12:13], v[12:13]
    v_pk_mov_b32 v[40:41], v[12:13], v[12:13]
    v_pk_mov_b32 v[42:43], v[12:13], v[12:13]
    v_pk_mov_b32 v[44:45], v[12:13], v[12:13]
    v_pk_mov_b32 v[46:47], v[12:13], v[12:13]
    v_pk_mov_b32 v[48:49], v[12:13], v[12:13]
    v_pk_mov_b32 v[50:51], v[12:13], v[12:13]
    v_pk_mov_b32 v[52:53], v[12:13], v[12:13]
    v_pk_mov_b32 v[54:55], v[12:13], v[12:13]
    v_pk_mov_b32 v[56:57], v[12:13], v[12:13]
    v_pk_mov_b32 v[58:59], v[12:13], v[12:13]
    v_pk_mov_b32 v[60:61], v[12:13], v[12:13]
    v_pk_mov_b32 v[62:63], v[12:13], v[12:13]
    s_waitcnt lgkmcnt(0)
    s_add_u32 s4, s16, 8912896
    s_addc_u32 s5, s17, 0
    s_load_dwordx2 s[64:65], s[4:5], 0
    s_barrier
    s_cmp_ge_u32 s25, 5
    s_cbranch_scc1 HELP
    s_add_u32 s62, s25, 1
LUTP_W0L:
    s_mul_i32 s3, s62, 33554944
    s_add_u32 s3, s3, 4286709632
    v_add_u32 v128, s3, v138
    s_lshl_b32 s3, s62, 10
    v_add_u32 v136, s3, v1
    v_add_u32 v129, 131074, v128
    v_add_u32 v130, 262148, v128
    v_add_u32 v131, 393222, v128
    v_add_u32 v137, 0x10000, v136
    v_or_b32 v132, 0x80008000, v128
    v_or_b32 v133, 0x80008000, v129
    v_or_b32 v134, 0x80008000, v130
    v_or_b32 v135, 0x80008000, v131
    ds_write_b128 v136, v[128:131] offset:32768
    ds_write_b128 v137, v[132:135] offset:32768
    s_add_u32 s62, s62, 5
    s_cmp_le_u32 s62, 5
    s_cbranch_scc1 LUTP_W0L
LUTP_END_W0:
    s_cmp_ge_u32 s2, 250
    s_cbranch_scc1 AUX
    global_load_dwordx4 v[72:75], v9, s[46:47]
    global_load_dwordx4 v[76:79], v9, s[46:47] offset:16
    global_load_dwordx4 v[80:83], v9, s[48:49]
    global_load_dwordx4 v[84:87], v9, s[48:49] offset:16
    s_waitcnt vmcnt(11)
    v_and_b32 v88, 0xff, v64
    v_lshlrev_b32 v88, 2, v88
    ds_add_rtn_u32 v92, v88, v15 offset:2816
    v_and_b32 v89, 0xff, v65
    v_lshlrev_b32 v89, 2, v89
    ds_add_rtn_u32 v93, v89, v15 offset:2816
    v_and_b32 v90, 0xff, v66
    v_lshlrev_b32 v90, 2, v90
    ds_add_rtn_u32 v94, v90, v15 offset:2816
    v_and_b32 v91, 0xff, v67
    v_lshlrev_b32 v91, 2, v91
    ds_add_rtn_u32 v95, v91, v15 offset:2816
    s_waitcnt vmcnt(10)
    v_lshrrev_b32 v64, 8, v64
    v_lshl_or_b32 v108, v68, 10, v64
    v_lshrrev_b32 v65, 8, v65
    v_lshl_or_b32 v110, v69, 10, v65
    v_lshrrev_b32 v66, 8, v66
    v_lshl_or_b32 v112, v70, 10, v66
    v_lshrrev_b32 v67, 8, v67
    v_lshl_or_b32 v114, v71, 10, v67
    s_mov_b32 s9, 87040
    s_waitcnt lgkmcnt(0)
    s_barrier
    ds_read_b128 v[96:99], v1 offset:2816
    s_add_u32 s64, s64, 1
    s_and_b32 s65, s65, 0x3ff
    v_mov_b32 v109, s64
    v_mov_b32 v111, s64
    v_mov_b32 v113, s64
    v_mov_b32 v115, s64
    v_mov_b32 v119, 0
    v_cmp_gt_u32 vcc, 10, v92
    v_mul_u32_u24 v116, 6, v92
    v_lshlrev_b32 v117, 1, v88
    v_cndmask_b32 v118, 0, v64, vcc
    v_lshlrev_b64 v[120:121], v116, v[118:119]
    ds_or_b64 v117, v[120:121] offset:3840
    v_cmp_gt_u32 vcc, 10, v93
    v_mul_u32_u24 v116, 6, v93
    v_lshlrev_b32 v117, 1, v89
    v_cndmask_b32 v118, 0, v65, vcc
    v_lshlrev_b64 v[122:123], v116, v[118:119]
    ds_or_b64 v117, v[122:123] offset:3840
    v_cmp_gt_u32 vcc, 10, v94
    v_mul_u32_u24 v116, 6, v94
    v_lshlrev_b32 v117, 1, v90
    v_cndmask_b32 v118, 0, v66, vcc
    v_lshlrev_b64 v[120:121], v116, v[118:119]
    ds_or_b64 v117, v[120:121] offset:3840
    v_cmp_gt_u32 vcc, 10, v95
    v_mul_u32_u24 v116, 6, v95
    v_lshlrev_b32 v117, 1, v91
    v_cndmask_b32 v118, 0, v67, vcc
    v_lshlrev_b64 v[122:123], v116, v[118:119]
    ds_or_b64 v117, v[122:123] offset:3840
    s_waitcnt lgkmcnt(4)
    v_add_u32 v10, v96, v97
    v_add3_u32 v10, v10, v98, v99
    v_mov_b32 v11, v10
    s_nop 1
    v_add_u32_dpp v11, v11, v11 row_shr:1 row_mask:0xf bank_mask:0xf bound_ctrl:0
    s_nop 1
    v_add_u32_dpp v11, v11, v11 row_shr:2 row_mask:0xf bank_mask:0xf bound_ctrl:0
    s_nop 1
    v_add_u32_dpp v11, v11, v11 row_shr:4 row_mask:0xf bank_mask:0xf bound_ctrl:0
    s_nop 1
    v_add_u32_dpp v11, v11, v11 row_shr:8 row_mask:0xf bank_mask:0xf bound_ctrl:0
    s_nop 1
    v_add_u32_dpp v11, v11, v11 row_bcast:15 row_mask:0xa bank_mask:0xf
    s_nop 1
    v_add_u32_dpp v11, v11, v11 row_bcast:31 row_mask:0xc bank_mask:0xf
    v_sub_u32 v100, v11, v10
    v_add_u32 v101, v100, v96
    v_add_u32 v102, v101, v97
    v_add_u32 v103, v102, v98
    ds_write_b128 v1, v[100:103] offset:5888
    ds_read_b32 v96, v88 offset:5888
    ds_read_b32 v97, v89 offset:5888
    ds_read_b32 v98, v90 offset:5888
    ds_read_b32 v99, v91 offset:5888
    s_waitcnt lgkmcnt(3)
    v_add_u32 v92, v92, v96
    v_lshl_add_u32 v88, v92, 3, s9
    ds_write_b64 v88, v[108:109]
    s_waitcnt lgkmcnt(3)
    v_add_u32 v93, v93, v97
    v_lshl_add_u32 v89, v93, 3, s9
    ds_write_b64 v89, v[110:111]
    s_waitcnt lgkmcnt(3)
    v_add_u32 v94, v94, v98
    v_lshl_add_u32 v90, v94, 3, s9
    ds_write_b64 v90, v[112:113]
    s_waitcnt lgkmcnt(3)
    v_add_u32 v95, v95, v99
    v_lshl_add_u32 v91, v95, 3, s9
    ds_write_b64 v91, v[114:115]
    v_lshlrev_b32 v92, 4, v92
    v_add_u32 v92, 8704, v92
    v_lshlrev_b32 v93, 4, v93
    v_add_u32 v93, 8704, v93
    v_lshlrev_b32 v94, 4, v94
    v_add_u32 v94, 8704, v94
    v_lshlrev_b32 v95, 4, v95
    v_add_u32 v95, 8704, v95
    s_waitcnt lgkmcnt(0)
    s_barrier
    s_waitcnt vmcnt(0)
    s_cmp_eq_u32 s25, 4
    s_cbranch_scc1 NO_X_TOUCH_9
    s_lshl_b32 s33, s2, 2
    s_add_u32 s33, s33, s25
    s_lshl_b32 s33, s33, 7
    s_add_u32 s33, s33, 0
    v_min_u32 v166, 240, v1
    v_lshl_add_u32 v166, v166, 13, s33
    buffer_load_dword v167, v166, s[12:15], 0 offen
NO_X_TOUCH_9:
    ds_write2_b64 v92, v[72:73], v[80:81] offset0:0 offset1:1
    ds_write2_b64 v93, v[74:75], v[82:83] offset0:0 offset1:1
    ds_write2_b64 v94, v[76:77], v[84:85] offset0:0 offset1:1
    ds_write2_b64 v95, v[78:79], v[86:87] offset0:0 offset1:1
BINNED:
    s_setprio 0
    s_waitcnt lgkmcnt(0)
    s_barrier
    v_mov_b32 v2, 0
    s_call_b64 s[6:7], CONST_SUB
    s_cmp_gt_u32 s62, 24
    s_cbranch_scc1 LUTP_END_W
LUTP_WL:
    s_mul_i32 s3, s62, 33554944
    s_add_u32 s3, s3, 4286709632
    v_add_u32 v128, s3, v138
    s_lshl_b32 s3, s62, 10
    v_add_u32 v136, s3, v1
    v_add_u32 v129, 131074, v128
    v_add_u32 v130, 262148, v128
    v_add_u32 v131, 393222, v128
    v_add_u32 v137, 0x10000, v136
    v_or_b32 v132, 0x80008000, v128
    v_or_b32 v133, 0x80008000, v129
    v_or_b32 v134, 0x80008000, v130
    v_or_b32 v135, 0x80008000, v131
    ds_write_b128 v136, v[128:131] offset:32768
    ds_write_b128 v137, v[132:135] offset:32768
    s_add_u32 s62, s62, 5
    s_cmp_le_u32 s62, 24
    s_cbranch_scc1 LUTP_WL
LUTP_END_W:
    s_cmp_eq_u32 s25, 4
    s_cbranch_scc1 WAVE4
    s_add_u32 s62, s25, 34
    v_mov_b32 v132, 0x80008000
    v_mov_b32 v133, 0x80008000
    v_mov_b32 v134, 0x80008000
    v_mov_b32 v135, 0x80008000
LUTP_UH:
    s_mul_i32 s3, s62, 33554944
    s_add_u32 s3, s3, 131072
    v_add_u32 v128, s3, v138
    s_lshl_b32 s3, s62, 10
    v_add_u32 v136, s3, v1
    v_add_u32 v129, 131074, v128
    v_add_u32 v130, 262148, v128
    v_add_u32 v131, 393222, v128
    v_add_u32 v137, 0x10000, v136
    ds_write_b128 v136, v[128:131] offset:32768
    ds_write_b128 v137, v[132:135] offset:32768
    s_add_u32 s62, s62, 4
    s_cmp_le_u32 s62, 62
    s_cbranch_scc1 LUTP_UH
LUTP_END_U:
    buffer_load_dwordx4 v[168:171], v6, s[16:19], 0 offen sc1
    s_lshl_b32 s33, s2, 2
    s_add_u32 s33, s33, s25
    s_lshl_b32 s33, s33, 7
    s_add_u32 s33, s33, 2097152
    v_min_u32 v166, 240, v1
    v_lshl_add_u32 v166, v166, 13, s33
    buffer_load_dword v167, v166, s[12:15], 0 offen
NO_X_TOUCH_6:
    s_waitcnt vmcnt(1)
    s_branch CHECK_TAB
POLL_TAB:
    s_waitcnt vmcnt(0)
CHECK_TAB:
    v_lshrrev_b32 v11, 22, v168
    v_cmp_ne_u32 vcc, s64, v169
    v_cmp_ne_u32 s[42:43], s65, v11
    s_or_b64 vcc, vcc, s[42:43]
    s_and_b64 exec, exec, vcc
    s_cbranch_execz POLLED_TAB
    s_sub_u32 s35, s35, 1
    s_cbranch_scc1 END
    buffer_load_dwordx4 v[168:171], v6, s[16:19], 0 offen sc1
    s_branch POLL_TAB
POLLED_TAB:
    s_mov_b64 exec, -1
    s_branch TAB_DONE
LUT_SUB:
    s_lshl_b32 s3, s62, 25
    s_add_u32 s3, s3, 0x8000
    v_lshl_add_u32 v128, v1, 15, s3
    v_add_u32 v129, 0x10000, v128
    v_add_u32 v130, 0x10000, v129
    v_add_u32 v131, 0x10000, v130
    v_add_u32 v132, 0x10000, v131
    v_add_u32 v133, 0x10000, v132
    v_add_u32 v134, 0x10000, v133
    v_add_u32 v135, 0x10000, v134
    v_pk_mul_f32 v[136:137], v[128:129], s[10:11]
    v_pk_mul_f32 v[138:139], v[130:131], s[10:11]
    v_pk_mul_f32 v[140:141], v[132:133], s[10:11]
    v_pk_mul_f32 v[142:143], v[134:135], s[10:11]
    v_exp_f32 v136, v136
    v_exp_f32 v137, v137
    v_exp_f32 v138, v138
    v_exp_f32 v139, v139
    v_exp_f32 v140, v140
    v_exp_f32 v141, v141
    v_exp_f32 v142, v142
    v_exp_f32 v143, v143
    s_lshl_b32 s3, s62, 10
    v_pk_add_f32 v[144:145], v[136:137], 1.0 op_sel_hi:[1,0]
    v_pk_add_f32 v[146:147], v[138:139], 1.0 op_sel_hi:[1,0]
    v_pk_add_f32 v[148:149], v[140:141], 1.0 op_sel_hi:[1,0]
    v_pk_add_f32 v[150:151], v[142:143], 1.0 op_sel_hi:[1,0]
    v_rcp_f32 v144, v144
    v_rcp_f32 v145, v145
    v_rcp_f32 v146, v146
    v_rcp_f32 v147, v147
    v_rcp_f32 v148, v148
    v_rcp_f32 v149, v149
    v_rcp_f32 v150, v150
    v_rcp_f32 v151, v151
    v_add_u32 v160, s3, v1
    v_pk_mul_f32 v[128:129], v[128:129], v[144:145]
    v_pk_mul_f32 v[130:131], v[130:131], v[146:147]
    v_pk_mul_f32 v[132:133], v[132:133], v[148:149]
    v_pk_mul_f32 v[134:135], v[134:135], v[150:151]
    v_add_u32 v161, 0x10000, v160
    v_pk_mul_f32 v[136:137], v[128:129], v[136:137] neg_lo:[1,0] neg_hi:[1,0]
    v_pk_mul_f32 v[138:139], v[130:131], v[138:139] neg_lo:[1,0] neg_hi:[1,0]
    v_pk_mul_f32 v[140:141], v[132:133], v[140:141] neg_lo:[1,0] neg_hi:[1,0]
    v_pk_mul_f32 v[142:143], v[134:135], v[142:143] neg_lo:[1,0] neg_hi:[1,0]
    v_cvt_pk_bf16_f32 v152, v128, v129
    v_cvt_pk_bf16_f32 v153, v130, v131
    v_cvt_pk_bf16_f32 v154, v132, v133
    v_cvt_pk_bf16_f32 v155, v134, v135
    v_cvt_pk_bf16_f32 v156, v136, v137
    v_cvt_pk_bf16_f32 v157, v138, v139
    v_cvt_pk_bf16_f32 v158, v140, v141
    v_cvt_pk_bf16_f32 v159, v142, v143
    ds_write_b128 v160, v[152:155] offset:32768
    ds_write_b128 v161, v[156:159] offset:32768
    s_add_u32 s62, s62, 1
    s_sub_u32 s63, s63, 1
    s_cmp_lg_u32 s63, 0
    s_cbranch_scc1 LUT_SUB
    s_setpc_b64 s[6:7]
CONST_SUB:
    ds_write_b32 v193, v192 offset:32256
    v_lshrrev_b32 v193, 3, v1
    v_and_b32 v193, 24, v193
    s_mov_b32 s4, 0x05040100
    s_mov_b32 s5, 0x07060302
    ds_read_b64_tr_b16 v[180:181], v193 offset:32256
    ds_read_b64_tr_b16 v[182:183], v193 offset:32288
    ds_read_b64_tr_b16 v[184:185], v193 offset:32320
    ds_read_b64_tr_b16 v[186:187], v193 offset:32352
    v_perm_b32 v176, v189, v188, s4
    v_perm_b32 v178, v189, v188, s5
    v_perm_b32 v177, v191, v190, s4
    v_perm_b32 v179, v191, v190, s5
    s_setpc_b64 s[6:7]
HELP:
    s_sub_u32 s8, s25, 5
    s_mul_i32 s4, s8, 3072
    s_cmp_eq_u32 s8, 1
    s_cselect_b32 s4, 4096, s4
    s_mul_i32 s3, s2, 10240
    s_add_u32 s3, s3, s4
    v_add_u32 v8, s3, v1
    s_add_u32 s4, s4, 87040
    v_add_u32 v9, s4, v1
    s_mul_i32 s4, s8, 7168
    s_mul_i32 s3, s2, 20480
    s_add_u32 s3, s3, s4
    s_add_u32 s3, s3, 2621440
    v_add_u32 v12, s3, v1
    v_add_u32 v13, s4, v1
    s_lshl_b32 s3, s2, 12
    s_add_u32 s3, s3, 7864320
    v_add_u32 v117, s3, v1
    s_waitcnt lgkmcnt(0)
    s_add_u32 s64, s64, 1
    s_and_b32 s65, s65, 0x3ff
    s_barrier
    s_cmp_eq_u32 s25, 6
    s_cbranch_scc1 ROW
    s_cmp_eq_u32 s25, 7
    s_cselect_b32 s62, 63, 0
    s_mov_b32 s63, 1
    s_call_b64 s[6:7], LUT_SUB
    s_waitcnt vmcnt(0)
    s_call_b64 s[6:7], CONST_SUB
    v_mov_b32 v10, 65280
    v_mov_b32 v11, 0x7f80
    s_cmp_lg_u32 s25, 7
    s_cbranch_scc1 NO_ROW
    ds_write_b16 v10, v11 offset:32768
    s_branch NO_ROW
ROW:
    v_lshrrev_b32 v116, 2, v1
    ds_read_b32 v100, v116 offset:2816
    ds_read_b32 v101, v116 offset:3072
    ds_read_b32 v102, v116 offset:3328
    ds_read_b32 v103, v116 offset:3584
    s_lshl_b32 s3, s2, 12
    s_add_u32 s3, s3, 7864320
    v_add_u32 v117, s3, v1
    v_lshrrev_b32 v116, 1, v1
    s_lshl_b32 s3, s65, 22
    s_waitcnt lgkmcnt(0)
    v_mov_b32 v104, v100
    v_mov_b32 v105, v101
    v_mov_b32 v106, v102
    v_mov_b32 v107, v103
    s_nop 0
    v_add_u32_dpp v104, v104, v104 row_shr:1 row_mask:0xf bank_mask:0xf bound_ctrl:0
    v_add_u32_dpp v105, v105, v105 row_shr:1 row_mask:0xf bank_mask:0xf bound_ctrl:0
    v_add_u32_dpp v106, v106, v106 row_shr:1 row_mask:0xf bank_mask:0xf bound_ctrl:0
    v_add_u32_dpp v107, v107, v107 row_shr:1 row_mask:0xf bank_mask:0xf bound_ctrl:0
    s_nop 0
    v_add_u32_dpp v104, v104, v104 row_shr:2 row_mask:0xf bank_mask:0xf bound_ctrl:0
    v_add_u32_dpp v105, v105, v105 row_shr:2 row_mask:0xf bank_mask:0xf bound_ctrl:0
    v_add_u32_dpp v106, v106, v106 row_shr:2 row_mask:0xf bank_mask:0xf bound_ctrl:0
    v_add_u32_dpp v107, v107, v107 row_shr:2 row_mask:0xf bank_mask:0xf bound_ctrl:0
    s_nop 0
    v_add_u32_dpp v104, v104, v104 row_shr:4 row_mask:0xf bank_mask:0xf bound_ctrl:0
    v_add_u32_dpp v105, v105, v105 row_shr:4 row_mask:0xf bank_mask:0xf bound_ctrl:0
    v_add_u32_dpp v106, v106, v106 row_shr:4 row_mask:0xf bank_mask:0xf bound_ctrl:0
    v_add_u32_dpp v107, v107, v107 row_shr:4 row_mask:0xf bank_mask:0xf bound_ctrl:0
    s_nop 0
    v_add_u32_dpp v104, v104, v104 row_shr:8 row_mask:0xf bank_mask:0xf bound_ctrl:0
    v_add_u32_dpp v105, v105, v105 row_shr:8 row_mask:0xf bank_mask:0xf bound_ctrl:0
    v_add_u32_dpp v106, v106, v106 row_shr:8 row_mask:0xf bank_mask:0xf bound_ctrl:0
    v_add_u32_dpp v107, v107, v107 row_shr:8 row_mask:0xf bank_mask:0xf bound_ctrl:0
    s_nop 0
    v_add_u32_dpp v104, v104, v104 row_bcast:15 row_mask:0xa bank_mask:0xf
    v_add_u32_dpp v105, v105, v105 row_bcast:15 row_mask:0xa bank_mask:0xf
    v_add_u32_dpp v106, v106, v106 row_bcast:15 row_mask:0xa bank_mask:0xf
    v_add_u32_dpp v107, v107, v107 row_bcast:15 row_mask:0xa bank_mask:0xf
    s_nop 0
    v_add_u32_dpp v104, v104, v104 row_bcast:31 row_mask:0xc bank_mask:0xf
    v_add_u32_dpp v105, v105, v105 row_bcast:31 row_mask:0xc bank_mask:0xf
    v_add_u32_dpp v106, v106, v106 row_bcast:31 row_mask:0xc bank_mask:0xf
    v_add_u32_dpp v107, v107, v107 row_bcast:31 row_mask:0xc bank_mask:0xf
    v_readlane_b32 s4, v104, 63
    v_readlane_b32 s5, v105, 63
    v_readlane_b32 s9, v106, 63
    v_sub_u32 v104, v104, v100
    v_sub_u32 v105, v105, v101
    v_sub_u32 v106, v106, v102
    v_sub_u32 v107, v107, v103
    s_add_u32 s5, s5, s4
    s_add_u32 s9, s9, s5
    v_add_u32 v105, s4, v105
    v_add_u32 v106, s5, v106
    v_add_u32 v107, s9, v107
    v_lshl_or_b32 v84, v100, 11, v104
    v_or_b32 v84, s3, v84
    v_mov_b32 v85, s64
    v_lshl_or_b32 v88, v101, 11, v105
    v_or_b32 v88, s3, v88
    v_mov_b32 v89, s64
    v_lshl_or_b32 v92, v102, 11, v106
    v_or_b32 v92, s3, v92
    v_mov_b32 v93, s64
    v_lshl_or_b32 v96, v103, 11, v107
    v_or_b32 v96, s3, v96
    v_mov_b32 v97, s64
    s_waitcnt vmcnt(0)
    s_call_b64 s[6:7], CONST_SUB
NO_ROW:
    s_barrier
    s_cmp_lg_u32 s25, 6
    s_cbranch_scc1 ROW_DONE
    ds_read_b64 v[86:87], v116 offset:3840
    ds_read_b64 v[90:91], v116 offset:4352
    ds_read_b64 v[94:95], v116 offset:4864
    ds_read_b64 v[98:99], v116 offset:5376
    s_waitcnt lgkmcnt(3)
    global_store_dwordx4 v117, v[84:87], s[16:17] offset:0 sc0 sc1
    s_waitcnt lgkmcnt(2)
    global_store_dwordx4 v117, v[88:91], s[16:17] offset:1024 sc0 sc1
    s_waitcnt lgkmcnt(1)
    global_store_dwordx4 v117, v[92:95], s[16:17] offset:2048 sc0 sc1
    s_waitcnt lgkmcnt(0)
    global_store_dwordx4 v117, v[96:99], s[16:17] offset:3072 sc0 sc1
ROW_DONE:
    ds_read_b128 v[64:67], v9 offset:0
    ds_read_b128 v[68:71], v9 offset:1024
    ds_read_b128 v[72:75], v9 offset:2048
    ds_read_b128 v[76:79], v9 offset:3072
    v_mov_b32 v2, 0
    s_add_u32 s62, s8, s8
    s_add_u32 s62, s62, 27
    s_cmp_eq_u32 s8, 2
    s_addc_u32 s62, s62, 0
    s_cmp_eq_u32 s8, 1
    s_cselect_b32 s63, 3, 2
    s_waitcnt lgkmcnt(0)
    s_barrier
    s_cmp_ge_u32 s2, 250
    s_cbranch_scc1 RECS_STORED
    ds_read_b128 v[84:87], v13 offset:8704
    ds_read_b128 v[88:91], v13 offset:9728
    ds_read_b128 v[92:95], v13 offset:10752
    ds_read_b128 v[96:99], v13 offset:11776
    ds_read_b128 v[100:103], v13 offset:12800
    ds_read_b128 v[104:107], v13 offset:13824
    ds_read_b128 v[108:111], v13 offset:14848
    s_waitcnt lgkmcnt(6)
    global_store_dwordx4 v12, v[84:87], s[16:17] offset:0 sc0 sc1
    s_waitcnt lgkmcnt(5)
    global_store_dwordx4 v12, v[88:91], s[16:17] offset:1024 sc0 sc1
    s_waitcnt lgkmcnt(4)
    global_store_dwordx4 v12, v[92:95], s[16:17] offset:2048 sc0 sc1
    s_waitcnt lgkmcnt(3)
    global_store_dwordx4 v12, v[96:99], s[16:17] offset:3072 sc0 sc1
    v_add_u32 v12, 4096, v12
    s_waitcnt lgkmcnt(2)
    global_store_dwordx4 v12, v[100:103], s[16:17] offset:0 sc0 sc1
    s_waitcnt lgkmcnt(1)
    global_store_dwordx4 v12, v[104:107], s[16:17] offset:1024 sc0 sc1
    s_cmp_eq_u32 s8, 2
    s_cbranch_scc1 RECS_STORED
    s_waitcnt lgkmcnt(0)
    global_store_dwordx4 v12, v[108:111], s[16:17] offset:2048 sc0 sc1
RECS_STORED:
    s_call_b64 s[6:7], LUT_SUB
    s_cmp_ge_u32 s2, 250
    s_cbranch_scc1 TAB_DONE
    v_mov_b32 v10, 0
    s_waitcnt vmcnt(0)
    s_mov_b64 exec, 1
    ds_add_u32 v10, v15 offset:1296
    s_mov_b64 exec, -1
WAIT_ACK:
    ds_read_b32 v11, v10 offset:1296
    s_waitcnt lgkmcnt(0)
    v_readfirstlane_b32 s3, v11
    s_cmp_eq_u32 s3, 3
    s_cbranch_scc0 WAIT_ACK
    global_store_dwordx4 v8, v[64:67], s[16:17] offset:0 sc0 sc1
    global_store_dwordx4 v8, v[68:71], s[16:17] offset:1024 sc0 sc1
    s_cmp_eq_u32 s8, 1
    s_cbranch_scc1 TAB_DONE
    global_store_dwordx4 v8, v[72:75], s[16:17] offset:2048 sc0 sc1
    global_store_dwordx4 v8, v[76:79], s[16:17] offset:3072 sc0 sc1
    s_branch TAB_DONE
AUX_LOAD:
    s_sub_u32 s4, s2, 250
    s_cmp_ge_u32 s4, 4
    s_cbranch_scc1 NO_EDGES
    s_cmp_ge_u32 s25, 4
    s_cbranch_scc1 NO_EDGES
    s_lshl_b32 s5, s25, 13
    s_lshl_b32 s8, s4, 6
    s_add_u32 s5, s5, s8
    v_lshrrev_b32 v80, 8, v1
    v_lshlrev_b32 v80, 11, v80
    v_bfe_u32 v81, v1, 4, 4
    v_lshl_add_u32 v80, v81, 2, v80
    v_add_u32 v80, s5, v80
    global_load_dword v64, v80, s[54:55] offset:0
    global_load_dword v65, v80, s[54:55] offset:256
    global_load_dword v66, v80, s[54:55] offset:512
    global_load_dword v67, v80, s[54:55] offset:768
    global_load_dword v68, v80, s[54:55] offset:1024
    global_load_dword v69, v80, s[54:55] offset:1280
    global_load_dword v70, v80, s[54:55] offset:1536
    global_load_dword v71, v80, s[54:55] offset:1792
    s_branch NO_EDGES
AUX:
    s_cmp_ge_u32 s2, 254
    s_cbranch_scc1 AUX_DONE
    s_cmp_ge_u32 s25, 4
    s_cbranch_scc1 AUX_DONE
    s_sub_u32 s4, s2, 250
    s_lshl_b32 s5, s4, 13
    s_lshl_b32 s8, s25, 10
    s_add_u32 s5, s5, s8
    s_add_u32 s5, s5, 7802880
    v_add_u32 v81, s5, v1
    s_mov_b32 s4, 0x05040100
    s_mov_b32 s5, 0x07060302
    s_waitcnt vmcnt(6)
    v_perm_b32 v72, v65, v64, s4
    v_perm_b32 v76, v65, v64, s5
    v_perm_b32 v73, v67, v66, s4
    v_perm_b32 v77, v67, v66, s5
    v_perm_b32 v74, v69, v68, s4
    v_perm_b32 v78, v69, v68, s5
    v_perm_b32 v75, v71, v70, s4
    v_perm_b32 v79, v71, v70, s5
    global_store_dwordx4 v81, v[72:75], s[16:17] sc0 sc1
    v_add_u32 v81, 4096, v81
    global_store_dwordx4 v81, v[76:79], s[16:17] sc0 sc1
AUX_DONE:
    s_waitcnt lgkmcnt(0)
    s_add_u32 s64, s64, 1
    s_and_b32 s65, s65, 0x3ff
    s_barrier
    s_waitcnt vmcnt(0)
    s_barrier
    s_branch BINNED
WAVE4:
    s_mov_b32 s62, 25
    s_mov_b32 s63, 2
    s_call_b64 s[6:7], LUT_SUB
TAB_DONE:
    s_cmp_ge_u32 s25, 4
    s_cbranch_scc1 TOTALS
    v_and_b32 v13, 0x7ff, v168
    v_bfe_u32 v2, v168, 11, 11
    v_add_u32 v4, v4, v13
    v_mov_b32 v3, v2
    s_nop 1
    v_add_u32_dpp v3, v3, v3 row_shr:1 row_mask:0xf bank_mask:0xf bound_ctrl:0
    s_nop 1
    v_add_u32_dpp v3, v3, v3 row_shr:2 row_mask:0xf bank_mask:0xf bound_ctrl:0
    s_nop 1
    v_add_u32_dpp v3, v3, v3 row_shr:4 row_mask:0xf bank_mask:0xf bound_ctrl:0
    s_nop 1
    v_add_u32_dpp v3, v3, v3 row_shr:8 row_mask:0xf bank_mask:0xf bound_ctrl:0
    s_nop 1
    v_add_u32_dpp v3, v3, v3 row_bcast:15 row_mask:0xa bank_mask:0xf
    s_nop 1
    v_add_u32_dpp v3, v3, v3 row_bcast:31 row_mask:0xc bank_mask:0xf
    s_lshl_b32 s3, s25, 2
    v_mov_b32 v10, s3
    v_add_u32 v11, 1, v3
    v_sub_u32 v3, v3, v2
    s_mov_b32 exec_lo, 0
    s_mov_b32 exec_hi, 0x80000000
    ds_write_b32 v10, v11 offset:1280
    s_mov_b64 exec, -1
TOTALS:
    v_mov_b32 v10, 0
TOTALS_SPIN:
    ds_read_b128 v[64:67], v10 offset:1280
    s_waitcnt lgkmcnt(0)
    v_readfirstlane_b32 s4, v64
    v_readfirstlane_b32 s5, v65
    v_readfirstlane_b32 s6, v66
    v_readfirstlane_b32 s7, v67
    s_min_u32 s3, s4, s5
    s_min_u32 s8, s6, s7
    s_min_u32 s3, s3, s8
    s_cmp_eq_u32 s3, 0
    s_cbranch_scc0 TOTALS_OK
    s_sub_u32 s35, s35, 1
    s_cbranch_scc0 TOTALS_SPIN
    s_endpgm
TOTALS_OK:
    s_add_u32 s5, s5, s4
    s_add_u32 s6, s6, s5
    s_add_u32 s7, s7, s6
    s_sub_u32 s26, s7, 4
    s_cmp_eq_u32 s25, 1
    s_cselect_b32 s3, s4, 0
    s_cmp_eq_u32 s25, 2
    s_cselect_b32 s3, s5, s3
    s_cmp_eq_u32 s25, 3
    s_cselect_b32 s3, s6, s3
    s_sub_u32 s3, s3, s25
    v_add_u32 v3, s3, v3
    s_cmp_lg_u32 s25, 4
    s_cbranch_scc1 EPOCH_DONE
    s_cmp_lg_u32 s2, 0
    s_cbranch_scc1 EPOCH_DONE
    v_mov_b32 v12, s64
    v_mov_b32 v10, 8912896
    s_mov_b64 exec, 1
    global_store_dword v10, v12, s[16:17] sc0 sc1
    s_mov_b64 exec, -1
EPOCH_DONE:
    s_lshl_b32 s33, s2, 3
    s_add_u32 s33, s33, s25
    s_lshl_b32 s33, s33, 7
    s_add_u32 s33, s33, 4194304
    v_min_u32 v166, 112, v1
    v_lshl_add_u32 v166, v166, 14, s33
    buffer_load_dword v167, v166, s[12:15], 0 offen
NO_X_TOUCH_3:
ROUND:
    v_mov_b32 v8, 0
    v_subrev_u32 v9, s27, v3
    v_mov_b32 v10, v4
    s_mov_b32 s3, 1472
    s_cmp_gt_u32 s26, 1472
    s_cbranch_scc1 EXPAND
    v_lshlrev_b32 v11, 2, v3
    v_cmpx_lt_u32 vcc, 0, v2
    ds_write_b32 v11, v10 offset:2816
    v_add_u32 v10, 1, v10
    v_cmpx_lt_u32 vcc, 1, v2
    ds_write_b32 v11, v10 offset:2820
    v_add_u32 v10, 1, v10
    v_cmpx_lt_u32 vcc, 2, v2
    ds_write_b32 v11, v10 offset:2824
    v_add_u32 v10, 1, v10
    v_cmpx_lt_u32 vcc, 3, v2
    ds_write_b32 v11, v10 offset:2828
    v_add_u32 v10, 1, v10
    v_cmpx_lt_u32 vcc, 4, v2
    ds_write_b32 v11, v10 offset:2832
    v_add_u32 v10, 1, v10
    v_cmpx_lt_u32 vcc, 5, v2
    ds_write_b32 v11, v10 offset:2836
    v_add_u32 v10, 1, v10
    v_cmpx_lt_u32 vcc, 6, v2
    s_cbranch_execz EXPAND_DONE
    ds_write_b32 v11, v10 offset:2840
    v_add_u32 v10, 1, v10
    v_cmpx_lt_u32 vcc, 7, v2
    ds_write_b32 v11, v10 offset:2844
    v_add_u32 v10, 1, v10
    v_cmpx_lt_u32 vcc, 8, v2
    s_cbranch_execz EXPAND_DONE
    ds_write_b32 v11, v10 offset:2848
    v_add_u32 v10, 1, v10
    v_cmpx_lt_u32 vcc, 9, v2
    ds_write_b32 v11, v10 offset:2852
    v_add_u32 v10, 1, v10
    v_cmpx_lt_u32 vcc, 10, v2
    s_cbranch_execz EXPAND_DONE
    ds_write_b32 v11, v10 offset:2856
    v_add_u32 v10, 1, v10
    v_cmpx_lt_u32 vcc, 11, v2
    ds_write_b32 v11, v10 offset:2860
    v_add_u32 v10, 1, v10
    v_cmpx_lt_u32 vcc, 12, v2
    s_cbranch_execz EXPAND_DONE
    ds_write_b32 v11, v10 offset:2864
    v_add_u32 v10, 1, v10
    v_cmpx_lt_u32 vcc, 13, v2
    ds_write_b32 v11, v10 offset:2868
    v_add_u32 v10, 1, v10
    v_cmpx_lt_u32 vcc, 14, v2
    s_cbranch_execz EXPAND_DONE
    ds_write_b32 v11, v10 offset:2872
    v_add_u32 v10, 1, v10
    v_cmpx_lt_u32 vcc, 15, v2
    ds_write_b32 v11, v10 offset:2876
    v_add_u32 v10, 1, v10
    v_mov_b32 v8, 16
    v_add_u32 v9, 16, v9
EXPAND:
    v_cmp_lt_u32 vcc, v8, v2
    s_and_b64 exec, exec, vcc
    s_cbranch_execz EXPAND_DONE
    v_cmp_gt_u32 vcc, s3, v9
    v_lshlrev_b32 v11, 2, v9
    s_and_saveexec_b64 s[42:43], vcc
    ds_write_b32 v11, v10 offset:2816
    s_mov_b64 exec, s[42:43]
    v_add_u32 v8, 1, v8
    v_add_u32 v9, 1, v9
    v_add_u32 v10, 1, v10
    s_branch EXPAND
EXPAND_DONE:
    s_mov_b64 exec, -1
    s_sub_u32 s28, s26, s27
    s_min_u32 s28, s28, 1472
    v_lshlrev_b32 v8, 2, v0
    v_add_u32 v9, 0, v0
    v_cmp_gt_u32 s[36:37], s28, v9
    v_add_u32 v9, 512, v0
    v_cmp_gt_u32 s[38:39], s28, v9
    v_add_u32 v9, 1024, v0
    v_cmp_gt_u32 s[40:41], s28, v9
    s_waitcnt lgkmcnt(0)
    s_barrier
    ds_read_b32 v64, v8 offset:2816
    ds_read_b32 v65, v8 offset:4864
    ds_read_b32 v66, v8 offset:6912
    s_mov_b32 s44, 13421
    s_waitcnt lgkmcnt(0)
    v_lshlrev_b32 v68, 3, v64
    v_lshlrev_b32 v64, 4, v64
    v_lshlrev_b32 v69, 3, v65
    v_lshlrev_b32 v65, 4, v65
    v_lshlrev_b32 v70, 3, v66
    v_lshlrev_b32 v66, 4, v66
    s_mov_b64 exec, s[40:41]
    s_cbranch_execz SKIP3
    buffer_load_dwordx2 v[100:101], v70, s[16:19], 0 offen sc1
SKIP3:
    s_mov_b64 exec, s[36:37]
    buffer_load_dwordx2 v[96:97], v68, s[16:19], 0 offen sc1
    s_mov_b64 exec, s[38:39]
    buffer_load_dwordx2 v[98:99], v69, s[16:19], 0 offen sc1
    s_mov_b64 exec, -1
    v_lshrrev_b32 v8, 4, v1
    s_cmp_lg_u32 s27, 0
    s_cbranch_scc1 KEY_WAIT
    s_cmp_ge_u32 s25, 4
    s_cbranch_scc1 DEG_DONE
    v_bfe_u32 v9, v170, 0, 6
    v_lshlrev_b32 v9, 2, v9
    v_cmpx_lt_u32 vcc, 0, v2
    ds_add_u32 v9, v15 offset:1024
    v_bfe_u32 v10, v170, 6, 6
    v_lshlrev_b32 v10, 2, v10
    v_cmpx_lt_u32 vcc, 1, v2
    ds_add_u32 v10, v15 offset:1024
    v_bfe_u32 v9, v170, 12, 6
    v_lshlrev_b32 v9, 2, v9
    v_cmpx_lt_u32 vcc, 2, v2
    ds_add_u32 v9, v15 offset:1024
    v_bfe_u32 v10, v170, 18, 6
    v_lshlrev_b32 v10, 2, v10
    v_cmpx_lt_u32 vcc, 3, v2
    ds_add_u32 v10, v15 offset:1024
    v_bfe_u32 v9, v170, 24, 6
    v_lshlrev_b32 v9, 2, v9
    v_cmpx_lt_u32 vcc, 4, v2
    ds_add_u32 v9, v15 offset:1024
    v_alignbit_b32 v10, v171, v170, 30
    v_and_b32 v10, 63, v10
    v_lshlrev_b32 v10, 2, v10
    v_cmpx_lt_u32 vcc, 5, v2
    ds_add_u32 v10, v15 offset:1024
    v_bfe_u32 v9, v171, 4, 6
    v_lshlrev_b32 v9, 2, v9
    v_cmpx_lt_u32 vcc, 6, v2
    ds_add_u32 v9, v15 offset:1024
    v_bfe_u32 v10, v171, 10, 6
    v_lshlrev_b32 v10, 2, v10
    v_cmpx_lt_u32 vcc, 7, v2
    ds_add_u32 v10, v15 offset:1024
    v_bfe_u32 v9, v171, 16, 6
    v_lshlrev_b32 v9, 2, v9
    v_cmpx_lt_u32 vcc, 8, v2
    ds_add_u32 v9, v15 offset:1024
    v_bfe_u32 v10, v171, 22, 6
    v_lshlrev_b32 v10, 2, v10
    v_cmpx_lt_u32 vcc, 9, v2
    ds_add_u32 v10, v15 offset:1024
    s_mov_b64 exec, -1
DEG_DONE:
    v_lshlrev_b32 v9, 2, v8
    v_cmp_gt_u32 s[42:43], 40, v8
    v_sub_u32 v10, 63, v8
    s_mul_i32 s10, s25, 5
    s_waitcnt lgkmcnt(0)
    s_barrier
    ds_read_b32 v84, v9 offset:1024
    v_add_u32 v11, s10, v8
    v_lshlrev_b32 v12, 2, v11
    s_waitcnt lgkmcnt(0)
    v_lshl_or_b32 v84, v84, 6, v10
    v_cndmask_b32 v84, 0, v84, s[42:43]
    s_nop 0
    v_readlane_b32 s4, v84, s10
    s_add_u32 s10, s10, 1
    v_readlane_b32 s5, v84, s10
    s_add_u32 s10, s10, 1
    v_readlane_b32 s6, v84, s10
    s_add_u32 s10, s10, 1
    v_readlane_b32 s7, v84, s10
    s_add_u32 s10, s10, 1
    v_readlane_b32 s8, v84, s10
    v_cmp_lt_u32 s[48:49], s4, v84
    v_cmp_lt_u32 s[50:51], s5, v84
    v_cmp_lt_u32 s[52:53], s6, v84
    v_cmp_lt_u32 s[54:55], s7, v84
    v_cmp_lt_u32 s[56:57], s8, v84
    s_bcnt1_i32_b64 s4, s[48:49]
    s_bcnt1_i32_b64 s5, s[50:51]
    s_bcnt1_i32_b64 s6, s[52:53]
    s_bcnt1_i32_b64 s7, s[54:55]
    s_bcnt1_i32_b64 s8, s[56:57]
    v_readlane_b32 s4, v174, s4
    v_readlane_b32 s5, v174, s5
    v_readlane_b32 s6, v174, s6
    v_readlane_b32 s7, v174, s7
    v_readlane_b32 s8, v174, s8
    s_nop 0
    v_writelane_b32 v9, s4, 0
    v_writelane_b32 v9, s5, 1
    v_writelane_b32 v9, s6, 2
    v_writelane_b32 v9, s7, 3
    v_writelane_b32 v9, s8, 4
    v_lshrrev_b32 v10, 11, v9
    v_bfe_u32 v13, v9, 8, 3
    v_lshlrev_b32 v10, 7, v10
    v_and_b32 v9, 0xff, v9
    v_lshl_or_b32 v10, v13, 19, v10
    s_mov_b64 exec, 0x1f
    ds_write_b32 v9, v11 offset:1344
    ds_write_b32 v12, v10 offset:1536
    s_mov_b64 exec, -1
    s_waitcnt lgkmcnt(0)
    s_barrier
KEY_WAIT:
    s_lshl_b32 s3, s25, 10
    s_add_u32 s3, s3, 8704
    s_mov_b32 s9, 2621440
KEY_WAIT0:
    s_waitcnt vmcnt(0)
KEY_CHECK:
    v_cmp_ne_u32 s[48:49], s64, v97
    v_cmp_ne_u32 s[50:51], s64, v99
    v_cmp_ne_u32 s[52:53], s64, v101
    v_and_b32 v72, 63, v96
    v_lshlrev_b32 v72, 2, v72
    v_and_b32 v73, 63, v98
    v_lshlrev_b32 v73, 2, v73
    v_and_b32 v74, 63, v100
    v_lshlrev_b32 v74, 2, v74
    s_and_b64 s[48:49], s[48:49], s[36:37]
    s_and_b64 s[50:51], s[50:51], s[38:39]
    s_and_b64 s[52:53], s[52:53], s[40:41]
    s_or_b64 s[48:49], s[48:49], s[50:51]
    s_or_b64 s[48:49], s[48:49], s[52:53]
    s_cbranch_scc0 KEYS_OK
    s_sub_u32 s35, s35, 1
    s_cbranch_scc1 END
    s_mov_b64 exec, s[40:41]
    s_cbranch_execz SKIP3R
    buffer_load_dwordx2 v[100:101], v70, s[16:19], 0 offen sc1
SKIP3R:
    s_mov_b64 exec, s[36:37]
    buffer_load_dwordx2 v[96:97], v68, s[16:19], 0 offen sc1
    s_mov_b64 exec, s[38:39]
    buffer_load_dwordx2 v[98:99], v69, s[16:19], 0 offen sc1
    s_mov_b64 exec, -1
    s_branch KEY_WAIT0
KEYS_OK:
    ds_read_b32 v72, v72 offset:1536
    ds_read_b32 v73, v73 offset:1536
    ds_read_b32 v74, v74 offset:1536
    s_add_u32 m0, s3, 16384
    s_mov_b64 exec, s[40:41]
    s_cbranch_execz SKIP3D
    buffer_load_dwordx4 v66, s[16:19], s9 offen sc1 lds
SKIP3D:
    s_add_u32 m0, s3, 0
    s_mov_b64 exec, s[36:37]
    buffer_load_dwordx4 v64, s[16:19], s9 offen sc1 lds
    s_mov_b64 exec, -1
    v_mul_hi_u32 v76, s44, v96
    v_add_u32 v9, 0, v0
    v_lshlrev_b32 v9, 21, v9
    v_lshrrev_b32 v80, 10, v96
    v_lshl_or_b32 v80, v80, 7, v9
    v_mul_hi_u32 v77, s44, v98
    v_add_u32 v9, 512, v0
    v_lshlrev_b32 v9, 21, v9
    v_lshrrev_b32 v81, 10, v98
    v_lshl_or_b32 v81, v81, 7, v9
    v_mul_hi_u32 v78, s44, v100
    v_add_u32 v9, 1024, v0
    v_lshlrev_b32 v9, 21, v9
    v_lshrrev_b32 v82, 10, v100
    v_lshl_or_b32 v82, v82, 7, v9
    s_waitcnt lgkmcnt(2)
    v_lshrrev_b32 v9, 16, v72
    v_and_b32 v72, 0x380, v72
    v_or_b32 v80, v80, v9
    v_lshl_add_u32 v72, v76, 2, v72
    s_waitcnt lgkmcnt(1)
    v_lshrrev_b32 v9, 16, v73
    v_and_b32 v73, 0x380, v73
    v_or_b32 v81, v81, v9
    v_lshl_add_u32 v73, v77, 2, v73
    s_waitcnt lgkmcnt(0)
    v_lshrrev_b32 v9, 16, v74
    v_and_b32 v74, 0x380, v74
    v_or_b32 v82, v82, v9
    v_lshl_add_u32 v74, v78, 2, v74
    s_mov_b64 exec, s[36:37]
    ds_add_rtn_u32 v76, v72, v15 offset:0
    s_mov_b64 exec, s[38:39]
    ds_add_rtn_u32 v77, v73, v15 offset:0
    s_mov_b64 exec, s[40:41]
    ds_add_rtn_u32 v78, v74, v15 offset:0
    s_mov_b64 exec, -1
    s_add_u32 m0, s3, 8192
    s_mov_b64 exec, s[38:39]
    buffer_load_dwordx4 v65, s[16:19], s9 offen sc1 lds
    s_mov_b64 exec, -1
    s_lshl_b32 s10, s25, 3
    s_add_u32 s11, s10, 8
    s_and_b32 s11, s11, 63
    s_waitcnt lgkmcnt(0)
    s_barrier
    ds_read_b128 v[84:87], v1 offset:0
    s_cmp_lg_u32 s27, 0
    s_cbranch_scc1 NO_X_TOUCH_8
    s_lshl_b32 s33, s2, 3
    s_add_u32 s33, s33, s25
    s_lshl_b32 s33, s33, 7
    s_add_u32 s33, s33, 6291456
    v_min_u32 v166, 112, v1
    v_lshl_add_u32 v166, v166, 14, s33
    buffer_load_dword v167, v166, s[12:15], 0 offen
NO_X_TOUCH_8:
    s_waitcnt lgkmcnt(0)
    v_add_u32 v10, v84, v85
    v_add3_u32 v10, v10, v86, v87
    v_mov_b32 v11, v10
    s_nop 1
    v_add_u32_dpp v11, v11, v11 row_shr:1 row_mask:0xf bank_mask:0xf bound_ctrl:0
    s_nop 1
    v_add_u32_dpp v11, v11, v11 row_shr:2 row_mask:0xf bank_mask:0xf bound_ctrl:0
    s_nop 1
    v_add_u32_dpp v11, v11, v11 row_shr:4 row_mask:0xf bank_mask:0xf bound_ctrl:0
    s_nop 1
    v_add_u32_dpp v11, v11, v11 row_shr:8 row_mask:0xf bank_mask:0xf bound_ctrl:0
    s_nop 1
    v_add_u32_dpp v11, v11, v11 row_bcast:15 row_mask:0xa bank_mask:0xf
    s_nop 1
    v_add_u32_dpp v11, v11, v11 row_bcast:31 row_mask:0xc bank_mask:0xf
    v_sub_u32 v88, v11, v10
    v_add_u32 v89, v88, v84
    v_add_u32 v90, v89, v85
    v_add_u32 v91, v90, v86
    ds_write_b128 v1, v[88:91] offset:1792
    v_readlane_b32 s29, v88, s10
    v_readlane_b32 s30, v88, s11
    ds_read_b32 v72, v72 offset:1792
    ds_read_b32 v73, v73 offset:1792
    ds_read_b32 v74, v74 offset:1792
    s_cmp_eq_u32 s25, 7
    s_cselect_b32 s30, s28, s30
    v_add_u32 v6, s29, v8
    v_lshlrev_b32 v5, 2, v6
    v_add_u32 v5, 2816, v5
    s_sub_u32 s11, s30, s29
    s_max_u32 s10, s11, 6
    s_add_u32 s10, s10, -3
    s_and_b32 s31, s10, -4
    s_max_u32 s10, s11, s31
    s_sub_u32 s32, s10, s31
    s_waitcnt lgkmcnt(2)
    v_add_lshl_u32 v72, v72, v76, 2
    s_mov_b64 exec, s[36:37]
    ds_write_b32 v72, v80 offset:2816
    s_mov_b64 exec, -1
    s_waitcnt lgkmcnt(2)
    v_add_lshl_u32 v73, v73, v77, 2
    s_mov_b64 exec, s[38:39]
    ds_write_b32 v73, v81 offset:2816
    s_mov_b64 exec, -1
    s_waitcnt lgkmcnt(2)
    v_add_lshl_u32 v74, v74, v78, 2
    s_mov_b64 exec, s[40:41]
    ds_write_b32 v74, v82 offset:2816
    s_mov_b64 exec, -1
    s_waitcnt lgkmcnt(0)
    s_barrier
    ds_read_b32 v165, v5
    s_mov_b32 s3, 0
    s_and_b32 s10, s25, 3
    s_lshl_b32 s10, s10, 13
    s_add_u32 s10, s10, 7802880
    s_add_u32 s11, s10, 4096
    v_mov_b32 v128, 0
    v_mov_b32 v129, 0
    v_mov_b32 v130, 0
    v_mov_b32 v131, 0
    v_mov_b32 v132, 0
    v_mov_b32 v133, 0
    v_mov_b32 v134, 0
    v_mov_b32 v135, 0
    s_waitcnt lgkmcnt(0)
    v_cmp_gt_u32 vcc, s30, v6
    v_add_u32 v6, 64, v6
    v_add_u32 v5, 256, v5
    v_cndmask_b32 v165, 40, v165, vcc
    v_lshrrev_b32 v8, 21, v165
    v_lshlrev_b32 v8, 4, v8
    v_lshlrev_b32 v9, 3, v165
    v_and_b32 v9, 0xfffc00, v9
    v_and_or_b32 v165, v165, 56, v9
    s_nop 0
    v_readlane_b32 s48, v165, 0
    s_and_b32 s33, s48, s34
    buffer_load_dwordx4 v[64:67], v1, s[12:15], s33 offen
    v_readlane_b32 s49, v165, 1
    s_and_b32 s33, s49, s34
    buffer_load_dwordx4 v[68:71], v1, s[12:15], s33 offen
    s_cmp_lg_u32 s27, 0
    s_cbranch_scc1 REC_WAIT
    s_waitcnt vmcnt(3)
    s_branch REC_IN
REC_WAIT:
    s_waitcnt vmcnt(2)
REC_IN:
    s_barrier
    ds_read_b128 v[168:171], v8 offset:8704
    v_readlane_b32 s50, v165, 2
    s_and_b32 s33, s50, s34
    buffer_load_dwordx4 v[72:75], v1, s[12:15], s33 offen
    v_readlane_b32 s51, v165, 3
    s_and_b32 s33, s51, s34
    buffer_load_dwordx4 v[76:79], v1, s[12:15], s33 offen
    v_readlane_b32 s52, v165, 4
    s_and_b32 s33, s52, s34
    buffer_load_dwordx4 v[80:83], v1, s[12:15], s33 offen
    v_readlane_b32 s53, v165, 5
    s_and_b32 s33, s53, s34
    buffer_load_dwordx4 v[84:87], v1, s[12:15], s33 offen
    v_mov_b32 v164, v165
    s_waitcnt lgkmcnt(0)
    v_mov_b32 v172, v170
    v_mov_b32 v173, v171
    v_mfma_f32_4x4x4_16b_bf16 v[148:151], v[168:169], v[180:181], 0
    v_mfma_f32_4x4x4_16b_bf16 v[152:155], v[168:169], v[182:183], 0
    v_mfma_f32_4x4x4_16b_bf16 v[156:159], v[168:169], v[184:185], 0
    v_mfma_f32_4x4x4_16b_bf16 v[160:163], v[168:169], v[186:187], 0
    v_mfma_f32_4x4x4_16b_bf16 v[112:115], v[172:173], v[176:177], 0 cbsz:4 abid:0
    v_mfma_f32_4x4x4_16b_bf16 v[116:119], v[172:173], v[178:179], 0 cbsz:4 abid:0
    v_mfma_f32_4x4x4_16b_bf16 v[120:123], v[172:173], v[176:177], 0 cbsz:4 abid:1
    s_nop 1
    v_cvt_pk_bf16_f32 v140, v148, v152
    v_cvt_pk_bf16_f32 v141, v156, v160
    v_cvt_pk_bf16_f32 v142, v149, v153
    v_cvt_pk_bf16_f32 v143, v157, v161
    v_cvt_pk_bf16_f32 v144, v150, v154
    v_cvt_pk_bf16_f32 v145, v158, v162
    v_cvt_pk_bf16_f32 v146, v151, v155
    v_cvt_pk_bf16_f32 v147, v159, v163
    v_lshlrev_b32_sdwa v136, v15, v112 dst_sel:DWORD dst_unused:UNUSED_PAD src0_sel:DWORD src1_sel:WORD_1
    v_lshlrev_b32_sdwa v137, v15, v113 dst_sel:DWORD dst_unused:UNUSED_PAD src0_sel:DWORD src1_sel:WORD_1
    ds_read_u16_d16_hi v128, v136 offset:32768
    ds_read_u16_d16_hi v129, v137 offset:32768
    v_lshlrev_b32_sdwa v138, v15, v116 dst_sel:DWORD dst_unused:UNUSED_PAD src0_sel:DWORD src1_sel:WORD_1
    v_lshlrev_b32_sdwa v139, v15, v117 dst_sel:DWORD dst_unused:UNUSED_PAD src0_sel:DWORD src1_sel:WORD_1
    ds_read_u16_d16_hi v130, v138 offset:32768
    ds_read_u16_d16_hi v131, v139 offset:32768
    s_waitcnt vmcnt(5)
    v_mfma_f32_4x4x4_16b_bf16 v[96:99], v[140:141], v[64:65], 0 cbsz:4 abid:0
    v_mfma_f32_4x4x4_16b_bf16 v[100:103], v[140:141], v[66:67], 0 cbsz:4 abid:0
A_0:
    s_sub_u32 s31, s31, 4
    s_cbranch_scc1 B_0
    v_mfma_f32_4x4x4_16b_bf16 v[124:127], v[172:173], v[178:179], 0 cbsz:4 abid:1
    v_lshlrev_b32_sdwa v136, v15, v114 dst_sel:DWORD dst_unused:UNUSED_PAD src0_sel:DWORD src1_sel:WORD_1
    s_waitcnt vmcnt(4)
    v_mfma_f32_4x4x4_16b_bf16 v[104:107], v[142:143], v[68:69], 0 cbsz:4 abid:0
    v_readlane_b32 s54, v164, 6
    v_mfma_f32_4x4x4_16b_bf16 v[108:111], v[142:143], v[70:71], 0 cbsz:4 abid:0
    v_lshlrev_b32_sdwa v137, v15, v115 dst_sel:DWORD dst_unused:UNUSED_PAD src0_sel:DWORD src1_sel:WORD_1
    ds_read_u16_d16_hi v132, v136 offset:32768
    ds_read_u16_d16_hi v133, v137 offset:32768
    s_and_b32 s33, s54, s34
    buffer_load_dwordx4 v[88:91], v1, s[12:15], s33 offen
    s_waitcnt lgkmcnt(2)
    s_set_gpr_idx_on s48, 0xc
    v_pk_fma_f32 v[16:17], v[128:129], v[96:97], v[16:17] op_sel:[0,0,0] op_sel_hi:[0,1,1]
    v_pk_fma_f32 v[18:19], v[128:129], v[98:99], v[18:19] op_sel:[0,0,0] op_sel_hi:[0,1,1]
    v_pk_fma_f32 v[20:21], v[130:131], v[100:101], v[20:21] op_sel:[0,0,0] op_sel_hi:[0,1,1]
    v_pk_fma_f32 v[22:23], v[130:131], v[102:103], v[22:23] op_sel:[0,0,0] op_sel_hi:[0,1,1]
    s_set_gpr_idx_off
    v_lshlrev_b32_sdwa v138, v15, v118 dst_sel:DWORD dst_unused:UNUSED_PAD src0_sel:DWORD src1_sel:WORD_1
    s_waitcnt vmcnt(4)
    v_mfma_f32_4x4x4_16b_bf16 v[96:99], v[144:145], v[72:73], 0 cbsz:4 abid:0
    v_readlane_b32 s55, v164, 7
    v_mfma_f32_4x4x4_16b_bf16 v[100:103], v[144:145], v[74:75], 0 cbsz:4 abid:0
    v_lshlrev_b32_sdwa v139, v15, v119 dst_sel:DWORD dst_unused:UNUSED_PAD src0_sel:DWORD src1_sel:WORD_1
    ds_read_u16_d16_hi v134, v138 offset:32768
    ds_read_u16_d16_hi v135, v139 offset:32768
    s_and_b32 s33, s55, s34
    buffer_load_dwordx4 v[92:95], v1, s[12:15], s33 offen
    s_set_gpr_idx_on s49, 0xc
    v_pk_fma_f32 v[16:17], v[128:129], v[104:105], v[16:17] op_sel:[1,0,0] op_sel_hi:[1,1,1]
    v_pk_fma_f32 v[18:19], v[128:129], v[106:107], v[18:19] op_sel:[1,0,0] op_sel_hi:[1,1,1]
    v_pk_fma_f32 v[20:21], v[130:131], v[108:109], v[20:21] op_sel:[1,0,0] op_sel_hi:[1,1,1]
    v_pk_fma_f32 v[22:23], v[130:131], v[110:111], v[22:23] op_sel:[1,0,0] op_sel_hi:[1,1,1]
    s_set_gpr_idx_off
    v_mfma_f32_4x4x4_16b_bf16 v[112:115], v[172:173], v[176:177], 0 cbsz:4 abid:2
    v_lshlrev_b32_sdwa v136, v15, v120 dst_sel:DWORD dst_unused:UNUSED_PAD src0_sel:DWORD src1_sel:WORD_1
    s_waitcnt vmcnt(4)
    v_mfma_f32_4x4x4_16b_bf16 v[104:107], v[146:147], v[76:77], 0 cbsz:4 abid:0
    v_readlane_b32 s56, v164, 8
    v_mfma_f32_4x4x4_16b_bf16 v[108:111], v[146:147], v[78:79], 0 cbsz:4 abid:0
    v_lshlrev_b32_sdwa v137, v15, v121 dst_sel:DWORD dst_unused:UNUSED_PAD src0_sel:DWORD src1_sel:WORD_1
    ds_read_u16_d16_hi v128, v136 offset:32768
    ds_read_u16_d16_hi v129, v137 offset:32768
    s_and_b32 s33, s56, s34
    buffer_load_dwordx4 v[64:67], v1, s[12:15], s33 offen
    s_waitcnt lgkmcnt(2)
    s_set_gpr_idx_on s50, 0xc
    v_pk_fma_f32 v[16:17], v[132:133], v[96:97], v[16:17] op_sel:[0,0,0] op_sel_hi:[0,1,1]
    v_pk_fma_f32 v[18:19], v[132:133], v[98:99], v[18:19] op_sel:[0,0,0] op_sel_hi:[0,1,1]
    v_pk_fma_f32 v[20:21], v[134:135], v[100:101], v[20:21] op_sel:[0,0,0] op_sel_hi:[0,1,1]
    v_pk_fma_f32 v[22:23], v[134:135], v[102:103], v[22:23] op_sel:[0,0,0] op_sel_hi:[0,1,1]
    s_set_gpr_idx_off
    v_lshlrev_b32_sdwa v138, v15, v124 dst_sel:DWORD dst_unused:UNUSED_PAD src0_sel:DWORD src1_sel:WORD_1
    s_waitcnt vmcnt(4)
    v_mfma_f32_4x4x4_16b_bf16 v[96:99], v[140:141], v[80:81], 0 cbsz:4 abid:1
    v_readlane_b32 s57, v164, 9
    v_mfma_f32_4x4x4_16b_bf16 v[100:103], v[140:141], v[82:83], 0 cbsz:4 abid:1
    v_lshlrev_b32_sdwa v139, v15, v125 dst_sel:DWORD dst_unused:UNUSED_PAD src0_sel:DWORD src1_sel:WORD_1
    ds_read_u16_d16_hi v130, v138 offset:32768
    ds_read_u16_d16_hi v131, v139 offset:32768
    s_and_b32 s33, s57, s34
    buffer_load_dwordx4 v[68:71], v1, s[12:15], s33 offen
    s_set_gpr_idx_on s51, 0xc
    v_pk_fma_f32 v[16:17], v[132:133], v[104:105], v[16:17] op_sel:[1,0,0] op_sel_hi:[1,1,1]
    v_pk_fma_f32 v[18:19], v[132:133], v[106:107], v[18:19] op_sel:[1,0,0] op_sel_hi:[1,1,1]
    v_pk_fma_f32 v[20:21], v[134:135], v[108:109], v[20:21] op_sel:[1,0,0] op_sel_hi:[1,1,1]
    v_pk_fma_f32 v[22:23], v[134:135], v[110:111], v[22:23] op_sel:[1,0,0] op_sel_hi:[1,1,1]
    s_set_gpr_idx_off
A_4:
    s_sub_u32 s31, s31, 4
    s_cbranch_scc1 B_4
    v_mfma_f32_4x4x4_16b_bf16 v[116:119], v[172:173], v[178:179], 0 cbsz:4 abid:2
    v_lshlrev_b32_sdwa v136, v15, v122 dst_sel:DWORD dst_unused:UNUSED_PAD src0_sel:DWORD src1_sel:WORD_1
    s_waitcnt vmcnt(4)
    v_mfma_f32_4x4x4_16b_bf16 v[104:107], v[142:143], v[84:85], 0 cbsz:4 abid:1
    v_readlane_b32 s58, v164, 10
    v_mfma_f32_4x4x4_16b_bf16 v[108:111], v[142:143], v[86:87], 0 cbsz:4 abid:1
    v_lshlrev_b32_sdwa v137, v15, v123 dst_sel:DWORD dst_unused:UNUSED_PAD src0_sel:DWORD src1_sel:WORD_1
    ds_read_u16_d16_hi v132, v136 offset:32768
    ds_read_u16_d16_hi v133, v137 offset:32768
    s_and_b32 s33, s58, s34
    buffer_load_dwordx4 v[72:75], v1, s[12:15], s33 offen
    s_waitcnt lgkmcnt(2)
    s_set_gpr_idx_on s52, 0xc
    v_pk_fma_f32 v[16:17], v[128:129], v[96:97], v[16:17] op_sel:[0,0,0] op_sel_hi:[0,1,1]
    v_pk_fma_f32 v[18:19], v[128:129], v[98:99], v[18:19] op_sel:[0,0,0] op_sel_hi:[0,1,1]
    v_pk_fma_f32 v[20:21], v[130:131], v[100:101], v[20:21] op_sel:[0,0,0] op_sel_hi:[0,1,1]
    v_pk_fma_f32 v[22:23], v[130:131], v[102:103], v[22:23] op_sel:[0,0,0] op_sel_hi:[0,1,1]
    s_set_gpr_idx_off
    v_lshlrev_b32_sdwa v138, v15, v126 dst_sel:DWORD dst_unused:UNUSED_PAD src0_sel:DWORD src1_sel:WORD_1
    s_waitcnt vmcnt(4)
    v_mfma_f32_4x4x4_16b_bf16 v[96:99], v[144:145], v[88:89], 0 cbsz:4 abid:1
    v_readlane_b32 s59, v164, 11
    v_mfma_f32_4x4x4_16b_bf16 v[100:103], v[144:145], v[90:91], 0 cbsz:4 abid:1
    v_lshlrev_b32_sdwa v139, v15, v127 dst_sel:DWORD dst_unused:UNUSED_PAD src0_sel:DWORD src1_sel:WORD_1
    ds_read_u16_d16_hi v134, v138 offset:32768
    ds_read_u16_d16_hi v135, v139 offset:32768
    s_and_b32 s33, s59, s34
    buffer_load_dwordx4 v[76:79], v1, s[12:15], s33 offen
    s_set_gpr_idx_on s53, 0xc
    v_pk_fma_f32 v[16:17], v[128:129], v[104:105], v[16:17] op_sel:[1,0,0] op_sel_hi:[1,1,1]
    v_pk_fma_f32 v[18:19], v[128:129], v[106:107], v[18:19] op_sel:[1,0,0] op_sel_hi:[1,1,1]
    v_pk_fma_f32 v[20:21], v[130:131], v[108:109], v[20:21] op_sel:[1,0,0] op_sel_hi:[1,1,1]
    v_pk_fma_f32 v[22:23], v[130:131], v[110:111], v[22:23] op_sel:[1,0,0] op_sel_hi:[1,1,1]
    s_set_gpr_idx_off
    v_mfma_f32_4x4x4_16b_bf16 v[120:123], v[172:173], v[176:177], 0 cbsz:4 abid:3
    v_lshlrev_b32_sdwa v136, v15, v112 dst_sel:DWORD dst_unused:UNUSED_PAD src0_sel:DWORD src1_sel:WORD_1
    s_waitcnt vmcnt(4)
    v_mfma_f32_4x4x4_16b_bf16 v[104:107], v[146:147], v[92:93], 0 cbsz:4 abid:1
    v_readlane_b32 s60, v164, 12
    v_mfma_f32_4x4x4_16b_bf16 v[108:111], v[146:147], v[94:95], 0 cbsz:4 abid:1
    v_lshlrev_b32_sdwa v137, v15, v113 dst_sel:DWORD dst_unused:UNUSED_PAD src0_sel:DWORD src1_sel:WORD_1
    ds_read_u16_d16_hi v128, v136 offset:32768
    ds_read_u16_d16_hi v129, v137 offset:32768
    s_and_b32 s33, s60, s34
    buffer_load_dwordx4 v[80:83], v1, s[12:15], s33 offen
    s_waitcnt lgkmcnt(2)
    s_set_gpr_idx_on s54, 0xc
    v_pk_fma_f32 v[16:17], v[132:133], v[96:97], v[16:17] op_sel:[0,0,0] op_sel_hi:[0,1,1]
    v_pk_fma_f32 v[18:19], v[132:133], v[98:99], v[18:19] op_sel:[0,0,0] op_sel_hi:[0,1,1]
    v_pk_fma_f32 v[20:21], v[134:135], v[100:101], v[20:21] op_sel:[0,0,0] op_sel_hi:[0,1,1]
    v_pk_fma_f32 v[22:23], v[134:135], v[102:103], v[22:23] op_sel:[0,0,0] op_sel_hi:[0,1,1]
    s_set_gpr_idx_off
    v_lshlrev_b32_sdwa v138, v15, v116 dst_sel:DWORD dst_unused:UNUSED_PAD src0_sel:DWORD src1_sel:WORD_1
    s_waitcnt vmcnt(4)
    v_mfma_f32_4x4x4_16b_bf16 v[96:99], v[140:141], v[64:65], 0 cbsz:4 abid:2
    v_readlane_b32 s61, v164, 13
    v_mfma_f32_4x4x4_16b_bf16 v[100:103], v[140:141], v[66:67], 0 cbsz:4 abid:2
    v_lshlrev_b32_sdwa v139, v15, v117 dst_sel:DWORD dst_unused:UNUSED_PAD src0_sel:DWORD src1_sel:WORD_1
    ds_read_u16_d16_hi v130, v138 offset:32768
    ds_read_u16_d16_hi v131, v139 offset:32768
    s_and_b32 s33, s61, s34
    buffer_load_dwordx4 v[84:87], v1, s[12:15], s33 offen
    s_set_gpr_idx_on s55, 0xc
    v_pk_fma_f32 v[16:17], v[132:133], v[104:105], v[16:17] op_sel:[1,0,0] op_sel_hi:[1,1,1]
    v_pk_fma_f32 v[18:19], v[132:133], v[106:107], v[18:19] op_sel:[1,0,0] op_sel_hi:[1,1,1]
    v_pk_fma_f32 v[20:21], v[134:135], v[108:109], v[20:21] op_sel:[1,0,0] op_sel_hi:[1,1,1]
    v_pk_fma_f32 v[22:23], v[134:135], v[110:111], v[22:23] op_sel:[1,0,0] op_sel_hi:[1,1,1]
    s_set_gpr_idx_off
A_8:
    s_sub_u32 s31, s31, 4
    s_cbranch_scc1 B_8
    v_mfma_f32_4x4x4_16b_bf16 v[124:127], v[172:173], v[178:179], 0 cbsz:4 abid:3
    v_lshlrev_b32_sdwa v136, v15, v114 dst_sel:DWORD dst_unused:UNUSED_PAD src0_sel:DWORD src1_sel:WORD_1
    s_waitcnt vmcnt(4)
    v_mfma_f32_4x4x4_16b_bf16 v[104:107], v[142:143], v[68:69], 0 cbsz:4 abid:2
    v_readlane_b32 s62, v164, 14
    v_mfma_f32_4x4x4_16b_bf16 v[108:111], v[142:143], v[70:71], 0 cbsz:4 abid:2
    v_lshlrev_b32_sdwa v137, v15, v115 dst_sel:DWORD dst_unused:UNUSED_PAD src0_sel:DWORD src1_sel:WORD_1
    ds_read_u16_d16_hi v132, v136 offset:32768
    ds_read_u16_d16_hi v133, v137 offset:32768
    s_and_b32 s33, s62, s34
    buffer_load_dwordx4 v[88:91], v1, s[12:15], s33 offen
    s_waitcnt lgkmcnt(2)
    s_set_gpr_idx_on s56, 0xc
    v_pk_fma_f32 v[16:17], v[128:129], v[96:97], v[16:17] op_sel:[0,0,0] op_sel_hi:[0,1,1]
    v_pk_fma_f32 v[18:19], v[128:129], v[98:99], v[18:19] op_sel:[0,0,0] op_sel_hi:[0,1,1]
    v_pk_fma_f32 v[20:21], v[130:131], v[100:101], v[20:21] op_sel:[0,0,0] op_sel_hi:[0,1,1]
    v_pk_fma_f32 v[22:23], v[130:131], v[102:103], v[22:23] op_sel:[0,0,0] op_sel_hi:[0,1,1]
    s_set_gpr_idx_off
    ds_read_b32 v165, v5
    v_lshlrev_b32_sdwa v138, v15, v118 dst_sel:DWORD dst_unused:UNUSED_PAD src0_sel:DWORD src1_sel:WORD_1
    s_waitcnt vmcnt(4)
    v_mfma_f32_4x4x4_16b_bf16 v[96:99], v[144:145], v[72:73], 0 cbsz:4 abid:2
    v_readlane_b32 s63, v164, 15
    v_mfma_f32_4x4x4_16b_bf16 v[100:103], v[144:145], v[74:75], 0 cbsz:4 abid:2
    v_lshlrev_b32_sdwa v139, v15, v119 dst_sel:DWORD dst_unused:UNUSED_PAD src0_sel:DWORD src1_sel:WORD_1
    ds_read_u16_d16_hi v134, v138 offset:32768
    ds_read_u16_d16_hi v135, v139 offset:32768
    s_and_b32 s33, s63, s34
    buffer_load_dwordx4 v[92:95], v1, s[12:15], s33 offen
    s_set_gpr_idx_on s57, 0xc
    v_pk_fma_f32 v[16:17], v[128:129], v[104:105], v[16:17] op_sel:[1,0,0] op_sel_hi:[1,1,1]
    v_pk_fma_f32 v[18:19], v[128:129], v[106:107], v[18:19] op_sel:[1,0,0] op_sel_hi:[1,1,1]
    v_pk_fma_f32 v[20:21], v[130:131], v[108:109], v[20:21] op_sel:[1,0,0] op_sel_hi:[1,1,1]
    v_pk_fma_f32 v[22:23], v[130:131], v[110:111], v[22:23] op_sel:[1,0,0] op_sel_hi:[1,1,1]
    s_set_gpr_idx_off
    v_mfma_f32_4x4x4_16b_bf16 v[112:115], v[172:173], v[176:177], 0 cbsz:4 abid:4
    v_lshlrev_b32_sdwa v136, v15, v120 dst_sel:DWORD dst_unused:UNUSED_PAD src0_sel:DWORD src1_sel:WORD_1
    s_waitcnt vmcnt(4)
    v_mfma_f32_4x4x4_16b_bf16 v[104:107], v[146:147], v[76:77], 0 cbsz:4 abid:2
    v_readlane_b32 s48, v164, 16
    v_mfma_f32_4x4x4_16b_bf16 v[108:111], v[146:147], v[78:79], 0 cbsz:4 abid:2
    v_lshlrev_b32_sdwa v137, v15, v121 dst_sel:DWORD dst_unused:UNUSED_PAD src0_sel:DWORD src1_sel:WORD_1
    ds_read_u16_d16_hi v128, v136 offset:32768
    ds_read_u16_d16_hi v129, v137 offset:32768
    s_and_b32 s33, s48, s34
    buffer_load_dwordx4 v[64:67], v1, s[12:15], s33 offen
    s_waitcnt lgkmcnt(2)
    s_set_gpr_idx_on s58, 0xc
    v_pk_fma_f32 v[16:17], v[132:133], v[96:97], v[16:17] op_sel:[0,0,0] op_sel_hi:[0,1,1]
    v_pk_fma_f32 v[18:19], v[132:133], v[98:99], v[18:19] op_sel:[0,0,0] op_sel_hi:[0,1,1]
    v_pk_fma_f32 v[20:21], v[134:135], v[100:101], v[20:21] op_sel:[0,0,0] op_sel_hi:[0,1,1]
    v_pk_fma_f32 v[22:23], v[134:135], v[102:103], v[22:23] op_sel:[0,0,0] op_sel_hi:[0,1,1]
    s_set_gpr_idx_off
    v_lshlrev_b32_sdwa v138, v15, v124 dst_sel:DWORD dst_unused:UNUSED_PAD src0_sel:DWORD src1_sel:WORD_1
    s_waitcnt vmcnt(4)
    v_mfma_f32_4x4x4_16b_bf16 v[96:99], v[140:141], v[80:81], 0 cbsz:4 abid:3
    v_readlane_b32 s49, v164, 17
    v_mfma_f32_4x4x4_16b_bf16 v[100:103], v[140:141], v[82:83], 0 cbsz:4 abid:3
    v_lshlrev_b32_sdwa v139, v15, v125 dst_sel:DWORD dst_unused:UNUSED_PAD src0_sel:DWORD src1_sel:WORD_1
    ds_read_u16_d16_hi v130, v138 offset:32768
    ds_read_u16_d16_hi v131, v139 offset:32768
    s_and_b32 s33, s49, s34
    buffer_load_dwordx4 v[68:71], v1, s[12:15], s33 offen
    s_set_gpr_idx_on s59, 0xc
    v_pk_fma_f32 v[16:17], v[132:133], v[104:105], v[16:17] op_sel:[1,0,0] op_sel_hi:[1,1,1]
    v_pk_fma_f32 v[18:19], v[132:133], v[106:107], v[18:19] op_sel:[1,0,0] op_sel_hi:[1,1,1]
    v_pk_fma_f32 v[20:21], v[134:135], v[108:109], v[20:21] op_sel:[1,0,0] op_sel_hi:[1,1,1]
    v_pk_fma_f32 v[22:23], v[134:135], v[110:111], v[22:23] op_sel:[1,0,0] op_sel_hi:[1,1,1]
    s_set_gpr_idx_off
A_12:
    s_sub_u32 s31, s31, 4
    s_cbranch_scc1 B_12
    v_mfma_f32_4x4x4_16b_bf16 v[116:119], v[172:173], v[178:179], 0 cbsz:4 abid:4
    v_lshlrev_b32_sdwa v136, v15, v122 dst_sel:DWORD dst_unused:UNUSED_PAD src0_sel:DWORD src1_sel:WORD_1
    s_waitcnt vmcnt(4)
    v_mfma_f32_4x4x4_16b_bf16 v[104:107], v[142:143], v[84:85], 0 cbsz:4 abid:3
    v_readlane_b32 s50, v164, 18
    v_mfma_f32_4x4x4_16b_bf16 v[108:111], v[142:143], v[86:87], 0 cbsz:4 abid:3
    v_lshlrev_b32_sdwa v137, v15, v123 dst_sel:DWORD dst_unused:UNUSED_PAD src0_sel:DWORD src1_sel:WORD_1
    ds_read_u16_d16_hi v132, v136 offset:32768
    ds_read_u16_d16_hi v133, v137 offset:32768
    s_and_b32 s33, s50, s34
    buffer_load_dwordx4 v[72:75], v1, s[12:15], s33 offen
    s_waitcnt lgkmcnt(2)
    s_set_gpr_idx_on s60, 0xc
    v_pk_fma_f32 v[16:17], v[128:129], v[96:97], v[16:17] op_sel:[0,0,0] op_sel_hi:[0,1,1]
    v_pk_fma_f32 v[18:19], v[128:129], v[98:99], v[18:19] op_sel:[0,0,0] op_sel_hi:[0,1,1]
    v_pk_fma_f32 v[20:21], v[130:131], v[100:101], v[20:21] op_sel:[0,0,0] op_sel_hi:[0,1,1]
    v_pk_fma_f32 v[22:23], v[130:131], v[102:103], v[22:23] op_sel:[0,0,0] op_sel_hi:[0,1,1]
    s_set_gpr_idx_off
    v_cmp_gt_u32 vcc, s30, v6
    v_add_u32 v6, 64, v6
    v_add_u32 v5, 256, v5
    v_cndmask_b32 v165, 40, v165, vcc
    v_lshrrev_b32 v8, 21, v165
    v_lshlrev_b32 v8, 4, v8
    v_lshlrev_b32 v9, 3, v165
    ds_read_b128 v[168:171], v8 offset:8704
    v_and_b32 v9, 0xfffc00, v9
    v_and_or_b32 v165, v165, 56, v9
    v_lshlrev_b32_sdwa v138, v15, v126 dst_sel:DWORD dst_unused:UNUSED_PAD src0_sel:DWORD src1_sel:WORD_1
    s_waitcnt vmcnt(4)
    v_mfma_f32_4x4x4_16b_bf16 v[96:99], v[144:145], v[88:89], 0 cbsz:4 abid:3
    v_readlane_b32 s51, v164, 19
    v_mfma_f32_4x4x4_16b_bf16 v[100:103], v[144:145], v[90:91], 0 cbsz:4 abid:3
    v_lshlrev_b32_sdwa v139, v15, v127 dst_sel:DWORD dst_unused:UNUSED_PAD src0_sel:DWORD src1_sel:WORD_1
    ds_read_u16_d16_hi v134, v138 offset:32768
    ds_read_u16_d16_hi v135, v139 offset:32768
    s_and_b32 s33, s51, s34
    buffer_load_dwordx4 v[76:79], v1, s[12:15], s33 offen
    s_set_gpr_idx_on s61, 0xc
    v_pk_fma_f32 v[16:17], v[128:129], v[104:105], v[16:17] op_sel:[1,0,0] op_sel_hi:[1,1,1]
    v_pk_fma_f32 v[18:19], v[128:129], v[106:107], v[18:19] op_sel:[1,0,0] op_sel_hi:[1,1,1]
    v_pk_fma_f32 v[20:21], v[130:131], v[108:109], v[20:21] op_sel:[1,0,0] op_sel_hi:[1,1,1]
    v_pk_fma_f32 v[22:23], v[130:131], v[110:111], v[22:23] op_sel:[1,0,0] op_sel_hi:[1,1,1]
    s_set_gpr_idx_off
    v_mfma_f32_4x4x4_16b_bf16 v[120:123], v[172:173], v[176:177], 0 cbsz:4 abid:5
    v_lshlrev_b32_sdwa v136, v15, v112 dst_sel:DWORD dst_unused:UNUSED_PAD src0_sel:DWORD src1_sel:WORD_1
    s_waitcnt vmcnt(4)
    v_mfma_f32_4x4x4_16b_bf16 v[104:107], v[146:147], v[92:93], 0 cbsz:4 abid:3
    v_readlane_b32 s52, v164, 20
    v_mfma_f32_4x4x4_16b_bf16 v[108:111], v[146:147], v[94:95], 0 cbsz:4 abid:3
    v_lshlrev_b32_sdwa v137, v15, v113 dst_sel:DWORD dst_unused:UNUSED_PAD src0_sel:DWORD src1_sel:WORD_1
    ds_read_u16_d16_hi v128, v136 offset:32768
    ds_read_u16_d16_hi v129, v137 offset:32768
    s_and_b32 s33, s52, s34
    buffer_load_dwordx4 v[80:83], v1, s[12:15], s33 offen
    s_waitcnt lgkmcnt(2)
    s_set_gpr_idx_on s62, 0xc
    v_pk_fma_f32 v[16:17], v[132:133], v[96:97], v[16:17] op_sel:[0,0,0] op_sel_hi:[0,1,1]
    v_pk_fma_f32 v[18:19], v[132:133], v[98:99], v[18:19] op_sel:[0,0,0] op_sel_hi:[0,1,1]
    v_pk_fma_f32 v[20:21], v[134:135], v[100:101], v[20:21] op_sel:[0,0,0] op_sel_hi:[0,1,1]
    v_pk_fma_f32 v[22:23], v[134:135], v[102:103], v[22:23] op_sel:[0,0,0] op_sel_hi:[0,1,1]
    s_set_gpr_idx_off
    v_lshlrev_b32_sdwa v138, v15, v116 dst_sel:DWORD dst_unused:UNUSED_PAD src0_sel:DWORD src1_sel:WORD_1
    s_waitcnt vmcnt(4)
    v_mfma_f32_4x4x4_16b_bf16 v[96:99], v[140:141], v[64:65], 0 cbsz:4 abid:4
    v_readlane_b32 s53, v164, 21
    v_mfma_f32_4x4x4_16b_bf16 v[100:103], v[140:141], v[66:67], 0 cbsz:4 abid:4
    v_lshlrev_b32_sdwa v139, v15, v117 dst_sel:DWORD dst_unused:UNUSED_PAD src0_sel:DWORD src1_sel:WORD_1
    ds_read_u16_d16_hi v130, v138 offset:32768
    ds_read_u16_d16_hi v131, v139 offset:32768
    s_and_b32 s33, s53, s34
    buffer_load_dwordx4 v[84:87], v1, s[12:15], s33 offen
    s_set_gpr_idx_on s63, 0xc
    v_pk_fma_f32 v[16:17], v[132:133], v[104:105], v[16:17] op_sel:[1,0,0] op_sel_hi:[1,1,1]
    v_pk_fma_f32 v[18:19], v[132:133], v[106:107], v[18:19] op_sel:[1,0,0] op_sel_hi:[1,1,1]
    v_pk_fma_f32 v[20:21], v[134:135], v[108:109], v[20:21] op_sel:[1,0,0] op_sel_hi:[1,1,1]
    v_pk_fma_f32 v[22:23], v[134:135], v[110:111], v[22:23] op_sel:[1,0,0] op_sel_hi:[1,1,1]
    s_set_gpr_idx_off
A_16:
    s_sub_u32 s31, s31, 4
    s_cbranch_scc1 B_16
    v_mfma_f32_4x4x4_16b_bf16 v[124:127], v[172:173], v[178:179], 0 cbsz:4 abid:5
    v_lshlrev_b32_sdwa v136, v15, v114 dst_sel:DWORD dst_unused:UNUSED_PAD src0_sel:DWORD src1_sel:WORD_1
    s_waitcnt vmcnt(4)
    v_mfma_f32_4x4x4_16b_bf16 v[104:107], v[142:143], v[68:69], 0 cbsz:4 abid:4
    v_readlane_b32 s54, v164, 22
    v_mfma_f32_4x4x4_16b_bf16 v[108:111], v[142:143], v[70:71], 0 cbsz:4 abid:4
    v_lshlrev_b32_sdwa v137, v15, v115 dst_sel:DWORD dst_unused:UNUSED_PAD src0_sel:DWORD src1_sel:WORD_1
    ds_read_u16_d16_hi v132, v136 offset:32768
    ds_read_u16_d16_hi v133, v137 offset:32768
    s_and_b32 s33, s54, s34
    buffer_load_dwordx4 v[88:91], v1, s[12:15], s33 offen
    s_waitcnt lgkmcnt(2)
    s_set_gpr_idx_on s48, 0xc
    v_pk_fma_f32 v[16:17], v[128:129], v[96:97], v[16:17] op_sel:[0,0,0] op_sel_hi:[0,1,1]
    v_pk_fma_f32 v[18:19], v[128:129], v[98:99], v[18:19] op_sel:[0,0,0] op_sel_hi:[0,1,1]
    v_pk_fma_f32 v[20:21], v[130:131], v[100:101], v[20:21] op_sel:[0,0,0] op_sel_hi:[0,1,1]
    v_pk_fma_f32 v[22:23], v[130:131], v[102:103], v[22:23] op_sel:[0,0,0] op_sel_hi:[0,1,1]
    s_set_gpr_idx_off
    v_lshlrev_b32_sdwa v138, v15, v118 dst_sel:DWORD dst_unused:UNUSED_PAD src0_sel:DWORD src1_sel:WORD_1
    s_waitcnt vmcnt(4)
    v_mfma_f32_4x4x4_16b_bf16 v[96:99], v[144:145], v[72:73], 0 cbsz:4 abid:4
    v_readlane_b32 s55, v164, 23
    v_mfma_f32_4x4x4_16b_bf16 v[100:103], v[144:145], v[74:75], 0 cbsz:4 abid:4
    v_lshlrev_b32_sdwa v139, v15, v119 dst_sel:DWORD dst_unused:UNUSED_PAD src0_sel:DWORD src1_sel:WORD_1
    ds_read_u16_d16_hi v134, v138 offset:32768
    ds_read_u16_d16_hi v135, v139 offset:32768
    s_and_b32 s33, s55, s34
    buffer_load_dwordx4 v[92:95], v1, s[12:15], s33 offen
    s_set_gpr_idx_on s49, 0xc
    v_pk_fma_f32 v[16:17], v[128:129], v[104:105], v[16:17] op_sel:[1,0,0] op_sel_hi:[1,1,1]
    v_pk_fma_f32 v[18:19], v[128:129], v[106:107], v[18:19] op_sel:[1,0,0] op_sel_hi:[1,1,1]
    v_pk_fma_f32 v[20:21], v[130:131], v[108:109], v[20:21] op_sel:[1,0,0] op_sel_hi:[1,1,1]
    v_pk_fma_f32 v[22:23], v[130:131], v[110:111], v[22:23] op_sel:[1,0,0] op_sel_hi:[1,1,1]
    s_set_gpr_idx_off
    v_mfma_f32_4x4x4_16b_bf16 v[112:115], v[172:173], v[176:177], 0 cbsz:4 abid:6
    v_lshlrev_b32_sdwa v136, v15, v120 dst_sel:DWORD dst_unused:UNUSED_PAD src0_sel:DWORD src1_sel:WORD_1
    s_waitcnt vmcnt(4)
    v_mfma_f32_4x4x4_16b_bf16 v[104:107], v[146:147], v[76:77], 0 cbsz:4 abid:4
    v_readlane_b32 s56, v164, 24
    v_mfma_f32_4x4x4_16b_bf16 v[108:111], v[146:147], v[78:79], 0 cbsz:4 abid:4
    v_lshlrev_b32_sdwa v137, v15, v121 dst_sel:DWORD dst_unused:UNUSED_PAD src0_sel:DWORD src1_sel:WORD_1
    ds_read_u16_d16_hi v128, v136 offset:32768
    ds_read_u16_d16_hi v129, v137 offset:32768
    s_and_b32 s33, s56, s34
    buffer_load_dwordx4 v[64:67], v1, s[12:15], s33 offen
    s_waitcnt lgkmcnt(2)
    s_set_gpr_idx_on s50, 0xc
    v_pk_fma_f32 v[16:17], v[132:133], v[96:97], v[16:17] op_sel:[0,0,0] op_sel_hi:[0,1,1]
    v_pk_fma_f32 v[18:19], v[132:133], v[98:99], v[18:19] op_sel:[0,0,0] op_sel_hi:[0,1,1]
    v_pk_fma_f32 v[20:21], v[134:135], v[100:101], v[20:21] op_sel:[0,0,0] op_sel_hi:[0,1,1]
    v_pk_fma_f32 v[22:23], v[134:135], v[102:103], v[22:23] op_sel:[0,0,0] op_sel_hi:[0,1,1]
    s_set_gpr_idx_off
    v_lshlrev_b32_sdwa v138, v15, v124 dst_sel:DWORD dst_unused:UNUSED_PAD src0_sel:DWORD src1_sel:WORD_1
    s_waitcnt vmcnt(4)
    v_mfma_f32_4x4x4_16b_bf16 v[96:99], v[140:141], v[80:81], 0 cbsz:4 abid:5
    v_readlane_b32 s57, v164, 25
    v_mfma_f32_4x4x4_16b_bf16 v[100:103], v[140:141], v[82:83], 0 cbsz:4 abid:5
    v_lshlrev_b32_sdwa v139, v15, v125 dst_sel:DWORD dst_unused:UNUSED_PAD src0_sel:DWORD src1_sel:WORD_1
    ds_read_u16_d16_hi v130, v138 offset:32768
    ds_read_u16_d16_hi v131, v139 offset:32768
    s_and_b32 s33, s57, s34
    buffer_load_dwordx4 v[68:71], v1, s[12:15], s33 offen
    s_set_gpr_idx_on s51, 0xc
    v_pk_fma_f32 v[16:17], v[132:133], v[104:105], v[16:17] op_sel:[1,0,0] op_sel_hi:[1,1,1]
    v_pk_fma_f32 v[18:19], v[132:133], v[106:107], v[18:19] op_sel:[1,0,0] op_sel_hi:[1,1,1]
    v_pk_fma_f32 v[20:21], v[134:135], v[108:109], v[20:21] op_sel:[1,0,0] op_sel_hi:[1,1,1]
    v_pk_fma_f32 v[22:23], v[134:135], v[110:111], v[22:23] op_sel:[1,0,0] op_sel_hi:[1,1,1]
    s_set_gpr_idx_off
A_20:
    s_sub_u32 s31, s31, 4
    s_cbranch_scc1 B_20
    v_mfma_f32_4x4x4_16b_bf16 v[116:119], v[172:173], v[178:179], 0 cbsz:4 abid:6
    v_lshlrev_b32_sdwa v136, v15, v122 dst_sel:DWORD dst_unused:UNUSED_PAD src0_sel:DWORD src1_sel:WORD_1
    s_waitcnt vmcnt(4)
    v_mfma_f32_4x4x4_16b_bf16 v[104:107], v[142:143], v[84:85], 0 cbsz:4 abid:5
    v_readlane_b32 s58, v164, 26
    v_mfma_f32_4x4x4_16b_bf16 v[108:111], v[142:143], v[86:87], 0 cbsz:4 abid:5
    v_lshlrev_b32_sdwa v137, v15, v123 dst_sel:DWORD dst_unused:UNUSED_PAD src0_sel:DWORD src1_sel:WORD_1
    ds_read_u16_d16_hi v132, v136 offset:32768
    ds_read_u16_d16_hi v133, v137 offset:32768
    s_and_b32 s33, s58, s34
    buffer_load_dwordx4 v[72:75], v1, s[12:15], s33 offen
    s_waitcnt lgkmcnt(2)
    s_set_gpr_idx_on s52, 0xc
    v_pk_fma_f32 v[16:17], v[128:129], v[96:97], v[16:17] op_sel:[0,0,0] op_sel_hi:[0,1,1]
    v_pk_fma_f32 v[18:19], v[128:129], v[98:99], v[18:19] op_sel:[0,0,0] op_sel_hi:[0,1,1]
    v_pk_fma_f32 v[20:21], v[130:131], v[100:101], v[20:21] op_sel:[0,0,0] op_sel_hi:[0,1,1]
    v_pk_fma_f32 v[22:23], v[130:131], v[102:103], v[22:23] op_sel:[0,0,0] op_sel_hi:[0,1,1]
    s_set_gpr_idx_off
    v_lshlrev_b32_sdwa v138, v15, v126 dst_sel:DWORD dst_unused:UNUSED_PAD src0_sel:DWORD src1_sel:WORD_1
    s_waitcnt vmcnt(4)
    v_mfma_f32_4x4x4_16b_bf16 v[96:99], v[144:145], v[88:89], 0 cbsz:4 abid:5
    v_readlane_b32 s59, v164, 27
    v_mfma_f32_4x4x4_16b_bf16 v[100:103], v[144:145], v[90:91], 0 cbsz:4 abid:5
    v_lshlrev_b32_sdwa v139, v15, v127 dst_sel:DWORD dst_unused:UNUSED_PAD src0_sel:DWORD src1_sel:WORD_1
    ds_read_u16_d16_hi v134, v138 offset:32768
    ds_read_u16_d16_hi v135, v139 offset:32768
    s_and_b32 s33, s59, s34
    buffer_load_dwordx4 v[76:79], v1, s[12:15], s33 offen
    s_set_gpr_idx_on s53, 0xc
    v_pk_fma_f32 v[16:17], v[128:129], v[104:105], v[16:17] op_sel:[1,0,0] op_sel_hi:[1,1,1]
    v_pk_fma_f32 v[18:19], v[128:129], v[106:107], v[18:19] op_sel:[1,0,0] op_sel_hi:[1,1,1]
    v_pk_fma_f32 v[20:21], v[130:131], v[108:109], v[20:21] op_sel:[1,0,0] op_sel_hi:[1,1,1]
    v_pk_fma_f32 v[22:23], v[130:131], v[110:111], v[22:23] op_sel:[1,0,0] op_sel_hi:[1,1,1]
    s_set_gpr_idx_off
    v_mfma_f32_4x4x4_16b_bf16 v[120:123], v[172:173], v[176:177], 0 cbsz:4 abid:7
    v_lshlrev_b32_sdwa v136, v15, v112 dst_sel:DWORD dst_unused:UNUSED_PAD src0_sel:DWORD src1_sel:WORD_1
    s_waitcnt vmcnt(4)
    v_mfma_f32_4x4x4_16b_bf16 v[104:107], v[146:147], v[92:93], 0 cbsz:4 abid:5
    v_readlane_b32 s60, v164, 28
    v_mfma_f32_4x4x4_16b_bf16 v[108:111], v[146:147], v[94:95], 0 cbsz:4 abid:5
    v_lshlrev_b32_sdwa v137, v15, v113 dst_sel:DWORD dst_unused:UNUSED_PAD src0_sel:DWORD src1_sel:WORD_1
    ds_read_u16_d16_hi v128, v136 offset:32768
    ds_read_u16_d16_hi v129, v137 offset:32768
    s_and_b32 s33, s60, s34
    buffer_load_dwordx4 v[80:83], v1, s[12:15], s33 offen
    s_waitcnt lgkmcnt(2)
    s_set_gpr_idx_on s54, 0xc
    v_pk_fma_f32 v[16:17], v[132:133], v[96:97], v[16:17] op_sel:[0,0,0] op_sel_hi:[0,1,1]
    v_pk_fma_f32 v[18:19], v[132:133], v[98:99], v[18:19] op_sel:[0,0,0] op_sel_hi:[0,1,1]
    v_pk_fma_f32 v[20:21], v[134:135], v[100:101], v[20:21] op_sel:[0,0,0] op_sel_hi:[0,1,1]
    v_pk_fma_f32 v[22:23], v[134:135], v[102:103], v[22:23] op_sel:[0,0,0] op_sel_hi:[0,1,1]
    s_set_gpr_idx_off
    v_lshlrev_b32_sdwa v138, v15, v116 dst_sel:DWORD dst_unused:UNUSED_PAD src0_sel:DWORD src1_sel:WORD_1
    s_waitcnt vmcnt(4)
    v_mfma_f32_4x4x4_16b_bf16 v[96:99], v[140:141], v[64:65], 0 cbsz:4 abid:6
    v_readlane_b32 s61, v164, 29
    v_mfma_f32_4x4x4_16b_bf16 v[100:103], v[140:141], v[66:67], 0 cbsz:4 abid:6
    v_lshlrev_b32_sdwa v139, v15, v117 dst_sel:DWORD dst_unused:UNUSED_PAD src0_sel:DWORD src1_sel:WORD_1
    ds_read_u16_d16_hi v130, v138 offset:32768
    ds_read_u16_d16_hi v131, v139 offset:32768
    s_and_b32 s33, s61, s34
    buffer_load_dwordx4 v[84:87], v1, s[12:15], s33 offen
    s_set_gpr_idx_on s55, 0xc
    v_pk_fma_f32 v[16:17], v[132:133], v[104:105], v[16:17] op_sel:[1,0,0] op_sel_hi:[1,1,1]
    v_pk_fma_f32 v[18:19], v[132:133], v[106:107], v[18:19] op_sel:[1,0,0] op_sel_hi:[1,1,1]
    v_pk_fma_f32 v[20:21], v[134:135], v[108:109], v[20:21] op_sel:[1,0,0] op_sel_hi:[1,1,1]
    v_pk_fma_f32 v[22:23], v[134:135], v[110:111], v[22:23] op_sel:[1,0,0] op_sel_hi:[1,1,1]
    s_set_gpr_idx_off
A_24:
    s_sub_u32 s31, s31, 4
    s_cbranch_scc1 B_24
    v_mfma_f32_4x4x4_16b_bf16 v[124:127], v[172:173], v[178:179], 0 cbsz:4 abid:7
    v_lshlrev_b32_sdwa v136, v15, v114 dst_sel:DWORD dst_unused:UNUSED_PAD src0_sel:DWORD src1_sel:WORD_1
    s_waitcnt vmcnt(4)
    v_mfma_f32_4x4x4_16b_bf16 v[104:107], v[142:143], v[68:69], 0 cbsz:4 abid:6
    v_readlane_b32 s62, v164, 30
    v_mfma_f32_4x4x4_16b_bf16 v[108:111], v[142:143], v[70:71], 0 cbsz:4 abid:6
    v_lshlrev_b32_sdwa v137, v15, v115 dst_sel:DWORD dst_unused:UNUSED_PAD src0_sel:DWORD src1_sel:WORD_1
    ds_read_u16_d16_hi v132, v136 offset:32768
    ds_read_u16_d16_hi v133, v137 offset:32768
    s_and_b32 s33, s62, s34
    buffer_load_dwordx4 v[88:91], v1, s[12:15], s33 offen
    s_waitcnt lgkmcnt(2)
    s_set_gpr_idx_on s56, 0xc
    v_pk_fma_f32 v[16:17], v[128:129], v[96:97], v[16:17] op_sel:[0,0,0] op_sel_hi:[0,1,1]
    v_pk_fma_f32 v[18:19], v[128:129], v[98:99], v[18:19] op_sel:[0,0,0] op_sel_hi:[0,1,1]
    v_pk_fma_f32 v[20:21], v[130:131], v[100:101], v[20:21] op_sel:[0,0,0] op_sel_hi:[0,1,1]
    v_pk_fma_f32 v[22:23], v[130:131], v[102:103], v[22:23] op_sel:[0,0,0] op_sel_hi:[0,1,1]
    s_set_gpr_idx_off
    v_lshlrev_b32_sdwa v138, v15, v118 dst_sel:DWORD dst_unused:UNUSED_PAD src0_sel:DWORD src1_sel:WORD_1
    s_waitcnt vmcnt(4)
    v_mfma_f32_4x4x4_16b_bf16 v[96:99], v[144:145], v[72:73], 0 cbsz:4 abid:6
    v_readlane_b32 s63, v164, 31
    v_mfma_f32_4x4x4_16b_bf16 v[100:103], v[144:145], v[74:75], 0 cbsz:4 abid:6
    v_lshlrev_b32_sdwa v139, v15, v119 dst_sel:DWORD dst_unused:UNUSED_PAD src0_sel:DWORD src1_sel:WORD_1
    ds_read_u16_d16_hi v134, v138 offset:32768
    ds_read_u16_d16_hi v135, v139 offset:32768
    s_and_b32 s33, s63, s34
    buffer_load_dwordx4 v[92:95], v1, s[12:15], s33 offen
    s_set_gpr_idx_on s57, 0xc
    v_pk_fma_f32 v[16:17], v[128:129], v[104:105], v[16:17] op_sel:[1,0,0] op_sel_hi:[1,1,1]
    v_pk_fma_f32 v[18:19], v[128:129], v[106:107], v[18:19] op_sel:[1,0,0] op_sel_hi:[1,1,1]
    v_pk_fma_f32 v[20:21], v[130:131], v[108:109], v[20:21] op_sel:[1,0,0] op_sel_hi:[1,1,1]
    v_pk_fma_f32 v[22:23], v[130:131], v[110:111], v[22:23] op_sel:[1,0,0] op_sel_hi:[1,1,1]
    s_set_gpr_idx_off
    v_mfma_f32_4x4x4_16b_bf16 v[112:115], v[172:173], v[176:177], 0 cbsz:4 abid:8
    v_lshlrev_b32_sdwa v136, v15, v120 dst_sel:DWORD dst_unused:UNUSED_PAD src0_sel:DWORD src1_sel:WORD_1
    s_waitcnt vmcnt(4)
    v_mfma_f32_4x4x4_16b_bf16 v[104:107], v[146:147], v[76:77], 0 cbsz:4 abid:6
    v_readlane_b32 s48, v164, 32
    v_mfma_f32_4x4x4_16b_bf16 v[108:111], v[146:147], v[78:79], 0 cbsz:4 abid:6
    v_lshlrev_b32_sdwa v137, v15, v121 dst_sel:DWORD dst_unused:UNUSED_PAD src0_sel:DWORD src1_sel:WORD_1
    ds_read_u16_d16_hi v128, v136 offset:32768
    ds_read_u16_d16_hi v129, v137 offset:32768
    s_and_b32 s33, s48, s34
    buffer_load_dwordx4 v[64:67], v1, s[12:15], s33 offen
    s_waitcnt lgkmcnt(2)
    s_set_gpr_idx_on s58, 0xc
    v_pk_fma_f32 v[16:17], v[132:133], v[96:97], v[16:17] op_sel:[0,0,0] op_sel_hi:[0,1,1]
    v_pk_fma_f32 v[18:19], v[132:133], v[98:99], v[18:19] op_sel:[0,0,0] op_sel_hi:[0,1,1]
    v_pk_fma_f32 v[20:21], v[134:135], v[100:101], v[20:21] op_sel:[0,0,0] op_sel_hi:[0,1,1]
    v_pk_fma_f32 v[22:23], v[134:135], v[102:103], v[22:23] op_sel:[0,0,0] op_sel_hi:[0,1,1]
    s_set_gpr_idx_off
    v_lshlrev_b32_sdwa v138, v15, v124 dst_sel:DWORD dst_unused:UNUSED_PAD src0_sel:DWORD src1_sel:WORD_1
    s_waitcnt vmcnt(4)
    v_mfma_f32_4x4x4_16b_bf16 v[96:99], v[140:141], v[80:81], 0 cbsz:4 abid:7
    v_readlane_b32 s49, v164, 33
    v_mfma_f32_4x4x4_16b_bf16 v[100:103], v[140:141], v[82:83], 0 cbsz:4 abid:7
    v_lshlrev_b32_sdwa v139, v15, v125 dst_sel:DWORD dst_unused:UNUSED_PAD src0_sel:DWORD src1_sel:WORD_1
    ds_read_u16_d16_hi v130, v138 offset:32768
    ds_read_u16_d16_hi v131, v139 offset:32768
    s_and_b32 s33, s49, s34
    buffer_load_dwordx4 v[68:71], v1, s[12:15], s33 offen
    s_set_gpr_idx_on s59, 0xc
    v_pk_fma_f32 v[16:17], v[132:133], v[104:105], v[16:17] op_sel:[1,0,0] op_sel_hi:[1,1,1]
    v_pk_fma_f32 v[18:19], v[132:133], v[106:107], v[18:19] op_sel:[1,0,0] op_sel_hi:[1,1,1]
    v_pk_fma_f32 v[20:21], v[134:135], v[108:109], v[20:21] op_sel:[1,0,0] op_sel_hi:[1,1,1]
    v_pk_fma_f32 v[22:23], v[134:135], v[110:111], v[22:23] op_sel:[1,0,0] op_sel_hi:[1,1,1]
    s_set_gpr_idx_off
A_28:
    s_sub_u32 s31, s31, 4
    s_cbranch_scc1 B_28
    v_mfma_f32_4x4x4_16b_bf16 v[116:119], v[172:173], v[178:179], 0 cbsz:4 abid:8
    v_lshlrev_b32_sdwa v136, v15, v122 dst_sel:DWORD dst_unused:UNUSED_PAD src0_sel:DWORD src1_sel:WORD_1
    s_waitcnt vmcnt(4)
    v_mfma_f32_4x4x4_16b_bf16 v[104:107], v[142:143], v[84:85], 0 cbsz:4 abid:7
    v_readlane_b32 s50, v164, 34
    v_mfma_f32_4x4x4_16b_bf16 v[108:111], v[142:143], v[86:87], 0 cbsz:4 abid:7
    v_lshlrev_b32_sdwa v137, v15, v123 dst_sel:DWORD dst_unused:UNUSED_PAD src0_sel:DWORD src1_sel:WORD_1
    ds_read_u16_d16_hi v132, v136 offset:32768
    ds_read_u16_d16_hi v133, v137 offset:32768
    s_and_b32 s33, s50, s34
    buffer_load_dwordx4 v[72:75], v1, s[12:15], s33 offen
    s_waitcnt lgkmcnt(2)
    s_set_gpr_idx_on s60, 0xc
    v_pk_fma_f32 v[16:17], v[128:129], v[96:97], v[16:17] op_sel:[0,0,0] op_sel_hi:[0,1,1]
    v_pk_fma_f32 v[18:19], v[128:129], v[98:99], v[18:19] op_sel:[0,0,0] op_sel_hi:[0,1,1]
    v_pk_fma_f32 v[20:21], v[130:131], v[100:101], v[20:21] op_sel:[0,0,0] op_sel_hi:[0,1,1]
    v_pk_fma_f32 v[22:23], v[130:131], v[102:103], v[22:23] op_sel:[0,0,0] op_sel_hi:[0,1,1]
    s_set_gpr_idx_off
    v_lshlrev_b32_sdwa v138, v15, v126 dst_sel:DWORD dst_unused:UNUSED_PAD src0_sel:DWORD src1_sel:WORD_1
    s_waitcnt vmcnt(4)
    v_mfma_f32_4x4x4_16b_bf16 v[96:99], v[144:145], v[88:89], 0 cbsz:4 abid:7
    v_readlane_b32 s51, v164, 35
    v_mfma_f32_4x4x4_16b_bf16 v[100:103], v[144:145], v[90:91], 0 cbsz:4 abid:7
    v_lshlrev_b32_sdwa v139, v15, v127 dst_sel:DWORD dst_unused:UNUSED_PAD src0_sel:DWORD src1_sel:WORD_1
    ds_read_u16_d16_hi v134, v138 offset:32768
    ds_read_u16_d16_hi v135, v139 offset:32768
    s_and_b32 s33, s51, s34
    buffer_load_dwordx4 v[76:79], v1, s[12:15], s33 offen
    s_set_gpr_idx_on s61, 0xc
    v_pk_fma_f32 v[16:17], v[128:129], v[104:105], v[16:17] op_sel:[1,0,0] op_sel_hi:[1,1,1]
    v_pk_fma_f32 v[18:19], v[128:129], v[106:107], v[18:19] op_sel:[1,0,0] op_sel_hi:[1,1,1]
    v_pk_fma_f32 v[20:21], v[130:131], v[108:109], v[20:21] op_sel:[1,0,0] op_sel_hi:[1,1,1]
    v_pk_fma_f32 v[22:23], v[130:131], v[110:111], v[22:23] op_sel:[1,0,0] op_sel_hi:[1,1,1]
    s_set_gpr_idx_off
    v_mfma_f32_4x4x4_16b_bf16 v[120:123], v[172:173], v[176:177], 0 cbsz:4 abid:9
    v_lshlrev_b32_sdwa v136, v15, v112 dst_sel:DWORD dst_unused:UNUSED_PAD src0_sel:DWORD src1_sel:WORD_1
    s_waitcnt vmcnt(4)
    v_mfma_f32_4x4x4_16b_bf16 v[104:107], v[146:147], v[92:93], 0 cbsz:4 abid:7
    v_readlane_b32 s52, v164, 36
    v_mfma_f32_4x4x4_16b_bf16 v[108:111], v[146:147], v[94:95], 0 cbsz:4 abid:7
    v_lshlrev_b32_sdwa v137, v15, v113 dst_sel:DWORD dst_unused:UNUSED_PAD src0_sel:DWORD src1_sel:WORD_1
    ds_read_u16_d16_hi v128, v136 offset:32768
    ds_read_u16_d16_hi v129, v137 offset:32768
    s_and_b32 s33, s52, s34
    buffer_load_dwordx4 v[80:83], v1, s[12:15], s33 offen
    s_waitcnt lgkmcnt(2)
    s_set_gpr_idx_on s62, 0xc
    v_pk_fma_f32 v[16:17], v[132:133], v[96:97], v[16:17] op_sel:[0,0,0] op_sel_hi:[0,1,1]
    v_pk_fma_f32 v[18:19], v[132:133], v[98:99], v[18:19] op_sel:[0,0,0] op_sel_hi:[0,1,1]
    v_pk_fma_f32 v[20:21], v[134:135], v[100:101], v[20:21] op_sel:[0,0,0] op_sel_hi:[0,1,1]
    v_pk_fma_f32 v[22:23], v[134:135], v[102:103], v[22:23] op_sel:[0,0,0] op_sel_hi:[0,1,1]
    s_set_gpr_idx_off
    v_lshlrev_b32_sdwa v138, v15, v116 dst_sel:DWORD dst_unused:UNUSED_PAD src0_sel:DWORD src1_sel:WORD_1
    s_waitcnt vmcnt(4)
    v_mfma_f32_4x4x4_16b_bf16 v[96:99], v[140:141], v[64:65], 0 cbsz:4 abid:8
    v_readlane_b32 s53, v164, 37
    v_mfma_f32_4x4x4_16b_bf16 v[100:103], v[140:141], v[66:67], 0 cbsz:4 abid:8
    v_lshlrev_b32_sdwa v139, v15, v117 dst_sel:DWORD dst_unused:UNUSED_PAD src0_sel:DWORD src1_sel:WORD_1
    ds_read_u16_d16_hi v130, v138 offset:32768
    ds_read_u16_d16_hi v131, v139 offset:32768
    s_and_b32 s33, s53, s34
    buffer_load_dwordx4 v[84:87], v1, s[12:15], s33 offen
    s_set_gpr_idx_on s63, 0xc
    v_pk_fma_f32 v[16:17], v[132:133], v[104:105], v[16:17] op_sel:[1,0,0] op_sel_hi:[1,1,1]
    v_pk_fma_f32 v[18:19], v[132:133], v[106:107], v[18:19] op_sel:[1,0,0] op_sel_hi:[1,1,1]
    v_pk_fma_f32 v[20:21], v[134:135], v[108:109], v[20:21] op_sel:[1,0,0] op_sel_hi:[1,1,1]
    v_pk_fma_f32 v[22:23], v[134:135], v[110:111], v[22:23] op_sel:[1,0,0] op_sel_hi:[1,1,1]
    s_set_gpr_idx_off
A_32:
    s_sub_u32 s31, s31, 4
    s_cbranch_scc1 B_32
    v_mfma_f32_4x4x4_16b_bf16 v[124:127], v[172:173], v[178:179], 0 cbsz:4 abid:9
    v_lshlrev_b32_sdwa v136, v15, v114 dst_sel:DWORD dst_unused:UNUSED_PAD src0_sel:DWORD src1_sel:WORD_1
    s_waitcnt vmcnt(4)
    v_mfma_f32_4x4x4_16b_bf16 v[104:107], v[142:143], v[68:69], 0 cbsz:4 abid:8
    v_readlane_b32 s54, v164, 38
    v_mfma_f32_4x4x4_16b_bf16 v[108:111], v[142:143], v[70:71], 0 cbsz:4 abid:8
    v_lshlrev_b32_sdwa v137, v15, v115 dst_sel:DWORD dst_unused:UNUSED_PAD src0_sel:DWORD src1_sel:WORD_1
    ds_read_u16_d16_hi v132, v136 offset:32768
    ds_read_u16_d16_hi v133, v137 offset:32768
    s_and_b32 s33, s54, s34
    buffer_load_dwordx4 v[88:91], v1, s[12:15], s33 offen
    s_waitcnt lgkmcnt(2)
    s_set_gpr_idx_on s48, 0xc
    v_pk_fma_f32 v[16:17], v[128:129], v[96:97], v[16:17] op_sel:[0,0,0] op_sel_hi:[0,1,1]
    v_pk_fma_f32 v[18:19], v[128:129], v[98:99], v[18:19] op_sel:[0,0,0] op_sel_hi:[0,1,1]
    v_pk_fma_f32 v[20:21], v[130:131], v[100:101], v[20:21] op_sel:[0,0,0] op_sel_hi:[0,1,1]
    v_pk_fma_f32 v[22:23], v[130:131], v[102:103], v[22:23] op_sel:[0,0,0] op_sel_hi:[0,1,1]
    s_set_gpr_idx_off
    v_lshlrev_b32_sdwa v138, v15, v118 dst_sel:DWORD dst_unused:UNUSED_PAD src0_sel:DWORD src1_sel:WORD_1
    s_waitcnt vmcnt(4)
    v_mfma_f32_4x4x4_16b_bf16 v[96:99], v[144:145], v[72:73], 0 cbsz:4 abid:8
    v_readlane_b32 s55, v164, 39
    v_mfma_f32_4x4x4_16b_bf16 v[100:103], v[144:145], v[74:75], 0 cbsz:4 abid:8
    v_lshlrev_b32_sdwa v139, v15, v119 dst_sel:DWORD dst_unused:UNUSED_PAD src0_sel:DWORD src1_sel:WORD_1
    ds_read_u16_d16_hi v134, v138 offset:32768
    ds_read_u16_d16_hi v135, v139 offset:32768
    s_and_b32 s33, s55, s34
    buffer_load_dwordx4 v[92:95], v1, s[12:15], s33 offen
    s_set_gpr_idx_on s49, 0xc
    v_pk_fma_f32 v[16:17], v[128:129], v[104:105], v[16:17] op_sel:[1,0,0] op_sel_hi:[1,1,1]
    v_pk_fma_f32 v[18:19], v[128:129], v[106:107], v[18:19] op_sel:[1,0,0] op_sel_hi:[1,1,1]
    v_pk_fma_f32 v[20:21], v[130:131], v[108:109], v[20:21] op_sel:[1,0,0] op_sel_hi:[1,1,1]
    v_pk_fma_f32 v[22:23], v[130:131], v[110:111], v[22:23] op_sel:[1,0,0] op_sel_hi:[1,1,1]
    s_set_gpr_idx_off
    v_mfma_f32_4x4x4_16b_bf16 v[112:115], v[172:173], v[176:177], 0 cbsz:4 abid:10
    v_lshlrev_b32_sdwa v136, v15, v120 dst_sel:DWORD dst_unused:UNUSED_PAD src0_sel:DWORD src1_sel:WORD_1
    s_waitcnt vmcnt(4)
    v_mfma_f32_4x4x4_16b_bf16 v[104:107], v[146:147], v[76:77], 0 cbsz:4 abid:8
    v_readlane_b32 s56, v164, 40
    v_mfma_f32_4x4x4_16b_bf16 v[108:111], v[146:147], v[78:79], 0 cbsz:4 abid:8
    v_lshlrev_b32_sdwa v137, v15, v121 dst_sel:DWORD dst_unused:UNUSED_PAD src0_sel:DWORD src1_sel:WORD_1
    ds_read_u16_d16_hi v128, v136 offset:32768
    ds_read_u16_d16_hi v129, v137 offset:32768
    s_and_b32 s33, s56, s34
    buffer_load_dwordx4 v[64:67], v1, s[12:15], s33 offen
    s_waitcnt lgkmcnt(2)
    s_set_gpr_idx_on s50, 0xc
    v_pk_fma_f32 v[16:17], v[132:133], v[96:97], v[16:17] op_sel:[0,0,0] op_sel_hi:[0,1,1]
    v_pk_fma_f32 v[18:19], v[132:133], v[98:99], v[18:19] op_sel:[0,0,0] op_sel_hi:[0,1,1]
    v_pk_fma_f32 v[20:21], v[134:135], v[100:101], v[20:21] op_sel:[0,0,0] op_sel_hi:[0,1,1]
    v_pk_fma_f32 v[22:23], v[134:135], v[102:103], v[22:23] op_sel:[0,0,0] op_sel_hi:[0,1,1]
    s_set_gpr_idx_off
    v_lshlrev_b32_sdwa v138, v15, v124 dst_sel:DWORD dst_unused:UNUSED_PAD src0_sel:DWORD src1_sel:WORD_1
    s_waitcnt vmcnt(4)
    v_mfma_f32_4x4x4_16b_bf16 v[96:99], v[140:141], v[80:81], 0 cbsz:4 abid:9
    v_readlane_b32 s57, v164, 41
    v_mfma_f32_4x4x4_16b_bf16 v[100:103], v[140:141], v[82:83], 0 cbsz:4 abid:9
    v_lshlrev_b32_sdwa v139, v15, v125 dst_sel:DWORD dst_unused:UNUSED_PAD src0_sel:DWORD src1_sel:WORD_1
    ds_read_u16_d16_hi v130, v138 offset:32768
    ds_read_u16_d16_hi v131, v139 offset:32768
    s_and_b32 s33, s57, s34
    buffer_load_dwordx4 v[68:71], v1, s[12:15], s33 offen
    s_set_gpr_idx_on s51, 0xc
    v_pk_fma_f32 v[16:17], v[132:133], v[104:105], v[16:17] op_sel:[1,0,0] op_sel_hi:[1,1,1]
    v_pk_fma_f32 v[18:19], v[132:133], v[106:107], v[18:19] op_sel:[1,0,0] op_sel_hi:[1,1,1]
    v_pk_fma_f32 v[20:21], v[134:135], v[108:109], v[20:21] op_sel:[1,0,0] op_sel_hi:[1,1,1]
    v_pk_fma_f32 v[22:23], v[134:135], v[110:111], v[22:23] op_sel:[1,0,0] op_sel_hi:[1,1,1]
    s_set_gpr_idx_off
A_36:
    s_sub_u32 s31, s31, 4
    s_cbranch_scc1 B_36
    v_mfma_f32_4x4x4_16b_bf16 v[116:119], v[172:173], v[178:179], 0 cbsz:4 abid:10
    v_lshlrev_b32_sdwa v136, v15, v122 dst_sel:DWORD dst_unused:UNUSED_PAD src0_sel:DWORD src1_sel:WORD_1
    s_waitcnt vmcnt(4)
    v_mfma_f32_4x4x4_16b_bf16 v[104:107], v[142:143], v[84:85], 0 cbsz:4 abid:9
    v_readlane_b32 s58, v164, 42
    v_mfma_f32_4x4x4_16b_bf16 v[108:111], v[142:143], v[86:87], 0 cbsz:4 abid:9
    v_lshlrev_b32_sdwa v137, v15, v123 dst_sel:DWORD dst_unused:UNUSED_PAD src0_sel:DWORD src1_sel:WORD_1
    ds_read_u16_d16_hi v132, v136 offset:32768
    ds_read_u16_d16_hi v133, v137 offset:32768
    s_and_b32 s33, s58, s34
    buffer_load_dwordx4 v[72:75], v1, s[12:15], s33 offen
    s_waitcnt lgkmcnt(2)
    s_set_gpr_idx_on s52, 0xc
    v_pk_fma_f32 v[16:17], v[128:129], v[96:97], v[16:17] op_sel:[0,0,0] op_sel_hi:[0,1,1]
    v_pk_fma_f32 v[18:19], v[128:129], v[98:99], v[18:19] op_sel:[0,0,0] op_sel_hi:[0,1,1]
    v_pk_fma_f32 v[20:21], v[130:131], v[100:101], v[20:21] op_sel:[0,0,0] op_sel_hi:[0,1,1]
    v_pk_fma_f32 v[22:23], v[130:131], v[102:103], v[22:23] op_sel:[0,0,0] op_sel_hi:[0,1,1]
    s_set_gpr_idx_off
    v_lshlrev_b32_sdwa v138, v15, v126 dst_sel:DWORD dst_unused:UNUSED_PAD src0_sel:DWORD src1_sel:WORD_1
    s_waitcnt vmcnt(4)
    v_mfma_f32_4x4x4_16b_bf16 v[96:99], v[144:145], v[88:89], 0 cbsz:4 abid:9
    v_readlane_b32 s59, v164, 43
    v_mfma_f32_4x4x4_16b_bf16 v[100:103], v[144:145], v[90:91], 0 cbsz:4 abid:9
    v_lshlrev_b32_sdwa v139, v15, v127 dst_sel:DWORD dst_unused:UNUSED_PAD src0_sel:DWORD src1_sel:WORD_1
    ds_read_u16_d16_hi v134, v138 offset:32768
    ds_read_u16_d16_hi v135, v139 offset:32768
    s_and_b32 s33, s59, s34
    buffer_load_dwordx4 v[76:79], v1, s[12:15], s33 offen
    s_set_gpr_idx_on s53, 0xc
    v_pk_fma_f32 v[16:17], v[128:129], v[104:105], v[16:17] op_sel:[1,0,0] op_sel_hi:[1,1,1]
    v_pk_fma_f32 v[18:19], v[128:129], v[106:107], v[18:19] op_sel:[1,0,0] op_sel_hi:[1,1,1]
    v_pk_fma_f32 v[20:21], v[130:131], v[108:109], v[20:21] op_sel:[1,0,0] op_sel_hi:[1,1,1]
    v_pk_fma_f32 v[22:23], v[130:131], v[110:111], v[22:23] op_sel:[1,0,0] op_sel_hi:[1,1,1]
    s_set_gpr_idx_off
    v_mfma_f32_4x4x4_16b_bf16 v[120:123], v[172:173], v[176:177], 0 cbsz:4 abid:11
    v_lshlrev_b32_sdwa v136, v15, v112 dst_sel:DWORD dst_unused:UNUSED_PAD src0_sel:DWORD src1_sel:WORD_1
    s_waitcnt vmcnt(4)
    v_mfma_f32_4x4x4_16b_bf16 v[104:107], v[146:147], v[92:93], 0 cbsz:4 abid:9
    v_readlane_b32 s60, v164, 44
    v_mfma_f32_4x4x4_16b_bf16 v[108:111], v[146:147], v[94:95], 0 cbsz:4 abid:9
    v_lshlrev_b32_sdwa v137, v15, v113 dst_sel:DWORD dst_unused:UNUSED_PAD src0_sel:DWORD src1_sel:WORD_1
    ds_read_u16_d16_hi v128, v136 offset:32768
    ds_read_u16_d16_hi v129, v137 offset:32768
    s_and_b32 s33, s60, s34
    buffer_load_dwordx4 v[80:83], v1, s[12:15], s33 offen
    s_waitcnt lgkmcnt(2)
    s_set_gpr_idx_on s54, 0xc
    v_pk_fma_f32 v[16:17], v[132:133], v[96:97], v[16:17] op_sel:[0,0,0] op_sel_hi:[0,1,1]
    v_pk_fma_f32 v[18:19], v[132:133], v[98:99], v[18:19] op_sel:[0,0,0] op_sel_hi:[0,1,1]
    v_pk_fma_f32 v[20:21], v[134:135], v[100:101], v[20:21] op_sel:[0,0,0] op_sel_hi:[0,1,1]
    v_pk_fma_f32 v[22:23], v[134:135], v[102:103], v[22:23] op_sel:[0,0,0] op_sel_hi:[0,1,1]
    s_set_gpr_idx_off
    v_lshlrev_b32_sdwa v138, v15, v116 dst_sel:DWORD dst_unused:UNUSED_PAD src0_sel:DWORD src1_sel:WORD_1
    s_waitcnt vmcnt(4)
    v_mfma_f32_4x4x4_16b_bf16 v[96:99], v[140:141], v[64:65], 0 cbsz:4 abid:10
    v_readlane_b32 s61, v164, 45
    v_mfma_f32_4x4x4_16b_bf16 v[100:103], v[140:141], v[66:67], 0 cbsz:4 abid:10
    v_lshlrev_b32_sdwa v139, v15, v117 dst_sel:DWORD dst_unused:UNUSED_PAD src0_sel:DWORD src1_sel:WORD_1
    ds_read_u16_d16_hi v130, v138 offset:32768
    ds_read_u16_d16_hi v131, v139 offset:32768
    s_and_b32 s33, s61, s34
    buffer_load_dwordx4 v[84:87], v1, s[12:15], s33 offen
    s_set_gpr_idx_on s55, 0xc
    v_pk_fma_f32 v[16:17], v[132:133], v[104:105], v[16:17] op_sel:[1,0,0] op_sel_hi:[1,1,1]
    v_pk_fma_f32 v[18:19], v[132:133], v[106:107], v[18:19] op_sel:[1,0,0] op_sel_hi:[1,1,1]
    v_pk_fma_f32 v[20:21], v[134:135], v[108:109], v[20:21] op_sel:[1,0,0] op_sel_hi:[1,1,1]
    v_pk_fma_f32 v[22:23], v[134:135], v[110:111], v[22:23] op_sel:[1,0,0] op_sel_hi:[1,1,1]
    s_set_gpr_idx_off
A_40:
    s_sub_u32 s31, s31, 4
    s_cbranch_scc1 B_40
    v_mfma_f32_4x4x4_16b_bf16 v[124:127], v[172:173], v[178:179], 0 cbsz:4 abid:11
    v_lshlrev_b32_sdwa v136, v15, v114 dst_sel:DWORD dst_unused:UNUSED_PAD src0_sel:DWORD src1_sel:WORD_1
    s_waitcnt vmcnt(4)
    v_mfma_f32_4x4x4_16b_bf16 v[104:107], v[142:143], v[68:69], 0 cbsz:4 abid:10
    v_readlane_b32 s62, v164, 46
    v_mfma_f32_4x4x4_16b_bf16 v[108:111], v[142:143], v[70:71], 0 cbsz:4 abid:10
    v_lshlrev_b32_sdwa v137, v15, v115 dst_sel:DWORD dst_unused:UNUSED_PAD src0_sel:DWORD src1_sel:WORD_1
    ds_read_u16_d16_hi v132, v136 offset:32768
    ds_read_u16_d16_hi v133, v137 offset:32768
    s_and_b32 s33, s62, s34
    buffer_load_dwordx4 v[88:91], v1, s[12:15], s33 offen
    s_waitcnt lgkmcnt(2)
    s_set_gpr_idx_on s56, 0xc
    v_pk_fma_f32 v[16:17], v[128:129], v[96:97], v[16:17] op_sel:[0,0,0] op_sel_hi:[0,1,1]
    v_pk_fma_f32 v[18:19], v[128:129], v[98:99], v[18:19] op_sel:[0,0,0] op_sel_hi:[0,1,1]
    v_pk_fma_f32 v[20:21], v[130:131], v[100:101], v[20:21] op_sel:[0,0,0] op_sel_hi:[0,1,1]
    v_pk_fma_f32 v[22:23], v[130:131], v[102:103], v[22:23] op_sel:[0,0,0] op_sel_hi:[0,1,1]
    s_set_gpr_idx_off
    v_mfma_f32_4x4x4_16b_bf16 v[148:151], v[168:169], v[180:181], 0
    v_lshlrev_b32_sdwa v138, v15, v118 dst_sel:DWORD dst_unused:UNUSED_PAD src0_sel:DWORD src1_sel:WORD_1
    s_waitcnt vmcnt(4)
    v_mfma_f32_4x4x4_16b_bf16 v[96:99], v[144:145], v[72:73], 0 cbsz:4 abid:10
    v_readlane_b32 s63, v164, 47
    v_mfma_f32_4x4x4_16b_bf16 v[100:103], v[144:145], v[74:75], 0 cbsz:4 abid:10
    v_lshlrev_b32_sdwa v139, v15, v119 dst_sel:DWORD dst_unused:UNUSED_PAD src0_sel:DWORD src1_sel:WORD_1
    ds_read_u16_d16_hi v134, v138 offset:32768
    ds_read_u16_d16_hi v135, v139 offset:32768
    s_and_b32 s33, s63, s34
    buffer_load_dwordx4 v[92:95], v1, s[12:15], s33 offen
    s_set_gpr_idx_on s57, 0xc
    v_pk_fma_f32 v[16:17], v[128:129], v[104:105], v[16:17] op_sel:[1,0,0] op_sel_hi:[1,1,1]
    v_pk_fma_f32 v[18:19], v[128:129], v[106:107], v[18:19] op_sel:[1,0,0] op_sel_hi:[1,1,1]
    v_pk_fma_f32 v[20:21], v[130:131], v[108:109], v[20:21] op_sel:[1,0,0] op_sel_hi:[1,1,1]
    v_pk_fma_f32 v[22:23], v[130:131], v[110:111], v[22:23] op_sel:[1,0,0] op_sel_hi:[1,1,1]
    s_set_gpr_idx_off
    v_mfma_f32_4x4x4_16b_bf16 v[112:115], v[172:173], v[176:177], 0 cbsz:4 abid:12
    v_lshlrev_b32_sdwa v136, v15, v120 dst_sel:DWORD dst_unused:UNUSED_PAD src0_sel:DWORD src1_sel:WORD_1
    s_waitcnt vmcnt(4)
    v_mfma_f32_4x4x4_16b_bf16 v[104:107], v[146:147], v[76:77], 0 cbsz:4 abid:10
    v_readlane_b32 s48, v164, 48
    v_mfma_f32_4x4x4_16b_bf16 v[108:111], v[146:147], v[78:79], 0 cbsz:4 abid:10
    v_lshlrev_b32_sdwa v137, v15, v121 dst_sel:DWORD dst_unused:UNUSED_PAD src0_sel:DWORD src1_sel:WORD_1
    ds_read_u16_d16_hi v128, v136 offset:32768
    ds_read_u16_d16_hi v129, v137 offset:32768
    s_and_b32 s33, s48, s34
    buffer_load_dwordx4 v[64:67], v1, s[12:15], s33 offen
    s_waitcnt lgkmcnt(2)
    s_set_gpr_idx_on s58, 0xc
    v_pk_fma_f32 v[16:17], v[132:133], v[96:97], v[16:17] op_sel:[0,0,0] op_sel_hi:[0,1,1]
    v_pk_fma_f32 v[18:19], v[132:133], v[98:99], v[18:19] op_sel:[0,0,0] op_sel_hi:[0,1,1]
    v_pk_fma_f32 v[20:21], v[134:135], v[100:101], v[20:21] op_sel:[0,0,0] op_sel_hi:[0,1,1]
    v_pk_fma_f32 v[22:23], v[134:135], v[102:103], v[22:23] op_sel:[0,0,0] op_sel_hi:[0,1,1]
    s_set_gpr_idx_off
    v_mfma_f32_4x4x4_16b_bf16 v[152:155], v[168:169], v[182:183], 0
    v_lshlrev_b32_sdwa v138, v15, v124 dst_sel:DWORD dst_unused:UNUSED_PAD src0_sel:DWORD src1_sel:WORD_1
    s_waitcnt vmcnt(4)
    v_mfma_f32_4x4x4_16b_bf16 v[96:99], v[140:141], v[80:81], 0 cbsz:4 abid:11
    v_readlane_b32 s49, v164, 49
    v_mfma_f32_4x4x4_16b_bf16 v[100:103], v[140:141], v[82:83], 0 cbsz:4 abid:11
    v_lshlrev_b32_sdwa v139, v15, v125 dst_sel:DWORD dst_unused:UNUSED_PAD src0_sel:DWORD src1_sel:WORD_1
    ds_read_u16_d16_hi v130, v138 offset:32768
    ds_read_u16_d16_hi v131, v139 offset:32768
    s_and_b32 s33, s49, s34
    buffer_load_dwordx4 v[68:71], v1, s[12:15], s33 offen
    s_set_gpr_idx_on s59, 0xc
    v_pk_fma_f32 v[16:17], v[132:133], v[104:105], v[16:17] op_sel:[1,0,0] op_sel_hi:[1,1,1]
    v_pk_fma_f32 v[18:19], v[132:133], v[106:107], v[18:19] op_sel:[1,0,0] op_sel_hi:[1,1,1]
    v_pk_fma_f32 v[20:21], v[134:135], v[108:109], v[20:21] op_sel:[1,0,0] op_sel_hi:[1,1,1]
    v_pk_fma_f32 v[22:23], v[134:135], v[110:111], v[22:23] op_sel:[1,0,0] op_sel_hi:[1,1,1]
    s_set_gpr_idx_off
A_44:
    s_sub_u32 s31, s31, 4
    s_cbranch_scc1 B_44
    v_mfma_f32_4x4x4_16b_bf16 v[116:119], v[172:173], v[178:179], 0 cbsz:4 abid:12
    v_lshlrev_b32_sdwa v136, v15, v122 dst_sel:DWORD dst_unused:UNUSED_PAD src0_sel:DWORD src1_sel:WORD_1
    s_waitcnt vmcnt(4)
    v_mfma_f32_4x4x4_16b_bf16 v[104:107], v[142:143], v[84:85], 0 cbsz:4 abid:11
    v_readlane_b32 s50, v164, 50
    v_mfma_f32_4x4x4_16b_bf16 v[108:111], v[142:143], v[86:87], 0 cbsz:4 abid:11
    v_lshlrev_b32_sdwa v137, v15, v123 dst_sel:DWORD dst_unused:UNUSED_PAD src0_sel:DWORD src1_sel:WORD_1
    ds_read_u16_d16_hi v132, v136 offset:32768
    ds_read_u16_d16_hi v133, v137 offset:32768
    s_and_b32 s33, s50, s34
    buffer_load_dwordx4 v[72:75], v1, s[12:15], s33 offen
    s_waitcnt lgkmcnt(2)
    s_set_gpr_idx_on s60, 0xc
    v_pk_fma_f32 v[16:17], v[128:129], v[96:97], v[16:17] op_sel:[0,0,0] op_sel_hi:[0,1,1]
    v_pk_fma_f32 v[18:19], v[128:129], v[98:99], v[18:19] op_sel:[0,0,0] op_sel_hi:[0,1,1]
    v_pk_fma_f32 v[20:21], v[130:131], v[100:101], v[20:21] op_sel:[0,0,0] op_sel_hi:[0,1,1]
    v_pk_fma_f32 v[22:23], v[130:131], v[102:103], v[22:23] op_sel:[0,0,0] op_sel_hi:[0,1,1]
    s_set_gpr_idx_off
    v_mfma_f32_4x4x4_16b_bf16 v[156:159], v[168:169], v[184:185], 0
    v_lshlrev_b32_sdwa v138, v15, v126 dst_sel:DWORD dst_unused:UNUSED_PAD src0_sel:DWORD src1_sel:WORD_1
    s_waitcnt vmcnt(4)
    v_mfma_f32_4x4x4_16b_bf16 v[96:99], v[144:145], v[88:89], 0 cbsz:4 abid:11
    v_readlane_b32 s51, v164, 51
    v_mfma_f32_4x4x4_16b_bf16 v[100:103], v[144:145], v[90:91], 0 cbsz:4 abid:11
    v_lshlrev_b32_sdwa v139, v15, v127 dst_sel:DWORD dst_unused:UNUSED_PAD src0_sel:DWORD src1_sel:WORD_1
    ds_read_u16_d16_hi v134, v138 offset:32768
    ds_read_u16_d16_hi v135, v139 offset:32768
    s_and_b32 s33, s51, s34
    buffer_load_dwordx4 v[76:79], v1, s[12:15], s33 offen
    s_set_gpr_idx_on s61, 0xc
    v_pk_fma_f32 v[16:17], v[128:129], v[104:105], v[16:17] op_sel:[1,0,0] op_sel_hi:[1,1,1]
    v_pk_fma_f32 v[18:19], v[128:129], v[106:107], v[18:19] op_sel:[1,0,0] op_sel_hi:[1,1,1]
    v_pk_fma_f32 v[20:21], v[130:131], v[108:109], v[20:21] op_sel:[1,0,0] op_sel_hi:[1,1,1]
    v_pk_fma_f32 v[22:23], v[130:131], v[110:111], v[22:23] op_sel:[1,0,0] op_sel_hi:[1,1,1]
    s_set_gpr_idx_off
    v_mfma_f32_4x4x4_16b_bf16 v[120:123], v[172:173], v[176:177], 0 cbsz:4 abid:13
    v_lshlrev_b32_sdwa v136, v15, v112 dst_sel:DWORD dst_unused:UNUSED_PAD src0_sel:DWORD src1_sel:WORD_1
    s_waitcnt vmcnt(4)
    v_mfma_f32_4x4x4_16b_bf16 v[104:107], v[146:147], v[92:93], 0 cbsz:4 abid:11
    v_readlane_b32 s52, v164, 52
    v_mfma_f32_4x4x4_16b_bf16 v[108:111], v[146:147], v[94:95], 0 cbsz:4 abid:11
    v_lshlrev_b32_sdwa v137, v15, v113 dst_sel:DWORD dst_unused:UNUSED_PAD src0_sel:DWORD src1_sel:WORD_1
    ds_read_u16_d16_hi v128, v136 offset:32768
    ds_read_u16_d16_hi v129, v137 offset:32768
    s_and_b32 s33, s52, s34
    buffer_load_dwordx4 v[80:83], v1, s[12:15], s33 offen
    s_waitcnt lgkmcnt(2)
    s_set_gpr_idx_on s62, 0xc
    v_pk_fma_f32 v[16:17], v[132:133], v[96:97], v[16:17] op_sel:[0,0,0] op_sel_hi:[0,1,1]
    v_pk_fma_f32 v[18:19], v[132:133], v[98:99], v[18:19] op_sel:[0,0,0] op_sel_hi:[0,1,1]
    v_pk_fma_f32 v[20:21], v[134:135], v[100:101], v[20:21] op_sel:[0,0,0] op_sel_hi:[0,1,1]
    v_pk_fma_f32 v[22:23], v[134:135], v[102:103], v[22:23] op_sel:[0,0,0] op_sel_hi:[0,1,1]
    s_set_gpr_idx_off
    v_mfma_f32_4x4x4_16b_bf16 v[160:163], v[168:169], v[186:187], 0
    v_lshlrev_b32_sdwa v138, v15, v116 dst_sel:DWORD dst_unused:UNUSED_PAD src0_sel:DWORD src1_sel:WORD_1
    s_waitcnt vmcnt(4)
    v_mfma_f32_4x4x4_16b_bf16 v[96:99], v[140:141], v[64:65], 0 cbsz:4 abid:12
    v_readlane_b32 s53, v164, 53
    v_mfma_f32_4x4x4_16b_bf16 v[100:103], v[140:141], v[66:67], 0 cbsz:4 abid:12
    v_lshlrev_b32_sdwa v139, v15, v117 dst_sel:DWORD dst_unused:UNUSED_PAD src0_sel:DWORD src1_sel:WORD_1
    ds_read_u16_d16_hi v130, v138 offset:32768
    ds_read_u16_d16_hi v131, v139 offset:32768
    s_and_b32 s33, s53, s34
    buffer_load_dwordx4 v[84:87], v1, s[12:15], s33 offen
    s_set_gpr_idx_on s63, 0xc
    v_pk_fma_f32 v[16:17], v[132:133], v[104:105], v[16:17] op_sel:[1,0,0] op_sel_hi:[1,1,1]
    v_pk_fma_f32 v[18:19], v[132:133], v[106:107], v[18:19] op_sel:[1,0,0] op_sel_hi:[1,1,1]
    v_pk_fma_f32 v[20:21], v[134:135], v[108:109], v[20:21] op_sel:[1,0,0] op_sel_hi:[1,1,1]
    v_pk_fma_f32 v[22:23], v[134:135], v[110:111], v[22:23] op_sel:[1,0,0] op_sel_hi:[1,1,1]
    s_set_gpr_idx_off
A_48:
    s_sub_u32 s31, s31, 4
    s_cbranch_scc1 B_48
    v_mfma_f32_4x4x4_16b_bf16 v[124:127], v[172:173], v[178:179], 0 cbsz:4 abid:13
    v_lshlrev_b32_sdwa v136, v15, v114 dst_sel:DWORD dst_unused:UNUSED_PAD src0_sel:DWORD src1_sel:WORD_1
    s_waitcnt vmcnt(4)
    v_mfma_f32_4x4x4_16b_bf16 v[104:107], v[142:143], v[68:69], 0 cbsz:4 abid:12
    v_readlane_b32 s54, v164, 54
    v_mfma_f32_4x4x4_16b_bf16 v[108:111], v[142:143], v[70:71], 0 cbsz:4 abid:12
    v_lshlrev_b32_sdwa v137, v15, v115 dst_sel:DWORD dst_unused:UNUSED_PAD src0_sel:DWORD src1_sel:WORD_1
    ds_read_u16_d16_hi v132, v136 offset:32768
    ds_read_u16_d16_hi v133, v137 offset:32768
    s_and_b32 s33, s54, s34
    buffer_load_dwordx4 v[88:91], v1, s[12:15], s33 offen
    s_waitcnt lgkmcnt(2)
    s_set_gpr_idx_on s48, 0xc
    v_pk_fma_f32 v[16:17], v[128:129], v[96:97], v[16:17] op_sel:[0,0,0] op_sel_hi:[0,1,1]
    v_pk_fma_f32 v[18:19], v[128:129], v[98:99], v[18:19] op_sel:[0,0,0] op_sel_hi:[0,1,1]
    v_pk_fma_f32 v[20:21], v[130:131], v[100:101], v[20:21] op_sel:[0,0,0] op_sel_hi:[0,1,1]
    v_pk_fma_f32 v[22:23], v[130:131], v[102:103], v[22:23] op_sel:[0,0,0] op_sel_hi:[0,1,1]
    s_set_gpr_idx_off
    v_lshlrev_b32_sdwa v138, v15, v118 dst_sel:DWORD dst_unused:UNUSED_PAD src0_sel:DWORD src1_sel:WORD_1
    s_waitcnt vmcnt(4)
    v_mfma_f32_4x4x4_16b_bf16 v[96:99], v[144:145], v[72:73], 0 cbsz:4 abid:12
    v_readlane_b32 s55, v164, 55
    v_mfma_f32_4x4x4_16b_bf16 v[100:103], v[144:145], v[74:75], 0 cbsz:4 abid:12
    v_lshlrev_b32_sdwa v139, v15, v119 dst_sel:DWORD dst_unused:UNUSED_PAD src0_sel:DWORD src1_sel:WORD_1
    ds_read_u16_d16_hi v134, v138 offset:32768
    ds_read_u16_d16_hi v135, v139 offset:32768
    s_and_b32 s33, s55, s34
    buffer_load_dwordx4 v[92:95], v1, s[12:15], s33 offen
    s_set_gpr_idx_on s49, 0xc
    v_pk_fma_f32 v[16:17], v[128:129], v[104:105], v[16:17] op_sel:[1,0,0] op_sel_hi:[1,1,1]
    v_pk_fma_f32 v[18:19], v[128:129], v[106:107], v[18:19] op_sel:[1,0,0] op_sel_hi:[1,1,1]
    v_pk_fma_f32 v[20:21], v[130:131], v[108:109], v[20:21] op_sel:[1,0,0] op_sel_hi:[1,1,1]
    v_pk_fma_f32 v[22:23], v[130:131], v[110:111], v[22:23] op_sel:[1,0,0] op_sel_hi:[1,1,1]
    s_set_gpr_idx_off
    v_mfma_f32_4x4x4_16b_bf16 v[112:115], v[172:173], v[176:177], 0 cbsz:4 abid:14
    v_lshlrev_b32_sdwa v136, v15, v120 dst_sel:DWORD dst_unused:UNUSED_PAD src0_sel:DWORD src1_sel:WORD_1
    s_waitcnt vmcnt(4)
    v_mfma_f32_4x4x4_16b_bf16 v[104:107], v[146:147], v[76:77], 0 cbsz:4 abid:12
    v_readlane_b32 s56, v164, 56
    v_mfma_f32_4x4x4_16b_bf16 v[108:111], v[146:147], v[78:79], 0 cbsz:4 abid:12
    v_lshlrev_b32_sdwa v137, v15, v121 dst_sel:DWORD dst_unused:UNUSED_PAD src0_sel:DWORD src1_sel:WORD_1
    ds_read_u16_d16_hi v128, v136 offset:32768
    ds_read_u16_d16_hi v129, v137 offset:32768
    s_and_b32 s33, s56, s34
    buffer_load_dwordx4 v[64:67], v1, s[12:15], s33 offen
    s_waitcnt lgkmcnt(2)
    s_set_gpr_idx_on s50, 0xc
    v_pk_fma_f32 v[16:17], v[132:133], v[96:97], v[16:17] op_sel:[0,0,0] op_sel_hi:[0,1,1]
    v_pk_fma_f32 v[18:19], v[132:133], v[98:99], v[18:19] op_sel:[0,0,0] op_sel_hi:[0,1,1]
    v_pk_fma_f32 v[20:21], v[134:135], v[100:101], v[20:21] op_sel:[0,0,0] op_sel_hi:[0,1,1]
    v_pk_fma_f32 v[22:23], v[134:135], v[102:103], v[22:23] op_sel:[0,0,0] op_sel_hi:[0,1,1]
    s_set_gpr_idx_off
    v_lshlrev_b32_sdwa v138, v15, v124 dst_sel:DWORD dst_unused:UNUSED_PAD src0_sel:DWORD src1_sel:WORD_1
    s_waitcnt vmcnt(4)
    v_mfma_f32_4x4x4_16b_bf16 v[96:99], v[140:141], v[80:81], 0 cbsz:4 abid:13
    v_readlane_b32 s57, v164, 57
    v_mfma_f32_4x4x4_16b_bf16 v[100:103], v[140:141], v[82:83], 0 cbsz:4 abid:13
    v_lshlrev_b32_sdwa v139, v15, v125 dst_sel:DWORD dst_unused:UNUSED_PAD src0_sel:DWORD src1_sel:WORD_1
    ds_read_u16_d16_hi v130, v138 offset:32768
    ds_read_u16_d16_hi v131, v139 offset:32768
    s_and_b32 s33, s57, s34
    buffer_load_dwordx4 v[68:71], v1, s[12:15], s33 offen
    s_set_gpr_idx_on s51, 0xc
    v_pk_fma_f32 v[16:17], v[132:133], v[104:105], v[16:17] op_sel:[1,0,0] op_sel_hi:[1,1,1]
    v_pk_fma_f32 v[18:19], v[132:133], v[106:107], v[18:19] op_sel:[1,0,0] op_sel_hi:[1,1,1]
    v_pk_fma_f32 v[20:21], v[134:135], v[108:109], v[20:21] op_sel:[1,0,0] op_sel_hi:[1,1,1]
    v_pk_fma_f32 v[22:23], v[134:135], v[110:111], v[22:23] op_sel:[1,0,0] op_sel_hi:[1,1,1]
    s_set_gpr_idx_off
A_52:
    s_sub_u32 s31, s31, 4
    s_cbranch_scc1 B_52
    v_mfma_f32_4x4x4_16b_bf16 v[116:119], v[172:173], v[178:179], 0 cbsz:4 abid:14
    v_lshlrev_b32_sdwa v136, v15, v122 dst_sel:DWORD dst_unused:UNUSED_PAD src0_sel:DWORD src1_sel:WORD_1
    s_waitcnt vmcnt(4)
    v_mfma_f32_4x4x4_16b_bf16 v[104:107], v[142:143], v[84:85], 0 cbsz:4 abid:13
    v_readlane_b32 s58, v164, 58
    v_mfma_f32_4x4x4_16b_bf16 v[108:111], v[142:143], v[86:87], 0 cbsz:4 abid:13
    v_lshlrev_b32_sdwa v137, v15, v123 dst_sel:DWORD dst_unused:UNUSED_PAD src0_sel:DWORD src1_sel:WORD_1
    ds_read_u16_d16_hi v132, v136 offset:32768
    ds_read_u16_d16_hi v133, v137 offset:32768
    s_and_b32 s33, s58, s34
    buffer_load_dwordx4 v[72:75], v1, s[12:15], s33 offen
    s_waitcnt lgkmcnt(2)
    s_set_gpr_idx_on s52, 0xc
    v_pk_fma_f32 v[16:17], v[128:129], v[96:97], v[16:17] op_sel:[0,0,0] op_sel_hi:[0,1,1]
    v_pk_fma_f32 v[18:19], v[128:129], v[98:99], v[18:19] op_sel:[0,0,0] op_sel_hi:[0,1,1]
    v_pk_fma_f32 v[20:21], v[130:131], v[100:101], v[20:21] op_sel:[0,0,0] op_sel_hi:[0,1,1]
    v_pk_fma_f32 v[22:23], v[130:131], v[102:103], v[22:23] op_sel:[0,0,0] op_sel_hi:[0,1,1]
    s_set_gpr_idx_off
    v_lshlrev_b32_sdwa v138, v15, v126 dst_sel:DWORD dst_unused:UNUSED_PAD src0_sel:DWORD src1_sel:WORD_1
    s_waitcnt vmcnt(4)
    v_mfma_f32_4x4x4_16b_bf16 v[96:99], v[144:145], v[88:89], 0 cbsz:4 abid:13
    v_readlane_b32 s59, v164, 59
    v_mfma_f32_4x4x4_16b_bf16 v[100:103], v[144:145], v[90:91], 0 cbsz:4 abid:13
    v_lshlrev_b32_sdwa v139, v15, v127 dst_sel:DWORD dst_unused:UNUSED_PAD src0_sel:DWORD src1_sel:WORD_1
    ds_read_u16_d16_hi v134, v138 offset:32768
    ds_read_u16_d16_hi v135, v139 offset:32768
    s_and_b32 s33, s59, s34
    buffer_load_dwordx4 v[76:79], v1, s[12:15], s33 offen
    s_set_gpr_idx_on s53, 0xc
    v_pk_fma_f32 v[16:17], v[128:129], v[104:105], v[16:17] op_sel:[1,0,0] op_sel_hi:[1,1,1]
    v_pk_fma_f32 v[18:19], v[128:129], v[106:107], v[18:19] op_sel:[1,0,0] op_sel_hi:[1,1,1]
    v_pk_fma_f32 v[20:21], v[130:131], v[108:109], v[20:21] op_sel:[1,0,0] op_sel_hi:[1,1,1]
    v_pk_fma_f32 v[22:23], v[130:131], v[110:111], v[22:23] op_sel:[1,0,0] op_sel_hi:[1,1,1]
    s_set_gpr_idx_off
    v_mfma_f32_4x4x4_16b_bf16 v[120:123], v[172:173], v[176:177], 0 cbsz:4 abid:15
    v_lshlrev_b32_sdwa v136, v15, v112 dst_sel:DWORD dst_unused:UNUSED_PAD src0_sel:DWORD src1_sel:WORD_1
    s_waitcnt vmcnt(4)
    v_mfma_f32_4x4x4_16b_bf16 v[104:107], v[146:147], v[92:93], 0 cbsz:4 abid:13
    v_readlane_b32 s60, v164, 60
    v_mfma_f32_4x4x4_16b_bf16 v[108:111], v[146:147], v[94:95], 0 cbsz:4 abid:13
    v_lshlrev_b32_sdwa v137, v15, v113 dst_sel:DWORD dst_unused:UNUSED_PAD src0_sel:DWORD src1_sel:WORD_1
    ds_read_u16_d16_hi v128, v136 offset:32768
    ds_read_u16_d16_hi v129, v137 offset:32768
    s_and_b32 s33, s60, s34
    buffer_load_dwordx4 v[80:83], v1, s[12:15], s33 offen
    s_waitcnt lgkmcnt(2)
    s_set_gpr_idx_on s54, 0xc
    v_pk_fma_f32 v[16:17], v[132:133], v[96:97], v[16:17] op_sel:[0,0,0] op_sel_hi:[0,1,1]
    v_pk_fma_f32 v[18:19], v[132:133], v[98:99], v[18:19] op_sel:[0,0,0] op_sel_hi:[0,1,1]
    v_pk_fma_f32 v[20:21], v[134:135], v[100:101], v[20:21] op_sel:[0,0,0] op_sel_hi:[0,1,1]
    v_pk_fma_f32 v[22:23], v[134:135], v[102:103], v[22:23] op_sel:[0,0,0] op_sel_hi:[0,1,1]
    s_set_gpr_idx_off
    v_lshlrev_b32_sdwa v138, v15, v116 dst_sel:DWORD dst_unused:UNUSED_PAD src0_sel:DWORD src1_sel:WORD_1
    s_waitcnt vmcnt(4)
    v_mfma_f32_4x4x4_16b_bf16 v[96:99], v[140:141], v[64:65], 0 cbsz:4 abid:14
    v_readlane_b32 s61, v164, 61
    v_mfma_f32_4x4x4_16b_bf16 v[100:103], v[140:141], v[66:67], 0 cbsz:4 abid:14
    v_lshlrev_b32_sdwa v139, v15, v117 dst_sel:DWORD dst_unused:UNUSED_PAD src0_sel:DWORD src1_sel:WORD_1
    ds_read_u16_d16_hi v130, v138 offset:32768
    ds_read_u16_d16_hi v131, v139 offset:32768
    s_and_b32 s33, s61, s34
    buffer_load_dwordx4 v[84:87], v1, s[12:15], s33 offen
    s_set_gpr_idx_on s55, 0xc
    v_pk_fma_f32 v[16:17], v[132:133], v[104:105], v[16:17] op_sel:[1,0,0] op_sel_hi:[1,1,1]
    v_pk_fma_f32 v[18:19], v[132:133], v[106:107], v[18:19] op_sel:[1,0,0] op_sel_hi:[1,1,1]
    v_pk_fma_f32 v[20:21], v[134:135], v[108:109], v[20:21] op_sel:[1,0,0] op_sel_hi:[1,1,1]
    v_pk_fma_f32 v[22:23], v[134:135], v[110:111], v[22:23] op_sel:[1,0,0] op_sel_hi:[1,1,1]
    s_set_gpr_idx_off
A_56:
    s_sub_u32 s31, s31, 4
    s_cbranch_scc1 B_56
    v_mfma_f32_4x4x4_16b_bf16 v[124:127], v[172:173], v[178:179], 0 cbsz:4 abid:15
    v_lshlrev_b32_sdwa v136, v15, v114 dst_sel:DWORD dst_unused:UNUSED_PAD src0_sel:DWORD src1_sel:WORD_1
    s_waitcnt vmcnt(4)
    v_mfma_f32_4x4x4_16b_bf16 v[104:107], v[142:143], v[68:69], 0 cbsz:4 abid:14
    v_readlane_b32 s62, v164, 62
    v_mfma_f32_4x4x4_16b_bf16 v[108:111], v[142:143], v[70:71], 0 cbsz:4 abid:14
    v_lshlrev_b32_sdwa v137, v15, v115 dst_sel:DWORD dst_unused:UNUSED_PAD src0_sel:DWORD src1_sel:WORD_1
    ds_read_u16_d16_hi v132, v136 offset:32768
    ds_read_u16_d16_hi v133, v137 offset:32768
    s_and_b32 s33, s62, s34
    buffer_load_dwordx4 v[88:91], v1, s[12:15], s33 offen
    s_waitcnt lgkmcnt(2)
    s_set_gpr_idx_on s56, 0xc
    v_pk_fma_f32 v[16:17], v[128:129], v[96:97], v[16:17] op_sel:[0,0,0] op_sel_hi:[0,1,1]
    v_pk_fma_f32 v[18:19], v[128:129], v[98:99], v[18:19] op_sel:[0,0,0] op_sel_hi:[0,1,1]
    v_pk_fma_f32 v[20:21], v[130:131], v[100:101], v[20:21] op_sel:[0,0,0] op_sel_hi:[0,1,1]
    v_pk_fma_f32 v[22:23], v[130:131], v[102:103], v[22:23] op_sel:[0,0,0] op_sel_hi:[0,1,1]
    s_set_gpr_idx_off
    v_lshlrev_b32_sdwa v138, v15, v118 dst_sel:DWORD dst_unused:UNUSED_PAD src0_sel:DWORD src1_sel:WORD_1
    s_waitcnt vmcnt(4)
    v_mfma_f32_4x4x4_16b_bf16 v[96:99], v[144:145], v[72:73], 0 cbsz:4 abid:14
    v_readlane_b32 s63, v164, 63
    v_mfma_f32_4x4x4_16b_bf16 v[100:103], v[144:145], v[74:75], 0 cbsz:4 abid:14
    v_lshlrev_b32_sdwa v139, v15, v119 dst_sel:DWORD dst_unused:UNUSED_PAD src0_sel:DWORD src1_sel:WORD_1
    ds_read_u16_d16_hi v134, v138 offset:32768
    ds_read_u16_d16_hi v135, v139 offset:32768
    s_and_b32 s33, s63, s34
    buffer_load_dwordx4 v[92:95], v1, s[12:15], s33 offen
    s_set_gpr_idx_on s57, 0xc
    v_pk_fma_f32 v[16:17], v[128:129], v[104:105], v[16:17] op_sel:[1,0,0] op_sel_hi:[1,1,1]
    v_pk_fma_f32 v[18:19], v[128:129], v[106:107], v[18:19] op_sel:[1,0,0] op_sel_hi:[1,1,1]
    v_pk_fma_f32 v[20:21], v[130:131], v[108:109], v[20:21] op_sel:[1,0,0] op_sel_hi:[1,1,1]
    v_pk_fma_f32 v[22:23], v[130:131], v[110:111], v[22:23] op_sel:[1,0,0] op_sel_hi:[1,1,1]
    s_set_gpr_idx_off
    v_mov_b32 v172, v170
    v_mov_b32 v173, v171
    s_nop 1
    v_mfma_f32_4x4x4_16b_bf16 v[112:115], v[172:173], v[176:177], 0 cbsz:4 abid:0
    v_lshlrev_b32_sdwa v136, v15, v120 dst_sel:DWORD dst_unused:UNUSED_PAD src0_sel:DWORD src1_sel:WORD_1
    s_waitcnt vmcnt(4)
    v_mfma_f32_4x4x4_16b_bf16 v[104:107], v[146:147], v[76:77], 0 cbsz:4 abid:14
    v_readlane_b32 s48, v165, 0
    v_mfma_f32_4x4x4_16b_bf16 v[108:111], v[146:147], v[78:79], 0 cbsz:4 abid:14
    v_lshlrev_b32_sdwa v137, v15, v121 dst_sel:DWORD dst_unused:UNUSED_PAD src0_sel:DWORD src1_sel:WORD_1
    ds_read_u16_d16_hi v128, v136 offset:32768
    ds_read_u16_d16_hi v129, v137 offset:32768
    s_and_b32 s33, s48, s34
    buffer_load_dwordx4 v[64:67], v1, s[12:15], s33 offen
    s_waitcnt lgkmcnt(2)
    s_set_gpr_idx_on s58, 0xc
    v_pk_fma_f32 v[16:17], v[132:133], v[96:97], v[16:17] op_sel:[0,0,0] op_sel_hi:[0,1,1]
    v_pk_fma_f32 v[18:19], v[132:133], v[98:99], v[18:19] op_sel:[0,0,0] op_sel_hi:[0,1,1]
    v_pk_fma_f32 v[20:21], v[134:135], v[100:101], v[20:21] op_sel:[0,0,0] op_sel_hi:[0,1,1]
    v_pk_fma_f32 v[22:23], v[134:135], v[102:103], v[22:23] op_sel:[0,0,0] op_sel_hi:[0,1,1]
    s_set_gpr_idx_off
    v_lshlrev_b32_sdwa v138, v15, v124 dst_sel:DWORD dst_unused:UNUSED_PAD src0_sel:DWORD src1_sel:WORD_1
    s_waitcnt vmcnt(4)
    v_mfma_f32_4x4x4_16b_bf16 v[96:99], v[140:141], v[80:81], 0 cbsz:4 abid:15
    v_readlane_b32 s49, v165, 1
    v_mfma_f32_4x4x4_16b_bf16 v[100:103], v[140:141], v[82:83], 0 cbsz:4 abid:15
    v_lshlrev_b32_sdwa v139, v15, v125 dst_sel:DWORD dst_unused:UNUSED_PAD src0_sel:DWORD src1_sel:WORD_1
    ds_read_u16_d16_hi v130, v138 offset:32768
    ds_read_u16_d16_hi v131, v139 offset:32768
    s_and_b32 s33, s49, s34
    buffer_load_dwordx4 v[68:71], v1, s[12:15], s33 offen
    s_set_gpr_idx_on s59, 0xc
    v_pk_fma_f32 v[16:17], v[132:133], v[104:105], v[16:17] op_sel:[1,0,0] op_sel_hi:[1,1,1]
    v_pk_fma_f32 v[18:19], v[132:133], v[106:107], v[18:19] op_sel:[1,0,0] op_sel_hi:[1,1,1]
    v_pk_fma_f32 v[20:21], v[134:135], v[108:109], v[20:21] op_sel:[1,0,0] op_sel_hi:[1,1,1]
    v_pk_fma_f32 v[22:23], v[134:135], v[110:111], v[22:23] op_sel:[1,0,0] op_sel_hi:[1,1,1]
    s_set_gpr_idx_off
A_60:
    s_sub_u32 s31, s31, 4
    s_cbranch_scc1 B_60
    v_mfma_f32_4x4x4_16b_bf16 v[116:119], v[172:173], v[178:179], 0 cbsz:4 abid:0
    v_lshlrev_b32_sdwa v136, v15, v122 dst_sel:DWORD dst_unused:UNUSED_PAD src0_sel:DWORD src1_sel:WORD_1
    s_waitcnt vmcnt(4)
    v_mfma_f32_4x4x4_16b_bf16 v[104:107], v[142:143], v[84:85], 0 cbsz:4 abid:15
    v_readlane_b32 s50, v165, 2
    v_mfma_f32_4x4x4_16b_bf16 v[108:111], v[142:143], v[86:87], 0 cbsz:4 abid:15
    v_lshlrev_b32_sdwa v137, v15, v123 dst_sel:DWORD dst_unused:UNUSED_PAD src0_sel:DWORD src1_sel:WORD_1
    ds_read_u16_d16_hi v132, v136 offset:32768
    ds_read_u16_d16_hi v133, v137 offset:32768
    v_cvt_pk_bf16_f32 v140, v148, v152
    v_cvt_pk_bf16_f32 v141, v156, v160
    s_and_b32 s33, s50, s34
    buffer_load_dwordx4 v[72:75], v1, s[12:15], s33 offen
    s_waitcnt lgkmcnt(2)
    s_set_gpr_idx_on s60, 0xc
    v_pk_fma_f32 v[16:17], v[128:129], v[96:97], v[16:17] op_sel:[0,0,0] op_sel_hi:[0,1,1]
    v_pk_fma_f32 v[18:19], v[128:129], v[98:99], v[18:19] op_sel:[0,0,0] op_sel_hi:[0,1,1]
    v_pk_fma_f32 v[20:21], v[130:131], v[100:101], v[20:21] op_sel:[0,0,0] op_sel_hi:[0,1,1]
    v_pk_fma_f32 v[22:23], v[130:131], v[102:103], v[22:23] op_sel:[0,0,0] op_sel_hi:[0,1,1]
    s_set_gpr_idx_off
    v_lshlrev_b32_sdwa v138, v15, v126 dst_sel:DWORD dst_unused:UNUSED_PAD src0_sel:DWORD src1_sel:WORD_1
    s_waitcnt vmcnt(4)
    v_mfma_f32_4x4x4_16b_bf16 v[96:99], v[144:145], v[88:89], 0 cbsz:4 abid:15
    v_readlane_b32 s51, v165, 3
    v_mfma_f32_4x4x4_16b_bf16 v[100:103], v[144:145], v[90:91], 0 cbsz:4 abid:15
    v_lshlrev_b32_sdwa v139, v15, v127 dst_sel:DWORD dst_unused:UNUSED_PAD src0_sel:DWORD src1_sel:WORD_1
    ds_read_u16_d16_hi v134, v138 offset:32768
    ds_read_u16_d16_hi v135, v139 offset:32768
    v_cvt_pk_bf16_f32 v142, v149, v153
    v_cvt_pk_bf16_f32 v143, v157, v161
    s_and_b32 s33, s51, s34
    buffer_load_dwordx4 v[76:79], v1, s[12:15], s33 offen
    s_set_gpr_idx_on s61, 0xc
    v_pk_fma_f32 v[16:17], v[128:129], v[104:105], v[16:17] op_sel:[1,0,0] op_sel_hi:[1,1,1]
    v_pk_fma_f32 v[18:19], v[128:129], v[106:107], v[18:19] op_sel:[1,0,0] op_sel_hi:[1,1,1]
    v_pk_fma_f32 v[20:21], v[130:131], v[108:109], v[20:21] op_sel:[1,0,0] op_sel_hi:[1,1,1]
    v_pk_fma_f32 v[22:23], v[130:131], v[110:111], v[22:23] op_sel:[1,0,0] op_sel_hi:[1,1,1]
    s_set_gpr_idx_off
    v_mfma_f32_4x4x4_16b_bf16 v[120:123], v[172:173], v[176:177], 0 cbsz:4 abid:1
    v_lshlrev_b32_sdwa v136, v15, v112 dst_sel:DWORD dst_unused:UNUSED_PAD src0_sel:DWORD src1_sel:WORD_1
    s_waitcnt vmcnt(4)
    v_mfma_f32_4x4x4_16b_bf16 v[104:107], v[146:147], v[92:93], 0 cbsz:4 abid:15
    v_readlane_b32 s52, v165, 4
    v_mfma_f32_4x4x4_16b_bf16 v[108:111], v[146:147], v[94:95], 0 cbsz:4 abid:15
    v_lshlrev_b32_sdwa v137, v15, v113 dst_sel:DWORD dst_unused:UNUSED_PAD src0_sel:DWORD src1_sel:WORD_1
    ds_read_u16_d16_hi v128, v136 offset:32768
    ds_read_u16_d16_hi v129, v137 offset:32768
    v_cvt_pk_bf16_f32 v144, v150, v154
    v_cvt_pk_bf16_f32 v145, v158, v162
    s_and_b32 s33, s52, s34
    buffer_load_dwordx4 v[80:83], v1, s[12:15], s33 offen
    s_waitcnt lgkmcnt(2)
    s_set_gpr_idx_on s62, 0xc
    v_pk_fma_f32 v[16:17], v[132:133], v[96:97], v[16:17] op_sel:[0,0,0] op_sel_hi:[0,1,1]
    v_pk_fma_f32 v[18:19], v[132:133], v[98:99], v[18:19] op_sel:[0,0,0] op_sel_hi:[0,1,1]
    v_pk_fma_f32 v[20:21], v[134:135], v[100:101], v[20:21] op_sel:[0,0,0] op_sel_hi:[0,1,1]
    v_pk_fma_f32 v[22:23], v[134:135], v[102:103], v[22:23] op_sel:[0,0,0] op_sel_hi:[0,1,1]
    s_set_gpr_idx_off
    v_lshlrev_b32_sdwa v138, v15, v116 dst_sel:DWORD dst_unused:UNUSED_PAD src0_sel:DWORD src1_sel:WORD_1
    s_waitcnt vmcnt(4)
    v_mfma_f32_4x4x4_16b_bf16 v[96:99], v[140:141], v[64:65], 0 cbsz:4 abid:0
    v_readlane_b32 s53, v165, 5
    v_mfma_f32_4x4x4_16b_bf16 v[100:103], v[140:141], v[66:67], 0 cbsz:4 abid:0
    v_lshlrev_b32_sdwa v139, v15, v117 dst_sel:DWORD dst_unused:UNUSED_PAD src0_sel:DWORD src1_sel:WORD_1
    ds_read_u16_d16_hi v130, v138 offset:32768
    ds_read_u16_d16_hi v131, v139 offset:32768
    v_cvt_pk_bf16_f32 v146, v151, v155
    v_cvt_pk_bf16_f32 v147, v159, v163
    s_and_b32 s33, s53, s34
    buffer_load_dwordx4 v[84:87], v1, s[12:15], s33 offen
    s_set_gpr_idx_on s63, 0xc
    v_pk_fma_f32 v[16:17], v[132:133], v[104:105], v[16:17] op_sel:[1,0,0] op_sel_hi:[1,1,1]
    v_pk_fma_f32 v[18:19], v[132:133], v[106:107], v[18:19] op_sel:[1,0,0] op_sel_hi:[1,1,1]
    v_pk_fma_f32 v[20:21], v[134:135], v[108:109], v[20:21] op_sel:[1,0,0] op_sel_hi:[1,1,1]
    v_pk_fma_f32 v[22:23], v[134:135], v[110:111], v[22:23] op_sel:[1,0,0] op_sel_hi:[1,1,1]
    s_set_gpr_idx_off
    v_mov_b32 v164, v165
    s_branch A_0
B_0:
    buffer_load_dwordx4 v[188:191], v1, s[16:19], s10 offen offset:0 sc1
    buffer_load_dwordx4 v[192:195], v1, s[16:19], s10 offen offset:1024 sc1
    buffer_load_dwordx4 v[196:199], v1, s[16:19], s10 offen offset:2048 sc1
    buffer_load_dwordx4 v[200:203], v1, s[16:19], s10 offen offset:3072 sc1
    buffer_load_dwordx4 v[204:207], v1, s[16:19], s11 offen offset:0 sc1
    buffer_load_dwordx4 v[208:211], v1, s[16:19], s11 offen offset:1024 sc1
    buffer_load_dwordx4 v[212:215], v1, s[16:19], s11 offen offset:2048 sc1
    buffer_load_dwordx4 v[216:219], v1, s[16:19], s11 offen offset:3072 sc1
    s_sub_u32 s32, s32, 1
    s_cbranch_scc1 MAIN_DONE
    v_mfma_f32_4x4x4_16b_bf16 v[124:127], v[172:173], v[178:179], 0 cbsz:4 abid:1
    v_lshlrev_b32_sdwa v136, v15, v114 dst_sel:DWORD dst_unused:UNUSED_PAD src0_sel:DWORD src1_sel:WORD_1
    s_waitcnt vmcnt(12)
    v_mfma_f32_4x4x4_16b_bf16 v[104:107], v[142:143], v[68:69], 0 cbsz:4 abid:0
    s_nop 0
    v_mfma_f32_4x4x4_16b_bf16 v[108:111], v[142:143], v[70:71], 0 cbsz:4 abid:0
    v_lshlrev_b32_sdwa v137, v15, v115 dst_sel:DWORD dst_unused:UNUSED_PAD src0_sel:DWORD src1_sel:WORD_1
    ds_read_u16_d16_hi v132, v136 offset:32768
    ds_read_u16_d16_hi v133, v137 offset:32768
    s_waitcnt lgkmcnt(2)
    s_set_gpr_idx_on s48, 0xc
    v_pk_fma_f32 v[16:17], v[128:129], v[96:97], v[16:17] op_sel:[0,0,0] op_sel_hi:[0,1,1]
    v_pk_fma_f32 v[18:19], v[128:129], v[98:99], v[18:19] op_sel:[0,0,0] op_sel_hi:[0,1,1]
    v_pk_fma_f32 v[20:21], v[130:131], v[100:101], v[20:21] op_sel:[0,0,0] op_sel_hi:[0,1,1]
    v_pk_fma_f32 v[22:23], v[130:131], v[102:103], v[22:23] op_sel:[0,0,0] op_sel_hi:[0,1,1]
    s_set_gpr_idx_off
    s_sub_u32 s32, s32, 1
    s_cbranch_scc1 MAIN_DONE
    v_lshlrev_b32_sdwa v138, v15, v118 dst_sel:DWORD dst_unused:UNUSED_PAD src0_sel:DWORD src1_sel:WORD_1
    s_waitcnt vmcnt(11)
    v_mfma_f32_4x4x4_16b_bf16 v[96:99], v[144:145], v[72:73], 0 cbsz:4 abid:0
    s_nop 0
    v_mfma_f32_4x4x4_16b_bf16 v[100:103], v[144:145], v[74:75], 0 cbsz:4 abid:0
    v_lshlrev_b32_sdwa v139, v15, v119 dst_sel:DWORD dst_unused:UNUSED_PAD src0_sel:DWORD src1_sel:WORD_1
    ds_read_u16_d16_hi v134, v138 offset:32768
    ds_read_u16_d16_hi v135, v139 offset:32768
    s_set_gpr_idx_on s49, 0xc
    v_pk_fma_f32 v[16:17], v[128:129], v[104:105], v[16:17] op_sel:[1,0,0] op_sel_hi:[1,1,1]
    v_pk_fma_f32 v[18:19], v[128:129], v[106:107], v[18:19] op_sel:[1,0,0] op_sel_hi:[1,1,1]
    v_pk_fma_f32 v[20:21], v[130:131], v[108:109], v[20:21] op_sel:[1,0,0] op_sel_hi:[1,1,1]
    v_pk_fma_f32 v[22:23], v[130:131], v[110:111], v[22:23] op_sel:[1,0,0] op_sel_hi:[1,1,1]
    s_set_gpr_idx_off
    s_sub_u32 s32, s32, 1
    s_cbranch_scc1 MAIN_DONE
    v_mfma_f32_4x4x4_16b_bf16 v[112:115], v[172:173], v[176:177], 0 cbsz:4 abid:2
    v_lshlrev_b32_sdwa v136, v15, v120 dst_sel:DWORD dst_unused:UNUSED_PAD src0_sel:DWORD src1_sel:WORD_1
    s_waitcnt vmcnt(10)
    v_mfma_f32_4x4x4_16b_bf16 v[104:107], v[146:147], v[76:77], 0 cbsz:4 abid:0
    s_nop 0
    v_mfma_f32_4x4x4_16b_bf16 v[108:111], v[146:147], v[78:79], 0 cbsz:4 abid:0
    v_lshlrev_b32_sdwa v137, v15, v121 dst_sel:DWORD dst_unused:UNUSED_PAD src0_sel:DWORD src1_sel:WORD_1
    ds_read_u16_d16_hi v128, v136 offset:32768
    ds_read_u16_d16_hi v129, v137 offset:32768
    s_waitcnt lgkmcnt(2)
    s_set_gpr_idx_on s50, 0xc
    v_pk_fma_f32 v[16:17], v[132:133], v[96:97], v[16:17] op_sel:[0,0,0] op_sel_hi:[0,1,1]
    v_pk_fma_f32 v[18:19], v[132:133], v[98:99], v[18:19] op_sel:[0,0,0] op_sel_hi:[0,1,1]
    v_pk_fma_f32 v[20:21], v[134:135], v[100:101], v[20:21] op_sel:[0,0,0] op_sel_hi:[0,1,1]
    v_pk_fma_f32 v[22:23], v[134:135], v[102:103], v[22:23] op_sel:[0,0,0] op_sel_hi:[0,1,1]
    s_set_gpr_idx_off
    s_sub_u32 s32, s32, 1
    s_cbranch_scc1 MAIN_DONE
    v_lshlrev_b32_sdwa v138, v15, v124 dst_sel:DWORD dst_unused:UNUSED_PAD src0_sel:DWORD src1_sel:WORD_1
    s_waitcnt vmcnt(9)
    v_mfma_f32_4x4x4_16b_bf16 v[96:99], v[140:141], v[80:81], 0 cbsz:4 abid:1
    s_nop 0
    v_mfma_f32_4x4x4_16b_bf16 v[100:103], v[140:141], v[82:83], 0 cbsz:4 abid:1
    v_lshlrev_b32_sdwa v139, v15, v125 dst_sel:DWORD dst_unused:UNUSED_PAD src0_sel:DWORD src1_sel:WORD_1
    ds_read_u16_d16_hi v130, v138 offset:32768
    ds_read_u16_d16_hi v131, v139 offset:32768
    s_set_gpr_idx_on s51, 0xc
    v_pk_fma_f32 v[16:17], v[132:133], v[104:105], v[16:17] op_sel:[1,0,0] op_sel_hi:[1,1,1]
    v_pk_fma_f32 v[18:19], v[132:133], v[106:107], v[18:19] op_sel:[1,0,0] op_sel_hi:[1,1,1]
    v_pk_fma_f32 v[20:21], v[134:135], v[108:109], v[20:21] op_sel:[1,0,0] op_sel_hi:[1,1,1]
    v_pk_fma_f32 v[22:23], v[134:135], v[110:111], v[22:23] op_sel:[1,0,0] op_sel_hi:[1,1,1]
    s_set_gpr_idx_off
    s_sub_u32 s32, s32, 1
    s_cbranch_scc1 MAIN_DONE
    v_mfma_f32_4x4x4_16b_bf16 v[116:119], v[172:173], v[178:179], 0 cbsz:4 abid:2
    v_lshlrev_b32_sdwa v136, v15, v122 dst_sel:DWORD dst_unused:UNUSED_PAD src0_sel:DWORD src1_sel:WORD_1
    s_waitcnt vmcnt(8)
    v_mfma_f32_4x4x4_16b_bf16 v[104:107], v[142:143], v[84:85], 0 cbsz:4 abid:1
    s_nop 0
    v_mfma_f32_4x4x4_16b_bf16 v[108:111], v[142:143], v[86:87], 0 cbsz:4 abid:1
    v_lshlrev_b32_sdwa v137, v15, v123 dst_sel:DWORD dst_unused:UNUSED_PAD src0_sel:DWORD src1_sel:WORD_1
    ds_read_u16_d16_hi v132, v136 offset:32768
    ds_read_u16_d16_hi v133, v137 offset:32768
    s_waitcnt lgkmcnt(2)
    s_set_gpr_idx_on s52, 0xc
    v_pk_fma_f32 v[16:17], v[128:129], v[96:97], v[16:17] op_sel:[0,0,0] op_sel_hi:[0,1,1]
    v_pk_fma_f32 v[18:19], v[128:129], v[98:99], v[18:19] op_sel:[0,0,0] op_sel_hi:[0,1,1]
    v_pk_fma_f32 v[20:21], v[130:131], v[100:101], v[20:21] op_sel:[0,0,0] op_sel_hi:[0,1,1]
    v_pk_fma_f32 v[22:23], v[130:131], v[102:103], v[22:23] op_sel:[0,0,0] op_sel_hi:[0,1,1]
    s_set_gpr_idx_off
    s_sub_u32 s32, s32, 1
    s_cbranch_scc1 MAIN_DONE
    v_lshlrev_b32_sdwa v138, v15, v126 dst_sel:DWORD dst_unused:UNUSED_PAD src0_sel:DWORD src1_sel:WORD_1
    v_mfma_f32_4x4x4_16b_bf16 v[96:99], v[144:145], v[88:89], 0 cbsz:4 abid:1
    s_nop 0
    v_mfma_f32_4x4x4_16b_bf16 v[100:103], v[144:145], v[90:91], 0 cbsz:4 abid:1
    v_lshlrev_b32_sdwa v139, v15, v127 dst_sel:DWORD dst_unused:UNUSED_PAD src0_sel:DWORD src1_sel:WORD_1
    ds_read_u16_d16_hi v134, v138 offset:32768
    ds_read_u16_d16_hi v135, v139 offset:32768
    s_set_gpr_idx_on s53, 0xc
    v_pk_fma_f32 v[16:17], v[128:129], v[104:105], v[16:17] op_sel:[1,0,0] op_sel_hi:[1,1,1]
    v_pk_fma_f32 v[18:19], v[128:129], v[106:107], v[18:19] op_sel:[1,0,0] op_sel_hi:[1,1,1]
    v_pk_fma_f32 v[20:21], v[130:131], v[108:109], v[20:21] op_sel:[1,0,0] op_sel_hi:[1,1,1]
    v_pk_fma_f32 v[22:23], v[130:131], v[110:111], v[22:23] op_sel:[1,0,0] op_sel_hi:[1,1,1]
    s_set_gpr_idx_off
    s_branch MAIN_DONE
B_4:
    buffer_load_dwordx4 v[188:191], v1, s[16:19], s10 offen offset:0 sc1
    buffer_load_dwordx4 v[192:195], v1, s[16:19], s10 offen offset:1024 sc1
    buffer_load_dwordx4 v[196:199], v1, s[16:19], s10 offen offset:2048 sc1
    buffer_load_dwordx4 v[200:203], v1, s[16:19], s10 offen offset:3072 sc1
    buffer_load_dwordx4 v[204:207], v1, s[16:19], s11 offen offset:0 sc1
    buffer_load_dwordx4 v[208:211], v1, s[16:19], s11 offen offset:1024 sc1
    buffer_load_dwordx4 v[212:215], v1, s[16:19], s11 offen offset:2048 sc1
    buffer_load_dwordx4 v[216:219], v1, s[16:19], s11 offen offset:3072 sc1
    s_sub_u32 s32, s32, 1
    s_cbranch_scc1 MAIN_DONE
    v_mfma_f32_4x4x4_16b_bf16 v[116:119], v[172:173], v[178:179], 0 cbsz:4 abid:2
    v_lshlrev_b32_sdwa v136, v15, v122 dst_sel:DWORD dst_unused:UNUSED_PAD src0_sel:DWORD src1_sel:WORD_1
    s_waitcnt vmcnt(12)
    v_mfma_f32_4x4x4_16b_bf16 v[104:107], v[142:143], v[84:85], 0 cbsz:4 abid:1
    s_nop 0
    v_mfma_f32_4x4x4_16b_bf16 v[108:111], v[142:143], v[86:87], 0 cbsz:4 abid:1
    v_lshlrev_b32_sdwa v137, v15, v123 dst_sel:DWORD dst_unused:UNUSED_PAD src0_sel:DWORD src1_sel:WORD_1
    ds_read_u16_d16_hi v132, v136 offset:32768
    ds_read_u16_d16_hi v133, v137 offset:32768
    s_waitcnt lgkmcnt(2)
    s_set_gpr_idx_on s52, 0xc
    v_pk_fma_f32 v[16:17], v[128:129], v[96:97], v[16:17] op_sel:[0,0,0] op_sel_hi:[0,1,1]
    v_pk_fma_f32 v[18:19], v[128:129], v[98:99], v[18:19] op_sel:[0,0,0] op_sel_hi:[0,1,1]
    v_pk_fma_f32 v[20:21], v[130:131], v[100:101], v[20:21] op_sel:[0,0,0] op_sel_hi:[0,1,1]
    v_pk_fma_f32 v[22:23], v[130:131], v[102:103], v[22:23] op_sel:[0,0,0] op_sel_hi:[0,1,1]
    s_set_gpr_idx_off
    s_sub_u32 s32, s32, 1
    s_cbranch_scc1 MAIN_DONE
    v_lshlrev_b32_sdwa v138, v15, v126 dst_sel:DWORD dst_unused:UNUSED_PAD src0_sel:DWORD src1_sel:WORD_1
    s_waitcnt vmcnt(11)
    v_mfma_f32_4x4x4_16b_bf16 v[96:99], v[144:145], v[88:89], 0 cbsz:4 abid:1
    s_nop 0
    v_mfma_f32_4x4x4_16b_bf16 v[100:103], v[144:145], v[90:91], 0 cbsz:4 abid:1
    v_lshlrev_b32_sdwa v139, v15, v127 dst_sel:DWORD dst_unused:UNUSED_PAD src0_sel:DWORD src1_sel:WORD_1
    ds_read_u16_d16_hi v134, v138 offset:32768
    ds_read_u16_d16_hi v135, v139 offset:32768
    s_set_gpr_idx_on s53, 0xc
    v_pk_fma_f32 v[16:17], v[128:129], v[104:105], v[16:17] op_sel:[1,0,0] op_sel_hi:[1,1,1]
    v_pk_fma_f32 v[18:19], v[128:129], v[106:107], v[18:19] op_sel:[1,0,0] op_sel_hi:[1,1,1]
    v_pk_fma_f32 v[20:21], v[130:131], v[108:109], v[20:21] op_sel:[1,0,0] op_sel_hi:[1,1,1]
    v_pk_fma_f32 v[22:23], v[130:131], v[110:111], v[22:23] op_sel:[1,0,0] op_sel_hi:[1,1,1]
    s_set_gpr_idx_off
    s_sub_u32 s32, s32, 1
    s_cbranch_scc1 MAIN_DONE
    v_mfma_f32_4x4x4_16b_bf16 v[120:123], v[172:173], v[176:177], 0 cbsz:4 abid:3
    v_lshlrev_b32_sdwa v136, v15, v112 dst_sel:DWORD dst_unused:UNUSED_PAD src0_sel:DWORD src1_sel:WORD_1
    s_waitcnt vmcnt(10)
    v_mfma_f32_4x4x4_16b_bf16 v[104:107], v[146:147], v[92:93], 0 cbsz:4 abid:1
    s_nop 0
    v_mfma_f32_4x4x4_16b_bf16 v[108:111], v[146:147], v[94:95], 0 cbsz:4 abid:1
    v_lshlrev_b32_sdwa v137, v15, v113 dst_sel:DWORD dst_unused:UNUSED_PAD src0_sel:DWORD src1_sel:WORD_1
    ds_read_u16_d16_hi v128, v136 offset:32768
    ds_read_u16_d16_hi v129, v137 offset:32768
    s_waitcnt lgkmcnt(2)
    s_set_gpr_idx_on s54, 0xc
    v_pk_fma_f32 v[16:17], v[132:133], v[96:97], v[16:17] op_sel:[0,0,0] op_sel_hi:[0,1,1]
    v_pk_fma_f32 v[18:19], v[132:133], v[98:99], v[18:19] op_sel:[0,0,0] op_sel_hi:[0,1,1]
    v_pk_fma_f32 v[20:21], v[134:135], v[100:101], v[20:21] op_sel:[0,0,0] op_sel_hi:[0,1,1]
    v_pk_fma_f32 v[22:23], v[134:135], v[102:103], v[22:23] op_sel:[0,0,0] op_sel_hi:[0,1,1]
    s_set_gpr_idx_off
    s_sub_u32 s32, s32, 1
    s_cbranch_scc1 MAIN_DONE
    v_lshlrev_b32_sdwa v138, v15, v116 dst_sel:DWORD dst_unused:UNUSED_PAD src0_sel:DWORD src1_sel:WORD_1
    s_waitcnt vmcnt(9)
    v_mfma_f32_4x4x4_16b_bf16 v[96:99], v[140:141], v[64:65], 0 cbsz:4 abid:2
    s_nop 0
    v_mfma_f32_4x4x4_16b_bf16 v[100:103], v[140:141], v[66:67], 0 cbsz:4 abid:2
    v_lshlrev_b32_sdwa v139, v15, v117 dst_sel:DWORD dst_unused:UNUSED_PAD src0_sel:DWORD src1_sel:WORD_1
    ds_read_u16_d16_hi v130, v138 offset:32768
    ds_read_u16_d16_hi v131, v139 offset:32768
    s_set_gpr_idx_on s55, 0xc
    v_pk_fma_f32 v[16:17], v[132:133], v[104:105], v[16:17] op_sel:[1,0,0] op_sel_hi:[1,1,1]
    v_pk_fma_f32 v[18:19], v[132:133], v[106:107], v[18:19] op_sel:[1,0,0] op_sel_hi:[1,1,1]
    v_pk_fma_f32 v[20:21], v[134:135], v[108:109], v[20:21] op_sel:[1,0,0] op_sel_hi:[1,1,1]
    v_pk_fma_f32 v[22:23], v[134:135], v[110:111], v[22:23] op_sel:[1,0,0] op_sel_hi:[1,1,1]
    s_set_gpr_idx_off
    s_sub_u32 s32, s32, 1
    s_cbranch_scc1 MAIN_DONE
    v_mfma_f32_4x4x4_16b_bf16 v[124:127], v[172:173], v[178:179], 0 cbsz:4 abid:3
    v_lshlrev_b32_sdwa v136, v15, v114 dst_sel:DWORD dst_unused:UNUSED_PAD src0_sel:DWORD src1_sel:WORD_1
    s_waitcnt vmcnt(8)
    v_mfma_f32_4x4x4_16b_bf16 v[104:107], v[142:143], v[68:69], 0 cbsz:4 abid:2
    s_nop 0
    v_mfma_f32_4x4x4_16b_bf16 v[108:111], v[142:143], v[70:71], 0 cbsz:4 abid:2
    v_lshlrev_b32_sdwa v137, v15, v115 dst_sel:DWORD dst_unused:UNUSED_PAD src0_sel:DWORD src1_sel:WORD_1
    ds_read_u16_d16_hi v132, v136 offset:32768
    ds_read_u16_d16_hi v133, v137 offset:32768
    s_waitcnt lgkmcnt(2)
    s_set_gpr_idx_on s56, 0xc
    v_pk_fma_f32 v[16:17], v[128:129], v[96:97], v[16:17] op_sel:[0,0,0] op_sel_hi:[0,1,1]
    v_pk_fma_f32 v[18:19], v[128:129], v[98:99], v[18:19] op_sel:[0,0,0] op_sel_hi:[0,1,1]
    v_pk_fma_f32 v[20:21], v[130:131], v[100:101], v[20:21] op_sel:[0,0,0] op_sel_hi:[0,1,1]
    v_pk_fma_f32 v[22:23], v[130:131], v[102:103], v[22:23] op_sel:[0,0,0] op_sel_hi:[0,1,1]
    s_set_gpr_idx_off
    s_sub_u32 s32, s32, 1
    s_cbranch_scc1 MAIN_DONE
    v_lshlrev_b32_sdwa v138, v15, v118 dst_sel:DWORD dst_unused:UNUSED_PAD src0_sel:DWORD src1_sel:WORD_1
    v_mfma_f32_4x4x4_16b_bf16 v[96:99], v[144:145], v[72:73], 0 cbsz:4 abid:2
    s_nop 0
    v_mfma_f32_4x4x4_16b_bf16 v[100:103], v[144:145], v[74:75], 0 cbsz:4 abid:2
    v_lshlrev_b32_sdwa v139, v15, v119 dst_sel:DWORD dst_unused:UNUSED_PAD src0_sel:DWORD src1_sel:WORD_1
    ds_read_u16_d16_hi v134, v138 offset:32768
    ds_read_u16_d16_hi v135, v139 offset:32768
    s_set_gpr_idx_on s57, 0xc
    v_pk_fma_f32 v[16:17], v[128:129], v[104:105], v[16:17] op_sel:[1,0,0] op_sel_hi:[1,1,1]
    v_pk_fma_f32 v[18:19], v[128:129], v[106:107], v[18:19] op_sel:[1,0,0] op_sel_hi:[1,1,1]
    v_pk_fma_f32 v[20:21], v[130:131], v[108:109], v[20:21] op_sel:[1,0,0] op_sel_hi:[1,1,1]
    v_pk_fma_f32 v[22:23], v[130:131], v[110:111], v[22:23] op_sel:[1,0,0] op_sel_hi:[1,1,1]
    s_set_gpr_idx_off
    s_branch MAIN_DONE
B_8:
    buffer_load_dwordx4 v[188:191], v1, s[16:19], s10 offen offset:0 sc1
    buffer_load_dwordx4 v[192:195], v1, s[16:19], s10 offen offset:1024 sc1
    buffer_load_dwordx4 v[196:199], v1, s[16:19], s10 offen offset:2048 sc1
    buffer_load_dwordx4 v[200:203], v1, s[16:19], s10 offen offset:3072 sc1
    buffer_load_dwordx4 v[204:207], v1, s[16:19], s11 offen offset:0 sc1
    buffer_load_dwordx4 v[208:211], v1, s[16:19], s11 offen offset:1024 sc1
    buffer_load_dwordx4 v[212:215], v1, s[16:19], s11 offen offset:2048 sc1
    buffer_load_dwordx4 v[216:219], v1, s[16:19], s11 offen offset:3072 sc1
    s_sub_u32 s32, s32, 1
    s_cbranch_scc1 MAIN_DONE
    v_mfma_f32_4x4x4_16b_bf16 v[124:127], v[172:173], v[178:179], 0 cbsz:4 abid:3
    v_lshlrev_b32_sdwa v136, v15, v114 dst_sel:DWORD dst_unused:UNUSED_PAD src0_sel:DWORD src1_sel:WORD_1
    s_waitcnt vmcnt(12)
    v_mfma_f32_4x4x4_16b_bf16 v[104:107], v[142:143], v[68:69], 0 cbsz:4 abid:2
    s_nop 0
    v_mfma_f32_4x4x4_16b_bf16 v[108:111], v[142:143], v[70:71], 0 cbsz:4 abid:2
    v_lshlrev_b32_sdwa v137, v15, v115 dst_sel:DWORD dst_unused:UNUSED_PAD src0_sel:DWORD src1_sel:WORD_1
    ds_read_u16_d16_hi v132, v136 offset:32768
    ds_read_u16_d16_hi v133, v137 offset:32768
    s_waitcnt lgkmcnt(2)
    s_set_gpr_idx_on s56, 0xc
    v_pk_fma_f32 v[16:17], v[128:129], v[96:97], v[16:17] op_sel:[0,0,0] op_sel_hi:[0,1,1]
    v_pk_fma_f32 v[18:19], v[128:129], v[98:99], v[18:19] op_sel:[0,0,0] op_sel_hi:[0,1,1]
    v_pk_fma_f32 v[20:21], v[130:131], v[100:101], v[20:21] op_sel:[0,0,0] op_sel_hi:[0,1,1]
    v_pk_fma_f32 v[22:23], v[130:131], v[102:103], v[22:23] op_sel:[0,0,0] op_sel_hi:[0,1,1]
    s_set_gpr_idx_off
    s_sub_u32 s32, s32, 1
    s_cbranch_scc1 MAIN_DONE
    v_lshlrev_b32_sdwa v138, v15, v118 dst_sel:DWORD dst_unused:UNUSED_PAD src0_sel:DWORD src1_sel:WORD_1
    s_waitcnt vmcnt(11)
    v_mfma_f32_4x4x4_16b_bf16 v[96:99], v[144:145], v[72:73], 0 cbsz:4 abid:2
    s_nop 0
    v_mfma_f32_4x4x4_16b_bf16 v[100:103], v[144:145], v[74:75], 0 cbsz:4 abid:2
    v_lshlrev_b32_sdwa v139, v15, v119 dst_sel:DWORD dst_unused:UNUSED_PAD src0_sel:DWORD src1_sel:WORD_1
    ds_read_u16_d16_hi v134, v138 offset:32768
    ds_read_u16_d16_hi v135, v139 offset:32768
    s_set_gpr_idx_on s57, 0xc
    v_pk_fma_f32 v[16:17], v[128:129], v[104:105], v[16:17] op_sel:[1,0,0] op_sel_hi:[1,1,1]
    v_pk_fma_f32 v[18:19], v[128:129], v[106:107], v[18:19] op_sel:[1,0,0] op_sel_hi:[1,1,1]
    v_pk_fma_f32 v[20:21], v[130:131], v[108:109], v[20:21] op_sel:[1,0,0] op_sel_hi:[1,1,1]
    v_pk_fma_f32 v[22:23], v[130:131], v[110:111], v[22:23] op_sel:[1,0,0] op_sel_hi:[1,1,1]
    s_set_gpr_idx_off
    s_sub_u32 s32, s32, 1
    s_cbranch_scc1 MAIN_DONE
    v_mfma_f32_4x4x4_16b_bf16 v[112:115], v[172:173], v[176:177], 0 cbsz:4 abid:4
    v_lshlrev_b32_sdwa v136, v15, v120 dst_sel:DWORD dst_unused:UNUSED_PAD src0_sel:DWORD src1_sel:WORD_1
    s_waitcnt vmcnt(10)
    v_mfma_f32_4x4x4_16b_bf16 v[104:107], v[146:147], v[76:77], 0 cbsz:4 abid:2
    s_nop 0
    v_mfma_f32_4x4x4_16b_bf16 v[108:111], v[146:147], v[78:79], 0 cbsz:4 abid:2
    v_lshlrev_b32_sdwa v137, v15, v121 dst_sel:DWORD dst_unused:UNUSED_PAD src0_sel:DWORD src1_sel:WORD_1
    ds_read_u16_d16_hi v128, v136 offset:32768
    ds_read_u16_d16_hi v129, v137 offset:32768
    s_waitcnt lgkmcnt(2)
    s_set_gpr_idx_on s58, 0xc
    v_pk_fma_f32 v[16:17], v[132:133], v[96:97], v[16:17] op_sel:[0,0,0] op_sel_hi:[0,1,1]
    v_pk_fma_f32 v[18:19], v[132:133], v[98:99], v[18:19] op_sel:[0,0,0] op_sel_hi:[0,1,1]
    v_pk_fma_f32 v[20:21], v[134:135], v[100:101], v[20:21] op_sel:[0,0,0] op_sel_hi:[0,1,1]
    v_pk_fma_f32 v[22:23], v[134:135], v[102:103], v[22:23] op_sel:[0,0,0] op_sel_hi:[0,1,1]
    s_set_gpr_idx_off
    s_sub_u32 s32, s32, 1
    s_cbranch_scc1 MAIN_DONE
    v_lshlrev_b32_sdwa v138, v15, v124 dst_sel:DWORD dst_unused:UNUSED_PAD src0_sel:DWORD src1_sel:WORD_1
    s_waitcnt vmcnt(9)
    v_mfma_f32_4x4x4_16b_bf16 v[96:99], v[140:141], v[80:81], 0 cbsz:4 abid:3
    s_nop 0
    v_mfma_f32_4x4x4_16b_bf16 v[100:103], v[140:141], v[82:83], 0 cbsz:4 abid:3
    v_lshlrev_b32_sdwa v139, v15, v125 dst_sel:DWORD dst_unused:UNUSED_PAD src0_sel:DWORD src1_sel:WORD_1
    ds_read_u16_d16_hi v130, v138 offset:32768
    ds_read_u16_d16_hi v131, v139 offset:32768
    s_set_gpr_idx_on s59, 0xc
    v_pk_fma_f32 v[16:17], v[132:133], v[104:105], v[16:17] op_sel:[1,0,0] op_sel_hi:[1,1,1]
    v_pk_fma_f32 v[18:19], v[132:133], v[106:107], v[18:19] op_sel:[1,0,0] op_sel_hi:[1,1,1]
    v_pk_fma_f32 v[20:21], v[134:135], v[108:109], v[20:21] op_sel:[1,0,0] op_sel_hi:[1,1,1]
    v_pk_fma_f32 v[22:23], v[134:135], v[110:111], v[22:23] op_sel:[1,0,0] op_sel_hi:[1,1,1]
    s_set_gpr_idx_off
    s_sub_u32 s32, s32, 1
    s_cbranch_scc1 MAIN_DONE
    v_mfma_f32_4x4x4_16b_bf16 v[116:119], v[172:173], v[178:179], 0 cbsz:4 abid:4
    v_lshlrev_b32_sdwa v136, v15, v122 dst_sel:DWORD dst_unused:UNUSED_PAD src0_sel:DWORD src1_sel:WORD_1
    s_waitcnt vmcnt(8)
    v_mfma_f32_4x4x4_16b_bf16 v[104:107], v[142:143], v[84:85], 0 cbsz:4 abid:3
    s_nop 0
    v_mfma_f32_4x4x4_16b_bf16 v[108:111], v[142:143], v[86:87], 0 cbsz:4 abid:3
    v_lshlrev_b32_sdwa v137, v15, v123 dst_sel:DWORD dst_unused:UNUSED_PAD src0_sel:DWORD src1_sel:WORD_1
    ds_read_u16_d16_hi v132, v136 offset:32768
    ds_read_u16_d16_hi v133, v137 offset:32768
    s_waitcnt lgkmcnt(2)
    s_set_gpr_idx_on s60, 0xc
    v_pk_fma_f32 v[16:17], v[128:129], v[96:97], v[16:17] op_sel:[0,0,0] op_sel_hi:[0,1,1]
    v_pk_fma_f32 v[18:19], v[128:129], v[98:99], v[18:19] op_sel:[0,0,0] op_sel_hi:[0,1,1]
    v_pk_fma_f32 v[20:21], v[130:131], v[100:101], v[20:21] op_sel:[0,0,0] op_sel_hi:[0,1,1]
    v_pk_fma_f32 v[22:23], v[130:131], v[102:103], v[22:23] op_sel:[0,0,0] op_sel_hi:[0,1,1]
    s_set_gpr_idx_off
    s_sub_u32 s32, s32, 1
    s_cbranch_scc1 MAIN_DONE
    v_lshlrev_b32_sdwa v138, v15, v126 dst_sel:DWORD dst_unused:UNUSED_PAD src0_sel:DWORD src1_sel:WORD_1
    v_mfma_f32_4x4x4_16b_bf16 v[96:99], v[144:145], v[88:89], 0 cbsz:4 abid:3
    s_nop 0
    v_mfma_f32_4x4x4_16b_bf16 v[100:103], v[144:145], v[90:91], 0 cbsz:4 abid:3
    v_lshlrev_b32_sdwa v139, v15, v127 dst_sel:DWORD dst_unused:UNUSED_PAD src0_sel:DWORD src1_sel:WORD_1
    ds_read_u16_d16_hi v134, v138 offset:32768
    ds_read_u16_d16_hi v135, v139 offset:32768
    s_set_gpr_idx_on s61, 0xc
    v_pk_fma_f32 v[16:17], v[128:129], v[104:105], v[16:17] op_sel:[1,0,0] op_sel_hi:[1,1,1]
    v_pk_fma_f32 v[18:19], v[128:129], v[106:107], v[18:19] op_sel:[1,0,0] op_sel_hi:[1,1,1]
    v_pk_fma_f32 v[20:21], v[130:131], v[108:109], v[20:21] op_sel:[1,0,0] op_sel_hi:[1,1,1]
    v_pk_fma_f32 v[22:23], v[130:131], v[110:111], v[22:23] op_sel:[1,0,0] op_sel_hi:[1,1,1]
    s_set_gpr_idx_off
    s_branch MAIN_DONE
B_12:
    buffer_load_dwordx4 v[188:191], v1, s[16:19], s10 offen offset:0 sc1
    buffer_load_dwordx4 v[192:195], v1, s[16:19], s10 offen offset:1024 sc1
    buffer_load_dwordx4 v[196:199], v1, s[16:19], s10 offen offset:2048 sc1
    buffer_load_dwordx4 v[200:203], v1, s[16:19], s10 offen offset:3072 sc1
    buffer_load_dwordx4 v[204:207], v1, s[16:19], s11 offen offset:0 sc1
    buffer_load_dwordx4 v[208:211], v1, s[16:19], s11 offen offset:1024 sc1
    buffer_load_dwordx4 v[212:215], v1, s[16:19], s11 offen offset:2048 sc1
    buffer_load_dwordx4 v[216:219], v1, s[16:19], s11 offen offset:3072 sc1
    s_sub_u32 s32, s32, 1
    s_cbranch_scc1 MAIN_DONE
    v_mfma_f32_4x4x4_16b_bf16 v[116:119], v[172:173], v[178:179], 0 cbsz:4 abid:4
    v_lshlrev_b32_sdwa v136, v15, v122 dst_sel:DWORD dst_unused:UNUSED_PAD src0_sel:DWORD src1_sel:WORD_1
    s_waitcnt vmcnt(12)
    v_mfma_f32_4x4x4_16b_bf16 v[104:107], v[142:143], v[84:85], 0 cbsz:4 abid:3
    s_nop 0
    v_mfma_f32_4x4x4_16b_bf16 v[108:111], v[142:143], v[86:87], 0 cbsz:4 abid:3
    v_lshlrev_b32_sdwa v137, v15, v123 dst_sel:DWORD dst_unused:UNUSED_PAD src0_sel:DWORD src1_sel:WORD_1
    ds_read_u16_d16_hi v132, v136 offset:32768
    ds_read_u16_d16_hi v133, v137 offset:32768
    s_waitcnt lgkmcnt(2)
    s_set_gpr_idx_on s60, 0xc
    v_pk_fma_f32 v[16:17], v[128:129], v[96:97], v[16:17] op_sel:[0,0,0] op_sel_hi:[0,1,1]
    v_pk_fma_f32 v[18:19], v[128:129], v[98:99], v[18:19] op_sel:[0,0,0] op_sel_hi:[0,1,1]
    v_pk_fma_f32 v[20:21], v[130:131], v[100:101], v[20:21] op_sel:[0,0,0] op_sel_hi:[0,1,1]
    v_pk_fma_f32 v[22:23], v[130:131], v[102:103], v[22:23] op_sel:[0,0,0] op_sel_hi:[0,1,1]
    s_set_gpr_idx_off
    s_sub_u32 s32, s32, 1
    s_cbranch_scc1 MAIN_DONE
    v_lshlrev_b32_sdwa v138, v15, v126 dst_sel:DWORD dst_unused:UNUSED_PAD src0_sel:DWORD src1_sel:WORD_1
    s_waitcnt vmcnt(11)
    v_mfma_f32_4x4x4_16b_bf16 v[96:99], v[144:145], v[88:89], 0 cbsz:4 abid:3
    s_nop 0
    v_mfma_f32_4x4x4_16b_bf16 v[100:103], v[144:145], v[90:91], 0 cbsz:4 abid:3
    v_lshlrev_b32_sdwa v139, v15, v127 dst_sel:DWORD dst_unused:UNUSED_PAD src0_sel:DWORD src1_sel:WORD_1
    ds_read_u16_d16_hi v134, v138 offset:32768
    ds_read_u16_d16_hi v135, v139 offset:32768
    s_set_gpr_idx_on s61, 0xc
    v_pk_fma_f32 v[16:17], v[128:129], v[104:105], v[16:17] op_sel:[1,0,0] op_sel_hi:[1,1,1]
    v_pk_fma_f32 v[18:19], v[128:129], v[106:107], v[18:19] op_sel:[1,0,0] op_sel_hi:[1,1,1]
    v_pk_fma_f32 v[20:21], v[130:131], v[108:109], v[20:21] op_sel:[1,0,0] op_sel_hi:[1,1,1]
    v_pk_fma_f32 v[22:23], v[130:131], v[110:111], v[22:23] op_sel:[1,0,0] op_sel_hi:[1,1,1]
    s_set_gpr_idx_off
    s_sub_u32 s32, s32, 1
    s_cbranch_scc1 MAIN_DONE
    v_mfma_f32_4x4x4_16b_bf16 v[120:123], v[172:173], v[176:177], 0 cbsz:4 abid:5
    v_lshlrev_b32_sdwa v136, v15, v112 dst_sel:DWORD dst_unused:UNUSED_PAD src0_sel:DWORD src1_sel:WORD_1
    s_waitcnt vmcnt(10)
    v_mfma_f32_4x4x4_16b_bf16 v[104:107], v[146:147], v[92:93], 0 cbsz:4 abid:3
    s_nop 0
    v_mfma_f32_4x4x4_16b_bf16 v[108:111], v[146:147], v[94:95], 0 cbsz:4 abid:3
    v_lshlrev_b32_sdwa v137, v15, v113 dst_sel:DWORD dst_unused:UNUSED_PAD src0_sel:DWORD src1_sel:WORD_1
    ds_read_u16_d16_hi v128, v136 offset:32768
    ds_read_u16_d16_hi v129, v137 offset:32768
    s_waitcnt lgkmcnt(2)
    s_set_gpr_idx_on s62, 0xc
    v_pk_fma_f32 v[16:17], v[132:133], v[96:97], v[16:17] op_sel:[0,0,0] op_sel_hi:[0,1,1]
    v_pk_fma_f32 v[18:19], v[132:133], v[98:99], v[18:19] op_sel:[0,0,0] op_sel_hi:[0,1,1]
    v_pk_fma_f32 v[20:21], v[134:135], v[100:101], v[20:21] op_sel:[0,0,0] op_sel_hi:[0,1,1]
    v_pk_fma_f32 v[22:23], v[134:135], v[102:103], v[22:23] op_sel:[0,0,0] op_sel_hi:[0,1,1]
    s_set_gpr_idx_off
    s_sub_u32 s32, s32, 1
    s_cbranch_scc1 MAIN_DONE
    v_lshlrev_b32_sdwa v138, v15, v116 dst_sel:DWORD dst_unused:UNUSED_PAD src0_sel:DWORD src1_sel:WORD_1
    s_waitcnt vmcnt(9)
    v_mfma_f32_4x4x4_16b_bf16 v[96:99], v[140:141], v[64:65], 0 cbsz:4 abid:4
    s_nop 0
    v_mfma_f32_4x4x4_16b_bf16 v[100:103], v[140:141], v[66:67], 0 cbsz:4 abid:4
    v_lshlrev_b32_sdwa v139, v15, v117 dst_sel:DWORD dst_unused:UNUSED_PAD src0_sel:DWORD src1_sel:WORD_1
    ds_read_u16_d16_hi v130, v138 offset:32768
    ds_read_u16_d16_hi v131, v139 offset:32768
    s_set_gpr_idx_on s63, 0xc
    v_pk_fma_f32 v[16:17], v[132:133], v[104:105], v[16:17] op_sel:[1,0,0] op_sel_hi:[1,1,1]
    v_pk_fma_f32 v[18:19], v[132:133], v[106:107], v[18:19] op_sel:[1,0,0] op_sel_hi:[1,1,1]
    v_pk_fma_f32 v[20:21], v[134:135], v[108:109], v[20:21] op_sel:[1,0,0] op_sel_hi:[1,1,1]
    v_pk_fma_f32 v[22:23], v[134:135], v[110:111], v[22:23] op_sel:[1,0,0] op_sel_hi:[1,1,1]
    s_set_gpr_idx_off
    s_sub_u32 s32, s32, 1
    s_cbranch_scc1 MAIN_DONE
    v_mfma_f32_4x4x4_16b_bf16 v[124:127], v[172:173], v[178:179], 0 cbsz:4 abid:5
    v_lshlrev_b32_sdwa v136, v15, v114 dst_sel:DWORD dst_unused:UNUSED_PAD src0_sel:DWORD src1_sel:WORD_1
    s_waitcnt vmcnt(8)
    v_mfma_f32_4x4x4_16b_bf16 v[104:107], v[142:143], v[68:69], 0 cbsz:4 abid:4
    s_nop 0
    v_mfma_f32_4x4x4_16b_bf16 v[108:111], v[142:143], v[70:71], 0 cbsz:4 abid:4
    v_lshlrev_b32_sdwa v137, v15, v115 dst_sel:DWORD dst_unused:UNUSED_PAD src0_sel:DWORD src1_sel:WORD_1
    ds_read_u16_d16_hi v132, v136 offset:32768
    ds_read_u16_d16_hi v133, v137 offset:32768
    s_waitcnt lgkmcnt(2)
    s_set_gpr_idx_on s48, 0xc
    v_pk_fma_f32 v[16:17], v[128:129], v[96:97], v[16:17] op_sel:[0,0,0] op_sel_hi:[0,1,1]
    v_pk_fma_f32 v[18:19], v[128:129], v[98:99], v[18:19] op_sel:[0,0,0] op_sel_hi:[0,1,1]
    v_pk_fma_f32 v[20:21], v[130:131], v[100:101], v[20:21] op_sel:[0,0,0] op_sel_hi:[0,1,1]
    v_pk_fma_f32 v[22:23], v[130:131], v[102:103], v[22:23] op_sel:[0,0,0] op_sel_hi:[0,1,1]
    s_set_gpr_idx_off
    s_sub_u32 s32, s32, 1
    s_cbranch_scc1 MAIN_DONE
    v_lshlrev_b32_sdwa v138, v15, v118 dst_sel:DWORD dst_unused:UNUSED_PAD src0_sel:DWORD src1_sel:WORD_1
    v_mfma_f32_4x4x4_16b_bf16 v[96:99], v[144:145], v[72:73], 0 cbsz:4 abid:4
    s_nop 0
    v_mfma_f32_4x4x4_16b_bf16 v[100:103], v[144:145], v[74:75], 0 cbsz:4 abid:4
    v_lshlrev_b32_sdwa v139, v15, v119 dst_sel:DWORD dst_unused:UNUSED_PAD src0_sel:DWORD src1_sel:WORD_1
    ds_read_u16_d16_hi v134, v138 offset:32768
    ds_read_u16_d16_hi v135, v139 offset:32768
    s_set_gpr_idx_on s49, 0xc
    v_pk_fma_f32 v[16:17], v[128:129], v[104:105], v[16:17] op_sel:[1,0,0] op_sel_hi:[1,1,1]
    v_pk_fma_f32 v[18:19], v[128:129], v[106:107], v[18:19] op_sel:[1,0,0] op_sel_hi:[1,1,1]
    v_pk_fma_f32 v[20:21], v[130:131], v[108:109], v[20:21] op_sel:[1,0,0] op_sel_hi:[1,1,1]
    v_pk_fma_f32 v[22:23], v[130:131], v[110:111], v[22:23] op_sel:[1,0,0] op_sel_hi:[1,1,1]
    s_set_gpr_idx_off
    s_branch MAIN_DONE
B_16:
    buffer_load_dwordx4 v[188:191], v1, s[16:19], s10 offen offset:0 sc1
    buffer_load_dwordx4 v[192:195], v1, s[16:19], s10 offen offset:1024 sc1
    buffer_load_dwordx4 v[196:199], v1, s[16:19], s10 offen offset:2048 sc1
    buffer_load_dwordx4 v[200:203], v1, s[16:19], s10 offen offset:3072 sc1
    buffer_load_dwordx4 v[204:207], v1, s[16:19], s11 offen offset:0 sc1
    buffer_load_dwordx4 v[208:211], v1, s[16:19], s11 offen offset:1024 sc1
    buffer_load_dwordx4 v[212:215], v1, s[16:19], s11 offen offset:2048 sc1
    buffer_load_dwordx4 v[216:219], v1, s[16:19], s11 offen offset:3072 sc1
    s_sub_u32 s32, s32, 1
    s_cbranch_scc1 MAIN_DONE
    v_mfma_f32_4x4x4_16b_bf16 v[124:127], v[172:173], v[178:179], 0 cbsz:4 abid:5
    v_lshlrev_b32_sdwa v136, v15, v114 dst_sel:DWORD dst_unused:UNUSED_PAD src0_sel:DWORD src1_sel:WORD_1
    s_waitcnt vmcnt(12)
    v_mfma_f32_4x4x4_16b_bf16 v[104:107], v[142:143], v[68:69], 0 cbsz:4 abid:4
    s_nop 0
    v_mfma_f32_4x4x4_16b_bf16 v[108:111], v[142:143], v[70:71], 0 cbsz:4 abid:4
    v_lshlrev_b32_sdwa v137, v15, v115 dst_sel:DWORD dst_unused:UNUSED_PAD src0_sel:DWORD src1_sel:WORD_1
    ds_read_u16_d16_hi v132, v136 offset:32768
    ds_read_u16_d16_hi v133, v137 offset:32768
    s_waitcnt lgkmcnt(2)
    s_set_gpr_idx_on s48, 0xc
    v_pk_fma_f32 v[16:17], v[128:129], v[96:97], v[16:17] op_sel:[0,0,0] op_sel_hi:[0,1,1]
    v_pk_fma_f32 v[18:19], v[128:129], v[98:99], v[18:19] op_sel:[0,0,0] op_sel_hi:[0,1,1]
    v_pk_fma_f32 v[20:21], v[130:131], v[100:101], v[20:21] op_sel:[0,0,0] op_sel_hi:[0,1,1]
    v_pk_fma_f32 v[22:23], v[130:131], v[102:103], v[22:23] op_sel:[0,0,0] op_sel_hi:[0,1,1]
    s_set_gpr_idx_off
    s_sub_u32 s32, s32, 1
    s_cbranch_scc1 MAIN_DONE
    v_lshlrev_b32_sdwa v138, v15, v118 dst_sel:DWORD dst_unused:UNUSED_PAD src0_sel:DWORD src1_sel:WORD_1
    s_waitcnt vmcnt(11)
    v_mfma_f32_4x4x4_16b_bf16 v[96:99], v[144:145], v[72:73], 0 cbsz:4 abid:4
    s_nop 0
    v_mfma_f32_4x4x4_16b_bf16 v[100:103], v[144:145], v[74:75], 0 cbsz:4 abid:4
    v_lshlrev_b32_sdwa v139, v15, v119 dst_sel:DWORD dst_unused:UNUSED_PAD src0_sel:DWORD src1_sel:WORD_1
    ds_read_u16_d16_hi v134, v138 offset:32768
    ds_read_u16_d16_hi v135, v139 offset:32768
    s_set_gpr_idx_on s49, 0xc
    v_pk_fma_f32 v[16:17], v[128:129], v[104:105], v[16:17] op_sel:[1,0,0] op_sel_hi:[1,1,1]
    v_pk_fma_f32 v[18:19], v[128:129], v[106:107], v[18:19] op_sel:[1,0,0] op_sel_hi:[1,1,1]
    v_pk_fma_f32 v[20:21], v[130:131], v[108:109], v[20:21] op_sel:[1,0,0] op_sel_hi:[1,1,1]
    v_pk_fma_f32 v[22:23], v[130:131], v[110:111], v[22:23] op_sel:[1,0,0] op_sel_hi:[1,1,1]
    s_set_gpr_idx_off
    s_sub_u32 s32, s32, 1
    s_cbranch_scc1 MAIN_DONE
    v_mfma_f32_4x4x4_16b_bf16 v[112:115], v[172:173], v[176:177], 0 cbsz:4 abid:6
    v_lshlrev_b32_sdwa v136, v15, v120 dst_sel:DWORD dst_unused:UNUSED_PAD src0_sel:DWORD src1_sel:WORD_1
    s_waitcnt vmcnt(10)
    v_mfma_f32_4x4x4_16b_bf16 v[104:107], v[146:147], v[76:77], 0 cbsz:4 abid:4
    s_nop 0
    v_mfma_f32_4x4x4_16b_bf16 v[108:111], v[146:147], v[78:79], 0 cbsz:4 abid:4
    v_lshlrev_b32_sdwa v137, v15, v121 dst_sel:DWORD dst_unused:UNUSED_PAD src0_sel:DWORD src1_sel:WORD_1
    ds_read_u16_d16_hi v128, v136 offset:32768
    ds_read_u16_d16_hi v129, v137 offset:32768
    s_waitcnt lgkmcnt(2)
    s_set_gpr_idx_on s50, 0xc
    v_pk_fma_f32 v[16:17], v[132:133], v[96:97], v[16:17] op_sel:[0,0,0] op_sel_hi:[0,1,1]
    v_pk_fma_f32 v[18:19], v[132:133], v[98:99], v[18:19] op_sel:[0,0,0] op_sel_hi:[0,1,1]
    v_pk_fma_f32 v[20:21], v[134:135], v[100:101], v[20:21] op_sel:[0,0,0] op_sel_hi:[0,1,1]
    v_pk_fma_f32 v[22:23], v[134:135], v[102:103], v[22:23] op_sel:[0,0,0] op_sel_hi:[0,1,1]
    s_set_gpr_idx_off
    s_sub_u32 s32, s32, 1
    s_cbranch_scc1 MAIN_DONE
    v_lshlrev_b32_sdwa v138, v15, v124 dst_sel:DWORD dst_unused:UNUSED_PAD src0_sel:DWORD src1_sel:WORD_1
    s_waitcnt vmcnt(9)
    v_mfma_f32_4x4x4_16b_bf16 v[96:99], v[140:141], v[80:81], 0 cbsz:4 abid:5
    s_nop 0
    v_mfma_f32_4x4x4_16b_bf16 v[100:103], v[140:141], v[82:83], 0 cbsz:4 abid:5
    v_lshlrev_b32_sdwa v139, v15, v125 dst_sel:DWORD dst_unused:UNUSED_PAD src0_sel:DWORD src1_sel:WORD_1
    ds_read_u16_d16_hi v130, v138 offset:32768
    ds_read_u16_d16_hi v131, v139 offset:32768
    s_set_gpr_idx_on s51, 0xc
    v_pk_fma_f32 v[16:17], v[132:133], v[104:105], v[16:17] op_sel:[1,0,0] op_sel_hi:[1,1,1]
    v_pk_fma_f32 v[18:19], v[132:133], v[106:107], v[18:19] op_sel:[1,0,0] op_sel_hi:[1,1,1]
    v_pk_fma_f32 v[20:21], v[134:135], v[108:109], v[20:21] op_sel:[1,0,0] op_sel_hi:[1,1,1]
    v_pk_fma_f32 v[22:23], v[134:135], v[110:111], v[22:23] op_sel:[1,0,0] op_sel_hi:[1,1,1]
    s_set_gpr_idx_off
    s_sub_u32 s32, s32, 1
    s_cbranch_scc1 MAIN_DONE
    v_mfma_f32_4x4x4_16b_bf16 v[116:119], v[172:173], v[178:179], 0 cbsz:4 abid:6
    v_lshlrev_b32_sdwa v136, v15, v122 dst_sel:DWORD dst_unused:UNUSED_PAD src0_sel:DWORD src1_sel:WORD_1
    s_waitcnt vmcnt(8)
    v_mfma_f32_4x4x4_16b_bf16 v[104:107], v[142:143], v[84:85], 0 cbsz:4 abid:5
    s_nop 0
    v_mfma_f32_4x4x4_16b_bf16 v[108:111], v[142:143], v[86:87], 0 cbsz:4 abid:5
    v_lshlrev_b32_sdwa v137, v15, v123 dst_sel:DWORD dst_unused:UNUSED_PAD src0_sel:DWORD src1_sel:WORD_1
    ds_read_u16_d16_hi v132, v136 offset:32768
    ds_read_u16_d16_hi v133, v137 offset:32768
    s_waitcnt lgkmcnt(2)
    s_set_gpr_idx_on s52, 0xc
    v_pk_fma_f32 v[16:17], v[128:129], v[96:97], v[16:17] op_sel:[0,0,0] op_sel_hi:[0,1,1]
    v_pk_fma_f32 v[18:19], v[128:129], v[98:99], v[18:19] op_sel:[0,0,0] op_sel_hi:[0,1,1]
    v_pk_fma_f32 v[20:21], v[130:131], v[100:101], v[20:21] op_sel:[0,0,0] op_sel_hi:[0,1,1]
    v_pk_fma_f32 v[22:23], v[130:131], v[102:103], v[22:23] op_sel:[0,0,0] op_sel_hi:[0,1,1]
    s_set_gpr_idx_off
    s_sub_u32 s32, s32, 1
    s_cbranch_scc1 MAIN_DONE
    v_lshlrev_b32_sdwa v138, v15, v126 dst_sel:DWORD dst_unused:UNUSED_PAD src0_sel:DWORD src1_sel:WORD_1
    v_mfma_f32_4x4x4_16b_bf16 v[96:99], v[144:145], v[88:89], 0 cbsz:4 abid:5
    s_nop 0
    v_mfma_f32_4x4x4_16b_bf16 v[100:103], v[144:145], v[90:91], 0 cbsz:4 abid:5
    v_lshlrev_b32_sdwa v139, v15, v127 dst_sel:DWORD dst_unused:UNUSED_PAD src0_sel:DWORD src1_sel:WORD_1
    ds_read_u16_d16_hi v134, v138 offset:32768
    ds_read_u16_d16_hi v135, v139 offset:32768
    s_set_gpr_idx_on s53, 0xc
    v_pk_fma_f32 v[16:17], v[128:129], v[104:105], v[16:17] op_sel:[1,0,0] op_sel_hi:[1,1,1]
    v_pk_fma_f32 v[18:19], v[128:129], v[106:107], v[18:19] op_sel:[1,0,0] op_sel_hi:[1,1,1]
    v_pk_fma_f32 v[20:21], v[130:131], v[108:109], v[20:21] op_sel:[1,0,0] op_sel_hi:[1,1,1]
    v_pk_fma_f32 v[22:23], v[130:131], v[110:111], v[22:23] op_sel:[1,0,0] op_sel_hi:[1,1,1]
    s_set_gpr_idx_off
    s_branch MAIN_DONE
B_20:
    buffer_load_dwordx4 v[188:191], v1, s[16:19], s10 offen offset:0 sc1
    buffer_load_dwordx4 v[192:195], v1, s[16:19], s10 offen offset:1024 sc1
    buffer_load_dwordx4 v[196:199], v1, s[16:19], s10 offen offset:2048 sc1
    buffer_load_dwordx4 v[200:203], v1, s[16:19], s10 offen offset:3072 sc1
    buffer_load_dwordx4 v[204:207], v1, s[16:19], s11 offen offset:0 sc1
    buffer_load_dwordx4 v[208:211], v1, s[16:19], s11 offen offset:1024 sc1
    buffer_load_dwordx4 v[212:215], v1, s[16:19], s11 offen offset:2048 sc1
    buffer_load_dwordx4 v[216:219], v1, s[16:19], s11 offen offset:3072 sc1
    s_sub_u32 s32, s32, 1
    s_cbranch_scc1 MAIN_DONE
    v_mfma_f32_4x4x4_16b_bf16 v[116:119], v[172:173], v[178:179], 0 cbsz:4 abid:6
    v_lshlrev_b32_sdwa v136, v15, v122 dst_sel:DWORD dst_unused:UNUSED_PAD src0_sel:DWORD src1_sel:WORD_1
    s_waitcnt vmcnt(12)
    v_mfma_f32_4x4x4_16b_bf16 v[104:107], v[142:143], v[84:85], 0 cbsz:4 abid:5
    s_nop 0
    v_mfma_f32_4x4x4_16b_bf16 v[108:111], v[142:143], v[86:87], 0 cbsz:4 abid:5
    v_lshlrev_b32_sdwa v137, v15, v123 dst_sel:DWORD dst_unused:UNUSED_PAD src0_sel:DWORD src1_sel:WORD_1
    ds_read_u16_d16_hi v132, v136 offset:32768
    ds_read_u16_d16_hi v133, v137 offset:32768
    s_waitcnt lgkmcnt(2)
    s_set_gpr_idx_on s52, 0xc
    v_pk_fma_f32 v[16:17], v[128:129], v[96:97], v[16:17] op_sel:[0,0,0] op_sel_hi:[0,1,1]
    v_pk_fma_f32 v[18:19], v[128:129], v[98:99], v[18:19] op_sel:[0,0,0] op_sel_hi:[0,1,1]
    v_pk_fma_f32 v[20:21], v[130:131], v[100:101], v[20:21] op_sel:[0,0,0] op_sel_hi:[0,1,1]
    v_pk_fma_f32 v[22:23], v[130:131], v[102:103], v[22:23] op_sel:[0,0,0] op_sel_hi:[0,1,1]
    s_set_gpr_idx_off
    s_sub_u32 s32, s32, 1
    s_cbranch_scc1 MAIN_DONE
    v_lshlrev_b32_sdwa v138, v15, v126 dst_sel:DWORD dst_unused:UNUSED_PAD src0_sel:DWORD src1_sel:WORD_1
    s_waitcnt vmcnt(11)
    v_mfma_f32_4x4x4_16b_bf16 v[96:99], v[144:145], v[88:89], 0 cbsz:4 abid:5
    s_nop 0
    v_mfma_f32_4x4x4_16b_bf16 v[100:103], v[144:145], v[90:91], 0 cbsz:4 abid:5
    v_lshlrev_b32_sdwa v139, v15, v127 dst_sel:DWORD dst_unused:UNUSED_PAD src0_sel:DWORD src1_sel:WORD_1
    ds_read_u16_d16_hi v134, v138 offset:32768
    ds_read_u16_d16_hi v135, v139 offset:32768
    s_set_gpr_idx_on s53, 0xc
    v_pk_fma_f32 v[16:17], v[128:129], v[104:105], v[16:17] op_sel:[1,0,0] op_sel_hi:[1,1,1]
    v_pk_fma_f32 v[18:19], v[128:129], v[106:107], v[18:19] op_sel:[1,0,0] op_sel_hi:[1,1,1]
    v_pk_fma_f32 v[20:21], v[130:131], v[108:109], v[20:21] op_sel:[1,0,0] op_sel_hi:[1,1,1]
    v_pk_fma_f32 v[22:23], v[130:131], v[110:111], v[22:23] op_sel:[1,0,0] op_sel_hi:[1,1,1]
    s_set_gpr_idx_off
    s_sub_u32 s32, s32, 1
    s_cbranch_scc1 MAIN_DONE
    v_mfma_f32_4x4x4_16b_bf16 v[120:123], v[172:173], v[176:177], 0 cbsz:4 abid:7
    v_lshlrev_b32_sdwa v136, v15, v112 dst_sel:DWORD dst_unused:UNUSED_PAD src0_sel:DWORD src1_sel:WORD_1
    s_waitcnt vmcnt(10)
    v_mfma_f32_4x4x4_16b_bf16 v[104:107], v[146:147], v[92:93], 0 cbsz:4 abid:5
    s_nop 0
    v_mfma_f32_4x4x4_16b_bf16 v[108:111], v[146:147], v[94:95], 0 cbsz:4 abid:5
    v_lshlrev_b32_sdwa v137, v15, v113 dst_sel:DWORD dst_unused:UNUSED_PAD src0_sel:DWORD src1_sel:WORD_1
    ds_read_u16_d16_hi v128, v136 offset:32768
    ds_read_u16_d16_hi v129, v137 offset:32768
    s_waitcnt lgkmcnt(2)
    s_set_gpr_idx_on s54, 0xc
    v_pk_fma_f32 v[16:17], v[132:133], v[96:97], v[16:17] op_sel:[0,0,0] op_sel_hi:[0,1,1]
    v_pk_fma_f32 v[18:19], v[132:133], v[98:99], v[18:19] op_sel:[0,0,0] op_sel_hi:[0,1,1]
    v_pk_fma_f32 v[20:21], v[134:135], v[100:101], v[20:21] op_sel:[0,0,0] op_sel_hi:[0,1,1]
    v_pk_fma_f32 v[22:23], v[134:135], v[102:103], v[22:23] op_sel:[0,0,0] op_sel_hi:[0,1,1]
    s_set_gpr_idx_off
    s_sub_u32 s32, s32, 1
    s_cbranch_scc1 MAIN_DONE
    v_lshlrev_b32_sdwa v138, v15, v116 dst_sel:DWORD dst_unused:UNUSED_PAD src0_sel:DWORD src1_sel:WORD_1
    s_waitcnt vmcnt(9)
    v_mfma_f32_4x4x4_16b_bf16 v[96:99], v[140:141], v[64:65], 0 cbsz:4 abid:6
    s_nop 0
    v_mfma_f32_4x4x4_16b_bf16 v[100:103], v[140:141], v[66:67], 0 cbsz:4 abid:6
    v_lshlrev_b32_sdwa v139, v15, v117 dst_sel:DWORD dst_unused:UNUSED_PAD src0_sel:DWORD src1_sel:WORD_1
    ds_read_u16_d16_hi v130, v138 offset:32768
    ds_read_u16_d16_hi v131, v139 offset:32768
    s_set_gpr_idx_on s55, 0xc
    v_pk_fma_f32 v[16:17], v[132:133], v[104:105], v[16:17] op_sel:[1,0,0] op_sel_hi:[1,1,1]
    v_pk_fma_f32 v[18:19], v[132:133], v[106:107], v[18:19] op_sel:[1,0,0] op_sel_hi:[1,1,1]
    v_pk_fma_f32 v[20:21], v[134:135], v[108:109], v[20:21] op_sel:[1,0,0] op_sel_hi:[1,1,1]
    v_pk_fma_f32 v[22:23], v[134:135], v[110:111], v[22:23] op_sel:[1,0,0] op_sel_hi:[1,1,1]
    s_set_gpr_idx_off
    s_sub_u32 s32, s32, 1
    s_cbranch_scc1 MAIN_DONE
    v_mfma_f32_4x4x4_16b_bf16 v[124:127], v[172:173], v[178:179], 0 cbsz:4 abid:7
    v_lshlrev_b32_sdwa v136, v15, v114 dst_sel:DWORD dst_unused:UNUSED_PAD src0_sel:DWORD src1_sel:WORD_1
    s_waitcnt vmcnt(8)
    v_mfma_f32_4x4x4_16b_bf16 v[104:107], v[142:143], v[68:69], 0 cbsz:4 abid:6
    s_nop 0
    v_mfma_f32_4x4x4_16b_bf16 v[108:111], v[142:143], v[70:71], 0 cbsz:4 abid:6
    v_lshlrev_b32_sdwa v137, v15, v115 dst_sel:DWORD dst_unused:UNUSED_PAD src0_sel:DWORD src1_sel:WORD_1
    ds_read_u16_d16_hi v132, v136 offset:32768
    ds_read_u16_d16_hi v133, v137 offset:32768
    s_waitcnt lgkmcnt(2)
    s_set_gpr_idx_on s56, 0xc
    v_pk_fma_f32 v[16:17], v[128:129], v[96:97], v[16:17] op_sel:[0,0,0] op_sel_hi:[0,1,1]
    v_pk_fma_f32 v[18:19], v[128:129], v[98:99], v[18:19] op_sel:[0,0,0] op_sel_hi:[0,1,1]
    v_pk_fma_f32 v[20:21], v[130:131], v[100:101], v[20:21] op_sel:[0,0,0] op_sel_hi:[0,1,1]
    v_pk_fma_f32 v[22:23], v[130:131], v[102:103], v[22:23] op_sel:[0,0,0] op_sel_hi:[0,1,1]
    s_set_gpr_idx_off
    s_sub_u32 s32, s32, 1
    s_cbranch_scc1 MAIN_DONE
    v_lshlrev_b32_sdwa v138, v15, v118 dst_sel:DWORD dst_unused:UNUSED_PAD src0_sel:DWORD src1_sel:WORD_1
    v_mfma_f32_4x4x4_16b_bf16 v[96:99], v[144:145], v[72:73], 0 cbsz:4 abid:6
    s_nop 0
    v_mfma_f32_4x4x4_16b_bf16 v[100:103], v[144:145], v[74:75], 0 cbsz:4 abid:6
    v_lshlrev_b32_sdwa v139, v15, v119 dst_sel:DWORD dst_unused:UNUSED_PAD src0_sel:DWORD src1_sel:WORD_1
    ds_read_u16_d16_hi v134, v138 offset:32768
    ds_read_u16_d16_hi v135, v139 offset:32768
    s_set_gpr_idx_on s57, 0xc
    v_pk_fma_f32 v[16:17], v[128:129], v[104:105], v[16:17] op_sel:[1,0,0] op_sel_hi:[1,1,1]
    v_pk_fma_f32 v[18:19], v[128:129], v[106:107], v[18:19] op_sel:[1,0,0] op_sel_hi:[1,1,1]
    v_pk_fma_f32 v[20:21], v[130:131], v[108:109], v[20:21] op_sel:[1,0,0] op_sel_hi:[1,1,1]
    v_pk_fma_f32 v[22:23], v[130:131], v[110:111], v[22:23] op_sel:[1,0,0] op_sel_hi:[1,1,1]
    s_set_gpr_idx_off
    s_branch MAIN_DONE
B_24:
    buffer_load_dwordx4 v[188:191], v1, s[16:19], s10 offen offset:0 sc1
    buffer_load_dwordx4 v[192:195], v1, s[16:19], s10 offen offset:1024 sc1
    buffer_load_dwordx4 v[196:199], v1, s[16:19], s10 offen offset:2048 sc1
    buffer_load_dwordx4 v[200:203], v1, s[16:19], s10 offen offset:3072 sc1
    buffer_load_dwordx4 v[204:207], v1, s[16:19], s11 offen offset:0 sc1
    buffer_load_dwordx4 v[208:211], v1, s[16:19], s11 offen offset:1024 sc1
    buffer_load_dwordx4 v[212:215], v1, s[16:19], s11 offen offset:2048 sc1
    buffer_load_dwordx4 v[216:219], v1, s[16:19], s11 offen offset:3072 sc1
    s_sub_u32 s32, s32, 1
    s_cbranch_scc1 MAIN_DONE
    v_mfma_f32_4x4x4_16b_bf16 v[124:127], v[172:173], v[178:179], 0 cbsz:4 abid:7
    v_lshlrev_b32_sdwa v136, v15, v114 dst_sel:DWORD dst_unused:UNUSED_PAD src0_sel:DWORD src1_sel:WORD_1
    s_waitcnt vmcnt(12)
    v_mfma_f32_4x4x4_16b_bf16 v[104:107], v[142:143], v[68:69], 0 cbsz:4 abid:6
    s_nop 0
    v_mfma_f32_4x4x4_16b_bf16 v[108:111], v[142:143], v[70:71], 0 cbsz:4 abid:6
    v_lshlrev_b32_sdwa v137, v15, v115 dst_sel:DWORD dst_unused:UNUSED_PAD src0_sel:DWORD src1_sel:WORD_1
    ds_read_u16_d16_hi v132, v136 offset:32768
    ds_read_u16_d16_hi v133, v137 offset:32768
    s_waitcnt lgkmcnt(2)
    s_set_gpr_idx_on s56, 0xc
    v_pk_fma_f32 v[16:17], v[128:129], v[96:97], v[16:17] op_sel:[0,0,0] op_sel_hi:[0,1,1]
    v_pk_fma_f32 v[18:19], v[128:129], v[98:99], v[18:19] op_sel:[0,0,0] op_sel_hi:[0,1,1]
    v_pk_fma_f32 v[20:21], v[130:131], v[100:101], v[20:21] op_sel:[0,0,0] op_sel_hi:[0,1,1]
    v_pk_fma_f32 v[22:23], v[130:131], v[102:103], v[22:23] op_sel:[0,0,0] op_sel_hi:[0,1,1]
    s_set_gpr_idx_off
    s_sub_u32 s32, s32, 1
    s_cbranch_scc1 MAIN_DONE
    v_lshlrev_b32_sdwa v138, v15, v118 dst_sel:DWORD dst_unused:UNUSED_PAD src0_sel:DWORD src1_sel:WORD_1
    s_waitcnt vmcnt(11)
    v_mfma_f32_4x4x4_16b_bf16 v[96:99], v[144:145], v[72:73], 0 cbsz:4 abid:6
    s_nop 0
    v_mfma_f32_4x4x4_16b_bf16 v[100:103], v[144:145], v[74:75], 0 cbsz:4 abid:6
    v_lshlrev_b32_sdwa v139, v15, v119 dst_sel:DWORD dst_unused:UNUSED_PAD src0_sel:DWORD src1_sel:WORD_1
    ds_read_u16_d16_hi v134, v138 offset:32768
    ds_read_u16_d16_hi v135, v139 offset:32768
    s_set_gpr_idx_on s57, 0xc
    v_pk_fma_f32 v[16:17], v[128:129], v[104:105], v[16:17] op_sel:[1,0,0] op_sel_hi:[1,1,1]
    v_pk_fma_f32 v[18:19], v[128:129], v[106:107], v[18:19] op_sel:[1,0,0] op_sel_hi:[1,1,1]
    v_pk_fma_f32 v[20:21], v[130:131], v[108:109], v[20:21] op_sel:[1,0,0] op_sel_hi:[1,1,1]
    v_pk_fma_f32 v[22:23], v[130:131], v[110:111], v[22:23] op_sel:[1,0,0] op_sel_hi:[1,1,1]
    s_set_gpr_idx_off
    s_sub_u32 s32, s32, 1
    s_cbranch_scc1 MAIN_DONE
    v_mfma_f32_4x4x4_16b_bf16 v[112:115], v[172:173], v[176:177], 0 cbsz:4 abid:8
    v_lshlrev_b32_sdwa v136, v15, v120 dst_sel:DWORD dst_unused:UNUSED_PAD src0_sel:DWORD src1_sel:WORD_1
    s_waitcnt vmcnt(10)
    v_mfma_f32_4x4x4_16b_bf16 v[104:107], v[146:147], v[76:77], 0 cbsz:4 abid:6
    s_nop 0
    v_mfma_f32_4x4x4_16b_bf16 v[108:111], v[146:147], v[78:79], 0 cbsz:4 abid:6
    v_lshlrev_b32_sdwa v137, v15, v121 dst_sel:DWORD dst_unused:UNUSED_PAD src0_sel:DWORD src1_sel:WORD_1
    ds_read_u16_d16_hi v128, v136 offset:32768
    ds_read_u16_d16_hi v129, v137 offset:32768
    s_waitcnt lgkmcnt(2)
    s_set_gpr_idx_on s58, 0xc
    v_pk_fma_f32 v[16:17], v[132:133], v[96:97], v[16:17] op_sel:[0,0,0] op_sel_hi:[0,1,1]
    v_pk_fma_f32 v[18:19], v[132:133], v[98:99], v[18:19] op_sel:[0,0,0] op_sel_hi:[0,1,1]
    v_pk_fma_f32 v[20:21], v[134:135], v[100:101], v[20:21] op_sel:[0,0,0] op_sel_hi:[0,1,1]
    v_pk_fma_f32 v[22:23], v[134:135], v[102:103], v[22:23] op_sel:[0,0,0] op_sel_hi:[0,1,1]
    s_set_gpr_idx_off
    s_sub_u32 s32, s32, 1
    s_cbranch_scc1 MAIN_DONE
    v_lshlrev_b32_sdwa v138, v15, v124 dst_sel:DWORD dst_unused:UNUSED_PAD src0_sel:DWORD src1_sel:WORD_1
    s_waitcnt vmcnt(9)
    v_mfma_f32_4x4x4_16b_bf16 v[96:99], v[140:141], v[80:81], 0 cbsz:4 abid:7
    s_nop 0
    v_mfma_f32_4x4x4_16b_bf16 v[100:103], v[140:141], v[82:83], 0 cbsz:4 abid:7
    v_lshlrev_b32_sdwa v139, v15, v125 dst_sel:DWORD dst_unused:UNUSED_PAD src0_sel:DWORD src1_sel:WORD_1
    ds_read_u16_d16_hi v130, v138 offset:32768
    ds_read_u16_d16_hi v131, v139 offset:32768
    s_set_gpr_idx_on s59, 0xc
    v_pk_fma_f32 v[16:17], v[132:133], v[104:105], v[16:17] op_sel:[1,0,0] op_sel_hi:[1,1,1]
    v_pk_fma_f32 v[18:19], v[132:133], v[106:107], v[18:19] op_sel:[1,0,0] op_sel_hi:[1,1,1]
    v_pk_fma_f32 v[20:21], v[134:135], v[108:109], v[20:21] op_sel:[1,0,0] op_sel_hi:[1,1,1]
    v_pk_fma_f32 v[22:23], v[134:135], v[110:111], v[22:23] op_sel:[1,0,0] op_sel_hi:[1,1,1]
    s_set_gpr_idx_off
    s_sub_u32 s32, s32, 1
    s_cbranch_scc1 MAIN_DONE
    v_mfma_f32_4x4x4_16b_bf16 v[116:119], v[172:173], v[178:179], 0 cbsz:4 abid:8
    v_lshlrev_b32_sdwa v136, v15, v122 dst_sel:DWORD dst_unused:UNUSED_PAD src0_sel:DWORD src1_sel:WORD_1
    s_waitcnt vmcnt(8)
    v_mfma_f32_4x4x4_16b_bf16 v[104:107], v[142:143], v[84:85], 0 cbsz:4 abid:7
    s_nop 0
    v_mfma_f32_4x4x4_16b_bf16 v[108:111], v[142:143], v[86:87], 0 cbsz:4 abid:7
    v_lshlrev_b32_sdwa v137, v15, v123 dst_sel:DWORD dst_unused:UNUSED_PAD src0_sel:DWORD src1_sel:WORD_1
    ds_read_u16_d16_hi v132, v136 offset:32768
    ds_read_u16_d16_hi v133, v137 offset:32768
    s_waitcnt lgkmcnt(2)
    s_set_gpr_idx_on s60, 0xc
    v_pk_fma_f32 v[16:17], v[128:129], v[96:97], v[16:17] op_sel:[0,0,0] op_sel_hi:[0,1,1]
    v_pk_fma_f32 v[18:19], v[128:129], v[98:99], v[18:19] op_sel:[0,0,0] op_sel_hi:[0,1,1]
    v_pk_fma_f32 v[20:21], v[130:131], v[100:101], v[20:21] op_sel:[0,0,0] op_sel_hi:[0,1,1]
    v_pk_fma_f32 v[22:23], v[130:131], v[102:103], v[22:23] op_sel:[0,0,0] op_sel_hi:[0,1,1]
    s_set_gpr_idx_off
    s_sub_u32 s32, s32, 1
    s_cbranch_scc1 MAIN_DONE
    v_lshlrev_b32_sdwa v138, v15, v126 dst_sel:DWORD dst_unused:UNUSED_PAD src0_sel:DWORD src1_sel:WORD_1
    v_mfma_f32_4x4x4_16b_bf16 v[96:99], v[144:145], v[88:89], 0 cbsz:4 abid:7
    s_nop 0
    v_mfma_f32_4x4x4_16b_bf16 v[100:103], v[144:145], v[90:91], 0 cbsz:4 abid:7
    v_lshlrev_b32_sdwa v139, v15, v127 dst_sel:DWORD dst_unused:UNUSED_PAD src0_sel:DWORD src1_sel:WORD_1
    ds_read_u16_d16_hi v134, v138 offset:32768
    ds_read_u16_d16_hi v135, v139 offset:32768
    s_set_gpr_idx_on s61, 0xc
    v_pk_fma_f32 v[16:17], v[128:129], v[104:105], v[16:17] op_sel:[1,0,0] op_sel_hi:[1,1,1]
    v_pk_fma_f32 v[18:19], v[128:129], v[106:107], v[18:19] op_sel:[1,0,0] op_sel_hi:[1,1,1]
    v_pk_fma_f32 v[20:21], v[130:131], v[108:109], v[20:21] op_sel:[1,0,0] op_sel_hi:[1,1,1]
    v_pk_fma_f32 v[22:23], v[130:131], v[110:111], v[22:23] op_sel:[1,0,0] op_sel_hi:[1,1,1]
    s_set_gpr_idx_off
    s_branch MAIN_DONE
B_28:
    buffer_load_dwordx4 v[188:191], v1, s[16:19], s10 offen offset:0 sc1
    buffer_load_dwordx4 v[192:195], v1, s[16:19], s10 offen offset:1024 sc1
    buffer_load_dwordx4 v[196:199], v1, s[16:19], s10 offen offset:2048 sc1
    buffer_load_dwordx4 v[200:203], v1, s[16:19], s10 offen offset:3072 sc1
    buffer_load_dwordx4 v[204:207], v1, s[16:19], s11 offen offset:0 sc1
    buffer_load_dwordx4 v[208:211], v1, s[16:19], s11 offen offset:1024 sc1
    buffer_load_dwordx4 v[212:215], v1, s[16:19], s11 offen offset:2048 sc1
    buffer_load_dwordx4 v[216:219], v1, s[16:19], s11 offen offset:3072 sc1
    s_sub_u32 s32, s32, 1
    s_cbranch_scc1 MAIN_DONE
    v_mfma_f32_4x4x4_16b_bf16 v[116:119], v[172:173], v[178:179], 0 cbsz:4 abid:8
    v_lshlrev_b32_sdwa v136, v15, v122 dst_sel:DWORD dst_unused:UNUSED_PAD src0_sel:DWORD src1_sel:WORD_1
    s_waitcnt vmcnt(12)
    v_mfma_f32_4x4x4_16b_bf16 v[104:107], v[142:143], v[84:85], 0 cbsz:4 abid:7
    s_nop 0
    v_mfma_f32_4x4x4_16b_bf16 v[108:111], v[142:143], v[86:87], 0 cbsz:4 abid:7
    v_lshlrev_b32_sdwa v137, v15, v123 dst_sel:DWORD dst_unused:UNUSED_PAD src0_sel:DWORD src1_sel:WORD_1
    ds_read_u16_d16_hi v132, v136 offset:32768
    ds_read_u16_d16_hi v133, v137 offset:32768
    s_waitcnt lgkmcnt(2)
    s_set_gpr_idx_on s60, 0xc
    v_pk_fma_f32 v[16:17], v[128:129], v[96:97], v[16:17] op_sel:[0,0,0] op_sel_hi:[0,1,1]
    v_pk_fma_f32 v[18:19], v[128:129], v[98:99], v[18:19] op_sel:[0,0,0] op_sel_hi:[0,1,1]
    v_pk_fma_f32 v[20:21], v[130:131], v[100:101], v[20:21] op_sel:[0,0,0] op_sel_hi:[0,1,1]
    v_pk_fma_f32 v[22:23], v[130:131], v[102:103], v[22:23] op_sel:[0,0,0] op_sel_hi:[0,1,1]
    s_set_gpr_idx_off
    s_sub_u32 s32, s32, 1
    s_cbranch_scc1 MAIN_DONE
    v_lshlrev_b32_sdwa v138, v15, v126 dst_sel:DWORD dst_unused:UNUSED_PAD src0_sel:DWORD src1_sel:WORD_1
    s_waitcnt vmcnt(11)
    v_mfma_f32_4x4x4_16b_bf16 v[96:99], v[144:145], v[88:89], 0 cbsz:4 abid:7
    s_nop 0
    v_mfma_f32_4x4x4_16b_bf16 v[100:103], v[144:145], v[90:91], 0 cbsz:4 abid:7
    v_lshlrev_b32_sdwa v139, v15, v127 dst_sel:DWORD dst_unused:UNUSED_PAD src0_sel:DWORD src1_sel:WORD_1
    ds_read_u16_d16_hi v134, v138 offset:32768
    ds_read_u16_d16_hi v135, v139 offset:32768
    s_set_gpr_idx_on s61, 0xc
    v_pk_fma_f32 v[16:17], v[128:129], v[104:105], v[16:17] op_sel:[1,0,0] op_sel_hi:[1,1,1]
    v_pk_fma_f32 v[18:19], v[128:129], v[106:107], v[18:19] op_sel:[1,0,0] op_sel_hi:[1,1,1]
    v_pk_fma_f32 v[20:21], v[130:131], v[108:109], v[20:21] op_sel:[1,0,0] op_sel_hi:[1,1,1]
    v_pk_fma_f32 v[22:23], v[130:131], v[110:111], v[22:23] op_sel:[1,0,0] op_sel_hi:[1,1,1]
    s_set_gpr_idx_off
    s_sub_u32 s32, s32, 1
    s_cbranch_scc1 MAIN_DONE
    v_mfma_f32_4x4x4_16b_bf16 v[120:123], v[172:173], v[176:177], 0 cbsz:4 abid:9
    v_lshlrev_b32_sdwa v136, v15, v112 dst_sel:DWORD dst_unused:UNUSED_PAD src0_sel:DWORD src1_sel:WORD_1
    s_waitcnt vmcnt(10)
    v_mfma_f32_4x4x4_16b_bf16 v[104:107], v[146:147], v[92:93], 0 cbsz:4 abid:7
    s_nop 0
    v_mfma_f32_4x4x4_16b_bf16 v[108:111], v[146:147], v[94:95], 0 cbsz:4 abid:7
    v_lshlrev_b32_sdwa v137, v15, v113 dst_sel:DWORD dst_unused:UNUSED_PAD src0_sel:DWORD src1_sel:WORD_1
    ds_read_u16_d16_hi v128, v136 offset:32768
    ds_read_u16_d16_hi v129, v137 offset:32768
    s_waitcnt lgkmcnt(2)
    s_set_gpr_idx_on s62, 0xc
    v_pk_fma_f32 v[16:17], v[132:133], v[96:97], v[16:17] op_sel:[0,0,0] op_sel_hi:[0,1,1]
    v_pk_fma_f32 v[18:19], v[132:133], v[98:99], v[18:19] op_sel:[0,0,0] op_sel_hi:[0,1,1]
    v_pk_fma_f32 v[20:21], v[134:135], v[100:101], v[20:21] op_sel:[0,0,0] op_sel_hi:[0,1,1]
    v_pk_fma_f32 v[22:23], v[134:135], v[102:103], v[22:23] op_sel:[0,0,0] op_sel_hi:[0,1,1]
    s_set_gpr_idx_off
    s_sub_u32 s32, s32, 1
    s_cbranch_scc1 MAIN_DONE
    v_lshlrev_b32_sdwa v138, v15, v116 dst_sel:DWORD dst_unused:UNUSED_PAD src0_sel:DWORD src1_sel:WORD_1
    s_waitcnt vmcnt(9)
    v_mfma_f32_4x4x4_16b_bf16 v[96:99], v[140:141], v[64:65], 0 cbsz:4 abid:8
    s_nop 0
    v_mfma_f32_4x4x4_16b_bf16 v[100:103], v[140:141], v[66:67], 0 cbsz:4 abid:8
    v_lshlrev_b32_sdwa v139, v15, v117 dst_sel:DWORD dst_unused:UNUSED_PAD src0_sel:DWORD src1_sel:WORD_1
    ds_read_u16_d16_hi v130, v138 offset:32768
    ds_read_u16_d16_hi v131, v139 offset:32768
    s_set_gpr_idx_on s63, 0xc
    v_pk_fma_f32 v[16:17], v[132:133], v[104:105], v[16:17] op_sel:[1,0,0] op_sel_hi:[1,1,1]
    v_pk_fma_f32 v[18:19], v[132:133], v[106:107], v[18:19] op_sel:[1,0,0] op_sel_hi:[1,1,1]
    v_pk_fma_f32 v[20:21], v[134:135], v[108:109], v[20:21] op_sel:[1,0,0] op_sel_hi:[1,1,1]
    v_pk_fma_f32 v[22:23], v[134:135], v[110:111], v[22:23] op_sel:[1,0,0] op_sel_hi:[1,1,1]
    s_set_gpr_idx_off
    s_sub_u32 s32, s32, 1
    s_cbranch_scc1 MAIN_DONE
    v_mfma_f32_4x4x4_16b_bf16 v[124:127], v[172:173], v[178:179], 0 cbsz:4 abid:9
    v_lshlrev_b32_sdwa v136, v15, v114 dst_sel:DWORD dst_unused:UNUSED_PAD src0_sel:DWORD src1_sel:WORD_1
    s_waitcnt vmcnt(8)
    v_mfma_f32_4x4x4_16b_bf16 v[104:107], v[142:143], v[68:69], 0 cbsz:4 abid:8
    s_nop 0
    v_mfma_f32_4x4x4_16b_bf16 v[108:111], v[142:143], v[70:71], 0 cbsz:4 abid:8
    v_lshlrev_b32_sdwa v137, v15, v115 dst_sel:DWORD dst_unused:UNUSED_PAD src0_sel:DWORD src1_sel:WORD_1
    ds_read_u16_d16_hi v132, v136 offset:32768
    ds_read_u16_d16_hi v133, v137 offset:32768
    s_waitcnt lgkmcnt(2)
    s_set_gpr_idx_on s48, 0xc
    v_pk_fma_f32 v[16:17], v[128:129], v[96:97], v[16:17] op_sel:[0,0,0] op_sel_hi:[0,1,1]
    v_pk_fma_f32 v[18:19], v[128:129], v[98:99], v[18:19] op_sel:[0,0,0] op_sel_hi:[0,1,1]
    v_pk_fma_f32 v[20:21], v[130:131], v[100:101], v[20:21] op_sel:[0,0,0] op_sel_hi:[0,1,1]
    v_pk_fma_f32 v[22:23], v[130:131], v[102:103], v[22:23] op_sel:[0,0,0] op_sel_hi:[0,1,1]
    s_set_gpr_idx_off
    s_sub_u32 s32, s32, 1
    s_cbranch_scc1 MAIN_DONE
    v_lshlrev_b32_sdwa v138, v15, v118 dst_sel:DWORD dst_unused:UNUSED_PAD src0_sel:DWORD src1_sel:WORD_1
    v_mfma_f32_4x4x4_16b_bf16 v[96:99], v[144:145], v[72:73], 0 cbsz:4 abid:8
    s_nop 0
    v_mfma_f32_4x4x4_16b_bf16 v[100:103], v[144:145], v[74:75], 0 cbsz:4 abid:8
    v_lshlrev_b32_sdwa v139, v15, v119 dst_sel:DWORD dst_unused:UNUSED_PAD src0_sel:DWORD src1_sel:WORD_1
    ds_read_u16_d16_hi v134, v138 offset:32768
    ds_read_u16_d16_hi v135, v139 offset:32768
    s_set_gpr_idx_on s49, 0xc
    v_pk_fma_f32 v[16:17], v[128:129], v[104:105], v[16:17] op_sel:[1,0,0] op_sel_hi:[1,1,1]
    v_pk_fma_f32 v[18:19], v[128:129], v[106:107], v[18:19] op_sel:[1,0,0] op_sel_hi:[1,1,1]
    v_pk_fma_f32 v[20:21], v[130:131], v[108:109], v[20:21] op_sel:[1,0,0] op_sel_hi:[1,1,1]
    v_pk_fma_f32 v[22:23], v[130:131], v[110:111], v[22:23] op_sel:[1,0,0] op_sel_hi:[1,1,1]
    s_set_gpr_idx_off
    s_branch MAIN_DONE
B_32:
    buffer_load_dwordx4 v[188:191], v1, s[16:19], s10 offen offset:0 sc1
    buffer_load_dwordx4 v[192:195], v1, s[16:19], s10 offen offset:1024 sc1
    buffer_load_dwordx4 v[196:199], v1, s[16:19], s10 offen offset:2048 sc1
    buffer_load_dwordx4 v[200:203], v1, s[16:19], s10 offen offset:3072 sc1
    buffer_load_dwordx4 v[204:207], v1, s[16:19], s11 offen offset:0 sc1
    buffer_load_dwordx4 v[208:211], v1, s[16:19], s11 offen offset:1024 sc1
    buffer_load_dwordx4 v[212:215], v1, s[16:19], s11 offen offset:2048 sc1
    buffer_load_dwordx4 v[216:219], v1, s[16:19], s11 offen offset:3072 sc1
    s_sub_u32 s32, s32, 1
    s_cbranch_scc1 MAIN_DONE
    v_mfma_f32_4x4x4_16b_bf16 v[124:127], v[172:173], v[178:179], 0 cbsz:4 abid:9
    v_lshlrev_b32_sdwa v136, v15, v114 dst_sel:DWORD dst_unused:UNUSED_PAD src0_sel:DWORD src1_sel:WORD_1
    s_waitcnt vmcnt(12)
    v_mfma_f32_4x4x4_16b_bf16 v[104:107], v[142:143], v[68:69], 0 cbsz:4 abid:8
    s_nop 0
    v_mfma_f32_4x4x4_16b_bf16 v[108:111], v[142:143], v[70:71], 0 cbsz:4 abid:8
    v_lshlrev_b32_sdwa v137, v15, v115 dst_sel:DWORD dst_unused:UNUSED_PAD src0_sel:DWORD src1_sel:WORD_1
    ds_read_u16_d16_hi v132, v136 offset:32768
    ds_read_u16_d16_hi v133, v137 offset:32768
    s_waitcnt lgkmcnt(2)
    s_set_gpr_idx_on s48, 0xc
    v_pk_fma_f32 v[16:17], v[128:129], v[96:97], v[16:17] op_sel:[0,0,0] op_sel_hi:[0,1,1]
    v_pk_fma_f32 v[18:19], v[128:129], v[98:99], v[18:19] op_sel:[0,0,0] op_sel_hi:[0,1,1]
    v_pk_fma_f32 v[20:21], v[130:131], v[100:101], v[20:21] op_sel:[0,0,0] op_sel_hi:[0,1,1]
    v_pk_fma_f32 v[22:23], v[130:131], v[102:103], v[22:23] op_sel:[0,0,0] op_sel_hi:[0,1,1]
    s_set_gpr_idx_off
    s_sub_u32 s32, s32, 1
    s_cbranch_scc1 MAIN_DONE
    v_lshlrev_b32_sdwa v138, v15, v118 dst_sel:DWORD dst_unused:UNUSED_PAD src0_sel:DWORD src1_sel:WORD_1
    s_waitcnt vmcnt(11)
    v_mfma_f32_4x4x4_16b_bf16 v[96:99], v[144:145], v[72:73], 0 cbsz:4 abid:8
    s_nop 0
    v_mfma_f32_4x4x4_16b_bf16 v[100:103], v[144:145], v[74:75], 0 cbsz:4 abid:8
    v_lshlrev_b32_sdwa v139, v15, v119 dst_sel:DWORD dst_unused:UNUSED_PAD src0_sel:DWORD src1_sel:WORD_1
    ds_read_u16_d16_hi v134, v138 offset:32768
    ds_read_u16_d16_hi v135, v139 offset:32768
    s_set_gpr_idx_on s49, 0xc
    v_pk_fma_f32 v[16:17], v[128:129], v[104:105], v[16:17] op_sel:[1,0,0] op_sel_hi:[1,1,1]
    v_pk_fma_f32 v[18:19], v[128:129], v[106:107], v[18:19] op_sel:[1,0,0] op_sel_hi:[1,1,1]
    v_pk_fma_f32 v[20:21], v[130:131], v[108:109], v[20:21] op_sel:[1,0,0] op_sel_hi:[1,1,1]
    v_pk_fma_f32 v[22:23], v[130:131], v[110:111], v[22:23] op_sel:[1,0,0] op_sel_hi:[1,1,1]
    s_set_gpr_idx_off
    s_sub_u32 s32, s32, 1
    s_cbranch_scc1 MAIN_DONE
    v_mfma_f32_4x4x4_16b_bf16 v[112:115], v[172:173], v[176:177], 0 cbsz:4 abid:10
    v_lshlrev_b32_sdwa v136, v15, v120 dst_sel:DWORD dst_unused:UNUSED_PAD src0_sel:DWORD src1_sel:WORD_1
    s_waitcnt vmcnt(10)
    v_mfma_f32_4x4x4_16b_bf16 v[104:107], v[146:147], v[76:77], 0 cbsz:4 abid:8
    s_nop 0
    v_mfma_f32_4x4x4_16b_bf16 v[108:111], v[146:147], v[78:79], 0 cbsz:4 abid:8
    v_lshlrev_b32_sdwa v137, v15, v121 dst_sel:DWORD dst_unused:UNUSED_PAD src0_sel:DWORD src1_sel:WORD_1
    ds_read_u16_d16_hi v128, v136 offset:32768
    ds_read_u16_d16_hi v129, v137 offset:32768
    s_waitcnt lgkmcnt(2)
    s_set_gpr_idx_on s50, 0xc
    v_pk_fma_f32 v[16:17], v[132:133], v[96:97], v[16:17] op_sel:[0,0,0] op_sel_hi:[0,1,1]
    v_pk_fma_f32 v[18:19], v[132:133], v[98:99], v[18:19] op_sel:[0,0,0] op_sel_hi:[0,1,1]
    v_pk_fma_f32 v[20:21], v[134:135], v[100:101], v[20:21] op_sel:[0,0,0] op_sel_hi:[0,1,1]
    v_pk_fma_f32 v[22:23], v[134:135], v[102:103], v[22:23] op_sel:[0,0,0] op_sel_hi:[0,1,1]
    s_set_gpr_idx_off
    s_sub_u32 s32, s32, 1
    s_cbranch_scc1 MAIN_DONE
    v_lshlrev_b32_sdwa v138, v15, v124 dst_sel:DWORD dst_unused:UNUSED_PAD src0_sel:DWORD src1_sel:WORD_1
    s_waitcnt vmcnt(9)
    v_mfma_f32_4x4x4_16b_bf16 v[96:99], v[140:141], v[80:81], 0 cbsz:4 abid:9
    s_nop 0
    v_mfma_f32_4x4x4_16b_bf16 v[100:103], v[140:141], v[82:83], 0 cbsz:4 abid:9
    v_lshlrev_b32_sdwa v139, v15, v125 dst_sel:DWORD dst_unused:UNUSED_PAD src0_sel:DWORD src1_sel:WORD_1
    ds_read_u16_d16_hi v130, v138 offset:32768
    ds_read_u16_d16_hi v131, v139 offset:32768
    s_set_gpr_idx_on s51, 0xc
    v_pk_fma_f32 v[16:17], v[132:133], v[104:105], v[16:17] op_sel:[1,0,0] op_sel_hi:[1,1,1]
    v_pk_fma_f32 v[18:19], v[132:133], v[106:107], v[18:19] op_sel:[1,0,0] op_sel_hi:[1,1,1]
    v_pk_fma_f32 v[20:21], v[134:135], v[108:109], v[20:21] op_sel:[1,0,0] op_sel_hi:[1,1,1]
    v_pk_fma_f32 v[22:23], v[134:135], v[110:111], v[22:23] op_sel:[1,0,0] op_sel_hi:[1,1,1]
    s_set_gpr_idx_off
    s_sub_u32 s32, s32, 1
    s_cbranch_scc1 MAIN_DONE
    v_mfma_f32_4x4x4_16b_bf16 v[116:119], v[172:173], v[178:179], 0 cbsz:4 abid:10
    v_lshlrev_b32_sdwa v136, v15, v122 dst_sel:DWORD dst_unused:UNUSED_PAD src0_sel:DWORD src1_sel:WORD_1
    s_waitcnt vmcnt(8)
    v_mfma_f32_4x4x4_16b_bf16 v[104:107], v[142:143], v[84:85], 0 cbsz:4 abid:9
    s_nop 0
    v_mfma_f32_4x4x4_16b_bf16 v[108:111], v[142:143], v[86:87], 0 cbsz:4 abid:9
    v_lshlrev_b32_sdwa v137, v15, v123 dst_sel:DWORD dst_unused:UNUSED_PAD src0_sel:DWORD src1_sel:WORD_1
    ds_read_u16_d16_hi v132, v136 offset:32768
    ds_read_u16_d16_hi v133, v137 offset:32768
    s_waitcnt lgkmcnt(2)
    s_set_gpr_idx_on s52, 0xc
    v_pk_fma_f32 v[16:17], v[128:129], v[96:97], v[16:17] op_sel:[0,0,0] op_sel_hi:[0,1,1]
    v_pk_fma_f32 v[18:19], v[128:129], v[98:99], v[18:19] op_sel:[0,0,0] op_sel_hi:[0,1,1]
    v_pk_fma_f32 v[20:21], v[130:131], v[100:101], v[20:21] op_sel:[0,0,0] op_sel_hi:[0,1,1]
    v_pk_fma_f32 v[22:23], v[130:131], v[102:103], v[22:23] op_sel:[0,0,0] op_sel_hi:[0,1,1]
    s_set_gpr_idx_off
    s_sub_u32 s32, s32, 1
    s_cbranch_scc1 MAIN_DONE
    v_lshlrev_b32_sdwa v138, v15, v126 dst_sel:DWORD dst_unused:UNUSED_PAD src0_sel:DWORD src1_sel:WORD_1
    v_mfma_f32_4x4x4_16b_bf16 v[96:99], v[144:145], v[88:89], 0 cbsz:4 abid:9
    s_nop 0
    v_mfma_f32_4x4x4_16b_bf16 v[100:103], v[144:145], v[90:91], 0 cbsz:4 abid:9
    v_lshlrev_b32_sdwa v139, v15, v127 dst_sel:DWORD dst_unused:UNUSED_PAD src0_sel:DWORD src1_sel:WORD_1
    ds_read_u16_d16_hi v134, v138 offset:32768
    ds_read_u16_d16_hi v135, v139 offset:32768
    s_set_gpr_idx_on s53, 0xc
    v_pk_fma_f32 v[16:17], v[128:129], v[104:105], v[16:17] op_sel:[1,0,0] op_sel_hi:[1,1,1]
    v_pk_fma_f32 v[18:19], v[128:129], v[106:107], v[18:19] op_sel:[1,0,0] op_sel_hi:[1,1,1]
    v_pk_fma_f32 v[20:21], v[130:131], v[108:109], v[20:21] op_sel:[1,0,0] op_sel_hi:[1,1,1]
    v_pk_fma_f32 v[22:23], v[130:131], v[110:111], v[22:23] op_sel:[1,0,0] op_sel_hi:[1,1,1]
    s_set_gpr_idx_off
    s_branch MAIN_DONE
B_36:
    buffer_load_dwordx4 v[188:191], v1, s[16:19], s10 offen offset:0 sc1
    buffer_load_dwordx4 v[192:195], v1, s[16:19], s10 offen offset:1024 sc1
    buffer_load_dwordx4 v[196:199], v1, s[16:19], s10 offen offset:2048 sc1
    buffer_load_dwordx4 v[200:203], v1, s[16:19], s10 offen offset:3072 sc1
    buffer_load_dwordx4 v[204:207], v1, s[16:19], s11 offen offset:0 sc1
    buffer_load_dwordx4 v[208:211], v1, s[16:19], s11 offen offset:1024 sc1
    buffer_load_dwordx4 v[212:215], v1, s[16:19], s11 offen offset:2048 sc1
    buffer_load_dwordx4 v[216:219], v1, s[16:19], s11 offen offset:3072 sc1
    s_sub_u32 s32, s32, 1
    s_cbranch_scc1 MAIN_DONE
    v_mfma_f32_4x4x4_16b_bf16 v[116:119], v[172:173], v[178:179], 0 cbsz:4 abid:10
    v_lshlrev_b32_sdwa v136, v15, v122 dst_sel:DWORD dst_unused:UNUSED_PAD src0_sel:DWORD src1_sel:WORD_1
    s_waitcnt vmcnt(12)
    v_mfma_f32_4x4x4_16b_bf16 v[104:107], v[142:143], v[84:85], 0 cbsz:4 abid:9
    s_nop 0
    v_mfma_f32_4x4x4_16b_bf16 v[108:111], v[142:143], v[86:87], 0 cbsz:4 abid:9
    v_lshlrev_b32_sdwa v137, v15, v123 dst_sel:DWORD dst_unused:UNUSED_PAD src0_sel:DWORD src1_sel:WORD_1
    ds_read_u16_d16_hi v132, v136 offset:32768
    ds_read_u16_d16_hi v133, v137 offset:32768
    s_waitcnt lgkmcnt(2)
    s_set_gpr_idx_on s52, 0xc
    v_pk_fma_f32 v[16:17], v[128:129], v[96:97], v[16:17] op_sel:[0,0,0] op_sel_hi:[0,1,1]
    v_pk_fma_f32 v[18:19], v[128:129], v[98:99], v[18:19] op_sel:[0,0,0] op_sel_hi:[0,1,1]
    v_pk_fma_f32 v[20:21], v[130:131], v[100:101], v[20:21] op_sel:[0,0,0] op_sel_hi:[0,1,1]
    v_pk_fma_f32 v[22:23], v[130:131], v[102:103], v[22:23] op_sel:[0,0,0] op_sel_hi:[0,1,1]
    s_set_gpr_idx_off
    s_sub_u32 s32, s32, 1
    s_cbranch_scc1 MAIN_DONE
    v_lshlrev_b32_sdwa v138, v15, v126 dst_sel:DWORD dst_unused:UNUSED_PAD src0_sel:DWORD src1_sel:WORD_1
    s_waitcnt vmcnt(11)
    v_mfma_f32_4x4x4_16b_bf16 v[96:99], v[144:145], v[88:89], 0 cbsz:4 abid:9
    s_nop 0
    v_mfma_f32_4x4x4_16b_bf16 v[100:103], v[144:145], v[90:91], 0 cbsz:4 abid:9
    v_lshlrev_b32_sdwa v139, v15, v127 dst_sel:DWORD dst_unused:UNUSED_PAD src0_sel:DWORD src1_sel:WORD_1
    ds_read_u16_d16_hi v134, v138 offset:32768
    ds_read_u16_d16_hi v135, v139 offset:32768
    s_set_gpr_idx_on s53, 0xc
    v_pk_fma_f32 v[16:17], v[128:129], v[104:105], v[16:17] op_sel:[1,0,0] op_sel_hi:[1,1,1]
    v_pk_fma_f32 v[18:19], v[128:129], v[106:107], v[18:19] op_sel:[1,0,0] op_sel_hi:[1,1,1]
    v_pk_fma_f32 v[20:21], v[130:131], v[108:109], v[20:21] op_sel:[1,0,0] op_sel_hi:[1,1,1]
    v_pk_fma_f32 v[22:23], v[130:131], v[110:111], v[22:23] op_sel:[1,0,0] op_sel_hi:[1,1,1]
    s_set_gpr_idx_off
    s_sub_u32 s32, s32, 1
    s_cbranch_scc1 MAIN_DONE
    v_mfma_f32_4x4x4_16b_bf16 v[120:123], v[172:173], v[176:177], 0 cbsz:4 abid:11
    v_lshlrev_b32_sdwa v136, v15, v112 dst_sel:DWORD dst_unused:UNUSED_PAD src0_sel:DWORD src1_sel:WORD_1
    s_waitcnt vmcnt(10)
    v_mfma_f32_4x4x4_16b_bf16 v[104:107], v[146:147], v[92:93], 0 cbsz:4 abid:9
    s_nop 0
    v_mfma_f32_4x4x4_16b_bf16 v[108:111], v[146:147], v[94:95], 0 cbsz:4 abid:9
    v_lshlrev_b32_sdwa v137, v15, v113 dst_sel:DWORD dst_unused:UNUSED_PAD src0_sel:DWORD src1_sel:WORD_1
    ds_read_u16_d16_hi v128, v136 offset:32768
    ds_read_u16_d16_hi v129, v137 offset:32768
    s_waitcnt lgkmcnt(2)
    s_set_gpr_idx_on s54, 0xc
    v_pk_fma_f32 v[16:17], v[132:133], v[96:97], v[16:17] op_sel:[0,0,0] op_sel_hi:[0,1,1]
    v_pk_fma_f32 v[18:19], v[132:133], v[98:99], v[18:19] op_sel:[0,0,0] op_sel_hi:[0,1,1]
    v_pk_fma_f32 v[20:21], v[134:135], v[100:101], v[20:21] op_sel:[0,0,0] op_sel_hi:[0,1,1]
    v_pk_fma_f32 v[22:23], v[134:135], v[102:103], v[22:23] op_sel:[0,0,0] op_sel_hi:[0,1,1]
    s_set_gpr_idx_off
    s_sub_u32 s32, s32, 1
    s_cbranch_scc1 MAIN_DONE
    v_lshlrev_b32_sdwa v138, v15, v116 dst_sel:DWORD dst_unused:UNUSED_PAD src0_sel:DWORD src1_sel:WORD_1
    s_waitcnt vmcnt(9)
    v_mfma_f32_4x4x4_16b_bf16 v[96:99], v[140:141], v[64:65], 0 cbsz:4 abid:10
    s_nop 0
    v_mfma_f32_4x4x4_16b_bf16 v[100:103], v[140:141], v[66:67], 0 cbsz:4 abid:10
    v_lshlrev_b32_sdwa v139, v15, v117 dst_sel:DWORD dst_unused:UNUSED_PAD src0_sel:DWORD src1_sel:WORD_1
    ds_read_u16_d16_hi v130, v138 offset:32768
    ds_read_u16_d16_hi v131, v139 offset:32768
    s_set_gpr_idx_on s55, 0xc
    v_pk_fma_f32 v[16:17], v[132:133], v[104:105], v[16:17] op_sel:[1,0,0] op_sel_hi:[1,1,1]
    v_pk_fma_f32 v[18:19], v[132:133], v[106:107], v[18:19] op_sel:[1,0,0] op_sel_hi:[1,1,1]
    v_pk_fma_f32 v[20:21], v[134:135], v[108:109], v[20:21] op_sel:[1,0,0] op_sel_hi:[1,1,1]
    v_pk_fma_f32 v[22:23], v[134:135], v[110:111], v[22:23] op_sel:[1,0,0] op_sel_hi:[1,1,1]
    s_set_gpr_idx_off
    s_sub_u32 s32, s32, 1
    s_cbranch_scc1 MAIN_DONE
    v_mfma_f32_4x4x4_16b_bf16 v[124:127], v[172:173], v[178:179], 0 cbsz:4 abid:11
    v_lshlrev_b32_sdwa v136, v15, v114 dst_sel:DWORD dst_unused:UNUSED_PAD src0_sel:DWORD src1_sel:WORD_1
    s_waitcnt vmcnt(8)
    v_mfma_f32_4x4x4_16b_bf16 v[104:107], v[142:143], v[68:69], 0 cbsz:4 abid:10
    s_nop 0
    v_mfma_f32_4x4x4_16b_bf16 v[108:111], v[142:143], v[70:71], 0 cbsz:4 abid:10
    v_lshlrev_b32_sdwa v137, v15, v115 dst_sel:DWORD dst_unused:UNUSED_PAD src0_sel:DWORD src1_sel:WORD_1
    ds_read_u16_d16_hi v132, v136 offset:32768
    ds_read_u16_d16_hi v133, v137 offset:32768
    s_waitcnt lgkmcnt(2)
    s_set_gpr_idx_on s56, 0xc
    v_pk_fma_f32 v[16:17], v[128:129], v[96:97], v[16:17] op_sel:[0,0,0] op_sel_hi:[0,1,1]
    v_pk_fma_f32 v[18:19], v[128:129], v[98:99], v[18:19] op_sel:[0,0,0] op_sel_hi:[0,1,1]
    v_pk_fma_f32 v[20:21], v[130:131], v[100:101], v[20:21] op_sel:[0,0,0] op_sel_hi:[0,1,1]
    v_pk_fma_f32 v[22:23], v[130:131], v[102:103], v[22:23] op_sel:[0,0,0] op_sel_hi:[0,1,1]
    s_set_gpr_idx_off
    s_sub_u32 s32, s32, 1
    s_cbranch_scc1 MAIN_DONE
    v_mfma_f32_4x4x4_16b_bf16 v[148:151], v[168:169], v[180:181], 0
    v_lshlrev_b32_sdwa v138, v15, v118 dst_sel:DWORD dst_unused:UNUSED_PAD src0_sel:DWORD src1_sel:WORD_1
    v_mfma_f32_4x4x4_16b_bf16 v[96:99], v[144:145], v[72:73], 0 cbsz:4 abid:10
    s_nop 0
    v_mfma_f32_4x4x4_16b_bf16 v[100:103], v[144:145], v[74:75], 0 cbsz:4 abid:10
    v_lshlrev_b32_sdwa v139, v15, v119 dst_sel:DWORD dst_unused:UNUSED_PAD src0_sel:DWORD src1_sel:WORD_1
    ds_read_u16_d16_hi v134, v138 offset:32768
    ds_read_u16_d16_hi v135, v139 offset:32768
    s_set_gpr_idx_on s57, 0xc
    v_pk_fma_f32 v[16:17], v[128:129], v[104:105], v[16:17] op_sel:[1,0,0] op_sel_hi:[1,1,1]
    v_pk_fma_f32 v[18:19], v[128:129], v[106:107], v[18:19] op_sel:[1,0,0] op_sel_hi:[1,1,1]
    v_pk_fma_f32 v[20:21], v[130:131], v[108:109], v[20:21] op_sel:[1,0,0] op_sel_hi:[1,1,1]
    v_pk_fma_f32 v[22:23], v[130:131], v[110:111], v[22:23] op_sel:[1,0,0] op_sel_hi:[1,1,1]
    s_set_gpr_idx_off
    s_branch MAIN_DONE
B_40:
    buffer_load_dwordx4 v[188:191], v1, s[16:19], s10 offen offset:0 sc1
    buffer_load_dwordx4 v[192:195], v1, s[16:19], s10 offen offset:1024 sc1
    buffer_load_dwordx4 v[196:199], v1, s[16:19], s10 offen offset:2048 sc1
    buffer_load_dwordx4 v[200:203], v1, s[16:19], s10 offen offset:3072 sc1
    buffer_load_dwordx4 v[204:207], v1, s[16:19], s11 offen offset:0 sc1
    buffer_load_dwordx4 v[208:211], v1, s[16:19], s11 offen offset:1024 sc1
    buffer_load_dwordx4 v[212:215], v1, s[16:19], s11 offen offset:2048 sc1
    buffer_load_dwordx4 v[216:219], v1, s[16:19], s11 offen offset:3072 sc1
    s_sub_u32 s32, s32, 1
    s_cbranch_scc1 MAIN_DONE
    v_mfma_f32_4x4x4_16b_bf16 v[124:127], v[172:173], v[178:179], 0 cbsz:4 abid:11
    v_lshlrev_b32_sdwa v136, v15, v114 dst_sel:DWORD dst_unused:UNUSED_PAD src0_sel:DWORD src1_sel:WORD_1
    s_waitcnt vmcnt(12)
    v_mfma_f32_4x4x4_16b_bf16 v[104:107], v[142:143], v[68:69], 0 cbsz:4 abid:10
    s_nop 0
    v_mfma_f32_4x4x4_16b_bf16 v[108:111], v[142:143], v[70:71], 0 cbsz:4 abid:10
    v_lshlrev_b32_sdwa v137, v15, v115 dst_sel:DWORD dst_unused:UNUSED_PAD src0_sel:DWORD src1_sel:WORD_1
    ds_read_u16_d16_hi v132, v136 offset:32768
    ds_read_u16_d16_hi v133, v137 offset:32768
    s_waitcnt lgkmcnt(2)
    s_set_gpr_idx_on s56, 0xc
    v_pk_fma_f32 v[16:17], v[128:129], v[96:97], v[16:17] op_sel:[0,0,0] op_sel_hi:[0,1,1]
    v_pk_fma_f32 v[18:19], v[128:129], v[98:99], v[18:19] op_sel:[0,0,0] op_sel_hi:[0,1,1]
    v_pk_fma_f32 v[20:21], v[130:131], v[100:101], v[20:21] op_sel:[0,0,0] op_sel_hi:[0,1,1]
    v_pk_fma_f32 v[22:23], v[130:131], v[102:103], v[22:23] op_sel:[0,0,0] op_sel_hi:[0,1,1]
    s_set_gpr_idx_off
    s_sub_u32 s32, s32, 1
    s_cbranch_scc1 MAIN_DONE
    v_mfma_f32_4x4x4_16b_bf16 v[148:151], v[168:169], v[180:181], 0
    v_lshlrev_b32_sdwa v138, v15, v118 dst_sel:DWORD dst_unused:UNUSED_PAD src0_sel:DWORD src1_sel:WORD_1
    s_waitcnt vmcnt(11)
    v_mfma_f32_4x4x4_16b_bf16 v[96:99], v[144:145], v[72:73], 0 cbsz:4 abid:10
    s_nop 0
    v_mfma_f32_4x4x4_16b_bf16 v[100:103], v[144:145], v[74:75], 0 cbsz:4 abid:10
    v_lshlrev_b32_sdwa v139, v15, v119 dst_sel:DWORD dst_unused:UNUSED_PAD src0_sel:DWORD src1_sel:WORD_1
    ds_read_u16_d16_hi v134, v138 offset:32768
    ds_read_u16_d16_hi v135, v139 offset:32768
    s_set_gpr_idx_on s57, 0xc
    v_pk_fma_f32 v[16:17], v[128:129], v[104:105], v[16:17] op_sel:[1,0,0] op_sel_hi:[1,1,1]
    v_pk_fma_f32 v[18:19], v[128:129], v[106:107], v[18:19] op_sel:[1,0,0] op_sel_hi:[1,1,1]
    v_pk_fma_f32 v[20:21], v[130:131], v[108:109], v[20:21] op_sel:[1,0,0] op_sel_hi:[1,1,1]
    v_pk_fma_f32 v[22:23], v[130:131], v[110:111], v[22:23] op_sel:[1,0,0] op_sel_hi:[1,1,1]
    s_set_gpr_idx_off
    s_sub_u32 s32, s32, 1
    s_cbranch_scc1 MAIN_DONE
    v_mfma_f32_4x4x4_16b_bf16 v[112:115], v[172:173], v[176:177], 0 cbsz:4 abid:12
    v_lshlrev_b32_sdwa v136, v15, v120 dst_sel:DWORD dst_unused:UNUSED_PAD src0_sel:DWORD src1_sel:WORD_1
    s_waitcnt vmcnt(10)
    v_mfma_f32_4x4x4_16b_bf16 v[104:107], v[146:147], v[76:77], 0 cbsz:4 abid:10
    s_nop 0
    v_mfma_f32_4x4x4_16b_bf16 v[108:111], v[146:147], v[78:79], 0 cbsz:4 abid:10
    v_lshlrev_b32_sdwa v137, v15, v121 dst_sel:DWORD dst_unused:UNUSED_PAD src0_sel:DWORD src1_sel:WORD_1
    ds_read_u16_d16_hi v128, v136 offset:32768
    ds_read_u16_d16_hi v129, v137 offset:32768
    s_waitcnt lgkmcnt(2)
    s_set_gpr_idx_on s58, 0xc
    v_pk_fma_f32 v[16:17], v[132:133], v[96:97], v[16:17] op_sel:[0,0,0] op_sel_hi:[0,1,1]
    v_pk_fma_f32 v[18:19], v[132:133], v[98:99], v[18:19] op_sel:[0,0,0] op_sel_hi:[0,1,1]
    v_pk_fma_f32 v[20:21], v[134:135], v[100:101], v[20:21] op_sel:[0,0,0] op_sel_hi:[0,1,1]
    v_pk_fma_f32 v[22:23], v[134:135], v[102:103], v[22:23] op_sel:[0,0,0] op_sel_hi:[0,1,1]
    s_set_gpr_idx_off
    s_sub_u32 s32, s32, 1
    s_cbranch_scc1 MAIN_DONE
    v_mfma_f32_4x4x4_16b_bf16 v[152:155], v[168:169], v[182:183], 0
    v_lshlrev_b32_sdwa v138, v15, v124 dst_sel:DWORD dst_unused:UNUSED_PAD src0_sel:DWORD src1_sel:WORD_1
    s_waitcnt vmcnt(9)
    v_mfma_f32_4x4x4_16b_bf16 v[96:99], v[140:141], v[80:81], 0 cbsz:4 abid:11
    s_nop 0
    v_mfma_f32_4x4x4_16b_bf16 v[100:103], v[140:141], v[82:83], 0 cbsz:4 abid:11
    v_lshlrev_b32_sdwa v139, v15, v125 dst_sel:DWORD dst_unused:UNUSED_PAD src0_sel:DWORD src1_sel:WORD_1
    ds_read_u16_d16_hi v130, v138 offset:32768
    ds_read_u16_d16_hi v131, v139 offset:32768
    s_set_gpr_idx_on s59, 0xc
    v_pk_fma_f32 v[16:17], v[132:133], v[104:105], v[16:17] op_sel:[1,0,0] op_sel_hi:[1,1,1]
    v_pk_fma_f32 v[18:19], v[132:133], v[106:107], v[18:19] op_sel:[1,0,0] op_sel_hi:[1,1,1]
    v_pk_fma_f32 v[20:21], v[134:135], v[108:109], v[20:21] op_sel:[1,0,0] op_sel_hi:[1,1,1]
    v_pk_fma_f32 v[22:23], v[134:135], v[110:111], v[22:23] op_sel:[1,0,0] op_sel_hi:[1,1,1]
    s_set_gpr_idx_off
    s_sub_u32 s32, s32, 1
    s_cbranch_scc1 MAIN_DONE
    v_mfma_f32_4x4x4_16b_bf16 v[116:119], v[172:173], v[178:179], 0 cbsz:4 abid:12
    v_lshlrev_b32_sdwa v136, v15, v122 dst_sel:DWORD dst_unused:UNUSED_PAD src0_sel:DWORD src1_sel:WORD_1
    s_waitcnt vmcnt(8)
    v_mfma_f32_4x4x4_16b_bf16 v[104:107], v[142:143], v[84:85], 0 cbsz:4 abid:11
    s_nop 0
    v_mfma_f32_4x4x4_16b_bf16 v[108:111], v[142:143], v[86:87], 0 cbsz:4 abid:11
    v_lshlrev_b32_sdwa v137, v15, v123 dst_sel:DWORD dst_unused:UNUSED_PAD src0_sel:DWORD src1_sel:WORD_1
    ds_read_u16_d16_hi v132, v136 offset:32768
    ds_read_u16_d16_hi v133, v137 offset:32768
    s_waitcnt lgkmcnt(2)
    s_set_gpr_idx_on s60, 0xc
    v_pk_fma_f32 v[16:17], v[128:129], v[96:97], v[16:17] op_sel:[0,0,0] op_sel_hi:[0,1,1]
    v_pk_fma_f32 v[18:19], v[128:129], v[98:99], v[18:19] op_sel:[0,0,0] op_sel_hi:[0,1,1]
    v_pk_fma_f32 v[20:21], v[130:131], v[100:101], v[20:21] op_sel:[0,0,0] op_sel_hi:[0,1,1]
    v_pk_fma_f32 v[22:23], v[130:131], v[102:103], v[22:23] op_sel:[0,0,0] op_sel_hi:[0,1,1]
    s_set_gpr_idx_off
    s_sub_u32 s32, s32, 1
    s_cbranch_scc1 MAIN_DONE
    v_mfma_f32_4x4x4_16b_bf16 v[156:159], v[168:169], v[184:185], 0
    v_lshlrev_b32_sdwa v138, v15, v126 dst_sel:DWORD dst_unused:UNUSED_PAD src0_sel:DWORD src1_sel:WORD_1
    v_mfma_f32_4x4x4_16b_bf16 v[96:99], v[144:145], v[88:89], 0 cbsz:4 abid:11
    s_nop 0
    v_mfma_f32_4x4x4_16b_bf16 v[100:103], v[144:145], v[90:91], 0 cbsz:4 abid:11
    v_lshlrev_b32_sdwa v139, v15, v127 dst_sel:DWORD dst_unused:UNUSED_PAD src0_sel:DWORD src1_sel:WORD_1
    ds_read_u16_d16_hi v134, v138 offset:32768
    ds_read_u16_d16_hi v135, v139 offset:32768
    s_set_gpr_idx_on s61, 0xc
    v_pk_fma_f32 v[16:17], v[128:129], v[104:105], v[16:17] op_sel:[1,0,0] op_sel_hi:[1,1,1]
    v_pk_fma_f32 v[18:19], v[128:129], v[106:107], v[18:19] op_sel:[1,0,0] op_sel_hi:[1,1,1]
    v_pk_fma_f32 v[20:21], v[130:131], v[108:109], v[20:21] op_sel:[1,0,0] op_sel_hi:[1,1,1]
    v_pk_fma_f32 v[22:23], v[130:131], v[110:111], v[22:23] op_sel:[1,0,0] op_sel_hi:[1,1,1]
    s_set_gpr_idx_off
    s_branch MAIN_DONE
B_44:
    buffer_load_dwordx4 v[188:191], v1, s[16:19], s10 offen offset:0 sc1
    buffer_load_dwordx4 v[192:195], v1, s[16:19], s10 offen offset:1024 sc1
    buffer_load_dwordx4 v[196:199], v1, s[16:19], s10 offen offset:2048 sc1
    buffer_load_dwordx4 v[200:203], v1, s[16:19], s10 offen offset:3072 sc1
    buffer_load_dwordx4 v[204:207], v1, s[16:19], s11 offen offset:0 sc1
    buffer_load_dwordx4 v[208:211], v1, s[16:19], s11 offen offset:1024 sc1
    buffer_load_dwordx4 v[212:215], v1, s[16:19], s11 offen offset:2048 sc1
    buffer_load_dwordx4 v[216:219], v1, s[16:19], s11 offen offset:3072 sc1
    s_sub_u32 s32, s32, 1
    s_cbranch_scc1 MAIN_DONE
    v_mfma_f32_4x4x4_16b_bf16 v[116:119], v[172:173], v[178:179], 0 cbsz:4 abid:12
    v_lshlrev_b32_sdwa v136, v15, v122 dst_sel:DWORD dst_unused:UNUSED_PAD src0_sel:DWORD src1_sel:WORD_1
    s_waitcnt vmcnt(12)
    v_mfma_f32_4x4x4_16b_bf16 v[104:107], v[142:143], v[84:85], 0 cbsz:4 abid:11
    s_nop 0
    v_mfma_f32_4x4x4_16b_bf16 v[108:111], v[142:143], v[86:87], 0 cbsz:4 abid:11
    v_lshlrev_b32_sdwa v137, v15, v123 dst_sel:DWORD dst_unused:UNUSED_PAD src0_sel:DWORD src1_sel:WORD_1
    ds_read_u16_d16_hi v132, v136 offset:32768
    ds_read_u16_d16_hi v133, v137 offset:32768
    s_waitcnt lgkmcnt(2)
    s_set_gpr_idx_on s60, 0xc
    v_pk_fma_f32 v[16:17], v[128:129], v[96:97], v[16:17] op_sel:[0,0,0] op_sel_hi:[0,1,1]
    v_pk_fma_f32 v[18:19], v[128:129], v[98:99], v[18:19] op_sel:[0,0,0] op_sel_hi:[0,1,1]
    v_pk_fma_f32 v[20:21], v[130:131], v[100:101], v[20:21] op_sel:[0,0,0] op_sel_hi:[0,1,1]
    v_pk_fma_f32 v[22:23], v[130:131], v[102:103], v[22:23] op_sel:[0,0,0] op_sel_hi:[0,1,1]
    s_set_gpr_idx_off
    s_sub_u32 s32, s32, 1
    s_cbranch_scc1 MAIN_DONE
    v_mfma_f32_4x4x4_16b_bf16 v[156:159], v[168:169], v[184:185], 0
    v_lshlrev_b32_sdwa v138, v15, v126 dst_sel:DWORD dst_unused:UNUSED_PAD src0_sel:DWORD src1_sel:WORD_1
    s_waitcnt vmcnt(11)
    v_mfma_f32_4x4x4_16b_bf16 v[96:99], v[144:145], v[88:89], 0 cbsz:4 abid:11
    s_nop 0
    v_mfma_f32_4x4x4_16b_bf16 v[100:103], v[144:145], v[90:91], 0 cbsz:4 abid:11
    v_lshlrev_b32_sdwa v139, v15, v127 dst_sel:DWORD dst_unused:UNUSED_PAD src0_sel:DWORD src1_sel:WORD_1
    ds_read_u16_d16_hi v134, v138 offset:32768
    ds_read_u16_d16_hi v135, v139 offset:32768
    s_set_gpr_idx_on s61, 0xc
    v_pk_fma_f32 v[16:17], v[128:129], v[104:105], v[16:17] op_sel:[1,0,0] op_sel_hi:[1,1,1]
    v_pk_fma_f32 v[18:19], v[128:129], v[106:107], v[18:19] op_sel:[1,0,0] op_sel_hi:[1,1,1]
    v_pk_fma_f32 v[20:21], v[130:131], v[108:109], v[20:21] op_sel:[1,0,0] op_sel_hi:[1,1,1]
    v_pk_fma_f32 v[22:23], v[130:131], v[110:111], v[22:23] op_sel:[1,0,0] op_sel_hi:[1,1,1]
    s_set_gpr_idx_off
    s_sub_u32 s32, s32, 1
    s_cbranch_scc1 MAIN_DONE
    v_mfma_f32_4x4x4_16b_bf16 v[120:123], v[172:173], v[176:177], 0 cbsz:4 abid:13
    v_lshlrev_b32_sdwa v136, v15, v112 dst_sel:DWORD dst_unused:UNUSED_PAD src0_sel:DWORD src1_sel:WORD_1
    s_waitcnt vmcnt(10)
    v_mfma_f32_4x4x4_16b_bf16 v[104:107], v[146:147], v[92:93], 0 cbsz:4 abid:11
    s_nop 0
    v_mfma_f32_4x4x4_16b_bf16 v[108:111], v[146:147], v[94:95], 0 cbsz:4 abid:11
    v_lshlrev_b32_sdwa v137, v15, v113 dst_sel:DWORD dst_unused:UNUSED_PAD src0_sel:DWORD src1_sel:WORD_1
    ds_read_u16_d16_hi v128, v136 offset:32768
    ds_read_u16_d16_hi v129, v137 offset:32768
    s_waitcnt lgkmcnt(2)
    s_set_gpr_idx_on s62, 0xc
    v_pk_fma_f32 v[16:17], v[132:133], v[96:97], v[16:17] op_sel:[0,0,0] op_sel_hi:[0,1,1]
    v_pk_fma_f32 v[18:19], v[132:133], v[98:99], v[18:19] op_sel:[0,0,0] op_sel_hi:[0,1,1]
    v_pk_fma_f32 v[20:21], v[134:135], v[100:101], v[20:21] op_sel:[0,0,0] op_sel_hi:[0,1,1]
    v_pk_fma_f32 v[22:23], v[134:135], v[102:103], v[22:23] op_sel:[0,0,0] op_sel_hi:[0,1,1]
    s_set_gpr_idx_off
    s_sub_u32 s32, s32, 1
    s_cbranch_scc1 MAIN_DONE
    v_mfma_f32_4x4x4_16b_bf16 v[160:163], v[168:169], v[186:187], 0
    v_lshlrev_b32_sdwa v138, v15, v116 dst_sel:DWORD dst_unused:UNUSED_PAD src0_sel:DWORD src1_sel:WORD_1
    s_waitcnt vmcnt(9)
    v_mfma_f32_4x4x4_16b_bf16 v[96:99], v[140:141], v[64:65], 0 cbsz:4 abid:12
    s_nop 0
    v_mfma_f32_4x4x4_16b_bf16 v[100:103], v[140:141], v[66:67], 0 cbsz:4 abid:12
    v_lshlrev_b32_sdwa v139, v15, v117 dst_sel:DWORD dst_unused:UNUSED_PAD src0_sel:DWORD src1_sel:WORD_1
    ds_read_u16_d16_hi v130, v138 offset:32768
    ds_read_u16_d16_hi v131, v139 offset:32768
    s_set_gpr_idx_on s63, 0xc
    v_pk_fma_f32 v[16:17], v[132:133], v[104:105], v[16:17] op_sel:[1,0,0] op_sel_hi:[1,1,1]
    v_pk_fma_f32 v[18:19], v[132:133], v[106:107], v[18:19] op_sel:[1,0,0] op_sel_hi:[1,1,1]
    v_pk_fma_f32 v[20:21], v[134:135], v[108:109], v[20:21] op_sel:[1,0,0] op_sel_hi:[1,1,1]
    v_pk_fma_f32 v[22:23], v[134:135], v[110:111], v[22:23] op_sel:[1,0,0] op_sel_hi:[1,1,1]
    s_set_gpr_idx_off
    s_sub_u32 s32, s32, 1
    s_cbranch_scc1 MAIN_DONE
    v_mfma_f32_4x4x4_16b_bf16 v[124:127], v[172:173], v[178:179], 0 cbsz:4 abid:13
    v_lshlrev_b32_sdwa v136, v15, v114 dst_sel:DWORD dst_unused:UNUSED_PAD src0_sel:DWORD src1_sel:WORD_1
    s_waitcnt vmcnt(8)
    v_mfma_f32_4x4x4_16b_bf16 v[104:107], v[142:143], v[68:69], 0 cbsz:4 abid:12
    s_nop 0
    v_mfma_f32_4x4x4_16b_bf16 v[108:111], v[142:143], v[70:71], 0 cbsz:4 abid:12
    v_lshlrev_b32_sdwa v137, v15, v115 dst_sel:DWORD dst_unused:UNUSED_PAD src0_sel:DWORD src1_sel:WORD_1
    ds_read_u16_d16_hi v132, v136 offset:32768
    ds_read_u16_d16_hi v133, v137 offset:32768
    s_waitcnt lgkmcnt(2)
    s_set_gpr_idx_on s48, 0xc
    v_pk_fma_f32 v[16:17], v[128:129], v[96:97], v[16:17] op_sel:[0,0,0] op_sel_hi:[0,1,1]
    v_pk_fma_f32 v[18:19], v[128:129], v[98:99], v[18:19] op_sel:[0,0,0] op_sel_hi:[0,1,1]
    v_pk_fma_f32 v[20:21], v[130:131], v[100:101], v[20:21] op_sel:[0,0,0] op_sel_hi:[0,1,1]
    v_pk_fma_f32 v[22:23], v[130:131], v[102:103], v[22:23] op_sel:[0,0,0] op_sel_hi:[0,1,1]
    s_set_gpr_idx_off
    s_sub_u32 s32, s32, 1
    s_cbranch_scc1 MAIN_DONE
    v_lshlrev_b32_sdwa v138, v15, v118 dst_sel:DWORD dst_unused:UNUSED_PAD src0_sel:DWORD src1_sel:WORD_1
    v_mfma_f32_4x4x4_16b_bf16 v[96:99], v[144:145], v[72:73], 0 cbsz:4 abid:12
    s_nop 0
    v_mfma_f32_4x4x4_16b_bf16 v[100:103], v[144:145], v[74:75], 0 cbsz:4 abid:12
    v_lshlrev_b32_sdwa v139, v15, v119 dst_sel:DWORD dst_unused:UNUSED_PAD src0_sel:DWORD src1_sel:WORD_1
    ds_read_u16_d16_hi v134, v138 offset:32768
    ds_read_u16_d16_hi v135, v139 offset:32768
    s_set_gpr_idx_on s49, 0xc
    v_pk_fma_f32 v[16:17], v[128:129], v[104:105], v[16:17] op_sel:[1,0,0] op_sel_hi:[1,1,1]
    v_pk_fma_f32 v[18:19], v[128:129], v[106:107], v[18:19] op_sel:[1,0,0] op_sel_hi:[1,1,1]
    v_pk_fma_f32 v[20:21], v[130:131], v[108:109], v[20:21] op_sel:[1,0,0] op_sel_hi:[1,1,1]
    v_pk_fma_f32 v[22:23], v[130:131], v[110:111], v[22:23] op_sel:[1,0,0] op_sel_hi:[1,1,1]
    s_set_gpr_idx_off
    s_branch MAIN_DONE
B_48:
    buffer_load_dwordx4 v[188:191], v1, s[16:19], s10 offen offset:0 sc1
    buffer_load_dwordx4 v[192:195], v1, s[16:19], s10 offen offset:1024 sc1
    buffer_load_dwordx4 v[196:199], v1, s[16:19], s10 offen offset:2048 sc1
    buffer_load_dwordx4 v[200:203], v1, s[16:19], s10 offen offset:3072 sc1
    buffer_load_dwordx4 v[204:207], v1, s[16:19], s11 offen offset:0 sc1
    buffer_load_dwordx4 v[208:211], v1, s[16:19], s11 offen offset:1024 sc1
    buffer_load_dwordx4 v[212:215], v1, s[16:19], s11 offen offset:2048 sc1
    buffer_load_dwordx4 v[216:219], v1, s[16:19], s11 offen offset:3072 sc1
    s_sub_u32 s32, s32, 1
    s_cbranch_scc1 MAIN_DONE
    v_mfma_f32_4x4x4_16b_bf16 v[124:127], v[172:173], v[178:179], 0 cbsz:4 abid:13
    v_lshlrev_b32_sdwa v136, v15, v114 dst_sel:DWORD dst_unused:UNUSED_PAD src0_sel:DWORD src1_sel:WORD_1
    s_waitcnt vmcnt(12)
    v_mfma_f32_4x4x4_16b_bf16 v[104:107], v[142:143], v[68:69], 0 cbsz:4 abid:12
    s_nop 0
    v_mfma_f32_4x4x4_16b_bf16 v[108:111], v[142:143], v[70:71], 0 cbsz:4 abid:12
    v_lshlrev_b32_sdwa v137, v15, v115 dst_sel:DWORD dst_unused:UNUSED_PAD src0_sel:DWORD src1_sel:WORD_1
    ds_read_u16_d16_hi v132, v136 offset:32768
    ds_read_u16_d16_hi v133, v137 offset:32768
    s_waitcnt lgkmcnt(2)
    s_set_gpr_idx_on s48, 0xc
    v_pk_fma_f32 v[16:17], v[128:129], v[96:97], v[16:17] op_sel:[0,0,0] op_sel_hi:[0,1,1]
    v_pk_fma_f32 v[18:19], v[128:129], v[98:99], v[18:19] op_sel:[0,0,0] op_sel_hi:[0,1,1]
    v_pk_fma_f32 v[20:21], v[130:131], v[100:101], v[20:21] op_sel:[0,0,0] op_sel_hi:[0,1,1]
    v_pk_fma_f32 v[22:23], v[130:131], v[102:103], v[22:23] op_sel:[0,0,0] op_sel_hi:[0,1,1]
    s_set_gpr_idx_off
    s_sub_u32 s32, s32, 1
    s_cbranch_scc1 MAIN_DONE
    v_lshlrev_b32_sdwa v138, v15, v118 dst_sel:DWORD dst_unused:UNUSED_PAD src0_sel:DWORD src1_sel:WORD_1
    s_waitcnt vmcnt(11)
    v_mfma_f32_4x4x4_16b_bf16 v[96:99], v[144:145], v[72:73], 0 cbsz:4 abid:12
    s_nop 0
    v_mfma_f32_4x4x4_16b_bf16 v[100:103], v[144:145], v[74:75], 0 cbsz:4 abid:12
    v_lshlrev_b32_sdwa v139, v15, v119 dst_sel:DWORD dst_unused:UNUSED_PAD src0_sel:DWORD src1_sel:WORD_1
    ds_read_u16_d16_hi v134, v138 offset:32768
    ds_read_u16_d16_hi v135, v139 offset:32768
    s_set_gpr_idx_on s49, 0xc
    v_pk_fma_f32 v[16:17], v[128:129], v[104:105], v[16:17] op_sel:[1,0,0] op_sel_hi:[1,1,1]
    v_pk_fma_f32 v[18:19], v[128:129], v[106:107], v[18:19] op_sel:[1,0,0] op_sel_hi:[1,1,1]
    v_pk_fma_f32 v[20:21], v[130:131], v[108:109], v[20:21] op_sel:[1,0,0] op_sel_hi:[1,1,1]
    v_pk_fma_f32 v[22:23], v[130:131], v[110:111], v[22:23] op_sel:[1,0,0] op_sel_hi:[1,1,1]
    s_set_gpr_idx_off
    s_sub_u32 s32, s32, 1
    s_cbranch_scc1 MAIN_DONE
    v_mfma_f32_4x4x4_16b_bf16 v[112:115], v[172:173], v[176:177], 0 cbsz:4 abid:14
    v_lshlrev_b32_sdwa v136, v15, v120 dst_sel:DWORD dst_unused:UNUSED_PAD src0_sel:DWORD src1_sel:WORD_1
    s_waitcnt vmcnt(10)
    v_mfma_f32_4x4x4_16b_bf16 v[104:107], v[146:147], v[76:77], 0 cbsz:4 abid:12
    s_nop 0
    v_mfma_f32_4x4x4_16b_bf16 v[108:111], v[146:147], v[78:79], 0 cbsz:4 abid:12
    v_lshlrev_b32_sdwa v137, v15, v121 dst_sel:DWORD dst_unused:UNUSED_PAD src0_sel:DWORD src1_sel:WORD_1
    ds_read_u16_d16_hi v128, v136 offset:32768
    ds_read_u16_d16_hi v129, v137 offset:32768
    s_waitcnt lgkmcnt(2)
    s_set_gpr_idx_on s50, 0xc
    v_pk_fma_f32 v[16:17], v[132:133], v[96:97], v[16:17] op_sel:[0,0,0] op_sel_hi:[0,1,1]
    v_pk_fma_f32 v[18:19], v[132:133], v[98:99], v[18:19] op_sel:[0,0,0] op_sel_hi:[0,1,1]
    v_pk_fma_f32 v[20:21], v[134:135], v[100:101], v[20:21] op_sel:[0,0,0] op_sel_hi:[0,1,1]
    v_pk_fma_f32 v[22:23], v[134:135], v[102:103], v[22:23] op_sel:[0,0,0] op_sel_hi:[0,1,1]
    s_set_gpr_idx_off
    s_sub_u32 s32, s32, 1
    s_cbranch_scc1 MAIN_DONE
    v_lshlrev_b32_sdwa v138, v15, v124 dst_sel:DWORD dst_unused:UNUSED_PAD src0_sel:DWORD src1_sel:WORD_1
    s_waitcnt vmcnt(9)
    v_mfma_f32_4x4x4_16b_bf16 v[96:99], v[140:141], v[80:81], 0 cbsz:4 abid:13
    s_nop 0
    v_mfma_f32_4x4x4_16b_bf16 v[100:103], v[140:141], v[82:83], 0 cbsz:4 abid:13
    v_lshlrev_b32_sdwa v139, v15, v125 dst_sel:DWORD dst_unused:UNUSED_PAD src0_sel:DWORD src1_sel:WORD_1
    ds_read_u16_d16_hi v130, v138 offset:32768
    ds_read_u16_d16_hi v131, v139 offset:32768
    s_set_gpr_idx_on s51, 0xc
    v_pk_fma_f32 v[16:17], v[132:133], v[104:105], v[16:17] op_sel:[1,0,0] op_sel_hi:[1,1,1]
    v_pk_fma_f32 v[18:19], v[132:133], v[106:107], v[18:19] op_sel:[1,0,0] op_sel_hi:[1,1,1]
    v_pk_fma_f32 v[20:21], v[134:135], v[108:109], v[20:21] op_sel:[1,0,0] op_sel_hi:[1,1,1]
    v_pk_fma_f32 v[22:23], v[134:135], v[110:111], v[22:23] op_sel:[1,0,0] op_sel_hi:[1,1,1]
    s_set_gpr_idx_off
    s_sub_u32 s32, s32, 1
    s_cbranch_scc1 MAIN_DONE
    v_mfma_f32_4x4x4_16b_bf16 v[116:119], v[172:173], v[178:179], 0 cbsz:4 abid:14
    v_lshlrev_b32_sdwa v136, v15, v122 dst_sel:DWORD dst_unused:UNUSED_PAD src0_sel:DWORD src1_sel:WORD_1
    s_waitcnt vmcnt(8)
    v_mfma_f32_4x4x4_16b_bf16 v[104:107], v[142:143], v[84:85], 0 cbsz:4 abid:13
    s_nop 0
    v_mfma_f32_4x4x4_16b_bf16 v[108:111], v[142:143], v[86:87], 0 cbsz:4 abid:13
    v_lshlrev_b32_sdwa v137, v15, v123 dst_sel:DWORD dst_unused:UNUSED_PAD src0_sel:DWORD src1_sel:WORD_1
    ds_read_u16_d16_hi v132, v136 offset:32768
    ds_read_u16_d16_hi v133, v137 offset:32768
    s_waitcnt lgkmcnt(2)
    s_set_gpr_idx_on s52, 0xc
    v_pk_fma_f32 v[16:17], v[128:129], v[96:97], v[16:17] op_sel:[0,0,0] op_sel_hi:[0,1,1]
    v_pk_fma_f32 v[18:19], v[128:129], v[98:99], v[18:19] op_sel:[0,0,0] op_sel_hi:[0,1,1]
    v_pk_fma_f32 v[20:21], v[130:131], v[100:101], v[20:21] op_sel:[0,0,0] op_sel_hi:[0,1,1]
    v_pk_fma_f32 v[22:23], v[130:131], v[102:103], v[22:23] op_sel:[0,0,0] op_sel_hi:[0,1,1]
    s_set_gpr_idx_off
    s_sub_u32 s32, s32, 1
    s_cbranch_scc1 MAIN_DONE
    v_lshlrev_b32_sdwa v138, v15, v126 dst_sel:DWORD dst_unused:UNUSED_PAD src0_sel:DWORD src1_sel:WORD_1
    v_mfma_f32_4x4x4_16b_bf16 v[96:99], v[144:145], v[88:89], 0 cbsz:4 abid:13
    s_nop 0
    v_mfma_f32_4x4x4_16b_bf16 v[100:103], v[144:145], v[90:91], 0 cbsz:4 abid:13
    v_lshlrev_b32_sdwa v139, v15, v127 dst_sel:DWORD dst_unused:UNUSED_PAD src0_sel:DWORD src1_sel:WORD_1
    ds_read_u16_d16_hi v134, v138 offset:32768
    ds_read_u16_d16_hi v135, v139 offset:32768
    s_set_gpr_idx_on s53, 0xc
    v_pk_fma_f32 v[16:17], v[128:129], v[104:105], v[16:17] op_sel:[1,0,0] op_sel_hi:[1,1,1]
    v_pk_fma_f32 v[18:19], v[128:129], v[106:107], v[18:19] op_sel:[1,0,0] op_sel_hi:[1,1,1]
    v_pk_fma_f32 v[20:21], v[130:131], v[108:109], v[20:21] op_sel:[1,0,0] op_sel_hi:[1,1,1]
    v_pk_fma_f32 v[22:23], v[130:131], v[110:111], v[22:23] op_sel:[1,0,0] op_sel_hi:[1,1,1]
    s_set_gpr_idx_off
    s_branch MAIN_DONE
B_52:
    buffer_load_dwordx4 v[188:191], v1, s[16:19], s10 offen offset:0 sc1
    buffer_load_dwordx4 v[192:195], v1, s[16:19], s10 offen offset:1024 sc1
    buffer_load_dwordx4 v[196:199], v1, s[16:19], s10 offen offset:2048 sc1
    buffer_load_dwordx4 v[200:203], v1, s[16:19], s10 offen offset:3072 sc1
    buffer_load_dwordx4 v[204:207], v1, s[16:19], s11 offen offset:0 sc1
    buffer_load_dwordx4 v[208:211], v1, s[16:19], s11 offen offset:1024 sc1
    buffer_load_dwordx4 v[212:215], v1, s[16:19], s11 offen offset:2048 sc1
    buffer_load_dwordx4 v[216:219], v1, s[16:19], s11 offen offset:3072 sc1
    s_sub_u32 s32, s32, 1
    s_cbranch_scc1 MAIN_DONE
    v_mfma_f32_4x4x4_16b_bf16 v[116:119], v[172:173], v[178:179], 0 cbsz:4 abid:14
    v_lshlrev_b32_sdwa v136, v15, v122 dst_sel:DWORD dst_unused:UNUSED_PAD src0_sel:DWORD src1_sel:WORD_1
    s_waitcnt vmcnt(12)
    v_mfma_f32_4x4x4_16b_bf16 v[104:107], v[142:143], v[84:85], 0 cbsz:4 abid:13
    s_nop 0
    v_mfma_f32_4x4x4_16b_bf16 v[108:111], v[142:143], v[86:87], 0 cbsz:4 abid:13
    v_lshlrev_b32_sdwa v137, v15, v123 dst_sel:DWORD dst_unused:UNUSED_PAD src0_sel:DWORD src1_sel:WORD_1
    ds_read_u16_d16_hi v132, v136 offset:32768
    ds_read_u16_d16_hi v133, v137 offset:32768
    s_waitcnt lgkmcnt(2)
    s_set_gpr_idx_on s52, 0xc
    v_pk_fma_f32 v[16:17], v[128:129], v[96:97], v[16:17] op_sel:[0,0,0] op_sel_hi:[0,1,1]
    v_pk_fma_f32 v[18:19], v[128:129], v[98:99], v[18:19] op_sel:[0,0,0] op_sel_hi:[0,1,1]
    v_pk_fma_f32 v[20:21], v[130:131], v[100:101], v[20:21] op_sel:[0,0,0] op_sel_hi:[0,1,1]
    v_pk_fma_f32 v[22:23], v[130:131], v[102:103], v[22:23] op_sel:[0,0,0] op_sel_hi:[0,1,1]
    s_set_gpr_idx_off
    s_sub_u32 s32, s32, 1
    s_cbranch_scc1 MAIN_DONE
    v_lshlrev_b32_sdwa v138, v15, v126 dst_sel:DWORD dst_unused:UNUSED_PAD src0_sel:DWORD src1_sel:WORD_1
    s_waitcnt vmcnt(11)
    v_mfma_f32_4x4x4_16b_bf16 v[96:99], v[144:145], v[88:89], 0 cbsz:4 abid:13
    s_nop 0
    v_mfma_f32_4x4x4_16b_bf16 v[100:103], v[144:145], v[90:91], 0 cbsz:4 abid:13
    v_lshlrev_b32_sdwa v139, v15, v127 dst_sel:DWORD dst_unused:UNUSED_PAD src0_sel:DWORD src1_sel:WORD_1
    ds_read_u16_d16_hi v134, v138 offset:32768
    ds_read_u16_d16_hi v135, v139 offset:32768
    s_set_gpr_idx_on s53, 0xc
    v_pk_fma_f32 v[16:17], v[128:129], v[104:105], v[16:17] op_sel:[1,0,0] op_sel_hi:[1,1,1]
    v_pk_fma_f32 v[18:19], v[128:129], v[106:107], v[18:19] op_sel:[1,0,0] op_sel_hi:[1,1,1]
    v_pk_fma_f32 v[20:21], v[130:131], v[108:109], v[20:21] op_sel:[1,0,0] op_sel_hi:[1,1,1]
    v_pk_fma_f32 v[22:23], v[130:131], v[110:111], v[22:23] op_sel:[1,0,0] op_sel_hi:[1,1,1]
    s_set_gpr_idx_off
    s_sub_u32 s32, s32, 1
    s_cbranch_scc1 MAIN_DONE
    v_mfma_f32_4x4x4_16b_bf16 v[120:123], v[172:173], v[176:177], 0 cbsz:4 abid:15
    v_lshlrev_b32_sdwa v136, v15, v112 dst_sel:DWORD dst_unused:UNUSED_PAD src0_sel:DWORD src1_sel:WORD_1
    s_waitcnt vmcnt(10)
    v_mfma_f32_4x4x4_16b_bf16 v[104:107], v[146:147], v[92:93], 0 cbsz:4 abid:13
    s_nop 0
    v_mfma_f32_4x4x4_16b_bf16 v[108:111], v[146:147], v[94:95], 0 cbsz:4 abid:13
    v_lshlrev_b32_sdwa v137, v15, v113 dst_sel:DWORD dst_unused:UNUSED_PAD src0_sel:DWORD src1_sel:WORD_1
    ds_read_u16_d16_hi v128, v136 offset:32768
    ds_read_u16_d16_hi v129, v137 offset:32768
    s_waitcnt lgkmcnt(2)
    s_set_gpr_idx_on s54, 0xc
    v_pk_fma_f32 v[16:17], v[132:133], v[96:97], v[16:17] op_sel:[0,0,0] op_sel_hi:[0,1,1]
    v_pk_fma_f32 v[18:19], v[132:133], v[98:99], v[18:19] op_sel:[0,0,0] op_sel_hi:[0,1,1]
    v_pk_fma_f32 v[20:21], v[134:135], v[100:101], v[20:21] op_sel:[0,0,0] op_sel_hi:[0,1,1]
    v_pk_fma_f32 v[22:23], v[134:135], v[102:103], v[22:23] op_sel:[0,0,0] op_sel_hi:[0,1,1]
    s_set_gpr_idx_off
    s_sub_u32 s32, s32, 1
    s_cbranch_scc1 MAIN_DONE
    v_lshlrev_b32_sdwa v138, v15, v116 dst_sel:DWORD dst_unused:UNUSED_PAD src0_sel:DWORD src1_sel:WORD_1
    s_waitcnt vmcnt(9)
    v_mfma_f32_4x4x4_16b_bf16 v[96:99], v[140:141], v[64:65], 0 cbsz:4 abid:14
    s_nop 0
    v_mfma_f32_4x4x4_16b_bf16 v[100:103], v[140:141], v[66:67], 0 cbsz:4 abid:14
    v_lshlrev_b32_sdwa v139, v15, v117 dst_sel:DWORD dst_unused:UNUSED_PAD src0_sel:DWORD src1_sel:WORD_1
    ds_read_u16_d16_hi v130, v138 offset:32768
    ds_read_u16_d16_hi v131, v139 offset:32768
    s_set_gpr_idx_on s55, 0xc
    v_pk_fma_f32 v[16:17], v[132:133], v[104:105], v[16:17] op_sel:[1,0,0] op_sel_hi:[1,1,1]
    v_pk_fma_f32 v[18:19], v[132:133], v[106:107], v[18:19] op_sel:[1,0,0] op_sel_hi:[1,1,1]
    v_pk_fma_f32 v[20:21], v[134:135], v[108:109], v[20:21] op_sel:[1,0,0] op_sel_hi:[1,1,1]
    v_pk_fma_f32 v[22:23], v[134:135], v[110:111], v[22:23] op_sel:[1,0,0] op_sel_hi:[1,1,1]
    s_set_gpr_idx_off
    s_sub_u32 s32, s32, 1
    s_cbranch_scc1 MAIN_DONE
    v_mfma_f32_4x4x4_16b_bf16 v[124:127], v[172:173], v[178:179], 0 cbsz:4 abid:15
    v_lshlrev_b32_sdwa v136, v15, v114 dst_sel:DWORD dst_unused:UNUSED_PAD src0_sel:DWORD src1_sel:WORD_1
    s_waitcnt vmcnt(8)
    v_mfma_f32_4x4x4_16b_bf16 v[104:107], v[142:143], v[68:69], 0 cbsz:4 abid:14
    s_nop 0
    v_mfma_f32_4x4x4_16b_bf16 v[108:111], v[142:143], v[70:71], 0 cbsz:4 abid:14
    v_lshlrev_b32_sdwa v137, v15, v115 dst_sel:DWORD dst_unused:UNUSED_PAD src0_sel:DWORD src1_sel:WORD_1
    ds_read_u16_d16_hi v132, v136 offset:32768
    ds_read_u16_d16_hi v133, v137 offset:32768
    s_waitcnt lgkmcnt(2)
    s_set_gpr_idx_on s56, 0xc
    v_pk_fma_f32 v[16:17], v[128:129], v[96:97], v[16:17] op_sel:[0,0,0] op_sel_hi:[0,1,1]
    v_pk_fma_f32 v[18:19], v[128:129], v[98:99], v[18:19] op_sel:[0,0,0] op_sel_hi:[0,1,1]
    v_pk_fma_f32 v[20:21], v[130:131], v[100:101], v[20:21] op_sel:[0,0,0] op_sel_hi:[0,1,1]
    v_pk_fma_f32 v[22:23], v[130:131], v[102:103], v[22:23] op_sel:[0,0,0] op_sel_hi:[0,1,1]
    s_set_gpr_idx_off
    s_sub_u32 s32, s32, 1
    s_cbranch_scc1 MAIN_DONE
    v_lshlrev_b32_sdwa v138, v15, v118 dst_sel:DWORD dst_unused:UNUSED_PAD src0_sel:DWORD src1_sel:WORD_1
    v_mfma_f32_4x4x4_16b_bf16 v[96:99], v[144:145], v[72:73], 0 cbsz:4 abid:14
    s_nop 0
    v_mfma_f32_4x4x4_16b_bf16 v[100:103], v[144:145], v[74:75], 0 cbsz:4 abid:14
    v_lshlrev_b32_sdwa v139, v15, v119 dst_sel:DWORD dst_unused:UNUSED_PAD src0_sel:DWORD src1_sel:WORD_1
    ds_read_u16_d16_hi v134, v138 offset:32768
    ds_read_u16_d16_hi v135, v139 offset:32768
    s_set_gpr_idx_on s57, 0xc
    v_pk_fma_f32 v[16:17], v[128:129], v[104:105], v[16:17] op_sel:[1,0,0] op_sel_hi:[1,1,1]
    v_pk_fma_f32 v[18:19], v[128:129], v[106:107], v[18:19] op_sel:[1,0,0] op_sel_hi:[1,1,1]
    v_pk_fma_f32 v[20:21], v[130:131], v[108:109], v[20:21] op_sel:[1,0,0] op_sel_hi:[1,1,1]
    v_pk_fma_f32 v[22:23], v[130:131], v[110:111], v[22:23] op_sel:[1,0,0] op_sel_hi:[1,1,1]
    s_set_gpr_idx_off
    v_mov_b32 v172, v170
    v_mov_b32 v173, v171
    s_nop 1
    s_branch MAIN_DONE
B_56:
    buffer_load_dwordx4 v[188:191], v1, s[16:19], s10 offen offset:0 sc1
    buffer_load_dwordx4 v[192:195], v1, s[16:19], s10 offen offset:1024 sc1
    buffer_load_dwordx4 v[196:199], v1, s[16:19], s10 offen offset:2048 sc1
    buffer_load_dwordx4 v[200:203], v1, s[16:19], s10 offen offset:3072 sc1
    buffer_load_dwordx4 v[204:207], v1, s[16:19], s11 offen offset:0 sc1
    buffer_load_dwordx4 v[208:211], v1, s[16:19], s11 offen offset:1024 sc1
    buffer_load_dwordx4 v[212:215], v1, s[16:19], s11 offen offset:2048 sc1
    buffer_load_dwordx4 v[216:219], v1, s[16:19], s11 offen offset:3072 sc1
    s_sub_u32 s32, s32, 1
    s_cbranch_scc1 MAIN_DONE
    v_mfma_f32_4x4x4_16b_bf16 v[124:127], v[172:173], v[178:179], 0 cbsz:4 abid:15
    v_lshlrev_b32_sdwa v136, v15, v114 dst_sel:DWORD dst_unused:UNUSED_PAD src0_sel:DWORD src1_sel:WORD_1
    s_waitcnt vmcnt(12)
    v_mfma_f32_4x4x4_16b_bf16 v[104:107], v[142:143], v[68:69], 0 cbsz:4 abid:14
    s_nop 0
    v_mfma_f32_4x4x4_16b_bf16 v[108:111], v[142:143], v[70:71], 0 cbsz:4 abid:14
    v_lshlrev_b32_sdwa v137, v15, v115 dst_sel:DWORD dst_unused:UNUSED_PAD src0_sel:DWORD src1_sel:WORD_1
    ds_read_u16_d16_hi v132, v136 offset:32768
    ds_read_u16_d16_hi v133, v137 offset:32768
    s_waitcnt lgkmcnt(2)
    s_set_gpr_idx_on s56, 0xc
    v_pk_fma_f32 v[16:17], v[128:129], v[96:97], v[16:17] op_sel:[0,0,0] op_sel_hi:[0,1,1]
    v_pk_fma_f32 v[18:19], v[128:129], v[98:99], v[18:19] op_sel:[0,0,0] op_sel_hi:[0,1,1]
    v_pk_fma_f32 v[20:21], v[130:131], v[100:101], v[20:21] op_sel:[0,0,0] op_sel_hi:[0,1,1]
    v_pk_fma_f32 v[22:23], v[130:131], v[102:103], v[22:23] op_sel:[0,0,0] op_sel_hi:[0,1,1]
    s_set_gpr_idx_off
    s_sub_u32 s32, s32, 1
    s_cbranch_scc1 MAIN_DONE
    v_lshlrev_b32_sdwa v138, v15, v118 dst_sel:DWORD dst_unused:UNUSED_PAD src0_sel:DWORD src1_sel:WORD_1
    s_waitcnt vmcnt(11)
    v_mfma_f32_4x4x4_16b_bf16 v[96:99], v[144:145], v[72:73], 0 cbsz:4 abid:14
    s_nop 0
    v_mfma_f32_4x4x4_16b_bf16 v[100:103], v[144:145], v[74:75], 0 cbsz:4 abid:14
    v_lshlrev_b32_sdwa v139, v15, v119 dst_sel:DWORD dst_unused:UNUSED_PAD src0_sel:DWORD src1_sel:WORD_1
    ds_read_u16_d16_hi v134, v138 offset:32768
    ds_read_u16_d16_hi v135, v139 offset:32768
    s_set_gpr_idx_on s57, 0xc
    v_pk_fma_f32 v[16:17], v[128:129], v[104:105], v[16:17] op_sel:[1,0,0] op_sel_hi:[1,1,1]
    v_pk_fma_f32 v[18:19], v[128:129], v[106:107], v[18:19] op_sel:[1,0,0] op_sel_hi:[1,1,1]
    v_pk_fma_f32 v[20:21], v[130:131], v[108:109], v[20:21] op_sel:[1,0,0] op_sel_hi:[1,1,1]
    v_pk_fma_f32 v[22:23], v[130:131], v[110:111], v[22:23] op_sel:[1,0,0] op_sel_hi:[1,1,1]
    s_set_gpr_idx_off
    v_mov_b32 v172, v170
    v_mov_b32 v173, v171
    s_nop 1
    s_sub_u32 s32, s32, 1
    s_cbranch_scc1 MAIN_DONE
    v_mfma_f32_4x4x4_16b_bf16 v[112:115], v[172:173], v[176:177], 0 cbsz:4 abid:0
    v_lshlrev_b32_sdwa v136, v15, v120 dst_sel:DWORD dst_unused:UNUSED_PAD src0_sel:DWORD src1_sel:WORD_1
    s_waitcnt vmcnt(10)
    v_mfma_f32_4x4x4_16b_bf16 v[104:107], v[146:147], v[76:77], 0 cbsz:4 abid:14
    s_nop 0
    v_mfma_f32_4x4x4_16b_bf16 v[108:111], v[146:147], v[78:79], 0 cbsz:4 abid:14
    v_lshlrev_b32_sdwa v137, v15, v121 dst_sel:DWORD dst_unused:UNUSED_PAD src0_sel:DWORD src1_sel:WORD_1
    ds_read_u16_d16_hi v128, v136 offset:32768
    ds_read_u16_d16_hi v129, v137 offset:32768
    s_waitcnt lgkmcnt(2)
    s_set_gpr_idx_on s58, 0xc
    v_pk_fma_f32 v[16:17], v[132:133], v[96:97], v[16:17] op_sel:[0,0,0] op_sel_hi:[0,1,1]
    v_pk_fma_f32 v[18:19], v[132:133], v[98:99], v[18:19] op_sel:[0,0,0] op_sel_hi:[0,1,1]
    v_pk_fma_f32 v[20:21], v[134:135], v[100:101], v[20:21] op_sel:[0,0,0] op_sel_hi:[0,1,1]
    v_pk_fma_f32 v[22:23], v[134:135], v[102:103], v[22:23] op_sel:[0,0,0] op_sel_hi:[0,1,1]
    s_set_gpr_idx_off
    s_sub_u32 s32, s32, 1
    s_cbranch_scc1 MAIN_DONE
    v_lshlrev_b32_sdwa v138, v15, v124 dst_sel:DWORD dst_unused:UNUSED_PAD src0_sel:DWORD src1_sel:WORD_1
    s_waitcnt vmcnt(9)
    v_mfma_f32_4x4x4_16b_bf16 v[96:99], v[140:141], v[80:81], 0 cbsz:4 abid:15
    s_nop 0
    v_mfma_f32_4x4x4_16b_bf16 v[100:103], v[140:141], v[82:83], 0 cbsz:4 abid:15
    v_lshlrev_b32_sdwa v139, v15, v125 dst_sel:DWORD dst_unused:UNUSED_PAD src0_sel:DWORD src1_sel:WORD_1
    ds_read_u16_d16_hi v130, v138 offset:32768
    ds_read_u16_d16_hi v131, v139 offset:32768
    s_set_gpr_idx_on s59, 0xc
    v_pk_fma_f32 v[16:17], v[132:133], v[104:105], v[16:17] op_sel:[1,0,0] op_sel_hi:[1,1,1]
    v_pk_fma_f32 v[18:19], v[132:133], v[106:107], v[18:19] op_sel:[1,0,0] op_sel_hi:[1,1,1]
    v_pk_fma_f32 v[20:21], v[134:135], v[108:109], v[20:21] op_sel:[1,0,0] op_sel_hi:[1,1,1]
    v_pk_fma_f32 v[22:23], v[134:135], v[110:111], v[22:23] op_sel:[1,0,0] op_sel_hi:[1,1,1]
    s_set_gpr_idx_off
    s_sub_u32 s32, s32, 1
    s_cbranch_scc1 MAIN_DONE
    v_mfma_f32_4x4x4_16b_bf16 v[116:119], v[172:173], v[178:179], 0 cbsz:4 abid:0
    v_lshlrev_b32_sdwa v136, v15, v122 dst_sel:DWORD dst_unused:UNUSED_PAD src0_sel:DWORD src1_sel:WORD_1
    s_waitcnt vmcnt(8)
    v_mfma_f32_4x4x4_16b_bf16 v[104:107], v[142:143], v[84:85], 0 cbsz:4 abid:15
    s_nop 0
    v_mfma_f32_4x4x4_16b_bf16 v[108:111], v[142:143], v[86:87], 0 cbsz:4 abid:15
    v_lshlrev_b32_sdwa v137, v15, v123 dst_sel:DWORD dst_unused:UNUSED_PAD src0_sel:DWORD src1_sel:WORD_1
    ds_read_u16_d16_hi v132, v136 offset:32768
    ds_read_u16_d16_hi v133, v137 offset:32768
    v_cvt_pk_bf16_f32 v140, v148, v152
    v_cvt_pk_bf16_f32 v141, v156, v160
    s_waitcnt lgkmcnt(2)
    s_set_gpr_idx_on s60, 0xc
    v_pk_fma_f32 v[16:17], v[128:129], v[96:97], v[16:17] op_sel:[0,0,0] op_sel_hi:[0,1,1]
    v_pk_fma_f32 v[18:19], v[128:129], v[98:99], v[18:19] op_sel:[0,0,0] op_sel_hi:[0,1,1]
    v_pk_fma_f32 v[20:21], v[130:131], v[100:101], v[20:21] op_sel:[0,0,0] op_sel_hi:[0,1,1]
    v_pk_fma_f32 v[22:23], v[130:131], v[102:103], v[22:23] op_sel:[0,0,0] op_sel_hi:[0,1,1]
    s_set_gpr_idx_off
    s_sub_u32 s32, s32, 1
    s_cbranch_scc1 MAIN_DONE
    v_lshlrev_b32_sdwa v138, v15, v126 dst_sel:DWORD dst_unused:UNUSED_PAD src0_sel:DWORD src1_sel:WORD_1
    v_mfma_f32_4x4x4_16b_bf16 v[96:99], v[144:145], v[88:89], 0 cbsz:4 abid:15
    s_nop 0
    v_mfma_f32_4x4x4_16b_bf16 v[100:103], v[144:145], v[90:91], 0 cbsz:4 abid:15
    v_lshlrev_b32_sdwa v139, v15, v127 dst_sel:DWORD dst_unused:UNUSED_PAD src0_sel:DWORD src1_sel:WORD_1
    ds_read_u16_d16_hi v134, v138 offset:32768
    ds_read_u16_d16_hi v135, v139 offset:32768
    v_cvt_pk_bf16_f32 v142, v149, v153
    v_cvt_pk_bf16_f32 v143, v157, v161
    s_set_gpr_idx_on s61, 0xc
    v_pk_fma_f32 v[16:17], v[128:129], v[104:105], v[16:17] op_sel:[1,0,0] op_sel_hi:[1,1,1]
    v_pk_fma_f32 v[18:19], v[128:129], v[106:107], v[18:19] op_sel:[1,0,0] op_sel_hi:[1,1,1]
    v_pk_fma_f32 v[20:21], v[130:131], v[108:109], v[20:21] op_sel:[1,0,0] op_sel_hi:[1,1,1]
    v_pk_fma_f32 v[22:23], v[130:131], v[110:111], v[22:23] op_sel:[1,0,0] op_sel_hi:[1,1,1]
    s_set_gpr_idx_off
    s_branch MAIN_DONE
B_60:
    buffer_load_dwordx4 v[188:191], v1, s[16:19], s10 offen offset:0 sc1
    buffer_load_dwordx4 v[192:195], v1, s[16:19], s10 offen offset:1024 sc1
    buffer_load_dwordx4 v[196:199], v1, s[16:19], s10 offen offset:2048 sc1
    buffer_load_dwordx4 v[200:203], v1, s[16:19], s10 offen offset:3072 sc1
    buffer_load_dwordx4 v[204:207], v1, s[16:19], s11 offen offset:0 sc1
    buffer_load_dwordx4 v[208:211], v1, s[16:19], s11 offen offset:1024 sc1
    buffer_load_dwordx4 v[212:215], v1, s[16:19], s11 offen offset:2048 sc1
    buffer_load_dwordx4 v[216:219], v1, s[16:19], s11 offen offset:3072 sc1
    s_sub_u32 s32, s32, 1
    s_cbranch_scc1 MAIN_DONE
    v_mfma_f32_4x4x4_16b_bf16 v[116:119], v[172:173], v[178:179], 0 cbsz:4 abid:0
    v_lshlrev_b32_sdwa v136, v15, v122 dst_sel:DWORD dst_unused:UNUSED_PAD src0_sel:DWORD src1_sel:WORD_1
    s_waitcnt vmcnt(12)
    v_mfma_f32_4x4x4_16b_bf16 v[104:107], v[142:143], v[84:85], 0 cbsz:4 abid:15
    s_nop 0
    v_mfma_f32_4x4x4_16b_bf16 v[108:111], v[142:143], v[86:87], 0 cbsz:4 abid:15
    v_lshlrev_b32_sdwa v137, v15, v123 dst_sel:DWORD dst_unused:UNUSED_PAD src0_sel:DWORD src1_sel:WORD_1
    ds_read_u16_d16_hi v132, v136 offset:32768
    ds_read_u16_d16_hi v133, v137 offset:32768
    v_cvt_pk_bf16_f32 v140, v148, v152
    v_cvt_pk_bf16_f32 v141, v156, v160
    s_waitcnt lgkmcnt(2)
    s_set_gpr_idx_on s60, 0xc
    v_pk_fma_f32 v[16:17], v[128:129], v[96:97], v[16:17] op_sel:[0,0,0] op_sel_hi:[0,1,1]
    v_pk_fma_f32 v[18:19], v[128:129], v[98:99], v[18:19] op_sel:[0,0,0] op_sel_hi:[0,1,1]
    v_pk_fma_f32 v[20:21], v[130:131], v[100:101], v[20:21] op_sel:[0,0,0] op_sel_hi:[0,1,1]
    v_pk_fma_f32 v[22:23], v[130:131], v[102:103], v[22:23] op_sel:[0,0,0] op_sel_hi:[0,1,1]
    s_set_gpr_idx_off
    s_sub_u32 s32, s32, 1
    s_cbranch_scc1 MAIN_DONE
    v_lshlrev_b32_sdwa v138, v15, v126 dst_sel:DWORD dst_unused:UNUSED_PAD src0_sel:DWORD src1_sel:WORD_1
    s_waitcnt vmcnt(11)
    v_mfma_f32_4x4x4_16b_bf16 v[96:99], v[144:145], v[88:89], 0 cbsz:4 abid:15
    s_nop 0
    v_mfma_f32_4x4x4_16b_bf16 v[100:103], v[144:145], v[90:91], 0 cbsz:4 abid:15
    v_lshlrev_b32_sdwa v139, v15, v127 dst_sel:DWORD dst_unused:UNUSED_PAD src0_sel:DWORD src1_sel:WORD_1
    ds_read_u16_d16_hi v134, v138 offset:32768
    ds_read_u16_d16_hi v135, v139 offset:32768
    v_cvt_pk_bf16_f32 v142, v149, v153
    v_cvt_pk_bf16_f32 v143, v157, v161
    s_set_gpr_idx_on s61, 0xc
    v_pk_fma_f32 v[16:17], v[128:129], v[104:105], v[16:17] op_sel:[1,0,0] op_sel_hi:[1,1,1]
    v_pk_fma_f32 v[18:19], v[128:129], v[106:107], v[18:19] op_sel:[1,0,0] op_sel_hi:[1,1,1]
    v_pk_fma_f32 v[20:21], v[130:131], v[108:109], v[20:21] op_sel:[1,0,0] op_sel_hi:[1,1,1]
    v_pk_fma_f32 v[22:23], v[130:131], v[110:111], v[22:23] op_sel:[1,0,0] op_sel_hi:[1,1,1]
    s_set_gpr_idx_off
    s_sub_u32 s32, s32, 1
    s_cbranch_scc1 MAIN_DONE
    v_mfma_f32_4x4x4_16b_bf16 v[120:123], v[172:173], v[176:177], 0 cbsz:4 abid:1
    v_lshlrev_b32_sdwa v136, v15, v112 dst_sel:DWORD dst_unused:UNUSED_PAD src0_sel:DWORD src1_sel:WORD_1
    s_waitcnt vmcnt(10)
    v_mfma_f32_4x4x4_16b_bf16 v[104:107], v[146:147], v[92:93], 0 cbsz:4 abid:15
    s_nop 0
    v_mfma_f32_4x4x4_16b_bf16 v[108:111], v[146:147], v[94:95], 0 cbsz:4 abid:15
    v_lshlrev_b32_sdwa v137, v15, v113 dst_sel:DWORD dst_unused:UNUSED_PAD src0_sel:DWORD src1_sel:WORD_1
    ds_read_u16_d16_hi v128, v136 offset:32768
    ds_read_u16_d16_hi v129, v137 offset:32768
    v_cvt_pk_bf16_f32 v144, v150, v154
    v_cvt_pk_bf16_f32 v145, v158, v162
    s_waitcnt lgkmcnt(2)
    s_set_gpr_idx_on s62, 0xc
    v_pk_fma_f32 v[16:17], v[132:133], v[96:97], v[16:17] op_sel:[0,0,0] op_sel_hi:[0,1,1]
    v_pk_fma_f32 v[18:19], v[132:133], v[98:99], v[18:19] op_sel:[0,0,0] op_sel_hi:[0,1,1]
    v_pk_fma_f32 v[20:21], v[134:135], v[100:101], v[20:21] op_sel:[0,0,0] op_sel_hi:[0,1,1]
    v_pk_fma_f32 v[22:23], v[134:135], v[102:103], v[22:23] op_sel:[0,0,0] op_sel_hi:[0,1,1]
    s_set_gpr_idx_off
    s_sub_u32 s32, s32, 1
    s_cbranch_scc1 MAIN_DONE
    v_lshlrev_b32_sdwa v138, v15, v116 dst_sel:DWORD dst_unused:UNUSED_PAD src0_sel:DWORD src1_sel:WORD_1
    s_waitcnt vmcnt(9)
    v_mfma_f32_4x4x4_16b_bf16 v[96:99], v[140:141], v[64:65], 0 cbsz:4 abid:0
    s_nop 0
    v_mfma_f32_4x4x4_16b_bf16 v[100:103], v[140:141], v[66:67], 0 cbsz:4 abid:0
    v_lshlrev_b32_sdwa v139, v15, v117 dst_sel:DWORD dst_unused:UNUSED_PAD src0_sel:DWORD src1_sel:WORD_1
    ds_read_u16_d16_hi v130, v138 offset:32768
    ds_read_u16_d16_hi v131, v139 offset:32768
    v_cvt_pk_bf16_f32 v146, v151, v155
    v_cvt_pk_bf16_f32 v147, v159, v163
    s_set_gpr_idx_on s63, 0xc
    v_pk_fma_f32 v[16:17], v[132:133], v[104:105], v[16:17] op_sel:[1,0,0] op_sel_hi:[1,1,1]
    v_pk_fma_f32 v[18:19], v[132:133], v[106:107], v[18:19] op_sel:[1,0,0] op_sel_hi:[1,1,1]
    v_pk_fma_f32 v[20:21], v[134:135], v[108:109], v[20:21] op_sel:[1,0,0] op_sel_hi:[1,1,1]
    v_pk_fma_f32 v[22:23], v[134:135], v[110:111], v[22:23] op_sel:[1,0,0] op_sel_hi:[1,1,1]
    s_set_gpr_idx_off
    s_sub_u32 s32, s32, 1
    s_cbranch_scc1 MAIN_DONE
    v_mfma_f32_4x4x4_16b_bf16 v[124:127], v[172:173], v[178:179], 0 cbsz:4 abid:1
    v_lshlrev_b32_sdwa v136, v15, v114 dst_sel:DWORD dst_unused:UNUSED_PAD src0_sel:DWORD src1_sel:WORD_1
    s_waitcnt vmcnt(8)
    v_mfma_f32_4x4x4_16b_bf16 v[104:107], v[142:143], v[68:69], 0 cbsz:4 abid:0
    s_nop 0
    v_mfma_f32_4x4x4_16b_bf16 v[108:111], v[142:143], v[70:71], 0 cbsz:4 abid:0
    v_lshlrev_b32_sdwa v137, v15, v115 dst_sel:DWORD dst_unused:UNUSED_PAD src0_sel:DWORD src1_sel:WORD_1
    ds_read_u16_d16_hi v132, v136 offset:32768
    ds_read_u16_d16_hi v133, v137 offset:32768
    s_waitcnt lgkmcnt(2)
    s_set_gpr_idx_on s48, 0xc
    v_pk_fma_f32 v[16:17], v[128:129], v[96:97], v[16:17] op_sel:[0,0,0] op_sel_hi:[0,1,1]
    v_pk_fma_f32 v[18:19], v[128:129], v[98:99], v[18:19] op_sel:[0,0,0] op_sel_hi:[0,1,1]
    v_pk_fma_f32 v[20:21], v[130:131], v[100:101], v[20:21] op_sel:[0,0,0] op_sel_hi:[0,1,1]
    v_pk_fma_f32 v[22:23], v[130:131], v[102:103], v[22:23] op_sel:[0,0,0] op_sel_hi:[0,1,1]
    s_set_gpr_idx_off
    s_sub_u32 s32, s32, 1
    s_cbranch_scc1 MAIN_DONE
    v_lshlrev_b32_sdwa v138, v15, v118 dst_sel:DWORD dst_unused:UNUSED_PAD src0_sel:DWORD src1_sel:WORD_1
    v_mfma_f32_4x4x4_16b_bf16 v[96:99], v[144:145], v[72:73], 0 cbsz:4 abid:0
    s_nop 0
    v_mfma_f32_4x4x4_16b_bf16 v[100:103], v[144:145], v[74:75], 0 cbsz:4 abid:0
    v_lshlrev_b32_sdwa v139, v15, v119 dst_sel:DWORD dst_unused:UNUSED_PAD src0_sel:DWORD src1_sel:WORD_1
    ds_read_u16_d16_hi v134, v138 offset:32768
    ds_read_u16_d16_hi v135, v139 offset:32768
    s_set_gpr_idx_on s49, 0xc
    v_pk_fma_f32 v[16:17], v[128:129], v[104:105], v[16:17] op_sel:[1,0,0] op_sel_hi:[1,1,1]
    v_pk_fma_f32 v[18:19], v[128:129], v[106:107], v[18:19] op_sel:[1,0,0] op_sel_hi:[1,1,1]
    v_pk_fma_f32 v[20:21], v[130:131], v[108:109], v[20:21] op_sel:[1,0,0] op_sel_hi:[1,1,1]
    v_pk_fma_f32 v[22:23], v[130:131], v[110:111], v[22:23] op_sel:[1,0,0] op_sel_hi:[1,1,1]
    s_set_gpr_idx_off
    s_branch MAIN_DONE
MAIN_DONE:
    s_add_u32 s27, s27, 1472
    s_cmp_ge_u32 s27, s26
    s_cbranch_scc1 ALL_DONE
    s_waitcnt vmcnt(0) lgkmcnt(0)
    v_lshlrev_b32 v11, 2, v0
    v_mov_b32 v12, 0
    v_cmp_gt_u32 vcc, 0x100, v0
    s_and_saveexec_b64 s[42:43], vcc
    ds_write_b32 v11, v12 offset:0
    s_mov_b64 exec, s[42:43]
    s_waitcnt lgkmcnt(0)
    s_barrier
    s_branch ROUND
ALL_DONE:
    v_lshrrev_b32 v11, 8, v1
    s_lshr_b32 s42, s25, 2
    s_mul_i32 s43, s42, 80
    v_mul_u32_u24 v9, 20, v11
    v_add_u32 v9, s43, v9
    ds_read_b32 v112, v9 offset:1344
    ds_read_b32 v113, v9 offset:1348
    ds_read_b32 v114, v9 offset:1352
    ds_read_b32 v115, v9 offset:1356
    ds_read_b32 v116, v9 offset:1360
    v_cvt_pk_bf16_f32 v140, v16, v20
    v_cvt_pk_bf16_f32 v141, v17, v21
    v_cvt_pk_bf16_f32 v142, v18, v22
    v_cvt_pk_bf16_f32 v143, v19, v23
    v_cvt_pk_bf16_f32 v144, v24, v28
    v_cvt_pk_bf16_f32 v145, v25, v29
    v_cvt_pk_bf16_f32 v146, v26, v30
    v_cvt_pk_bf16_f32 v147, v27, v31
    v_cvt_pk_bf16_f32 v148, v32, v36
    v_cvt_pk_bf16_f32 v149, v33, v37
    v_cvt_pk_bf16_f32 v150, v34, v38
    v_cvt_pk_bf16_f32 v151, v35, v39
    v_cvt_pk_bf16_f32 v152, v40, v44
    v_cvt_pk_bf16_f32 v153, v41, v45
    v_cvt_pk_bf16_f32 v154, v42, v46
    v_cvt_pk_bf16_f32 v155, v43, v47
    v_cvt_pk_bf16_f32 v156, v48, v52
    v_cvt_pk_bf16_f32 v157, v49, v53
    v_cvt_pk_bf16_f32 v158, v50, v54
    v_cvt_pk_bf16_f32 v159, v51, v55
    s_mul_i32 s43, s25, 1152
    s_add_u32 s43, s43, 32768
    v_lshrrev_b32 v12, 2, v1
    v_add_u32 v12, s43, v12
    v_bfe_u32 v10, v1, 4, 4
    s_mul_i32 s43, s42, 4608
    s_add_u32 s43, s43, 32768
    v_mul_u32_u24 v8, 288, v10
    v_lshl_add_u32 v8, v11, 4, v8
    v_add_u32 v8, s43, v8
    s_lshl_b32 s42, s24, 10
    s_and_b32 s43, s25, 3
    s_lshl_b32 s43, s43, 8
    s_add_u32 s42, s42, s43
    v_lshl_add_u32 v10, v10, 4, s42
    s_waitcnt lgkmcnt(0)
    v_lshl_add_u32 v112, v112, 18, v10
    v_lshl_add_u32 v113, v113, 18, v10
    v_lshl_add_u32 v114, v114, 18, v10
    v_lshl_add_u32 v115, v115, 18, v10
    v_lshl_add_u32 v116, v116, 18, v10
    s_barrier
    ds_write_b32 v12, v140 offset:0
    ds_write_b32 v12, v141 offset:288
    ds_write_b32 v12, v142 offset:576
    ds_write_b32 v12, v143 offset:864
    ds_write_b32 v12, v144 offset:9216
    ds_write_b32 v12, v145 offset:9504
    ds_write_b32 v12, v146 offset:9792
    ds_write_b32 v12, v147 offset:10080
    s_waitcnt vmcnt(0) lgkmcnt(0)
    s_barrier
    ds_read_b128 v[64:67], v8 offset:0
    ds_read_b128 v[68:71], v8 offset:64
    ds_read_b128 v[72:75], v8 offset:128
    ds_read_b128 v[76:79], v8 offset:192
    ds_read_b128 v[80:83], v8 offset:9216
    ds_read_b128 v[84:87], v8 offset:9280
    ds_read_b128 v[88:91], v8 offset:9344
    ds_read_b128 v[92:95], v8 offset:9408
    s_waitcnt lgkmcnt(4)
    ds_write_b32 v12, v148 offset:18432
    ds_write_b32 v12, v149 offset:18720
    ds_write_b32 v12, v150 offset:19008
    ds_write_b32 v12, v151 offset:19296
    ds_write_b32 v12, v152 offset:27648
    ds_write_b32 v12, v153 offset:27936
    ds_write_b32 v12, v154 offset:28224
    ds_write_b32 v12, v155 offset:28512
    v_mfma_f32_16x16x32_bf16 v[16:19], v[64:67], v[188:191], 0
    v_mfma_f32_16x16x32_bf16 v[20:23], v[64:67], v[204:207], 0
    v_mfma_f32_16x16x32_bf16 v[16:19], v[68:71], v[192:195], v[16:19]
    v_mfma_f32_16x16x32_bf16 v[20:23], v[68:71], v[208:211], v[20:23]
    v_mfma_f32_16x16x32_bf16 v[16:19], v[72:75], v[196:199], v[16:19]
    v_mfma_f32_16x16x32_bf16 v[20:23], v[72:75], v[212:215], v[20:23]
    v_mfma_f32_16x16x32_bf16 v[16:19], v[76:79], v[200:203], v[16:19]
    v_mfma_f32_16x16x32_bf16 v[20:23], v[76:79], v[216:219], v[20:23]
    ds_write_b32 v12, v156 offset:36864
    ds_write_b32 v12, v157 offset:37152
    ds_write_b32 v12, v158 offset:37440
    ds_write_b32 v12, v159 offset:37728
    s_waitcnt lgkmcnt(0)
    s_barrier
    ds_read_b128 v[64:67], v8 offset:18432
    ds_read_b128 v[68:71], v8 offset:18496
    ds_read_b128 v[72:75], v8 offset:18560
    ds_read_b128 v[76:79], v8 offset:18624
    v_mfma_f32_16x16x32_bf16 v[24:27], v[80:83], v[188:191], 0
    v_mfma_f32_16x16x32_bf16 v[28:31], v[80:83], v[204:207], 0
    v_mfma_f32_16x16x32_bf16 v[24:27], v[84:87], v[192:195], v[24:27]
    v_mfma_f32_16x16x32_bf16 v[28:31], v[84:87], v[208:211], v[28:31]
    v_mfma_f32_16x16x32_bf16 v[24:27], v[88:91], v[196:199], v[24:27]
    v_mfma_f32_16x16x32_bf16 v[28:31], v[88:91], v[212:215], v[28:31]
    v_mfma_f32_16x16x32_bf16 v[24:27], v[92:95], v[200:203], v[24:27]
    v_mfma_f32_16x16x32_bf16 v[28:31], v[92:95], v[216:219], v[28:31]
    v_cvt_pk_bf16_f32 v128, v16, v17
    v_cvt_pk_bf16_f32 v129, v18, v19
    v_cvt_pk_bf16_f32 v130, v20, v21
    v_cvt_pk_bf16_f32 v131, v22, v23
    buffer_store_dwordx4 v[128:131], v112, s[20:23], 0 offen sc0 sc1
    ds_read_b128 v[80:83], v8 offset:27648
    ds_read_b128 v[84:87], v8 offset:27712
    ds_read_b128 v[88:91], v8 offset:27776
    ds_read_b128 v[92:95], v8 offset:27840
    s_waitcnt lgkmcnt(7)
    v_mfma_f32_16x16x32_bf16 v[32:35], v[64:67], v[188:191], 0
    v_mfma_f32_16x16x32_bf16 v[36:39], v[64:67], v[204:207], 0
    s_waitcnt lgkmcnt(6)
    v_mfma_f32_16x16x32_bf16 v[32:35], v[68:71], v[192:195], v[32:35]
    v_mfma_f32_16x16x32_bf16 v[36:39], v[68:71], v[208:211], v[36:39]
    s_waitcnt lgkmcnt(5)
    v_mfma_f32_16x16x32_bf16 v[32:35], v[72:75], v[196:199], v[32:35]
    v_mfma_f32_16x16x32_bf16 v[36:39], v[72:75], v[212:215], v[36:39]
    s_waitcnt lgkmcnt(4)
    v_mfma_f32_16x16x32_bf16 v[32:35], v[76:79], v[200:203], v[32:35]
    v_mfma_f32_16x16x32_bf16 v[36:39], v[76:79], v[216:219], v[36:39]
    v_cvt_pk_bf16_f32 v132, v24, v25
    v_cvt_pk_bf16_f32 v133, v26, v27
    v_cvt_pk_bf16_f32 v134, v28, v29
    v_cvt_pk_bf16_f32 v135, v30, v31
    buffer_store_dwordx4 v[132:135], v113, s[20:23], 0 offen sc0 sc1
    ds_read_b128 v[64:67], v8 offset:36864
    ds_read_b128 v[68:71], v8 offset:36928
    ds_read_b128 v[72:75], v8 offset:36992
    ds_read_b128 v[76:79], v8 offset:37056
    s_waitcnt lgkmcnt(7)
    v_mfma_f32_16x16x32_bf16 v[40:43], v[80:83], v[188:191], 0
    v_mfma_f32_16x16x32_bf16 v[44:47], v[80:83], v[204:207], 0
    s_waitcnt lgkmcnt(6)
    v_mfma_f32_16x16x32_bf16 v[40:43], v[84:87], v[192:195], v[40:43]
    v_mfma_f32_16x16x32_bf16 v[44:47], v[84:87], v[208:211], v[44:47]
    s_waitcnt lgkmcnt(5)
    v_mfma_f32_16x16x32_bf16 v[40:43], v[88:91], v[196:199], v[40:43]
    v_mfma_f32_16x16x32_bf16 v[44:47], v[88:91], v[212:215], v[44:47]
    s_waitcnt lgkmcnt(4)
    v_mfma_f32_16x16x32_bf16 v[40:43], v[92:95], v[200:203], v[40:43]
    v_mfma_f32_16x16x32_bf16 v[44:47], v[92:95], v[216:219], v[44:47]
    v_cvt_pk_bf16_f32 v128, v32, v33
    v_cvt_pk_bf16_f32 v129, v34, v35
    v_cvt_pk_bf16_f32 v130, v36, v37
    v_cvt_pk_bf16_f32 v131, v38, v39
    buffer_store_dwordx4 v[128:131], v114, s[20:23], 0 offen sc0 sc1
    s_waitcnt lgkmcnt(3)
    v_mfma_f32_16x16x32_bf16 v[48:51], v[64:67], v[188:191], 0
    v_mfma_f32_16x16x32_bf16 v[52:55], v[64:67], v[204:207], 0
    s_waitcnt lgkmcnt(2)
    v_mfma_f32_16x16x32_bf16 v[48:51], v[68:71], v[192:195], v[48:51]
    v_mfma_f32_16x16x32_bf16 v[52:55], v[68:71], v[208:211], v[52:55]
    s_waitcnt lgkmcnt(1)
    v_mfma_f32_16x16x32_bf16 v[48:51], v[72:75], v[196:199], v[48:51]
    v_mfma_f32_16x16x32_bf16 v[52:55], v[72:75], v[212:215], v[52:55]
    s_waitcnt lgkmcnt(0)
    v_mfma_f32_16x16x32_bf16 v[48:51], v[76:79], v[200:203], v[48:51]
    v_mfma_f32_16x16x32_bf16 v[52:55], v[76:79], v[216:219], v[52:55]
    v_cvt_pk_bf16_f32 v132, v40, v41
    v_cvt_pk_bf16_f32 v133, v42, v43
    v_cvt_pk_bf16_f32 v134, v44, v45
    v_cvt_pk_bf16_f32 v135, v46, v47
    buffer_store_dwordx4 v[132:135], v115, s[20:23], 0 offen sc0 sc1
    s_nop 3
    v_cvt_pk_bf16_f32 v128, v48, v49
    v_cvt_pk_bf16_f32 v129, v50, v51
    v_cvt_pk_bf16_f32 v130, v52, v53
    v_cvt_pk_bf16_f32 v131, v54, v55
    buffer_store_dwordx4 v[128:131], v116, s[20:23], 0 offen sc0 sc1
END:
    s_endpgm
    .p2align 6
    .type DEAL_TABLE,@object
DEAL_TABLE:
    .short 8272, 4136, 8532, 14476, 12408, 6204, 2068, 10340, 0, 8792, 4396, 12668, 2328, 14736, 6464, 10600, 260, 9052, 14996, 6724, 520, 2588, 10860, 12928, 4656, 11120, 780, 2848, 13188, 15256, 6984, 4916, 1040, 11380, 7244, 3108, 13448, 15516, 5176, 9312, 0, 0, 0, 0, 0, 0, 0, 0, 0, 0, 0, 0, 0, 0, 0, 0, 0, 0, 0, 0, 0, 0, 0, 0, 0, 4136, 14476, 2068, 8272, 12408, 10340, 6204, 12668, 6464, 2328, 14736, 8532, 260, 4396, 10600, 8792, 6724, 10860, 12928, 14996, 2588, 520, 4656, 15256, 11120, 4916, 9052, 6984, 13188, 780, 2848, 11380, 3108, 7244, 13448, 9312, 5176, 15516, 1040, 0, 0, 0, 0, 0, 0, 0, 0, 0, 0, 0, 0, 0, 0, 0, 0, 0, 0, 0, 0, 0, 0, 0, 0
    .size DEAL_TABLE, 256
.section .rodata,"a"
.p2align 6
.amdhsa_kernel gather_scatter__tensor_product_equiv_tfn__graph_kernel
  .amdhsa_next_free_vgpr 220
  .amdhsa_next_free_sgpr 66
  .amdhsa_accum_offset 220
  .amdhsa_group_segment_fixed_size 0
  .amdhsa_kernarg_size 88
  .amdhsa_user_sgpr_count 2
  .amdhsa_user_sgpr_kernarg_segment_ptr 1
  .amdhsa_system_sgpr_workgroup_id_x 1
  .amdhsa_float_denorm_mode_32 3
.end_amdhsa_kernel
```

```asm
; @launch grid=(256,1,1) block=(512,1,1) lds=163840
.amdgcn_target "amdgcn-amd-amdhsa--gfx950"
.text
.globl gather_scatter__tensor_product_equiv_tfn__graph_kernel
.p2align 8
.type gather_scatter__tensor_product_equiv_tfn__graph_kernel,@function
gather_scatter__tensor_product_equiv_tfn__graph_kernel:
    s_cmp_ge_u32 s2, 256
    s_cbranch_scc1 END
    s_load_dwordx16 s[40:55], s[0:1], 0
    s_load_dwordx2 s[16:17], s[0:1], 80
    s_load_dwordx2 s[12:13], s[0:1], 0
    s_load_dwordx2 s[20:21], s[0:1], 64
    s_getpc_b64 s[6:7]
CODE_HERE:
    v_lshrrev_b32 v8, 6, v0
    s_lshr_b32 s5, s2, 3
    s_lshl_b32 s4, s5, 10
    v_readfirstlane_b32 s25, v8
    v_and_b32 v10, 7, v0
    v_lshl_add_u32 v10, v10, 7, s4
    v_min_u32 v10, END-CODE_HERE, v10
    s_cmp_lg_u32 s25, 7
    s_cbranch_scc1 NO_CODE_TOUCH
    global_load_dword v167, v10, s[6:7]
NO_CODE_TOUCH:
    s_mul_i32 s3, s2, 5120
    v_lshl_add_u32 v8, v0, 4, s3
    v_and_b32 v10, 63, v0
    v_lshlrev_b32 v1, 4, v10
    v_lshlrev_b32 v193, 2, v10
    v_lshlrev_b32 v11, 4, v0
    v_mov_b32 v12, 0
    v_mov_b32 v13, 0
    v_pk_mov_b32 v[16:17], v[12:13], v[12:13]
    v_pk_mov_b32 v[18:19], v[12:13], v[12:13]
    ds_write_b128 v11, v[16:19]
    s_cmp_ge_u32 s25, 5
    s_waitcnt lgkmcnt(0)
    s_cbranch_scc1 NO_EDGES
    s_cmp_ge_u32 s2, 250
    s_cbranch_scc1 AUX_LOAD
    s_setprio 1
    global_load_dwordx4 v[64:67], v8, s[44:45]
    global_load_dwordx4 v[68:71], v8, s[42:43]
NO_EDGES:
    s_add_u32 s4, s16, 8912896
    s_addc_u32 s5, s17, 0
    s_load_dwordx2 s[64:65], s[4:5], 0
    global_load_dword v188, v193, s[50:51] offset:0
    global_load_dword v189, v193, s[50:51] offset:256
    global_load_dword v190, v193, s[50:51] offset:512
    global_load_dword v191, v193, s[50:51] offset:768
    v_and_b32 v193, 0x7f, v193
    global_load_dword v192, v193, s[52:53]
    s_and_b32 s3, s2, 0x87
    s_cmp_eq_u32 s3, 0
    s_cselect_b32 s3, 128, 0
    s_add_u32 s3, s3, DEAL_TABLE-CODE_HERE
    v_lshl_add_u32 v174, v10, 1, s3
    global_load_ushort v174, v174, s[6:7]
    s_mov_b32 s14, 10240000
    s_mov_b32 s15, 0x20000
    v_lshlrev_b32 v9, 1, v8
    s_and_b32 s4, s2, 7
    s_lshl_b32 s4, s4, 5
    s_lshr_b32 s5, s2, 3
    s_or_b32 s24, s4, s5
    v_mov_b32 v15, 1
    s_mov_b32 s18, 8913024
    s_mov_b32 s19, 0x20000
    s_mov_b32 s22, 10240000
    s_mov_b32 s23, 0x20000
    s_mov_b32 s34, 0xfffffc00
    s_mov_b32 s27, 0
    s_mov_b32 s10, 0xbfb8aa3b
    s_mov_b32 s11, 0xbfb8aa3b
    s_mov_b32 s35, 2097152
    v_and_b32 v4, 0xff, v0
    s_lshl_b32 s3, s24, 4
    s_add_u32 s3, s3, 7864320
    v_lshl_add_u32 v6, v4, 12, s3
    v_mul_u32_u24 v4, 1280, v4
    v_mul_u32_u24 v138, 0x8000, v1
    v_lshl_add_u32 v138, v10, 3, v138
    v_pk_mov_b32 v[20:21], v[12:13], v[12:13]
    v_pk_mov_b32 v[22:23], v[12:13], v[12:13]
    v_pk_mov_b32 v[24:25], v[12:13], v[12:13]
    v_pk_mov_b32 v[26:27], v[12:13], v[12:13]
    v_pk_mov_b32 v[28:29], v[12:13], v[12:13]
    v_pk_mov_b32 v[30:31], v[12:13], v[12:13]
    v_pk_mov_b32 v[32:33], v[12:13], v[12:13]
    v_pk_mov_b32 v[34:35], v[12:13], v[12:13]
    v_pk_mov_b32 v[36:37], v[12:13], v[12:13]
    v_pk_mov_b32 v[38:39], v[12:13], v[12:13]
    v_pk_mov_b32 v[40:41], v[12:13], v[12:13]
    v_pk_mov_b32 v[42:43], v[12:13], v[12:13]
    v_pk_mov_b32 v[44:45], v[12:13], v[12:13]
    v_pk_mov_b32 v[46:47], v[12:13], v[12:13]
    v_pk_mov_b32 v[48:49], v[12:13], v[12:13]
    v_pk_mov_b32 v[50:51], v[12:13], v[12:13]
    v_pk_mov_b32 v[52:53], v[12:13], v[12:13]
    v_pk_mov_b32 v[54:55], v[12:13], v[12:13]
    v_pk_mov_b32 v[56:57], v[12:13], v[12:13]
    v_pk_mov_b32 v[58:59], v[12:13], v[12:13]
    v_pk_mov_b32 v[60:61], v[12:13], v[12:13]
    v_pk_mov_b32 v[62:63], v[12:13], v[12:13]
    s_barrier
    s_cmp_ge_u32 s25, 5
    s_cbranch_scc1 HELP
    s_add_u32 s62, s25, 1
LUTP_W0L:
    s_mul_i32 s3, s62, 33554944
    s_add_u32 s3, s3, 4286709632
    v_add_u32 v128, s3, v138
    s_lshl_b32 s3, s62, 10
    v_add_u32 v136, s3, v1
    v_add_u32 v129, 131074, v128
    v_add_u32 v130, 262148, v128
    v_add_u32 v131, 393222, v128
    v_add_u32 v137, 0x10000, v136
    v_or_b32 v132, 0x80008000, v128
    v_or_b32 v133, 0x80008000, v129
    v_or_b32 v134, 0x80008000, v130
    v_or_b32 v135, 0x80008000, v131
    ds_write_b128 v136, v[128:131] offset:32768
    ds_write_b128 v137, v[132:135] offset:32768
    s_add_u32 s62, s62, 5
    s_cmp_le_u32 s62, 5
    s_cbranch_scc1 LUTP_W0L
LUTP_END_W0:
    s_cmp_ge_u32 s2, 250
    s_cbranch_scc1 AUX
    global_load_dwordx4 v[72:75], v9, s[46:47]
    global_load_dwordx4 v[76:79], v9, s[46:47] offset:16
    global_load_dwordx4 v[80:83], v9, s[48:49]
    global_load_dwordx4 v[84:87], v9, s[48:49] offset:16
    s_waitcnt vmcnt(11)
    v_and_b32 v88, 0xff, v64
    v_lshlrev_b32 v88, 2, v88
    ds_add_rtn_u32 v92, v88, v15 offset:2816
    v_and_b32 v89, 0xff, v65
    v_lshlrev_b32 v89, 2, v89
    ds_add_rtn_u32 v93, v89, v15 offset:2816
    v_and_b32 v90, 0xff, v66
    v_lshlrev_b32 v90, 2, v90
    ds_add_rtn_u32 v94, v90, v15 offset:2816
    v_and_b32 v91, 0xff, v67
    v_lshlrev_b32 v91, 2, v91
    ds_add_rtn_u32 v95, v91, v15 offset:2816
    s_waitcnt vmcnt(10)
    v_lshrrev_b32 v64, 8, v64
    v_lshl_or_b32 v108, v68, 10, v64
    v_lshrrev_b32 v65, 8, v65
    v_lshl_or_b32 v110, v69, 10, v65
    v_lshrrev_b32 v66, 8, v66
    v_lshl_or_b32 v112, v70, 10, v66
    v_lshrrev_b32 v67, 8, v67
    v_lshl_or_b32 v114, v71, 10, v67
    s_mov_b32 s9, 87040
    s_waitcnt lgkmcnt(0)
    s_barrier
    ds_read_b128 v[96:99], v1 offset:2816
    s_add_u32 s64, s64, 1
    s_and_b32 s65, s65, 0x3ff
    v_mov_b32 v109, s64
    v_mov_b32 v111, s64
    v_mov_b32 v113, s64
    v_mov_b32 v115, s64
    v_mov_b32 v119, 0
    v_cmp_gt_u32 vcc, 10, v92
    v_mul_u32_u24 v116, 6, v92
    v_lshlrev_b32 v117, 1, v88
    v_cndmask_b32 v118, 0, v64, vcc
    v_lshlrev_b64 v[120:121], v116, v[118:119]
    ds_or_b64 v117, v[120:121] offset:3840
    v_cmp_gt_u32 vcc, 10, v93
    v_mul_u32_u24 v116, 6, v93
    v_lshlrev_b32 v117, 1, v89
    v_cndmask_b32 v118, 0, v65, vcc
    v_lshlrev_b64 v[122:123], v116, v[118:119]
    ds_or_b64 v117, v[122:123] offset:3840
    v_cmp_gt_u32 vcc, 10, v94
    v_mul_u32_u24 v116, 6, v94
    v_lshlrev_b32 v117, 1, v90
    v_cndmask_b32 v118, 0, v66, vcc
    v_lshlrev_b64 v[120:121], v116, v[118:119]
    ds_or_b64 v117, v[120:121] offset:3840
    v_cmp_gt_u32 vcc, 10, v95
    v_mul_u32_u24 v116, 6, v95
    v_lshlrev_b32 v117, 1, v91
    v_cndmask_b32 v118, 0, v67, vcc
    v_lshlrev_b64 v[122:123], v116, v[118:119]
    ds_or_b64 v117, v[122:123] offset:3840
    s_waitcnt lgkmcnt(4)
    v_add_u32 v10, v96, v97
    v_add3_u32 v10, v10, v98, v99
    v_mov_b32 v11, v10
    s_nop 1
    v_add_u32_dpp v11, v11, v11 row_shr:1 row_mask:0xf bank_mask:0xf bound_ctrl:0
    s_nop 1
    v_add_u32_dpp v11, v11, v11 row_shr:2 row_mask:0xf bank_mask:0xf bound_ctrl:0
    s_nop 1
    v_add_u32_dpp v11, v11, v11 row_shr:4 row_mask:0xf bank_mask:0xf bound_ctrl:0
    s_nop 1
    v_add_u32_dpp v11, v11, v11 row_shr:8 row_mask:0xf bank_mask:0xf bound_ctrl:0
    s_nop 1
    v_add_u32_dpp v11, v11, v11 row_bcast:15 row_mask:0xa bank_mask:0xf
    s_nop 1
    v_add_u32_dpp v11, v11, v11 row_bcast:31 row_mask:0xc bank_mask:0xf
    v_sub_u32 v100, v11, v10
    v_add_u32 v101, v100, v96
    v_add_u32 v102, v101, v97
    v_add_u32 v103, v102, v98
    ds_write_b128 v1, v[100:103] offset:5888
    ds_read_b32 v96, v88 offset:5888
    ds_read_b32 v97, v89 offset:5888
    ds_read_b32 v98, v90 offset:5888
    ds_read_b32 v99, v91 offset:5888
    s_waitcnt lgkmcnt(3)
    v_add_u32 v92, v92, v96
    v_lshl_add_u32 v88, v92, 3, s9
    ds_write_b64 v88, v[108:109]
    s_waitcnt lgkmcnt(3)
    v_add_u32 v93, v93, v97
    v_lshl_add_u32 v89, v93, 3, s9
    ds_write_b64 v89, v[110:111]
    s_waitcnt lgkmcnt(3)
    v_add_u32 v94, v94, v98
    v_lshl_add_u32 v90, v94, 3, s9
    ds_write_b64 v90, v[112:113]
    s_waitcnt lgkmcnt(3)
    v_add_u32 v95, v95, v99
    v_lshl_add_u32 v91, v95, 3, s9
    ds_write_b64 v91, v[114:115]
    v_lshlrev_b32 v92, 4, v92
    v_add_u32 v92, 8704, v92
    v_lshlrev_b32 v93, 4, v93
    v_add_u32 v93, 8704, v93
    v_lshlrev_b32 v94, 4, v94
    v_add_u32 v94, 8704, v94
    v_lshlrev_b32 v95, 4, v95
    v_add_u32 v95, 8704, v95
    s_waitcnt lgkmcnt(0)
    s_barrier
    s_waitcnt vmcnt(0)
    s_cmp_eq_u32 s25, 4
    s_cbranch_scc1 NO_X_TOUCH_9
    s_lshl_b32 s33, s2, 2
    s_add_u32 s33, s33, s25
    s_lshl_b32 s33, s33, 7
    s_add_u32 s33, s33, 0
    v_min_u32 v166, 240, v1
    v_lshl_add_u32 v166, v166, 13, s33
    buffer_load_dword v167, v166, s[12:15], 0 offen
NO_X_TOUCH_9:
    ds_write2_b64 v92, v[72:73], v[80:81] offset0:0 offset1:1
    ds_write2_b64 v93, v[74:75], v[82:83] offset0:0 offset1:1
    ds_write2_b64 v94, v[76:77], v[84:85] offset0:0 offset1:1
    ds_write2_b64 v95, v[78:79], v[86:87] offset0:0 offset1:1
BINNED:
    s_setprio 0
    s_waitcnt lgkmcnt(0)
    s_barrier
    v_mov_b32 v2, 0
    s_call_b64 s[6:7], CONST_SUB
    s_cmp_gt_u32 s62, 24
    s_cbranch_scc1 LUTP_END_W
LUTP_WL:
    s_mul_i32 s3, s62, 33554944
    s_add_u32 s3, s3, 4286709632
    v_add_u32 v128, s3, v138
    s_lshl_b32 s3, s62, 10
    v_add_u32 v136, s3, v1
    v_add_u32 v129, 131074, v128
    v_add_u32 v130, 262148, v128
    v_add_u32 v131, 393222, v128
    v_add_u32 v137, 0x10000, v136
    v_or_b32 v132, 0x80008000, v128
    v_or_b32 v133, 0x80008000, v129
    v_or_b32 v134, 0x80008000, v130
    v_or_b32 v135, 0x80008000, v131
    ds_write_b128 v136, v[128:131] offset:32768
    ds_write_b128 v137, v[132:135] offset:32768
    s_add_u32 s62, s62, 5
    s_cmp_le_u32 s62, 24
    s_cbranch_scc1 LUTP_WL
LUTP_END_W:
    s_cmp_eq_u32 s25, 4
    s_cbranch_scc1 WAVE4
    s_add_u32 s62, s25, 34
    v_mov_b32 v132, 0x80008000
    v_mov_b32 v133, 0x80008000
    v_mov_b32 v134, 0x80008000
    v_mov_b32 v135, 0x80008000
LUTP_UH:
    s_mul_i32 s3, s62, 33554944
    s_add_u32 s3, s3, 131072
    v_add_u32 v128, s3, v138
    s_lshl_b32 s3, s62, 10
    v_add_u32 v136, s3, v1
    v_add_u32 v129, 131074, v128
    v_add_u32 v130, 262148, v128
    v_add_u32 v131, 393222, v128
    v_add_u32 v137, 0x10000, v136
    ds_write_b128 v136, v[128:131] offset:32768
    ds_write_b128 v137, v[132:135] offset:32768
    s_add_u32 s62, s62, 4
    s_cmp_le_u32 s62, 62
    s_cbranch_scc1 LUTP_UH
LUTP_END_U:
    buffer_load_dwordx4 v[168:171], v6, s[16:19], 0 offen sc1
    s_lshl_b32 s33, s2, 2
    s_add_u32 s33, s33, s25
    s_lshl_b32 s33, s33, 7
    s_add_u32 s33, s33, 2097152
    v_min_u32 v166, 240, v1
    v_lshl_add_u32 v166, v166, 13, s33
    buffer_load_dword v167, v166, s[12:15], 0 offen
NO_X_TOUCH_6:
    s_waitcnt vmcnt(1)
    s_branch CHECK_TAB
POLL_TAB:
    s_waitcnt vmcnt(0)
CHECK_TAB:
    v_lshrrev_b32 v11, 22, v168
    v_cmp_ne_u32 vcc, s64, v169
    v_cmp_ne_u32 s[42:43], s65, v11
    s_or_b64 vcc, vcc, s[42:43]
    s_and_b64 exec, exec, vcc
    s_cbranch_execz POLLED_TAB
    s_sub_u32 s35, s35, 1
    s_cbranch_scc1 END
    buffer_load_dwordx4 v[168:171], v6, s[16:19], 0 offen sc1
    s_branch POLL_TAB
POLLED_TAB:
    s_mov_b64 exec, -1
    s_branch TAB_DONE
LUT_SUB:
    s_lshl_b32 s3, s62, 25
    s_add_u32 s3, s3, 0x8000
    v_lshl_add_u32 v128, v1, 15, s3
    v_add_u32 v129, 0x10000, v128
    v_add_u32 v130, 0x10000, v129
    v_add_u32 v131, 0x10000, v130
    v_add_u32 v132, 0x10000, v131
    v_add_u32 v133, 0x10000, v132
    v_add_u32 v134, 0x10000, v133
    v_add_u32 v135, 0x10000, v134
    v_pk_mul_f32 v[136:137], v[128:129], s[10:11]
    v_pk_mul_f32 v[138:139], v[130:131], s[10:11]
    v_pk_mul_f32 v[140:141], v[132:133], s[10:11]
    v_pk_mul_f32 v[142:143], v[134:135], s[10:11]
    v_exp_f32 v136, v136
    v_exp_f32 v137, v137
    v_exp_f32 v138, v138
    v_exp_f32 v139, v139
    v_exp_f32 v140, v140
    v_exp_f32 v141, v141
    v_exp_f32 v142, v142
    v_exp_f32 v143, v143
    s_lshl_b32 s3, s62, 10
    v_pk_add_f32 v[144:145], v[136:137], 1.0 op_sel_hi:[1,0]
    v_pk_add_f32 v[146:147], v[138:139], 1.0 op_sel_hi:[1,0]
    v_pk_add_f32 v[148:149], v[140:141], 1.0 op_sel_hi:[1,0]
    v_pk_add_f32 v[150:151], v[142:143], 1.0 op_sel_hi:[1,0]
    v_rcp_f32 v144, v144
    v_rcp_f32 v145, v145
    v_rcp_f32 v146, v146
    v_rcp_f32 v147, v147
    v_rcp_f32 v148, v148
    v_rcp_f32 v149, v149
    v_rcp_f32 v150, v150
    v_rcp_f32 v151, v151
    v_add_u32 v160, s3, v1
    v_pk_mul_f32 v[128:129], v[128:129], v[144:145]
    v_pk_mul_f32 v[130:131], v[130:131], v[146:147]
    v_pk_mul_f32 v[132:133], v[132:133], v[148:149]
    v_pk_mul_f32 v[134:135], v[134:135], v[150:151]
    v_add_u32 v161, 0x10000, v160
    v_pk_mul_f32 v[136:137], v[128:129], v[136:137] neg_lo:[1,0] neg_hi:[1,0]
    v_pk_mul_f32 v[138:139], v[130:131], v[138:139] neg_lo:[1,0] neg_hi:[1,0]
    v_pk_mul_f32 v[140:141], v[132:133], v[140:141] neg_lo:[1,0] neg_hi:[1,0]
    v_pk_mul_f32 v[142:143], v[134:135], v[142:143] neg_lo:[1,0] neg_hi:[1,0]
    v_cvt_pk_bf16_f32 v152, v128, v129
    v_cvt_pk_bf16_f32 v153, v130, v131
    v_cvt_pk_bf16_f32 v154, v132, v133
    v_cvt_pk_bf16_f32 v155, v134, v135
    v_cvt_pk_bf16_f32 v156, v136, v137
    v_cvt_pk_bf16_f32 v157, v138, v139
    v_cvt_pk_bf16_f32 v158, v140, v141
    v_cvt_pk_bf16_f32 v159, v142, v143
    ds_write_b128 v160, v[152:155] offset:32768
    ds_write_b128 v161, v[156:159] offset:32768
    s_add_u32 s62, s62, 1
    s_sub_u32 s63, s63, 1
    s_cmp_lg_u32 s63, 0
    s_cbranch_scc1 LUT_SUB
    s_setpc_b64 s[6:7]
CONST_SUB:
    ds_write_b32 v193, v192 offset:32256
    v_lshrrev_b32 v193, 3, v1
    v_and_b32 v193, 24, v193
    s_mov_b32 s4, 0x05040100
    s_mov_b32 s5, 0x07060302
    ds_read_b64_tr_b16 v[180:181], v193 offset:32256
    ds_read_b64_tr_b16 v[182:183], v193 offset:32288
    ds_read_b64_tr_b16 v[184:185], v193 offset:32320
    ds_read_b64_tr_b16 v[186:187], v193 offset:32352
    v_perm_b32 v176, v189, v188, s4
    v_perm_b32 v178, v189, v188, s5
    v_perm_b32 v177, v191, v190, s4
    v_perm_b32 v179, v191, v190, s5
    s_setpc_b64 s[6:7]
HELP:
    s_sub_u32 s8, s25, 5
    s_mul_i32 s4, s8, 3072
    s_cmp_eq_u32 s8, 1
    s_cselect_b32 s4, 4096, s4
    s_mul_i32 s3, s2, 10240
    s_add_u32 s3, s3, s4
    v_add_u32 v8, s3, v1
    s_add_u32 s4, s4, 87040
    v_add_u32 v9, s4, v1
    s_mul_i32 s4, s8, 7168
    s_mul_i32 s3, s2, 20480
    s_add_u32 s3, s3, s4
    s_add_u32 s3, s3, 2621440
    v_add_u32 v12, s3, v1
    v_add_u32 v13, s4, v1
    s_lshl_b32 s3, s2, 12
    s_add_u32 s3, s3, 7864320
    v_add_u32 v117, s3, v1
    s_waitcnt lgkmcnt(0)
    s_add_u32 s64, s64, 1
    s_and_b32 s65, s65, 0x3ff
    s_barrier
    s_cmp_eq_u32 s25, 6
    s_cbranch_scc1 ROW
    s_cmp_eq_u32 s25, 7
    s_cselect_b32 s62, 63, 0
    s_mov_b32 s63, 1
    s_call_b64 s[6:7], LUT_SUB
    s_waitcnt vmcnt(0)
    s_call_b64 s[6:7], CONST_SUB
    v_mov_b32 v10, 65280
    v_mov_b32 v11, 0x7f80
    s_cmp_lg_u32 s25, 7
    s_cbranch_scc1 NO_ROW
    ds_write_b16 v10, v11 offset:32768
    s_branch NO_ROW
ROW:
    v_lshrrev_b32 v116, 2, v1
    ds_read_b32 v100, v116 offset:2816
    ds_read_b32 v101, v116 offset:3072
    ds_read_b32 v102, v116 offset:3328
    ds_read_b32 v103, v116 offset:3584
    s_lshl_b32 s3, s2, 12
    s_add_u32 s3, s3, 7864320
    v_add_u32 v117, s3, v1
    v_lshrrev_b32 v116, 1, v1
    s_lshl_b32 s3, s65, 22
    s_waitcnt lgkmcnt(0)
    v_mov_b32 v104, v100
    v_mov_b32 v105, v101
    v_mov_b32 v106, v102
    v_mov_b32 v107, v103
    s_nop 0
    v_add_u32_dpp v104, v104, v104 row_shr:1 row_mask:0xf bank_mask:0xf bound_ctrl:0
    v_add_u32_dpp v105, v105, v105 row_shr:1 row_mask:0xf bank_mask:0xf bound_ctrl:0
    v_add_u32_dpp v106, v106, v106 row_shr:1 row_mask:0xf bank_mask:0xf bound_ctrl:0
    v_add_u32_dpp v107, v107, v107 row_shr:1 row_mask:0xf bank_mask:0xf bound_ctrl:0
    s_nop 0
    v_add_u32_dpp v104, v104, v104 row_shr:2 row_mask:0xf bank_mask:0xf bound_ctrl:0
    v_add_u32_dpp v105, v105, v105 row_shr:2 row_mask:0xf bank_mask:0xf bound_ctrl:0
    v_add_u32_dpp v106, v106, v106 row_shr:2 row_mask:0xf bank_mask:0xf bound_ctrl:0
    v_add_u32_dpp v107, v107, v107 row_shr:2 row_mask:0xf bank_mask:0xf bound_ctrl:0
    s_nop 0
    v_add_u32_dpp v104, v104, v104 row_shr:4 row_mask:0xf bank_mask:0xf bound_ctrl:0
    v_add_u32_dpp v105, v105, v105 row_shr:4 row_mask:0xf bank_mask:0xf bound_ctrl:0
    v_add_u32_dpp v106, v106, v106 row_shr:4 row_mask:0xf bank_mask:0xf bound_ctrl:0
    v_add_u32_dpp v107, v107, v107 row_shr:4 row_mask:0xf bank_mask:0xf bound_ctrl:0
    s_nop 0
    v_add_u32_dpp v104, v104, v104 row_shr:8 row_mask:0xf bank_mask:0xf bound_ctrl:0
    v_add_u32_dpp v105, v105, v105 row_shr:8 row_mask:0xf bank_mask:0xf bound_ctrl:0
    v_add_u32_dpp v106, v106, v106 row_shr:8 row_mask:0xf bank_mask:0xf bound_ctrl:0
    v_add_u32_dpp v107, v107, v107 row_shr:8 row_mask:0xf bank_mask:0xf bound_ctrl:0
    s_nop 0
    v_add_u32_dpp v104, v104, v104 row_bcast:15 row_mask:0xa bank_mask:0xf
    v_add_u32_dpp v105, v105, v105 row_bcast:15 row_mask:0xa bank_mask:0xf
    v_add_u32_dpp v106, v106, v106 row_bcast:15 row_mask:0xa bank_mask:0xf
    v_add_u32_dpp v107, v107, v107 row_bcast:15 row_mask:0xa bank_mask:0xf
    s_nop 0
    v_add_u32_dpp v104, v104, v104 row_bcast:31 row_mask:0xc bank_mask:0xf
    v_add_u32_dpp v105, v105, v105 row_bcast:31 row_mask:0xc bank_mask:0xf
    v_add_u32_dpp v106, v106, v106 row_bcast:31 row_mask:0xc bank_mask:0xf
    v_add_u32_dpp v107, v107, v107 row_bcast:31 row_mask:0xc bank_mask:0xf
    v_readlane_b32 s4, v104, 63
    v_readlane_b32 s5, v105, 63
    v_readlane_b32 s9, v106, 63
    v_sub_u32 v104, v104, v100
    v_sub_u32 v105, v105, v101
    v_sub_u32 v106, v106, v102
    v_sub_u32 v107, v107, v103
    s_add_u32 s5, s5, s4
    s_add_u32 s9, s9, s5
    v_add_u32 v105, s4, v105
    v_add_u32 v106, s5, v106
    v_add_u32 v107, s9, v107
    v_lshl_or_b32 v84, v100, 11, v104
    v_or_b32 v84, s3, v84
    v_mov_b32 v85, s64
    v_lshl_or_b32 v88, v101, 11, v105
    v_or_b32 v88, s3, v88
    v_mov_b32 v89, s64
    v_lshl_or_b32 v92, v102, 11, v106
    v_or_b32 v92, s3, v92
    v_mov_b32 v93, s64
    v_lshl_or_b32 v96, v103, 11, v107
    v_or_b32 v96, s3, v96
    v_mov_b32 v97, s64
    s_waitcnt vmcnt(0)
    s_call_b64 s[6:7], CONST_SUB
NO_ROW:
    s_barrier
    s_cmp_lg_u32 s25, 6
    s_cbranch_scc1 ROW_DONE
    ds_read_b64 v[86:87], v116 offset:3840
    ds_read_b64 v[90:91], v116 offset:4352
    ds_read_b64 v[94:95], v116 offset:4864
    ds_read_b64 v[98:99], v116 offset:5376
    s_waitcnt lgkmcnt(3)
    global_store_dwordx4 v117, v[84:87], s[16:17] offset:0 sc0 sc1
    s_waitcnt lgkmcnt(2)
    global_store_dwordx4 v117, v[88:91], s[16:17] offset:1024 sc0 sc1
    s_waitcnt lgkmcnt(1)
    global_store_dwordx4 v117, v[92:95], s[16:17] offset:2048 sc0 sc1
    s_waitcnt lgkmcnt(0)
    global_store_dwordx4 v117, v[96:99], s[16:17] offset:3072 sc0 sc1
ROW_DONE:
    ds_read_b128 v[64:67], v9 offset:0
    ds_read_b128 v[68:71], v9 offset:1024
    ds_read_b128 v[72:75], v9 offset:2048
    ds_read_b128 v[76:79], v9 offset:3072
    v_mov_b32 v2, 0
    s_add_u32 s62, s8, s8
    s_add_u32 s62, s62, 27
    s_cmp_eq_u32 s8, 2
    s_addc_u32 s62, s62, 0
    s_cmp_eq_u32 s8, 1
    s_cselect_b32 s63, 3, 2
    s_waitcnt lgkmcnt(0)
    s_barrier
    s_cmp_ge_u32 s2, 250
    s_cbranch_scc1 RECS_STORED
    ds_read_b128 v[84:87], v13 offset:8704
    ds_read_b128 v[88:91], v13 offset:9728
    ds_read_b128 v[92:95], v13 offset:10752
    ds_read_b128 v[96:99], v13 offset:11776
    ds_read_b128 v[100:103], v13 offset:12800
    ds_read_b128 v[104:107], v13 offset:13824
    ds_read_b128 v[108:111], v13 offset:14848
    s_waitcnt lgkmcnt(6)
    global_store_dwordx4 v12, v[84:87], s[16:17] offset:0 sc0 sc1
    s_waitcnt lgkmcnt(5)
    global_store_dwordx4 v12, v[88:91], s[16:17] offset:1024 sc0 sc1
    s_waitcnt lgkmcnt(4)
    global_store_dwordx4 v12, v[92:95], s[16:17] offset:2048 sc0 sc1
    s_waitcnt lgkmcnt(3)
    global_store_dwordx4 v12, v[96:99], s[16:17] offset:3072 sc0 sc1
    v_add_u32 v12, 4096, v12
    s_waitcnt lgkmcnt(2)
    global_store_dwordx4 v12, v[100:103], s[16:17] offset:0 sc0 sc1
    s_waitcnt lgkmcnt(1)
    global_store_dwordx4 v12, v[104:107], s[16:17] offset:1024 sc0 sc1
    s_cmp_eq_u32 s8, 2
    s_cbranch_scc1 RECS_STORED
    s_waitcnt lgkmcnt(0)
    global_store_dwordx4 v12, v[108:111], s[16:17] offset:2048 sc0 sc1
RECS_STORED:
    s_call_b64 s[6:7], LUT_SUB
    s_cmp_ge_u32 s2, 250
    s_cbranch_scc1 TAB_DONE
    v_mov_b32 v10, 0
    s_waitcnt vmcnt(0)
    s_mov_b64 exec, 1
    ds_add_u32 v10, v15 offset:1296
    s_mov_b64 exec, -1
WAIT_ACK:
    ds_read_b32 v11, v10 offset:1296
    s_waitcnt lgkmcnt(0)
    v_readfirstlane_b32 s3, v11
    s_cmp_eq_u32 s3, 3
    s_cbranch_scc0 WAIT_ACK
    global_store_dwordx4 v8, v[64:67], s[16:17] offset:0 sc0 sc1
    global_store_dwordx4 v8, v[68:71], s[16:17] offset:1024 sc0 sc1
    s_cmp_eq_u32 s8, 1
    s_cbranch_scc1 TAB_DONE
    global_store_dwordx4 v8, v[72:75], s[16:17] offset:2048 sc0 sc1
    global_store_dwordx4 v8, v[76:79], s[16:17] offset:3072 sc0 sc1
    s_branch TAB_DONE
AUX_LOAD:
    s_sub_u32 s4, s2, 250
    s_cmp_ge_u32 s4, 4
    s_cbranch_scc1 NO_EDGES
    s_cmp_ge_u32 s25, 4
    s_cbranch_scc1 NO_EDGES
    s_lshl_b32 s5, s25, 13
    s_lshl_b32 s8, s4, 6
    s_add_u32 s5, s5, s8
    v_lshrrev_b32 v80, 8, v1
    v_lshlrev_b32 v80, 11, v80
    v_bfe_u32 v81, v1, 4, 4
    v_lshl_add_u32 v80, v81, 2, v80
    v_add_u32 v80, s5, v80
    global_load_dword v64, v80, s[54:55] offset:0
    global_load_dword v65, v80, s[54:55] offset:256
    global_load_dword v66, v80, s[54:55] offset:512
    global_load_dword v67, v80, s[54:55] offset:768
    global_load_dword v68, v80, s[54:55] offset:1024
    global_load_dword v69, v80, s[54:55] offset:1280
    global_load_dword v70, v80, s[54:55] offset:1536
    global_load_dword v71, v80, s[54:55] offset:1792
    s_branch NO_EDGES
AUX:
    s_cmp_ge_u32 s2, 254
    s_cbranch_scc1 AUX_DONE
    s_cmp_ge_u32 s25, 4
    s_cbranch_scc1 AUX_DONE
    s_sub_u32 s4, s2, 250
    s_lshl_b32 s5, s4, 13
    s_lshl_b32 s8, s25, 10
    s_add_u32 s5, s5, s8
    s_add_u32 s5, s5, 7802880
    v_add_u32 v81, s5, v1
    s_mov_b32 s4, 0x05040100
    s_mov_b32 s5, 0x07060302
    s_waitcnt vmcnt(6)
    v_perm_b32 v72, v65, v64, s4
    v_perm_b32 v76, v65, v64, s5
    v_perm_b32 v73, v67, v66, s4
    v_perm_b32 v77, v67, v66, s5
    v_perm_b32 v74, v69, v68, s4
    v_perm_b32 v78, v69, v68, s5
    v_perm_b32 v75, v71, v70, s4
    v_perm_b32 v79, v71, v70, s5
    global_store_dwordx4 v81, v[72:75], s[16:17] sc0 sc1
    v_add_u32 v81, 4096, v81
    global_store_dwordx4 v81, v[76:79], s[16:17] sc0 sc1
AUX_DONE:
    s_waitcnt lgkmcnt(0)
    s_add_u32 s64, s64, 1
    s_and_b32 s65, s65, 0x3ff
    s_barrier
    s_waitcnt vmcnt(0)
    s_barrier
    s_branch BINNED
WAVE4:
    s_mov_b32 s62, 25
    s_mov_b32 s63, 2
    s_call_b64 s[6:7], LUT_SUB
TAB_DONE:
    s_cmp_ge_u32 s25, 4
    s_cbranch_scc1 TOTALS
    v_and_b32 v13, 0x7ff, v168
    v_bfe_u32 v2, v168, 11, 11
    v_add_u32 v4, v4, v13
    v_mov_b32 v3, v2
    s_nop 1
    v_add_u32_dpp v3, v3, v3 row_shr:1 row_mask:0xf bank_mask:0xf bound_ctrl:0
    s_nop 1
    v_add_u32_dpp v3, v3, v3 row_shr:2 row_mask:0xf bank_mask:0xf bound_ctrl:0
    s_nop 1
    v_add_u32_dpp v3, v3, v3 row_shr:4 row_mask:0xf bank_mask:0xf bound_ctrl:0
    s_nop 1
    v_add_u32_dpp v3, v3, v3 row_shr:8 row_mask:0xf bank_mask:0xf bound_ctrl:0
    s_nop 1
    v_add_u32_dpp v3, v3, v3 row_bcast:15 row_mask:0xa bank_mask:0xf
    s_nop 1
    v_add_u32_dpp v3, v3, v3 row_bcast:31 row_mask:0xc bank_mask:0xf
    s_lshl_b32 s3, s25, 2
    v_mov_b32 v10, s3
    v_add_u32 v11, 1, v3
    v_sub_u32 v3, v3, v2
    s_mov_b32 exec_lo, 0
    s_mov_b32 exec_hi, 0x80000000
    ds_write_b32 v10, v11 offset:1280
    s_mov_b64 exec, -1
TOTALS:
    v_mov_b32 v10, 0
TOTALS_SPIN:
    ds_read_b128 v[64:67], v10 offset:1280
    s_waitcnt lgkmcnt(0)
    v_readfirstlane_b32 s4, v64
    v_readfirstlane_b32 s5, v65
    v_readfirstlane_b32 s6, v66
    v_readfirstlane_b32 s7, v67
    s_min_u32 s3, s4, s5
    s_min_u32 s8, s6, s7
    s_min_u32 s3, s3, s8
    s_cmp_eq_u32 s3, 0
    s_cbranch_scc0 TOTALS_OK
    s_sub_u32 s35, s35, 1
    s_cbranch_scc0 TOTALS_SPIN
    s_endpgm
TOTALS_OK:
    s_add_u32 s5, s5, s4
    s_add_u32 s6, s6, s5
    s_add_u32 s7, s7, s6
    s_sub_u32 s26, s7, 4
    s_cmp_eq_u32 s25, 1
    s_cselect_b32 s3, s4, 0
    s_cmp_eq_u32 s25, 2
    s_cselect_b32 s3, s5, s3
    s_cmp_eq_u32 s25, 3
    s_cselect_b32 s3, s6, s3
    s_sub_u32 s3, s3, s25
    v_add_u32 v3, s3, v3
    s_cmp_lg_u32 s25, 4
    s_cbranch_scc1 EPOCH_DONE
    s_cmp_lg_u32 s2, 0
    s_cbranch_scc1 EPOCH_DONE
    v_mov_b32 v12, s64
    v_mov_b32 v10, 8912896
    s_mov_b64 exec, 1
    global_store_dword v10, v12, s[16:17] sc0 sc1
    s_mov_b64 exec, -1
EPOCH_DONE:
    s_lshl_b32 s33, s2, 3
    s_add_u32 s33, s33, s25
    s_lshl_b32 s33, s33, 7
    s_add_u32 s33, s33, 4194304
    v_min_u32 v166, 112, v1
    v_lshl_add_u32 v166, v166, 14, s33
    buffer_load_dword v167, v166, s[12:15], 0 offen
NO_X_TOUCH_3:
ROUND:
    v_mov_b32 v8, 0
    v_subrev_u32 v9, s27, v3
    v_mov_b32 v10, v4
    s_mov_b32 s3, 1472
    s_cmp_gt_u32 s26, 1472
    s_cbranch_scc1 EXPAND
    v_lshlrev_b32 v11, 2, v3
    v_cmpx_lt_u32 vcc, 0, v2
    ds_write_b32 v11, v10 offset:2816
    v_add_u32 v10, 1, v10
    v_cmpx_lt_u32 vcc, 1, v2
    ds_write_b32 v11, v10 offset:2820
    v_add_u32 v10, 1, v10
    v_cmpx_lt_u32 vcc, 2, v2
    ds_write_b32 v11, v10 offset:2824
    v_add_u32 v10, 1, v10
    v_cmpx_lt_u32 vcc, 3, v2
    ds_write_b32 v11, v10 offset:2828
    v_add_u32 v10, 1, v10
    v_cmpx_lt_u32 vcc, 4, v2
    ds_write_b32 v11, v10 offset:2832
    v_add_u32 v10, 1, v10
    v_cmpx_lt_u32 vcc, 5, v2
    ds_write_b32 v11, v10 offset:2836
    v_add_u32 v10, 1, v10
    v_cmpx_lt_u32 vcc, 6, v2
    s_cbranch_execz EXPAND_DONE
    ds_write_b32 v11, v10 offset:2840
    v_add_u32 v10, 1, v10
    v_cmpx_lt_u32 vcc, 7, v2
    ds_write_b32 v11, v10 offset:2844
    v_add_u32 v10, 1, v10
    v_cmpx_lt_u32 vcc, 8, v2
    s_cbranch_execz EXPAND_DONE
    ds_write_b32 v11, v10 offset:2848
    v_add_u32 v10, 1, v10
    v_cmpx_lt_u32 vcc, 9, v2
    ds_write_b32 v11, v10 offset:2852
    v_add_u32 v10, 1, v10
    v_cmpx_lt_u32 vcc, 10, v2
    s_cbranch_execz EXPAND_DONE
    ds_write_b32 v11, v10 offset:2856
    v_add_u32 v10, 1, v10
    v_cmpx_lt_u32 vcc, 11, v2
    ds_write_b32 v11, v10 offset:2860
    v_add_u32 v10, 1, v10
    v_cmpx_lt_u32 vcc, 12, v2
    s_cbranch_execz EXPAND_DONE
    ds_write_b32 v11, v10 offset:2864
    v_add_u32 v10, 1, v10
    v_cmpx_lt_u32 vcc, 13, v2
    ds_write_b32 v11, v10 offset:2868
    v_add_u32 v10, 1, v10
    v_cmpx_lt_u32 vcc, 14, v2
    s_cbranch_execz EXPAND_DONE
    ds_write_b32 v11, v10 offset:2872
    v_add_u32 v10, 1, v10
    v_cmpx_lt_u32 vcc, 15, v2
    ds_write_b32 v11, v10 offset:2876
    v_add_u32 v10, 1, v10
    v_mov_b32 v8, 16
    v_add_u32 v9, 16, v9
EXPAND:
    v_cmp_lt_u32 vcc, v8, v2
    s_and_b64 exec, exec, vcc
    s_cbranch_execz EXPAND_DONE
    v_cmp_gt_u32 vcc, s3, v9
    v_lshlrev_b32 v11, 2, v9
    s_and_saveexec_b64 s[42:43], vcc
    ds_write_b32 v11, v10 offset:2816
    s_mov_b64 exec, s[42:43]
    v_add_u32 v8, 1, v8
    v_add_u32 v9, 1, v9
    v_add_u32 v10, 1, v10
    s_branch EXPAND
EXPAND_DONE:
    s_mov_b64 exec, -1
    s_sub_u32 s28, s26, s27
    s_min_u32 s28, s28, 1472
    v_lshlrev_b32 v8, 2, v0
    v_add_u32 v9, 0, v0
    v_cmp_gt_u32 s[36:37], s28, v9
    v_add_u32 v9, 512, v0
    v_cmp_gt_u32 s[38:39], s28, v9
    v_add_u32 v9, 1024, v0
    v_cmp_gt_u32 s[40:41], s28, v9
    s_waitcnt lgkmcnt(0)
    s_barrier
    ds_read_b32 v64, v8 offset:2816
    ds_read_b32 v65, v8 offset:4864
    ds_read_b32 v66, v8 offset:6912
    s_mov_b32 s44, 13421
    s_waitcnt lgkmcnt(0)
    v_lshlrev_b32 v68, 3, v64
    v_lshlrev_b32 v64, 4, v64
    v_lshlrev_b32 v69, 3, v65
    v_lshlrev_b32 v65, 4, v65
    v_lshlrev_b32 v70, 3, v66
    v_lshlrev_b32 v66, 4, v66
    s_mov_b64 exec, s[40:41]
    s_cbranch_execz SKIP3
    buffer_load_dwordx2 v[100:101], v70, s[16:19], 0 offen sc1
SKIP3:
    s_mov_b64 exec, s[36:37]
    buffer_load_dwordx2 v[96:97], v68, s[16:19], 0 offen sc1
    s_mov_b64 exec, s[38:39]
    buffer_load_dwordx2 v[98:99], v69, s[16:19], 0 offen sc1
    s_mov_b64 exec, -1
    v_lshrrev_b32 v8, 4, v1
    s_cmp_lg_u32 s27, 0
    s_cbranch_scc1 KEY_WAIT
    s_cmp_ge_u32 s25, 4
    s_cbranch_scc1 DEG_DONE
    v_bfe_u32 v9, v170, 0, 6
    v_lshlrev_b32 v9, 2, v9
    v_cmpx_lt_u32 vcc, 0, v2
    ds_add_u32 v9, v15 offset:1024
    v_bfe_u32 v10, v170, 6, 6
    v_lshlrev_b32 v10, 2, v10
    v_cmpx_lt_u32 vcc, 1, v2
    ds_add_u32 v10, v15 offset:1024
    v_bfe_u32 v9, v170, 12, 6
    v_lshlrev_b32 v9, 2, v9
    v_cmpx_lt_u32 vcc, 2, v2
    ds_add_u32 v9, v15 offset:1024
    v_bfe_u32 v10, v170, 18, 6
    v_lshlrev_b32 v10, 2, v10
    v_cmpx_lt_u32 vcc, 3, v2
    ds_add_u32 v10, v15 offset:1024
    v_bfe_u32 v9, v170, 24, 6
    v_lshlrev_b32 v9, 2, v9
    v_cmpx_lt_u32 vcc, 4, v2
    ds_add_u32 v9, v15 offset:1024
    v_alignbit_b32 v10, v171, v170, 30
    v_and_b32 v10, 63, v10
    v_lshlrev_b32 v10, 2, v10
    v_cmpx_lt_u32 vcc, 5, v2
    ds_add_u32 v10, v15 offset:1024
    v_bfe_u32 v9, v171, 4, 6
    v_lshlrev_b32 v9, 2, v9
    v_cmpx_lt_u32 vcc, 6, v2
    ds_add_u32 v9, v15 offset:1024
    v_bfe_u32 v10, v171, 10, 6
    v_lshlrev_b32 v10, 2, v10
    v_cmpx_lt_u32 vcc, 7, v2
    ds_add_u32 v10, v15 offset:1024
    v_bfe_u32 v9, v171, 16, 6
    v_lshlrev_b32 v9, 2, v9
    v_cmpx_lt_u32 vcc, 8, v2
    ds_add_u32 v9, v15 offset:1024
    v_bfe_u32 v10, v171, 22, 6
    v_lshlrev_b32 v10, 2, v10
    v_cmpx_lt_u32 vcc, 9, v2
    ds_add_u32 v10, v15 offset:1024
    s_mov_b64 exec, -1
DEG_DONE:
    v_lshlrev_b32 v9, 2, v8
    v_cmp_gt_u32 s[42:43], 40, v8
    v_sub_u32 v10, 63, v8
    s_mul_i32 s10, s25, 5
    s_waitcnt lgkmcnt(0)
    s_barrier
    ds_read_b32 v84, v9 offset:1024
    v_add_u32 v11, s10, v8
    v_lshlrev_b32 v12, 2, v11
    s_waitcnt lgkmcnt(0)
    v_lshl_or_b32 v84, v84, 6, v10
    v_cndmask_b32 v84, 0, v84, s[42:43]
    s_nop 0
    v_readlane_b32 s4, v84, s10
    s_add_u32 s10, s10, 1
    v_readlane_b32 s5, v84, s10
    s_add_u32 s10, s10, 1
    v_readlane_b32 s6, v84, s10
    s_add_u32 s10, s10, 1
    v_readlane_b32 s7, v84, s10
    s_add_u32 s10, s10, 1
    v_readlane_b32 s8, v84, s10
    v_cmp_lt_u32 s[48:49], s4, v84
    v_cmp_lt_u32 s[50:51], s5, v84
    v_cmp_lt_u32 s[52:53], s6, v84
    v_cmp_lt_u32 s[54:55], s7, v84
    v_cmp_lt_u32 s[56:57], s8, v84
    s_bcnt1_i32_b64 s4, s[48:49]
    s_bcnt1_i32_b64 s5, s[50:51]
    s_bcnt1_i32_b64 s6, s[52:53]
    s_bcnt1_i32_b64 s7, s[54:55]
    s_bcnt1_i32_b64 s8, s[56:57]
    v_readlane_b32 s4, v174, s4
    v_readlane_b32 s5, v174, s5
    v_readlane_b32 s6, v174, s6
    v_readlane_b32 s7, v174, s7
    v_readlane_b32 s8, v174, s8
    s_nop 0
    v_writelane_b32 v9, s4, 0
    v_writelane_b32 v9, s5, 1
    v_writelane_b32 v9, s6, 2
    v_writelane_b32 v9, s7, 3
    v_writelane_b32 v9, s8, 4
    v_lshrrev_b32 v10, 11, v9
    v_bfe_u32 v13, v9, 8, 3
    v_lshlrev_b32 v10, 7, v10
    v_and_b32 v9, 0xff, v9
    v_lshl_or_b32 v10, v13, 19, v10
    s_mov_b64 exec, 0x1f
    ds_write_b32 v9, v11 offset:1344
    ds_write_b32 v12, v10 offset:1536
    s_mov_b64 exec, -1
    s_waitcnt lgkmcnt(0)
    s_barrier
KEY_WAIT:
    s_lshl_b32 s3, s25, 10
    s_add_u32 s3, s3, 8704
    s_mov_b32 s9, 2621440
KEY_WAIT0:
    s_waitcnt vmcnt(0)
    v_cmp_ne_u32 s[48:49], s64, v97
    v_cmp_ne_u32 s[50:51], s64, v99
    v_cmp_ne_u32 s[52:53], s64, v101
    v_and_b32 v72, 63, v96
    v_lshlrev_b32 v72, 2, v72
    v_and_b32 v73, 63, v98
    v_lshlrev_b32 v73, 2, v73
    v_and_b32 v74, 63, v100
    v_lshlrev_b32 v74, 2, v74
    s_and_b64 s[48:49], s[48:49], s[36:37]
    s_and_b64 s[50:51], s[50:51], s[38:39]
    s_and_b64 s[52:53], s[52:53], s[40:41]
    s_or_b64 s[48:49], s[48:49], s[50:51]
    s_or_b64 s[48:49], s[48:49], s[52:53]
    s_cbranch_scc0 KEYS_OK
    s_sub_u32 s35, s35, 1
    s_cbranch_scc1 END
    s_mov_b64 exec, s[40:41]
    s_cbranch_execz SKIP3R
    buffer_load_dwordx2 v[100:101], v70, s[16:19], 0 offen sc1
SKIP3R:
    s_mov_b64 exec, s[36:37]
    buffer_load_dwordx2 v[96:97], v68, s[16:19], 0 offen sc1
    s_mov_b64 exec, s[38:39]
    buffer_load_dwordx2 v[98:99], v69, s[16:19], 0 offen sc1
    s_mov_b64 exec, -1
    s_branch KEY_WAIT0
KEYS_OK:
    ds_read_b32 v72, v72 offset:1536
    ds_read_b32 v73, v73 offset:1536
    ds_read_b32 v74, v74 offset:1536
    s_add_u32 m0, s3, 16384
    s_mov_b64 exec, s[40:41]
    s_cbranch_execz SKIP3D
    buffer_load_dwordx4 v66, s[16:19], s9 offen sc1 lds
SKIP3D:
    s_add_u32 m0, s3, 0
    s_mov_b64 exec, s[36:37]
    buffer_load_dwordx4 v64, s[16:19], s9 offen sc1 lds
    s_mov_b64 exec, -1
    v_mul_hi_u32 v76, s44, v96
    v_add_u32 v9, 0, v0
    v_lshlrev_b32 v9, 21, v9
    v_lshrrev_b32 v80, 10, v96
    v_lshl_or_b32 v80, v80, 7, v9
    v_mul_hi_u32 v77, s44, v98
    v_add_u32 v9, 512, v0
    v_lshlrev_b32 v9, 21, v9
    v_lshrrev_b32 v81, 10, v98
    v_lshl_or_b32 v81, v81, 7, v9
    v_mul_hi_u32 v78, s44, v100
    v_add_u32 v9, 1024, v0
    v_lshlrev_b32 v9, 21, v9
    v_lshrrev_b32 v82, 10, v100
    v_lshl_or_b32 v82, v82, 7, v9
    s_waitcnt lgkmcnt(2)
    v_lshrrev_b32 v9, 16, v72
    v_and_b32 v72, 0x380, v72
    v_or_b32 v80, v80, v9
    v_lshl_add_u32 v72, v76, 2, v72
    s_waitcnt lgkmcnt(1)
    v_lshrrev_b32 v9, 16, v73
    v_and_b32 v73, 0x380, v73
    v_or_b32 v81, v81, v9
    v_lshl_add_u32 v73, v77, 2, v73
    s_waitcnt lgkmcnt(0)
    v_lshrrev_b32 v9, 16, v74
    v_and_b32 v74, 0x380, v74
    v_or_b32 v82, v82, v9
    v_lshl_add_u32 v74, v78, 2, v74
    s_mov_b64 exec, s[36:37]
    ds_add_rtn_u32 v76, v72, v15 offset:0
    s_mov_b64 exec, s[38:39]
    ds_add_rtn_u32 v77, v73, v15 offset:0
    s_mov_b64 exec, s[40:41]
    ds_add_rtn_u32 v78, v74, v15 offset:0
    s_mov_b64 exec, -1
    s_add_u32 m0, s3, 8192
    s_mov_b64 exec, s[38:39]
    buffer_load_dwordx4 v65, s[16:19], s9 offen sc1 lds
    s_mov_b64 exec, -1
    s_lshl_b32 s10, s25, 3
    s_add_u32 s11, s10, 8
    s_and_b32 s11, s11, 63
    s_waitcnt lgkmcnt(0)
    s_barrier
    ds_read_b128 v[84:87], v1 offset:0
    s_cmp_lg_u32 s27, 0
    s_cbranch_scc1 NO_X_TOUCH_8
    s_lshl_b32 s33, s2, 3
    s_add_u32 s33, s33, s25
    s_lshl_b32 s33, s33, 7
    s_add_u32 s33, s33, 6291456
    v_min_u32 v166, 112, v1
    v_lshl_add_u32 v166, v166, 14, s33
    buffer_load_dword v167, v166, s[12:15], 0 offen
NO_X_TOUCH_8:
    s_waitcnt lgkmcnt(0)
    v_add_u32 v10, v84, v85
    v_add3_u32 v10, v10, v86, v87
    v_mov_b32 v11, v10
    s_nop 1
    v_add_u32_dpp v11, v11, v11 row_shr:1 row_mask:0xf bank_mask:0xf bound_ctrl:0
    s_nop 1
    v_add_u32_dpp v11, v11, v11 row_shr:2 row_mask:0xf bank_mask:0xf bound_ctrl:0
    s_nop 1
    v_add_u32_dpp v11, v11, v11 row_shr:4 row_mask:0xf bank_mask:0xf bound_ctrl:0
    s_nop 1
    v_add_u32_dpp v11, v11, v11 row_shr:8 row_mask:0xf bank_mask:0xf bound_ctrl:0
    s_nop 1
    v_add_u32_dpp v11, v11, v11 row_bcast:15 row_mask:0xa bank_mask:0xf
    s_nop 1
    v_add_u32_dpp v11, v11, v11 row_bcast:31 row_mask:0xc bank_mask:0xf
    v_sub_u32 v88, v11, v10
    v_add_u32 v89, v88, v84
    v_add_u32 v90, v89, v85
    v_add_u32 v91, v90, v86
    ds_write_b128 v1, v[88:91] offset:1792
    v_readlane_b32 s29, v88, s10
    v_readlane_b32 s30, v88, s11
    ds_read_b32 v72, v72 offset:1792
    ds_read_b32 v73, v73 offset:1792
    ds_read_b32 v74, v74 offset:1792
    s_cmp_eq_u32 s25, 7
    s_cselect_b32 s30, s28, s30
    v_add_u32 v6, s29, v8
    v_lshlrev_b32 v5, 2, v6
    v_add_u32 v5, 2816, v5
    s_sub_u32 s11, s30, s29
    s_max_u32 s10, s11, 6
    s_add_u32 s10, s10, -3
    s_and_b32 s31, s10, -4
    s_max_u32 s10, s11, s31
    s_sub_u32 s32, s10, s31
    s_waitcnt lgkmcnt(2)
    v_add_lshl_u32 v72, v72, v76, 2
    s_mov_b64 exec, s[36:37]
    ds_write_b32 v72, v80 offset:2816
    s_mov_b64 exec, -1
    s_waitcnt lgkmcnt(2)
    v_add_lshl_u32 v73, v73, v77, 2
    s_mov_b64 exec, s[38:39]
    ds_write_b32 v73, v81 offset:2816
    s_mov_b64 exec, -1
    s_waitcnt lgkmcnt(2)
    v_add_lshl_u32 v74, v74, v78, 2
    s_mov_b64 exec, s[40:41]
    ds_write_b32 v74, v82 offset:2816
    s_mov_b64 exec, -1
    s_waitcnt lgkmcnt(0)
    s_barrier
    ds_read_b32 v165, v5
    s_and_b32 s10, s25, 3
    s_lshl_b32 s10, s10, 13
    s_add_u32 s10, s10, 7802880
    s_add_u32 s11, s10, 4096
    v_mov_b32 v128, 0
    v_mov_b32 v129, 0
    v_mov_b32 v130, 0
    v_mov_b32 v131, 0
    v_mov_b32 v132, 0
    v_mov_b32 v133, 0
    v_mov_b32 v134, 0
    v_mov_b32 v135, 0
    s_waitcnt lgkmcnt(0)
    v_cmp_gt_u32 vcc, s30, v6
    v_add_u32 v6, 64, v6
    v_add_u32 v5, 256, v5
    v_cndmask_b32 v165, 40, v165, vcc
    v_lshrrev_b32 v8, 21, v165
    v_lshlrev_b32 v8, 4, v8
    v_lshlrev_b32 v9, 3, v165
    v_and_b32 v9, 0xfffc00, v9
    v_and_or_b32 v165, v165, 56, v9
    s_nop 0
    v_readlane_b32 s48, v165, 0
    s_and_b32 s33, s48, s34
    buffer_load_dwordx4 v[64:67], v1, s[12:15], s33 offen
    v_readlane_b32 s49, v165, 1
    s_and_b32 s33, s49, s34
    buffer_load_dwordx4 v[68:71], v1, s[12:15], s33 offen
    s_cmp_lg_u32 s27, 0
    s_cbranch_scc1 REC_WAIT
    s_waitcnt vmcnt(3)
    s_branch REC_IN
REC_WAIT:
    s_waitcnt vmcnt(2)
REC_IN:
    s_barrier
    ds_read_b128 v[168:171], v8 offset:8704
    v_readlane_b32 s50, v165, 2
    s_and_b32 s33, s50, s34
    buffer_load_dwordx4 v[72:75], v1, s[12:15], s33 offen
    v_readlane_b32 s51, v165, 3
    s_and_b32 s33, s51, s34
    buffer_load_dwordx4 v[76:79], v1, s[12:15], s33 offen
    v_readlane_b32 s52, v165, 4
    s_and_b32 s33, s52, s34
    buffer_load_dwordx4 v[80:83], v1, s[12:15], s33 offen
    v_readlane_b32 s53, v165, 5
    s_and_b32 s33, s53, s34
    buffer_load_dwordx4 v[84:87], v1, s[12:15], s33 offen
    v_mov_b32 v164, v165
    s_waitcnt lgkmcnt(0)
    v_mov_b32 v172, v170
    v_mov_b32 v173, v171
    v_mfma_f32_4x4x4_16b_bf16 v[148:151], v[168:169], v[180:181], 0
    v_mfma_f32_4x4x4_16b_bf16 v[152:155], v[168:169], v[182:183], 0
    v_mfma_f32_4x4x4_16b_bf16 v[156:159], v[168:169], v[184:185], 0
    v_mfma_f32_4x4x4_16b_bf16 v[160:163], v[168:169], v[186:187], 0
    v_mfma_f32_4x4x4_16b_bf16 v[112:115], v[172:173], v[176:177], 0 cbsz:4 abid:0
    v_mfma_f32_4x4x4_16b_bf16 v[116:119], v[172:173], v[178:179], 0 cbsz:4 abid:0
    v_mfma_f32_4x4x4_16b_bf16 v[120:123], v[172:173], v[176:177], 0 cbsz:4 abid:1
    s_nop 1
    v_cvt_pk_bf16_f32 v140, v148, v152
    v_cvt_pk_bf16_f32 v141, v156, v160
    v_cvt_pk_bf16_f32 v142, v149, v153
    v_cvt_pk_bf16_f32 v143, v157, v161
    v_cvt_pk_bf16_f32 v144, v150, v154
    v_cvt_pk_bf16_f32 v145, v158, v162
    v_cvt_pk_bf16_f32 v146, v151, v155
    v_cvt_pk_bf16_f32 v147, v159, v163
    v_lshlrev_b32_sdwa v136, v15, v112 dst_sel:DWORD dst_unused:UNUSED_PAD src0_sel:DWORD src1_sel:WORD_1
    v_lshlrev_b32_sdwa v137, v15, v113 dst_sel:DWORD dst_unused:UNUSED_PAD src0_sel:DWORD src1_sel:WORD_1
    ds_read_u16_d16_hi v128, v136 offset:32768
    ds_read_u16_d16_hi v129, v137 offset:32768
    v_lshlrev_b32_sdwa v138, v15, v116 dst_sel:DWORD dst_unused:UNUSED_PAD src0_sel:DWORD src1_sel:WORD_1
    v_lshlrev_b32_sdwa v139, v15, v117 dst_sel:DWORD dst_unused:UNUSED_PAD src0_sel:DWORD src1_sel:WORD_1
    ds_read_u16_d16_hi v130, v138 offset:32768
    ds_read_u16_d16_hi v131, v139 offset:32768
    s_waitcnt vmcnt(5)
    v_mfma_f32_4x4x4_16b_bf16 v[96:99], v[140:141], v[64:65], 0 cbsz:4 abid:0
    v_mfma_f32_4x4x4_16b_bf16 v[100:103], v[140:141], v[66:67], 0 cbsz:4 abid:0
A_0:
    s_sub_u32 s31, s31, 4
    s_cbranch_scc1 B_0
    v_mfma_f32_4x4x4_16b_bf16 v[124:127], v[172:173], v[178:179], 0 cbsz:4 abid:1
    v_lshlrev_b32_sdwa v136, v15, v114 dst_sel:DWORD dst_unused:UNUSED_PAD src0_sel:DWORD src1_sel:WORD_1
    s_waitcnt vmcnt(4)
    v_mfma_f32_4x4x4_16b_bf16 v[104:107], v[142:143], v[68:69], 0 cbsz:4 abid:0
    v_readlane_b32 s54, v164, 6
    v_mfma_f32_4x4x4_16b_bf16 v[108:111], v[142:143], v[70:71], 0 cbsz:4 abid:0
    v_lshlrev_b32_sdwa v137, v15, v115 dst_sel:DWORD dst_unused:UNUSED_PAD src0_sel:DWORD src1_sel:WORD_1
    ds_read_u16_d16_hi v132, v136 offset:32768
    ds_read_u16_d16_hi v133, v137 offset:32768
    s_and_b32 s33, s54, s34
    buffer_load_dwordx4 v[88:91], v1, s[12:15], s33 offen
    s_waitcnt lgkmcnt(2)
    s_set_gpr_idx_on s48, 0xc
    v_pk_fma_f32 v[16:17], v[128:129], v[96:97], v[16:17] op_sel:[0,0,0] op_sel_hi:[0,1,1]
    v_pk_fma_f32 v[18:19], v[128:129], v[98:99], v[18:19] op_sel:[0,0,0] op_sel_hi:[0,1,1]
    v_pk_fma_f32 v[20:21], v[130:131], v[100:101], v[20:21] op_sel:[0,0,0] op_sel_hi:[0,1,1]
    v_pk_fma_f32 v[22:23], v[130:131], v[102:103], v[22:23] op_sel:[0,0,0] op_sel_hi:[0,1,1]
    s_set_gpr_idx_off
    v_lshlrev_b32_sdwa v138, v15, v118 dst_sel:DWORD dst_unused:UNUSED_PAD src0_sel:DWORD src1_sel:WORD_1
    s_waitcnt vmcnt(4)
    v_mfma_f32_4x4x4_16b_bf16 v[96:99], v[144:145], v[72:73], 0 cbsz:4 abid:0
    v_readlane_b32 s55, v164, 7
    v_mfma_f32_4x4x4_16b_bf16 v[100:103], v[144:145], v[74:75], 0 cbsz:4 abid:0
    v_lshlrev_b32_sdwa v139, v15, v119 dst_sel:DWORD dst_unused:UNUSED_PAD src0_sel:DWORD src1_sel:WORD_1
    ds_read_u16_d16_hi v134, v138 offset:32768
    ds_read_u16_d16_hi v135, v139 offset:32768
    s_and_b32 s33, s55, s34
    buffer_load_dwordx4 v[92:95], v1, s[12:15], s33 offen
    s_set_gpr_idx_on s49, 0xc
    v_pk_fma_f32 v[16:17], v[128:129], v[104:105], v[16:17] op_sel:[1,0,0] op_sel_hi:[1,1,1]
    v_pk_fma_f32 v[18:19], v[128:129], v[106:107], v[18:19] op_sel:[1,0,0] op_sel_hi:[1,1,1]
    v_pk_fma_f32 v[20:21], v[130:131], v[108:109], v[20:21] op_sel:[1,0,0] op_sel_hi:[1,1,1]
    v_pk_fma_f32 v[22:23], v[130:131], v[110:111], v[22:23] op_sel:[1,0,0] op_sel_hi:[1,1,1]
    s_set_gpr_idx_off
    v_mfma_f32_4x4x4_16b_bf16 v[112:115], v[172:173], v[176:177], 0 cbsz:4 abid:2
    v_lshlrev_b32_sdwa v136, v15, v120 dst_sel:DWORD dst_unused:UNUSED_PAD src0_sel:DWORD src1_sel:WORD_1
    s_waitcnt vmcnt(4)
    v_mfma_f32_4x4x4_16b_bf16 v[104:107], v[146:147], v[76:77], 0 cbsz:4 abid:0
    v_readlane_b32 s56, v164, 8
    v_mfma_f32_4x4x4_16b_bf16 v[108:111], v[146:147], v[78:79], 0 cbsz:4 abid:0
    v_lshlrev_b32_sdwa v137, v15, v121 dst_sel:DWORD dst_unused:UNUSED_PAD src0_sel:DWORD src1_sel:WORD_1
    ds_read_u16_d16_hi v128, v136 offset:32768
    ds_read_u16_d16_hi v129, v137 offset:32768
    s_and_b32 s33, s56, s34
    buffer_load_dwordx4 v[64:67], v1, s[12:15], s33 offen
    s_waitcnt lgkmcnt(2)
    s_set_gpr_idx_on s50, 0xc
    v_pk_fma_f32 v[16:17], v[132:133], v[96:97], v[16:17] op_sel:[0,0,0] op_sel_hi:[0,1,1]
    v_pk_fma_f32 v[18:19], v[132:133], v[98:99], v[18:19] op_sel:[0,0,0] op_sel_hi:[0,1,1]
    v_pk_fma_f32 v[20:21], v[134:135], v[100:101], v[20:21] op_sel:[0,0,0] op_sel_hi:[0,1,1]
    v_pk_fma_f32 v[22:23], v[134:135], v[102:103], v[22:23] op_sel:[0,0,0] op_sel_hi:[0,1,1]
    s_set_gpr_idx_off
    v_lshlrev_b32_sdwa v138, v15, v124 dst_sel:DWORD dst_unused:UNUSED_PAD src0_sel:DWORD src1_sel:WORD_1
    s_waitcnt vmcnt(4)
    v_mfma_f32_4x4x4_16b_bf16 v[96:99], v[140:141], v[80:81], 0 cbsz:4 abid:1
    v_readlane_b32 s57, v164, 9
    v_mfma_f32_4x4x4_16b_bf16 v[100:103], v[140:141], v[82:83], 0 cbsz:4 abid:1
    v_lshlrev_b32_sdwa v139, v15, v125 dst_sel:DWORD dst_unused:UNUSED_PAD src0_sel:DWORD src1_sel:WORD_1
    ds_read_u16_d16_hi v130, v138 offset:32768
    ds_read_u16_d16_hi v131, v139 offset:32768
    s_and_b32 s33, s57, s34
    buffer_load_dwordx4 v[68:71], v1, s[12:15], s33 offen
    s_set_gpr_idx_on s51, 0xc
    v_pk_fma_f32 v[16:17], v[132:133], v[104:105], v[16:17] op_sel:[1,0,0] op_sel_hi:[1,1,1]
    v_pk_fma_f32 v[18:19], v[132:133], v[106:107], v[18:19] op_sel:[1,0,0] op_sel_hi:[1,1,1]
    v_pk_fma_f32 v[20:21], v[134:135], v[108:109], v[20:21] op_sel:[1,0,0] op_sel_hi:[1,1,1]
    v_pk_fma_f32 v[22:23], v[134:135], v[110:111], v[22:23] op_sel:[1,0,0] op_sel_hi:[1,1,1]
    s_set_gpr_idx_off
A_4:
    s_sub_u32 s31, s31, 4
    s_cbranch_scc1 B_4
    v_mfma_f32_4x4x4_16b_bf16 v[116:119], v[172:173], v[178:179], 0 cbsz:4 abid:2
    v_lshlrev_b32_sdwa v136, v15, v122 dst_sel:DWORD dst_unused:UNUSED_PAD src0_sel:DWORD src1_sel:WORD_1
    s_waitcnt vmcnt(4)
    v_mfma_f32_4x4x4_16b_bf16 v[104:107], v[142:143], v[84:85], 0 cbsz:4 abid:1
    v_readlane_b32 s58, v164, 10
    v_mfma_f32_4x4x4_16b_bf16 v[108:111], v[142:143], v[86:87], 0 cbsz:4 abid:1
    v_lshlrev_b32_sdwa v137, v15, v123 dst_sel:DWORD dst_unused:UNUSED_PAD src0_sel:DWORD src1_sel:WORD_1
    ds_read_u16_d16_hi v132, v136 offset:32768
    ds_read_u16_d16_hi v133, v137 offset:32768
    s_and_b32 s33, s58, s34
    buffer_load_dwordx4 v[72:75], v1, s[12:15], s33 offen
    s_waitcnt lgkmcnt(2)
    s_set_gpr_idx_on s52, 0xc
    v_pk_fma_f32 v[16:17], v[128:129], v[96:97], v[16:17] op_sel:[0,0,0] op_sel_hi:[0,1,1]
    v_pk_fma_f32 v[18:19], v[128:129], v[98:99], v[18:19] op_sel:[0,0,0] op_sel_hi:[0,1,1]
    v_pk_fma_f32 v[20:21], v[130:131], v[100:101], v[20:21] op_sel:[0,0,0] op_sel_hi:[0,1,1]
    v_pk_fma_f32 v[22:23], v[130:131], v[102:103], v[22:23] op_sel:[0,0,0] op_sel_hi:[0,1,1]
    s_set_gpr_idx_off
    v_lshlrev_b32_sdwa v138, v15, v126 dst_sel:DWORD dst_unused:UNUSED_PAD src0_sel:DWORD src1_sel:WORD_1
    s_waitcnt vmcnt(4)
    v_mfma_f32_4x4x4_16b_bf16 v[96:99], v[144:145], v[88:89], 0 cbsz:4 abid:1
    v_readlane_b32 s59, v164, 11
    v_mfma_f32_4x4x4_16b_bf16 v[100:103], v[144:145], v[90:91], 0 cbsz:4 abid:1
    v_lshlrev_b32_sdwa v139, v15, v127 dst_sel:DWORD dst_unused:UNUSED_PAD src0_sel:DWORD src1_sel:WORD_1
    ds_read_u16_d16_hi v134, v138 offset:32768
    ds_read_u16_d16_hi v135, v139 offset:32768
    s_and_b32 s33, s59, s34
    buffer_load_dwordx4 v[76:79], v1, s[12:15], s33 offen
    s_set_gpr_idx_on s53, 0xc
    v_pk_fma_f32 v[16:17], v[128:129], v[104:105], v[16:17] op_sel:[1,0,0] op_sel_hi:[1,1,1]
    v_pk_fma_f32 v[18:19], v[128:129], v[106:107], v[18:19] op_sel:[1,0,0] op_sel_hi:[1,1,1]
    v_pk_fma_f32 v[20:21], v[130:131], v[108:109], v[20:21] op_sel:[1,0,0] op_sel_hi:[1,1,1]
    v_pk_fma_f32 v[22:23], v[130:131], v[110:111], v[22:23] op_sel:[1,0,0] op_sel_hi:[1,1,1]
    s_set_gpr_idx_off
    v_mfma_f32_4x4x4_16b_bf16 v[120:123], v[172:173], v[176:177], 0 cbsz:4 abid:3
    v_lshlrev_b32_sdwa v136, v15, v112 dst_sel:DWORD dst_unused:UNUSED_PAD src0_sel:DWORD src1_sel:WORD_1
    s_waitcnt vmcnt(4)
    v_mfma_f32_4x4x4_16b_bf16 v[104:107], v[146:147], v[92:93], 0 cbsz:4 abid:1
    v_readlane_b32 s60, v164, 12
    v_mfma_f32_4x4x4_16b_bf16 v[108:111], v[146:147], v[94:95], 0 cbsz:4 abid:1
    v_lshlrev_b32_sdwa v137, v15, v113 dst_sel:DWORD dst_unused:UNUSED_PAD src0_sel:DWORD src1_sel:WORD_1
    ds_read_u16_d16_hi v128, v136 offset:32768
    ds_read_u16_d16_hi v129, v137 offset:32768
    s_and_b32 s33, s60, s34
    buffer_load_dwordx4 v[80:83], v1, s[12:15], s33 offen
    s_waitcnt lgkmcnt(2)
    s_set_gpr_idx_on s54, 0xc
    v_pk_fma_f32 v[16:17], v[132:133], v[96:97], v[16:17] op_sel:[0,0,0] op_sel_hi:[0,1,1]
    v_pk_fma_f32 v[18:19], v[132:133], v[98:99], v[18:19] op_sel:[0,0,0] op_sel_hi:[0,1,1]
    v_pk_fma_f32 v[20:21], v[134:135], v[100:101], v[20:21] op_sel:[0,0,0] op_sel_hi:[0,1,1]
    v_pk_fma_f32 v[22:23], v[134:135], v[102:103], v[22:23] op_sel:[0,0,0] op_sel_hi:[0,1,1]
    s_set_gpr_idx_off
    v_lshlrev_b32_sdwa v138, v15, v116 dst_sel:DWORD dst_unused:UNUSED_PAD src0_sel:DWORD src1_sel:WORD_1
    s_waitcnt vmcnt(4)
    v_mfma_f32_4x4x4_16b_bf16 v[96:99], v[140:141], v[64:65], 0 cbsz:4 abid:2
    v_readlane_b32 s61, v164, 13
    v_mfma_f32_4x4x4_16b_bf16 v[100:103], v[140:141], v[66:67], 0 cbsz:4 abid:2
    v_lshlrev_b32_sdwa v139, v15, v117 dst_sel:DWORD dst_unused:UNUSED_PAD src0_sel:DWORD src1_sel:WORD_1
    ds_read_u16_d16_hi v130, v138 offset:32768
    ds_read_u16_d16_hi v131, v139 offset:32768
    s_and_b32 s33, s61, s34
    buffer_load_dwordx4 v[84:87], v1, s[12:15], s33 offen
    s_set_gpr_idx_on s55, 0xc
    v_pk_fma_f32 v[16:17], v[132:133], v[104:105], v[16:17] op_sel:[1,0,0] op_sel_hi:[1,1,1]
    v_pk_fma_f32 v[18:19], v[132:133], v[106:107], v[18:19] op_sel:[1,0,0] op_sel_hi:[1,1,1]
    v_pk_fma_f32 v[20:21], v[134:135], v[108:109], v[20:21] op_sel:[1,0,0] op_sel_hi:[1,1,1]
    v_pk_fma_f32 v[22:23], v[134:135], v[110:111], v[22:23] op_sel:[1,0,0] op_sel_hi:[1,1,1]
    s_set_gpr_idx_off
A_8:
    s_sub_u32 s31, s31, 4
    s_cbranch_scc1 B_8
    v_mfma_f32_4x4x4_16b_bf16 v[124:127], v[172:173], v[178:179], 0 cbsz:4 abid:3
    v_lshlrev_b32_sdwa v136, v15, v114 dst_sel:DWORD dst_unused:UNUSED_PAD src0_sel:DWORD src1_sel:WORD_1
    s_waitcnt vmcnt(4)
    v_mfma_f32_4x4x4_16b_bf16 v[104:107], v[142:143], v[68:69], 0 cbsz:4 abid:2
    v_readlane_b32 s62, v164, 14
    v_mfma_f32_4x4x4_16b_bf16 v[108:111], v[142:143], v[70:71], 0 cbsz:4 abid:2
    v_lshlrev_b32_sdwa v137, v15, v115 dst_sel:DWORD dst_unused:UNUSED_PAD src0_sel:DWORD src1_sel:WORD_1
    ds_read_u16_d16_hi v132, v136 offset:32768
    ds_read_u16_d16_hi v133, v137 offset:32768
    s_and_b32 s33, s62, s34
    buffer_load_dwordx4 v[88:91], v1, s[12:15], s33 offen
    s_waitcnt lgkmcnt(2)
    s_set_gpr_idx_on s56, 0xc
    v_pk_fma_f32 v[16:17], v[128:129], v[96:97], v[16:17] op_sel:[0,0,0] op_sel_hi:[0,1,1]
    v_pk_fma_f32 v[18:19], v[128:129], v[98:99], v[18:19] op_sel:[0,0,0] op_sel_hi:[0,1,1]
    v_pk_fma_f32 v[20:21], v[130:131], v[100:101], v[20:21] op_sel:[0,0,0] op_sel_hi:[0,1,1]
    v_pk_fma_f32 v[22:23], v[130:131], v[102:103], v[22:23] op_sel:[0,0,0] op_sel_hi:[0,1,1]
    s_set_gpr_idx_off
    ds_read_b32 v165, v5
    v_lshlrev_b32_sdwa v138, v15, v118 dst_sel:DWORD dst_unused:UNUSED_PAD src0_sel:DWORD src1_sel:WORD_1
    s_waitcnt vmcnt(4)
    v_mfma_f32_4x4x4_16b_bf16 v[96:99], v[144:145], v[72:73], 0 cbsz:4 abid:2
    v_readlane_b32 s63, v164, 15
    v_mfma_f32_4x4x4_16b_bf16 v[100:103], v[144:145], v[74:75], 0 cbsz:4 abid:2
    v_lshlrev_b32_sdwa v139, v15, v119 dst_sel:DWORD dst_unused:UNUSED_PAD src0_sel:DWORD src1_sel:WORD_1
    ds_read_u16_d16_hi v134, v138 offset:32768
    ds_read_u16_d16_hi v135, v139 offset:32768
    s_and_b32 s33, s63, s34
    buffer_load_dwordx4 v[92:95], v1, s[12:15], s33 offen
    s_set_gpr_idx_on s57, 0xc
    v_pk_fma_f32 v[16:17], v[128:129], v[104:105], v[16:17] op_sel:[1,0,0] op_sel_hi:[1,1,1]
    v_pk_fma_f32 v[18:19], v[128:129], v[106:107], v[18:19] op_sel:[1,0,0] op_sel_hi:[1,1,1]
    v_pk_fma_f32 v[20:21], v[130:131], v[108:109], v[20:21] op_sel:[1,0,0] op_sel_hi:[1,1,1]
    v_pk_fma_f32 v[22:23], v[130:131], v[110:111], v[22:23] op_sel:[1,0,0] op_sel_hi:[1,1,1]
    s_set_gpr_idx_off
    v_mfma_f32_4x4x4_16b_bf16 v[112:115], v[172:173], v[176:177], 0 cbsz:4 abid:4
    v_lshlrev_b32_sdwa v136, v15, v120 dst_sel:DWORD dst_unused:UNUSED_PAD src0_sel:DWORD src1_sel:WORD_1
    s_waitcnt vmcnt(4)
    v_mfma_f32_4x4x4_16b_bf16 v[104:107], v[146:147], v[76:77], 0 cbsz:4 abid:2
    v_readlane_b32 s48, v164, 16
    v_mfma_f32_4x4x4_16b_bf16 v[108:111], v[146:147], v[78:79], 0 cbsz:4 abid:2
    v_lshlrev_b32_sdwa v137, v15, v121 dst_sel:DWORD dst_unused:UNUSED_PAD src0_sel:DWORD src1_sel:WORD_1
    ds_read_u16_d16_hi v128, v136 offset:32768
    ds_read_u16_d16_hi v129, v137 offset:32768
    s_and_b32 s33, s48, s34
    buffer_load_dwordx4 v[64:67], v1, s[12:15], s33 offen
    s_waitcnt lgkmcnt(2)
    s_set_gpr_idx_on s58, 0xc
    v_pk_fma_f32 v[16:17], v[132:133], v[96:97], v[16:17] op_sel:[0,0,0] op_sel_hi:[0,1,1]
    v_pk_fma_f32 v[18:19], v[132:133], v[98:99], v[18:19] op_sel:[0,0,0] op_sel_hi:[0,1,1]
    v_pk_fma_f32 v[20:21], v[134:135], v[100:101], v[20:21] op_sel:[0,0,0] op_sel_hi:[0,1,1]
    v_pk_fma_f32 v[22:23], v[134:135], v[102:103], v[22:23] op_sel:[0,0,0] op_sel_hi:[0,1,1]
    s_set_gpr_idx_off
    v_lshlrev_b32_sdwa v138, v15, v124 dst_sel:DWORD dst_unused:UNUSED_PAD src0_sel:DWORD src1_sel:WORD_1
    s_waitcnt vmcnt(4)
    v_mfma_f32_4x4x4_16b_bf16 v[96:99], v[140:141], v[80:81], 0 cbsz:4 abid:3
    v_readlane_b32 s49, v164, 17
    v_mfma_f32_4x4x4_16b_bf16 v[100:103], v[140:141], v[82:83], 0 cbsz:4 abid:3
    v_lshlrev_b32_sdwa v139, v15, v125 dst_sel:DWORD dst_unused:UNUSED_PAD src0_sel:DWORD src1_sel:WORD_1
    ds_read_u16_d16_hi v130, v138 offset:32768
    ds_read_u16_d16_hi v131, v139 offset:32768
    s_and_b32 s33, s49, s34
    buffer_load_dwordx4 v[68:71], v1, s[12:15], s33 offen
    s_set_gpr_idx_on s59, 0xc
    v_pk_fma_f32 v[16:17], v[132:133], v[104:105], v[16:17] op_sel:[1,0,0] op_sel_hi:[1,1,1]
    v_pk_fma_f32 v[18:19], v[132:133], v[106:107], v[18:19] op_sel:[1,0,0] op_sel_hi:[1,1,1]
    v_pk_fma_f32 v[20:21], v[134:135], v[108:109], v[20:21] op_sel:[1,0,0] op_sel_hi:[1,1,1]
    v_pk_fma_f32 v[22:23], v[134:135], v[110:111], v[22:23] op_sel:[1,0,0] op_sel_hi:[1,1,1]
    s_set_gpr_idx_off
A_12:
    s_sub_u32 s31, s31, 4
    s_cbranch_scc1 B_12
    v_mfma_f32_4x4x4_16b_bf16 v[116:119], v[172:173], v[178:179], 0 cbsz:4 abid:4
    v_lshlrev_b32_sdwa v136, v15, v122 dst_sel:DWORD dst_unused:UNUSED_PAD src0_sel:DWORD src1_sel:WORD_1
    s_waitcnt vmcnt(4)
    v_mfma_f32_4x4x4_16b_bf16 v[104:107], v[142:143], v[84:85], 0 cbsz:4 abid:3
    v_readlane_b32 s50, v164, 18
    v_mfma_f32_4x4x4_16b_bf16 v[108:111], v[142:143], v[86:87], 0 cbsz:4 abid:3
    v_lshlrev_b32_sdwa v137, v15, v123 dst_sel:DWORD dst_unused:UNUSED_PAD src0_sel:DWORD src1_sel:WORD_1
    ds_read_u16_d16_hi v132, v136 offset:32768
    ds_read_u16_d16_hi v133, v137 offset:32768
    s_and_b32 s33, s50, s34
    buffer_load_dwordx4 v[72:75], v1, s[12:15], s33 offen
    s_waitcnt lgkmcnt(2)
    s_set_gpr_idx_on s60, 0xc
    v_pk_fma_f32 v[16:17], v[128:129], v[96:97], v[16:17] op_sel:[0,0,0] op_sel_hi:[0,1,1]
    v_pk_fma_f32 v[18:19], v[128:129], v[98:99], v[18:19] op_sel:[0,0,0] op_sel_hi:[0,1,1]
    v_pk_fma_f32 v[20:21], v[130:131], v[100:101], v[20:21] op_sel:[0,0,0] op_sel_hi:[0,1,1]
    v_pk_fma_f32 v[22:23], v[130:131], v[102:103], v[22:23] op_sel:[0,0,0] op_sel_hi:[0,1,1]
    s_set_gpr_idx_off
    v_cmp_gt_u32 vcc, s30, v6
    v_add_u32 v6, 64, v6
    v_add_u32 v5, 256, v5
    v_cndmask_b32 v165, 40, v165, vcc
    v_lshrrev_b32 v8, 21, v165
    v_lshlrev_b32 v8, 4, v8
    v_lshlrev_b32 v9, 3, v165
    ds_read_b128 v[168:171], v8 offset:8704
    v_and_b32 v9, 0xfffc00, v9
    v_and_or_b32 v165, v165, 56, v9
    v_lshlrev_b32_sdwa v138, v15, v126 dst_sel:DWORD dst_unused:UNUSED_PAD src0_sel:DWORD src1_sel:WORD_1
    s_waitcnt vmcnt(4)
    v_mfma_f32_4x4x4_16b_bf16 v[96:99], v[144:145], v[88:89], 0 cbsz:4 abid:3
    v_readlane_b32 s51, v164, 19
    v_mfma_f32_4x4x4_16b_bf16 v[100:103], v[144:145], v[90:91], 0 cbsz:4 abid:3
    v_lshlrev_b32_sdwa v139, v15, v127 dst_sel:DWORD dst_unused:UNUSED_PAD src0_sel:DWORD src1_sel:WORD_1
    ds_read_u16_d16_hi v134, v138 offset:32768
    ds_read_u16_d16_hi v135, v139 offset:32768
    s_and_b32 s33, s51, s34
    buffer_load_dwordx4 v[76:79], v1, s[12:15], s33 offen
    s_set_gpr_idx_on s61, 0xc
    v_pk_fma_f32 v[16:17], v[128:129], v[104:105], v[16:17] op_sel:[1,0,0] op_sel_hi:[1,1,1]
    v_pk_fma_f32 v[18:19], v[128:129], v[106:107], v[18:19] op_sel:[1,0,0] op_sel_hi:[1,1,1]
    v_pk_fma_f32 v[20:21], v[130:131], v[108:109], v[20:21] op_sel:[1,0,0] op_sel_hi:[1,1,1]
    v_pk_fma_f32 v[22:23], v[130:131], v[110:111], v[22:23] op_sel:[1,0,0] op_sel_hi:[1,1,1]
    s_set_gpr_idx_off
    v_mfma_f32_4x4x4_16b_bf16 v[120:123], v[172:173], v[176:177], 0 cbsz:4 abid:5
    v_lshlrev_b32_sdwa v136, v15, v112 dst_sel:DWORD dst_unused:UNUSED_PAD src0_sel:DWORD src1_sel:WORD_1
    s_waitcnt vmcnt(4)
    v_mfma_f32_4x4x4_16b_bf16 v[104:107], v[146:147], v[92:93], 0 cbsz:4 abid:3
    v_readlane_b32 s52, v164, 20
    v_mfma_f32_4x4x4_16b_bf16 v[108:111], v[146:147], v[94:95], 0 cbsz:4 abid:3
    v_lshlrev_b32_sdwa v137, v15, v113 dst_sel:DWORD dst_unused:UNUSED_PAD src0_sel:DWORD src1_sel:WORD_1
    ds_read_u16_d16_hi v128, v136 offset:32768
    ds_read_u16_d16_hi v129, v137 offset:32768
    s_and_b32 s33, s52, s34
    buffer_load_dwordx4 v[80:83], v1, s[12:15], s33 offen
    s_waitcnt lgkmcnt(2)
    s_set_gpr_idx_on s62, 0xc
    v_pk_fma_f32 v[16:17], v[132:133], v[96:97], v[16:17] op_sel:[0,0,0] op_sel_hi:[0,1,1]
    v_pk_fma_f32 v[18:19], v[132:133], v[98:99], v[18:19] op_sel:[0,0,0] op_sel_hi:[0,1,1]
    v_pk_fma_f32 v[20:21], v[134:135], v[100:101], v[20:21] op_sel:[0,0,0] op_sel_hi:[0,1,1]
    v_pk_fma_f32 v[22:23], v[134:135], v[102:103], v[22:23] op_sel:[0,0,0] op_sel_hi:[0,1,1]
    s_set_gpr_idx_off
    v_lshlrev_b32_sdwa v138, v15, v116 dst_sel:DWORD dst_unused:UNUSED_PAD src0_sel:DWORD src1_sel:WORD_1
    s_waitcnt vmcnt(4)
    v_mfma_f32_4x4x4_16b_bf16 v[96:99], v[140:141], v[64:65], 0 cbsz:4 abid:4
    v_readlane_b32 s53, v164, 21
    v_mfma_f32_4x4x4_16b_bf16 v[100:103], v[140:141], v[66:67], 0 cbsz:4 abid:4
    v_lshlrev_b32_sdwa v139, v15, v117 dst_sel:DWORD dst_unused:UNUSED_PAD src0_sel:DWORD src1_sel:WORD_1
    ds_read_u16_d16_hi v130, v138 offset:32768
    ds_read_u16_d16_hi v131, v139 offset:32768
    s_and_b32 s33, s53, s34
    buffer_load_dwordx4 v[84:87], v1, s[12:15], s33 offen
    s_set_gpr_idx_on s63, 0xc
    v_pk_fma_f32 v[16:17], v[132:133], v[104:105], v[16:17] op_sel:[1,0,0] op_sel_hi:[1,1,1]
    v_pk_fma_f32 v[18:19], v[132:133], v[106:107], v[18:19] op_sel:[1,0,0] op_sel_hi:[1,1,1]
    v_pk_fma_f32 v[20:21], v[134:135], v[108:109], v[20:21] op_sel:[1,0,0] op_sel_hi:[1,1,1]
    v_pk_fma_f32 v[22:23], v[134:135], v[110:111], v[22:23] op_sel:[1,0,0] op_sel_hi:[1,1,1]
    s_set_gpr_idx_off
A_16:
    s_sub_u32 s31, s31, 4
    s_cbranch_scc1 B_16
    v_mfma_f32_4x4x4_16b_bf16 v[124:127], v[172:173], v[178:179], 0 cbsz:4 abid:5
    v_lshlrev_b32_sdwa v136, v15, v114 dst_sel:DWORD dst_unused:UNUSED_PAD src0_sel:DWORD src1_sel:WORD_1
    s_waitcnt vmcnt(4)
    v_mfma_f32_4x4x4_16b_bf16 v[104:107], v[142:143], v[68:69], 0 cbsz:4 abid:4
    v_readlane_b32 s54, v164, 22
    v_mfma_f32_4x4x4_16b_bf16 v[108:111], v[142:143], v[70:71], 0 cbsz:4 abid:4
    v_lshlrev_b32_sdwa v137, v15, v115 dst_sel:DWORD dst_unused:UNUSED_PAD src0_sel:DWORD src1_sel:WORD_1
    ds_read_u16_d16_hi v132, v136 offset:32768
    ds_read_u16_d16_hi v133, v137 offset:32768
    s_and_b32 s33, s54, s34
    buffer_load_dwordx4 v[88:91], v1, s[12:15], s33 offen
    s_waitcnt lgkmcnt(2)
    s_set_gpr_idx_on s48, 0xc
    v_pk_fma_f32 v[16:17], v[128:129], v[96:97], v[16:17] op_sel:[0,0,0] op_sel_hi:[0,1,1]
    v_pk_fma_f32 v[18:19], v[128:129], v[98:99], v[18:19] op_sel:[0,0,0] op_sel_hi:[0,1,1]
    v_pk_fma_f32 v[20:21], v[130:131], v[100:101], v[20:21] op_sel:[0,0,0] op_sel_hi:[0,1,1]
    v_pk_fma_f32 v[22:23], v[130:131], v[102:103], v[22:23] op_sel:[0,0,0] op_sel_hi:[0,1,1]
    s_set_gpr_idx_off
    v_lshlrev_b32_sdwa v138, v15, v118 dst_sel:DWORD dst_unused:UNUSED_PAD src0_sel:DWORD src1_sel:WORD_1
    s_waitcnt vmcnt(4)
    v_mfma_f32_4x4x4_16b_bf16 v[96:99], v[144:145], v[72:73], 0 cbsz:4 abid:4
    v_readlane_b32 s55, v164, 23
    v_mfma_f32_4x4x4_16b_bf16 v[100:103], v[144:145], v[74:75], 0 cbsz:4 abid:4
    v_lshlrev_b32_sdwa v139, v15, v119 dst_sel:DWORD dst_unused:UNUSED_PAD src0_sel:DWORD src1_sel:WORD_1
    ds_read_u16_d16_hi v134, v138 offset:32768
    ds_read_u16_d16_hi v135, v139 offset:32768
    s_and_b32 s33, s55, s34
    buffer_load_dwordx4 v[92:95], v1, s[12:15], s33 offen
    s_set_gpr_idx_on s49, 0xc
    v_pk_fma_f32 v[16:17], v[128:129], v[104:105], v[16:17] op_sel:[1,0,0] op_sel_hi:[1,1,1]
    v_pk_fma_f32 v[18:19], v[128:129], v[106:107], v[18:19] op_sel:[1,0,0] op_sel_hi:[1,1,1]
    v_pk_fma_f32 v[20:21], v[130:131], v[108:109], v[20:21] op_sel:[1,0,0] op_sel_hi:[1,1,1]
    v_pk_fma_f32 v[22:23], v[130:131], v[110:111], v[22:23] op_sel:[1,0,0] op_sel_hi:[1,1,1]
    s_set_gpr_idx_off
    v_mfma_f32_4x4x4_16b_bf16 v[112:115], v[172:173], v[176:177], 0 cbsz:4 abid:6
    v_lshlrev_b32_sdwa v136, v15, v120 dst_sel:DWORD dst_unused:UNUSED_PAD src0_sel:DWORD src1_sel:WORD_1
    s_waitcnt vmcnt(4)
    v_mfma_f32_4x4x4_16b_bf16 v[104:107], v[146:147], v[76:77], 0 cbsz:4 abid:4
    v_readlane_b32 s56, v164, 24
    v_mfma_f32_4x4x4_16b_bf16 v[108:111], v[146:147], v[78:79], 0 cbsz:4 abid:4
    v_lshlrev_b32_sdwa v137, v15, v121 dst_sel:DWORD dst_unused:UNUSED_PAD src0_sel:DWORD src1_sel:WORD_1
    ds_read_u16_d16_hi v128, v136 offset:32768
    ds_read_u16_d16_hi v129, v137 offset:32768
    s_and_b32 s33, s56, s34
    buffer_load_dwordx4 v[64:67], v1, s[12:15], s33 offen
    s_waitcnt lgkmcnt(2)
    s_set_gpr_idx_on s50, 0xc
    v_pk_fma_f32 v[16:17], v[132:133], v[96:97], v[16:17] op_sel:[0,0,0] op_sel_hi:[0,1,1]
    v_pk_fma_f32 v[18:19], v[132:133], v[98:99], v[18:19] op_sel:[0,0,0] op_sel_hi:[0,1,1]
    v_pk_fma_f32 v[20:21], v[134:135], v[100:101], v[20:21] op_sel:[0,0,0] op_sel_hi:[0,1,1]
    v_pk_fma_f32 v[22:23], v[134:135], v[102:103], v[22:23] op_sel:[0,0,0] op_sel_hi:[0,1,1]
    s_set_gpr_idx_off
    v_lshlrev_b32_sdwa v138, v15, v124 dst_sel:DWORD dst_unused:UNUSED_PAD src0_sel:DWORD src1_sel:WORD_1
    s_waitcnt vmcnt(4)
    v_mfma_f32_4x4x4_16b_bf16 v[96:99], v[140:141], v[80:81], 0 cbsz:4 abid:5
    v_readlane_b32 s57, v164, 25
    v_mfma_f32_4x4x4_16b_bf16 v[100:103], v[140:141], v[82:83], 0 cbsz:4 abid:5
    v_lshlrev_b32_sdwa v139, v15, v125 dst_sel:DWORD dst_unused:UNUSED_PAD src0_sel:DWORD src1_sel:WORD_1
    ds_read_u16_d16_hi v130, v138 offset:32768
    ds_read_u16_d16_hi v131, v139 offset:32768
    s_and_b32 s33, s57, s34
    buffer_load_dwordx4 v[68:71], v1, s[12:15], s33 offen
    s_set_gpr_idx_on s51, 0xc
    v_pk_fma_f32 v[16:17], v[132:133], v[104:105], v[16:17] op_sel:[1,0,0] op_sel_hi:[1,1,1]
    v_pk_fma_f32 v[18:19], v[132:133], v[106:107], v[18:19] op_sel:[1,0,0] op_sel_hi:[1,1,1]
    v_pk_fma_f32 v[20:21], v[134:135], v[108:109], v[20:21] op_sel:[1,0,0] op_sel_hi:[1,1,1]
    v_pk_fma_f32 v[22:23], v[134:135], v[110:111], v[22:23] op_sel:[1,0,0] op_sel_hi:[1,1,1]
    s_set_gpr_idx_off
A_20:
    s_sub_u32 s31, s31, 4
    s_cbranch_scc1 B_20
    v_mfma_f32_4x4x4_16b_bf16 v[116:119], v[172:173], v[178:179], 0 cbsz:4 abid:6
    v_lshlrev_b32_sdwa v136, v15, v122 dst_sel:DWORD dst_unused:UNUSED_PAD src0_sel:DWORD src1_sel:WORD_1
    s_waitcnt vmcnt(4)
    v_mfma_f32_4x4x4_16b_bf16 v[104:107], v[142:143], v[84:85], 0 cbsz:4 abid:5
    v_readlane_b32 s58, v164, 26
    v_mfma_f32_4x4x4_16b_bf16 v[108:111], v[142:143], v[86:87], 0 cbsz:4 abid:5
    v_lshlrev_b32_sdwa v137, v15, v123 dst_sel:DWORD dst_unused:UNUSED_PAD src0_sel:DWORD src1_sel:WORD_1
    ds_read_u16_d16_hi v132, v136 offset:32768
    ds_read_u16_d16_hi v133, v137 offset:32768
    s_and_b32 s33, s58, s34
    buffer_load_dwordx4 v[72:75], v1, s[12:15], s33 offen
    s_waitcnt lgkmcnt(2)
    s_set_gpr_idx_on s52, 0xc
    v_pk_fma_f32 v[16:17], v[128:129], v[96:97], v[16:17] op_sel:[0,0,0] op_sel_hi:[0,1,1]
    v_pk_fma_f32 v[18:19], v[128:129], v[98:99], v[18:19] op_sel:[0,0,0] op_sel_hi:[0,1,1]
    v_pk_fma_f32 v[20:21], v[130:131], v[100:101], v[20:21] op_sel:[0,0,0] op_sel_hi:[0,1,1]
    v_pk_fma_f32 v[22:23], v[130:131], v[102:103], v[22:23] op_sel:[0,0,0] op_sel_hi:[0,1,1]
    s_set_gpr_idx_off
    v_lshlrev_b32_sdwa v138, v15, v126 dst_sel:DWORD dst_unused:UNUSED_PAD src0_sel:DWORD src1_sel:WORD_1
    s_waitcnt vmcnt(4)
    v_mfma_f32_4x4x4_16b_bf16 v[96:99], v[144:145], v[88:89], 0 cbsz:4 abid:5
    v_readlane_b32 s59, v164, 27
    v_mfma_f32_4x4x4_16b_bf16 v[100:103], v[144:145], v[90:91], 0 cbsz:4 abid:5
    v_lshlrev_b32_sdwa v139, v15, v127 dst_sel:DWORD dst_unused:UNUSED_PAD src0_sel:DWORD src1_sel:WORD_1
    ds_read_u16_d16_hi v134, v138 offset:32768
    ds_read_u16_d16_hi v135, v139 offset:32768
    s_and_b32 s33, s59, s34
    buffer_load_dwordx4 v[76:79], v1, s[12:15], s33 offen
    s_set_gpr_idx_on s53, 0xc
    v_pk_fma_f32 v[16:17], v[128:129], v[104:105], v[16:17] op_sel:[1,0,0] op_sel_hi:[1,1,1]
    v_pk_fma_f32 v[18:19], v[128:129], v[106:107], v[18:19] op_sel:[1,0,0] op_sel_hi:[1,1,1]
    v_pk_fma_f32 v[20:21], v[130:131], v[108:109], v[20:21] op_sel:[1,0,0] op_sel_hi:[1,1,1]
    v_pk_fma_f32 v[22:23], v[130:131], v[110:111], v[22:23] op_sel:[1,0,0] op_sel_hi:[1,1,1]
    s_set_gpr_idx_off
    v_mfma_f32_4x4x4_16b_bf16 v[120:123], v[172:173], v[176:177], 0 cbsz:4 abid:7
    v_lshlrev_b32_sdwa v136, v15, v112 dst_sel:DWORD dst_unused:UNUSED_PAD src0_sel:DWORD src1_sel:WORD_1
    s_waitcnt vmcnt(4)
    v_mfma_f32_4x4x4_16b_bf16 v[104:107], v[146:147], v[92:93], 0 cbsz:4 abid:5
    v_readlane_b32 s60, v164, 28
    v_mfma_f32_4x4x4_16b_bf16 v[108:111], v[146:147], v[94:95], 0 cbsz:4 abid:5
    v_lshlrev_b32_sdwa v137, v15, v113 dst_sel:DWORD dst_unused:UNUSED_PAD src0_sel:DWORD src1_sel:WORD_1
    ds_read_u16_d16_hi v128, v136 offset:32768
    ds_read_u16_d16_hi v129, v137 offset:32768
    s_and_b32 s33, s60, s34
    buffer_load_dwordx4 v[80:83], v1, s[12:15], s33 offen
    s_waitcnt lgkmcnt(2)
    s_set_gpr_idx_on s54, 0xc
    v_pk_fma_f32 v[16:17], v[132:133], v[96:97], v[16:17] op_sel:[0,0,0] op_sel_hi:[0,1,1]
    v_pk_fma_f32 v[18:19], v[132:133], v[98:99], v[18:19] op_sel:[0,0,0] op_sel_hi:[0,1,1]
    v_pk_fma_f32 v[20:21], v[134:135], v[100:101], v[20:21] op_sel:[0,0,0] op_sel_hi:[0,1,1]
    v_pk_fma_f32 v[22:23], v[134:135], v[102:103], v[22:23] op_sel:[0,0,0] op_sel_hi:[0,1,1]
    s_set_gpr_idx_off
    v_lshlrev_b32_sdwa v138, v15, v116 dst_sel:DWORD dst_unused:UNUSED_PAD src0_sel:DWORD src1_sel:WORD_1
    s_waitcnt vmcnt(4)
    v_mfma_f32_4x4x4_16b_bf16 v[96:99], v[140:141], v[64:65], 0 cbsz:4 abid:6
    v_readlane_b32 s61, v164, 29
    v_mfma_f32_4x4x4_16b_bf16 v[100:103], v[140:141], v[66:67], 0 cbsz:4 abid:6
    v_lshlrev_b32_sdwa v139, v15, v117 dst_sel:DWORD dst_unused:UNUSED_PAD src0_sel:DWORD src1_sel:WORD_1
    ds_read_u16_d16_hi v130, v138 offset:32768
    ds_read_u16_d16_hi v131, v139 offset:32768
    s_and_b32 s33, s61, s34
    buffer_load_dwordx4 v[84:87], v1, s[12:15], s33 offen
    s_set_gpr_idx_on s55, 0xc
    v_pk_fma_f32 v[16:17], v[132:133], v[104:105], v[16:17] op_sel:[1,0,0] op_sel_hi:[1,1,1]
    v_pk_fma_f32 v[18:19], v[132:133], v[106:107], v[18:19] op_sel:[1,0,0] op_sel_hi:[1,1,1]
    v_pk_fma_f32 v[20:21], v[134:135], v[108:109], v[20:21] op_sel:[1,0,0] op_sel_hi:[1,1,1]
    v_pk_fma_f32 v[22:23], v[134:135], v[110:111], v[22:23] op_sel:[1,0,0] op_sel_hi:[1,1,1]
    s_set_gpr_idx_off
A_24:
    s_sub_u32 s31, s31, 4
    s_cbranch_scc1 B_24
    v_mfma_f32_4x4x4_16b_bf16 v[124:127], v[172:173], v[178:179], 0 cbsz:4 abid:7
    v_lshlrev_b32_sdwa v136, v15, v114 dst_sel:DWORD dst_unused:UNUSED_PAD src0_sel:DWORD src1_sel:WORD_1
    s_waitcnt vmcnt(4)
    v_mfma_f32_4x4x4_16b_bf16 v[104:107], v[142:143], v[68:69], 0 cbsz:4 abid:6
    v_readlane_b32 s62, v164, 30
    v_mfma_f32_4x4x4_16b_bf16 v[108:111], v[142:143], v[70:71], 0 cbsz:4 abid:6
    v_lshlrev_b32_sdwa v137, v15, v115 dst_sel:DWORD dst_unused:UNUSED_PAD src0_sel:DWORD src1_sel:WORD_1
    ds_read_u16_d16_hi v132, v136 offset:32768
    ds_read_u16_d16_hi v133, v137 offset:32768
    s_and_b32 s33, s62, s34
    buffer_load_dwordx4 v[88:91], v1, s[12:15], s33 offen
    s_waitcnt lgkmcnt(2)
    s_set_gpr_idx_on s56, 0xc
    v_pk_fma_f32 v[16:17], v[128:129], v[96:97], v[16:17] op_sel:[0,0,0] op_sel_hi:[0,1,1]
    v_pk_fma_f32 v[18:19], v[128:129], v[98:99], v[18:19] op_sel:[0,0,0] op_sel_hi:[0,1,1]
    v_pk_fma_f32 v[20:21], v[130:131], v[100:101], v[20:21] op_sel:[0,0,0] op_sel_hi:[0,1,1]
    v_pk_fma_f32 v[22:23], v[130:131], v[102:103], v[22:23] op_sel:[0,0,0] op_sel_hi:[0,1,1]
    s_set_gpr_idx_off
    v_lshlrev_b32_sdwa v138, v15, v118 dst_sel:DWORD dst_unused:UNUSED_PAD src0_sel:DWORD src1_sel:WORD_1
    s_waitcnt vmcnt(4)
    v_mfma_f32_4x4x4_16b_bf16 v[96:99], v[144:145], v[72:73], 0 cbsz:4 abid:6
    v_readlane_b32 s63, v164, 31
    v_mfma_f32_4x4x4_16b_bf16 v[100:103], v[144:145], v[74:75], 0 cbsz:4 abid:6
    v_lshlrev_b32_sdwa v139, v15, v119 dst_sel:DWORD dst_unused:UNUSED_PAD src0_sel:DWORD src1_sel:WORD_1
    ds_read_u16_d16_hi v134, v138 offset:32768
    ds_read_u16_d16_hi v135, v139 offset:32768
    s_and_b32 s33, s63, s34
    buffer_load_dwordx4 v[92:95], v1, s[12:15], s33 offen
    s_set_gpr_idx_on s57, 0xc
    v_pk_fma_f32 v[16:17], v[128:129], v[104:105], v[16:17] op_sel:[1,0,0] op_sel_hi:[1,1,1]
    v_pk_fma_f32 v[18:19], v[128:129], v[106:107], v[18:19] op_sel:[1,0,0] op_sel_hi:[1,1,1]
    v_pk_fma_f32 v[20:21], v[130:131], v[108:109], v[20:21] op_sel:[1,0,0] op_sel_hi:[1,1,1]
    v_pk_fma_f32 v[22:23], v[130:131], v[110:111], v[22:23] op_sel:[1,0,0] op_sel_hi:[1,1,1]
    s_set_gpr_idx_off
    v_mfma_f32_4x4x4_16b_bf16 v[112:115], v[172:173], v[176:177], 0 cbsz:4 abid:8
    v_lshlrev_b32_sdwa v136, v15, v120 dst_sel:DWORD dst_unused:UNUSED_PAD src0_sel:DWORD src1_sel:WORD_1
    s_waitcnt vmcnt(4)
    v_mfma_f32_4x4x4_16b_bf16 v[104:107], v[146:147], v[76:77], 0 cbsz:4 abid:6
    v_readlane_b32 s48, v164, 32
    v_mfma_f32_4x4x4_16b_bf16 v[108:111], v[146:147], v[78:79], 0 cbsz:4 abid:6
    v_lshlrev_b32_sdwa v137, v15, v121 dst_sel:DWORD dst_unused:UNUSED_PAD src0_sel:DWORD src1_sel:WORD_1
    ds_read_u16_d16_hi v128, v136 offset:32768
    ds_read_u16_d16_hi v129, v137 offset:32768
    s_and_b32 s33, s48, s34
    buffer_load_dwordx4 v[64:67], v1, s[12:15], s33 offen
    s_waitcnt lgkmcnt(2)
    s_set_gpr_idx_on s58, 0xc
    v_pk_fma_f32 v[16:17], v[132:133], v[96:97], v[16:17] op_sel:[0,0,0] op_sel_hi:[0,1,1]
    v_pk_fma_f32 v[18:19], v[132:133], v[98:99], v[18:19] op_sel:[0,0,0] op_sel_hi:[0,1,1]
    v_pk_fma_f32 v[20:21], v[134:135], v[100:101], v[20:21] op_sel:[0,0,0] op_sel_hi:[0,1,1]
    v_pk_fma_f32 v[22:23], v[134:135], v[102:103], v[22:23] op_sel:[0,0,0] op_sel_hi:[0,1,1]
    s_set_gpr_idx_off
    v_lshlrev_b32_sdwa v138, v15, v124 dst_sel:DWORD dst_unused:UNUSED_PAD src0_sel:DWORD src1_sel:WORD_1
    s_waitcnt vmcnt(4)
    v_mfma_f32_4x4x4_16b_bf16 v[96:99], v[140:141], v[80:81], 0 cbsz:4 abid:7
    v_readlane_b32 s49, v164, 33
    v_mfma_f32_4x4x4_16b_bf16 v[100:103], v[140:141], v[82:83], 0 cbsz:4 abid:7
    v_lshlrev_b32_sdwa v139, v15, v125 dst_sel:DWORD dst_unused:UNUSED_PAD src0_sel:DWORD src1_sel:WORD_1
    ds_read_u16_d16_hi v130, v138 offset:32768
    ds_read_u16_d16_hi v131, v139 offset:32768
    s_and_b32 s33, s49, s34
    buffer_load_dwordx4 v[68:71], v1, s[12:15], s33 offen
    s_set_gpr_idx_on s59, 0xc
    v_pk_fma_f32 v[16:17], v[132:133], v[104:105], v[16:17] op_sel:[1,0,0] op_sel_hi:[1,1,1]
    v_pk_fma_f32 v[18:19], v[132:133], v[106:107], v[18:19] op_sel:[1,0,0] op_sel_hi:[1,1,1]
    v_pk_fma_f32 v[20:21], v[134:135], v[108:109], v[20:21] op_sel:[1,0,0] op_sel_hi:[1,1,1]
    v_pk_fma_f32 v[22:23], v[134:135], v[110:111], v[22:23] op_sel:[1,0,0] op_sel_hi:[1,1,1]
    s_set_gpr_idx_off
A_28:
    s_sub_u32 s31, s31, 4
    s_cbranch_scc1 B_28
    v_mfma_f32_4x4x4_16b_bf16 v[116:119], v[172:173], v[178:179], 0 cbsz:4 abid:8
    v_lshlrev_b32_sdwa v136, v15, v122 dst_sel:DWORD dst_unused:UNUSED_PAD src0_sel:DWORD src1_sel:WORD_1
    s_waitcnt vmcnt(4)
    v_mfma_f32_4x4x4_16b_bf16 v[104:107], v[142:143], v[84:85], 0 cbsz:4 abid:7
    v_readlane_b32 s50, v164, 34
    v_mfma_f32_4x4x4_16b_bf16 v[108:111], v[142:143], v[86:87], 0 cbsz:4 abid:7
    v_lshlrev_b32_sdwa v137, v15, v123 dst_sel:DWORD dst_unused:UNUSED_PAD src0_sel:DWORD src1_sel:WORD_1
    ds_read_u16_d16_hi v132, v136 offset:32768
    ds_read_u16_d16_hi v133, v137 offset:32768
    s_and_b32 s33, s50, s34
    buffer_load_dwordx4 v[72:75], v1, s[12:15], s33 offen
    s_waitcnt lgkmcnt(2)
    s_set_gpr_idx_on s60, 0xc
    v_pk_fma_f32 v[16:17], v[128:129], v[96:97], v[16:17] op_sel:[0,0,0] op_sel_hi:[0,1,1]
    v_pk_fma_f32 v[18:19], v[128:129], v[98:99], v[18:19] op_sel:[0,0,0] op_sel_hi:[0,1,1]
    v_pk_fma_f32 v[20:21], v[130:131], v[100:101], v[20:21] op_sel:[0,0,0] op_sel_hi:[0,1,1]
    v_pk_fma_f32 v[22:23], v[130:131], v[102:103], v[22:23] op_sel:[0,0,0] op_sel_hi:[0,1,1]
    s_set_gpr_idx_off
    v_lshlrev_b32_sdwa v138, v15, v126 dst_sel:DWORD dst_unused:UNUSED_PAD src0_sel:DWORD src1_sel:WORD_1
    s_waitcnt vmcnt(4)
    v_mfma_f32_4x4x4_16b_bf16 v[96:99], v[144:145], v[88:89], 0 cbsz:4 abid:7
    v_readlane_b32 s51, v164, 35
    v_mfma_f32_4x4x4_16b_bf16 v[100:103], v[144:145], v[90:91], 0 cbsz:4 abid:7
    v_lshlrev_b32_sdwa v139, v15, v127 dst_sel:DWORD dst_unused:UNUSED_PAD src0_sel:DWORD src1_sel:WORD_1
    ds_read_u16_d16_hi v134, v138 offset:32768
    ds_read_u16_d16_hi v135, v139 offset:32768
    s_and_b32 s33, s51, s34
    buffer_load_dwordx4 v[76:79], v1, s[12:15], s33 offen
    s_set_gpr_idx_on s61, 0xc
    v_pk_fma_f32 v[16:17], v[128:129], v[104:105], v[16:17] op_sel:[1,0,0] op_sel_hi:[1,1,1]
    v_pk_fma_f32 v[18:19], v[128:129], v[106:107], v[18:19] op_sel:[1,0,0] op_sel_hi:[1,1,1]
    v_pk_fma_f32 v[20:21], v[130:131], v[108:109], v[20:21] op_sel:[1,0,0] op_sel_hi:[1,1,1]
    v_pk_fma_f32 v[22:23], v[130:131], v[110:111], v[22:23] op_sel:[1,0,0] op_sel_hi:[1,1,1]
    s_set_gpr_idx_off
    v_mfma_f32_4x4x4_16b_bf16 v[120:123], v[172:173], v[176:177], 0 cbsz:4 abid:9
    v_lshlrev_b32_sdwa v136, v15, v112 dst_sel:DWORD dst_unused:UNUSED_PAD src0_sel:DWORD src1_sel:WORD_1
    s_waitcnt vmcnt(4)
    v_mfma_f32_4x4x4_16b_bf16 v[104:107], v[146:147], v[92:93], 0 cbsz:4 abid:7
    v_readlane_b32 s52, v164, 36
    v_mfma_f32_4x4x4_16b_bf16 v[108:111], v[146:147], v[94:95], 0 cbsz:4 abid:7
    v_lshlrev_b32_sdwa v137, v15, v113 dst_sel:DWORD dst_unused:UNUSED_PAD src0_sel:DWORD src1_sel:WORD_1
    ds_read_u16_d16_hi v128, v136 offset:32768
    ds_read_u16_d16_hi v129, v137 offset:32768
    s_and_b32 s33, s52, s34
    buffer_load_dwordx4 v[80:83], v1, s[12:15], s33 offen
    s_waitcnt lgkmcnt(2)
    s_set_gpr_idx_on s62, 0xc
    v_pk_fma_f32 v[16:17], v[132:133], v[96:97], v[16:17] op_sel:[0,0,0] op_sel_hi:[0,1,1]
    v_pk_fma_f32 v[18:19], v[132:133], v[98:99], v[18:19] op_sel:[0,0,0] op_sel_hi:[0,1,1]
    v_pk_fma_f32 v[20:21], v[134:135], v[100:101], v[20:21] op_sel:[0,0,0] op_sel_hi:[0,1,1]
    v_pk_fma_f32 v[22:23], v[134:135], v[102:103], v[22:23] op_sel:[0,0,0] op_sel_hi:[0,1,1]
    s_set_gpr_idx_off
    v_lshlrev_b32_sdwa v138, v15, v116 dst_sel:DWORD dst_unused:UNUSED_PAD src0_sel:DWORD src1_sel:WORD_1
    s_waitcnt vmcnt(4)
    v_mfma_f32_4x4x4_16b_bf16 v[96:99], v[140:141], v[64:65], 0 cbsz:4 abid:8
    v_readlane_b32 s53, v164, 37
    v_mfma_f32_4x4x4_16b_bf16 v[100:103], v[140:141], v[66:67], 0 cbsz:4 abid:8
    v_lshlrev_b32_sdwa v139, v15, v117 dst_sel:DWORD dst_unused:UNUSED_PAD src0_sel:DWORD src1_sel:WORD_1
    ds_read_u16_d16_hi v130, v138 offset:32768
    ds_read_u16_d16_hi v131, v139 offset:32768
    s_and_b32 s33, s53, s34
    buffer_load_dwordx4 v[84:87], v1, s[12:15], s33 offen
    s_set_gpr_idx_on s63, 0xc
    v_pk_fma_f32 v[16:17], v[132:133], v[104:105], v[16:17] op_sel:[1,0,0] op_sel_hi:[1,1,1]
    v_pk_fma_f32 v[18:19], v[132:133], v[106:107], v[18:19] op_sel:[1,0,0] op_sel_hi:[1,1,1]
    v_pk_fma_f32 v[20:21], v[134:135], v[108:109], v[20:21] op_sel:[1,0,0] op_sel_hi:[1,1,1]
    v_pk_fma_f32 v[22:23], v[134:135], v[110:111], v[22:23] op_sel:[1,0,0] op_sel_hi:[1,1,1]
    s_set_gpr_idx_off
A_32:
    s_sub_u32 s31, s31, 4
    s_cbranch_scc1 B_32
    v_mfma_f32_4x4x4_16b_bf16 v[124:127], v[172:173], v[178:179], 0 cbsz:4 abid:9
    v_lshlrev_b32_sdwa v136, v15, v114 dst_sel:DWORD dst_unused:UNUSED_PAD src0_sel:DWORD src1_sel:WORD_1
    s_waitcnt vmcnt(4)
    v_mfma_f32_4x4x4_16b_bf16 v[104:107], v[142:143], v[68:69], 0 cbsz:4 abid:8
    v_readlane_b32 s54, v164, 38
    v_mfma_f32_4x4x4_16b_bf16 v[108:111], v[142:143], v[70:71], 0 cbsz:4 abid:8
    v_lshlrev_b32_sdwa v137, v15, v115 dst_sel:DWORD dst_unused:UNUSED_PAD src0_sel:DWORD src1_sel:WORD_1
    ds_read_u16_d16_hi v132, v136 offset:32768
    ds_read_u16_d16_hi v133, v137 offset:32768
    s_and_b32 s33, s54, s34
    buffer_load_dwordx4 v[88:91], v1, s[12:15], s33 offen
    s_waitcnt lgkmcnt(2)
    s_set_gpr_idx_on s48, 0xc
    v_pk_fma_f32 v[16:17], v[128:129], v[96:97], v[16:17] op_sel:[0,0,0] op_sel_hi:[0,1,1]
    v_pk_fma_f32 v[18:19], v[128:129], v[98:99], v[18:19] op_sel:[0,0,0] op_sel_hi:[0,1,1]
    v_pk_fma_f32 v[20:21], v[130:131], v[100:101], v[20:21] op_sel:[0,0,0] op_sel_hi:[0,1,1]
    v_pk_fma_f32 v[22:23], v[130:131], v[102:103], v[22:23] op_sel:[0,0,0] op_sel_hi:[0,1,1]
    s_set_gpr_idx_off
    v_lshlrev_b32_sdwa v138, v15, v118 dst_sel:DWORD dst_unused:UNUSED_PAD src0_sel:DWORD src1_sel:WORD_1
    s_waitcnt vmcnt(4)
    v_mfma_f32_4x4x4_16b_bf16 v[96:99], v[144:145], v[72:73], 0 cbsz:4 abid:8
    v_readlane_b32 s55, v164, 39
    v_mfma_f32_4x4x4_16b_bf16 v[100:103], v[144:145], v[74:75], 0 cbsz:4 abid:8
    v_lshlrev_b32_sdwa v139, v15, v119 dst_sel:DWORD dst_unused:UNUSED_PAD src0_sel:DWORD src1_sel:WORD_1
    ds_read_u16_d16_hi v134, v138 offset:32768
    ds_read_u16_d16_hi v135, v139 offset:32768
    s_and_b32 s33, s55, s34
    buffer_load_dwordx4 v[92:95], v1, s[12:15], s33 offen
    s_set_gpr_idx_on s49, 0xc
    v_pk_fma_f32 v[16:17], v[128:129], v[104:105], v[16:17] op_sel:[1,0,0] op_sel_hi:[1,1,1]
    v_pk_fma_f32 v[18:19], v[128:129], v[106:107], v[18:19] op_sel:[1,0,0] op_sel_hi:[1,1,1]
    v_pk_fma_f32 v[20:21], v[130:131], v[108:109], v[20:21] op_sel:[1,0,0] op_sel_hi:[1,1,1]
    v_pk_fma_f32 v[22:23], v[130:131], v[110:111], v[22:23] op_sel:[1,0,0] op_sel_hi:[1,1,1]
    s_set_gpr_idx_off
    v_mfma_f32_4x4x4_16b_bf16 v[112:115], v[172:173], v[176:177], 0 cbsz:4 abid:10
    v_lshlrev_b32_sdwa v136, v15, v120 dst_sel:DWORD dst_unused:UNUSED_PAD src0_sel:DWORD src1_sel:WORD_1
    s_waitcnt vmcnt(4)
    v_mfma_f32_4x4x4_16b_bf16 v[104:107], v[146:147], v[76:77], 0 cbsz:4 abid:8
    v_readlane_b32 s56, v164, 40
    v_mfma_f32_4x4x4_16b_bf16 v[108:111], v[146:147], v[78:79], 0 cbsz:4 abid:8
    v_lshlrev_b32_sdwa v137, v15, v121 dst_sel:DWORD dst_unused:UNUSED_PAD src0_sel:DWORD src1_sel:WORD_1
    ds_read_u16_d16_hi v128, v136 offset:32768
    ds_read_u16_d16_hi v129, v137 offset:32768
    s_and_b32 s33, s56, s34
    buffer_load_dwordx4 v[64:67], v1, s[12:15], s33 offen
    s_waitcnt lgkmcnt(2)
    s_set_gpr_idx_on s50, 0xc
    v_pk_fma_f32 v[16:17], v[132:133], v[96:97], v[16:17] op_sel:[0,0,0] op_sel_hi:[0,1,1]
    v_pk_fma_f32 v[18:19], v[132:133], v[98:99], v[18:19] op_sel:[0,0,0] op_sel_hi:[0,1,1]
    v_pk_fma_f32 v[20:21], v[134:135], v[100:101], v[20:21] op_sel:[0,0,0] op_sel_hi:[0,1,1]
    v_pk_fma_f32 v[22:23], v[134:135], v[102:103], v[22:23] op_sel:[0,0,0] op_sel_hi:[0,1,1]
    s_set_gpr_idx_off
    v_lshlrev_b32_sdwa v138, v15, v124 dst_sel:DWORD dst_unused:UNUSED_PAD src0_sel:DWORD src1_sel:WORD_1
    s_waitcnt vmcnt(4)
    v_mfma_f32_4x4x4_16b_bf16 v[96:99], v[140:141], v[80:81], 0 cbsz:4 abid:9
    v_readlane_b32 s57, v164, 41
    v_mfma_f32_4x4x4_16b_bf16 v[100:103], v[140:141], v[82:83], 0 cbsz:4 abid:9
    v_lshlrev_b32_sdwa v139, v15, v125 dst_sel:DWORD dst_unused:UNUSED_PAD src0_sel:DWORD src1_sel:WORD_1
    ds_read_u16_d16_hi v130, v138 offset:32768
    ds_read_u16_d16_hi v131, v139 offset:32768
    s_and_b32 s33, s57, s34
    buffer_load_dwordx4 v[68:71], v1, s[12:15], s33 offen
    s_set_gpr_idx_on s51, 0xc
    v_pk_fma_f32 v[16:17], v[132:133], v[104:105], v[16:17] op_sel:[1,0,0] op_sel_hi:[1,1,1]
    v_pk_fma_f32 v[18:19], v[132:133], v[106:107], v[18:19] op_sel:[1,0,0] op_sel_hi:[1,1,1]
    v_pk_fma_f32 v[20:21], v[134:135], v[108:109], v[20:21] op_sel:[1,0,0] op_sel_hi:[1,1,1]
    v_pk_fma_f32 v[22:23], v[134:135], v[110:111], v[22:23] op_sel:[1,0,0] op_sel_hi:[1,1,1]
    s_set_gpr_idx_off
A_36:
    s_sub_u32 s31, s31, 4
    s_cbranch_scc1 B_36
    v_mfma_f32_4x4x4_16b_bf16 v[116:119], v[172:173], v[178:179], 0 cbsz:4 abid:10
    v_lshlrev_b32_sdwa v136, v15, v122 dst_sel:DWORD dst_unused:UNUSED_PAD src0_sel:DWORD src1_sel:WORD_1
    s_waitcnt vmcnt(4)
    v_mfma_f32_4x4x4_16b_bf16 v[104:107], v[142:143], v[84:85], 0 cbsz:4 abid:9
    v_readlane_b32 s58, v164, 42
    v_mfma_f32_4x4x4_16b_bf16 v[108:111], v[142:143], v[86:87], 0 cbsz:4 abid:9
    v_lshlrev_b32_sdwa v137, v15, v123 dst_sel:DWORD dst_unused:UNUSED_PAD src0_sel:DWORD src1_sel:WORD_1
    ds_read_u16_d16_hi v132, v136 offset:32768
    ds_read_u16_d16_hi v133, v137 offset:32768
    s_and_b32 s33, s58, s34
    buffer_load_dwordx4 v[72:75], v1, s[12:15], s33 offen
    s_waitcnt lgkmcnt(2)
    s_set_gpr_idx_on s52, 0xc
    v_pk_fma_f32 v[16:17], v[128:129], v[96:97], v[16:17] op_sel:[0,0,0] op_sel_hi:[0,1,1]
    v_pk_fma_f32 v[18:19], v[128:129], v[98:99], v[18:19] op_sel:[0,0,0] op_sel_hi:[0,1,1]
    v_pk_fma_f32 v[20:21], v[130:131], v[100:101], v[20:21] op_sel:[0,0,0] op_sel_hi:[0,1,1]
    v_pk_fma_f32 v[22:23], v[130:131], v[102:103], v[22:23] op_sel:[0,0,0] op_sel_hi:[0,1,1]
    s_set_gpr_idx_off
    v_lshlrev_b32_sdwa v138, v15, v126 dst_sel:DWORD dst_unused:UNUSED_PAD src0_sel:DWORD src1_sel:WORD_1
    s_waitcnt vmcnt(4)
    v_mfma_f32_4x4x4_16b_bf16 v[96:99], v[144:145], v[88:89], 0 cbsz:4 abid:9
    v_readlane_b32 s59, v164, 43
    v_mfma_f32_4x4x4_16b_bf16 v[100:103], v[144:145], v[90:91], 0 cbsz:4 abid:9
    v_lshlrev_b32_sdwa v139, v15, v127 dst_sel:DWORD dst_unused:UNUSED_PAD src0_sel:DWORD src1_sel:WORD_1
    ds_read_u16_d16_hi v134, v138 offset:32768
    ds_read_u16_d16_hi v135, v139 offset:32768
    s_and_b32 s33, s59, s34
    buffer_load_dwordx4 v[76:79], v1, s[12:15], s33 offen
    s_set_gpr_idx_on s53, 0xc
    v_pk_fma_f32 v[16:17], v[128:129], v[104:105], v[16:17] op_sel:[1,0,0] op_sel_hi:[1,1,1]
    v_pk_fma_f32 v[18:19], v[128:129], v[106:107], v[18:19] op_sel:[1,0,0] op_sel_hi:[1,1,1]
    v_pk_fma_f32 v[20:21], v[130:131], v[108:109], v[20:21] op_sel:[1,0,0] op_sel_hi:[1,1,1]
    v_pk_fma_f32 v[22:23], v[130:131], v[110:111], v[22:23] op_sel:[1,0,0] op_sel_hi:[1,1,1]
    s_set_gpr_idx_off
    v_mfma_f32_4x4x4_16b_bf16 v[120:123], v[172:173], v[176:177], 0 cbsz:4 abid:11
    v_lshlrev_b32_sdwa v136, v15, v112 dst_sel:DWORD dst_unused:UNUSED_PAD src0_sel:DWORD src1_sel:WORD_1
    s_waitcnt vmcnt(4)
    v_mfma_f32_4x4x4_16b_bf16 v[104:107], v[146:147], v[92:93], 0 cbsz:4 abid:9
    v_readlane_b32 s60, v164, 44
    v_mfma_f32_4x4x4_16b_bf16 v[108:111], v[146:147], v[94:95], 0 cbsz:4 abid:9
    v_lshlrev_b32_sdwa v137, v15, v113 dst_sel:DWORD dst_unused:UNUSED_PAD src0_sel:DWORD src1_sel:WORD_1
    ds_read_u16_d16_hi v128, v136 offset:32768
    ds_read_u16_d16_hi v129, v137 offset:32768
    s_and_b32 s33, s60, s34
    buffer_load_dwordx4 v[80:83], v1, s[12:15], s33 offen
    s_waitcnt lgkmcnt(2)
    s_set_gpr_idx_on s54, 0xc
    v_pk_fma_f32 v[16:17], v[132:133], v[96:97], v[16:17] op_sel:[0,0,0] op_sel_hi:[0,1,1]
    v_pk_fma_f32 v[18:19], v[132:133], v[98:99], v[18:19] op_sel:[0,0,0] op_sel_hi:[0,1,1]
    v_pk_fma_f32 v[20:21], v[134:135], v[100:101], v[20:21] op_sel:[0,0,0] op_sel_hi:[0,1,1]
    v_pk_fma_f32 v[22:23], v[134:135], v[102:103], v[22:23] op_sel:[0,0,0] op_sel_hi:[0,1,1]
    s_set_gpr_idx_off
    v_lshlrev_b32_sdwa v138, v15, v116 dst_sel:DWORD dst_unused:UNUSED_PAD src0_sel:DWORD src1_sel:WORD_1
    s_waitcnt vmcnt(4)
    v_mfma_f32_4x4x4_16b_bf16 v[96:99], v[140:141], v[64:65], 0 cbsz:4 abid:10
    v_readlane_b32 s61, v164, 45
    v_mfma_f32_4x4x4_16b_bf16 v[100:103], v[140:141], v[66:67], 0 cbsz:4 abid:10
    v_lshlrev_b32_sdwa v139, v15, v117 dst_sel:DWORD dst_unused:UNUSED_PAD src0_sel:DWORD src1_sel:WORD_1
    ds_read_u16_d16_hi v130, v138 offset:32768
    ds_read_u16_d16_hi v131, v139 offset:32768
    s_and_b32 s33, s61, s34
    buffer_load_dwordx4 v[84:87], v1, s[12:15], s33 offen
    s_set_gpr_idx_on s55, 0xc
    v_pk_fma_f32 v[16:17], v[132:133], v[104:105], v[16:17] op_sel:[1,0,0] op_sel_hi:[1,1,1]
    v_pk_fma_f32 v[18:19], v[132:133], v[106:107], v[18:19] op_sel:[1,0,0] op_sel_hi:[1,1,1]
    v_pk_fma_f32 v[20:21], v[134:135], v[108:109], v[20:21] op_sel:[1,0,0] op_sel_hi:[1,1,1]
    v_pk_fma_f32 v[22:23], v[134:135], v[110:111], v[22:23] op_sel:[1,0,0] op_sel_hi:[1,1,1]
    s_set_gpr_idx_off
A_40:
    s_sub_u32 s31, s31, 4
    s_cbranch_scc1 B_40
    v_mfma_f32_4x4x4_16b_bf16 v[124:127], v[172:173], v[178:179], 0 cbsz:4 abid:11
    v_lshlrev_b32_sdwa v136, v15, v114 dst_sel:DWORD dst_unused:UNUSED_PAD src0_sel:DWORD src1_sel:WORD_1
    s_waitcnt vmcnt(4)
    v_mfma_f32_4x4x4_16b_bf16 v[104:107], v[142:143], v[68:69], 0 cbsz:4 abid:10
    v_readlane_b32 s62, v164, 46
    v_mfma_f32_4x4x4_16b_bf16 v[108:111], v[142:143], v[70:71], 0 cbsz:4 abid:10
    v_lshlrev_b32_sdwa v137, v15, v115 dst_sel:DWORD dst_unused:UNUSED_PAD src0_sel:DWORD src1_sel:WORD_1
    ds_read_u16_d16_hi v132, v136 offset:32768
    ds_read_u16_d16_hi v133, v137 offset:32768
    s_and_b32 s33, s62, s34
    buffer_load_dwordx4 v[88:91], v1, s[12:15], s33 offen
    s_waitcnt lgkmcnt(2)
    s_set_gpr_idx_on s56, 0xc
    v_pk_fma_f32 v[16:17], v[128:129], v[96:97], v[16:17] op_sel:[0,0,0] op_sel_hi:[0,1,1]
    v_pk_fma_f32 v[18:19], v[128:129], v[98:99], v[18:19] op_sel:[0,0,0] op_sel_hi:[0,1,1]
    v_pk_fma_f32 v[20:21], v[130:131], v[100:101], v[20:21] op_sel:[0,0,0] op_sel_hi:[0,1,1]
    v_pk_fma_f32 v[22:23], v[130:131], v[102:103], v[22:23] op_sel:[0,0,0] op_sel_hi:[0,1,1]
    s_set_gpr_idx_off
    v_mfma_f32_4x4x4_16b_bf16 v[148:151], v[168:169], v[180:181], 0
    v_lshlrev_b32_sdwa v138, v15, v118 dst_sel:DWORD dst_unused:UNUSED_PAD src0_sel:DWORD src1_sel:WORD_1
    s_waitcnt vmcnt(4)
    v_mfma_f32_4x4x4_16b_bf16 v[96:99], v[144:145], v[72:73], 0 cbsz:4 abid:10
    v_readlane_b32 s63, v164, 47
    v_mfma_f32_4x4x4_16b_bf16 v[100:103], v[144:145], v[74:75], 0 cbsz:4 abid:10
    v_lshlrev_b32_sdwa v139, v15, v119 dst_sel:DWORD dst_unused:UNUSED_PAD src0_sel:DWORD src1_sel:WORD_1
    ds_read_u16_d16_hi v134, v138 offset:32768
    ds_read_u16_d16_hi v135, v139 offset:32768
    s_and_b32 s33, s63, s34
    buffer_load_dwordx4 v[92:95], v1, s[12:15], s33 offen
    s_set_gpr_idx_on s57, 0xc
    v_pk_fma_f32 v[16:17], v[128:129], v[104:105], v[16:17] op_sel:[1,0,0] op_sel_hi:[1,1,1]
    v_pk_fma_f32 v[18:19], v[128:129], v[106:107], v[18:19] op_sel:[1,0,0] op_sel_hi:[1,1,1]
    v_pk_fma_f32 v[20:21], v[130:131], v[108:109], v[20:21] op_sel:[1,0,0] op_sel_hi:[1,1,1]
    v_pk_fma_f32 v[22:23], v[130:131], v[110:111], v[22:23] op_sel:[1,0,0] op_sel_hi:[1,1,1]
    s_set_gpr_idx_off
    v_mfma_f32_4x4x4_16b_bf16 v[112:115], v[172:173], v[176:177], 0 cbsz:4 abid:12
    v_lshlrev_b32_sdwa v136, v15, v120 dst_sel:DWORD dst_unused:UNUSED_PAD src0_sel:DWORD src1_sel:WORD_1
    s_waitcnt vmcnt(4)
    v_mfma_f32_4x4x4_16b_bf16 v[104:107], v[146:147], v[76:77], 0 cbsz:4 abid:10
    v_readlane_b32 s48, v164, 48
    v_mfma_f32_4x4x4_16b_bf16 v[108:111], v[146:147], v[78:79], 0 cbsz:4 abid:10
    v_lshlrev_b32_sdwa v137, v15, v121 dst_sel:DWORD dst_unused:UNUSED_PAD src0_sel:DWORD src1_sel:WORD_1
    ds_read_u16_d16_hi v128, v136 offset:32768
    ds_read_u16_d16_hi v129, v137 offset:32768
    s_and_b32 s33, s48, s34
    buffer_load_dwordx4 v[64:67], v1, s[12:15], s33 offen
    s_waitcnt lgkmcnt(2)
    s_set_gpr_idx_on s58, 0xc
    v_pk_fma_f32 v[16:17], v[132:133], v[96:97], v[16:17] op_sel:[0,0,0] op_sel_hi:[0,1,1]
    v_pk_fma_f32 v[18:19], v[132:133], v[98:99], v[18:19] op_sel:[0,0,0] op_sel_hi:[0,1,1]
    v_pk_fma_f32 v[20:21], v[134:135], v[100:101], v[20:21] op_sel:[0,0,0] op_sel_hi:[0,1,1]
    v_pk_fma_f32 v[22:23], v[134:135], v[102:103], v[22:23] op_sel:[0,0,0] op_sel_hi:[0,1,1]
    s_set_gpr_idx_off
    v_mfma_f32_4x4x4_16b_bf16 v[152:155], v[168:169], v[182:183], 0
    v_lshlrev_b32_sdwa v138, v15, v124 dst_sel:DWORD dst_unused:UNUSED_PAD src0_sel:DWORD src1_sel:WORD_1
    s_waitcnt vmcnt(4)
    v_mfma_f32_4x4x4_16b_bf16 v[96:99], v[140:141], v[80:81], 0 cbsz:4 abid:11
    v_readlane_b32 s49, v164, 49
    v_mfma_f32_4x4x4_16b_bf16 v[100:103], v[140:141], v[82:83], 0 cbsz:4 abid:11
    v_lshlrev_b32_sdwa v139, v15, v125 dst_sel:DWORD dst_unused:UNUSED_PAD src0_sel:DWORD src1_sel:WORD_1
    ds_read_u16_d16_hi v130, v138 offset:32768
    ds_read_u16_d16_hi v131, v139 offset:32768
    s_and_b32 s33, s49, s34
    buffer_load_dwordx4 v[68:71], v1, s[12:15], s33 offen
    s_set_gpr_idx_on s59, 0xc
    v_pk_fma_f32 v[16:17], v[132:133], v[104:105], v[16:17] op_sel:[1,0,0] op_sel_hi:[1,1,1]
    v_pk_fma_f32 v[18:19], v[132:133], v[106:107], v[18:19] op_sel:[1,0,0] op_sel_hi:[1,1,1]
    v_pk_fma_f32 v[20:21], v[134:135], v[108:109], v[20:21] op_sel:[1,0,0] op_sel_hi:[1,1,1]
    v_pk_fma_f32 v[22:23], v[134:135], v[110:111], v[22:23] op_sel:[1,0,0] op_sel_hi:[1,1,1]
    s_set_gpr_idx_off
A_44:
    s_sub_u32 s31, s31, 4
    s_cbranch_scc1 B_44
    v_mfma_f32_4x4x4_16b_bf16 v[116:119], v[172:173], v[178:179], 0 cbsz:4 abid:12
    v_lshlrev_b32_sdwa v136, v15, v122 dst_sel:DWORD dst_unused:UNUSED_PAD src0_sel:DWORD src1_sel:WORD_1
    s_waitcnt vmcnt(4)
    v_mfma_f32_4x4x4_16b_bf16 v[104:107], v[142:143], v[84:85], 0 cbsz:4 abid:11
    v_readlane_b32 s50, v164, 50
    v_mfma_f32_4x4x4_16b_bf16 v[108:111], v[142:143], v[86:87], 0 cbsz:4 abid:11
    v_lshlrev_b32_sdwa v137, v15, v123 dst_sel:DWORD dst_unused:UNUSED_PAD src0_sel:DWORD src1_sel:WORD_1
    ds_read_u16_d16_hi v132, v136 offset:32768
    ds_read_u16_d16_hi v133, v137 offset:32768
    s_and_b32 s33, s50, s34
    buffer_load_dwordx4 v[72:75], v1, s[12:15], s33 offen
    s_waitcnt lgkmcnt(2)
    s_set_gpr_idx_on s60, 0xc
    v_pk_fma_f32 v[16:17], v[128:129], v[96:97], v[16:17] op_sel:[0,0,0] op_sel_hi:[0,1,1]
    v_pk_fma_f32 v[18:19], v[128:129], v[98:99], v[18:19] op_sel:[0,0,0] op_sel_hi:[0,1,1]
    v_pk_fma_f32 v[20:21], v[130:131], v[100:101], v[20:21] op_sel:[0,0,0] op_sel_hi:[0,1,1]
    v_pk_fma_f32 v[22:23], v[130:131], v[102:103], v[22:23] op_sel:[0,0,0] op_sel_hi:[0,1,1]
    s_set_gpr_idx_off
    v_mfma_f32_4x4x4_16b_bf16 v[156:159], v[168:169], v[184:185], 0
    v_lshlrev_b32_sdwa v138, v15, v126 dst_sel:DWORD dst_unused:UNUSED_PAD src0_sel:DWORD src1_sel:WORD_1
    s_waitcnt vmcnt(4)
    v_mfma_f32_4x4x4_16b_bf16 v[96:99], v[144:145], v[88:89], 0 cbsz:4 abid:11
    v_readlane_b32 s51, v164, 51
    v_mfma_f32_4x4x4_16b_bf16 v[100:103], v[144:145], v[90:91], 0 cbsz:4 abid:11
    v_lshlrev_b32_sdwa v139, v15, v127 dst_sel:DWORD dst_unused:UNUSED_PAD src0_sel:DWORD src1_sel:WORD_1
    ds_read_u16_d16_hi v134, v138 offset:32768
    ds_read_u16_d16_hi v135, v139 offset:32768
    s_and_b32 s33, s51, s34
    buffer_load_dwordx4 v[76:79], v1, s[12:15], s33 offen
    s_set_gpr_idx_on s61, 0xc
    v_pk_fma_f32 v[16:17], v[128:129], v[104:105], v[16:17] op_sel:[1,0,0] op_sel_hi:[1,1,1]
    v_pk_fma_f32 v[18:19], v[128:129], v[106:107], v[18:19] op_sel:[1,0,0] op_sel_hi:[1,1,1]
    v_pk_fma_f32 v[20:21], v[130:131], v[108:109], v[20:21] op_sel:[1,0,0] op_sel_hi:[1,1,1]
    v_pk_fma_f32 v[22:23], v[130:131], v[110:111], v[22:23] op_sel:[1,0,0] op_sel_hi:[1,1,1]
    s_set_gpr_idx_off
    v_mfma_f32_4x4x4_16b_bf16 v[120:123], v[172:173], v[176:177], 0 cbsz:4 abid:13
    v_lshlrev_b32_sdwa v136, v15, v112 dst_sel:DWORD dst_unused:UNUSED_PAD src0_sel:DWORD src1_sel:WORD_1
    s_waitcnt vmcnt(4)
    v_mfma_f32_4x4x4_16b_bf16 v[104:107], v[146:147], v[92:93], 0 cbsz:4 abid:11
    v_readlane_b32 s52, v164, 52
    v_mfma_f32_4x4x4_16b_bf16 v[108:111], v[146:147], v[94:95], 0 cbsz:4 abid:11
    v_lshlrev_b32_sdwa v137, v15, v113 dst_sel:DWORD dst_unused:UNUSED_PAD src0_sel:DWORD src1_sel:WORD_1
    ds_read_u16_d16_hi v128, v136 offset:32768
    ds_read_u16_d16_hi v129, v137 offset:32768
    s_and_b32 s33, s52, s34
    buffer_load_dwordx4 v[80:83], v1, s[12:15], s33 offen
    s_waitcnt lgkmcnt(2)
    s_set_gpr_idx_on s62, 0xc
    v_pk_fma_f32 v[16:17], v[132:133], v[96:97], v[16:17] op_sel:[0,0,0] op_sel_hi:[0,1,1]
    v_pk_fma_f32 v[18:19], v[132:133], v[98:99], v[18:19] op_sel:[0,0,0] op_sel_hi:[0,1,1]
    v_pk_fma_f32 v[20:21], v[134:135], v[100:101], v[20:21] op_sel:[0,0,0] op_sel_hi:[0,1,1]
    v_pk_fma_f32 v[22:23], v[134:135], v[102:103], v[22:23] op_sel:[0,0,0] op_sel_hi:[0,1,1]
    s_set_gpr_idx_off
    v_mfma_f32_4x4x4_16b_bf16 v[160:163], v[168:169], v[186:187], 0
    v_lshlrev_b32_sdwa v138, v15, v116 dst_sel:DWORD dst_unused:UNUSED_PAD src0_sel:DWORD src1_sel:WORD_1
    s_waitcnt vmcnt(4)
    v_mfma_f32_4x4x4_16b_bf16 v[96:99], v[140:141], v[64:65], 0 cbsz:4 abid:12
    v_readlane_b32 s53, v164, 53
    v_mfma_f32_4x4x4_16b_bf16 v[100:103], v[140:141], v[66:67], 0 cbsz:4 abid:12
    v_lshlrev_b32_sdwa v139, v15, v117 dst_sel:DWORD dst_unused:UNUSED_PAD src0_sel:DWORD src1_sel:WORD_1
    ds_read_u16_d16_hi v130, v138 offset:32768
    ds_read_u16_d16_hi v131, v139 offset:32768
    s_and_b32 s33, s53, s34
    buffer_load_dwordx4 v[84:87], v1, s[12:15], s33 offen
    s_set_gpr_idx_on s63, 0xc
    v_pk_fma_f32 v[16:17], v[132:133], v[104:105], v[16:17] op_sel:[1,0,0] op_sel_hi:[1,1,1]
    v_pk_fma_f32 v[18:19], v[132:133], v[106:107], v[18:19] op_sel:[1,0,0] op_sel_hi:[1,1,1]
    v_pk_fma_f32 v[20:21], v[134:135], v[108:109], v[20:21] op_sel:[1,0,0] op_sel_hi:[1,1,1]
    v_pk_fma_f32 v[22:23], v[134:135], v[110:111], v[22:23] op_sel:[1,0,0] op_sel_hi:[1,1,1]
    s_set_gpr_idx_off
A_48:
    s_sub_u32 s31, s31, 4
    s_cbranch_scc1 B_48
    v_mfma_f32_4x4x4_16b_bf16 v[124:127], v[172:173], v[178:179], 0 cbsz:4 abid:13
    v_lshlrev_b32_sdwa v136, v15, v114 dst_sel:DWORD dst_unused:UNUSED_PAD src0_sel:DWORD src1_sel:WORD_1
    s_waitcnt vmcnt(4)
    v_mfma_f32_4x4x4_16b_bf16 v[104:107], v[142:143], v[68:69], 0 cbsz:4 abid:12
    v_readlane_b32 s54, v164, 54
    v_mfma_f32_4x4x4_16b_bf16 v[108:111], v[142:143], v[70:71], 0 cbsz:4 abid:12
    v_lshlrev_b32_sdwa v137, v15, v115 dst_sel:DWORD dst_unused:UNUSED_PAD src0_sel:DWORD src1_sel:WORD_1
    ds_read_u16_d16_hi v132, v136 offset:32768
    ds_read_u16_d16_hi v133, v137 offset:32768
    s_and_b32 s33, s54, s34
    buffer_load_dwordx4 v[88:91], v1, s[12:15], s33 offen
    s_waitcnt lgkmcnt(2)
    s_set_gpr_idx_on s48, 0xc
    v_pk_fma_f32 v[16:17], v[128:129], v[96:97], v[16:17] op_sel:[0,0,0] op_sel_hi:[0,1,1]
    v_pk_fma_f32 v[18:19], v[128:129], v[98:99], v[18:19] op_sel:[0,0,0] op_sel_hi:[0,1,1]
    v_pk_fma_f32 v[20:21], v[130:131], v[100:101], v[20:21] op_sel:[0,0,0] op_sel_hi:[0,1,1]
    v_pk_fma_f32 v[22:23], v[130:131], v[102:103], v[22:23] op_sel:[0,0,0] op_sel_hi:[0,1,1]
    s_set_gpr_idx_off
    v_lshlrev_b32_sdwa v138, v15, v118 dst_sel:DWORD dst_unused:UNUSED_PAD src0_sel:DWORD src1_sel:WORD_1
    s_waitcnt vmcnt(4)
    v_mfma_f32_4x4x4_16b_bf16 v[96:99], v[144:145], v[72:73], 0 cbsz:4 abid:12
    v_readlane_b32 s55, v164, 55
    v_mfma_f32_4x4x4_16b_bf16 v[100:103], v[144:145], v[74:75], 0 cbsz:4 abid:12
    v_lshlrev_b32_sdwa v139, v15, v119 dst_sel:DWORD dst_unused:UNUSED_PAD src0_sel:DWORD src1_sel:WORD_1
    ds_read_u16_d16_hi v134, v138 offset:32768
    ds_read_u16_d16_hi v135, v139 offset:32768
    s_and_b32 s33, s55, s34
    buffer_load_dwordx4 v[92:95], v1, s[12:15], s33 offen
    s_set_gpr_idx_on s49, 0xc
    v_pk_fma_f32 v[16:17], v[128:129], v[104:105], v[16:17] op_sel:[1,0,0] op_sel_hi:[1,1,1]
    v_pk_fma_f32 v[18:19], v[128:129], v[106:107], v[18:19] op_sel:[1,0,0] op_sel_hi:[1,1,1]
    v_pk_fma_f32 v[20:21], v[130:131], v[108:109], v[20:21] op_sel:[1,0,0] op_sel_hi:[1,1,1]
    v_pk_fma_f32 v[22:23], v[130:131], v[110:111], v[22:23] op_sel:[1,0,0] op_sel_hi:[1,1,1]
    s_set_gpr_idx_off
    v_mfma_f32_4x4x4_16b_bf16 v[112:115], v[172:173], v[176:177], 0 cbsz:4 abid:14
    v_lshlrev_b32_sdwa v136, v15, v120 dst_sel:DWORD dst_unused:UNUSED_PAD src0_sel:DWORD src1_sel:WORD_1
    s_waitcnt vmcnt(4)
    v_mfma_f32_4x4x4_16b_bf16 v[104:107], v[146:147], v[76:77], 0 cbsz:4 abid:12
    v_readlane_b32 s56, v164, 56
    v_mfma_f32_4x4x4_16b_bf16 v[108:111], v[146:147], v[78:79], 0 cbsz:4 abid:12
    v_lshlrev_b32_sdwa v137, v15, v121 dst_sel:DWORD dst_unused:UNUSED_PAD src0_sel:DWORD src1_sel:WORD_1
    ds_read_u16_d16_hi v128, v136 offset:32768
    ds_read_u16_d16_hi v129, v137 offset:32768
    s_and_b32 s33, s56, s34
    buffer_load_dwordx4 v[64:67], v1, s[12:15], s33 offen
    s_waitcnt lgkmcnt(2)
    s_set_gpr_idx_on s50, 0xc
    v_pk_fma_f32 v[16:17], v[132:133], v[96:97], v[16:17] op_sel:[0,0,0] op_sel_hi:[0,1,1]
    v_pk_fma_f32 v[18:19], v[132:133], v[98:99], v[18:19] op_sel:[0,0,0] op_sel_hi:[0,1,1]
    v_pk_fma_f32 v[20:21], v[134:135], v[100:101], v[20:21] op_sel:[0,0,0] op_sel_hi:[0,1,1]
    v_pk_fma_f32 v[22:23], v[134:135], v[102:103], v[22:23] op_sel:[0,0,0] op_sel_hi:[0,1,1]
    s_set_gpr_idx_off
    v_lshlrev_b32_sdwa v138, v15, v124 dst_sel:DWORD dst_unused:UNUSED_PAD src0_sel:DWORD src1_sel:WORD_1
    s_waitcnt vmcnt(4)
    v_mfma_f32_4x4x4_16b_bf16 v[96:99], v[140:141], v[80:81], 0 cbsz:4 abid:13
    v_readlane_b32 s57, v164, 57
    v_mfma_f32_4x4x4_16b_bf16 v[100:103], v[140:141], v[82:83], 0 cbsz:4 abid:13
    v_lshlrev_b32_sdwa v139, v15, v125 dst_sel:DWORD dst_unused:UNUSED_PAD src0_sel:DWORD src1_sel:WORD_1
    ds_read_u16_d16_hi v130, v138 offset:32768
    ds_read_u16_d16_hi v131, v139 offset:32768
    s_and_b32 s33, s57, s34
    buffer_load_dwordx4 v[68:71], v1, s[12:15], s33 offen
    s_set_gpr_idx_on s51, 0xc
    v_pk_fma_f32 v[16:17], v[132:133], v[104:105], v[16:17] op_sel:[1,0,0] op_sel_hi:[1,1,1]
    v_pk_fma_f32 v[18:19], v[132:133], v[106:107], v[18:19] op_sel:[1,0,0] op_sel_hi:[1,1,1]
    v_pk_fma_f32 v[20:21], v[134:135], v[108:109], v[20:21] op_sel:[1,0,0] op_sel_hi:[1,1,1]
    v_pk_fma_f32 v[22:23], v[134:135], v[110:111], v[22:23] op_sel:[1,0,0] op_sel_hi:[1,1,1]
    s_set_gpr_idx_off
A_52:
    s_sub_u32 s31, s31, 4
    s_cbranch_scc1 B_52
    v_mfma_f32_4x4x4_16b_bf16 v[116:119], v[172:173], v[178:179], 0 cbsz:4 abid:14
    v_lshlrev_b32_sdwa v136, v15, v122 dst_sel:DWORD dst_unused:UNUSED_PAD src0_sel:DWORD src1_sel:WORD_1
    s_waitcnt vmcnt(4)
    v_mfma_f32_4x4x4_16b_bf16 v[104:107], v[142:143], v[84:85], 0 cbsz:4 abid:13
    v_readlane_b32 s58, v164, 58
    v_mfma_f32_4x4x4_16b_bf16 v[108:111], v[142:143], v[86:87], 0 cbsz:4 abid:13
    v_lshlrev_b32_sdwa v137, v15, v123 dst_sel:DWORD dst_unused:UNUSED_PAD src0_sel:DWORD src1_sel:WORD_1
    ds_read_u16_d16_hi v132, v136 offset:32768
    ds_read_u16_d16_hi v133, v137 offset:32768
    s_and_b32 s33, s58, s34
    buffer_load_dwordx4 v[72:75], v1, s[12:15], s33 offen
    s_waitcnt lgkmcnt(2)
    s_set_gpr_idx_on s52, 0xc
    v_pk_fma_f32 v[16:17], v[128:129], v[96:97], v[16:17] op_sel:[0,0,0] op_sel_hi:[0,1,1]
    v_pk_fma_f32 v[18:19], v[128:129], v[98:99], v[18:19] op_sel:[0,0,0] op_sel_hi:[0,1,1]
    v_pk_fma_f32 v[20:21], v[130:131], v[100:101], v[20:21] op_sel:[0,0,0] op_sel_hi:[0,1,1]
    v_pk_fma_f32 v[22:23], v[130:131], v[102:103], v[22:23] op_sel:[0,0,0] op_sel_hi:[0,1,1]
    s_set_gpr_idx_off
    v_lshlrev_b32_sdwa v138, v15, v126 dst_sel:DWORD dst_unused:UNUSED_PAD src0_sel:DWORD src1_sel:WORD_1
    s_waitcnt vmcnt(4)
    v_mfma_f32_4x4x4_16b_bf16 v[96:99], v[144:145], v[88:89], 0 cbsz:4 abid:13
    v_readlane_b32 s59, v164, 59
    v_mfma_f32_4x4x4_16b_bf16 v[100:103], v[144:145], v[90:91], 0 cbsz:4 abid:13
    v_lshlrev_b32_sdwa v139, v15, v127 dst_sel:DWORD dst_unused:UNUSED_PAD src0_sel:DWORD src1_sel:WORD_1
    ds_read_u16_d16_hi v134, v138 offset:32768
    ds_read_u16_d16_hi v135, v139 offset:32768
    s_and_b32 s33, s59, s34
    buffer_load_dwordx4 v[76:79], v1, s[12:15], s33 offen
    s_set_gpr_idx_on s53, 0xc
    v_pk_fma_f32 v[16:17], v[128:129], v[104:105], v[16:17] op_sel:[1,0,0] op_sel_hi:[1,1,1]
    v_pk_fma_f32 v[18:19], v[128:129], v[106:107], v[18:19] op_sel:[1,0,0] op_sel_hi:[1,1,1]
    v_pk_fma_f32 v[20:21], v[130:131], v[108:109], v[20:21] op_sel:[1,0,0] op_sel_hi:[1,1,1]
    v_pk_fma_f32 v[22:23], v[130:131], v[110:111], v[22:23] op_sel:[1,0,0] op_sel_hi:[1,1,1]
    s_set_gpr_idx_off
    v_mfma_f32_4x4x4_16b_bf16 v[120:123], v[172:173], v[176:177], 0 cbsz:4 abid:15
    v_lshlrev_b32_sdwa v136, v15, v112 dst_sel:DWORD dst_unused:UNUSED_PAD src0_sel:DWORD src1_sel:WORD_1
    s_waitcnt vmcnt(4)
    v_mfma_f32_4x4x4_16b_bf16 v[104:107], v[146:147], v[92:93], 0 cbsz:4 abid:13
    v_readlane_b32 s60, v164, 60
    v_mfma_f32_4x4x4_16b_bf16 v[108:111], v[146:147], v[94:95], 0 cbsz:4 abid:13
    v_lshlrev_b32_sdwa v137, v15, v113 dst_sel:DWORD dst_unused:UNUSED_PAD src0_sel:DWORD src1_sel:WORD_1
    ds_read_u16_d16_hi v128, v136 offset:32768
    ds_read_u16_d16_hi v129, v137 offset:32768
    s_and_b32 s33, s60, s34
    buffer_load_dwordx4 v[80:83], v1, s[12:15], s33 offen
    s_waitcnt lgkmcnt(2)
    s_set_gpr_idx_on s54, 0xc
    v_pk_fma_f32 v[16:17], v[132:133], v[96:97], v[16:17] op_sel:[0,0,0] op_sel_hi:[0,1,1]
    v_pk_fma_f32 v[18:19], v[132:133], v[98:99], v[18:19] op_sel:[0,0,0] op_sel_hi:[0,1,1]
    v_pk_fma_f32 v[20:21], v[134:135], v[100:101], v[20:21] op_sel:[0,0,0] op_sel_hi:[0,1,1]
    v_pk_fma_f32 v[22:23], v[134:135], v[102:103], v[22:23] op_sel:[0,0,0] op_sel_hi:[0,1,1]
    s_set_gpr_idx_off
    v_lshlrev_b32_sdwa v138, v15, v116 dst_sel:DWORD dst_unused:UNUSED_PAD src0_sel:DWORD src1_sel:WORD_1
    s_waitcnt vmcnt(4)
    v_mfma_f32_4x4x4_16b_bf16 v[96:99], v[140:141], v[64:65], 0 cbsz:4 abid:14
    v_readlane_b32 s61, v164, 61
    v_mfma_f32_4x4x4_16b_bf16 v[100:103], v[140:141], v[66:67], 0 cbsz:4 abid:14
    v_lshlrev_b32_sdwa v139, v15, v117 dst_sel:DWORD dst_unused:UNUSED_PAD src0_sel:DWORD src1_sel:WORD_1
    ds_read_u16_d16_hi v130, v138 offset:32768
    ds_read_u16_d16_hi v131, v139 offset:32768
    s_and_b32 s33, s61, s34
    buffer_load_dwordx4 v[84:87], v1, s[12:15], s33 offen
    s_set_gpr_idx_on s55, 0xc
    v_pk_fma_f32 v[16:17], v[132:133], v[104:105], v[16:17] op_sel:[1,0,0] op_sel_hi:[1,1,1]
    v_pk_fma_f32 v[18:19], v[132:133], v[106:107], v[18:19] op_sel:[1,0,0] op_sel_hi:[1,1,1]
    v_pk_fma_f32 v[20:21], v[134:135], v[108:109], v[20:21] op_sel:[1,0,0] op_sel_hi:[1,1,1]
    v_pk_fma_f32 v[22:23], v[134:135], v[110:111], v[22:23] op_sel:[1,0,0] op_sel_hi:[1,1,1]
    s_set_gpr_idx_off
A_56:
    s_sub_u32 s31, s31, 4
    s_cbranch_scc1 B_56
    v_mfma_f32_4x4x4_16b_bf16 v[124:127], v[172:173], v[178:179], 0 cbsz:4 abid:15
    v_lshlrev_b32_sdwa v136, v15, v114 dst_sel:DWORD dst_unused:UNUSED_PAD src0_sel:DWORD src1_sel:WORD_1
    s_waitcnt vmcnt(4)
    v_mfma_f32_4x4x4_16b_bf16 v[104:107], v[142:143], v[68:69], 0 cbsz:4 abid:14
    v_readlane_b32 s62, v164, 62
    v_mfma_f32_4x4x4_16b_bf16 v[108:111], v[142:143], v[70:71], 0 cbsz:4 abid:14
    v_lshlrev_b32_sdwa v137, v15, v115 dst_sel:DWORD dst_unused:UNUSED_PAD src0_sel:DWORD src1_sel:WORD_1
    ds_read_u16_d16_hi v132, v136 offset:32768
    ds_read_u16_d16_hi v133, v137 offset:32768
    s_and_b32 s33, s62, s34
    buffer_load_dwordx4 v[88:91], v1, s[12:15], s33 offen
    s_waitcnt lgkmcnt(2)
    s_set_gpr_idx_on s56, 0xc
    v_pk_fma_f32 v[16:17], v[128:129], v[96:97], v[16:17] op_sel:[0,0,0] op_sel_hi:[0,1,1]
    v_pk_fma_f32 v[18:19], v[128:129], v[98:99], v[18:19] op_sel:[0,0,0] op_sel_hi:[0,1,1]
    v_pk_fma_f32 v[20:21], v[130:131], v[100:101], v[20:21] op_sel:[0,0,0] op_sel_hi:[0,1,1]
    v_pk_fma_f32 v[22:23], v[130:131], v[102:103], v[22:23] op_sel:[0,0,0] op_sel_hi:[0,1,1]
    s_set_gpr_idx_off
    v_lshlrev_b32_sdwa v138, v15, v118 dst_sel:DWORD dst_unused:UNUSED_PAD src0_sel:DWORD src1_sel:WORD_1
    s_waitcnt vmcnt(4)
    v_mfma_f32_4x4x4_16b_bf16 v[96:99], v[144:145], v[72:73], 0 cbsz:4 abid:14
    v_readlane_b32 s63, v164, 63
    v_mfma_f32_4x4x4_16b_bf16 v[100:103], v[144:145], v[74:75], 0 cbsz:4 abid:14
    v_lshlrev_b32_sdwa v139, v15, v119 dst_sel:DWORD dst_unused:UNUSED_PAD src0_sel:DWORD src1_sel:WORD_1
    ds_read_u16_d16_hi v134, v138 offset:32768
    ds_read_u16_d16_hi v135, v139 offset:32768
    s_and_b32 s33, s63, s34
    buffer_load_dwordx4 v[92:95], v1, s[12:15], s33 offen
    s_set_gpr_idx_on s57, 0xc
    v_pk_fma_f32 v[16:17], v[128:129], v[104:105], v[16:17] op_sel:[1,0,0] op_sel_hi:[1,1,1]
    v_pk_fma_f32 v[18:19], v[128:129], v[106:107], v[18:19] op_sel:[1,0,0] op_sel_hi:[1,1,1]
    v_pk_fma_f32 v[20:21], v[130:131], v[108:109], v[20:21] op_sel:[1,0,0] op_sel_hi:[1,1,1]
    v_pk_fma_f32 v[22:23], v[130:131], v[110:111], v[22:23] op_sel:[1,0,0] op_sel_hi:[1,1,1]
    s_set_gpr_idx_off
    v_mov_b32 v172, v170
    v_mov_b32 v173, v171
    s_nop 1
    v_mfma_f32_4x4x4_16b_bf16 v[112:115], v[172:173], v[176:177], 0 cbsz:4 abid:0
    v_lshlrev_b32_sdwa v136, v15, v120 dst_sel:DWORD dst_unused:UNUSED_PAD src0_sel:DWORD src1_sel:WORD_1
    s_waitcnt vmcnt(4)
    v_mfma_f32_4x4x4_16b_bf16 v[104:107], v[146:147], v[76:77], 0 cbsz:4 abid:14
    v_readlane_b32 s48, v165, 0
    v_mfma_f32_4x4x4_16b_bf16 v[108:111], v[146:147], v[78:79], 0 cbsz:4 abid:14
    v_lshlrev_b32_sdwa v137, v15, v121 dst_sel:DWORD dst_unused:UNUSED_PAD src0_sel:DWORD src1_sel:WORD_1
    ds_read_u16_d16_hi v128, v136 offset:32768
    ds_read_u16_d16_hi v129, v137 offset:32768
    s_and_b32 s33, s48, s34
    buffer_load_dwordx4 v[64:67], v1, s[12:15], s33 offen
    s_waitcnt lgkmcnt(2)
    s_set_gpr_idx_on s58, 0xc
    v_pk_fma_f32 v[16:17], v[132:133], v[96:97], v[16:17] op_sel:[0,0,0] op_sel_hi:[0,1,1]
    v_pk_fma_f32 v[18:19], v[132:133], v[98:99], v[18:19] op_sel:[0,0,0] op_sel_hi:[0,1,1]
    v_pk_fma_f32 v[20:21], v[134:135], v[100:101], v[20:21] op_sel:[0,0,0] op_sel_hi:[0,1,1]
    v_pk_fma_f32 v[22:23], v[134:135], v[102:103], v[22:23] op_sel:[0,0,0] op_sel_hi:[0,1,1]
    s_set_gpr_idx_off
    v_lshlrev_b32_sdwa v138, v15, v124 dst_sel:DWORD dst_unused:UNUSED_PAD src0_sel:DWORD src1_sel:WORD_1
    s_waitcnt vmcnt(4)
    v_mfma_f32_4x4x4_16b_bf16 v[96:99], v[140:141], v[80:81], 0 cbsz:4 abid:15
    v_readlane_b32 s49, v165, 1
    v_mfma_f32_4x4x4_16b_bf16 v[100:103], v[140:141], v[82:83], 0 cbsz:4 abid:15
    v_lshlrev_b32_sdwa v139, v15, v125 dst_sel:DWORD dst_unused:UNUSED_PAD src0_sel:DWORD src1_sel:WORD_1
    ds_read_u16_d16_hi v130, v138 offset:32768
    ds_read_u16_d16_hi v131, v139 offset:32768
    s_and_b32 s33, s49, s34
    buffer_load_dwordx4 v[68:71], v1, s[12:15], s33 offen
    s_set_gpr_idx_on s59, 0xc
    v_pk_fma_f32 v[16:17], v[132:133], v[104:105], v[16:17] op_sel:[1,0,0] op_sel_hi:[1,1,1]
    v_pk_fma_f32 v[18:19], v[132:133], v[106:107], v[18:19] op_sel:[1,0,0] op_sel_hi:[1,1,1]
    v_pk_fma_f32 v[20:21], v[134:135], v[108:109], v[20:21] op_sel:[1,0,0] op_sel_hi:[1,1,1]
    v_pk_fma_f32 v[22:23], v[134:135], v[110:111], v[22:23] op_sel:[1,0,0] op_sel_hi:[1,1,1]
    s_set_gpr_idx_off
A_60:
    s_sub_u32 s31, s31, 4
    s_cbranch_scc1 B_60
    v_mfma_f32_4x4x4_16b_bf16 v[116:119], v[172:173], v[178:179], 0 cbsz:4 abid:0
    v_lshlrev_b32_sdwa v136, v15, v122 dst_sel:DWORD dst_unused:UNUSED_PAD src0_sel:DWORD src1_sel:WORD_1
    s_waitcnt vmcnt(4)
    v_mfma_f32_4x4x4_16b_bf16 v[104:107], v[142:143], v[84:85], 0 cbsz:4 abid:15
    v_readlane_b32 s50, v165, 2
    v_mfma_f32_4x4x4_16b_bf16 v[108:111], v[142:143], v[86:87], 0 cbsz:4 abid:15
    v_lshlrev_b32_sdwa v137, v15, v123 dst_sel:DWORD dst_unused:UNUSED_PAD src0_sel:DWORD src1_sel:WORD_1
    ds_read_u16_d16_hi v132, v136 offset:32768
    ds_read_u16_d16_hi v133, v137 offset:32768
    v_cvt_pk_bf16_f32 v140, v148, v152
    v_cvt_pk_bf16_f32 v141, v156, v160
    s_and_b32 s33, s50, s34
    buffer_load_dwordx4 v[72:75], v1, s[12:15], s33 offen
    s_waitcnt lgkmcnt(2)
    s_set_gpr_idx_on s60, 0xc
    v_pk_fma_f32 v[16:17], v[128:129], v[96:97], v[16:17] op_sel:[0,0,0] op_sel_hi:[0,1,1]
    v_pk_fma_f32 v[18:19], v[128:129], v[98:99], v[18:19] op_sel:[0,0,0] op_sel_hi:[0,1,1]
    v_pk_fma_f32 v[20:21], v[130:131], v[100:101], v[20:21] op_sel:[0,0,0] op_sel_hi:[0,1,1]
    v_pk_fma_f32 v[22:23], v[130:131], v[102:103], v[22:23] op_sel:[0,0,0] op_sel_hi:[0,1,1]
    s_set_gpr_idx_off
    v_lshlrev_b32_sdwa v138, v15, v126 dst_sel:DWORD dst_unused:UNUSED_PAD src0_sel:DWORD src1_sel:WORD_1
    s_waitcnt vmcnt(4)
    v_mfma_f32_4x4x4_16b_bf16 v[96:99], v[144:145], v[88:89], 0 cbsz:4 abid:15
    v_readlane_b32 s51, v165, 3
    v_mfma_f32_4x4x4_16b_bf16 v[100:103], v[144:145], v[90:91], 0 cbsz:4 abid:15
    v_lshlrev_b32_sdwa v139, v15, v127 dst_sel:DWORD dst_unused:UNUSED_PAD src0_sel:DWORD src1_sel:WORD_1
    ds_read_u16_d16_hi v134, v138 offset:32768
    ds_read_u16_d16_hi v135, v139 offset:32768
    v_cvt_pk_bf16_f32 v142, v149, v153
    v_cvt_pk_bf16_f32 v143, v157, v161
    s_and_b32 s33, s51, s34
    buffer_load_dwordx4 v[76:79], v1, s[12:15], s33 offen
    s_set_gpr_idx_on s61, 0xc
    v_pk_fma_f32 v[16:17], v[128:129], v[104:105], v[16:17] op_sel:[1,0,0] op_sel_hi:[1,1,1]
    v_pk_fma_f32 v[18:19], v[128:129], v[106:107], v[18:19] op_sel:[1,0,0] op_sel_hi:[1,1,1]
    v_pk_fma_f32 v[20:21], v[130:131], v[108:109], v[20:21] op_sel:[1,0,0] op_sel_hi:[1,1,1]
    v_pk_fma_f32 v[22:23], v[130:131], v[110:111], v[22:23] op_sel:[1,0,0] op_sel_hi:[1,1,1]
    s_set_gpr_idx_off
    v_mfma_f32_4x4x4_16b_bf16 v[120:123], v[172:173], v[176:177], 0 cbsz:4 abid:1
    v_lshlrev_b32_sdwa v136, v15, v112 dst_sel:DWORD dst_unused:UNUSED_PAD src0_sel:DWORD src1_sel:WORD_1
    s_waitcnt vmcnt(4)
    v_mfma_f32_4x4x4_16b_bf16 v[104:107], v[146:147], v[92:93], 0 cbsz:4 abid:15
    v_readlane_b32 s52, v165, 4
    v_mfma_f32_4x4x4_16b_bf16 v[108:111], v[146:147], v[94:95], 0 cbsz:4 abid:15
    v_lshlrev_b32_sdwa v137, v15, v113 dst_sel:DWORD dst_unused:UNUSED_PAD src0_sel:DWORD src1_sel:WORD_1
    ds_read_u16_d16_hi v128, v136 offset:32768
    ds_read_u16_d16_hi v129, v137 offset:32768
    v_cvt_pk_bf16_f32 v144, v150, v154
    v_cvt_pk_bf16_f32 v145, v158, v162
    s_and_b32 s33, s52, s34
    buffer_load_dwordx4 v[80:83], v1, s[12:15], s33 offen
    s_waitcnt lgkmcnt(2)
    s_set_gpr_idx_on s62, 0xc
    v_pk_fma_f32 v[16:17], v[132:133], v[96:97], v[16:17] op_sel:[0,0,0] op_sel_hi:[0,1,1]
    v_pk_fma_f32 v[18:19], v[132:133], v[98:99], v[18:19] op_sel:[0,0,0] op_sel_hi:[0,1,1]
    v_pk_fma_f32 v[20:21], v[134:135], v[100:101], v[20:21] op_sel:[0,0,0] op_sel_hi:[0,1,1]
    v_pk_fma_f32 v[22:23], v[134:135], v[102:103], v[22:23] op_sel:[0,0,0] op_sel_hi:[0,1,1]
    s_set_gpr_idx_off
    v_lshlrev_b32_sdwa v138, v15, v116 dst_sel:DWORD dst_unused:UNUSED_PAD src0_sel:DWORD src1_sel:WORD_1
    s_waitcnt vmcnt(4)
    v_mfma_f32_4x4x4_16b_bf16 v[96:99], v[140:141], v[64:65], 0 cbsz:4 abid:0
    v_readlane_b32 s53, v165, 5
    v_mfma_f32_4x4x4_16b_bf16 v[100:103], v[140:141], v[66:67], 0 cbsz:4 abid:0
    v_lshlrev_b32_sdwa v139, v15, v117 dst_sel:DWORD dst_unused:UNUSED_PAD src0_sel:DWORD src1_sel:WORD_1
    ds_read_u16_d16_hi v130, v138 offset:32768
    ds_read_u16_d16_hi v131, v139 offset:32768
    v_cvt_pk_bf16_f32 v146, v151, v155
    v_cvt_pk_bf16_f32 v147, v159, v163
    s_and_b32 s33, s53, s34
    buffer_load_dwordx4 v[84:87], v1, s[12:15], s33 offen
    s_set_gpr_idx_on s63, 0xc
    v_pk_fma_f32 v[16:17], v[132:133], v[104:105], v[16:17] op_sel:[1,0,0] op_sel_hi:[1,1,1]
    v_pk_fma_f32 v[18:19], v[132:133], v[106:107], v[18:19] op_sel:[1,0,0] op_sel_hi:[1,1,1]
    v_pk_fma_f32 v[20:21], v[134:135], v[108:109], v[20:21] op_sel:[1,0,0] op_sel_hi:[1,1,1]
    v_pk_fma_f32 v[22:23], v[134:135], v[110:111], v[22:23] op_sel:[1,0,0] op_sel_hi:[1,1,1]
    s_set_gpr_idx_off
    v_mov_b32 v164, v165
    s_branch A_0
B_0:
    buffer_load_dwordx4 v[188:191], v1, s[16:19], s10 offen offset:0 sc1
    buffer_load_dwordx4 v[192:195], v1, s[16:19], s10 offen offset:1024 sc1
    buffer_load_dwordx4 v[196:199], v1, s[16:19], s10 offen offset:2048 sc1
    buffer_load_dwordx4 v[200:203], v1, s[16:19], s10 offen offset:3072 sc1
    buffer_load_dwordx4 v[204:207], v1, s[16:19], s11 offen offset:0 sc1
    buffer_load_dwordx4 v[208:211], v1, s[16:19], s11 offen offset:1024 sc1
    buffer_load_dwordx4 v[212:215], v1, s[16:19], s11 offen offset:2048 sc1
    buffer_load_dwordx4 v[216:219], v1, s[16:19], s11 offen offset:3072 sc1
    s_sub_u32 s32, s32, 1
    s_cbranch_scc1 MAIN_DONE
    v_mfma_f32_4x4x4_16b_bf16 v[124:127], v[172:173], v[178:179], 0 cbsz:4 abid:1
    v_lshlrev_b32_sdwa v136, v15, v114 dst_sel:DWORD dst_unused:UNUSED_PAD src0_sel:DWORD src1_sel:WORD_1
    s_waitcnt vmcnt(12)
    v_mfma_f32_4x4x4_16b_bf16 v[104:107], v[142:143], v[68:69], 0 cbsz:4 abid:0
    s_nop 0
    v_mfma_f32_4x4x4_16b_bf16 v[108:111], v[142:143], v[70:71], 0 cbsz:4 abid:0
    v_lshlrev_b32_sdwa v137, v15, v115 dst_sel:DWORD dst_unused:UNUSED_PAD src0_sel:DWORD src1_sel:WORD_1
    ds_read_u16_d16_hi v132, v136 offset:32768
    ds_read_u16_d16_hi v133, v137 offset:32768
    s_waitcnt lgkmcnt(2)
    s_set_gpr_idx_on s48, 0xc
    v_pk_fma_f32 v[16:17], v[128:129], v[96:97], v[16:17] op_sel:[0,0,0] op_sel_hi:[0,1,1]
    v_pk_fma_f32 v[18:19], v[128:129], v[98:99], v[18:19] op_sel:[0,0,0] op_sel_hi:[0,1,1]
    v_pk_fma_f32 v[20:21], v[130:131], v[100:101], v[20:21] op_sel:[0,0,0] op_sel_hi:[0,1,1]
    v_pk_fma_f32 v[22:23], v[130:131], v[102:103], v[22:23] op_sel:[0,0,0] op_sel_hi:[0,1,1]
    s_set_gpr_idx_off
    s_sub_u32 s32, s32, 1
    s_cbranch_scc1 MAIN_DONE
    v_lshlrev_b32_sdwa v138, v15, v118 dst_sel:DWORD dst_unused:UNUSED_PAD src0_sel:DWORD src1_sel:WORD_1
    s_waitcnt vmcnt(11)
    v_mfma_f32_4x4x4_16b_bf16 v[96:99], v[144:145], v[72:73], 0 cbsz:4 abid:0
    s_nop 0
    v_mfma_f32_4x4x4_16b_bf16 v[100:103], v[144:145], v[74:75], 0 cbsz:4 abid:0
    v_lshlrev_b32_sdwa v139, v15, v119 dst_sel:DWORD dst_unused:UNUSED_PAD src0_sel:DWORD src1_sel:WORD_1
    ds_read_u16_d16_hi v134, v138 offset:32768
    ds_read_u16_d16_hi v135, v139 offset:32768
    s_set_gpr_idx_on s49, 0xc
    v_pk_fma_f32 v[16:17], v[128:129], v[104:105], v[16:17] op_sel:[1,0,0] op_sel_hi:[1,1,1]
    v_pk_fma_f32 v[18:19], v[128:129], v[106:107], v[18:19] op_sel:[1,0,0] op_sel_hi:[1,1,1]
    v_pk_fma_f32 v[20:21], v[130:131], v[108:109], v[20:21] op_sel:[1,0,0] op_sel_hi:[1,1,1]
    v_pk_fma_f32 v[22:23], v[130:131], v[110:111], v[22:23] op_sel:[1,0,0] op_sel_hi:[1,1,1]
    s_set_gpr_idx_off
    s_sub_u32 s32, s32, 1
    s_cbranch_scc1 MAIN_DONE
    v_mfma_f32_4x4x4_16b_bf16 v[112:115], v[172:173], v[176:177], 0 cbsz:4 abid:2
    v_lshlrev_b32_sdwa v136, v15, v120 dst_sel:DWORD dst_unused:UNUSED_PAD src0_sel:DWORD src1_sel:WORD_1
    s_waitcnt vmcnt(10)
    v_mfma_f32_4x4x4_16b_bf16 v[104:107], v[146:147], v[76:77], 0 cbsz:4 abid:0
    s_nop 0
    v_mfma_f32_4x4x4_16b_bf16 v[108:111], v[146:147], v[78:79], 0 cbsz:4 abid:0
    v_lshlrev_b32_sdwa v137, v15, v121 dst_sel:DWORD dst_unused:UNUSED_PAD src0_sel:DWORD src1_sel:WORD_1
    ds_read_u16_d16_hi v128, v136 offset:32768
    ds_read_u16_d16_hi v129, v137 offset:32768
    s_waitcnt lgkmcnt(2)
    s_set_gpr_idx_on s50, 0xc
    v_pk_fma_f32 v[16:17], v[132:133], v[96:97], v[16:17] op_sel:[0,0,0] op_sel_hi:[0,1,1]
    v_pk_fma_f32 v[18:19], v[132:133], v[98:99], v[18:19] op_sel:[0,0,0] op_sel_hi:[0,1,1]
    v_pk_fma_f32 v[20:21], v[134:135], v[100:101], v[20:21] op_sel:[0,0,0] op_sel_hi:[0,1,1]
    v_pk_fma_f32 v[22:23], v[134:135], v[102:103], v[22:23] op_sel:[0,0,0] op_sel_hi:[0,1,1]
    s_set_gpr_idx_off
    s_sub_u32 s32, s32, 1
    s_cbranch_scc1 MAIN_DONE
    v_lshlrev_b32_sdwa v138, v15, v124 dst_sel:DWORD dst_unused:UNUSED_PAD src0_sel:DWORD src1_sel:WORD_1
    s_waitcnt vmcnt(9)
    v_mfma_f32_4x4x4_16b_bf16 v[96:99], v[140:141], v[80:81], 0 cbsz:4 abid:1
    s_nop 0
    v_mfma_f32_4x4x4_16b_bf16 v[100:103], v[140:141], v[82:83], 0 cbsz:4 abid:1
    v_lshlrev_b32_sdwa v139, v15, v125 dst_sel:DWORD dst_unused:UNUSED_PAD src0_sel:DWORD src1_sel:WORD_1
    ds_read_u16_d16_hi v130, v138 offset:32768
    ds_read_u16_d16_hi v131, v139 offset:32768
    s_set_gpr_idx_on s51, 0xc
    v_pk_fma_f32 v[16:17], v[132:133], v[104:105], v[16:17] op_sel:[1,0,0] op_sel_hi:[1,1,1]
    v_pk_fma_f32 v[18:19], v[132:133], v[106:107], v[18:19] op_sel:[1,0,0] op_sel_hi:[1,1,1]
    v_pk_fma_f32 v[20:21], v[134:135], v[108:109], v[20:21] op_sel:[1,0,0] op_sel_hi:[1,1,1]
    v_pk_fma_f32 v[22:23], v[134:135], v[110:111], v[22:23] op_sel:[1,0,0] op_sel_hi:[1,1,1]
    s_set_gpr_idx_off
    s_sub_u32 s32, s32, 1
    s_cbranch_scc1 MAIN_DONE
    v_mfma_f32_4x4x4_16b_bf16 v[116:119], v[172:173], v[178:179], 0 cbsz:4 abid:2
    v_lshlrev_b32_sdwa v136, v15, v122 dst_sel:DWORD dst_unused:UNUSED_PAD src0_sel:DWORD src1_sel:WORD_1
    s_waitcnt vmcnt(8)
    v_mfma_f32_4x4x4_16b_bf16 v[104:107], v[142:143], v[84:85], 0 cbsz:4 abid:1
    s_nop 0
    v_mfma_f32_4x4x4_16b_bf16 v[108:111], v[142:143], v[86:87], 0 cbsz:4 abid:1
    v_lshlrev_b32_sdwa v137, v15, v123 dst_sel:DWORD dst_unused:UNUSED_PAD src0_sel:DWORD src1_sel:WORD_1
    ds_read_u16_d16_hi v132, v136 offset:32768
    ds_read_u16_d16_hi v133, v137 offset:32768
    s_waitcnt lgkmcnt(2)
    s_set_gpr_idx_on s52, 0xc
    v_pk_fma_f32 v[16:17], v[128:129], v[96:97], v[16:17] op_sel:[0,0,0] op_sel_hi:[0,1,1]
    v_pk_fma_f32 v[18:19], v[128:129], v[98:99], v[18:19] op_sel:[0,0,0] op_sel_hi:[0,1,1]
    v_pk_fma_f32 v[20:21], v[130:131], v[100:101], v[20:21] op_sel:[0,0,0] op_sel_hi:[0,1,1]
    v_pk_fma_f32 v[22:23], v[130:131], v[102:103], v[22:23] op_sel:[0,0,0] op_sel_hi:[0,1,1]
    s_set_gpr_idx_off
    s_sub_u32 s32, s32, 1
    s_cbranch_scc1 MAIN_DONE
    v_lshlrev_b32_sdwa v138, v15, v126 dst_sel:DWORD dst_unused:UNUSED_PAD src0_sel:DWORD src1_sel:WORD_1
    v_mfma_f32_4x4x4_16b_bf16 v[96:99], v[144:145], v[88:89], 0 cbsz:4 abid:1
    s_nop 0
    v_mfma_f32_4x4x4_16b_bf16 v[100:103], v[144:145], v[90:91], 0 cbsz:4 abid:1
    v_lshlrev_b32_sdwa v139, v15, v127 dst_sel:DWORD dst_unused:UNUSED_PAD src0_sel:DWORD src1_sel:WORD_1
    ds_read_u16_d16_hi v134, v138 offset:32768
    ds_read_u16_d16_hi v135, v139 offset:32768
    s_set_gpr_idx_on s53, 0xc
    v_pk_fma_f32 v[16:17], v[128:129], v[104:105], v[16:17] op_sel:[1,0,0] op_sel_hi:[1,1,1]
    v_pk_fma_f32 v[18:19], v[128:129], v[106:107], v[18:19] op_sel:[1,0,0] op_sel_hi:[1,1,1]
    v_pk_fma_f32 v[20:21], v[130:131], v[108:109], v[20:21] op_sel:[1,0,0] op_sel_hi:[1,1,1]
    v_pk_fma_f32 v[22:23], v[130:131], v[110:111], v[22:23] op_sel:[1,0,0] op_sel_hi:[1,1,1]
    s_set_gpr_idx_off
    s_branch MAIN_DONE
B_4:
    buffer_load_dwordx4 v[188:191], v1, s[16:19], s10 offen offset:0 sc1
    buffer_load_dwordx4 v[192:195], v1, s[16:19], s10 offen offset:1024 sc1
    buffer_load_dwordx4 v[196:199], v1, s[16:19], s10 offen offset:2048 sc1
    buffer_load_dwordx4 v[200:203], v1, s[16:19], s10 offen offset:3072 sc1
    buffer_load_dwordx4 v[204:207], v1, s[16:19], s11 offen offset:0 sc1
    buffer_load_dwordx4 v[208:211], v1, s[16:19], s11 offen offset:1024 sc1
    buffer_load_dwordx4 v[212:215], v1, s[16:19], s11 offen offset:2048 sc1
    buffer_load_dwordx4 v[216:219], v1, s[16:19], s11 offen offset:3072 sc1
    s_sub_u32 s32, s32, 1
    s_cbranch_scc1 MAIN_DONE
    v_mfma_f32_4x4x4_16b_bf16 v[116:119], v[172:173], v[178:179], 0 cbsz:4 abid:2
    v_lshlrev_b32_sdwa v136, v15, v122 dst_sel:DWORD dst_unused:UNUSED_PAD src0_sel:DWORD src1_sel:WORD_1
    s_waitcnt vmcnt(12)
    v_mfma_f32_4x4x4_16b_bf16 v[104:107], v[142:143], v[84:85], 0 cbsz:4 abid:1
    s_nop 0
    v_mfma_f32_4x4x4_16b_bf16 v[108:111], v[142:143], v[86:87], 0 cbsz:4 abid:1
    v_lshlrev_b32_sdwa v137, v15, v123 dst_sel:DWORD dst_unused:UNUSED_PAD src0_sel:DWORD src1_sel:WORD_1
    ds_read_u16_d16_hi v132, v136 offset:32768
    ds_read_u16_d16_hi v133, v137 offset:32768
    s_waitcnt lgkmcnt(2)
    s_set_gpr_idx_on s52, 0xc
    v_pk_fma_f32 v[16:17], v[128:129], v[96:97], v[16:17] op_sel:[0,0,0] op_sel_hi:[0,1,1]
    v_pk_fma_f32 v[18:19], v[128:129], v[98:99], v[18:19] op_sel:[0,0,0] op_sel_hi:[0,1,1]
    v_pk_fma_f32 v[20:21], v[130:131], v[100:101], v[20:21] op_sel:[0,0,0] op_sel_hi:[0,1,1]
    v_pk_fma_f32 v[22:23], v[130:131], v[102:103], v[22:23] op_sel:[0,0,0] op_sel_hi:[0,1,1]
    s_set_gpr_idx_off
    s_sub_u32 s32, s32, 1
    s_cbranch_scc1 MAIN_DONE
    v_lshlrev_b32_sdwa v138, v15, v126 dst_sel:DWORD dst_unused:UNUSED_PAD src0_sel:DWORD src1_sel:WORD_1
    s_waitcnt vmcnt(11)
    v_mfma_f32_4x4x4_16b_bf16 v[96:99], v[144:145], v[88:89], 0 cbsz:4 abid:1
    s_nop 0
    v_mfma_f32_4x4x4_16b_bf16 v[100:103], v[144:145], v[90:91], 0 cbsz:4 abid:1
    v_lshlrev_b32_sdwa v139, v15, v127 dst_sel:DWORD dst_unused:UNUSED_PAD src0_sel:DWORD src1_sel:WORD_1
    ds_read_u16_d16_hi v134, v138 offset:32768
    ds_read_u16_d16_hi v135, v139 offset:32768
    s_set_gpr_idx_on s53, 0xc
    v_pk_fma_f32 v[16:17], v[128:129], v[104:105], v[16:17] op_sel:[1,0,0] op_sel_hi:[1,1,1]
    v_pk_fma_f32 v[18:19], v[128:129], v[106:107], v[18:19] op_sel:[1,0,0] op_sel_hi:[1,1,1]
    v_pk_fma_f32 v[20:21], v[130:131], v[108:109], v[20:21] op_sel:[1,0,0] op_sel_hi:[1,1,1]
    v_pk_fma_f32 v[22:23], v[130:131], v[110:111], v[22:23] op_sel:[1,0,0] op_sel_hi:[1,1,1]
    s_set_gpr_idx_off
    s_sub_u32 s32, s32, 1
    s_cbranch_scc1 MAIN_DONE
    v_mfma_f32_4x4x4_16b_bf16 v[120:123], v[172:173], v[176:177], 0 cbsz:4 abid:3
    v_lshlrev_b32_sdwa v136, v15, v112 dst_sel:DWORD dst_unused:UNUSED_PAD src0_sel:DWORD src1_sel:WORD_1
    s_waitcnt vmcnt(10)
    v_mfma_f32_4x4x4_16b_bf16 v[104:107], v[146:147], v[92:93], 0 cbsz:4 abid:1
    s_nop 0
    v_mfma_f32_4x4x4_16b_bf16 v[108:111], v[146:147], v[94:95], 0 cbsz:4 abid:1
    v_lshlrev_b32_sdwa v137, v15, v113 dst_sel:DWORD dst_unused:UNUSED_PAD src0_sel:DWORD src1_sel:WORD_1
    ds_read_u16_d16_hi v128, v136 offset:32768
    ds_read_u16_d16_hi v129, v137 offset:32768
    s_waitcnt lgkmcnt(2)
    s_set_gpr_idx_on s54, 0xc
    v_pk_fma_f32 v[16:17], v[132:133], v[96:97], v[16:17] op_sel:[0,0,0] op_sel_hi:[0,1,1]
    v_pk_fma_f32 v[18:19], v[132:133], v[98:99], v[18:19] op_sel:[0,0,0] op_sel_hi:[0,1,1]
    v_pk_fma_f32 v[20:21], v[134:135], v[100:101], v[20:21] op_sel:[0,0,0] op_sel_hi:[0,1,1]
    v_pk_fma_f32 v[22:23], v[134:135], v[102:103], v[22:23] op_sel:[0,0,0] op_sel_hi:[0,1,1]
    s_set_gpr_idx_off
    s_sub_u32 s32, s32, 1
    s_cbranch_scc1 MAIN_DONE
    v_lshlrev_b32_sdwa v138, v15, v116 dst_sel:DWORD dst_unused:UNUSED_PAD src0_sel:DWORD src1_sel:WORD_1
    s_waitcnt vmcnt(9)
    v_mfma_f32_4x4x4_16b_bf16 v[96:99], v[140:141], v[64:65], 0 cbsz:4 abid:2
    s_nop 0
    v_mfma_f32_4x4x4_16b_bf16 v[100:103], v[140:141], v[66:67], 0 cbsz:4 abid:2
    v_lshlrev_b32_sdwa v139, v15, v117 dst_sel:DWORD dst_unused:UNUSED_PAD src0_sel:DWORD src1_sel:WORD_1
    ds_read_u16_d16_hi v130, v138 offset:32768
    ds_read_u16_d16_hi v131, v139 offset:32768
    s_set_gpr_idx_on s55, 0xc
    v_pk_fma_f32 v[16:17], v[132:133], v[104:105], v[16:17] op_sel:[1,0,0] op_sel_hi:[1,1,1]
    v_pk_fma_f32 v[18:19], v[132:133], v[106:107], v[18:19] op_sel:[1,0,0] op_sel_hi:[1,1,1]
    v_pk_fma_f32 v[20:21], v[134:135], v[108:109], v[20:21] op_sel:[1,0,0] op_sel_hi:[1,1,1]
    v_pk_fma_f32 v[22:23], v[134:135], v[110:111], v[22:23] op_sel:[1,0,0] op_sel_hi:[1,1,1]
    s_set_gpr_idx_off
    s_sub_u32 s32, s32, 1
    s_cbranch_scc1 MAIN_DONE
    v_mfma_f32_4x4x4_16b_bf16 v[124:127], v[172:173], v[178:179], 0 cbsz:4 abid:3
    v_lshlrev_b32_sdwa v136, v15, v114 dst_sel:DWORD dst_unused:UNUSED_PAD src0_sel:DWORD src1_sel:WORD_1
    s_waitcnt vmcnt(8)
    v_mfma_f32_4x4x4_16b_bf16 v[104:107], v[142:143], v[68:69], 0 cbsz:4 abid:2
    s_nop 0
    v_mfma_f32_4x4x4_16b_bf16 v[108:111], v[142:143], v[70:71], 0 cbsz:4 abid:2
    v_lshlrev_b32_sdwa v137, v15, v115 dst_sel:DWORD dst_unused:UNUSED_PAD src0_sel:DWORD src1_sel:WORD_1
    ds_read_u16_d16_hi v132, v136 offset:32768
    ds_read_u16_d16_hi v133, v137 offset:32768
    s_waitcnt lgkmcnt(2)
    s_set_gpr_idx_on s56, 0xc
    v_pk_fma_f32 v[16:17], v[128:129], v[96:97], v[16:17] op_sel:[0,0,0] op_sel_hi:[0,1,1]
    v_pk_fma_f32 v[18:19], v[128:129], v[98:99], v[18:19] op_sel:[0,0,0] op_sel_hi:[0,1,1]
    v_pk_fma_f32 v[20:21], v[130:131], v[100:101], v[20:21] op_sel:[0,0,0] op_sel_hi:[0,1,1]
    v_pk_fma_f32 v[22:23], v[130:131], v[102:103], v[22:23] op_sel:[0,0,0] op_sel_hi:[0,1,1]
    s_set_gpr_idx_off
    s_sub_u32 s32, s32, 1
    s_cbranch_scc1 MAIN_DONE
    v_lshlrev_b32_sdwa v138, v15, v118 dst_sel:DWORD dst_unused:UNUSED_PAD src0_sel:DWORD src1_sel:WORD_1
    v_mfma_f32_4x4x4_16b_bf16 v[96:99], v[144:145], v[72:73], 0 cbsz:4 abid:2
    s_nop 0
    v_mfma_f32_4x4x4_16b_bf16 v[100:103], v[144:145], v[74:75], 0 cbsz:4 abid:2
    v_lshlrev_b32_sdwa v139, v15, v119 dst_sel:DWORD dst_unused:UNUSED_PAD src0_sel:DWORD src1_sel:WORD_1
    ds_read_u16_d16_hi v134, v138 offset:32768
    ds_read_u16_d16_hi v135, v139 offset:32768
    s_set_gpr_idx_on s57, 0xc
    v_pk_fma_f32 v[16:17], v[128:129], v[104:105], v[16:17] op_sel:[1,0,0] op_sel_hi:[1,1,1]
    v_pk_fma_f32 v[18:19], v[128:129], v[106:107], v[18:19] op_sel:[1,0,0] op_sel_hi:[1,1,1]
    v_pk_fma_f32 v[20:21], v[130:131], v[108:109], v[20:21] op_sel:[1,0,0] op_sel_hi:[1,1,1]
    v_pk_fma_f32 v[22:23], v[130:131], v[110:111], v[22:23] op_sel:[1,0,0] op_sel_hi:[1,1,1]
    s_set_gpr_idx_off
    s_branch MAIN_DONE
B_8:
    buffer_load_dwordx4 v[188:191], v1, s[16:19], s10 offen offset:0 sc1
    buffer_load_dwordx4 v[192:195], v1, s[16:19], s10 offen offset:1024 sc1
    buffer_load_dwordx4 v[196:199], v1, s[16:19], s10 offen offset:2048 sc1
    buffer_load_dwordx4 v[200:203], v1, s[16:19], s10 offen offset:3072 sc1
    buffer_load_dwordx4 v[204:207], v1, s[16:19], s11 offen offset:0 sc1
    buffer_load_dwordx4 v[208:211], v1, s[16:19], s11 offen offset:1024 sc1
    buffer_load_dwordx4 v[212:215], v1, s[16:19], s11 offen offset:2048 sc1
    buffer_load_dwordx4 v[216:219], v1, s[16:19], s11 offen offset:3072 sc1
    s_sub_u32 s32, s32, 1
    s_cbranch_scc1 MAIN_DONE
    v_mfma_f32_4x4x4_16b_bf16 v[124:127], v[172:173], v[178:179], 0 cbsz:4 abid:3
    v_lshlrev_b32_sdwa v136, v15, v114 dst_sel:DWORD dst_unused:UNUSED_PAD src0_sel:DWORD src1_sel:WORD_1
    s_waitcnt vmcnt(12)
    v_mfma_f32_4x4x4_16b_bf16 v[104:107], v[142:143], v[68:69], 0 cbsz:4 abid:2
    s_nop 0
    v_mfma_f32_4x4x4_16b_bf16 v[108:111], v[142:143], v[70:71], 0 cbsz:4 abid:2
    v_lshlrev_b32_sdwa v137, v15, v115 dst_sel:DWORD dst_unused:UNUSED_PAD src0_sel:DWORD src1_sel:WORD_1
    ds_read_u16_d16_hi v132, v136 offset:32768
    ds_read_u16_d16_hi v133, v137 offset:32768
    s_waitcnt lgkmcnt(2)
    s_set_gpr_idx_on s56, 0xc
    v_pk_fma_f32 v[16:17], v[128:129], v[96:97], v[16:17] op_sel:[0,0,0] op_sel_hi:[0,1,1]
    v_pk_fma_f32 v[18:19], v[128:129], v[98:99], v[18:19] op_sel:[0,0,0] op_sel_hi:[0,1,1]
    v_pk_fma_f32 v[20:21], v[130:131], v[100:101], v[20:21] op_sel:[0,0,0] op_sel_hi:[0,1,1]
    v_pk_fma_f32 v[22:23], v[130:131], v[102:103], v[22:23] op_sel:[0,0,0] op_sel_hi:[0,1,1]
    s_set_gpr_idx_off
    s_sub_u32 s32, s32, 1
    s_cbranch_scc1 MAIN_DONE
    v_lshlrev_b32_sdwa v138, v15, v118 dst_sel:DWORD dst_unused:UNUSED_PAD src0_sel:DWORD src1_sel:WORD_1
    s_waitcnt vmcnt(11)
    v_mfma_f32_4x4x4_16b_bf16 v[96:99], v[144:145], v[72:73], 0 cbsz:4 abid:2
    s_nop 0
    v_mfma_f32_4x4x4_16b_bf16 v[100:103], v[144:145], v[74:75], 0 cbsz:4 abid:2
    v_lshlrev_b32_sdwa v139, v15, v119 dst_sel:DWORD dst_unused:UNUSED_PAD src0_sel:DWORD src1_sel:WORD_1
    ds_read_u16_d16_hi v134, v138 offset:32768
    ds_read_u16_d16_hi v135, v139 offset:32768
    s_set_gpr_idx_on s57, 0xc
    v_pk_fma_f32 v[16:17], v[128:129], v[104:105], v[16:17] op_sel:[1,0,0] op_sel_hi:[1,1,1]
    v_pk_fma_f32 v[18:19], v[128:129], v[106:107], v[18:19] op_sel:[1,0,0] op_sel_hi:[1,1,1]
    v_pk_fma_f32 v[20:21], v[130:131], v[108:109], v[20:21] op_sel:[1,0,0] op_sel_hi:[1,1,1]
    v_pk_fma_f32 v[22:23], v[130:131], v[110:111], v[22:23] op_sel:[1,0,0] op_sel_hi:[1,1,1]
    s_set_gpr_idx_off
    s_sub_u32 s32, s32, 1
    s_cbranch_scc1 MAIN_DONE
    v_mfma_f32_4x4x4_16b_bf16 v[112:115], v[172:173], v[176:177], 0 cbsz:4 abid:4
    v_lshlrev_b32_sdwa v136, v15, v120 dst_sel:DWORD dst_unused:UNUSED_PAD src0_sel:DWORD src1_sel:WORD_1
    s_waitcnt vmcnt(10)
    v_mfma_f32_4x4x4_16b_bf16 v[104:107], v[146:147], v[76:77], 0 cbsz:4 abid:2
    s_nop 0
    v_mfma_f32_4x4x4_16b_bf16 v[108:111], v[146:147], v[78:79], 0 cbsz:4 abid:2
    v_lshlrev_b32_sdwa v137, v15, v121 dst_sel:DWORD dst_unused:UNUSED_PAD src0_sel:DWORD src1_sel:WORD_1
    ds_read_u16_d16_hi v128, v136 offset:32768
    ds_read_u16_d16_hi v129, v137 offset:32768
    s_waitcnt lgkmcnt(2)
    s_set_gpr_idx_on s58, 0xc
    v_pk_fma_f32 v[16:17], v[132:133], v[96:97], v[16:17] op_sel:[0,0,0] op_sel_hi:[0,1,1]
    v_pk_fma_f32 v[18:19], v[132:133], v[98:99], v[18:19] op_sel:[0,0,0] op_sel_hi:[0,1,1]
    v_pk_fma_f32 v[20:21], v[134:135], v[100:101], v[20:21] op_sel:[0,0,0] op_sel_hi:[0,1,1]
    v_pk_fma_f32 v[22:23], v[134:135], v[102:103], v[22:23] op_sel:[0,0,0] op_sel_hi:[0,1,1]
    s_set_gpr_idx_off
    s_sub_u32 s32, s32, 1
    s_cbranch_scc1 MAIN_DONE
    v_lshlrev_b32_sdwa v138, v15, v124 dst_sel:DWORD dst_unused:UNUSED_PAD src0_sel:DWORD src1_sel:WORD_1
    s_waitcnt vmcnt(9)
    v_mfma_f32_4x4x4_16b_bf16 v[96:99], v[140:141], v[80:81], 0 cbsz:4 abid:3
    s_nop 0
    v_mfma_f32_4x4x4_16b_bf16 v[100:103], v[140:141], v[82:83], 0 cbsz:4 abid:3
    v_lshlrev_b32_sdwa v139, v15, v125 dst_sel:DWORD dst_unused:UNUSED_PAD src0_sel:DWORD src1_sel:WORD_1
    ds_read_u16_d16_hi v130, v138 offset:32768
    ds_read_u16_d16_hi v131, v139 offset:32768
    s_set_gpr_idx_on s59, 0xc
    v_pk_fma_f32 v[16:17], v[132:133], v[104:105], v[16:17] op_sel:[1,0,0] op_sel_hi:[1,1,1]
    v_pk_fma_f32 v[18:19], v[132:133], v[106:107], v[18:19] op_sel:[1,0,0] op_sel_hi:[1,1,1]
    v_pk_fma_f32 v[20:21], v[134:135], v[108:109], v[20:21] op_sel:[1,0,0] op_sel_hi:[1,1,1]
    v_pk_fma_f32 v[22:23], v[134:135], v[110:111], v[22:23] op_sel:[1,0,0] op_sel_hi:[1,1,1]
    s_set_gpr_idx_off
    s_sub_u32 s32, s32, 1
    s_cbranch_scc1 MAIN_DONE
    v_mfma_f32_4x4x4_16b_bf16 v[116:119], v[172:173], v[178:179], 0 cbsz:4 abid:4
    v_lshlrev_b32_sdwa v136, v15, v122 dst_sel:DWORD dst_unused:UNUSED_PAD src0_sel:DWORD src1_sel:WORD_1
    s_waitcnt vmcnt(8)
    v_mfma_f32_4x4x4_16b_bf16 v[104:107], v[142:143], v[84:85], 0 cbsz:4 abid:3
    s_nop 0
    v_mfma_f32_4x4x4_16b_bf16 v[108:111], v[142:143], v[86:87], 0 cbsz:4 abid:3
    v_lshlrev_b32_sdwa v137, v15, v123 dst_sel:DWORD dst_unused:UNUSED_PAD src0_sel:DWORD src1_sel:WORD_1
    ds_read_u16_d16_hi v132, v136 offset:32768
    ds_read_u16_d16_hi v133, v137 offset:32768
    s_waitcnt lgkmcnt(2)
    s_set_gpr_idx_on s60, 0xc
    v_pk_fma_f32 v[16:17], v[128:129], v[96:97], v[16:17] op_sel:[0,0,0] op_sel_hi:[0,1,1]
    v_pk_fma_f32 v[18:19], v[128:129], v[98:99], v[18:19] op_sel:[0,0,0] op_sel_hi:[0,1,1]
    v_pk_fma_f32 v[20:21], v[130:131], v[100:101], v[20:21] op_sel:[0,0,0] op_sel_hi:[0,1,1]
    v_pk_fma_f32 v[22:23], v[130:131], v[102:103], v[22:23] op_sel:[0,0,0] op_sel_hi:[0,1,1]
    s_set_gpr_idx_off
    s_sub_u32 s32, s32, 1
    s_cbranch_scc1 MAIN_DONE
    v_lshlrev_b32_sdwa v138, v15, v126 dst_sel:DWORD dst_unused:UNUSED_PAD src0_sel:DWORD src1_sel:WORD_1
    v_mfma_f32_4x4x4_16b_bf16 v[96:99], v[144:145], v[88:89], 0 cbsz:4 abid:3
    s_nop 0
    v_mfma_f32_4x4x4_16b_bf16 v[100:103], v[144:145], v[90:91], 0 cbsz:4 abid:3
    v_lshlrev_b32_sdwa v139, v15, v127 dst_sel:DWORD dst_unused:UNUSED_PAD src0_sel:DWORD src1_sel:WORD_1
    ds_read_u16_d16_hi v134, v138 offset:32768
    ds_read_u16_d16_hi v135, v139 offset:32768
    s_set_gpr_idx_on s61, 0xc
    v_pk_fma_f32 v[16:17], v[128:129], v[104:105], v[16:17] op_sel:[1,0,0] op_sel_hi:[1,1,1]
    v_pk_fma_f32 v[18:19], v[128:129], v[106:107], v[18:19] op_sel:[1,0,0] op_sel_hi:[1,1,1]
    v_pk_fma_f32 v[20:21], v[130:131], v[108:109], v[20:21] op_sel:[1,0,0] op_sel_hi:[1,1,1]
    v_pk_fma_f32 v[22:23], v[130:131], v[110:111], v[22:23] op_sel:[1,0,0] op_sel_hi:[1,1,1]
    s_set_gpr_idx_off
    s_branch MAIN_DONE
B_12:
    buffer_load_dwordx4 v[188:191], v1, s[16:19], s10 offen offset:0 sc1
    buffer_load_dwordx4 v[192:195], v1, s[16:19], s10 offen offset:1024 sc1
    buffer_load_dwordx4 v[196:199], v1, s[16:19], s10 offen offset:2048 sc1
    buffer_load_dwordx4 v[200:203], v1, s[16:19], s10 offen offset:3072 sc1
    buffer_load_dwordx4 v[204:207], v1, s[16:19], s11 offen offset:0 sc1
    buffer_load_dwordx4 v[208:211], v1, s[16:19], s11 offen offset:1024 sc1
    buffer_load_dwordx4 v[212:215], v1, s[16:19], s11 offen offset:2048 sc1
    buffer_load_dwordx4 v[216:219], v1, s[16:19], s11 offen offset:3072 sc1
    s_sub_u32 s32, s32, 1
    s_cbranch_scc1 MAIN_DONE
    v_mfma_f32_4x4x4_16b_bf16 v[116:119], v[172:173], v[178:179], 0 cbsz:4 abid:4
    v_lshlrev_b32_sdwa v136, v15, v122 dst_sel:DWORD dst_unused:UNUSED_PAD src0_sel:DWORD src1_sel:WORD_1
    s_waitcnt vmcnt(12)
    v_mfma_f32_4x4x4_16b_bf16 v[104:107], v[142:143], v[84:85], 0 cbsz:4 abid:3
    s_nop 0
    v_mfma_f32_4x4x4_16b_bf16 v[108:111], v[142:143], v[86:87], 0 cbsz:4 abid:3
    v_lshlrev_b32_sdwa v137, v15, v123 dst_sel:DWORD dst_unused:UNUSED_PAD src0_sel:DWORD src1_sel:WORD_1
    ds_read_u16_d16_hi v132, v136 offset:32768
    ds_read_u16_d16_hi v133, v137 offset:32768
    s_waitcnt lgkmcnt(2)
    s_set_gpr_idx_on s60, 0xc
    v_pk_fma_f32 v[16:17], v[128:129], v[96:97], v[16:17] op_sel:[0,0,0] op_sel_hi:[0,1,1]
    v_pk_fma_f32 v[18:19], v[128:129], v[98:99], v[18:19] op_sel:[0,0,0] op_sel_hi:[0,1,1]
    v_pk_fma_f32 v[20:21], v[130:131], v[100:101], v[20:21] op_sel:[0,0,0] op_sel_hi:[0,1,1]
    v_pk_fma_f32 v[22:23], v[130:131], v[102:103], v[22:23] op_sel:[0,0,0] op_sel_hi:[0,1,1]
    s_set_gpr_idx_off
    s_sub_u32 s32, s32, 1
    s_cbranch_scc1 MAIN_DONE
    v_lshlrev_b32_sdwa v138, v15, v126 dst_sel:DWORD dst_unused:UNUSED_PAD src0_sel:DWORD src1_sel:WORD_1
    s_waitcnt vmcnt(11)
    v_mfma_f32_4x4x4_16b_bf16 v[96:99], v[144:145], v[88:89], 0 cbsz:4 abid:3
    s_nop 0
    v_mfma_f32_4x4x4_16b_bf16 v[100:103], v[144:145], v[90:91], 0 cbsz:4 abid:3
    v_lshlrev_b32_sdwa v139, v15, v127 dst_sel:DWORD dst_unused:UNUSED_PAD src0_sel:DWORD src1_sel:WORD_1
    ds_read_u16_d16_hi v134, v138 offset:32768
    ds_read_u16_d16_hi v135, v139 offset:32768
    s_set_gpr_idx_on s61, 0xc
    v_pk_fma_f32 v[16:17], v[128:129], v[104:105], v[16:17] op_sel:[1,0,0] op_sel_hi:[1,1,1]
    v_pk_fma_f32 v[18:19], v[128:129], v[106:107], v[18:19] op_sel:[1,0,0] op_sel_hi:[1,1,1]
    v_pk_fma_f32 v[20:21], v[130:131], v[108:109], v[20:21] op_sel:[1,0,0] op_sel_hi:[1,1,1]
    v_pk_fma_f32 v[22:23], v[130:131], v[110:111], v[22:23] op_sel:[1,0,0] op_sel_hi:[1,1,1]
    s_set_gpr_idx_off
    s_sub_u32 s32, s32, 1
    s_cbranch_scc1 MAIN_DONE
    v_mfma_f32_4x4x4_16b_bf16 v[120:123], v[172:173], v[176:177], 0 cbsz:4 abid:5
    v_lshlrev_b32_sdwa v136, v15, v112 dst_sel:DWORD dst_unused:UNUSED_PAD src0_sel:DWORD src1_sel:WORD_1
    s_waitcnt vmcnt(10)
    v_mfma_f32_4x4x4_16b_bf16 v[104:107], v[146:147], v[92:93], 0 cbsz:4 abid:3
    s_nop 0
    v_mfma_f32_4x4x4_16b_bf16 v[108:111], v[146:147], v[94:95], 0 cbsz:4 abid:3
    v_lshlrev_b32_sdwa v137, v15, v113 dst_sel:DWORD dst_unused:UNUSED_PAD src0_sel:DWORD src1_sel:WORD_1
    ds_read_u16_d16_hi v128, v136 offset:32768
    ds_read_u16_d16_hi v129, v137 offset:32768
    s_waitcnt lgkmcnt(2)
    s_set_gpr_idx_on s62, 0xc
    v_pk_fma_f32 v[16:17], v[132:133], v[96:97], v[16:17] op_sel:[0,0,0] op_sel_hi:[0,1,1]
    v_pk_fma_f32 v[18:19], v[132:133], v[98:99], v[18:19] op_sel:[0,0,0] op_sel_hi:[0,1,1]
    v_pk_fma_f32 v[20:21], v[134:135], v[100:101], v[20:21] op_sel:[0,0,0] op_sel_hi:[0,1,1]
    v_pk_fma_f32 v[22:23], v[134:135], v[102:103], v[22:23] op_sel:[0,0,0] op_sel_hi:[0,1,1]
    s_set_gpr_idx_off
    s_sub_u32 s32, s32, 1
    s_cbranch_scc1 MAIN_DONE
    v_lshlrev_b32_sdwa v138, v15, v116 dst_sel:DWORD dst_unused:UNUSED_PAD src0_sel:DWORD src1_sel:WORD_1
    s_waitcnt vmcnt(9)
    v_mfma_f32_4x4x4_16b_bf16 v[96:99], v[140:141], v[64:65], 0 cbsz:4 abid:4
    s_nop 0
    v_mfma_f32_4x4x4_16b_bf16 v[100:103], v[140:141], v[66:67], 0 cbsz:4 abid:4
    v_lshlrev_b32_sdwa v139, v15, v117 dst_sel:DWORD dst_unused:UNUSED_PAD src0_sel:DWORD src1_sel:WORD_1
    ds_read_u16_d16_hi v130, v138 offset:32768
    ds_read_u16_d16_hi v131, v139 offset:32768
    s_set_gpr_idx_on s63, 0xc
    v_pk_fma_f32 v[16:17], v[132:133], v[104:105], v[16:17] op_sel:[1,0,0] op_sel_hi:[1,1,1]
    v_pk_fma_f32 v[18:19], v[132:133], v[106:107], v[18:19] op_sel:[1,0,0] op_sel_hi:[1,1,1]
    v_pk_fma_f32 v[20:21], v[134:135], v[108:109], v[20:21] op_sel:[1,0,0] op_sel_hi:[1,1,1]
    v_pk_fma_f32 v[22:23], v[134:135], v[110:111], v[22:23] op_sel:[1,0,0] op_sel_hi:[1,1,1]
    s_set_gpr_idx_off
    s_sub_u32 s32, s32, 1
    s_cbranch_scc1 MAIN_DONE
    v_mfma_f32_4x4x4_16b_bf16 v[124:127], v[172:173], v[178:179], 0 cbsz:4 abid:5
    v_lshlrev_b32_sdwa v136, v15, v114 dst_sel:DWORD dst_unused:UNUSED_PAD src0_sel:DWORD src1_sel:WORD_1
    s_waitcnt vmcnt(8)
    v_mfma_f32_4x4x4_16b_bf16 v[104:107], v[142:143], v[68:69], 0 cbsz:4 abid:4
    s_nop 0
    v_mfma_f32_4x4x4_16b_bf16 v[108:111], v[142:143], v[70:71], 0 cbsz:4 abid:4
    v_lshlrev_b32_sdwa v137, v15, v115 dst_sel:DWORD dst_unused:UNUSED_PAD src0_sel:DWORD src1_sel:WORD_1
    ds_read_u16_d16_hi v132, v136 offset:32768
    ds_read_u16_d16_hi v133, v137 offset:32768
    s_waitcnt lgkmcnt(2)
    s_set_gpr_idx_on s48, 0xc
    v_pk_fma_f32 v[16:17], v[128:129], v[96:97], v[16:17] op_sel:[0,0,0] op_sel_hi:[0,1,1]
    v_pk_fma_f32 v[18:19], v[128:129], v[98:99], v[18:19] op_sel:[0,0,0] op_sel_hi:[0,1,1]
    v_pk_fma_f32 v[20:21], v[130:131], v[100:101], v[20:21] op_sel:[0,0,0] op_sel_hi:[0,1,1]
    v_pk_fma_f32 v[22:23], v[130:131], v[102:103], v[22:23] op_sel:[0,0,0] op_sel_hi:[0,1,1]
    s_set_gpr_idx_off
    s_sub_u32 s32, s32, 1
    s_cbranch_scc1 MAIN_DONE
    v_lshlrev_b32_sdwa v138, v15, v118 dst_sel:DWORD dst_unused:UNUSED_PAD src0_sel:DWORD src1_sel:WORD_1
    v_mfma_f32_4x4x4_16b_bf16 v[96:99], v[144:145], v[72:73], 0 cbsz:4 abid:4
    s_nop 0
    v_mfma_f32_4x4x4_16b_bf16 v[100:103], v[144:145], v[74:75], 0 cbsz:4 abid:4
    v_lshlrev_b32_sdwa v139, v15, v119 dst_sel:DWORD dst_unused:UNUSED_PAD src0_sel:DWORD src1_sel:WORD_1
    ds_read_u16_d16_hi v134, v138 offset:32768
    ds_read_u16_d16_hi v135, v139 offset:32768
    s_set_gpr_idx_on s49, 0xc
    v_pk_fma_f32 v[16:17], v[128:129], v[104:105], v[16:17] op_sel:[1,0,0] op_sel_hi:[1,1,1]
    v_pk_fma_f32 v[18:19], v[128:129], v[106:107], v[18:19] op_sel:[1,0,0] op_sel_hi:[1,1,1]
    v_pk_fma_f32 v[20:21], v[130:131], v[108:109], v[20:21] op_sel:[1,0,0] op_sel_hi:[1,1,1]
    v_pk_fma_f32 v[22:23], v[130:131], v[110:111], v[22:23] op_sel:[1,0,0] op_sel_hi:[1,1,1]
    s_set_gpr_idx_off
    s_branch MAIN_DONE
B_16:
    buffer_load_dwordx4 v[188:191], v1, s[16:19], s10 offen offset:0 sc1
    buffer_load_dwordx4 v[192:195], v1, s[16:19], s10 offen offset:1024 sc1
    buffer_load_dwordx4 v[196:199], v1, s[16:19], s10 offen offset:2048 sc1
    buffer_load_dwordx4 v[200:203], v1, s[16:19], s10 offen offset:3072 sc1
    buffer_load_dwordx4 v[204:207], v1, s[16:19], s11 offen offset:0 sc1
    buffer_load_dwordx4 v[208:211], v1, s[16:19], s11 offen offset:1024 sc1
    buffer_load_dwordx4 v[212:215], v1, s[16:19], s11 offen offset:2048 sc1
    buffer_load_dwordx4 v[216:219], v1, s[16:19], s11 offen offset:3072 sc1
    s_sub_u32 s32, s32, 1
    s_cbranch_scc1 MAIN_DONE
    v_mfma_f32_4x4x4_16b_bf16 v[124:127], v[172:173], v[178:179], 0 cbsz:4 abid:5
    v_lshlrev_b32_sdwa v136, v15, v114 dst_sel:DWORD dst_unused:UNUSED_PAD src0_sel:DWORD src1_sel:WORD_1
    s_waitcnt vmcnt(12)
    v_mfma_f32_4x4x4_16b_bf16 v[104:107], v[142:143], v[68:69], 0 cbsz:4 abid:4
    s_nop 0
    v_mfma_f32_4x4x4_16b_bf16 v[108:111], v[142:143], v[70:71], 0 cbsz:4 abid:4
    v_lshlrev_b32_sdwa v137, v15, v115 dst_sel:DWORD dst_unused:UNUSED_PAD src0_sel:DWORD src1_sel:WORD_1
    ds_read_u16_d16_hi v132, v136 offset:32768
    ds_read_u16_d16_hi v133, v137 offset:32768
    s_waitcnt lgkmcnt(2)
    s_set_gpr_idx_on s48, 0xc
    v_pk_fma_f32 v[16:17], v[128:129], v[96:97], v[16:17] op_sel:[0,0,0] op_sel_hi:[0,1,1]
    v_pk_fma_f32 v[18:19], v[128:129], v[98:99], v[18:19] op_sel:[0,0,0] op_sel_hi:[0,1,1]
    v_pk_fma_f32 v[20:21], v[130:131], v[100:101], v[20:21] op_sel:[0,0,0] op_sel_hi:[0,1,1]
    v_pk_fma_f32 v[22:23], v[130:131], v[102:103], v[22:23] op_sel:[0,0,0] op_sel_hi:[0,1,1]
    s_set_gpr_idx_off
    s_sub_u32 s32, s32, 1
    s_cbranch_scc1 MAIN_DONE
    v_lshlrev_b32_sdwa v138, v15, v118 dst_sel:DWORD dst_unused:UNUSED_PAD src0_sel:DWORD src1_sel:WORD_1
    s_waitcnt vmcnt(11)
    v_mfma_f32_4x4x4_16b_bf16 v[96:99], v[144:145], v[72:73], 0 cbsz:4 abid:4
    s_nop 0
    v_mfma_f32_4x4x4_16b_bf16 v[100:103], v[144:145], v[74:75], 0 cbsz:4 abid:4
    v_lshlrev_b32_sdwa v139, v15, v119 dst_sel:DWORD dst_unused:UNUSED_PAD src0_sel:DWORD src1_sel:WORD_1
    ds_read_u16_d16_hi v134, v138 offset:32768
    ds_read_u16_d16_hi v135, v139 offset:32768
    s_set_gpr_idx_on s49, 0xc
    v_pk_fma_f32 v[16:17], v[128:129], v[104:105], v[16:17] op_sel:[1,0,0] op_sel_hi:[1,1,1]
    v_pk_fma_f32 v[18:19], v[128:129], v[106:107], v[18:19] op_sel:[1,0,0] op_sel_hi:[1,1,1]
    v_pk_fma_f32 v[20:21], v[130:131], v[108:109], v[20:21] op_sel:[1,0,0] op_sel_hi:[1,1,1]
    v_pk_fma_f32 v[22:23], v[130:131], v[110:111], v[22:23] op_sel:[1,0,0] op_sel_hi:[1,1,1]
    s_set_gpr_idx_off
    s_sub_u32 s32, s32, 1
    s_cbranch_scc1 MAIN_DONE
    v_mfma_f32_4x4x4_16b_bf16 v[112:115], v[172:173], v[176:177], 0 cbsz:4 abid:6
    v_lshlrev_b32_sdwa v136, v15, v120 dst_sel:DWORD dst_unused:UNUSED_PAD src0_sel:DWORD src1_sel:WORD_1
    s_waitcnt vmcnt(10)
    v_mfma_f32_4x4x4_16b_bf16 v[104:107], v[146:147], v[76:77], 0 cbsz:4 abid:4
    s_nop 0
    v_mfma_f32_4x4x4_16b_bf16 v[108:111], v[146:147], v[78:79], 0 cbsz:4 abid:4
    v_lshlrev_b32_sdwa v137, v15, v121 dst_sel:DWORD dst_unused:UNUSED_PAD src0_sel:DWORD src1_sel:WORD_1
    ds_read_u16_d16_hi v128, v136 offset:32768
    ds_read_u16_d16_hi v129, v137 offset:32768
    s_waitcnt lgkmcnt(2)
    s_set_gpr_idx_on s50, 0xc
    v_pk_fma_f32 v[16:17], v[132:133], v[96:97], v[16:17] op_sel:[0,0,0] op_sel_hi:[0,1,1]
    v_pk_fma_f32 v[18:19], v[132:133], v[98:99], v[18:19] op_sel:[0,0,0] op_sel_hi:[0,1,1]
    v_pk_fma_f32 v[20:21], v[134:135], v[100:101], v[20:21] op_sel:[0,0,0] op_sel_hi:[0,1,1]
    v_pk_fma_f32 v[22:23], v[134:135], v[102:103], v[22:23] op_sel:[0,0,0] op_sel_hi:[0,1,1]
    s_set_gpr_idx_off
    s_sub_u32 s32, s32, 1
    s_cbranch_scc1 MAIN_DONE
    v_lshlrev_b32_sdwa v138, v15, v124 dst_sel:DWORD dst_unused:UNUSED_PAD src0_sel:DWORD src1_sel:WORD_1
    s_waitcnt vmcnt(9)
    v_mfma_f32_4x4x4_16b_bf16 v[96:99], v[140:141], v[80:81], 0 cbsz:4 abid:5
    s_nop 0
    v_mfma_f32_4x4x4_16b_bf16 v[100:103], v[140:141], v[82:83], 0 cbsz:4 abid:5
    v_lshlrev_b32_sdwa v139, v15, v125 dst_sel:DWORD dst_unused:UNUSED_PAD src0_sel:DWORD src1_sel:WORD_1
    ds_read_u16_d16_hi v130, v138 offset:32768
    ds_read_u16_d16_hi v131, v139 offset:32768
    s_set_gpr_idx_on s51, 0xc
    v_pk_fma_f32 v[16:17], v[132:133], v[104:105], v[16:17] op_sel:[1,0,0] op_sel_hi:[1,1,1]
    v_pk_fma_f32 v[18:19], v[132:133], v[106:107], v[18:19] op_sel:[1,0,0] op_sel_hi:[1,1,1]
    v_pk_fma_f32 v[20:21], v[134:135], v[108:109], v[20:21] op_sel:[1,0,0] op_sel_hi:[1,1,1]
    v_pk_fma_f32 v[22:23], v[134:135], v[110:111], v[22:23] op_sel:[1,0,0] op_sel_hi:[1,1,1]
    s_set_gpr_idx_off
    s_sub_u32 s32, s32, 1
    s_cbranch_scc1 MAIN_DONE
    v_mfma_f32_4x4x4_16b_bf16 v[116:119], v[172:173], v[178:179], 0 cbsz:4 abid:6
    v_lshlrev_b32_sdwa v136, v15, v122 dst_sel:DWORD dst_unused:UNUSED_PAD src0_sel:DWORD src1_sel:WORD_1
    s_waitcnt vmcnt(8)
    v_mfma_f32_4x4x4_16b_bf16 v[104:107], v[142:143], v[84:85], 0 cbsz:4 abid:5
    s_nop 0
    v_mfma_f32_4x4x4_16b_bf16 v[108:111], v[142:143], v[86:87], 0 cbsz:4 abid:5
    v_lshlrev_b32_sdwa v137, v15, v123 dst_sel:DWORD dst_unused:UNUSED_PAD src0_sel:DWORD src1_sel:WORD_1
    ds_read_u16_d16_hi v132, v136 offset:32768
    ds_read_u16_d16_hi v133, v137 offset:32768
    s_waitcnt lgkmcnt(2)
    s_set_gpr_idx_on s52, 0xc
    v_pk_fma_f32 v[16:17], v[128:129], v[96:97], v[16:17] op_sel:[0,0,0] op_sel_hi:[0,1,1]
    v_pk_fma_f32 v[18:19], v[128:129], v[98:99], v[18:19] op_sel:[0,0,0] op_sel_hi:[0,1,1]
    v_pk_fma_f32 v[20:21], v[130:131], v[100:101], v[20:21] op_sel:[0,0,0] op_sel_hi:[0,1,1]
    v_pk_fma_f32 v[22:23], v[130:131], v[102:103], v[22:23] op_sel:[0,0,0] op_sel_hi:[0,1,1]
    s_set_gpr_idx_off
    s_sub_u32 s32, s32, 1
    s_cbranch_scc1 MAIN_DONE
    v_lshlrev_b32_sdwa v138, v15, v126 dst_sel:DWORD dst_unused:UNUSED_PAD src0_sel:DWORD src1_sel:WORD_1
    v_mfma_f32_4x4x4_16b_bf16 v[96:99], v[144:145], v[88:89], 0 cbsz:4 abid:5
    s_nop 0
    v_mfma_f32_4x4x4_16b_bf16 v[100:103], v[144:145], v[90:91], 0 cbsz:4 abid:5
    v_lshlrev_b32_sdwa v139, v15, v127 dst_sel:DWORD dst_unused:UNUSED_PAD src0_sel:DWORD src1_sel:WORD_1
    ds_read_u16_d16_hi v134, v138 offset:32768
    ds_read_u16_d16_hi v135, v139 offset:32768
    s_set_gpr_idx_on s53, 0xc
    v_pk_fma_f32 v[16:17], v[128:129], v[104:105], v[16:17] op_sel:[1,0,0] op_sel_hi:[1,1,1]
    v_pk_fma_f32 v[18:19], v[128:129], v[106:107], v[18:19] op_sel:[1,0,0] op_sel_hi:[1,1,1]
    v_pk_fma_f32 v[20:21], v[130:131], v[108:109], v[20:21] op_sel:[1,0,0] op_sel_hi:[1,1,1]
    v_pk_fma_f32 v[22:23], v[130:131], v[110:111], v[22:23] op_sel:[1,0,0] op_sel_hi:[1,1,1]
    s_set_gpr_idx_off
    s_branch MAIN_DONE
B_20:
    buffer_load_dwordx4 v[188:191], v1, s[16:19], s10 offen offset:0 sc1
    buffer_load_dwordx4 v[192:195], v1, s[16:19], s10 offen offset:1024 sc1
    buffer_load_dwordx4 v[196:199], v1, s[16:19], s10 offen offset:2048 sc1
    buffer_load_dwordx4 v[200:203], v1, s[16:19], s10 offen offset:3072 sc1
    buffer_load_dwordx4 v[204:207], v1, s[16:19], s11 offen offset:0 sc1
    buffer_load_dwordx4 v[208:211], v1, s[16:19], s11 offen offset:1024 sc1
    buffer_load_dwordx4 v[212:215], v1, s[16:19], s11 offen offset:2048 sc1
    buffer_load_dwordx4 v[216:219], v1, s[16:19], s11 offen offset:3072 sc1
    s_sub_u32 s32, s32, 1
    s_cbranch_scc1 MAIN_DONE
    v_mfma_f32_4x4x4_16b_bf16 v[116:119], v[172:173], v[178:179], 0 cbsz:4 abid:6
    v_lshlrev_b32_sdwa v136, v15, v122 dst_sel:DWORD dst_unused:UNUSED_PAD src0_sel:DWORD src1_sel:WORD_1
    s_waitcnt vmcnt(12)
    v_mfma_f32_4x4x4_16b_bf16 v[104:107], v[142:143], v[84:85], 0 cbsz:4 abid:5
    s_nop 0
    v_mfma_f32_4x4x4_16b_bf16 v[108:111], v[142:143], v[86:87], 0 cbsz:4 abid:5
    v_lshlrev_b32_sdwa v137, v15, v123 dst_sel:DWORD dst_unused:UNUSED_PAD src0_sel:DWORD src1_sel:WORD_1
    ds_read_u16_d16_hi v132, v136 offset:32768
    ds_read_u16_d16_hi v133, v137 offset:32768
    s_waitcnt lgkmcnt(2)
    s_set_gpr_idx_on s52, 0xc
    v_pk_fma_f32 v[16:17], v[128:129], v[96:97], v[16:17] op_sel:[0,0,0] op_sel_hi:[0,1,1]
    v_pk_fma_f32 v[18:19], v[128:129], v[98:99], v[18:19] op_sel:[0,0,0] op_sel_hi:[0,1,1]
    v_pk_fma_f32 v[20:21], v[130:131], v[100:101], v[20:21] op_sel:[0,0,0] op_sel_hi:[0,1,1]
    v_pk_fma_f32 v[22:23], v[130:131], v[102:103], v[22:23] op_sel:[0,0,0] op_sel_hi:[0,1,1]
    s_set_gpr_idx_off
    s_sub_u32 s32, s32, 1
    s_cbranch_scc1 MAIN_DONE
    v_lshlrev_b32_sdwa v138, v15, v126 dst_sel:DWORD dst_unused:UNUSED_PAD src0_sel:DWORD src1_sel:WORD_1
    s_waitcnt vmcnt(11)
    v_mfma_f32_4x4x4_16b_bf16 v[96:99], v[144:145], v[88:89], 0 cbsz:4 abid:5
    s_nop 0
    v_mfma_f32_4x4x4_16b_bf16 v[100:103], v[144:145], v[90:91], 0 cbsz:4 abid:5
    v_lshlrev_b32_sdwa v139, v15, v127 dst_sel:DWORD dst_unused:UNUSED_PAD src0_sel:DWORD src1_sel:WORD_1
    ds_read_u16_d16_hi v134, v138 offset:32768
    ds_read_u16_d16_hi v135, v139 offset:32768
    s_set_gpr_idx_on s53, 0xc
    v_pk_fma_f32 v[16:17], v[128:129], v[104:105], v[16:17] op_sel:[1,0,0] op_sel_hi:[1,1,1]
    v_pk_fma_f32 v[18:19], v[128:129], v[106:107], v[18:19] op_sel:[1,0,0] op_sel_hi:[1,1,1]
    v_pk_fma_f32 v[20:21], v[130:131], v[108:109], v[20:21] op_sel:[1,0,0] op_sel_hi:[1,1,1]
    v_pk_fma_f32 v[22:23], v[130:131], v[110:111], v[22:23] op_sel:[1,0,0] op_sel_hi:[1,1,1]
    s_set_gpr_idx_off
    s_sub_u32 s32, s32, 1
    s_cbranch_scc1 MAIN_DONE
    v_mfma_f32_4x4x4_16b_bf16 v[120:123], v[172:173], v[176:177], 0 cbsz:4 abid:7
    v_lshlrev_b32_sdwa v136, v15, v112 dst_sel:DWORD dst_unused:UNUSED_PAD src0_sel:DWORD src1_sel:WORD_1
    s_waitcnt vmcnt(10)
    v_mfma_f32_4x4x4_16b_bf16 v[104:107], v[146:147], v[92:93], 0 cbsz:4 abid:5
    s_nop 0
    v_mfma_f32_4x4x4_16b_bf16 v[108:111], v[146:147], v[94:95], 0 cbsz:4 abid:5
    v_lshlrev_b32_sdwa v137, v15, v113 dst_sel:DWORD dst_unused:UNUSED_PAD src0_sel:DWORD src1_sel:WORD_1
    ds_read_u16_d16_hi v128, v136 offset:32768
    ds_read_u16_d16_hi v129, v137 offset:32768
    s_waitcnt lgkmcnt(2)
    s_set_gpr_idx_on s54, 0xc
    v_pk_fma_f32 v[16:17], v[132:133], v[96:97], v[16:17] op_sel:[0,0,0] op_sel_hi:[0,1,1]
    v_pk_fma_f32 v[18:19], v[132:133], v[98:99], v[18:19] op_sel:[0,0,0] op_sel_hi:[0,1,1]
    v_pk_fma_f32 v[20:21], v[134:135], v[100:101], v[20:21] op_sel:[0,0,0] op_sel_hi:[0,1,1]
    v_pk_fma_f32 v[22:23], v[134:135], v[102:103], v[22:23] op_sel:[0,0,0] op_sel_hi:[0,1,1]
    s_set_gpr_idx_off
    s_sub_u32 s32, s32, 1
    s_cbranch_scc1 MAIN_DONE
    v_lshlrev_b32_sdwa v138, v15, v116 dst_sel:DWORD dst_unused:UNUSED_PAD src0_sel:DWORD src1_sel:WORD_1
    s_waitcnt vmcnt(9)
    v_mfma_f32_4x4x4_16b_bf16 v[96:99], v[140:141], v[64:65], 0 cbsz:4 abid:6
    s_nop 0
    v_mfma_f32_4x4x4_16b_bf16 v[100:103], v[140:141], v[66:67], 0 cbsz:4 abid:6
    v_lshlrev_b32_sdwa v139, v15, v117 dst_sel:DWORD dst_unused:UNUSED_PAD src0_sel:DWORD src1_sel:WORD_1
    ds_read_u16_d16_hi v130, v138 offset:32768
    ds_read_u16_d16_hi v131, v139 offset:32768
    s_set_gpr_idx_on s55, 0xc
    v_pk_fma_f32 v[16:17], v[132:133], v[104:105], v[16:17] op_sel:[1,0,0] op_sel_hi:[1,1,1]
    v_pk_fma_f32 v[18:19], v[132:133], v[106:107], v[18:19] op_sel:[1,0,0] op_sel_hi:[1,1,1]
    v_pk_fma_f32 v[20:21], v[134:135], v[108:109], v[20:21] op_sel:[1,0,0] op_sel_hi:[1,1,1]
    v_pk_fma_f32 v[22:23], v[134:135], v[110:111], v[22:23] op_sel:[1,0,0] op_sel_hi:[1,1,1]
    s_set_gpr_idx_off
    s_sub_u32 s32, s32, 1
    s_cbranch_scc1 MAIN_DONE
    v_mfma_f32_4x4x4_16b_bf16 v[124:127], v[172:173], v[178:179], 0 cbsz:4 abid:7
    v_lshlrev_b32_sdwa v136, v15, v114 dst_sel:DWORD dst_unused:UNUSED_PAD src0_sel:DWORD src1_sel:WORD_1
    s_waitcnt vmcnt(8)
    v_mfma_f32_4x4x4_16b_bf16 v[104:107], v[142:143], v[68:69], 0 cbsz:4 abid:6
    s_nop 0
    v_mfma_f32_4x4x4_16b_bf16 v[108:111], v[142:143], v[70:71], 0 cbsz:4 abid:6
    v_lshlrev_b32_sdwa v137, v15, v115 dst_sel:DWORD dst_unused:UNUSED_PAD src0_sel:DWORD src1_sel:WORD_1
    ds_read_u16_d16_hi v132, v136 offset:32768
    ds_read_u16_d16_hi v133, v137 offset:32768
    s_waitcnt lgkmcnt(2)
    s_set_gpr_idx_on s56, 0xc
    v_pk_fma_f32 v[16:17], v[128:129], v[96:97], v[16:17] op_sel:[0,0,0] op_sel_hi:[0,1,1]
    v_pk_fma_f32 v[18:19], v[128:129], v[98:99], v[18:19] op_sel:[0,0,0] op_sel_hi:[0,1,1]
    v_pk_fma_f32 v[20:21], v[130:131], v[100:101], v[20:21] op_sel:[0,0,0] op_sel_hi:[0,1,1]
    v_pk_fma_f32 v[22:23], v[130:131], v[102:103], v[22:23] op_sel:[0,0,0] op_sel_hi:[0,1,1]
    s_set_gpr_idx_off
    s_sub_u32 s32, s32, 1
    s_cbranch_scc1 MAIN_DONE
    v_lshlrev_b32_sdwa v138, v15, v118 dst_sel:DWORD dst_unused:UNUSED_PAD src0_sel:DWORD src1_sel:WORD_1
    v_mfma_f32_4x4x4_16b_bf16 v[96:99], v[144:145], v[72:73], 0 cbsz:4 abid:6
    s_nop 0
    v_mfma_f32_4x4x4_16b_bf16 v[100:103], v[144:145], v[74:75], 0 cbsz:4 abid:6
    v_lshlrev_b32_sdwa v139, v15, v119 dst_sel:DWORD dst_unused:UNUSED_PAD src0_sel:DWORD src1_sel:WORD_1
    ds_read_u16_d16_hi v134, v138 offset:32768
    ds_read_u16_d16_hi v135, v139 offset:32768
    s_set_gpr_idx_on s57, 0xc
    v_pk_fma_f32 v[16:17], v[128:129], v[104:105], v[16:17] op_sel:[1,0,0] op_sel_hi:[1,1,1]
    v_pk_fma_f32 v[18:19], v[128:129], v[106:107], v[18:19] op_sel:[1,0,0] op_sel_hi:[1,1,1]
    v_pk_fma_f32 v[20:21], v[130:131], v[108:109], v[20:21] op_sel:[1,0,0] op_sel_hi:[1,1,1]
    v_pk_fma_f32 v[22:23], v[130:131], v[110:111], v[22:23] op_sel:[1,0,0] op_sel_hi:[1,1,1]
    s_set_gpr_idx_off
    s_branch MAIN_DONE
B_24:
    buffer_load_dwordx4 v[188:191], v1, s[16:19], s10 offen offset:0 sc1
    buffer_load_dwordx4 v[192:195], v1, s[16:19], s10 offen offset:1024 sc1
    buffer_load_dwordx4 v[196:199], v1, s[16:19], s10 offen offset:2048 sc1
    buffer_load_dwordx4 v[200:203], v1, s[16:19], s10 offen offset:3072 sc1
    buffer_load_dwordx4 v[204:207], v1, s[16:19], s11 offen offset:0 sc1
    buffer_load_dwordx4 v[208:211], v1, s[16:19], s11 offen offset:1024 sc1
    buffer_load_dwordx4 v[212:215], v1, s[16:19], s11 offen offset:2048 sc1
    buffer_load_dwordx4 v[216:219], v1, s[16:19], s11 offen offset:3072 sc1
    s_sub_u32 s32, s32, 1
    s_cbranch_scc1 MAIN_DONE
    v_mfma_f32_4x4x4_16b_bf16 v[124:127], v[172:173], v[178:179], 0 cbsz:4 abid:7
    v_lshlrev_b32_sdwa v136, v15, v114 dst_sel:DWORD dst_unused:UNUSED_PAD src0_sel:DWORD src1_sel:WORD_1
    s_waitcnt vmcnt(12)
    v_mfma_f32_4x4x4_16b_bf16 v[104:107], v[142:143], v[68:69], 0 cbsz:4 abid:6
    s_nop 0
    v_mfma_f32_4x4x4_16b_bf16 v[108:111], v[142:143], v[70:71], 0 cbsz:4 abid:6
    v_lshlrev_b32_sdwa v137, v15, v115 dst_sel:DWORD dst_unused:UNUSED_PAD src0_sel:DWORD src1_sel:WORD_1
    ds_read_u16_d16_hi v132, v136 offset:32768
    ds_read_u16_d16_hi v133, v137 offset:32768
    s_waitcnt lgkmcnt(2)
    s_set_gpr_idx_on s56, 0xc
    v_pk_fma_f32 v[16:17], v[128:129], v[96:97], v[16:17] op_sel:[0,0,0] op_sel_hi:[0,1,1]
    v_pk_fma_f32 v[18:19], v[128:129], v[98:99], v[18:19] op_sel:[0,0,0] op_sel_hi:[0,1,1]
    v_pk_fma_f32 v[20:21], v[130:131], v[100:101], v[20:21] op_sel:[0,0,0] op_sel_hi:[0,1,1]
    v_pk_fma_f32 v[22:23], v[130:131], v[102:103], v[22:23] op_sel:[0,0,0] op_sel_hi:[0,1,1]
    s_set_gpr_idx_off
    s_sub_u32 s32, s32, 1
    s_cbranch_scc1 MAIN_DONE
    v_lshlrev_b32_sdwa v138, v15, v118 dst_sel:DWORD dst_unused:UNUSED_PAD src0_sel:DWORD src1_sel:WORD_1
    s_waitcnt vmcnt(11)
    v_mfma_f32_4x4x4_16b_bf16 v[96:99], v[144:145], v[72:73], 0 cbsz:4 abid:6
    s_nop 0
    v_mfma_f32_4x4x4_16b_bf16 v[100:103], v[144:145], v[74:75], 0 cbsz:4 abid:6
    v_lshlrev_b32_sdwa v139, v15, v119 dst_sel:DWORD dst_unused:UNUSED_PAD src0_sel:DWORD src1_sel:WORD_1
    ds_read_u16_d16_hi v134, v138 offset:32768
    ds_read_u16_d16_hi v135, v139 offset:32768
    s_set_gpr_idx_on s57, 0xc
    v_pk_fma_f32 v[16:17], v[128:129], v[104:105], v[16:17] op_sel:[1,0,0] op_sel_hi:[1,1,1]
    v_pk_fma_f32 v[18:19], v[128:129], v[106:107], v[18:19] op_sel:[1,0,0] op_sel_hi:[1,1,1]
    v_pk_fma_f32 v[20:21], v[130:131], v[108:109], v[20:21] op_sel:[1,0,0] op_sel_hi:[1,1,1]
    v_pk_fma_f32 v[22:23], v[130:131], v[110:111], v[22:23] op_sel:[1,0,0] op_sel_hi:[1,1,1]
    s_set_gpr_idx_off
    s_sub_u32 s32, s32, 1
    s_cbranch_scc1 MAIN_DONE
    v_mfma_f32_4x4x4_16b_bf16 v[112:115], v[172:173], v[176:177], 0 cbsz:4 abid:8
    v_lshlrev_b32_sdwa v136, v15, v120 dst_sel:DWORD dst_unused:UNUSED_PAD src0_sel:DWORD src1_sel:WORD_1
    s_waitcnt vmcnt(10)
    v_mfma_f32_4x4x4_16b_bf16 v[104:107], v[146:147], v[76:77], 0 cbsz:4 abid:6
    s_nop 0
    v_mfma_f32_4x4x4_16b_bf16 v[108:111], v[146:147], v[78:79], 0 cbsz:4 abid:6
    v_lshlrev_b32_sdwa v137, v15, v121 dst_sel:DWORD dst_unused:UNUSED_PAD src0_sel:DWORD src1_sel:WORD_1
    ds_read_u16_d16_hi v128, v136 offset:32768
    ds_read_u16_d16_hi v129, v137 offset:32768
    s_waitcnt lgkmcnt(2)
    s_set_gpr_idx_on s58, 0xc
    v_pk_fma_f32 v[16:17], v[132:133], v[96:97], v[16:17] op_sel:[0,0,0] op_sel_hi:[0,1,1]
    v_pk_fma_f32 v[18:19], v[132:133], v[98:99], v[18:19] op_sel:[0,0,0] op_sel_hi:[0,1,1]
    v_pk_fma_f32 v[20:21], v[134:135], v[100:101], v[20:21] op_sel:[0,0,0] op_sel_hi:[0,1,1]
    v_pk_fma_f32 v[22:23], v[134:135], v[102:103], v[22:23] op_sel:[0,0,0] op_sel_hi:[0,1,1]
    s_set_gpr_idx_off
    s_sub_u32 s32, s32, 1
    s_cbranch_scc1 MAIN_DONE
    v_lshlrev_b32_sdwa v138, v15, v124 dst_sel:DWORD dst_unused:UNUSED_PAD src0_sel:DWORD src1_sel:WORD_1
    s_waitcnt vmcnt(9)
    v_mfma_f32_4x4x4_16b_bf16 v[96:99], v[140:141], v[80:81], 0 cbsz:4 abid:7
    s_nop 0
    v_mfma_f32_4x4x4_16b_bf16 v[100:103], v[140:141], v[82:83], 0 cbsz:4 abid:7
    v_lshlrev_b32_sdwa v139, v15, v125 dst_sel:DWORD dst_unused:UNUSED_PAD src0_sel:DWORD src1_sel:WORD_1
    ds_read_u16_d16_hi v130, v138 offset:32768
    ds_read_u16_d16_hi v131, v139 offset:32768
    s_set_gpr_idx_on s59, 0xc
    v_pk_fma_f32 v[16:17], v[132:133], v[104:105], v[16:17] op_sel:[1,0,0] op_sel_hi:[1,1,1]
    v_pk_fma_f32 v[18:19], v[132:133], v[106:107], v[18:19] op_sel:[1,0,0] op_sel_hi:[1,1,1]
    v_pk_fma_f32 v[20:21], v[134:135], v[108:109], v[20:21] op_sel:[1,0,0] op_sel_hi:[1,1,1]
    v_pk_fma_f32 v[22:23], v[134:135], v[110:111], v[22:23] op_sel:[1,0,0] op_sel_hi:[1,1,1]
    s_set_gpr_idx_off
    s_sub_u32 s32, s32, 1
    s_cbranch_scc1 MAIN_DONE
    v_mfma_f32_4x4x4_16b_bf16 v[116:119], v[172:173], v[178:179], 0 cbsz:4 abid:8
    v_lshlrev_b32_sdwa v136, v15, v122 dst_sel:DWORD dst_unused:UNUSED_PAD src0_sel:DWORD src1_sel:WORD_1
    s_waitcnt vmcnt(8)
    v_mfma_f32_4x4x4_16b_bf16 v[104:107], v[142:143], v[84:85], 0 cbsz:4 abid:7
    s_nop 0
    v_mfma_f32_4x4x4_16b_bf16 v[108:111], v[142:143], v[86:87], 0 cbsz:4 abid:7
    v_lshlrev_b32_sdwa v137, v15, v123 dst_sel:DWORD dst_unused:UNUSED_PAD src0_sel:DWORD src1_sel:WORD_1
    ds_read_u16_d16_hi v132, v136 offset:32768
    ds_read_u16_d16_hi v133, v137 offset:32768
    s_waitcnt lgkmcnt(2)
    s_set_gpr_idx_on s60, 0xc
    v_pk_fma_f32 v[16:17], v[128:129], v[96:97], v[16:17] op_sel:[0,0,0] op_sel_hi:[0,1,1]
    v_pk_fma_f32 v[18:19], v[128:129], v[98:99], v[18:19] op_sel:[0,0,0] op_sel_hi:[0,1,1]
    v_pk_fma_f32 v[20:21], v[130:131], v[100:101], v[20:21] op_sel:[0,0,0] op_sel_hi:[0,1,1]
    v_pk_fma_f32 v[22:23], v[130:131], v[102:103], v[22:23] op_sel:[0,0,0] op_sel_hi:[0,1,1]
    s_set_gpr_idx_off
    s_sub_u32 s32, s32, 1
    s_cbranch_scc1 MAIN_DONE
    v_lshlrev_b32_sdwa v138, v15, v126 dst_sel:DWORD dst_unused:UNUSED_PAD src0_sel:DWORD src1_sel:WORD_1
    v_mfma_f32_4x4x4_16b_bf16 v[96:99], v[144:145], v[88:89], 0 cbsz:4 abid:7
    s_nop 0
    v_mfma_f32_4x4x4_16b_bf16 v[100:103], v[144:145], v[90:91], 0 cbsz:4 abid:7
    v_lshlrev_b32_sdwa v139, v15, v127 dst_sel:DWORD dst_unused:UNUSED_PAD src0_sel:DWORD src1_sel:WORD_1
    ds_read_u16_d16_hi v134, v138 offset:32768
    ds_read_u16_d16_hi v135, v139 offset:32768
    s_set_gpr_idx_on s61, 0xc
    v_pk_fma_f32 v[16:17], v[128:129], v[104:105], v[16:17] op_sel:[1,0,0] op_sel_hi:[1,1,1]
    v_pk_fma_f32 v[18:19], v[128:129], v[106:107], v[18:19] op_sel:[1,0,0] op_sel_hi:[1,1,1]
    v_pk_fma_f32 v[20:21], v[130:131], v[108:109], v[20:21] op_sel:[1,0,0] op_sel_hi:[1,1,1]
    v_pk_fma_f32 v[22:23], v[130:131], v[110:111], v[22:23] op_sel:[1,0,0] op_sel_hi:[1,1,1]
    s_set_gpr_idx_off
    s_branch MAIN_DONE
B_28:
    buffer_load_dwordx4 v[188:191], v1, s[16:19], s10 offen offset:0 sc1
    buffer_load_dwordx4 v[192:195], v1, s[16:19], s10 offen offset:1024 sc1
    buffer_load_dwordx4 v[196:199], v1, s[16:19], s10 offen offset:2048 sc1
    buffer_load_dwordx4 v[200:203], v1, s[16:19], s10 offen offset:3072 sc1
    buffer_load_dwordx4 v[204:207], v1, s[16:19], s11 offen offset:0 sc1
    buffer_load_dwordx4 v[208:211], v1, s[16:19], s11 offen offset:1024 sc1
    buffer_load_dwordx4 v[212:215], v1, s[16:19], s11 offen offset:2048 sc1
    buffer_load_dwordx4 v[216:219], v1, s[16:19], s11 offen offset:3072 sc1
    s_sub_u32 s32, s32, 1
    s_cbranch_scc1 MAIN_DONE
    v_mfma_f32_4x4x4_16b_bf16 v[116:119], v[172:173], v[178:179], 0 cbsz:4 abid:8
    v_lshlrev_b32_sdwa v136, v15, v122 dst_sel:DWORD dst_unused:UNUSED_PAD src0_sel:DWORD src1_sel:WORD_1
    s_waitcnt vmcnt(12)
    v_mfma_f32_4x4x4_16b_bf16 v[104:107], v[142:143], v[84:85], 0 cbsz:4 abid:7
    s_nop 0
    v_mfma_f32_4x4x4_16b_bf16 v[108:111], v[142:143], v[86:87], 0 cbsz:4 abid:7
    v_lshlrev_b32_sdwa v137, v15, v123 dst_sel:DWORD dst_unused:UNUSED_PAD src0_sel:DWORD src1_sel:WORD_1
    ds_read_u16_d16_hi v132, v136 offset:32768
    ds_read_u16_d16_hi v133, v137 offset:32768
    s_waitcnt lgkmcnt(2)
    s_set_gpr_idx_on s60, 0xc
    v_pk_fma_f32 v[16:17], v[128:129], v[96:97], v[16:17] op_sel:[0,0,0] op_sel_hi:[0,1,1]
    v_pk_fma_f32 v[18:19], v[128:129], v[98:99], v[18:19] op_sel:[0,0,0] op_sel_hi:[0,1,1]
    v_pk_fma_f32 v[20:21], v[130:131], v[100:101], v[20:21] op_sel:[0,0,0] op_sel_hi:[0,1,1]
    v_pk_fma_f32 v[22:23], v[130:131], v[102:103], v[22:23] op_sel:[0,0,0] op_sel_hi:[0,1,1]
    s_set_gpr_idx_off
    s_sub_u32 s32, s32, 1
    s_cbranch_scc1 MAIN_DONE
    v_lshlrev_b32_sdwa v138, v15, v126 dst_sel:DWORD dst_unused:UNUSED_PAD src0_sel:DWORD src1_sel:WORD_1
    s_waitcnt vmcnt(11)
    v_mfma_f32_4x4x4_16b_bf16 v[96:99], v[144:145], v[88:89], 0 cbsz:4 abid:7
    s_nop 0
    v_mfma_f32_4x4x4_16b_bf16 v[100:103], v[144:145], v[90:91], 0 cbsz:4 abid:7
    v_lshlrev_b32_sdwa v139, v15, v127 dst_sel:DWORD dst_unused:UNUSED_PAD src0_sel:DWORD src1_sel:WORD_1
    ds_read_u16_d16_hi v134, v138 offset:32768
    ds_read_u16_d16_hi v135, v139 offset:32768
    s_set_gpr_idx_on s61, 0xc
    v_pk_fma_f32 v[16:17], v[128:129], v[104:105], v[16:17] op_sel:[1,0,0] op_sel_hi:[1,1,1]
    v_pk_fma_f32 v[18:19], v[128:129], v[106:107], v[18:19] op_sel:[1,0,0] op_sel_hi:[1,1,1]
    v_pk_fma_f32 v[20:21], v[130:131], v[108:109], v[20:21] op_sel:[1,0,0] op_sel_hi:[1,1,1]
    v_pk_fma_f32 v[22:23], v[130:131], v[110:111], v[22:23] op_sel:[1,0,0] op_sel_hi:[1,1,1]
    s_set_gpr_idx_off
    s_sub_u32 s32, s32, 1
    s_cbranch_scc1 MAIN_DONE
    v_mfma_f32_4x4x4_16b_bf16 v[120:123], v[172:173], v[176:177], 0 cbsz:4 abid:9
    v_lshlrev_b32_sdwa v136, v15, v112 dst_sel:DWORD dst_unused:UNUSED_PAD src0_sel:DWORD src1_sel:WORD_1
    s_waitcnt vmcnt(10)
    v_mfma_f32_4x4x4_16b_bf16 v[104:107], v[146:147], v[92:93], 0 cbsz:4 abid:7
    s_nop 0
    v_mfma_f32_4x4x4_16b_bf16 v[108:111], v[146:147], v[94:95], 0 cbsz:4 abid:7
    v_lshlrev_b32_sdwa v137, v15, v113 dst_sel:DWORD dst_unused:UNUSED_PAD src0_sel:DWORD src1_sel:WORD_1
    ds_read_u16_d16_hi v128, v136 offset:32768
    ds_read_u16_d16_hi v129, v137 offset:32768
    s_waitcnt lgkmcnt(2)
    s_set_gpr_idx_on s62, 0xc
    v_pk_fma_f32 v[16:17], v[132:133], v[96:97], v[16:17] op_sel:[0,0,0] op_sel_hi:[0,1,1]
    v_pk_fma_f32 v[18:19], v[132:133], v[98:99], v[18:19] op_sel:[0,0,0] op_sel_hi:[0,1,1]
    v_pk_fma_f32 v[20:21], v[134:135], v[100:101], v[20:21] op_sel:[0,0,0] op_sel_hi:[0,1,1]
    v_pk_fma_f32 v[22:23], v[134:135], v[102:103], v[22:23] op_sel:[0,0,0] op_sel_hi:[0,1,1]
    s_set_gpr_idx_off
    s_sub_u32 s32, s32, 1
    s_cbranch_scc1 MAIN_DONE
    v_lshlrev_b32_sdwa v138, v15, v116 dst_sel:DWORD dst_unused:UNUSED_PAD src0_sel:DWORD src1_sel:WORD_1
    s_waitcnt vmcnt(9)
    v_mfma_f32_4x4x4_16b_bf16 v[96:99], v[140:141], v[64:65], 0 cbsz:4 abid:8
    s_nop 0
    v_mfma_f32_4x4x4_16b_bf16 v[100:103], v[140:141], v[66:67], 0 cbsz:4 abid:8
    v_lshlrev_b32_sdwa v139, v15, v117 dst_sel:DWORD dst_unused:UNUSED_PAD src0_sel:DWORD src1_sel:WORD_1
    ds_read_u16_d16_hi v130, v138 offset:32768
    ds_read_u16_d16_hi v131, v139 offset:32768
    s_set_gpr_idx_on s63, 0xc
    v_pk_fma_f32 v[16:17], v[132:133], v[104:105], v[16:17] op_sel:[1,0,0] op_sel_hi:[1,1,1]
    v_pk_fma_f32 v[18:19], v[132:133], v[106:107], v[18:19] op_sel:[1,0,0] op_sel_hi:[1,1,1]
    v_pk_fma_f32 v[20:21], v[134:135], v[108:109], v[20:21] op_sel:[1,0,0] op_sel_hi:[1,1,1]
    v_pk_fma_f32 v[22:23], v[134:135], v[110:111], v[22:23] op_sel:[1,0,0] op_sel_hi:[1,1,1]
    s_set_gpr_idx_off
    s_sub_u32 s32, s32, 1
    s_cbranch_scc1 MAIN_DONE
    v_mfma_f32_4x4x4_16b_bf16 v[124:127], v[172:173], v[178:179], 0 cbsz:4 abid:9
    v_lshlrev_b32_sdwa v136, v15, v114 dst_sel:DWORD dst_unused:UNUSED_PAD src0_sel:DWORD src1_sel:WORD_1
    s_waitcnt vmcnt(8)
    v_mfma_f32_4x4x4_16b_bf16 v[104:107], v[142:143], v[68:69], 0 cbsz:4 abid:8
    s_nop 0
    v_mfma_f32_4x4x4_16b_bf16 v[108:111], v[142:143], v[70:71], 0 cbsz:4 abid:8
    v_lshlrev_b32_sdwa v137, v15, v115 dst_sel:DWORD dst_unused:UNUSED_PAD src0_sel:DWORD src1_sel:WORD_1
    ds_read_u16_d16_hi v132, v136 offset:32768
    ds_read_u16_d16_hi v133, v137 offset:32768
    s_waitcnt lgkmcnt(2)
    s_set_gpr_idx_on s48, 0xc
    v_pk_fma_f32 v[16:17], v[128:129], v[96:97], v[16:17] op_sel:[0,0,0] op_sel_hi:[0,1,1]
    v_pk_fma_f32 v[18:19], v[128:129], v[98:99], v[18:19] op_sel:[0,0,0] op_sel_hi:[0,1,1]
    v_pk_fma_f32 v[20:21], v[130:131], v[100:101], v[20:21] op_sel:[0,0,0] op_sel_hi:[0,1,1]
    v_pk_fma_f32 v[22:23], v[130:131], v[102:103], v[22:23] op_sel:[0,0,0] op_sel_hi:[0,1,1]
    s_set_gpr_idx_off
    s_sub_u32 s32, s32, 1
    s_cbranch_scc1 MAIN_DONE
    v_lshlrev_b32_sdwa v138, v15, v118 dst_sel:DWORD dst_unused:UNUSED_PAD src0_sel:DWORD src1_sel:WORD_1
    v_mfma_f32_4x4x4_16b_bf16 v[96:99], v[144:145], v[72:73], 0 cbsz:4 abid:8
    s_nop 0
    v_mfma_f32_4x4x4_16b_bf16 v[100:103], v[144:145], v[74:75], 0 cbsz:4 abid:8
    v_lshlrev_b32_sdwa v139, v15, v119 dst_sel:DWORD dst_unused:UNUSED_PAD src0_sel:DWORD src1_sel:WORD_1
    ds_read_u16_d16_hi v134, v138 offset:32768
    ds_read_u16_d16_hi v135, v139 offset:32768
    s_set_gpr_idx_on s49, 0xc
    v_pk_fma_f32 v[16:17], v[128:129], v[104:105], v[16:17] op_sel:[1,0,0] op_sel_hi:[1,1,1]
    v_pk_fma_f32 v[18:19], v[128:129], v[106:107], v[18:19] op_sel:[1,0,0] op_sel_hi:[1,1,1]
    v_pk_fma_f32 v[20:21], v[130:131], v[108:109], v[20:21] op_sel:[1,0,0] op_sel_hi:[1,1,1]
    v_pk_fma_f32 v[22:23], v[130:131], v[110:111], v[22:23] op_sel:[1,0,0] op_sel_hi:[1,1,1]
    s_set_gpr_idx_off
    s_branch MAIN_DONE
B_32:
    buffer_load_dwordx4 v[188:191], v1, s[16:19], s10 offen offset:0 sc1
    buffer_load_dwordx4 v[192:195], v1, s[16:19], s10 offen offset:1024 sc1
    buffer_load_dwordx4 v[196:199], v1, s[16:19], s10 offen offset:2048 sc1
    buffer_load_dwordx4 v[200:203], v1, s[16:19], s10 offen offset:3072 sc1
    buffer_load_dwordx4 v[204:207], v1, s[16:19], s11 offen offset:0 sc1
    buffer_load_dwordx4 v[208:211], v1, s[16:19], s11 offen offset:1024 sc1
    buffer_load_dwordx4 v[212:215], v1, s[16:19], s11 offen offset:2048 sc1
    buffer_load_dwordx4 v[216:219], v1, s[16:19], s11 offen offset:3072 sc1
    s_sub_u32 s32, s32, 1
    s_cbranch_scc1 MAIN_DONE
    v_mfma_f32_4x4x4_16b_bf16 v[124:127], v[172:173], v[178:179], 0 cbsz:4 abid:9
    v_lshlrev_b32_sdwa v136, v15, v114 dst_sel:DWORD dst_unused:UNUSED_PAD src0_sel:DWORD src1_sel:WORD_1
    s_waitcnt vmcnt(12)
    v_mfma_f32_4x4x4_16b_bf16 v[104:107], v[142:143], v[68:69], 0 cbsz:4 abid:8
    s_nop 0
    v_mfma_f32_4x4x4_16b_bf16 v[108:111], v[142:143], v[70:71], 0 cbsz:4 abid:8
    v_lshlrev_b32_sdwa v137, v15, v115 dst_sel:DWORD dst_unused:UNUSED_PAD src0_sel:DWORD src1_sel:WORD_1
    ds_read_u16_d16_hi v132, v136 offset:32768
    ds_read_u16_d16_hi v133, v137 offset:32768
    s_waitcnt lgkmcnt(2)
    s_set_gpr_idx_on s48, 0xc
    v_pk_fma_f32 v[16:17], v[128:129], v[96:97], v[16:17] op_sel:[0,0,0] op_sel_hi:[0,1,1]
    v_pk_fma_f32 v[18:19], v[128:129], v[98:99], v[18:19] op_sel:[0,0,0] op_sel_hi:[0,1,1]
    v_pk_fma_f32 v[20:21], v[130:131], v[100:101], v[20:21] op_sel:[0,0,0] op_sel_hi:[0,1,1]
    v_pk_fma_f32 v[22:23], v[130:131], v[102:103], v[22:23] op_sel:[0,0,0] op_sel_hi:[0,1,1]
    s_set_gpr_idx_off
    s_sub_u32 s32, s32, 1
    s_cbranch_scc1 MAIN_DONE
    v_lshlrev_b32_sdwa v138, v15, v118 dst_sel:DWORD dst_unused:UNUSED_PAD src0_sel:DWORD src1_sel:WORD_1
    s_waitcnt vmcnt(11)
    v_mfma_f32_4x4x4_16b_bf16 v[96:99], v[144:145], v[72:73], 0 cbsz:4 abid:8
    s_nop 0
    v_mfma_f32_4x4x4_16b_bf16 v[100:103], v[144:145], v[74:75], 0 cbsz:4 abid:8
    v_lshlrev_b32_sdwa v139, v15, v119 dst_sel:DWORD dst_unused:UNUSED_PAD src0_sel:DWORD src1_sel:WORD_1
    ds_read_u16_d16_hi v134, v138 offset:32768
    ds_read_u16_d16_hi v135, v139 offset:32768
    s_set_gpr_idx_on s49, 0xc
    v_pk_fma_f32 v[16:17], v[128:129], v[104:105], v[16:17] op_sel:[1,0,0] op_sel_hi:[1,1,1]
    v_pk_fma_f32 v[18:19], v[128:129], v[106:107], v[18:19] op_sel:[1,0,0] op_sel_hi:[1,1,1]
    v_pk_fma_f32 v[20:21], v[130:131], v[108:109], v[20:21] op_sel:[1,0,0] op_sel_hi:[1,1,1]
    v_pk_fma_f32 v[22:23], v[130:131], v[110:111], v[22:23] op_sel:[1,0,0] op_sel_hi:[1,1,1]
    s_set_gpr_idx_off
    s_sub_u32 s32, s32, 1
    s_cbranch_scc1 MAIN_DONE
    v_mfma_f32_4x4x4_16b_bf16 v[112:115], v[172:173], v[176:177], 0 cbsz:4 abid:10
    v_lshlrev_b32_sdwa v136, v15, v120 dst_sel:DWORD dst_unused:UNUSED_PAD src0_sel:DWORD src1_sel:WORD_1
    s_waitcnt vmcnt(10)
    v_mfma_f32_4x4x4_16b_bf16 v[104:107], v[146:147], v[76:77], 0 cbsz:4 abid:8
    s_nop 0
    v_mfma_f32_4x4x4_16b_bf16 v[108:111], v[146:147], v[78:79], 0 cbsz:4 abid:8
    v_lshlrev_b32_sdwa v137, v15, v121 dst_sel:DWORD dst_unused:UNUSED_PAD src0_sel:DWORD src1_sel:WORD_1
    ds_read_u16_d16_hi v128, v136 offset:32768
    ds_read_u16_d16_hi v129, v137 offset:32768
    s_waitcnt lgkmcnt(2)
    s_set_gpr_idx_on s50, 0xc
    v_pk_fma_f32 v[16:17], v[132:133], v[96:97], v[16:17] op_sel:[0,0,0] op_sel_hi:[0,1,1]
    v_pk_fma_f32 v[18:19], v[132:133], v[98:99], v[18:19] op_sel:[0,0,0] op_sel_hi:[0,1,1]
    v_pk_fma_f32 v[20:21], v[134:135], v[100:101], v[20:21] op_sel:[0,0,0] op_sel_hi:[0,1,1]
    v_pk_fma_f32 v[22:23], v[134:135], v[102:103], v[22:23] op_sel:[0,0,0] op_sel_hi:[0,1,1]
    s_set_gpr_idx_off
    s_sub_u32 s32, s32, 1
    s_cbranch_scc1 MAIN_DONE
    v_lshlrev_b32_sdwa v138, v15, v124 dst_sel:DWORD dst_unused:UNUSED_PAD src0_sel:DWORD src1_sel:WORD_1
    s_waitcnt vmcnt(9)
    v_mfma_f32_4x4x4_16b_bf16 v[96:99], v[140:141], v[80:81], 0 cbsz:4 abid:9
    s_nop 0
    v_mfma_f32_4x4x4_16b_bf16 v[100:103], v[140:141], v[82:83], 0 cbsz:4 abid:9
    v_lshlrev_b32_sdwa v139, v15, v125 dst_sel:DWORD dst_unused:UNUSED_PAD src0_sel:DWORD src1_sel:WORD_1
    ds_read_u16_d16_hi v130, v138 offset:32768
    ds_read_u16_d16_hi v131, v139 offset:32768
    s_set_gpr_idx_on s51, 0xc
    v_pk_fma_f32 v[16:17], v[132:133], v[104:105], v[16:17] op_sel:[1,0,0] op_sel_hi:[1,1,1]
    v_pk_fma_f32 v[18:19], v[132:133], v[106:107], v[18:19] op_sel:[1,0,0] op_sel_hi:[1,1,1]
    v_pk_fma_f32 v[20:21], v[134:135], v[108:109], v[20:21] op_sel:[1,0,0] op_sel_hi:[1,1,1]
    v_pk_fma_f32 v[22:23], v[134:135], v[110:111], v[22:23] op_sel:[1,0,0] op_sel_hi:[1,1,1]
    s_set_gpr_idx_off
    s_sub_u32 s32, s32, 1
    s_cbranch_scc1 MAIN_DONE
    v_mfma_f32_4x4x4_16b_bf16 v[116:119], v[172:173], v[178:179], 0 cbsz:4 abid:10
    v_lshlrev_b32_sdwa v136, v15, v122 dst_sel:DWORD dst_unused:UNUSED_PAD src0_sel:DWORD src1_sel:WORD_1
    s_waitcnt vmcnt(8)
    v_mfma_f32_4x4x4_16b_bf16 v[104:107], v[142:143], v[84:85], 0 cbsz:4 abid:9
    s_nop 0
    v_mfma_f32_4x4x4_16b_bf16 v[108:111], v[142:143], v[86:87], 0 cbsz:4 abid:9
    v_lshlrev_b32_sdwa v137, v15, v123 dst_sel:DWORD dst_unused:UNUSED_PAD src0_sel:DWORD src1_sel:WORD_1
    ds_read_u16_d16_hi v132, v136 offset:32768
    ds_read_u16_d16_hi v133, v137 offset:32768
    s_waitcnt lgkmcnt(2)
    s_set_gpr_idx_on s52, 0xc
    v_pk_fma_f32 v[16:17], v[128:129], v[96:97], v[16:17] op_sel:[0,0,0] op_sel_hi:[0,1,1]
    v_pk_fma_f32 v[18:19], v[128:129], v[98:99], v[18:19] op_sel:[0,0,0] op_sel_hi:[0,1,1]
    v_pk_fma_f32 v[20:21], v[130:131], v[100:101], v[20:21] op_sel:[0,0,0] op_sel_hi:[0,1,1]
    v_pk_fma_f32 v[22:23], v[130:131], v[102:103], v[22:23] op_sel:[0,0,0] op_sel_hi:[0,1,1]
    s_set_gpr_idx_off
    s_sub_u32 s32, s32, 1
    s_cbranch_scc1 MAIN_DONE
    v_lshlrev_b32_sdwa v138, v15, v126 dst_sel:DWORD dst_unused:UNUSED_PAD src0_sel:DWORD src1_sel:WORD_1
    v_mfma_f32_4x4x4_16b_bf16 v[96:99], v[144:145], v[88:89], 0 cbsz:4 abid:9
    s_nop 0
    v_mfma_f32_4x4x4_16b_bf16 v[100:103], v[144:145], v[90:91], 0 cbsz:4 abid:9
    v_lshlrev_b32_sdwa v139, v15, v127 dst_sel:DWORD dst_unused:UNUSED_PAD src0_sel:DWORD src1_sel:WORD_1
    ds_read_u16_d16_hi v134, v138 offset:32768
    ds_read_u16_d16_hi v135, v139 offset:32768
    s_set_gpr_idx_on s53, 0xc
    v_pk_fma_f32 v[16:17], v[128:129], v[104:105], v[16:17] op_sel:[1,0,0] op_sel_hi:[1,1,1]
    v_pk_fma_f32 v[18:19], v[128:129], v[106:107], v[18:19] op_sel:[1,0,0] op_sel_hi:[1,1,1]
    v_pk_fma_f32 v[20:21], v[130:131], v[108:109], v[20:21] op_sel:[1,0,0] op_sel_hi:[1,1,1]
    v_pk_fma_f32 v[22:23], v[130:131], v[110:111], v[22:23] op_sel:[1,0,0] op_sel_hi:[1,1,1]
    s_set_gpr_idx_off
    s_branch MAIN_DONE
B_36:
    buffer_load_dwordx4 v[188:191], v1, s[16:19], s10 offen offset:0 sc1
    buffer_load_dwordx4 v[192:195], v1, s[16:19], s10 offen offset:1024 sc1
    buffer_load_dwordx4 v[196:199], v1, s[16:19], s10 offen offset:2048 sc1
    buffer_load_dwordx4 v[200:203], v1, s[16:19], s10 offen offset:3072 sc1
    buffer_load_dwordx4 v[204:207], v1, s[16:19], s11 offen offset:0 sc1
    buffer_load_dwordx4 v[208:211], v1, s[16:19], s11 offen offset:1024 sc1
    buffer_load_dwordx4 v[212:215], v1, s[16:19], s11 offen offset:2048 sc1
    buffer_load_dwordx4 v[216:219], v1, s[16:19], s11 offen offset:3072 sc1
    s_sub_u32 s32, s32, 1
    s_cbranch_scc1 MAIN_DONE
    v_mfma_f32_4x4x4_16b_bf16 v[116:119], v[172:173], v[178:179], 0 cbsz:4 abid:10
    v_lshlrev_b32_sdwa v136, v15, v122 dst_sel:DWORD dst_unused:UNUSED_PAD src0_sel:DWORD src1_sel:WORD_1
    s_waitcnt vmcnt(12)
    v_mfma_f32_4x4x4_16b_bf16 v[104:107], v[142:143], v[84:85], 0 cbsz:4 abid:9
    s_nop 0
    v_mfma_f32_4x4x4_16b_bf16 v[108:111], v[142:143], v[86:87], 0 cbsz:4 abid:9
    v_lshlrev_b32_sdwa v137, v15, v123 dst_sel:DWORD dst_unused:UNUSED_PAD src0_sel:DWORD src1_sel:WORD_1
    ds_read_u16_d16_hi v132, v136 offset:32768
    ds_read_u16_d16_hi v133, v137 offset:32768
    s_waitcnt lgkmcnt(2)
    s_set_gpr_idx_on s52, 0xc
    v_pk_fma_f32 v[16:17], v[128:129], v[96:97], v[16:17] op_sel:[0,0,0] op_sel_hi:[0,1,1]
    v_pk_fma_f32 v[18:19], v[128:129], v[98:99], v[18:19] op_sel:[0,0,0] op_sel_hi:[0,1,1]
    v_pk_fma_f32 v[20:21], v[130:131], v[100:101], v[20:21] op_sel:[0,0,0] op_sel_hi:[0,1,1]
    v_pk_fma_f32 v[22:23], v[130:131], v[102:103], v[22:23] op_sel:[0,0,0] op_sel_hi:[0,1,1]
    s_set_gpr_idx_off
    s_sub_u32 s32, s32, 1
    s_cbranch_scc1 MAIN_DONE
    v_lshlrev_b32_sdwa v138, v15, v126 dst_sel:DWORD dst_unused:UNUSED_PAD src0_sel:DWORD src1_sel:WORD_1
    s_waitcnt vmcnt(11)
    v_mfma_f32_4x4x4_16b_bf16 v[96:99], v[144:145], v[88:89], 0 cbsz:4 abid:9
    s_nop 0
    v_mfma_f32_4x4x4_16b_bf16 v[100:103], v[144:145], v[90:91], 0 cbsz:4 abid:9
    v_lshlrev_b32_sdwa v139, v15, v127 dst_sel:DWORD dst_unused:UNUSED_PAD src0_sel:DWORD src1_sel:WORD_1
    ds_read_u16_d16_hi v134, v138 offset:32768
    ds_read_u16_d16_hi v135, v139 offset:32768
    s_set_gpr_idx_on s53, 0xc
    v_pk_fma_f32 v[16:17], v[128:129], v[104:105], v[16:17] op_sel:[1,0,0] op_sel_hi:[1,1,1]
    v_pk_fma_f32 v[18:19], v[128:129], v[106:107], v[18:19] op_sel:[1,0,0] op_sel_hi:[1,1,1]
    v_pk_fma_f32 v[20:21], v[130:131], v[108:109], v[20:21] op_sel:[1,0,0] op_sel_hi:[1,1,1]
    v_pk_fma_f32 v[22:23], v[130:131], v[110:111], v[22:23] op_sel:[1,0,0] op_sel_hi:[1,1,1]
    s_set_gpr_idx_off
    s_sub_u32 s32, s32, 1
    s_cbranch_scc1 MAIN_DONE
    v_mfma_f32_4x4x4_16b_bf16 v[120:123], v[172:173], v[176:177], 0 cbsz:4 abid:11
    v_lshlrev_b32_sdwa v136, v15, v112 dst_sel:DWORD dst_unused:UNUSED_PAD src0_sel:DWORD src1_sel:WORD_1
    s_waitcnt vmcnt(10)
    v_mfma_f32_4x4x4_16b_bf16 v[104:107], v[146:147], v[92:93], 0 cbsz:4 abid:9
    s_nop 0
    v_mfma_f32_4x4x4_16b_bf16 v[108:111], v[146:147], v[94:95], 0 cbsz:4 abid:9
    v_lshlrev_b32_sdwa v137, v15, v113 dst_sel:DWORD dst_unused:UNUSED_PAD src0_sel:DWORD src1_sel:WORD_1
    ds_read_u16_d16_hi v128, v136 offset:32768
    ds_read_u16_d16_hi v129, v137 offset:32768
    s_waitcnt lgkmcnt(2)
    s_set_gpr_idx_on s54, 0xc
    v_pk_fma_f32 v[16:17], v[132:133], v[96:97], v[16:17] op_sel:[0,0,0] op_sel_hi:[0,1,1]
    v_pk_fma_f32 v[18:19], v[132:133], v[98:99], v[18:19] op_sel:[0,0,0] op_sel_hi:[0,1,1]
    v_pk_fma_f32 v[20:21], v[134:135], v[100:101], v[20:21] op_sel:[0,0,0] op_sel_hi:[0,1,1]
    v_pk_fma_f32 v[22:23], v[134:135], v[102:103], v[22:23] op_sel:[0,0,0] op_sel_hi:[0,1,1]
    s_set_gpr_idx_off
    s_sub_u32 s32, s32, 1
    s_cbranch_scc1 MAIN_DONE
    v_lshlrev_b32_sdwa v138, v15, v116 dst_sel:DWORD dst_unused:UNUSED_PAD src0_sel:DWORD src1_sel:WORD_1
    s_waitcnt vmcnt(9)
    v_mfma_f32_4x4x4_16b_bf16 v[96:99], v[140:141], v[64:65], 0 cbsz:4 abid:10
    s_nop 0
    v_mfma_f32_4x4x4_16b_bf16 v[100:103], v[140:141], v[66:67], 0 cbsz:4 abid:10
    v_lshlrev_b32_sdwa v139, v15, v117 dst_sel:DWORD dst_unused:UNUSED_PAD src0_sel:DWORD src1_sel:WORD_1
    ds_read_u16_d16_hi v130, v138 offset:32768
    ds_read_u16_d16_hi v131, v139 offset:32768
    s_set_gpr_idx_on s55, 0xc
    v_pk_fma_f32 v[16:17], v[132:133], v[104:105], v[16:17] op_sel:[1,0,0] op_sel_hi:[1,1,1]
    v_pk_fma_f32 v[18:19], v[132:133], v[106:107], v[18:19] op_sel:[1,0,0] op_sel_hi:[1,1,1]
    v_pk_fma_f32 v[20:21], v[134:135], v[108:109], v[20:21] op_sel:[1,0,0] op_sel_hi:[1,1,1]
    v_pk_fma_f32 v[22:23], v[134:135], v[110:111], v[22:23] op_sel:[1,0,0] op_sel_hi:[1,1,1]
    s_set_gpr_idx_off
    s_sub_u32 s32, s32, 1
    s_cbranch_scc1 MAIN_DONE
    v_mfma_f32_4x4x4_16b_bf16 v[124:127], v[172:173], v[178:179], 0 cbsz:4 abid:11
    v_lshlrev_b32_sdwa v136, v15, v114 dst_sel:DWORD dst_unused:UNUSED_PAD src0_sel:DWORD src1_sel:WORD_1
    s_waitcnt vmcnt(8)
    v_mfma_f32_4x4x4_16b_bf16 v[104:107], v[142:143], v[68:69], 0 cbsz:4 abid:10
    s_nop 0
    v_mfma_f32_4x4x4_16b_bf16 v[108:111], v[142:143], v[70:71], 0 cbsz:4 abid:10
    v_lshlrev_b32_sdwa v137, v15, v115 dst_sel:DWORD dst_unused:UNUSED_PAD src0_sel:DWORD src1_sel:WORD_1
    ds_read_u16_d16_hi v132, v136 offset:32768
    ds_read_u16_d16_hi v133, v137 offset:32768
    s_waitcnt lgkmcnt(2)
    s_set_gpr_idx_on s56, 0xc
    v_pk_fma_f32 v[16:17], v[128:129], v[96:97], v[16:17] op_sel:[0,0,0] op_sel_hi:[0,1,1]
    v_pk_fma_f32 v[18:19], v[128:129], v[98:99], v[18:19] op_sel:[0,0,0] op_sel_hi:[0,1,1]
    v_pk_fma_f32 v[20:21], v[130:131], v[100:101], v[20:21] op_sel:[0,0,0] op_sel_hi:[0,1,1]
    v_pk_fma_f32 v[22:23], v[130:131], v[102:103], v[22:23] op_sel:[0,0,0] op_sel_hi:[0,1,1]
    s_set_gpr_idx_off
    s_sub_u32 s32, s32, 1
    s_cbranch_scc1 MAIN_DONE
    v_mfma_f32_4x4x4_16b_bf16 v[148:151], v[168:169], v[180:181], 0
    v_lshlrev_b32_sdwa v138, v15, v118 dst_sel:DWORD dst_unused:UNUSED_PAD src0_sel:DWORD src1_sel:WORD_1
    v_mfma_f32_4x4x4_16b_bf16 v[96:99], v[144:145], v[72:73], 0 cbsz:4 abid:10
    s_nop 0
    v_mfma_f32_4x4x4_16b_bf16 v[100:103], v[144:145], v[74:75], 0 cbsz:4 abid:10
    v_lshlrev_b32_sdwa v139, v15, v119 dst_sel:DWORD dst_unused:UNUSED_PAD src0_sel:DWORD src1_sel:WORD_1
    ds_read_u16_d16_hi v134, v138 offset:32768
    ds_read_u16_d16_hi v135, v139 offset:32768
    s_set_gpr_idx_on s57, 0xc
    v_pk_fma_f32 v[16:17], v[128:129], v[104:105], v[16:17] op_sel:[1,0,0] op_sel_hi:[1,1,1]
    v_pk_fma_f32 v[18:19], v[128:129], v[106:107], v[18:19] op_sel:[1,0,0] op_sel_hi:[1,1,1]
    v_pk_fma_f32 v[20:21], v[130:131], v[108:109], v[20:21] op_sel:[1,0,0] op_sel_hi:[1,1,1]
    v_pk_fma_f32 v[22:23], v[130:131], v[110:111], v[22:23] op_sel:[1,0,0] op_sel_hi:[1,1,1]
    s_set_gpr_idx_off
    s_branch MAIN_DONE
B_40:
    buffer_load_dwordx4 v[188:191], v1, s[16:19], s10 offen offset:0 sc1
    buffer_load_dwordx4 v[192:195], v1, s[16:19], s10 offen offset:1024 sc1
    buffer_load_dwordx4 v[196:199], v1, s[16:19], s10 offen offset:2048 sc1
    buffer_load_dwordx4 v[200:203], v1, s[16:19], s10 offen offset:3072 sc1
    buffer_load_dwordx4 v[204:207], v1, s[16:19], s11 offen offset:0 sc1
    buffer_load_dwordx4 v[208:211], v1, s[16:19], s11 offen offset:1024 sc1
    buffer_load_dwordx4 v[212:215], v1, s[16:19], s11 offen offset:2048 sc1
    buffer_load_dwordx4 v[216:219], v1, s[16:19], s11 offen offset:3072 sc1
    s_sub_u32 s32, s32, 1
    s_cbranch_scc1 MAIN_DONE
    v_mfma_f32_4x4x4_16b_bf16 v[124:127], v[172:173], v[178:179], 0 cbsz:4 abid:11
    v_lshlrev_b32_sdwa v136, v15, v114 dst_sel:DWORD dst_unused:UNUSED_PAD src0_sel:DWORD src1_sel:WORD_1
    s_waitcnt vmcnt(12)
    v_mfma_f32_4x4x4_16b_bf16 v[104:107], v[142:143], v[68:69], 0 cbsz:4 abid:10
    s_nop 0
    v_mfma_f32_4x4x4_16b_bf16 v[108:111], v[142:143], v[70:71], 0 cbsz:4 abid:10
    v_lshlrev_b32_sdwa v137, v15, v115 dst_sel:DWORD dst_unused:UNUSED_PAD src0_sel:DWORD src1_sel:WORD_1
    ds_read_u16_d16_hi v132, v136 offset:32768
    ds_read_u16_d16_hi v133, v137 offset:32768
    s_waitcnt lgkmcnt(2)
    s_set_gpr_idx_on s56, 0xc
    v_pk_fma_f32 v[16:17], v[128:129], v[96:97], v[16:17] op_sel:[0,0,0] op_sel_hi:[0,1,1]
    v_pk_fma_f32 v[18:19], v[128:129], v[98:99], v[18:19] op_sel:[0,0,0] op_sel_hi:[0,1,1]
    v_pk_fma_f32 v[20:21], v[130:131], v[100:101], v[20:21] op_sel:[0,0,0] op_sel_hi:[0,1,1]
    v_pk_fma_f32 v[22:23], v[130:131], v[102:103], v[22:23] op_sel:[0,0,0] op_sel_hi:[0,1,1]
    s_set_gpr_idx_off
    s_sub_u32 s32, s32, 1
    s_cbranch_scc1 MAIN_DONE
    v_mfma_f32_4x4x4_16b_bf16 v[148:151], v[168:169], v[180:181], 0
    v_lshlrev_b32_sdwa v138, v15, v118 dst_sel:DWORD dst_unused:UNUSED_PAD src0_sel:DWORD src1_sel:WORD_1
    s_waitcnt vmcnt(11)
    v_mfma_f32_4x4x4_16b_bf16 v[96:99], v[144:145], v[72:73], 0 cbsz:4 abid:10
    s_nop 0
    v_mfma_f32_4x4x4_16b_bf16 v[100:103], v[144:145], v[74:75], 0 cbsz:4 abid:10
    v_lshlrev_b32_sdwa v139, v15, v119 dst_sel:DWORD dst_unused:UNUSED_PAD src0_sel:DWORD src1_sel:WORD_1
    ds_read_u16_d16_hi v134, v138 offset:32768
    ds_read_u16_d16_hi v135, v139 offset:32768
    s_set_gpr_idx_on s57, 0xc
    v_pk_fma_f32 v[16:17], v[128:129], v[104:105], v[16:17] op_sel:[1,0,0] op_sel_hi:[1,1,1]
    v_pk_fma_f32 v[18:19], v[128:129], v[106:107], v[18:19] op_sel:[1,0,0] op_sel_hi:[1,1,1]
    v_pk_fma_f32 v[20:21], v[130:131], v[108:109], v[20:21] op_sel:[1,0,0] op_sel_hi:[1,1,1]
    v_pk_fma_f32 v[22:23], v[130:131], v[110:111], v[22:23] op_sel:[1,0,0] op_sel_hi:[1,1,1]
    s_set_gpr_idx_off
    s_sub_u32 s32, s32, 1
    s_cbranch_scc1 MAIN_DONE
    v_mfma_f32_4x4x4_16b_bf16 v[112:115], v[172:173], v[176:177], 0 cbsz:4 abid:12
    v_lshlrev_b32_sdwa v136, v15, v120 dst_sel:DWORD dst_unused:UNUSED_PAD src0_sel:DWORD src1_sel:WORD_1
    s_waitcnt vmcnt(10)
    v_mfma_f32_4x4x4_16b_bf16 v[104:107], v[146:147], v[76:77], 0 cbsz:4 abid:10
    s_nop 0
    v_mfma_f32_4x4x4_16b_bf16 v[108:111], v[146:147], v[78:79], 0 cbsz:4 abid:10
    v_lshlrev_b32_sdwa v137, v15, v121 dst_sel:DWORD dst_unused:UNUSED_PAD src0_sel:DWORD src1_sel:WORD_1
    ds_read_u16_d16_hi v128, v136 offset:32768
    ds_read_u16_d16_hi v129, v137 offset:32768
    s_waitcnt lgkmcnt(2)
    s_set_gpr_idx_on s58, 0xc
    v_pk_fma_f32 v[16:17], v[132:133], v[96:97], v[16:17] op_sel:[0,0,0] op_sel_hi:[0,1,1]
    v_pk_fma_f32 v[18:19], v[132:133], v[98:99], v[18:19] op_sel:[0,0,0] op_sel_hi:[0,1,1]
    v_pk_fma_f32 v[20:21], v[134:135], v[100:101], v[20:21] op_sel:[0,0,0] op_sel_hi:[0,1,1]
    v_pk_fma_f32 v[22:23], v[134:135], v[102:103], v[22:23] op_sel:[0,0,0] op_sel_hi:[0,1,1]
    s_set_gpr_idx_off
    s_sub_u32 s32, s32, 1
    s_cbranch_scc1 MAIN_DONE
    v_mfma_f32_4x4x4_16b_bf16 v[152:155], v[168:169], v[182:183], 0
    v_lshlrev_b32_sdwa v138, v15, v124 dst_sel:DWORD dst_unused:UNUSED_PAD src0_sel:DWORD src1_sel:WORD_1
    s_waitcnt vmcnt(9)
    v_mfma_f32_4x4x4_16b_bf16 v[96:99], v[140:141], v[80:81], 0 cbsz:4 abid:11
    s_nop 0
    v_mfma_f32_4x4x4_16b_bf16 v[100:103], v[140:141], v[82:83], 0 cbsz:4 abid:11
    v_lshlrev_b32_sdwa v139, v15, v125 dst_sel:DWORD dst_unused:UNUSED_PAD src0_sel:DWORD src1_sel:WORD_1
    ds_read_u16_d16_hi v130, v138 offset:32768
    ds_read_u16_d16_hi v131, v139 offset:32768
    s_set_gpr_idx_on s59, 0xc
    v_pk_fma_f32 v[16:17], v[132:133], v[104:105], v[16:17] op_sel:[1,0,0] op_sel_hi:[1,1,1]
    v_pk_fma_f32 v[18:19], v[132:133], v[106:107], v[18:19] op_sel:[1,0,0] op_sel_hi:[1,1,1]
    v_pk_fma_f32 v[20:21], v[134:135], v[108:109], v[20:21] op_sel:[1,0,0] op_sel_hi:[1,1,1]
    v_pk_fma_f32 v[22:23], v[134:135], v[110:111], v[22:23] op_sel:[1,0,0] op_sel_hi:[1,1,1]
    s_set_gpr_idx_off
    s_sub_u32 s32, s32, 1
    s_cbranch_scc1 MAIN_DONE
    v_mfma_f32_4x4x4_16b_bf16 v[116:119], v[172:173], v[178:179], 0 cbsz:4 abid:12
    v_lshlrev_b32_sdwa v136, v15, v122 dst_sel:DWORD dst_unused:UNUSED_PAD src0_sel:DWORD src1_sel:WORD_1
    s_waitcnt vmcnt(8)
    v_mfma_f32_4x4x4_16b_bf16 v[104:107], v[142:143], v[84:85], 0 cbsz:4 abid:11
    s_nop 0
    v_mfma_f32_4x4x4_16b_bf16 v[108:111], v[142:143], v[86:87], 0 cbsz:4 abid:11
    v_lshlrev_b32_sdwa v137, v15, v123 dst_sel:DWORD dst_unused:UNUSED_PAD src0_sel:DWORD src1_sel:WORD_1
    ds_read_u16_d16_hi v132, v136 offset:32768
    ds_read_u16_d16_hi v133, v137 offset:32768
    s_waitcnt lgkmcnt(2)
    s_set_gpr_idx_on s60, 0xc
    v_pk_fma_f32 v[16:17], v[128:129], v[96:97], v[16:17] op_sel:[0,0,0] op_sel_hi:[0,1,1]
    v_pk_fma_f32 v[18:19], v[128:129], v[98:99], v[18:19] op_sel:[0,0,0] op_sel_hi:[0,1,1]
    v_pk_fma_f32 v[20:21], v[130:131], v[100:101], v[20:21] op_sel:[0,0,0] op_sel_hi:[0,1,1]
    v_pk_fma_f32 v[22:23], v[130:131], v[102:103], v[22:23] op_sel:[0,0,0] op_sel_hi:[0,1,1]
    s_set_gpr_idx_off
    s_sub_u32 s32, s32, 1
    s_cbranch_scc1 MAIN_DONE
    v_mfma_f32_4x4x4_16b_bf16 v[156:159], v[168:169], v[184:185], 0
    v_lshlrev_b32_sdwa v138, v15, v126 dst_sel:DWORD dst_unused:UNUSED_PAD src0_sel:DWORD src1_sel:WORD_1
    v_mfma_f32_4x4x4_16b_bf16 v[96:99], v[144:145], v[88:89], 0 cbsz:4 abid:11
    s_nop 0
    v_mfma_f32_4x4x4_16b_bf16 v[100:103], v[144:145], v[90:91], 0 cbsz:4 abid:11
    v_lshlrev_b32_sdwa v139, v15, v127 dst_sel:DWORD dst_unused:UNUSED_PAD src0_sel:DWORD src1_sel:WORD_1
    ds_read_u16_d16_hi v134, v138 offset:32768
    ds_read_u16_d16_hi v135, v139 offset:32768
    s_set_gpr_idx_on s61, 0xc
    v_pk_fma_f32 v[16:17], v[128:129], v[104:105], v[16:17] op_sel:[1,0,0] op_sel_hi:[1,1,1]
    v_pk_fma_f32 v[18:19], v[128:129], v[106:107], v[18:19] op_sel:[1,0,0] op_sel_hi:[1,1,1]
    v_pk_fma_f32 v[20:21], v[130:131], v[108:109], v[20:21] op_sel:[1,0,0] op_sel_hi:[1,1,1]
    v_pk_fma_f32 v[22:23], v[130:131], v[110:111], v[22:23] op_sel:[1,0,0] op_sel_hi:[1,1,1]
    s_set_gpr_idx_off
    s_branch MAIN_DONE
B_44:
    buffer_load_dwordx4 v[188:191], v1, s[16:19], s10 offen offset:0 sc1
    buffer_load_dwordx4 v[192:195], v1, s[16:19], s10 offen offset:1024 sc1
    buffer_load_dwordx4 v[196:199], v1, s[16:19], s10 offen offset:2048 sc1
    buffer_load_dwordx4 v[200:203], v1, s[16:19], s10 offen offset:3072 sc1
    buffer_load_dwordx4 v[204:207], v1, s[16:19], s11 offen offset:0 sc1
    buffer_load_dwordx4 v[208:211], v1, s[16:19], s11 offen offset:1024 sc1
    buffer_load_dwordx4 v[212:215], v1, s[16:19], s11 offen offset:2048 sc1
    buffer_load_dwordx4 v[216:219], v1, s[16:19], s11 offen offset:3072 sc1
    s_sub_u32 s32, s32, 1
    s_cbranch_scc1 MAIN_DONE
    v_mfma_f32_4x4x4_16b_bf16 v[116:119], v[172:173], v[178:179], 0 cbsz:4 abid:12
    v_lshlrev_b32_sdwa v136, v15, v122 dst_sel:DWORD dst_unused:UNUSED_PAD src0_sel:DWORD src1_sel:WORD_1
    s_waitcnt vmcnt(12)
    v_mfma_f32_4x4x4_16b_bf16 v[104:107], v[142:143], v[84:85], 0 cbsz:4 abid:11
    s_nop 0
    v_mfma_f32_4x4x4_16b_bf16 v[108:111], v[142:143], v[86:87], 0 cbsz:4 abid:11
    v_lshlrev_b32_sdwa v137, v15, v123 dst_sel:DWORD dst_unused:UNUSED_PAD src0_sel:DWORD src1_sel:WORD_1
    ds_read_u16_d16_hi v132, v136 offset:32768
    ds_read_u16_d16_hi v133, v137 offset:32768
    s_waitcnt lgkmcnt(2)
    s_set_gpr_idx_on s60, 0xc
    v_pk_fma_f32 v[16:17], v[128:129], v[96:97], v[16:17] op_sel:[0,0,0] op_sel_hi:[0,1,1]
    v_pk_fma_f32 v[18:19], v[128:129], v[98:99], v[18:19] op_sel:[0,0,0] op_sel_hi:[0,1,1]
    v_pk_fma_f32 v[20:21], v[130:131], v[100:101], v[20:21] op_sel:[0,0,0] op_sel_hi:[0,1,1]
    v_pk_fma_f32 v[22:23], v[130:131], v[102:103], v[22:23] op_sel:[0,0,0] op_sel_hi:[0,1,1]
    s_set_gpr_idx_off
    s_sub_u32 s32, s32, 1
    s_cbranch_scc1 MAIN_DONE
    v_mfma_f32_4x4x4_16b_bf16 v[156:159], v[168:169], v[184:185], 0
    v_lshlrev_b32_sdwa v138, v15, v126 dst_sel:DWORD dst_unused:UNUSED_PAD src0_sel:DWORD src1_sel:WORD_1
    s_waitcnt vmcnt(11)
    v_mfma_f32_4x4x4_16b_bf16 v[96:99], v[144:145], v[88:89], 0 cbsz:4 abid:11
    s_nop 0
    v_mfma_f32_4x4x4_16b_bf16 v[100:103], v[144:145], v[90:91], 0 cbsz:4 abid:11
    v_lshlrev_b32_sdwa v139, v15, v127 dst_sel:DWORD dst_unused:UNUSED_PAD src0_sel:DWORD src1_sel:WORD_1
    ds_read_u16_d16_hi v134, v138 offset:32768
    ds_read_u16_d16_hi v135, v139 offset:32768
    s_set_gpr_idx_on s61, 0xc
    v_pk_fma_f32 v[16:17], v[128:129], v[104:105], v[16:17] op_sel:[1,0,0] op_sel_hi:[1,1,1]
    v_pk_fma_f32 v[18:19], v[128:129], v[106:107], v[18:19] op_sel:[1,0,0] op_sel_hi:[1,1,1]
    v_pk_fma_f32 v[20:21], v[130:131], v[108:109], v[20:21] op_sel:[1,0,0] op_sel_hi:[1,1,1]
    v_pk_fma_f32 v[22:23], v[130:131], v[110:111], v[22:23] op_sel:[1,0,0] op_sel_hi:[1,1,1]
    s_set_gpr_idx_off
    s_sub_u32 s32, s32, 1
    s_cbranch_scc1 MAIN_DONE
    v_mfma_f32_4x4x4_16b_bf16 v[120:123], v[172:173], v[176:177], 0 cbsz:4 abid:13
    v_lshlrev_b32_sdwa v136, v15, v112 dst_sel:DWORD dst_unused:UNUSED_PAD src0_sel:DWORD src1_sel:WORD_1
    s_waitcnt vmcnt(10)
    v_mfma_f32_4x4x4_16b_bf16 v[104:107], v[146:147], v[92:93], 0 cbsz:4 abid:11
    s_nop 0
    v_mfma_f32_4x4x4_16b_bf16 v[108:111], v[146:147], v[94:95], 0 cbsz:4 abid:11
    v_lshlrev_b32_sdwa v137, v15, v113 dst_sel:DWORD dst_unused:UNUSED_PAD src0_sel:DWORD src1_sel:WORD_1
    ds_read_u16_d16_hi v128, v136 offset:32768
    ds_read_u16_d16_hi v129, v137 offset:32768
    s_waitcnt lgkmcnt(2)
    s_set_gpr_idx_on s62, 0xc
    v_pk_fma_f32 v[16:17], v[132:133], v[96:97], v[16:17] op_sel:[0,0,0] op_sel_hi:[0,1,1]
    v_pk_fma_f32 v[18:19], v[132:133], v[98:99], v[18:19] op_sel:[0,0,0] op_sel_hi:[0,1,1]
    v_pk_fma_f32 v[20:21], v[134:135], v[100:101], v[20:21] op_sel:[0,0,0] op_sel_hi:[0,1,1]
    v_pk_fma_f32 v[22:23], v[134:135], v[102:103], v[22:23] op_sel:[0,0,0] op_sel_hi:[0,1,1]
    s_set_gpr_idx_off
    s_sub_u32 s32, s32, 1
    s_cbranch_scc1 MAIN_DONE
    v_mfma_f32_4x4x4_16b_bf16 v[160:163], v[168:169], v[186:187], 0
    v_lshlrev_b32_sdwa v138, v15, v116 dst_sel:DWORD dst_unused:UNUSED_PAD src0_sel:DWORD src1_sel:WORD_1
    s_waitcnt vmcnt(9)
    v_mfma_f32_4x4x4_16b_bf16 v[96:99], v[140:141], v[64:65], 0 cbsz:4 abid:12
    s_nop 0
    v_mfma_f32_4x4x4_16b_bf16 v[100:103], v[140:141], v[66:67], 0 cbsz:4 abid:12
    v_lshlrev_b32_sdwa v139, v15, v117 dst_sel:DWORD dst_unused:UNUSED_PAD src0_sel:DWORD src1_sel:WORD_1
    ds_read_u16_d16_hi v130, v138 offset:32768
    ds_read_u16_d16_hi v131, v139 offset:32768
    s_set_gpr_idx_on s63, 0xc
    v_pk_fma_f32 v[16:17], v[132:133], v[104:105], v[16:17] op_sel:[1,0,0] op_sel_hi:[1,1,1]
    v_pk_fma_f32 v[18:19], v[132:133], v[106:107], v[18:19] op_sel:[1,0,0] op_sel_hi:[1,1,1]
    v_pk_fma_f32 v[20:21], v[134:135], v[108:109], v[20:21] op_sel:[1,0,0] op_sel_hi:[1,1,1]
    v_pk_fma_f32 v[22:23], v[134:135], v[110:111], v[22:23] op_sel:[1,0,0] op_sel_hi:[1,1,1]
    s_set_gpr_idx_off
    s_sub_u32 s32, s32, 1
    s_cbranch_scc1 MAIN_DONE
    v_mfma_f32_4x4x4_16b_bf16 v[124:127], v[172:173], v[178:179], 0 cbsz:4 abid:13
    v_lshlrev_b32_sdwa v136, v15, v114 dst_sel:DWORD dst_unused:UNUSED_PAD src0_sel:DWORD src1_sel:WORD_1
    s_waitcnt vmcnt(8)
    v_mfma_f32_4x4x4_16b_bf16 v[104:107], v[142:143], v[68:69], 0 cbsz:4 abid:12
    s_nop 0
    v_mfma_f32_4x4x4_16b_bf16 v[108:111], v[142:143], v[70:71], 0 cbsz:4 abid:12
    v_lshlrev_b32_sdwa v137, v15, v115 dst_sel:DWORD dst_unused:UNUSED_PAD src0_sel:DWORD src1_sel:WORD_1
    ds_read_u16_d16_hi v132, v136 offset:32768
    ds_read_u16_d16_hi v133, v137 offset:32768
    s_waitcnt lgkmcnt(2)
    s_set_gpr_idx_on s48, 0xc
    v_pk_fma_f32 v[16:17], v[128:129], v[96:97], v[16:17] op_sel:[0,0,0] op_sel_hi:[0,1,1]
    v_pk_fma_f32 v[18:19], v[128:129], v[98:99], v[18:19] op_sel:[0,0,0] op_sel_hi:[0,1,1]
    v_pk_fma_f32 v[20:21], v[130:131], v[100:101], v[20:21] op_sel:[0,0,0] op_sel_hi:[0,1,1]
    v_pk_fma_f32 v[22:23], v[130:131], v[102:103], v[22:23] op_sel:[0,0,0] op_sel_hi:[0,1,1]
    s_set_gpr_idx_off
    s_sub_u32 s32, s32, 1
    s_cbranch_scc1 MAIN_DONE
    v_lshlrev_b32_sdwa v138, v15, v118 dst_sel:DWORD dst_unused:UNUSED_PAD src0_sel:DWORD src1_sel:WORD_1
    v_mfma_f32_4x4x4_16b_bf16 v[96:99], v[144:145], v[72:73], 0 cbsz:4 abid:12
    s_nop 0
    v_mfma_f32_4x4x4_16b_bf16 v[100:103], v[144:145], v[74:75], 0 cbsz:4 abid:12
    v_lshlrev_b32_sdwa v139, v15, v119 dst_sel:DWORD dst_unused:UNUSED_PAD src0_sel:DWORD src1_sel:WORD_1
    ds_read_u16_d16_hi v134, v138 offset:32768
    ds_read_u16_d16_hi v135, v139 offset:32768
    s_set_gpr_idx_on s49, 0xc
    v_pk_fma_f32 v[16:17], v[128:129], v[104:105], v[16:17] op_sel:[1,0,0] op_sel_hi:[1,1,1]
    v_pk_fma_f32 v[18:19], v[128:129], v[106:107], v[18:19] op_sel:[1,0,0] op_sel_hi:[1,1,1]
    v_pk_fma_f32 v[20:21], v[130:131], v[108:109], v[20:21] op_sel:[1,0,0] op_sel_hi:[1,1,1]
    v_pk_fma_f32 v[22:23], v[130:131], v[110:111], v[22:23] op_sel:[1,0,0] op_sel_hi:[1,1,1]
    s_set_gpr_idx_off
    s_branch MAIN_DONE
B_48:
    buffer_load_dwordx4 v[188:191], v1, s[16:19], s10 offen offset:0 sc1
    buffer_load_dwordx4 v[192:195], v1, s[16:19], s10 offen offset:1024 sc1
    buffer_load_dwordx4 v[196:199], v1, s[16:19], s10 offen offset:2048 sc1
    buffer_load_dwordx4 v[200:203], v1, s[16:19], s10 offen offset:3072 sc1
    buffer_load_dwordx4 v[204:207], v1, s[16:19], s11 offen offset:0 sc1
    buffer_load_dwordx4 v[208:211], v1, s[16:19], s11 offen offset:1024 sc1
    buffer_load_dwordx4 v[212:215], v1, s[16:19], s11 offen offset:2048 sc1
    buffer_load_dwordx4 v[216:219], v1, s[16:19], s11 offen offset:3072 sc1
    s_sub_u32 s32, s32, 1
    s_cbranch_scc1 MAIN_DONE
    v_mfma_f32_4x4x4_16b_bf16 v[124:127], v[172:173], v[178:179], 0 cbsz:4 abid:13
    v_lshlrev_b32_sdwa v136, v15, v114 dst_sel:DWORD dst_unused:UNUSED_PAD src0_sel:DWORD src1_sel:WORD_1
    s_waitcnt vmcnt(12)
    v_mfma_f32_4x4x4_16b_bf16 v[104:107], v[142:143], v[68:69], 0 cbsz:4 abid:12
    s_nop 0
    v_mfma_f32_4x4x4_16b_bf16 v[108:111], v[142:143], v[70:71], 0 cbsz:4 abid:12
    v_lshlrev_b32_sdwa v137, v15, v115 dst_sel:DWORD dst_unused:UNUSED_PAD src0_sel:DWORD src1_sel:WORD_1
    ds_read_u16_d16_hi v132, v136 offset:32768
    ds_read_u16_d16_hi v133, v137 offset:32768
    s_waitcnt lgkmcnt(2)
    s_set_gpr_idx_on s48, 0xc
    v_pk_fma_f32 v[16:17], v[128:129], v[96:97], v[16:17] op_sel:[0,0,0] op_sel_hi:[0,1,1]
    v_pk_fma_f32 v[18:19], v[128:129], v[98:99], v[18:19] op_sel:[0,0,0] op_sel_hi:[0,1,1]
    v_pk_fma_f32 v[20:21], v[130:131], v[100:101], v[20:21] op_sel:[0,0,0] op_sel_hi:[0,1,1]
    v_pk_fma_f32 v[22:23], v[130:131], v[102:103], v[22:23] op_sel:[0,0,0] op_sel_hi:[0,1,1]
    s_set_gpr_idx_off
    s_sub_u32 s32, s32, 1
    s_cbranch_scc1 MAIN_DONE
    v_lshlrev_b32_sdwa v138, v15, v118 dst_sel:DWORD dst_unused:UNUSED_PAD src0_sel:DWORD src1_sel:WORD_1
    s_waitcnt vmcnt(11)
    v_mfma_f32_4x4x4_16b_bf16 v[96:99], v[144:145], v[72:73], 0 cbsz:4 abid:12
    s_nop 0
    v_mfma_f32_4x4x4_16b_bf16 v[100:103], v[144:145], v[74:75], 0 cbsz:4 abid:12
    v_lshlrev_b32_sdwa v139, v15, v119 dst_sel:DWORD dst_unused:UNUSED_PAD src0_sel:DWORD src1_sel:WORD_1
    ds_read_u16_d16_hi v134, v138 offset:32768
    ds_read_u16_d16_hi v135, v139 offset:32768
    s_set_gpr_idx_on s49, 0xc
    v_pk_fma_f32 v[16:17], v[128:129], v[104:105], v[16:17] op_sel:[1,0,0] op_sel_hi:[1,1,1]
    v_pk_fma_f32 v[18:19], v[128:129], v[106:107], v[18:19] op_sel:[1,0,0] op_sel_hi:[1,1,1]
    v_pk_fma_f32 v[20:21], v[130:131], v[108:109], v[20:21] op_sel:[1,0,0] op_sel_hi:[1,1,1]
    v_pk_fma_f32 v[22:23], v[130:131], v[110:111], v[22:23] op_sel:[1,0,0] op_sel_hi:[1,1,1]
    s_set_gpr_idx_off
    s_sub_u32 s32, s32, 1
    s_cbranch_scc1 MAIN_DONE
    v_mfma_f32_4x4x4_16b_bf16 v[112:115], v[172:173], v[176:177], 0 cbsz:4 abid:14
    v_lshlrev_b32_sdwa v136, v15, v120 dst_sel:DWORD dst_unused:UNUSED_PAD src0_sel:DWORD src1_sel:WORD_1
    s_waitcnt vmcnt(10)
    v_mfma_f32_4x4x4_16b_bf16 v[104:107], v[146:147], v[76:77], 0 cbsz:4 abid:12
    s_nop 0
    v_mfma_f32_4x4x4_16b_bf16 v[108:111], v[146:147], v[78:79], 0 cbsz:4 abid:12
    v_lshlrev_b32_sdwa v137, v15, v121 dst_sel:DWORD dst_unused:UNUSED_PAD src0_sel:DWORD src1_sel:WORD_1
    ds_read_u16_d16_hi v128, v136 offset:32768
    ds_read_u16_d16_hi v129, v137 offset:32768
    s_waitcnt lgkmcnt(2)
    s_set_gpr_idx_on s50, 0xc
    v_pk_fma_f32 v[16:17], v[132:133], v[96:97], v[16:17] op_sel:[0,0,0] op_sel_hi:[0,1,1]
    v_pk_fma_f32 v[18:19], v[132:133], v[98:99], v[18:19] op_sel:[0,0,0] op_sel_hi:[0,1,1]
    v_pk_fma_f32 v[20:21], v[134:135], v[100:101], v[20:21] op_sel:[0,0,0] op_sel_hi:[0,1,1]
    v_pk_fma_f32 v[22:23], v[134:135], v[102:103], v[22:23] op_sel:[0,0,0] op_sel_hi:[0,1,1]
    s_set_gpr_idx_off
    s_sub_u32 s32, s32, 1
    s_cbranch_scc1 MAIN_DONE
    v_lshlrev_b32_sdwa v138, v15, v124 dst_sel:DWORD dst_unused:UNUSED_PAD src0_sel:DWORD src1_sel:WORD_1
    s_waitcnt vmcnt(9)
    v_mfma_f32_4x4x4_16b_bf16 v[96:99], v[140:141], v[80:81], 0 cbsz:4 abid:13
    s_nop 0
    v_mfma_f32_4x4x4_16b_bf16 v[100:103], v[140:141], v[82:83], 0 cbsz:4 abid:13
    v_lshlrev_b32_sdwa v139, v15, v125 dst_sel:DWORD dst_unused:UNUSED_PAD src0_sel:DWORD src1_sel:WORD_1
    ds_read_u16_d16_hi v130, v138 offset:32768
    ds_read_u16_d16_hi v131, v139 offset:32768
    s_set_gpr_idx_on s51, 0xc
    v_pk_fma_f32 v[16:17], v[132:133], v[104:105], v[16:17] op_sel:[1,0,0] op_sel_hi:[1,1,1]
    v_pk_fma_f32 v[18:19], v[132:133], v[106:107], v[18:19] op_sel:[1,0,0] op_sel_hi:[1,1,1]
    v_pk_fma_f32 v[20:21], v[134:135], v[108:109], v[20:21] op_sel:[1,0,0] op_sel_hi:[1,1,1]
    v_pk_fma_f32 v[22:23], v[134:135], v[110:111], v[22:23] op_sel:[1,0,0] op_sel_hi:[1,1,1]
    s_set_gpr_idx_off
    s_sub_u32 s32, s32, 1
    s_cbranch_scc1 MAIN_DONE
    v_mfma_f32_4x4x4_16b_bf16 v[116:119], v[172:173], v[178:179], 0 cbsz:4 abid:14
    v_lshlrev_b32_sdwa v136, v15, v122 dst_sel:DWORD dst_unused:UNUSED_PAD src0_sel:DWORD src1_sel:WORD_1
    s_waitcnt vmcnt(8)
    v_mfma_f32_4x4x4_16b_bf16 v[104:107], v[142:143], v[84:85], 0 cbsz:4 abid:13
    s_nop 0
    v_mfma_f32_4x4x4_16b_bf16 v[108:111], v[142:143], v[86:87], 0 cbsz:4 abid:13
    v_lshlrev_b32_sdwa v137, v15, v123 dst_sel:DWORD dst_unused:UNUSED_PAD src0_sel:DWORD src1_sel:WORD_1
    ds_read_u16_d16_hi v132, v136 offset:32768
    ds_read_u16_d16_hi v133, v137 offset:32768
    s_waitcnt lgkmcnt(2)
    s_set_gpr_idx_on s52, 0xc
    v_pk_fma_f32 v[16:17], v[128:129], v[96:97], v[16:17] op_sel:[0,0,0] op_sel_hi:[0,1,1]
    v_pk_fma_f32 v[18:19], v[128:129], v[98:99], v[18:19] op_sel:[0,0,0] op_sel_hi:[0,1,1]
    v_pk_fma_f32 v[20:21], v[130:131], v[100:101], v[20:21] op_sel:[0,0,0] op_sel_hi:[0,1,1]
    v_pk_fma_f32 v[22:23], v[130:131], v[102:103], v[22:23] op_sel:[0,0,0] op_sel_hi:[0,1,1]
    s_set_gpr_idx_off
    s_sub_u32 s32, s32, 1
    s_cbranch_scc1 MAIN_DONE
    v_lshlrev_b32_sdwa v138, v15, v126 dst_sel:DWORD dst_unused:UNUSED_PAD src0_sel:DWORD src1_sel:WORD_1
    v_mfma_f32_4x4x4_16b_bf16 v[96:99], v[144:145], v[88:89], 0 cbsz:4 abid:13
    s_nop 0
    v_mfma_f32_4x4x4_16b_bf16 v[100:103], v[144:145], v[90:91], 0 cbsz:4 abid:13
    v_lshlrev_b32_sdwa v139, v15, v127 dst_sel:DWORD dst_unused:UNUSED_PAD src0_sel:DWORD src1_sel:WORD_1
    ds_read_u16_d16_hi v134, v138 offset:32768
    ds_read_u16_d16_hi v135, v139 offset:32768
    s_set_gpr_idx_on s53, 0xc
    v_pk_fma_f32 v[16:17], v[128:129], v[104:105], v[16:17] op_sel:[1,0,0] op_sel_hi:[1,1,1]
    v_pk_fma_f32 v[18:19], v[128:129], v[106:107], v[18:19] op_sel:[1,0,0] op_sel_hi:[1,1,1]
    v_pk_fma_f32 v[20:21], v[130:131], v[108:109], v[20:21] op_sel:[1,0,0] op_sel_hi:[1,1,1]
    v_pk_fma_f32 v[22:23], v[130:131], v[110:111], v[22:23] op_sel:[1,0,0] op_sel_hi:[1,1,1]
    s_set_gpr_idx_off
    s_branch MAIN_DONE
B_52:
    buffer_load_dwordx4 v[188:191], v1, s[16:19], s10 offen offset:0 sc1
    buffer_load_dwordx4 v[192:195], v1, s[16:19], s10 offen offset:1024 sc1
    buffer_load_dwordx4 v[196:199], v1, s[16:19], s10 offen offset:2048 sc1
    buffer_load_dwordx4 v[200:203], v1, s[16:19], s10 offen offset:3072 sc1
    buffer_load_dwordx4 v[204:207], v1, s[16:19], s11 offen offset:0 sc1
    buffer_load_dwordx4 v[208:211], v1, s[16:19], s11 offen offset:1024 sc1
    buffer_load_dwordx4 v[212:215], v1, s[16:19], s11 offen offset:2048 sc1
    buffer_load_dwordx4 v[216:219], v1, s[16:19], s11 offen offset:3072 sc1
    s_sub_u32 s32, s32, 1
    s_cbranch_scc1 MAIN_DONE
    v_mfma_f32_4x4x4_16b_bf16 v[116:119], v[172:173], v[178:179], 0 cbsz:4 abid:14
    v_lshlrev_b32_sdwa v136, v15, v122 dst_sel:DWORD dst_unused:UNUSED_PAD src0_sel:DWORD src1_sel:WORD_1
    s_waitcnt vmcnt(12)
    v_mfma_f32_4x4x4_16b_bf16 v[104:107], v[142:143], v[84:85], 0 cbsz:4 abid:13
    s_nop 0
    v_mfma_f32_4x4x4_16b_bf16 v[108:111], v[142:143], v[86:87], 0 cbsz:4 abid:13
    v_lshlrev_b32_sdwa v137, v15, v123 dst_sel:DWORD dst_unused:UNUSED_PAD src0_sel:DWORD src1_sel:WORD_1
    ds_read_u16_d16_hi v132, v136 offset:32768
    ds_read_u16_d16_hi v133, v137 offset:32768
    s_waitcnt lgkmcnt(2)
    s_set_gpr_idx_on s52, 0xc
    v_pk_fma_f32 v[16:17], v[128:129], v[96:97], v[16:17] op_sel:[0,0,0] op_sel_hi:[0,1,1]
    v_pk_fma_f32 v[18:19], v[128:129], v[98:99], v[18:19] op_sel:[0,0,0] op_sel_hi:[0,1,1]
    v_pk_fma_f32 v[20:21], v[130:131], v[100:101], v[20:21] op_sel:[0,0,0] op_sel_hi:[0,1,1]
    v_pk_fma_f32 v[22:23], v[130:131], v[102:103], v[22:23] op_sel:[0,0,0] op_sel_hi:[0,1,1]
    s_set_gpr_idx_off
    s_sub_u32 s32, s32, 1
    s_cbranch_scc1 MAIN_DONE
    v_lshlrev_b32_sdwa v138, v15, v126 dst_sel:DWORD dst_unused:UNUSED_PAD src0_sel:DWORD src1_sel:WORD_1
    s_waitcnt vmcnt(11)
    v_mfma_f32_4x4x4_16b_bf16 v[96:99], v[144:145], v[88:89], 0 cbsz:4 abid:13
    s_nop 0
    v_mfma_f32_4x4x4_16b_bf16 v[100:103], v[144:145], v[90:91], 0 cbsz:4 abid:13
    v_lshlrev_b32_sdwa v139, v15, v127 dst_sel:DWORD dst_unused:UNUSED_PAD src0_sel:DWORD src1_sel:WORD_1
    ds_read_u16_d16_hi v134, v138 offset:32768
    ds_read_u16_d16_hi v135, v139 offset:32768
    s_set_gpr_idx_on s53, 0xc
    v_pk_fma_f32 v[16:17], v[128:129], v[104:105], v[16:17] op_sel:[1,0,0] op_sel_hi:[1,1,1]
    v_pk_fma_f32 v[18:19], v[128:129], v[106:107], v[18:19] op_sel:[1,0,0] op_sel_hi:[1,1,1]
    v_pk_fma_f32 v[20:21], v[130:131], v[108:109], v[20:21] op_sel:[1,0,0] op_sel_hi:[1,1,1]
    v_pk_fma_f32 v[22:23], v[130:131], v[110:111], v[22:23] op_sel:[1,0,0] op_sel_hi:[1,1,1]
    s_set_gpr_idx_off
    s_sub_u32 s32, s32, 1
    s_cbranch_scc1 MAIN_DONE
    v_mfma_f32_4x4x4_16b_bf16 v[120:123], v[172:173], v[176:177], 0 cbsz:4 abid:15
    v_lshlrev_b32_sdwa v136, v15, v112 dst_sel:DWORD dst_unused:UNUSED_PAD src0_sel:DWORD src1_sel:WORD_1
    s_waitcnt vmcnt(10)
    v_mfma_f32_4x4x4_16b_bf16 v[104:107], v[146:147], v[92:93], 0 cbsz:4 abid:13
    s_nop 0
    v_mfma_f32_4x4x4_16b_bf16 v[108:111], v[146:147], v[94:95], 0 cbsz:4 abid:13
    v_lshlrev_b32_sdwa v137, v15, v113 dst_sel:DWORD dst_unused:UNUSED_PAD src0_sel:DWORD src1_sel:WORD_1
    ds_read_u16_d16_hi v128, v136 offset:32768
    ds_read_u16_d16_hi v129, v137 offset:32768
    s_waitcnt lgkmcnt(2)
    s_set_gpr_idx_on s54, 0xc
    v_pk_fma_f32 v[16:17], v[132:133], v[96:97], v[16:17] op_sel:[0,0,0] op_sel_hi:[0,1,1]
    v_pk_fma_f32 v[18:19], v[132:133], v[98:99], v[18:19] op_sel:[0,0,0] op_sel_hi:[0,1,1]
    v_pk_fma_f32 v[20:21], v[134:135], v[100:101], v[20:21] op_sel:[0,0,0] op_sel_hi:[0,1,1]
    v_pk_fma_f32 v[22:23], v[134:135], v[102:103], v[22:23] op_sel:[0,0,0] op_sel_hi:[0,1,1]
    s_set_gpr_idx_off
    s_sub_u32 s32, s32, 1
    s_cbranch_scc1 MAIN_DONE
    v_lshlrev_b32_sdwa v138, v15, v116 dst_sel:DWORD dst_unused:UNUSED_PAD src0_sel:DWORD src1_sel:WORD_1
    s_waitcnt vmcnt(9)
    v_mfma_f32_4x4x4_16b_bf16 v[96:99], v[140:141], v[64:65], 0 cbsz:4 abid:14
    s_nop 0
    v_mfma_f32_4x4x4_16b_bf16 v[100:103], v[140:141], v[66:67], 0 cbsz:4 abid:14
    v_lshlrev_b32_sdwa v139, v15, v117 dst_sel:DWORD dst_unused:UNUSED_PAD src0_sel:DWORD src1_sel:WORD_1
    ds_read_u16_d16_hi v130, v138 offset:32768
    ds_read_u16_d16_hi v131, v139 offset:32768
    s_set_gpr_idx_on s55, 0xc
    v_pk_fma_f32 v[16:17], v[132:133], v[104:105], v[16:17] op_sel:[1,0,0] op_sel_hi:[1,1,1]
    v_pk_fma_f32 v[18:19], v[132:133], v[106:107], v[18:19] op_sel:[1,0,0] op_sel_hi:[1,1,1]
    v_pk_fma_f32 v[20:21], v[134:135], v[108:109], v[20:21] op_sel:[1,0,0] op_sel_hi:[1,1,1]
    v_pk_fma_f32 v[22:23], v[134:135], v[110:111], v[22:23] op_sel:[1,0,0] op_sel_hi:[1,1,1]
    s_set_gpr_idx_off
    s_sub_u32 s32, s32, 1
    s_cbranch_scc1 MAIN_DONE
    v_mfma_f32_4x4x4_16b_bf16 v[124:127], v[172:173], v[178:179], 0 cbsz:4 abid:15
    v_lshlrev_b32_sdwa v136, v15, v114 dst_sel:DWORD dst_unused:UNUSED_PAD src0_sel:DWORD src1_sel:WORD_1
    s_waitcnt vmcnt(8)
    v_mfma_f32_4x4x4_16b_bf16 v[104:107], v[142:143], v[68:69], 0 cbsz:4 abid:14
    s_nop 0
    v_mfma_f32_4x4x4_16b_bf16 v[108:111], v[142:143], v[70:71], 0 cbsz:4 abid:14
    v_lshlrev_b32_sdwa v137, v15, v115 dst_sel:DWORD dst_unused:UNUSED_PAD src0_sel:DWORD src1_sel:WORD_1
    ds_read_u16_d16_hi v132, v136 offset:32768
    ds_read_u16_d16_hi v133, v137 offset:32768
    s_waitcnt lgkmcnt(2)
    s_set_gpr_idx_on s56, 0xc
    v_pk_fma_f32 v[16:17], v[128:129], v[96:97], v[16:17] op_sel:[0,0,0] op_sel_hi:[0,1,1]
    v_pk_fma_f32 v[18:19], v[128:129], v[98:99], v[18:19] op_sel:[0,0,0] op_sel_hi:[0,1,1]
    v_pk_fma_f32 v[20:21], v[130:131], v[100:101], v[20:21] op_sel:[0,0,0] op_sel_hi:[0,1,1]
    v_pk_fma_f32 v[22:23], v[130:131], v[102:103], v[22:23] op_sel:[0,0,0] op_sel_hi:[0,1,1]
    s_set_gpr_idx_off
    s_sub_u32 s32, s32, 1
    s_cbranch_scc1 MAIN_DONE
    v_lshlrev_b32_sdwa v138, v15, v118 dst_sel:DWORD dst_unused:UNUSED_PAD src0_sel:DWORD src1_sel:WORD_1
    v_mfma_f32_4x4x4_16b_bf16 v[96:99], v[144:145], v[72:73], 0 cbsz:4 abid:14
    s_nop 0
    v_mfma_f32_4x4x4_16b_bf16 v[100:103], v[144:145], v[74:75], 0 cbsz:4 abid:14
    v_lshlrev_b32_sdwa v139, v15, v119 dst_sel:DWORD dst_unused:UNUSED_PAD src0_sel:DWORD src1_sel:WORD_1
    ds_read_u16_d16_hi v134, v138 offset:32768
    ds_read_u16_d16_hi v135, v139 offset:32768
    s_set_gpr_idx_on s57, 0xc
    v_pk_fma_f32 v[16:17], v[128:129], v[104:105], v[16:17] op_sel:[1,0,0] op_sel_hi:[1,1,1]
    v_pk_fma_f32 v[18:19], v[128:129], v[106:107], v[18:19] op_sel:[1,0,0] op_sel_hi:[1,1,1]
    v_pk_fma_f32 v[20:21], v[130:131], v[108:109], v[20:21] op_sel:[1,0,0] op_sel_hi:[1,1,1]
    v_pk_fma_f32 v[22:23], v[130:131], v[110:111], v[22:23] op_sel:[1,0,0] op_sel_hi:[1,1,1]
    s_set_gpr_idx_off
    v_mov_b32 v172, v170
    v_mov_b32 v173, v171
    s_nop 1
    s_branch MAIN_DONE
B_56:
    buffer_load_dwordx4 v[188:191], v1, s[16:19], s10 offen offset:0 sc1
    buffer_load_dwordx4 v[192:195], v1, s[16:19], s10 offen offset:1024 sc1
    buffer_load_dwordx4 v[196:199], v1, s[16:19], s10 offen offset:2048 sc1
    buffer_load_dwordx4 v[200:203], v1, s[16:19], s10 offen offset:3072 sc1
    buffer_load_dwordx4 v[204:207], v1, s[16:19], s11 offen offset:0 sc1
    buffer_load_dwordx4 v[208:211], v1, s[16:19], s11 offen offset:1024 sc1
    buffer_load_dwordx4 v[212:215], v1, s[16:19], s11 offen offset:2048 sc1
    buffer_load_dwordx4 v[216:219], v1, s[16:19], s11 offen offset:3072 sc1
    s_sub_u32 s32, s32, 1
    s_cbranch_scc1 MAIN_DONE
    v_mfma_f32_4x4x4_16b_bf16 v[124:127], v[172:173], v[178:179], 0 cbsz:4 abid:15
    v_lshlrev_b32_sdwa v136, v15, v114 dst_sel:DWORD dst_unused:UNUSED_PAD src0_sel:DWORD src1_sel:WORD_1
    s_waitcnt vmcnt(12)
    v_mfma_f32_4x4x4_16b_bf16 v[104:107], v[142:143], v[68:69], 0 cbsz:4 abid:14
    s_nop 0
    v_mfma_f32_4x4x4_16b_bf16 v[108:111], v[142:143], v[70:71], 0 cbsz:4 abid:14
    v_lshlrev_b32_sdwa v137, v15, v115 dst_sel:DWORD dst_unused:UNUSED_PAD src0_sel:DWORD src1_sel:WORD_1
    ds_read_u16_d16_hi v132, v136 offset:32768
    ds_read_u16_d16_hi v133, v137 offset:32768
    s_waitcnt lgkmcnt(2)
    s_set_gpr_idx_on s56, 0xc
    v_pk_fma_f32 v[16:17], v[128:129], v[96:97], v[16:17] op_sel:[0,0,0] op_sel_hi:[0,1,1]
    v_pk_fma_f32 v[18:19], v[128:129], v[98:99], v[18:19] op_sel:[0,0,0] op_sel_hi:[0,1,1]
    v_pk_fma_f32 v[20:21], v[130:131], v[100:101], v[20:21] op_sel:[0,0,0] op_sel_hi:[0,1,1]
    v_pk_fma_f32 v[22:23], v[130:131], v[102:103], v[22:23] op_sel:[0,0,0] op_sel_hi:[0,1,1]
    s_set_gpr_idx_off
    s_sub_u32 s32, s32, 1
    s_cbranch_scc1 MAIN_DONE
    v_lshlrev_b32_sdwa v138, v15, v118 dst_sel:DWORD dst_unused:UNUSED_PAD src0_sel:DWORD src1_sel:WORD_1
    s_waitcnt vmcnt(11)
    v_mfma_f32_4x4x4_16b_bf16 v[96:99], v[144:145], v[72:73], 0 cbsz:4 abid:14
    s_nop 0
    v_mfma_f32_4x4x4_16b_bf16 v[100:103], v[144:145], v[74:75], 0 cbsz:4 abid:14
    v_lshlrev_b32_sdwa v139, v15, v119 dst_sel:DWORD dst_unused:UNUSED_PAD src0_sel:DWORD src1_sel:WORD_1
    ds_read_u16_d16_hi v134, v138 offset:32768
    ds_read_u16_d16_hi v135, v139 offset:32768
    s_set_gpr_idx_on s57, 0xc
    v_pk_fma_f32 v[16:17], v[128:129], v[104:105], v[16:17] op_sel:[1,0,0] op_sel_hi:[1,1,1]
    v_pk_fma_f32 v[18:19], v[128:129], v[106:107], v[18:19] op_sel:[1,0,0] op_sel_hi:[1,1,1]
    v_pk_fma_f32 v[20:21], v[130:131], v[108:109], v[20:21] op_sel:[1,0,0] op_sel_hi:[1,1,1]
    v_pk_fma_f32 v[22:23], v[130:131], v[110:111], v[22:23] op_sel:[1,0,0] op_sel_hi:[1,1,1]
    s_set_gpr_idx_off
    v_mov_b32 v172, v170
    v_mov_b32 v173, v171
    s_nop 1
    s_sub_u32 s32, s32, 1
    s_cbranch_scc1 MAIN_DONE
    v_mfma_f32_4x4x4_16b_bf16 v[112:115], v[172:173], v[176:177], 0 cbsz:4 abid:0
    v_lshlrev_b32_sdwa v136, v15, v120 dst_sel:DWORD dst_unused:UNUSED_PAD src0_sel:DWORD src1_sel:WORD_1
    s_waitcnt vmcnt(10)
    v_mfma_f32_4x4x4_16b_bf16 v[104:107], v[146:147], v[76:77], 0 cbsz:4 abid:14
    s_nop 0
    v_mfma_f32_4x4x4_16b_bf16 v[108:111], v[146:147], v[78:79], 0 cbsz:4 abid:14
    v_lshlrev_b32_sdwa v137, v15, v121 dst_sel:DWORD dst_unused:UNUSED_PAD src0_sel:DWORD src1_sel:WORD_1
    ds_read_u16_d16_hi v128, v136 offset:32768
    ds_read_u16_d16_hi v129, v137 offset:32768
    s_waitcnt lgkmcnt(2)
    s_set_gpr_idx_on s58, 0xc
    v_pk_fma_f32 v[16:17], v[132:133], v[96:97], v[16:17] op_sel:[0,0,0] op_sel_hi:[0,1,1]
    v_pk_fma_f32 v[18:19], v[132:133], v[98:99], v[18:19] op_sel:[0,0,0] op_sel_hi:[0,1,1]
    v_pk_fma_f32 v[20:21], v[134:135], v[100:101], v[20:21] op_sel:[0,0,0] op_sel_hi:[0,1,1]
    v_pk_fma_f32 v[22:23], v[134:135], v[102:103], v[22:23] op_sel:[0,0,0] op_sel_hi:[0,1,1]
    s_set_gpr_idx_off
    s_sub_u32 s32, s32, 1
    s_cbranch_scc1 MAIN_DONE
    v_lshlrev_b32_sdwa v138, v15, v124 dst_sel:DWORD dst_unused:UNUSED_PAD src0_sel:DWORD src1_sel:WORD_1
    s_waitcnt vmcnt(9)
    v_mfma_f32_4x4x4_16b_bf16 v[96:99], v[140:141], v[80:81], 0 cbsz:4 abid:15
    s_nop 0
    v_mfma_f32_4x4x4_16b_bf16 v[100:103], v[140:141], v[82:83], 0 cbsz:4 abid:15
    v_lshlrev_b32_sdwa v139, v15, v125 dst_sel:DWORD dst_unused:UNUSED_PAD src0_sel:DWORD src1_sel:WORD_1
    ds_read_u16_d16_hi v130, v138 offset:32768
    ds_read_u16_d16_hi v131, v139 offset:32768
    s_set_gpr_idx_on s59, 0xc
    v_pk_fma_f32 v[16:17], v[132:133], v[104:105], v[16:17] op_sel:[1,0,0] op_sel_hi:[1,1,1]
    v_pk_fma_f32 v[18:19], v[132:133], v[106:107], v[18:19] op_sel:[1,0,0] op_sel_hi:[1,1,1]
    v_pk_fma_f32 v[20:21], v[134:135], v[108:109], v[20:21] op_sel:[1,0,0] op_sel_hi:[1,1,1]
    v_pk_fma_f32 v[22:23], v[134:135], v[110:111], v[22:23] op_sel:[1,0,0] op_sel_hi:[1,1,1]
    s_set_gpr_idx_off
    s_sub_u32 s32, s32, 1
    s_cbranch_scc1 MAIN_DONE
    v_mfma_f32_4x4x4_16b_bf16 v[116:119], v[172:173], v[178:179], 0 cbsz:4 abid:0
    v_lshlrev_b32_sdwa v136, v15, v122 dst_sel:DWORD dst_unused:UNUSED_PAD src0_sel:DWORD src1_sel:WORD_1
    s_waitcnt vmcnt(8)
    v_mfma_f32_4x4x4_16b_bf16 v[104:107], v[142:143], v[84:85], 0 cbsz:4 abid:15
    s_nop 0
    v_mfma_f32_4x4x4_16b_bf16 v[108:111], v[142:143], v[86:87], 0 cbsz:4 abid:15
    v_lshlrev_b32_sdwa v137, v15, v123 dst_sel:DWORD dst_unused:UNUSED_PAD src0_sel:DWORD src1_sel:WORD_1
    ds_read_u16_d16_hi v132, v136 offset:32768
    ds_read_u16_d16_hi v133, v137 offset:32768
    v_cvt_pk_bf16_f32 v140, v148, v152
    v_cvt_pk_bf16_f32 v141, v156, v160
    s_waitcnt lgkmcnt(2)
    s_set_gpr_idx_on s60, 0xc
    v_pk_fma_f32 v[16:17], v[128:129], v[96:97], v[16:17] op_sel:[0,0,0] op_sel_hi:[0,1,1]
    v_pk_fma_f32 v[18:19], v[128:129], v[98:99], v[18:19] op_sel:[0,0,0] op_sel_hi:[0,1,1]
    v_pk_fma_f32 v[20:21], v[130:131], v[100:101], v[20:21] op_sel:[0,0,0] op_sel_hi:[0,1,1]
    v_pk_fma_f32 v[22:23], v[130:131], v[102:103], v[22:23] op_sel:[0,0,0] op_sel_hi:[0,1,1]
    s_set_gpr_idx_off
    s_sub_u32 s32, s32, 1
    s_cbranch_scc1 MAIN_DONE
    v_lshlrev_b32_sdwa v138, v15, v126 dst_sel:DWORD dst_unused:UNUSED_PAD src0_sel:DWORD src1_sel:WORD_1
    v_mfma_f32_4x4x4_16b_bf16 v[96:99], v[144:145], v[88:89], 0 cbsz:4 abid:15
    s_nop 0
    v_mfma_f32_4x4x4_16b_bf16 v[100:103], v[144:145], v[90:91], 0 cbsz:4 abid:15
    v_lshlrev_b32_sdwa v139, v15, v127 dst_sel:DWORD dst_unused:UNUSED_PAD src0_sel:DWORD src1_sel:WORD_1
    ds_read_u16_d16_hi v134, v138 offset:32768
    ds_read_u16_d16_hi v135, v139 offset:32768
    v_cvt_pk_bf16_f32 v142, v149, v153
    v_cvt_pk_bf16_f32 v143, v157, v161
    s_set_gpr_idx_on s61, 0xc
    v_pk_fma_f32 v[16:17], v[128:129], v[104:105], v[16:17] op_sel:[1,0,0] op_sel_hi:[1,1,1]
    v_pk_fma_f32 v[18:19], v[128:129], v[106:107], v[18:19] op_sel:[1,0,0] op_sel_hi:[1,1,1]
    v_pk_fma_f32 v[20:21], v[130:131], v[108:109], v[20:21] op_sel:[1,0,0] op_sel_hi:[1,1,1]
    v_pk_fma_f32 v[22:23], v[130:131], v[110:111], v[22:23] op_sel:[1,0,0] op_sel_hi:[1,1,1]
    s_set_gpr_idx_off
    s_branch MAIN_DONE
B_60:
    buffer_load_dwordx4 v[188:191], v1, s[16:19], s10 offen offset:0 sc1
    buffer_load_dwordx4 v[192:195], v1, s[16:19], s10 offen offset:1024 sc1
    buffer_load_dwordx4 v[196:199], v1, s[16:19], s10 offen offset:2048 sc1
    buffer_load_dwordx4 v[200:203], v1, s[16:19], s10 offen offset:3072 sc1
    buffer_load_dwordx4 v[204:207], v1, s[16:19], s11 offen offset:0 sc1
    buffer_load_dwordx4 v[208:211], v1, s[16:19], s11 offen offset:1024 sc1
    buffer_load_dwordx4 v[212:215], v1, s[16:19], s11 offen offset:2048 sc1
    buffer_load_dwordx4 v[216:219], v1, s[16:19], s11 offen offset:3072 sc1
    s_sub_u32 s32, s32, 1
    s_cbranch_scc1 MAIN_DONE
    v_mfma_f32_4x4x4_16b_bf16 v[116:119], v[172:173], v[178:179], 0 cbsz:4 abid:0
    v_lshlrev_b32_sdwa v136, v15, v122 dst_sel:DWORD dst_unused:UNUSED_PAD src0_sel:DWORD src1_sel:WORD_1
    s_waitcnt vmcnt(12)
    v_mfma_f32_4x4x4_16b_bf16 v[104:107], v[142:143], v[84:85], 0 cbsz:4 abid:15
    s_nop 0
    v_mfma_f32_4x4x4_16b_bf16 v[108:111], v[142:143], v[86:87], 0 cbsz:4 abid:15
    v_lshlrev_b32_sdwa v137, v15, v123 dst_sel:DWORD dst_unused:UNUSED_PAD src0_sel:DWORD src1_sel:WORD_1
    ds_read_u16_d16_hi v132, v136 offset:32768
    ds_read_u16_d16_hi v133, v137 offset:32768
    v_cvt_pk_bf16_f32 v140, v148, v152
    v_cvt_pk_bf16_f32 v141, v156, v160
    s_waitcnt lgkmcnt(2)
    s_set_gpr_idx_on s60, 0xc
    v_pk_fma_f32 v[16:17], v[128:129], v[96:97], v[16:17] op_sel:[0,0,0] op_sel_hi:[0,1,1]
    v_pk_fma_f32 v[18:19], v[128:129], v[98:99], v[18:19] op_sel:[0,0,0] op_sel_hi:[0,1,1]
    v_pk_fma_f32 v[20:21], v[130:131], v[100:101], v[20:21] op_sel:[0,0,0] op_sel_hi:[0,1,1]
    v_pk_fma_f32 v[22:23], v[130:131], v[102:103], v[22:23] op_sel:[0,0,0] op_sel_hi:[0,1,1]
    s_set_gpr_idx_off
    s_sub_u32 s32, s32, 1
    s_cbranch_scc1 MAIN_DONE
    v_lshlrev_b32_sdwa v138, v15, v126 dst_sel:DWORD dst_unused:UNUSED_PAD src0_sel:DWORD src1_sel:WORD_1
    s_waitcnt vmcnt(11)
    v_mfma_f32_4x4x4_16b_bf16 v[96:99], v[144:145], v[88:89], 0 cbsz:4 abid:15
    s_nop 0
    v_mfma_f32_4x4x4_16b_bf16 v[100:103], v[144:145], v[90:91], 0 cbsz:4 abid:15
    v_lshlrev_b32_sdwa v139, v15, v127 dst_sel:DWORD dst_unused:UNUSED_PAD src0_sel:DWORD src1_sel:WORD_1
    ds_read_u16_d16_hi v134, v138 offset:32768
    ds_read_u16_d16_hi v135, v139 offset:32768
    v_cvt_pk_bf16_f32 v142, v149, v153
    v_cvt_pk_bf16_f32 v143, v157, v161
    s_set_gpr_idx_on s61, 0xc
    v_pk_fma_f32 v[16:17], v[128:129], v[104:105], v[16:17] op_sel:[1,0,0] op_sel_hi:[1,1,1]
    v_pk_fma_f32 v[18:19], v[128:129], v[106:107], v[18:19] op_sel:[1,0,0] op_sel_hi:[1,1,1]
    v_pk_fma_f32 v[20:21], v[130:131], v[108:109], v[20:21] op_sel:[1,0,0] op_sel_hi:[1,1,1]
    v_pk_fma_f32 v[22:23], v[130:131], v[110:111], v[22:23] op_sel:[1,0,0] op_sel_hi:[1,1,1]
    s_set_gpr_idx_off
    s_sub_u32 s32, s32, 1
    s_cbranch_scc1 MAIN_DONE
    v_mfma_f32_4x4x4_16b_bf16 v[120:123], v[172:173], v[176:177], 0 cbsz:4 abid:1
    v_lshlrev_b32_sdwa v136, v15, v112 dst_sel:DWORD dst_unused:UNUSED_PAD src0_sel:DWORD src1_sel:WORD_1
    s_waitcnt vmcnt(10)
    v_mfma_f32_4x4x4_16b_bf16 v[104:107], v[146:147], v[92:93], 0 cbsz:4 abid:15
    s_nop 0
    v_mfma_f32_4x4x4_16b_bf16 v[108:111], v[146:147], v[94:95], 0 cbsz:4 abid:15
    v_lshlrev_b32_sdwa v137, v15, v113 dst_sel:DWORD dst_unused:UNUSED_PAD src0_sel:DWORD src1_sel:WORD_1
    ds_read_u16_d16_hi v128, v136 offset:32768
    ds_read_u16_d16_hi v129, v137 offset:32768
    v_cvt_pk_bf16_f32 v144, v150, v154
    v_cvt_pk_bf16_f32 v145, v158, v162
    s_waitcnt lgkmcnt(2)
    s_set_gpr_idx_on s62, 0xc
    v_pk_fma_f32 v[16:17], v[132:133], v[96:97], v[16:17] op_sel:[0,0,0] op_sel_hi:[0,1,1]
    v_pk_fma_f32 v[18:19], v[132:133], v[98:99], v[18:19] op_sel:[0,0,0] op_sel_hi:[0,1,1]
    v_pk_fma_f32 v[20:21], v[134:135], v[100:101], v[20:21] op_sel:[0,0,0] op_sel_hi:[0,1,1]
    v_pk_fma_f32 v[22:23], v[134:135], v[102:103], v[22:23] op_sel:[0,0,0] op_sel_hi:[0,1,1]
    s_set_gpr_idx_off
    s_sub_u32 s32, s32, 1
    s_cbranch_scc1 MAIN_DONE
    v_lshlrev_b32_sdwa v138, v15, v116 dst_sel:DWORD dst_unused:UNUSED_PAD src0_sel:DWORD src1_sel:WORD_1
    s_waitcnt vmcnt(9)
    v_mfma_f32_4x4x4_16b_bf16 v[96:99], v[140:141], v[64:65], 0 cbsz:4 abid:0
    s_nop 0
    v_mfma_f32_4x4x4_16b_bf16 v[100:103], v[140:141], v[66:67], 0 cbsz:4 abid:0
    v_lshlrev_b32_sdwa v139, v15, v117 dst_sel:DWORD dst_unused:UNUSED_PAD src0_sel:DWORD src1_sel:WORD_1
    ds_read_u16_d16_hi v130, v138 offset:32768
    ds_read_u16_d16_hi v131, v139 offset:32768
    v_cvt_pk_bf16_f32 v146, v151, v155
    v_cvt_pk_bf16_f32 v147, v159, v163
    s_set_gpr_idx_on s63, 0xc
    v_pk_fma_f32 v[16:17], v[132:133], v[104:105], v[16:17] op_sel:[1,0,0] op_sel_hi:[1,1,1]
    v_pk_fma_f32 v[18:19], v[132:133], v[106:107], v[18:19] op_sel:[1,0,0] op_sel_hi:[1,1,1]
    v_pk_fma_f32 v[20:21], v[134:135], v[108:109], v[20:21] op_sel:[1,0,0] op_sel_hi:[1,1,1]
    v_pk_fma_f32 v[22:23], v[134:135], v[110:111], v[22:23] op_sel:[1,0,0] op_sel_hi:[1,1,1]
    s_set_gpr_idx_off
    s_sub_u32 s32, s32, 1
    s_cbranch_scc1 MAIN_DONE
    v_mfma_f32_4x4x4_16b_bf16 v[124:127], v[172:173], v[178:179], 0 cbsz:4 abid:1
    v_lshlrev_b32_sdwa v136, v15, v114 dst_sel:DWORD dst_unused:UNUSED_PAD src0_sel:DWORD src1_sel:WORD_1
    s_waitcnt vmcnt(8)
    v_mfma_f32_4x4x4_16b_bf16 v[104:107], v[142:143], v[68:69], 0 cbsz:4 abid:0
    s_nop 0
    v_mfma_f32_4x4x4_16b_bf16 v[108:111], v[142:143], v[70:71], 0 cbsz:4 abid:0
    v_lshlrev_b32_sdwa v137, v15, v115 dst_sel:DWORD dst_unused:UNUSED_PAD src0_sel:DWORD src1_sel:WORD_1
    ds_read_u16_d16_hi v132, v136 offset:32768
    ds_read_u16_d16_hi v133, v137 offset:32768
    s_waitcnt lgkmcnt(2)
    s_set_gpr_idx_on s48, 0xc
    v_pk_fma_f32 v[16:17], v[128:129], v[96:97], v[16:17] op_sel:[0,0,0] op_sel_hi:[0,1,1]
    v_pk_fma_f32 v[18:19], v[128:129], v[98:99], v[18:19] op_sel:[0,0,0] op_sel_hi:[0,1,1]
    v_pk_fma_f32 v[20:21], v[130:131], v[100:101], v[20:21] op_sel:[0,0,0] op_sel_hi:[0,1,1]
    v_pk_fma_f32 v[22:23], v[130:131], v[102:103], v[22:23] op_sel:[0,0,0] op_sel_hi:[0,1,1]
    s_set_gpr_idx_off
    s_sub_u32 s32, s32, 1
    s_cbranch_scc1 MAIN_DONE
    v_lshlrev_b32_sdwa v138, v15, v118 dst_sel:DWORD dst_unused:UNUSED_PAD src0_sel:DWORD src1_sel:WORD_1
    v_mfma_f32_4x4x4_16b_bf16 v[96:99], v[144:145], v[72:73], 0 cbsz:4 abid:0
    s_nop 0
    v_mfma_f32_4x4x4_16b_bf16 v[100:103], v[144:145], v[74:75], 0 cbsz:4 abid:0
    v_lshlrev_b32_sdwa v139, v15, v119 dst_sel:DWORD dst_unused:UNUSED_PAD src0_sel:DWORD src1_sel:WORD_1
    ds_read_u16_d16_hi v134, v138 offset:32768
    ds_read_u16_d16_hi v135, v139 offset:32768
    s_set_gpr_idx_on s49, 0xc
    v_pk_fma_f32 v[16:17], v[128:129], v[104:105], v[16:17] op_sel:[1,0,0] op_sel_hi:[1,1,1]
    v_pk_fma_f32 v[18:19], v[128:129], v[106:107], v[18:19] op_sel:[1,0,0] op_sel_hi:[1,1,1]
    v_pk_fma_f32 v[20:21], v[130:131], v[108:109], v[20:21] op_sel:[1,0,0] op_sel_hi:[1,1,1]
    v_pk_fma_f32 v[22:23], v[130:131], v[110:111], v[22:23] op_sel:[1,0,0] op_sel_hi:[1,1,1]
    s_set_gpr_idx_off
    s_branch MAIN_DONE
MAIN_DONE:
    s_add_u32 s27, s27, 1472
    s_cmp_ge_u32 s27, s26
    s_cbranch_scc1 ALL_DONE
    s_waitcnt vmcnt(0) lgkmcnt(0)
    v_lshlrev_b32 v11, 2, v0
    v_mov_b32 v12, 0
    v_cmp_gt_u32 vcc, 0x100, v0
    s_and_saveexec_b64 s[42:43], vcc
    ds_write_b32 v11, v12 offset:0
    s_mov_b64 exec, s[42:43]
    s_waitcnt lgkmcnt(0)
    s_barrier
    s_branch ROUND
ALL_DONE:
    v_lshrrev_b32 v11, 8, v1
    s_lshr_b32 s42, s25, 2
    s_mul_i32 s43, s42, 80
    v_mul_u32_u24 v9, 20, v11
    v_add_u32 v9, s43, v9
    ds_read_b32 v112, v9 offset:1344
    ds_read_b32 v113, v9 offset:1348
    ds_read_b32 v114, v9 offset:1352
    ds_read_b32 v115, v9 offset:1356
    ds_read_b32 v116, v9 offset:1360
    v_cvt_pk_bf16_f32 v140, v16, v20
    v_cvt_pk_bf16_f32 v141, v17, v21
    v_cvt_pk_bf16_f32 v142, v18, v22
    v_cvt_pk_bf16_f32 v143, v19, v23
    v_cvt_pk_bf16_f32 v144, v24, v28
    v_cvt_pk_bf16_f32 v145, v25, v29
    v_cvt_pk_bf16_f32 v146, v26, v30
    v_cvt_pk_bf16_f32 v147, v27, v31
    v_cvt_pk_bf16_f32 v148, v32, v36
    v_cvt_pk_bf16_f32 v149, v33, v37
    v_cvt_pk_bf16_f32 v150, v34, v38
    v_cvt_pk_bf16_f32 v151, v35, v39
    v_cvt_pk_bf16_f32 v152, v40, v44
    v_cvt_pk_bf16_f32 v153, v41, v45
    v_cvt_pk_bf16_f32 v154, v42, v46
    v_cvt_pk_bf16_f32 v155, v43, v47
    v_cvt_pk_bf16_f32 v156, v48, v52
    v_cvt_pk_bf16_f32 v157, v49, v53
    v_cvt_pk_bf16_f32 v158, v50, v54
    v_cvt_pk_bf16_f32 v159, v51, v55
    s_mul_i32 s43, s25, 1152
    s_add_u32 s43, s43, 32768
    v_lshrrev_b32 v12, 2, v1
    v_add_u32 v12, s43, v12
    v_bfe_u32 v10, v1, 4, 4
    s_mul_i32 s43, s42, 4608
    s_add_u32 s43, s43, 32768
    v_mul_u32_u24 v8, 288, v10
    v_lshl_add_u32 v8, v11, 4, v8
    v_add_u32 v8, s43, v8
    s_lshl_b32 s42, s24, 10
    s_and_b32 s43, s25, 3
    s_lshl_b32 s43, s43, 8
    s_add_u32 s42, s42, s43
    v_lshl_add_u32 v10, v10, 4, s42
    s_waitcnt lgkmcnt(0)
    v_lshl_add_u32 v112, v112, 18, v10
    v_lshl_add_u32 v113, v113, 18, v10
    v_lshl_add_u32 v114, v114, 18, v10
    v_lshl_add_u32 v115, v115, 18, v10
    v_lshl_add_u32 v116, v116, 18, v10
    s_barrier
    ds_write_b32 v12, v140 offset:0
    ds_write_b32 v12, v141 offset:288
    ds_write_b32 v12, v142 offset:576
    ds_write_b32 v12, v143 offset:864
    ds_write_b32 v12, v144 offset:9216
    ds_write_b32 v12, v145 offset:9504
    ds_write_b32 v12, v146 offset:9792
    ds_write_b32 v12, v147 offset:10080
    s_waitcnt vmcnt(0) lgkmcnt(0)
    s_barrier
    ds_read_b128 v[64:67], v8 offset:0
    ds_read_b128 v[68:71], v8 offset:64
    ds_read_b128 v[72:75], v8 offset:128
    ds_read_b128 v[76:79], v8 offset:192
    ds_read_b128 v[80:83], v8 offset:9216
    ds_read_b128 v[84:87], v8 offset:9280
    ds_read_b128 v[88:91], v8 offset:9344
    ds_read_b128 v[92:95], v8 offset:9408
    s_waitcnt lgkmcnt(7)
    v_mfma_f32_16x16x32_bf16 v[16:19], v[64:67], v[188:191], 0
    v_mfma_f32_16x16x32_bf16 v[20:23], v[64:67], v[204:207], 0
    ds_write_b32 v12, v148 offset:18432
    ds_write_b32 v12, v149 offset:18720
    ds_write_b32 v12, v150 offset:19008
    s_waitcnt lgkmcnt(9)
    v_mfma_f32_16x16x32_bf16 v[16:19], v[68:71], v[192:195], v[16:19]
    v_mfma_f32_16x16x32_bf16 v[20:23], v[68:71], v[208:211], v[20:23]
    ds_write_b32 v12, v151 offset:19296
    ds_write_b32 v12, v152 offset:27648
    ds_write_b32 v12, v153 offset:27936
    s_waitcnt lgkmcnt(11)
    v_mfma_f32_16x16x32_bf16 v[16:19], v[72:75], v[196:199], v[16:19]
    v_mfma_f32_16x16x32_bf16 v[20:23], v[72:75], v[212:215], v[20:23]
    ds_write_b32 v12, v154 offset:28224
    ds_write_b32 v12, v155 offset:28512
    ds_write_b32 v12, v156 offset:36864
    s_waitcnt lgkmcnt(13)
    v_mfma_f32_16x16x32_bf16 v[16:19], v[76:79], v[200:203], v[16:19]
    v_mfma_f32_16x16x32_bf16 v[20:23], v[76:79], v[216:219], v[20:23]
    ds_write_b32 v12, v157 offset:37152
    ds_write_b32 v12, v158 offset:37440
    ds_write_b32 v12, v159 offset:37728
    s_waitcnt lgkmcnt(0)
    s_barrier
    ds_read_b128 v[64:67], v8 offset:18432
    ds_read_b128 v[68:71], v8 offset:18496
    ds_read_b128 v[72:75], v8 offset:18560
    ds_read_b128 v[76:79], v8 offset:18624
    v_mfma_f32_16x16x32_bf16 v[24:27], v[80:83], v[188:191], 0
    v_mfma_f32_16x16x32_bf16 v[28:31], v[80:83], v[204:207], 0
    v_mfma_f32_16x16x32_bf16 v[24:27], v[84:87], v[192:195], v[24:27]
    v_mfma_f32_16x16x32_bf16 v[28:31], v[84:87], v[208:211], v[28:31]
    v_mfma_f32_16x16x32_bf16 v[24:27], v[88:91], v[196:199], v[24:27]
    v_mfma_f32_16x16x32_bf16 v[28:31], v[88:91], v[212:215], v[28:31]
    v_mfma_f32_16x16x32_bf16 v[24:27], v[92:95], v[200:203], v[24:27]
    v_mfma_f32_16x16x32_bf16 v[28:31], v[92:95], v[216:219], v[28:31]
    v_cvt_pk_bf16_f32 v128, v16, v17
    v_cvt_pk_bf16_f32 v129, v18, v19
    v_cvt_pk_bf16_f32 v130, v20, v21
    v_cvt_pk_bf16_f32 v131, v22, v23
    buffer_store_dwordx4 v[128:131], v112, s[20:23], 0 offen sc0 sc1
    ds_read_b128 v[80:83], v8 offset:27648
    ds_read_b128 v[84:87], v8 offset:27712
    ds_read_b128 v[88:91], v8 offset:27776
    ds_read_b128 v[92:95], v8 offset:27840
    s_waitcnt lgkmcnt(7)
    v_mfma_f32_16x16x32_bf16 v[32:35], v[64:67], v[188:191], 0
    v_mfma_f32_16x16x32_bf16 v[36:39], v[64:67], v[204:207], 0
    s_waitcnt lgkmcnt(6)
    v_mfma_f32_16x16x32_bf16 v[32:35], v[68:71], v[192:195], v[32:35]
    v_mfma_f32_16x16x32_bf16 v[36:39], v[68:71], v[208:211], v[36:39]
    s_waitcnt lgkmcnt(5)
    v_mfma_f32_16x16x32_bf16 v[32:35], v[72:75], v[196:199], v[32:35]
    v_mfma_f32_16x16x32_bf16 v[36:39], v[72:75], v[212:215], v[36:39]
    s_waitcnt lgkmcnt(4)
    v_mfma_f32_16x16x32_bf16 v[32:35], v[76:79], v[200:203], v[32:35]
    v_mfma_f32_16x16x32_bf16 v[36:39], v[76:79], v[216:219], v[36:39]
    v_cvt_pk_bf16_f32 v132, v24, v25
    v_cvt_pk_bf16_f32 v133, v26, v27
    v_cvt_pk_bf16_f32 v134, v28, v29
    v_cvt_pk_bf16_f32 v135, v30, v31
    buffer_store_dwordx4 v[132:135], v113, s[20:23], 0 offen sc0 sc1
    ds_read_b128 v[64:67], v8 offset:36864
    ds_read_b128 v[68:71], v8 offset:36928
    ds_read_b128 v[72:75], v8 offset:36992
    ds_read_b128 v[76:79], v8 offset:37056
    s_waitcnt lgkmcnt(7)
    v_mfma_f32_16x16x32_bf16 v[40:43], v[80:83], v[188:191], 0
    v_mfma_f32_16x16x32_bf16 v[44:47], v[80:83], v[204:207], 0
    s_waitcnt lgkmcnt(6)
    v_mfma_f32_16x16x32_bf16 v[40:43], v[84:87], v[192:195], v[40:43]
    v_mfma_f32_16x16x32_bf16 v[44:47], v[84:87], v[208:211], v[44:47]
    s_waitcnt lgkmcnt(5)
    v_mfma_f32_16x16x32_bf16 v[40:43], v[88:91], v[196:199], v[40:43]
    v_mfma_f32_16x16x32_bf16 v[44:47], v[88:91], v[212:215], v[44:47]
    s_waitcnt lgkmcnt(4)
    v_mfma_f32_16x16x32_bf16 v[40:43], v[92:95], v[200:203], v[40:43]
    v_mfma_f32_16x16x32_bf16 v[44:47], v[92:95], v[216:219], v[44:47]
    v_cvt_pk_bf16_f32 v128, v32, v33
    v_cvt_pk_bf16_f32 v129, v34, v35
    v_cvt_pk_bf16_f32 v130, v36, v37
    v_cvt_pk_bf16_f32 v131, v38, v39
    buffer_store_dwordx4 v[128:131], v114, s[20:23], 0 offen sc0 sc1
    s_waitcnt lgkmcnt(3)
    v_mfma_f32_16x16x32_bf16 v[48:51], v[64:67], v[188:191], 0
    v_mfma_f32_16x16x32_bf16 v[52:55], v[64:67], v[204:207], 0
    s_waitcnt lgkmcnt(2)
    v_mfma_f32_16x16x32_bf16 v[48:51], v[68:71], v[192:195], v[48:51]
    v_mfma_f32_16x16x32_bf16 v[52:55], v[68:71], v[208:211], v[52:55]
    s_waitcnt lgkmcnt(1)
    v_mfma_f32_16x16x32_bf16 v[48:51], v[72:75], v[196:199], v[48:51]
    v_mfma_f32_16x16x32_bf16 v[52:55], v[72:75], v[212:215], v[52:55]
    s_waitcnt lgkmcnt(0)
    v_mfma_f32_16x16x32_bf16 v[48:51], v[76:79], v[200:203], v[48:51]
    v_mfma_f32_16x16x32_bf16 v[52:55], v[76:79], v[216:219], v[52:55]
    v_cvt_pk_bf16_f32 v132, v40, v41
    v_cvt_pk_bf16_f32 v133, v42, v43
    v_cvt_pk_bf16_f32 v134, v44, v45
    v_cvt_pk_bf16_f32 v135, v46, v47
    buffer_store_dwordx4 v[132:135], v115, s[20:23], 0 offen sc0 sc1
    s_nop 3
    v_cvt_pk_bf16_f32 v128, v48, v49
    v_cvt_pk_bf16_f32 v129, v50, v51
    v_cvt_pk_bf16_f32 v130, v52, v53
    v_cvt_pk_bf16_f32 v131, v54, v55
    buffer_store_dwordx4 v[128:131], v116, s[20:23], 0 offen sc0 sc1
END:
    s_endpgm
    .p2align 6
    .type DEAL_TABLE,@object
DEAL_TABLE:
    .short 8272, 4136, 8532, 14476, 12408, 6204, 2068, 10340, 0, 8792, 4396, 12668, 2328, 14736, 6464, 10600, 260, 9052, 14996, 6724, 520, 2588, 10860, 12928, 4656, 11120, 780, 2848, 13188, 15256, 6984, 4916, 1040, 11380, 7244, 3108, 13448, 15516, 5176, 9312, 0, 0, 0, 0, 0, 0, 0, 0, 0, 0, 0, 0, 0, 0, 0, 0, 0, 0, 0, 0, 0, 0, 0, 0, 0, 4136, 14476, 2068, 8272, 12408, 10340, 6204, 12668, 6464, 2328, 14736, 8532, 260, 4396, 10600, 8792, 6724, 10860, 12928, 14996, 2588, 520, 4656, 15256, 11120, 4916, 9052, 6984, 13188, 780, 2848, 11380, 3108, 7244, 13448, 9312, 5176, 15516, 1040, 0, 0, 0, 0, 0, 0, 0, 0, 0, 0, 0, 0, 0, 0, 0, 0, 0, 0, 0, 0, 0, 0, 0, 0
    .size DEAL_TABLE, 256
.section .rodata,"a"
.p2align 6
.amdhsa_kernel gather_scatter__tensor_product_equiv_tfn__graph_kernel
  .amdhsa_next_free_vgpr 220
  .amdhsa_next_free_sgpr 66
  .amdhsa_accum_offset 220
  .amdhsa_group_segment_fixed_size 0
  .amdhsa_kernarg_size 88
  .amdhsa_user_sgpr_count 2
  .amdhsa_user_sgpr_kernarg_segment_ptr 1
  .amdhsa_system_sgpr_workgroup_id_x 1
  .amdhsa_float_denorm_mode_32 3
.end_amdhsa_kernel
```

```asm
; @launch grid=(256,1,1) block=(512,1,1) lds=163840
.amdgcn_target "amdgcn-amd-amdhsa--gfx950"
.text
.globl gather_scatter__tensor_product_equiv_tfn__graph_kernel
.p2align 8
.type gather_scatter__tensor_product_equiv_tfn__graph_kernel,@function
gather_scatter__tensor_product_equiv_tfn__graph_kernel:
    s_cmp_ge_u32 s2, 256
    s_cbranch_scc1 END
    s_load_dwordx16 s[40:55], s[0:1], 0
    s_load_dwordx2 s[16:17], s[0:1], 80
    s_load_dwordx2 s[12:13], s[0:1], 0
    s_load_dwordx2 s[20:21], s[0:1], 64
    s_getpc_b64 s[6:7]
CODE_HERE:
    v_lshrrev_b32 v8, 6, v0
    s_lshr_b32 s5, s2, 3
    s_lshl_b32 s4, s5, 10
    v_readfirstlane_b32 s25, v8
    v_and_b32 v10, 7, v0
    v_lshl_add_u32 v10, v10, 7, s4
    v_min_u32 v10, END-CODE_HERE, v10
    s_cmp_lg_u32 s25, 7
    s_cbranch_scc1 NO_CODE_TOUCH
    global_load_dword v167, v10, s[6:7]
NO_CODE_TOUCH:
    s_mul_i32 s3, s2, 5120
    v_lshl_add_u32 v8, v0, 4, s3
    v_and_b32 v10, 63, v0
    v_lshlrev_b32 v1, 4, v10
    v_lshlrev_b32 v193, 2, v10
    v_lshlrev_b32 v11, 4, v0
    v_mov_b32 v12, 0
    v_mov_b32 v13, 0
    v_pk_mov_b32 v[16:17], v[12:13], v[12:13]
    v_pk_mov_b32 v[18:19], v[12:13], v[12:13]
    ds_write_b128 v11, v[16:19]
    s_cmp_ge_u32 s25, 5
    s_waitcnt lgkmcnt(0)
    s_cbranch_scc1 NO_EDGES
    s_cmp_ge_u32 s2, 250
    s_cbranch_scc1 AUX_LOAD
    s_setprio 1
    global_load_dwordx4 v[64:67], v8, s[44:45]
    global_load_dwordx4 v[68:71], v8, s[42:43]
NO_EDGES:
    s_add_u32 s4, s16, 8912896
    s_addc_u32 s5, s17, 0
    s_load_dwordx2 s[64:65], s[4:5], 0
    global_load_dword v188, v193, s[50:51] offset:0
    global_load_dword v189, v193, s[50:51] offset:256
    global_load_dword v190, v193, s[50:51] offset:512
    global_load_dword v191, v193, s[50:51] offset:768
    v_and_b32 v193, 0x7f, v193
    global_load_dword v192, v193, s[52:53]
    s_and_b32 s3, s2, 0x87
    s_cmp_eq_u32 s3, 0
    s_cselect_b32 s3, 128, 0
    s_add_u32 s3, s3, DEAL_TABLE-CODE_HERE
    v_lshl_add_u32 v174, v10, 1, s3
    global_load_ushort v174, v174, s[6:7]
    s_mov_b32 s14, 10240000
    s_mov_b32 s15, 0x20000
    v_lshlrev_b32 v9, 1, v8
    s_and_b32 s4, s2, 7
    s_lshl_b32 s4, s4, 5
    s_lshr_b32 s5, s2, 3
    s_or_b32 s24, s4, s5
    v_mov_b32 v15, 1
    s_mov_b32 s18, 8913024
    s_mov_b32 s19, 0x20000
    s_mov_b32 s22, 10240000
    s_mov_b32 s23, 0x20000
    s_mov_b32 s34, 0xfffffc00
    s_mov_b32 s27, 0
    s_mov_b32 s10, 0xbfb8aa3b
    s_mov_b32 s11, 0xbfb8aa3b
    s_mov_b32 s35, 2097152
    s_sub_u32 s61, 0, s2
    s_and_b32 s61, s61, 7
    s_mul_i32 s61, s61, 1280000
    v_and_b32 v4, 0xff, v0
    s_lshl_b32 s3, s24, 4
    s_add_u32 s3, s3, 7864320
    v_lshl_add_u32 v6, v4, 12, s3
    v_mul_u32_u24 v4, 1280, v4
    v_mul_u32_u24 v138, 0x8000, v1
    v_lshl_add_u32 v138, v10, 3, v138
    v_pk_mov_b32 v[20:21], v[12:13], v[12:13]
    v_pk_mov_b32 v[22:23], v[12:13], v[12:13]
    v_pk_mov_b32 v[24:25], v[12:13], v[12:13]
    v_pk_mov_b32 v[26:27], v[12:13], v[12:13]
    v_pk_mov_b32 v[28:29], v[12:13], v[12:13]
    v_pk_mov_b32 v[30:31], v[12:13], v[12:13]
    v_pk_mov_b32 v[32:33], v[12:13], v[12:13]
    v_pk_mov_b32 v[34:35], v[12:13], v[12:13]
    v_pk_mov_b32 v[36:37], v[12:13], v[12:13]
    v_pk_mov_b32 v[38:39], v[12:13], v[12:13]
    v_pk_mov_b32 v[40:41], v[12:13], v[12:13]
    v_pk_mov_b32 v[42:43], v[12:13], v[12:13]
    v_pk_mov_b32 v[44:45], v[12:13], v[12:13]
    v_pk_mov_b32 v[46:47], v[12:13], v[12:13]
    v_pk_mov_b32 v[48:49], v[12:13], v[12:13]
    v_pk_mov_b32 v[50:51], v[12:13], v[12:13]
    v_pk_mov_b32 v[52:53], v[12:13], v[12:13]
    v_pk_mov_b32 v[54:55], v[12:13], v[12:13]
    v_pk_mov_b32 v[56:57], v[12:13], v[12:13]
    v_pk_mov_b32 v[58:59], v[12:13], v[12:13]
    v_pk_mov_b32 v[60:61], v[12:13], v[12:13]
    v_pk_mov_b32 v[62:63], v[12:13], v[12:13]
    s_barrier
    s_cmp_ge_u32 s25, 5
    s_cbranch_scc1 HELP
    s_add_u32 s62, s25, 1
LUTP_W0L:
    s_mul_i32 s3, s62, 33554944
    s_add_u32 s3, s3, 4286709632
    v_add_u32 v128, s3, v138
    s_lshl_b32 s3, s62, 10
    v_add_u32 v136, s3, v1
    v_add_u32 v129, 131074, v128
    v_add_u32 v130, 262148, v128
    v_add_u32 v131, 393222, v128
    v_add_u32 v137, 0x10000, v136
    v_or_b32 v132, 0x80008000, v128
    v_or_b32 v133, 0x80008000, v129
    v_or_b32 v134, 0x80008000, v130
    v_or_b32 v135, 0x80008000, v131
    ds_write_b128 v136, v[128:131] offset:32768
    ds_write_b128 v137, v[132:135] offset:32768
    s_add_u32 s62, s62, 5
    s_cmp_le_u32 s62, 5
    s_cbranch_scc1 LUTP_W0L
LUTP_END_W0:
    s_cmp_ge_u32 s2, 250
    s_cbranch_scc1 AUX
    global_load_dwordx4 v[72:75], v9, s[46:47]
    global_load_dwordx4 v[76:79], v9, s[46:47] offset:16
    global_load_dwordx4 v[80:83], v9, s[48:49]
    global_load_dwordx4 v[84:87], v9, s[48:49] offset:16
    s_waitcnt vmcnt(11)
    v_and_b32 v88, 0xff, v64
    v_lshlrev_b32 v88, 2, v88
    ds_add_rtn_u32 v92, v88, v15 offset:2816
    v_and_b32 v89, 0xff, v65
    v_lshlrev_b32 v89, 2, v89
    ds_add_rtn_u32 v93, v89, v15 offset:2816
    v_and_b32 v90, 0xff, v66
    v_lshlrev_b32 v90, 2, v90
    ds_add_rtn_u32 v94, v90, v15 offset:2816
    v_and_b32 v91, 0xff, v67
    v_lshlrev_b32 v91, 2, v91
    ds_add_rtn_u32 v95, v91, v15 offset:2816
    s_waitcnt vmcnt(10)
    v_lshrrev_b32 v64, 8, v64
    v_lshl_or_b32 v108, v68, 10, v64
    v_lshrrev_b32 v65, 8, v65
    v_lshl_or_b32 v110, v69, 10, v65
    v_lshrrev_b32 v66, 8, v66
    v_lshl_or_b32 v112, v70, 10, v66
    v_lshrrev_b32 v67, 8, v67
    v_lshl_or_b32 v114, v71, 10, v67
    s_mov_b32 s9, 87040
    s_waitcnt lgkmcnt(0)
    s_barrier
    ds_read_b128 v[96:99], v1 offset:2816
    s_add_u32 s64, s64, 1
    s_and_b32 s65, s65, 0x3ff
    v_mov_b32 v109, s64
    v_mov_b32 v111, s64
    v_mov_b32 v113, s64
    v_mov_b32 v115, s64
    v_mov_b32 v119, 0
    v_cmp_gt_u32 vcc, 10, v92
    v_mul_u32_u24 v116, 6, v92
    v_lshlrev_b32 v117, 1, v88
    v_cndmask_b32 v118, 0, v64, vcc
    v_lshlrev_b64 v[120:121], v116, v[118:119]
    ds_or_b64 v117, v[120:121] offset:3840
    v_cmp_gt_u32 vcc, 10, v93
    v_mul_u32_u24 v116, 6, v93
    v_lshlrev_b32 v117, 1, v89
    v_cndmask_b32 v118, 0, v65, vcc
    v_lshlrev_b64 v[122:123], v116, v[118:119]
    ds_or_b64 v117, v[122:123] offset:3840
    v_cmp_gt_u32 vcc, 10, v94
    v_mul_u32_u24 v116, 6, v94
    v_lshlrev_b32 v117, 1, v90
    v_cndmask_b32 v118, 0, v66, vcc
    v_lshlrev_b64 v[120:121], v116, v[118:119]
    ds_or_b64 v117, v[120:121] offset:3840
    v_cmp_gt_u32 vcc, 10, v95
    v_mul_u32_u24 v116, 6, v95
    v_lshlrev_b32 v117, 1, v91
    v_cndmask_b32 v118, 0, v67, vcc
    v_lshlrev_b64 v[122:123], v116, v[118:119]
    ds_or_b64 v117, v[122:123] offset:3840
    s_waitcnt lgkmcnt(4)
    v_add_u32 v10, v96, v97
    v_add3_u32 v10, v10, v98, v99
    v_mov_b32 v11, v10
    s_nop 1
    v_add_u32_dpp v11, v11, v11 row_shr:1 row_mask:0xf bank_mask:0xf bound_ctrl:0
    s_nop 1
    v_add_u32_dpp v11, v11, v11 row_shr:2 row_mask:0xf bank_mask:0xf bound_ctrl:0
    s_nop 1
    v_add_u32_dpp v11, v11, v11 row_shr:4 row_mask:0xf bank_mask:0xf bound_ctrl:0
    s_nop 1
    v_add_u32_dpp v11, v11, v11 row_shr:8 row_mask:0xf bank_mask:0xf bound_ctrl:0
    s_nop 1
    v_add_u32_dpp v11, v11, v11 row_bcast:15 row_mask:0xa bank_mask:0xf
    s_nop 1
    v_add_u32_dpp v11, v11, v11 row_bcast:31 row_mask:0xc bank_mask:0xf
    v_sub_u32 v100, v11, v10
    v_add_u32 v101, v100, v96
    v_add_u32 v102, v101, v97
    v_add_u32 v103, v102, v98
    ds_write_b128 v1, v[100:103] offset:5888
    ds_read_b32 v96, v88 offset:5888
    ds_read_b32 v97, v89 offset:5888
    ds_read_b32 v98, v90 offset:5888
    ds_read_b32 v99, v91 offset:5888
    s_waitcnt lgkmcnt(3)
    v_add_u32 v92, v92, v96
    v_lshl_add_u32 v88, v92, 3, s9
    ds_write_b64 v88, v[108:109]
    s_waitcnt lgkmcnt(3)
    v_add_u32 v93, v93, v97
    v_lshl_add_u32 v89, v93, 3, s9
    ds_write_b64 v89, v[110:111]
    s_waitcnt lgkmcnt(3)
    v_add_u32 v94, v94, v98
    v_lshl_add_u32 v90, v94, 3, s9
    ds_write_b64 v90, v[112:113]
    s_waitcnt lgkmcnt(3)
    v_add_u32 v95, v95, v99
    v_lshl_add_u32 v91, v95, 3, s9
    ds_write_b64 v91, v[114:115]
    v_lshlrev_b32 v92, 4, v92
    v_add_u32 v92, 8704, v92
    v_lshlrev_b32 v93, 4, v93
    v_add_u32 v93, 8704, v93
    v_lshlrev_b32 v94, 4, v94
    v_add_u32 v94, 8704, v94
    v_lshlrev_b32 v95, 4, v95
    v_add_u32 v95, 8704, v95
    s_waitcnt lgkmcnt(0)
    s_barrier
    s_waitcnt vmcnt(0)
    s_cmp_eq_u32 s25, 4
    s_cbranch_scc1 NO_X_TOUCH_9
    s_lshr_b32 s33, s2, 3
    s_lshl_b32 s33, s33, 2
    s_add_u32 s33, s33, s25
    s_lshl_b32 s33, s33, 7
    s_add_u32 s33, s33, s61
    s_add_u32 s33, s33, 0
    v_min_u32 v166, 176, v1
    v_lshl_add_u32 v166, v166, 10, s33
    buffer_load_dword v167, v166, s[12:15], 0 offen
NO_X_TOUCH_9:
    ds_write2_b64 v92, v[72:73], v[80:81] offset0:0 offset1:1
    ds_write2_b64 v93, v[74:75], v[82:83] offset0:0 offset1:1
    ds_write2_b64 v94, v[76:77], v[84:85] offset0:0 offset1:1
    ds_write2_b64 v95, v[78:79], v[86:87] offset0:0 offset1:1
BINNED:
    s_setprio 0
    s_waitcnt lgkmcnt(0)
    s_barrier
    v_mov_b32 v2, 0
    s_call_b64 s[6:7], CONST_SUB
    s_cmp_gt_u32 s62, 24
    s_cbranch_scc1 LUTP_END_W
LUTP_WL:
    s_mul_i32 s3, s62, 33554944
    s_add_u32 s3, s3, 4286709632
    v_add_u32 v128, s3, v138
    s_lshl_b32 s3, s62, 10
    v_add_u32 v136, s3, v1
    v_add_u32 v129, 131074, v128
    v_add_u32 v130, 262148, v128
    v_add_u32 v131, 393222, v128
    v_add_u32 v137, 0x10000, v136
    v_or_b32 v132, 0x80008000, v128
    v_or_b32 v133, 0x80008000, v129
    v_or_b32 v134, 0x80008000, v130
    v_or_b32 v135, 0x80008000, v131
    ds_write_b128 v136, v[128:131] offset:32768
    ds_write_b128 v137, v[132:135] offset:32768
    s_add_u32 s62, s62, 5
    s_cmp_le_u32 s62, 24
    s_cbranch_scc1 LUTP_WL
LUTP_END_W:
    s_cmp_eq_u32 s25, 4
    s_cbranch_scc1 WAVE4
    s_add_u32 s62, s25, 34
    v_mov_b32 v132, 0x80008000
    v_mov_b32 v133, 0x80008000
    v_mov_b32 v134, 0x80008000
    v_mov_b32 v135, 0x80008000
LUTP_UH:
    s_mul_i32 s3, s62, 33554944
    s_add_u32 s3, s3, 131072
    v_add_u32 v128, s3, v138
    s_lshl_b32 s3, s62, 10
    v_add_u32 v136, s3, v1
    v_add_u32 v129, 131074, v128
    v_add_u32 v130, 262148, v128
    v_add_u32 v131, 393222, v128
    v_add_u32 v137, 0x10000, v136
    ds_write_b128 v136, v[128:131] offset:32768
    ds_write_b128 v137, v[132:135] offset:32768
    s_add_u32 s62, s62, 4
    s_cmp_le_u32 s62, 62
    s_cbranch_scc1 LUTP_UH
LUTP_END_U:
    buffer_load_dwordx4 v[168:171], v6, s[16:19], 0 offen sc1
    s_lshr_b32 s33, s2, 3
    s_lshl_b32 s33, s33, 2
    s_add_u32 s33, s33, s25
    s_lshl_b32 s33, s33, 7
    s_add_u32 s33, s33, s61
    s_add_u32 s33, s33, 196608
    v_min_u32 v166, 240, v1
    v_lshl_add_u32 v166, v166, 10, s33
    buffer_load_dword v167, v166, s[12:15], 0 offen
NO_X_TOUCH_6:
    s_waitcnt vmcnt(1)
    s_branch CHECK_TAB
POLL_TAB:
    s_waitcnt vmcnt(0)
CHECK_TAB:
    v_lshrrev_b32 v11, 22, v168
    v_cmp_ne_u32 vcc, s64, v169
    v_cmp_ne_u32 s[42:43], s65, v11
    s_or_b64 vcc, vcc, s[42:43]
    s_and_b64 exec, exec, vcc
    s_cbranch_execz POLLED_TAB
    s_sub_u32 s35, s35, 1
    s_cbranch_scc1 END
    buffer_load_dwordx4 v[168:171], v6, s[16:19], 0 offen sc1
    s_branch POLL_TAB
POLLED_TAB:
    s_mov_b64 exec, -1
    s_branch TAB_DONE
LUT_SUB:
    s_lshl_b32 s3, s62, 25
    s_add_u32 s3, s3, 0x8000
    v_lshl_add_u32 v128, v1, 15, s3
    v_add_u32 v129, 0x10000, v128
    v_add_u32 v130, 0x10000, v129
    v_add_u32 v131, 0x10000, v130
    v_add_u32 v132, 0x10000, v131
    v_add_u32 v133, 0x10000, v132
    v_add_u32 v134, 0x10000, v133
    v_add_u32 v135, 0x10000, v134
    v_pk_mul_f32 v[136:137], v[128:129], s[10:11]
    v_pk_mul_f32 v[138:139], v[130:131], s[10:11]
    v_pk_mul_f32 v[140:141], v[132:133], s[10:11]
    v_pk_mul_f32 v[142:143], v[134:135], s[10:11]
    v_exp_f32 v136, v136
    v_exp_f32 v137, v137
    v_exp_f32 v138, v138
    v_exp_f32 v139, v139
    v_exp_f32 v140, v140
    v_exp_f32 v141, v141
    v_exp_f32 v142, v142
    v_exp_f32 v143, v143
    s_lshl_b32 s3, s62, 10
    v_pk_add_f32 v[144:145], v[136:137], 1.0 op_sel_hi:[1,0]
    v_pk_add_f32 v[146:147], v[138:139], 1.0 op_sel_hi:[1,0]
    v_pk_add_f32 v[148:149], v[140:141], 1.0 op_sel_hi:[1,0]
    v_pk_add_f32 v[150:151], v[142:143], 1.0 op_sel_hi:[1,0]
    v_rcp_f32 v144, v144
    v_rcp_f32 v145, v145
    v_rcp_f32 v146, v146
    v_rcp_f32 v147, v147
    v_rcp_f32 v148, v148
    v_rcp_f32 v149, v149
    v_rcp_f32 v150, v150
    v_rcp_f32 v151, v151
    v_add_u32 v160, s3, v1
    v_pk_mul_f32 v[128:129], v[128:129], v[144:145]
    v_pk_mul_f32 v[130:131], v[130:131], v[146:147]
    v_pk_mul_f32 v[132:133], v[132:133], v[148:149]
    v_pk_mul_f32 v[134:135], v[134:135], v[150:151]
    v_add_u32 v161, 0x10000, v160
    v_pk_mul_f32 v[136:137], v[128:129], v[136:137] neg_lo:[1,0] neg_hi:[1,0]
    v_pk_mul_f32 v[138:139], v[130:131], v[138:139] neg_lo:[1,0] neg_hi:[1,0]
    v_pk_mul_f32 v[140:141], v[132:133], v[140:141] neg_lo:[1,0] neg_hi:[1,0]
    v_pk_mul_f32 v[142:143], v[134:135], v[142:143] neg_lo:[1,0] neg_hi:[1,0]
    v_cvt_pk_bf16_f32 v152, v128, v129
    v_cvt_pk_bf16_f32 v153, v130, v131
    v_cvt_pk_bf16_f32 v154, v132, v133
    v_cvt_pk_bf16_f32 v155, v134, v135
    v_cvt_pk_bf16_f32 v156, v136, v137
    v_cvt_pk_bf16_f32 v157, v138, v139
    v_cvt_pk_bf16_f32 v158, v140, v141
    v_cvt_pk_bf16_f32 v159, v142, v143
    ds_write_b128 v160, v[152:155] offset:32768
    ds_write_b128 v161, v[156:159] offset:32768
    s_add_u32 s62, s62, 1
    s_sub_u32 s63, s63, 1
    s_cmp_lg_u32 s63, 0
    s_cbranch_scc1 LUT_SUB
    s_setpc_b64 s[6:7]
CONST_SUB:
    ds_write_b32 v193, v192 offset:32256
    v_lshrrev_b32 v193, 3, v1
    v_and_b32 v193, 24, v193
    s_mov_b32 s4, 0x05040100
    s_mov_b32 s5, 0x07060302
    ds_read_b64_tr_b16 v[180:181], v193 offset:32256
    ds_read_b64_tr_b16 v[182:183], v193 offset:32288
    ds_read_b64_tr_b16 v[184:185], v193 offset:32320
    ds_read_b64_tr_b16 v[186:187], v193 offset:32352
    v_perm_b32 v176, v189, v188, s4
    v_perm_b32 v178, v189, v188, s5
    v_perm_b32 v177, v191, v190, s4
    v_perm_b32 v179, v191, v190, s5
    s_setpc_b64 s[6:7]
HELP:
    s_sub_u32 s8, s25, 5
    s_mul_i32 s4, s8, 3072
    s_cmp_eq_u32 s8, 1
    s_cselect_b32 s4, 4096, s4
    s_mul_i32 s3, s2, 10240
    s_add_u32 s3, s3, s4
    v_add_u32 v8, s3, v1
    s_add_u32 s4, s4, 87040
    v_add_u32 v9, s4, v1
    s_mul_i32 s4, s8, 7168
    s_mul_i32 s3, s2, 20480
    s_add_u32 s3, s3, s4
    s_add_u32 s3, s3, 2621440
    v_add_u32 v12, s3, v1
    v_add_u32 v13, s4, v1
    s_lshl_b32 s3, s2, 12
    s_add_u32 s3, s3, 7864320
    v_add_u32 v117, s3, v1
    s_waitcnt lgkmcnt(0)
    s_add_u32 s64, s64, 1
    s_and_b32 s65, s65, 0x3ff
    s_barrier
    s_cmp_eq_u32 s25, 6
    s_cbranch_scc1 ROW
    s_cmp_eq_u32 s25, 7
    s_cselect_b32 s62, 63, 0
    s_mov_b32 s63, 1
    s_call_b64 s[6:7], LUT_SUB
    s_waitcnt vmcnt(0)
    s_call_b64 s[6:7], CONST_SUB
    v_mov_b32 v10, 65280
    v_mov_b32 v11, 0x7f80
    s_cmp_lg_u32 s25, 7
    s_cbranch_scc1 NO_ROW
    ds_write_b16 v10, v11 offset:32768
    s_branch NO_ROW
ROW:
    v_lshrrev_b32 v116, 2, v1
    ds_read_b32 v100, v116 offset:2816
    ds_read_b32 v101, v116 offset:3072
    ds_read_b32 v102, v116 offset:3328
    ds_read_b32 v103, v116 offset:3584
    s_lshl_b32 s3, s2, 12
    s_add_u32 s3, s3, 7864320
    v_add_u32 v117, s3, v1
    v_lshrrev_b32 v116, 1, v1
    s_lshl_b32 s3, s65, 22
    s_waitcnt lgkmcnt(0)
    v_mov_b32 v104, v100
    v_mov_b32 v105, v101
    v_mov_b32 v106, v102
    v_mov_b32 v107, v103
    s_nop 0
    v_add_u32_dpp v104, v104, v104 row_shr:1 row_mask:0xf bank_mask:0xf bound_ctrl:0
    v_add_u32_dpp v105, v105, v105 row_shr:1 row_mask:0xf bank_mask:0xf bound_ctrl:0
    v_add_u32_dpp v106, v106, v106 row_shr:1 row_mask:0xf bank_mask:0xf bound_ctrl:0
    v_add_u32_dpp v107, v107, v107 row_shr:1 row_mask:0xf bank_mask:0xf bound_ctrl:0
    s_nop 0
    v_add_u32_dpp v104, v104, v104 row_shr:2 row_mask:0xf bank_mask:0xf bound_ctrl:0
    v_add_u32_dpp v105, v105, v105 row_shr:2 row_mask:0xf bank_mask:0xf bound_ctrl:0
    v_add_u32_dpp v106, v106, v106 row_shr:2 row_mask:0xf bank_mask:0xf bound_ctrl:0
    v_add_u32_dpp v107, v107, v107 row_shr:2 row_mask:0xf bank_mask:0xf bound_ctrl:0
    s_nop 0
    v_add_u32_dpp v104, v104, v104 row_shr:4 row_mask:0xf bank_mask:0xf bound_ctrl:0
    v_add_u32_dpp v105, v105, v105 row_shr:4 row_mask:0xf bank_mask:0xf bound_ctrl:0
    v_add_u32_dpp v106, v106, v106 row_shr:4 row_mask:0xf bank_mask:0xf bound_ctrl:0
    v_add_u32_dpp v107, v107, v107 row_shr:4 row_mask:0xf bank_mask:0xf bound_ctrl:0
    s_nop 0
    v_add_u32_dpp v104, v104, v104 row_shr:8 row_mask:0xf bank_mask:0xf bound_ctrl:0
    v_add_u32_dpp v105, v105, v105 row_shr:8 row_mask:0xf bank_mask:0xf bound_ctrl:0
    v_add_u32_dpp v106, v106, v106 row_shr:8 row_mask:0xf bank_mask:0xf bound_ctrl:0
    v_add_u32_dpp v107, v107, v107 row_shr:8 row_mask:0xf bank_mask:0xf bound_ctrl:0
    s_nop 0
    v_add_u32_dpp v104, v104, v104 row_bcast:15 row_mask:0xa bank_mask:0xf
    v_add_u32_dpp v105, v105, v105 row_bcast:15 row_mask:0xa bank_mask:0xf
    v_add_u32_dpp v106, v106, v106 row_bcast:15 row_mask:0xa bank_mask:0xf
    v_add_u32_dpp v107, v107, v107 row_bcast:15 row_mask:0xa bank_mask:0xf
    s_nop 0
    v_add_u32_dpp v104, v104, v104 row_bcast:31 row_mask:0xc bank_mask:0xf
    v_add_u32_dpp v105, v105, v105 row_bcast:31 row_mask:0xc bank_mask:0xf
    v_add_u32_dpp v106, v106, v106 row_bcast:31 row_mask:0xc bank_mask:0xf
    v_add_u32_dpp v107, v107, v107 row_bcast:31 row_mask:0xc bank_mask:0xf
    v_readlane_b32 s4, v104, 63
    v_readlane_b32 s5, v105, 63
    v_readlane_b32 s9, v106, 63
    v_sub_u32 v104, v104, v100
    v_sub_u32 v105, v105, v101
    v_sub_u32 v106, v106, v102
    v_sub_u32 v107, v107, v103
    s_add_u32 s5, s5, s4
    s_add_u32 s9, s9, s5
    v_add_u32 v105, s4, v105
    v_add_u32 v106, s5, v106
    v_add_u32 v107, s9, v107
    v_lshl_or_b32 v84, v100, 11, v104
    v_or_b32 v84, s3, v84
    v_mov_b32 v85, s64
    v_lshl_or_b32 v88, v101, 11, v105
    v_or_b32 v88, s3, v88
    v_mov_b32 v89, s64
    v_lshl_or_b32 v92, v102, 11, v106
    v_or_b32 v92, s3, v92
    v_mov_b32 v93, s64
    v_lshl_or_b32 v96, v103, 11, v107
    v_or_b32 v96, s3, v96
    v_mov_b32 v97, s64
    s_waitcnt vmcnt(0)
    s_call_b64 s[6:7], CONST_SUB
NO_ROW:
    s_barrier
    s_cmp_lg_u32 s25, 6
    s_cbranch_scc1 ROW_DONE
    ds_read_b64 v[86:87], v116 offset:3840
    ds_read_b64 v[90:91], v116 offset:4352
    ds_read_b64 v[94:95], v116 offset:4864
    ds_read_b64 v[98:99], v116 offset:5376
    s_waitcnt lgkmcnt(3)
    global_store_dwordx4 v117, v[84:87], s[16:17] offset:0 sc0 sc1
    s_waitcnt lgkmcnt(2)
    global_store_dwordx4 v117, v[88:91], s[16:17] offset:1024 sc0 sc1
    s_waitcnt lgkmcnt(1)
    global_store_dwordx4 v117, v[92:95], s[16:17] offset:2048 sc0 sc1
    s_waitcnt lgkmcnt(0)
    global_store_dwordx4 v117, v[96:99], s[16:17] offset:3072 sc0 sc1
ROW_DONE:
    ds_read_b128 v[64:67], v9 offset:0
    ds_read_b128 v[68:71], v9 offset:1024
    ds_read_b128 v[72:75], v9 offset:2048
    ds_read_b128 v[76:79], v9 offset:3072
    v_mov_b32 v2, 0
    s_add_u32 s62, s8, s8
    s_add_u32 s62, s62, 27
    s_cmp_eq_u32 s8, 2
    s_addc_u32 s62, s62, 0
    s_cmp_eq_u32 s8, 1
    s_cselect_b32 s63, 3, 2
    s_waitcnt lgkmcnt(0)
    s_barrier
    s_cmp_ge_u32 s2, 250
    s_cbranch_scc1 RECS_STORED
    ds_read_b128 v[84:87], v13 offset:8704
    ds_read_b128 v[88:91], v13 offset:9728
    ds_read_b128 v[92:95], v13 offset:10752
    ds_read_b128 v[96:99], v13 offset:11776
    ds_read_b128 v[100:103], v13 offset:12800
    ds_read_b128 v[104:107], v13 offset:13824
    ds_read_b128 v[108:111], v13 offset:14848
    s_waitcnt lgkmcnt(6)
    global_store_dwordx4 v12, v[84:87], s[16:17] offset:0 sc0 sc1
    s_waitcnt lgkmcnt(5)
    global_store_dwordx4 v12, v[88:91], s[16:17] offset:1024 sc0 sc1
    s_waitcnt lgkmcnt(4)
    global_store_dwordx4 v12, v[92:95], s[16:17] offset:2048 sc0 sc1
    s_waitcnt lgkmcnt(3)
    global_store_dwordx4 v12, v[96:99], s[16:17] offset:3072 sc0 sc1
    v_add_u32 v12, 4096, v12
    s_waitcnt lgkmcnt(2)
    global_store_dwordx4 v12, v[100:103], s[16:17] offset:0 sc0 sc1
    s_waitcnt lgkmcnt(1)
    global_store_dwordx4 v12, v[104:107], s[16:17] offset:1024 sc0 sc1
    s_cmp_eq_u32 s8, 2
    s_cbranch_scc1 RECS_STORED
    s_waitcnt lgkmcnt(0)
    global_store_dwordx4 v12, v[108:111], s[16:17] offset:2048 sc0 sc1
RECS_STORED:
    s_call_b64 s[6:7], LUT_SUB
    s_cmp_ge_u32 s2, 250
    s_cbranch_scc1 TAB_DONE
    v_mov_b32 v10, 0
    s_waitcnt vmcnt(0)
    s_mov_b64 exec, 1
    ds_add_u32 v10, v15 offset:1296
    s_mov_b64 exec, -1
WAIT_ACK:
    ds_read_b32 v11, v10 offset:1296
    s_waitcnt lgkmcnt(0)
    v_readfirstlane_b32 s3, v11
    s_cmp_eq_u32 s3, 3
    s_cbranch_scc0 WAIT_ACK
    global_store_dwordx4 v8, v[64:67], s[16:17] offset:0 sc0 sc1
    global_store_dwordx4 v8, v[68:71], s[16:17] offset:1024 sc0 sc1
    s_cmp_eq_u32 s8, 1
    s_cbranch_scc1 TAB_DONE
    global_store_dwordx4 v8, v[72:75], s[16:17] offset:2048 sc0 sc1
    global_store_dwordx4 v8, v[76:79], s[16:17] offset:3072 sc0 sc1
    s_branch TAB_DONE
AUX_LOAD:
    s_sub_u32 s4, s2, 250
    s_cmp_ge_u32 s4, 4
    s_cbranch_scc1 NO_EDGES
    s_cmp_ge_u32 s25, 4
    s_cbranch_scc1 NO_EDGES
    s_lshl_b32 s5, s25, 13
    s_lshl_b32 s8, s4, 6
    s_add_u32 s5, s5, s8
    v_lshrrev_b32 v80, 8, v1
    v_lshlrev_b32 v80, 11, v80
    v_bfe_u32 v81, v1, 4, 4
    v_lshl_add_u32 v80, v81, 2, v80
    v_add_u32 v80, s5, v80
    global_load_dword v64, v80, s[54:55] offset:0
    global_load_dword v65, v80, s[54:55] offset:256
    global_load_dword v66, v80, s[54:55] offset:512
    global_load_dword v67, v80, s[54:55] offset:768
    global_load_dword v68, v80, s[54:55] offset:1024
    global_load_dword v69, v80, s[54:55] offset:1280
    global_load_dword v70, v80, s[54:55] offset:1536
    global_load_dword v71, v80, s[54:55] offset:1792
    s_branch NO_EDGES
AUX:
    s_cmp_ge_u32 s2, 254
    s_cbranch_scc1 AUX_DONE
    s_cmp_ge_u32 s25, 4
    s_cbranch_scc1 AUX_DONE
    s_sub_u32 s4, s2, 250
    s_lshl_b32 s5, s4, 13
    s_lshl_b32 s8, s25, 10
    s_add_u32 s5, s5, s8
    s_add_u32 s5, s5, 7802880
    v_add_u32 v81, s5, v1
    s_mov_b32 s4, 0x05040100
    s_mov_b32 s5, 0x07060302
    s_waitcnt vmcnt(6)
    v_perm_b32 v72, v65, v64, s4
    v_perm_b32 v76, v65, v64, s5
    v_perm_b32 v73, v67, v66, s4
    v_perm_b32 v77, v67, v66, s5
    v_perm_b32 v74, v69, v68, s4
    v_perm_b32 v78, v69, v68, s5
    v_perm_b32 v75, v71, v70, s4
    v_perm_b32 v79, v71, v70, s5
    global_store_dwordx4 v81, v[72:75], s[16:17] sc0 sc1
    v_add_u32 v81, 4096, v81
    global_store_dwordx4 v81, v[76:79], s[16:17] sc0 sc1
AUX_DONE:
    s_waitcnt lgkmcnt(0)
    s_add_u32 s64, s64, 1
    s_and_b32 s65, s65, 0x3ff
    s_barrier
    s_waitcnt vmcnt(0)
    s_barrier
    s_branch BINNED
WAVE4:
    s_mov_b32 s62, 25
    s_mov_b32 s63, 2
    s_call_b64 s[6:7], LUT_SUB
TAB_DONE:
    s_cmp_ge_u32 s25, 4
    s_cbranch_scc1 TOTALS
    v_and_b32 v13, 0x7ff, v168
    v_bfe_u32 v2, v168, 11, 11
    v_add_u32 v4, v4, v13
    v_mov_b32 v3, v2
    s_nop 1
    v_add_u32_dpp v3, v3, v3 row_shr:1 row_mask:0xf bank_mask:0xf bound_ctrl:0
    s_nop 1
    v_add_u32_dpp v3, v3, v3 row_shr:2 row_mask:0xf bank_mask:0xf bound_ctrl:0
    s_nop 1
    v_add_u32_dpp v3, v3, v3 row_shr:4 row_mask:0xf bank_mask:0xf bound_ctrl:0
    s_nop 1
    v_add_u32_dpp v3, v3, v3 row_shr:8 row_mask:0xf bank_mask:0xf bound_ctrl:0
    s_nop 1
    v_add_u32_dpp v3, v3, v3 row_bcast:15 row_mask:0xa bank_mask:0xf
    s_nop 1
    v_add_u32_dpp v3, v3, v3 row_bcast:31 row_mask:0xc bank_mask:0xf
    s_lshl_b32 s3, s25, 2
    v_mov_b32 v10, s3
    v_add_u32 v11, 1, v3
    v_sub_u32 v3, v3, v2
    s_mov_b32 exec_lo, 0
    s_mov_b32 exec_hi, 0x80000000
    ds_write_b32 v10, v11 offset:1280
    s_mov_b64 exec, -1
TOTALS:
    v_mov_b32 v10, 0
TOTALS_SPIN:
    ds_read_b128 v[64:67], v10 offset:1280
    s_waitcnt lgkmcnt(0)
    v_readfirstlane_b32 s4, v64
    v_readfirstlane_b32 s5, v65
    v_readfirstlane_b32 s6, v66
    v_readfirstlane_b32 s7, v67
    s_min_u32 s3, s4, s5
    s_min_u32 s8, s6, s7
    s_min_u32 s3, s3, s8
    s_cmp_eq_u32 s3, 0
    s_cbranch_scc0 TOTALS_OK
    s_sub_u32 s35, s35, 1
    s_cbranch_scc0 TOTALS_SPIN
    s_endpgm
TOTALS_OK:
    s_add_u32 s5, s5, s4
    s_add_u32 s6, s6, s5
    s_add_u32 s7, s7, s6
    s_sub_u32 s26, s7, 4
    s_cmp_eq_u32 s25, 1
    s_cselect_b32 s3, s4, 0
    s_cmp_eq_u32 s25, 2
    s_cselect_b32 s3, s5, s3
    s_cmp_eq_u32 s25, 3
    s_cselect_b32 s3, s6, s3
    s_sub_u32 s3, s3, s25
    v_add_u32 v3, s3, v3
    s_cmp_lg_u32 s25, 4
    s_cbranch_scc1 EPOCH_DONE
    s_cmp_lg_u32 s2, 0
    s_cbranch_scc1 EPOCH_DONE
    v_mov_b32 v12, s64
    v_mov_b32 v10, 8912896
    s_mov_b64 exec, 1
    global_store_dword v10, v12, s[16:17] sc0 sc1
    s_mov_b64 exec, -1
EPOCH_DONE:
    s_lshr_b32 s33, s2, 3
    s_lshl_b32 s33, s33, 3
    s_add_u32 s33, s33, s25
    s_lshl_b32 s33, s33, 7
    s_add_u32 s33, s33, s61
    s_add_u32 s33, s33, 458752
    v_min_u32 v166, 208, v1
    v_lshl_add_u32 v166, v166, 11, s33
    buffer_load_dword v167, v166, s[12:15], 0 offen
NO_X_TOUCH_3:
ROUND:
    v_mov_b32 v8, 0
    v_subrev_u32 v9, s27, v3
    v_mov_b32 v10, v4
    s_mov_b32 s3, 1472
    s_cmp_gt_u32 s26, 1472
    s_cbranch_scc1 EXPAND
    v_lshlrev_b32 v11, 2, v3
    v_cmpx_lt_u32 vcc, 0, v2
    ds_write_b32 v11, v10 offset:2816
    v_add_u32 v10, 1, v10
    v_cmpx_lt_u32 vcc, 1, v2
    ds_write_b32 v11, v10 offset:2820
    v_add_u32 v10, 1, v10
    v_cmpx_lt_u32 vcc, 2, v2
    ds_write_b32 v11, v10 offset:2824
    v_add_u32 v10, 1, v10
    v_cmpx_lt_u32 vcc, 3, v2
    ds_write_b32 v11, v10 offset:2828
    v_add_u32 v10, 1, v10
    v_cmpx_lt_u32 vcc, 4, v2
    ds_write_b32 v11, v10 offset:2832
    v_add_u32 v10, 1, v10
    v_cmpx_lt_u32 vcc, 5, v2
    ds_write_b32 v11, v10 offset:2836
    v_add_u32 v10, 1, v10
    v_cmpx_lt_u32 vcc, 6, v2
    s_cbranch_execz EXPAND_DONE
    ds_write_b32 v11, v10 offset:2840
    v_add_u32 v10, 1, v10
    v_cmpx_lt_u32 vcc, 7, v2
    ds_write_b32 v11, v10 offset:2844
    v_add_u32 v10, 1, v10
    v_cmpx_lt_u32 vcc, 8, v2
    s_cbranch_execz EXPAND_DONE
    ds_write_b32 v11, v10 offset:2848
    v_add_u32 v10, 1, v10
    v_cmpx_lt_u32 vcc, 9, v2
    ds_write_b32 v11, v10 offset:2852
    v_add_u32 v10, 1, v10
    v_cmpx_lt_u32 vcc, 10, v2
    s_cbranch_execz EXPAND_DONE
    ds_write_b32 v11, v10 offset:2856
    v_add_u32 v10, 1, v10
    v_cmpx_lt_u32 vcc, 11, v2
    ds_write_b32 v11, v10 offset:2860
    v_add_u32 v10, 1, v10
    v_cmpx_lt_u32 vcc, 12, v2
    s_cbranch_execz EXPAND_DONE
    ds_write_b32 v11, v10 offset:2864
    v_add_u32 v10, 1, v10
    v_cmpx_lt_u32 vcc, 13, v2
    ds_write_b32 v11, v10 offset:2868
    v_add_u32 v10, 1, v10
    v_cmpx_lt_u32 vcc, 14, v2
    s_cbranch_execz EXPAND_DONE
    ds_write_b32 v11, v10 offset:2872
    v_add_u32 v10, 1, v10
    v_cmpx_lt_u32 vcc, 15, v2
    ds_write_b32 v11, v10 offset:2876
    v_add_u32 v10, 1, v10
    v_mov_b32 v8, 16
    v_add_u32 v9, 16, v9
EXPAND:
    v_cmp_lt_u32 vcc, v8, v2
    s_and_b64 exec, exec, vcc
    s_cbranch_execz EXPAND_DONE
    v_cmp_gt_u32 vcc, s3, v9
    v_lshlrev_b32 v11, 2, v9
    s_and_saveexec_b64 s[42:43], vcc
    ds_write_b32 v11, v10 offset:2816
    s_mov_b64 exec, s[42:43]
    v_add_u32 v8, 1, v8
    v_add_u32 v9, 1, v9
    v_add_u32 v10, 1, v10
    s_branch EXPAND
EXPAND_DONE:
    s_mov_b64 exec, -1
    s_sub_u32 s28, s26, s27
    s_min_u32 s28, s28, 1472
    v_lshlrev_b32 v8, 2, v0
    v_add_u32 v9, 0, v0
    v_cmp_gt_u32 s[36:37], s28, v9
    v_add_u32 v9, 512, v0
    v_cmp_gt_u32 s[38:39], s28, v9
    v_add_u32 v9, 1024, v0
    v_cmp_gt_u32 s[40:41], s28, v9
    s_waitcnt lgkmcnt(0)
    s_barrier
    ds_read_b32 v64, v8 offset:2816
    ds_read_b32 v65, v8 offset:4864
    ds_read_b32 v66, v8 offset:6912
    s_mov_b32 s44, 13421
    s_and_b32 s45, s2, 7
    s_mul_i32 s45, s45, 4
    s_waitcnt lgkmcnt(0)
    v_lshlrev_b32 v68, 3, v64
    v_lshlrev_b32 v64, 4, v64
    v_lshlrev_b32 v69, 3, v65
    v_lshlrev_b32 v65, 4, v65
    v_lshlrev_b32 v70, 3, v66
    v_lshlrev_b32 v66, 4, v66
    s_mov_b64 exec, s[40:41]
    s_cbranch_execz SKIP3
    buffer_load_dwordx2 v[100:101], v70, s[16:19], 0 offen sc1
SKIP3:
    s_mov_b64 exec, s[36:37]
    buffer_load_dwordx2 v[96:97], v68, s[16:19], 0 offen sc1
    s_mov_b64 exec, s[38:39]
    buffer_load_dwordx2 v[98:99], v69, s[16:19], 0 offen sc1
    s_mov_b64 exec, -1
    v_lshrrev_b32 v8, 4, v1
    s_cmp_lg_u32 s27, 0
    s_cbranch_scc1 KEY_WAIT
    s_cmp_ge_u32 s25, 4
    s_cbranch_scc1 DEG_DONE
    v_bfe_u32 v9, v170, 0, 6
    v_lshlrev_b32 v9, 2, v9
    v_cmpx_lt_u32 vcc, 0, v2
    ds_add_u32 v9, v15 offset:1024
    v_bfe_u32 v10, v170, 6, 6
    v_lshlrev_b32 v10, 2, v10
    v_cmpx_lt_u32 vcc, 1, v2
    ds_add_u32 v10, v15 offset:1024
    v_bfe_u32 v9, v170, 12, 6
    v_lshlrev_b32 v9, 2, v9
    v_cmpx_lt_u32 vcc, 2, v2
    ds_add_u32 v9, v15 offset:1024
    v_bfe_u32 v10, v170, 18, 6
    v_lshlrev_b32 v10, 2, v10
    v_cmpx_lt_u32 vcc, 3, v2
    ds_add_u32 v10, v15 offset:1024
    v_bfe_u32 v9, v170, 24, 6
    v_lshlrev_b32 v9, 2, v9
    v_cmpx_lt_u32 vcc, 4, v2
    ds_add_u32 v9, v15 offset:1024
    v_alignbit_b32 v10, v171, v170, 30
    v_and_b32 v10, 63, v10
    v_lshlrev_b32 v10, 2, v10
    v_cmpx_lt_u32 vcc, 5, v2
    ds_add_u32 v10, v15 offset:1024
    v_bfe_u32 v9, v171, 4, 6
    v_lshlrev_b32 v9, 2, v9
    v_cmpx_lt_u32 vcc, 6, v2
    ds_add_u32 v9, v15 offset:1024
    v_bfe_u32 v10, v171, 10, 6
    v_lshlrev_b32 v10, 2, v10
    v_cmpx_lt_u32 vcc, 7, v2
    ds_add_u32 v10, v15 offset:1024
    v_bfe_u32 v9, v171, 16, 6
    v_lshlrev_b32 v9, 2, v9
    v_cmpx_lt_u32 vcc, 8, v2
    ds_add_u32 v9, v15 offset:1024
    v_bfe_u32 v10, v171, 22, 6
    v_lshlrev_b32 v10, 2, v10
    v_cmpx_lt_u32 vcc, 9, v2
    ds_add_u32 v10, v15 offset:1024
    s_mov_b64 exec, -1
DEG_DONE:
    v_lshlrev_b32 v9, 2, v8
    v_cmp_gt_u32 s[42:43], 40, v8
    v_sub_u32 v10, 63, v8
    s_mul_i32 s10, s25, 5
    s_waitcnt lgkmcnt(0)
    s_barrier
    ds_read_b32 v84, v9 offset:1024
    v_add_u32 v11, s10, v8
    v_lshlrev_b32 v12, 2, v11
    s_waitcnt lgkmcnt(0)
    v_lshl_or_b32 v84, v84, 6, v10
    v_cndmask_b32 v84, 0, v84, s[42:43]
    s_nop 0
    v_readlane_b32 s4, v84, s10
    s_add_u32 s10, s10, 1
    v_readlane_b32 s5, v84, s10
    s_add_u32 s10, s10, 1
    v_readlane_b32 s6, v84, s10
    s_add_u32 s10, s10, 1
    v_readlane_b32 s7, v84, s10
    s_add_u32 s10, s10, 1
    v_readlane_b32 s8, v84, s10
    v_cmp_lt_u32 s[48:49], s4, v84
    v_cmp_lt_u32 s[50:51], s5, v84
    v_cmp_lt_u32 s[52:53], s6, v84
    v_cmp_lt_u32 s[54:55], s7, v84
    v_cmp_lt_u32 s[56:57], s8, v84
    s_bcnt1_i32_b64 s4, s[48:49]
    s_bcnt1_i32_b64 s5, s[50:51]
    s_bcnt1_i32_b64 s6, s[52:53]
    s_bcnt1_i32_b64 s7, s[54:55]
    s_bcnt1_i32_b64 s8, s[56:57]
    v_readlane_b32 s4, v174, s4
    v_readlane_b32 s5, v174, s5
    v_readlane_b32 s6, v174, s6
    v_readlane_b32 s7, v174, s7
    v_readlane_b32 s8, v174, s8
    s_nop 0
    v_writelane_b32 v9, s4, 0
    v_writelane_b32 v9, s5, 1
    v_writelane_b32 v9, s6, 2
    v_writelane_b32 v9, s7, 3
    v_writelane_b32 v9, s8, 4
    v_lshrrev_b32 v10, 11, v9
    v_bfe_u32 v13, v9, 8, 3
    v_lshlrev_b32 v10, 7, v10
    v_and_b32 v9, 0xff, v9
    v_lshl_or_b32 v10, v13, 19, v10
    s_mov_b64 exec, 0x1f
    ds_write_b32 v9, v11 offset:1344
    ds_write_b32 v12, v10 offset:1536
    s_mov_b64 exec, -1
    s_waitcnt lgkmcnt(0)
    s_barrier
KEY_WAIT:
    s_lshl_b32 s3, s25, 10
    s_add_u32 s3, s3, 8704
    s_mov_b32 s9, 2621440
KEY_WAIT0:
    s_waitcnt vmcnt(0)
    v_cmp_ne_u32 s[48:49], s64, v97
    v_cmp_ne_u32 s[50:51], s64, v99
    v_cmp_ne_u32 s[52:53], s64, v101
    v_and_b32 v72, 63, v96
    v_lshlrev_b32 v72, 2, v72
    v_and_b32 v73, 63, v98
    v_lshlrev_b32 v73, 2, v73
    v_and_b32 v74, 63, v100
    v_lshlrev_b32 v74, 2, v74
    s_and_b64 s[48:49], s[48:49], s[36:37]
    s_and_b64 s[50:51], s[50:51], s[38:39]
    s_and_b64 s[52:53], s[52:53], s[40:41]
    s_or_b64 s[48:49], s[48:49], s[50:51]
    s_or_b64 s[48:49], s[48:49], s[52:53]
    s_cbranch_scc0 KEYS_OK
    s_sub_u32 s35, s35, 1
    s_cbranch_scc1 END
    s_mov_b64 exec, s[40:41]
    s_cbranch_execz SKIP3R
    buffer_load_dwordx2 v[100:101], v70, s[16:19], 0 offen sc1
SKIP3R:
    s_mov_b64 exec, s[36:37]
    buffer_load_dwordx2 v[96:97], v68, s[16:19], 0 offen sc1
    s_mov_b64 exec, s[38:39]
    buffer_load_dwordx2 v[98:99], v69, s[16:19], 0 offen sc1
    s_mov_b64 exec, -1
    s_branch KEY_WAIT0
KEYS_OK:
    ds_read_b32 v72, v72 offset:1536
    ds_read_b32 v73, v73 offset:1536
    ds_read_b32 v74, v74 offset:1536
    s_add_u32 m0, s3, 16384
    s_mov_b64 exec, s[40:41]
    s_cbranch_execz SKIP3D
    buffer_load_dwordx4 v66, s[16:19], s9 offen sc1 lds
SKIP3D:
    s_add_u32 m0, s3, 0
    s_mov_b64 exec, s[36:37]
    buffer_load_dwordx4 v64, s[16:19], s9 offen sc1 lds
    s_mov_b64 exec, -1
    v_mul_hi_u32 v76, s44, v96
    v_add_u32 v76, s45, v76
    v_and_b32 v76, 31, v76
    v_add_u32 v9, 0, v0
    v_lshlrev_b32 v9, 21, v9
    v_lshrrev_b32 v80, 10, v96
    v_lshl_or_b32 v80, v80, 7, v9
    v_mul_hi_u32 v77, s44, v98
    v_add_u32 v77, s45, v77
    v_and_b32 v77, 31, v77
    v_add_u32 v9, 512, v0
    v_lshlrev_b32 v9, 21, v9
    v_lshrrev_b32 v81, 10, v98
    v_lshl_or_b32 v81, v81, 7, v9
    v_mul_hi_u32 v78, s44, v100
    v_add_u32 v78, s45, v78
    v_and_b32 v78, 31, v78
    v_add_u32 v9, 1024, v0
    v_lshlrev_b32 v9, 21, v9
    v_lshrrev_b32 v82, 10, v100
    v_lshl_or_b32 v82, v82, 7, v9
    s_waitcnt lgkmcnt(2)
    v_lshrrev_b32 v9, 16, v72
    v_and_b32 v72, 0x380, v72
    v_or_b32 v80, v80, v9
    v_lshl_add_u32 v72, v76, 2, v72
    s_waitcnt lgkmcnt(1)
    v_lshrrev_b32 v9, 16, v73
    v_and_b32 v73, 0x380, v73
    v_or_b32 v81, v81, v9
    v_lshl_add_u32 v73, v77, 2, v73
    s_waitcnt lgkmcnt(0)
    v_lshrrev_b32 v9, 16, v74
    v_and_b32 v74, 0x380, v74
    v_or_b32 v82, v82, v9
    v_lshl_add_u32 v74, v78, 2, v74
    s_mov_b64 exec, s[36:37]
    ds_add_rtn_u32 v76, v72, v15 offset:0
    s_mov_b64 exec, s[38:39]
    ds_add_rtn_u32 v77, v73, v15 offset:0
    s_mov_b64 exec, s[40:41]
    ds_add_rtn_u32 v78, v74, v15 offset:0
    s_mov_b64 exec, -1
    s_add_u32 m0, s3, 8192
    s_mov_b64 exec, s[38:39]
    buffer_load_dwordx4 v65, s[16:19], s9 offen sc1 lds
    s_mov_b64 exec, -1
    s_lshl_b32 s10, s25, 3
    s_add_u32 s11, s10, 8
    s_and_b32 s11, s11, 63
    s_waitcnt lgkmcnt(0)
    s_barrier
    ds_read_b128 v[84:87], v1 offset:0
    s_cmp_lg_u32 s27, 0
    s_cbranch_scc1 NO_X_TOUCH_8
    s_lshr_b32 s33, s2, 3
    s_lshl_b32 s33, s33, 3
    s_add_u32 s33, s33, s25
    s_lshl_b32 s33, s33, 7
    s_add_u32 s33, s33, s61
    s_add_u32 s33, s33, 917504
    v_min_u32 v166, 160, v1
    v_lshl_add_u32 v166, v166, 11, s33
    buffer_load_dword v167, v166, s[12:15], 0 offen
NO_X_TOUCH_8:
    s_waitcnt lgkmcnt(0)
    v_add_u32 v10, v84, v85
    v_add3_u32 v10, v10, v86, v87
    v_mov_b32 v11, v10
    s_nop 1
    v_add_u32_dpp v11, v11, v11 row_shr:1 row_mask:0xf bank_mask:0xf bound_ctrl:0
    s_nop 1
    v_add_u32_dpp v11, v11, v11 row_shr:2 row_mask:0xf bank_mask:0xf bound_ctrl:0
    s_nop 1
    v_add_u32_dpp v11, v11, v11 row_shr:4 row_mask:0xf bank_mask:0xf bound_ctrl:0
    s_nop 1
    v_add_u32_dpp v11, v11, v11 row_shr:8 row_mask:0xf bank_mask:0xf bound_ctrl:0
    s_nop 1
    v_add_u32_dpp v11, v11, v11 row_bcast:15 row_mask:0xa bank_mask:0xf
    s_nop 1
    v_add_u32_dpp v11, v11, v11 row_bcast:31 row_mask:0xc bank_mask:0xf
    v_sub_u32 v88, v11, v10
    v_add_u32 v89, v88, v84
    v_add_u32 v90, v89, v85
    v_add_u32 v91, v90, v86
    ds_write_b128 v1, v[88:91] offset:1792
    v_readlane_b32 s29, v88, s10
    v_readlane_b32 s30, v88, s11
    ds_read_b32 v72, v72 offset:1792
    ds_read_b32 v73, v73 offset:1792
    ds_read_b32 v74, v74 offset:1792
    s_cmp_eq_u32 s25, 7
    s_cselect_b32 s30, s28, s30
    v_add_u32 v6, s29, v8
    v_lshlrev_b32 v5, 2, v6
    v_add_u32 v5, 2816, v5
    s_sub_u32 s11, s30, s29
    s_max_u32 s10, s11, 6
    s_add_u32 s10, s10, -3
    s_and_b32 s31, s10, -4
    s_max_u32 s10, s11, s31
    s_sub_u32 s32, s10, s31
    s_waitcnt lgkmcnt(2)
    v_add_lshl_u32 v72, v72, v76, 2
    s_mov_b64 exec, s[36:37]
    ds_write_b32 v72, v80 offset:2816
    s_mov_b64 exec, -1
    s_waitcnt lgkmcnt(2)
    v_add_lshl_u32 v73, v73, v77, 2
    s_mov_b64 exec, s[38:39]
    ds_write_b32 v73, v81 offset:2816
    s_mov_b64 exec, -1
    s_waitcnt lgkmcnt(2)
    v_add_lshl_u32 v74, v74, v78, 2
    s_mov_b64 exec, s[40:41]
    ds_write_b32 v74, v82 offset:2816
    s_mov_b64 exec, -1
    s_waitcnt lgkmcnt(0)
    s_barrier
    ds_read_b32 v165, v5
    s_and_b32 s10, s25, 3
    s_lshl_b32 s10, s10, 13
    s_add_u32 s10, s10, 7802880
    s_add_u32 s11, s10, 4096
    v_mov_b32 v128, 0
    v_mov_b32 v129, 0
    v_mov_b32 v130, 0
    v_mov_b32 v131, 0
    v_mov_b32 v132, 0
    v_mov_b32 v133, 0
    v_mov_b32 v134, 0
    v_mov_b32 v135, 0
    s_waitcnt lgkmcnt(0)
    v_cmp_gt_u32 vcc, s30, v6
    v_add_u32 v6, 64, v6
    v_add_u32 v5, 256, v5
    v_cndmask_b32 v165, 40, v165, vcc
    v_lshrrev_b32 v8, 21, v165
    v_lshlrev_b32 v8, 4, v8
    v_lshlrev_b32 v9, 3, v165
    v_and_b32 v9, 0xfffc00, v9
    v_and_or_b32 v165, v165, 56, v9
    s_nop 0
    v_readlane_b32 s48, v165, 0
    s_and_b32 s33, s48, s34
    buffer_load_dwordx4 v[64:67], v1, s[12:15], s33 offen
    v_readlane_b32 s49, v165, 1
    s_and_b32 s33, s49, s34
    buffer_load_dwordx4 v[68:71], v1, s[12:15], s33 offen
    s_cmp_lg_u32 s27, 0
    s_cbranch_scc1 REC_WAIT
    s_waitcnt vmcnt(3)
    s_branch REC_IN
REC_WAIT:
    s_waitcnt vmcnt(2)
REC_IN:
    s_barrier
    ds_read_b128 v[168:171], v8 offset:8704
    v_readlane_b32 s50, v165, 2
    s_and_b32 s33, s50, s34
    buffer_load_dwordx4 v[72:75], v1, s[12:15], s33 offen
    v_readlane_b32 s51, v165, 3
    s_and_b32 s33, s51, s34
    buffer_load_dwordx4 v[76:79], v1, s[12:15], s33 offen
    v_readlane_b32 s52, v165, 4
    s_and_b32 s33, s52, s34
    buffer_load_dwordx4 v[80:83], v1, s[12:15], s33 offen
    v_readlane_b32 s53, v165, 5
    s_and_b32 s33, s53, s34
    buffer_load_dwordx4 v[84:87], v1, s[12:15], s33 offen
    v_mov_b32 v164, v165
    s_waitcnt lgkmcnt(0)
    v_mov_b32 v172, v170
    v_mov_b32 v173, v171
    v_mfma_f32_4x4x4_16b_bf16 v[148:151], v[168:169], v[180:181], 0
    v_mfma_f32_4x4x4_16b_bf16 v[152:155], v[168:169], v[182:183], 0
    v_mfma_f32_4x4x4_16b_bf16 v[156:159], v[168:169], v[184:185], 0
    v_mfma_f32_4x4x4_16b_bf16 v[160:163], v[168:169], v[186:187], 0
    v_mfma_f32_4x4x4_16b_bf16 v[112:115], v[172:173], v[176:177], 0 cbsz:4 abid:0
    v_mfma_f32_4x4x4_16b_bf16 v[116:119], v[172:173], v[178:179], 0 cbsz:4 abid:0
    v_mfma_f32_4x4x4_16b_bf16 v[120:123], v[172:173], v[176:177], 0 cbsz:4 abid:1
    s_nop 1
    v_cvt_pk_bf16_f32 v140, v148, v152
    v_cvt_pk_bf16_f32 v141, v156, v160
    v_cvt_pk_bf16_f32 v142, v149, v153
    v_cvt_pk_bf16_f32 v143, v157, v161
    v_cvt_pk_bf16_f32 v144, v150, v154
    v_cvt_pk_bf16_f32 v145, v158, v162
    v_cvt_pk_bf16_f32 v146, v151, v155
    v_cvt_pk_bf16_f32 v147, v159, v163
    v_lshlrev_b32_sdwa v136, v15, v112 dst_sel:DWORD dst_unused:UNUSED_PAD src0_sel:DWORD src1_sel:WORD_1
    v_lshlrev_b32_sdwa v137, v15, v113 dst_sel:DWORD dst_unused:UNUSED_PAD src0_sel:DWORD src1_sel:WORD_1
    ds_read_u16_d16_hi v128, v136 offset:32768
    ds_read_u16_d16_hi v129, v137 offset:32768
    v_lshlrev_b32_sdwa v138, v15, v116 dst_sel:DWORD dst_unused:UNUSED_PAD src0_sel:DWORD src1_sel:WORD_1
    v_lshlrev_b32_sdwa v139, v15, v117 dst_sel:DWORD dst_unused:UNUSED_PAD src0_sel:DWORD src1_sel:WORD_1
    ds_read_u16_d16_hi v130, v138 offset:32768
    ds_read_u16_d16_hi v131, v139 offset:32768
    s_waitcnt vmcnt(5)
    v_mfma_f32_4x4x4_16b_bf16 v[96:99], v[140:141], v[64:65], 0 cbsz:4 abid:0
    v_mfma_f32_4x4x4_16b_bf16 v[100:103], v[140:141], v[66:67], 0 cbsz:4 abid:0
A_0:
    s_sub_u32 s31, s31, 4
    s_cbranch_scc1 B_0
    v_mfma_f32_4x4x4_16b_bf16 v[124:127], v[172:173], v[178:179], 0 cbsz:4 abid:1
    v_lshlrev_b32_sdwa v136, v15, v114 dst_sel:DWORD dst_unused:UNUSED_PAD src0_sel:DWORD src1_sel:WORD_1
    s_waitcnt vmcnt(4)
    v_mfma_f32_4x4x4_16b_bf16 v[104:107], v[142:143], v[68:69], 0 cbsz:4 abid:0
    v_readlane_b32 s54, v164, 6
    v_mfma_f32_4x4x4_16b_bf16 v[108:111], v[142:143], v[70:71], 0 cbsz:4 abid:0
    v_lshlrev_b32_sdwa v137, v15, v115 dst_sel:DWORD dst_unused:UNUSED_PAD src0_sel:DWORD src1_sel:WORD_1
    ds_read_u16_d16_hi v132, v136 offset:32768
    ds_read_u16_d16_hi v133, v137 offset:32768
    s_and_b32 s33, s54, s34
    buffer_load_dwordx4 v[88:91], v1, s[12:15], s33 offen
    s_waitcnt lgkmcnt(2)
    s_set_gpr_idx_on s48, 0xc
    v_pk_fma_f32 v[16:17], v[128:129], v[96:97], v[16:17] op_sel:[0,0,0] op_sel_hi:[0,1,1]
    v_pk_fma_f32 v[18:19], v[128:129], v[98:99], v[18:19] op_sel:[0,0,0] op_sel_hi:[0,1,1]
    v_pk_fma_f32 v[20:21], v[130:131], v[100:101], v[20:21] op_sel:[0,0,0] op_sel_hi:[0,1,1]
    v_pk_fma_f32 v[22:23], v[130:131], v[102:103], v[22:23] op_sel:[0,0,0] op_sel_hi:[0,1,1]
    s_set_gpr_idx_off
    v_lshlrev_b32_sdwa v138, v15, v118 dst_sel:DWORD dst_unused:UNUSED_PAD src0_sel:DWORD src1_sel:WORD_1
    s_waitcnt vmcnt(4)
    v_mfma_f32_4x4x4_16b_bf16 v[96:99], v[144:145], v[72:73], 0 cbsz:4 abid:0
    v_readlane_b32 s55, v164, 7
    v_mfma_f32_4x4x4_16b_bf16 v[100:103], v[144:145], v[74:75], 0 cbsz:4 abid:0
    v_lshlrev_b32_sdwa v139, v15, v119 dst_sel:DWORD dst_unused:UNUSED_PAD src0_sel:DWORD src1_sel:WORD_1
    ds_read_u16_d16_hi v134, v138 offset:32768
    ds_read_u16_d16_hi v135, v139 offset:32768
    s_and_b32 s33, s55, s34
    buffer_load_dwordx4 v[92:95], v1, s[12:15], s33 offen
    s_set_gpr_idx_on s49, 0xc
    v_pk_fma_f32 v[16:17], v[128:129], v[104:105], v[16:17] op_sel:[1,0,0] op_sel_hi:[1,1,1]
    v_pk_fma_f32 v[18:19], v[128:129], v[106:107], v[18:19] op_sel:[1,0,0] op_sel_hi:[1,1,1]
    v_pk_fma_f32 v[20:21], v[130:131], v[108:109], v[20:21] op_sel:[1,0,0] op_sel_hi:[1,1,1]
    v_pk_fma_f32 v[22:23], v[130:131], v[110:111], v[22:23] op_sel:[1,0,0] op_sel_hi:[1,1,1]
    s_set_gpr_idx_off
    v_mfma_f32_4x4x4_16b_bf16 v[112:115], v[172:173], v[176:177], 0 cbsz:4 abid:2
    v_lshlrev_b32_sdwa v136, v15, v120 dst_sel:DWORD dst_unused:UNUSED_PAD src0_sel:DWORD src1_sel:WORD_1
    s_waitcnt vmcnt(4)
    v_mfma_f32_4x4x4_16b_bf16 v[104:107], v[146:147], v[76:77], 0 cbsz:4 abid:0
    v_readlane_b32 s56, v164, 8
    v_mfma_f32_4x4x4_16b_bf16 v[108:111], v[146:147], v[78:79], 0 cbsz:4 abid:0
    v_lshlrev_b32_sdwa v137, v15, v121 dst_sel:DWORD dst_unused:UNUSED_PAD src0_sel:DWORD src1_sel:WORD_1
    ds_read_u16_d16_hi v128, v136 offset:32768
    ds_read_u16_d16_hi v129, v137 offset:32768
    s_and_b32 s33, s56, s34
    buffer_load_dwordx4 v[64:67], v1, s[12:15], s33 offen
    s_waitcnt lgkmcnt(2)
    s_set_gpr_idx_on s50, 0xc
    v_pk_fma_f32 v[16:17], v[132:133], v[96:97], v[16:17] op_sel:[0,0,0] op_sel_hi:[0,1,1]
    v_pk_fma_f32 v[18:19], v[132:133], v[98:99], v[18:19] op_sel:[0,0,0] op_sel_hi:[0,1,1]
    v_pk_fma_f32 v[20:21], v[134:135], v[100:101], v[20:21] op_sel:[0,0,0] op_sel_hi:[0,1,1]
    v_pk_fma_f32 v[22:23], v[134:135], v[102:103], v[22:23] op_sel:[0,0,0] op_sel_hi:[0,1,1]
    s_set_gpr_idx_off
    v_lshlrev_b32_sdwa v138, v15, v124 dst_sel:DWORD dst_unused:UNUSED_PAD src0_sel:DWORD src1_sel:WORD_1
    s_waitcnt vmcnt(4)
    v_mfma_f32_4x4x4_16b_bf16 v[96:99], v[140:141], v[80:81], 0 cbsz:4 abid:1
    v_readlane_b32 s57, v164, 9
    v_mfma_f32_4x4x4_16b_bf16 v[100:103], v[140:141], v[82:83], 0 cbsz:4 abid:1
    v_lshlrev_b32_sdwa v139, v15, v125 dst_sel:DWORD dst_unused:UNUSED_PAD src0_sel:DWORD src1_sel:WORD_1
    ds_read_u16_d16_hi v130, v138 offset:32768
    ds_read_u16_d16_hi v131, v139 offset:32768
    s_and_b32 s33, s57, s34
    buffer_load_dwordx4 v[68:71], v1, s[12:15], s33 offen
    s_set_gpr_idx_on s51, 0xc
    v_pk_fma_f32 v[16:17], v[132:133], v[104:105], v[16:17] op_sel:[1,0,0] op_sel_hi:[1,1,1]
    v_pk_fma_f32 v[18:19], v[132:133], v[106:107], v[18:19] op_sel:[1,0,0] op_sel_hi:[1,1,1]
    v_pk_fma_f32 v[20:21], v[134:135], v[108:109], v[20:21] op_sel:[1,0,0] op_sel_hi:[1,1,1]
    v_pk_fma_f32 v[22:23], v[134:135], v[110:111], v[22:23] op_sel:[1,0,0] op_sel_hi:[1,1,1]
    s_set_gpr_idx_off
A_4:
    s_sub_u32 s31, s31, 4
    s_cbranch_scc1 B_4
    v_mfma_f32_4x4x4_16b_bf16 v[116:119], v[172:173], v[178:179], 0 cbsz:4 abid:2
    v_lshlrev_b32_sdwa v136, v15, v122 dst_sel:DWORD dst_unused:UNUSED_PAD src0_sel:DWORD src1_sel:WORD_1
    s_waitcnt vmcnt(4)
    v_mfma_f32_4x4x4_16b_bf16 v[104:107], v[142:143], v[84:85], 0 cbsz:4 abid:1
    v_readlane_b32 s58, v164, 10
    v_mfma_f32_4x4x4_16b_bf16 v[108:111], v[142:143], v[86:87], 0 cbsz:4 abid:1
    v_lshlrev_b32_sdwa v137, v15, v123 dst_sel:DWORD dst_unused:UNUSED_PAD src0_sel:DWORD src1_sel:WORD_1
    ds_read_u16_d16_hi v132, v136 offset:32768
    ds_read_u16_d16_hi v133, v137 offset:32768
    s_and_b32 s33, s58, s34
    buffer_load_dwordx4 v[72:75], v1, s[12:15], s33 offen
    s_waitcnt lgkmcnt(2)
    s_set_gpr_idx_on s52, 0xc
    v_pk_fma_f32 v[16:17], v[128:129], v[96:97], v[16:17] op_sel:[0,0,0] op_sel_hi:[0,1,1]
    v_pk_fma_f32 v[18:19], v[128:129], v[98:99], v[18:19] op_sel:[0,0,0] op_sel_hi:[0,1,1]
    v_pk_fma_f32 v[20:21], v[130:131], v[100:101], v[20:21] op_sel:[0,0,0] op_sel_hi:[0,1,1]
    v_pk_fma_f32 v[22:23], v[130:131], v[102:103], v[22:23] op_sel:[0,0,0] op_sel_hi:[0,1,1]
    s_set_gpr_idx_off
    v_lshlrev_b32_sdwa v138, v15, v126 dst_sel:DWORD dst_unused:UNUSED_PAD src0_sel:DWORD src1_sel:WORD_1
    s_waitcnt vmcnt(4)
    v_mfma_f32_4x4x4_16b_bf16 v[96:99], v[144:145], v[88:89], 0 cbsz:4 abid:1
    v_readlane_b32 s59, v164, 11
    v_mfma_f32_4x4x4_16b_bf16 v[100:103], v[144:145], v[90:91], 0 cbsz:4 abid:1
    v_lshlrev_b32_sdwa v139, v15, v127 dst_sel:DWORD dst_unused:UNUSED_PAD src0_sel:DWORD src1_sel:WORD_1
    ds_read_u16_d16_hi v134, v138 offset:32768
    ds_read_u16_d16_hi v135, v139 offset:32768
    s_and_b32 s33, s59, s34
    buffer_load_dwordx4 v[76:79], v1, s[12:15], s33 offen
    s_set_gpr_idx_on s53, 0xc
    v_pk_fma_f32 v[16:17], v[128:129], v[104:105], v[16:17] op_sel:[1,0,0] op_sel_hi:[1,1,1]
    v_pk_fma_f32 v[18:19], v[128:129], v[106:107], v[18:19] op_sel:[1,0,0] op_sel_hi:[1,1,1]
    v_pk_fma_f32 v[20:21], v[130:131], v[108:109], v[20:21] op_sel:[1,0,0] op_sel_hi:[1,1,1]
    v_pk_fma_f32 v[22:23], v[130:131], v[110:111], v[22:23] op_sel:[1,0,0] op_sel_hi:[1,1,1]
    s_set_gpr_idx_off
    v_mfma_f32_4x4x4_16b_bf16 v[120:123], v[172:173], v[176:177], 0 cbsz:4 abid:3
    v_lshlrev_b32_sdwa v136, v15, v112 dst_sel:DWORD dst_unused:UNUSED_PAD src0_sel:DWORD src1_sel:WORD_1
    s_waitcnt vmcnt(4)
    v_mfma_f32_4x4x4_16b_bf16 v[104:107], v[146:147], v[92:93], 0 cbsz:4 abid:1
    v_readlane_b32 s60, v164, 12
    v_mfma_f32_4x4x4_16b_bf16 v[108:111], v[146:147], v[94:95], 0 cbsz:4 abid:1
    v_lshlrev_b32_sdwa v137, v15, v113 dst_sel:DWORD dst_unused:UNUSED_PAD src0_sel:DWORD src1_sel:WORD_1
    ds_read_u16_d16_hi v128, v136 offset:32768
    ds_read_u16_d16_hi v129, v137 offset:32768
    s_and_b32 s33, s60, s34
    buffer_load_dwordx4 v[80:83], v1, s[12:15], s33 offen
    s_waitcnt lgkmcnt(2)
    s_set_gpr_idx_on s54, 0xc
    v_pk_fma_f32 v[16:17], v[132:133], v[96:97], v[16:17] op_sel:[0,0,0] op_sel_hi:[0,1,1]
    v_pk_fma_f32 v[18:19], v[132:133], v[98:99], v[18:19] op_sel:[0,0,0] op_sel_hi:[0,1,1]
    v_pk_fma_f32 v[20:21], v[134:135], v[100:101], v[20:21] op_sel:[0,0,0] op_sel_hi:[0,1,1]
    v_pk_fma_f32 v[22:23], v[134:135], v[102:103], v[22:23] op_sel:[0,0,0] op_sel_hi:[0,1,1]
    s_set_gpr_idx_off
    v_lshlrev_b32_sdwa v138, v15, v116 dst_sel:DWORD dst_unused:UNUSED_PAD src0_sel:DWORD src1_sel:WORD_1
    s_waitcnt vmcnt(4)
    v_mfma_f32_4x4x4_16b_bf16 v[96:99], v[140:141], v[64:65], 0 cbsz:4 abid:2
    v_readlane_b32 s61, v164, 13
    v_mfma_f32_4x4x4_16b_bf16 v[100:103], v[140:141], v[66:67], 0 cbsz:4 abid:2
    v_lshlrev_b32_sdwa v139, v15, v117 dst_sel:DWORD dst_unused:UNUSED_PAD src0_sel:DWORD src1_sel:WORD_1
    ds_read_u16_d16_hi v130, v138 offset:32768
    ds_read_u16_d16_hi v131, v139 offset:32768
    s_and_b32 s33, s61, s34
    buffer_load_dwordx4 v[84:87], v1, s[12:15], s33 offen
    s_set_gpr_idx_on s55, 0xc
    v_pk_fma_f32 v[16:17], v[132:133], v[104:105], v[16:17] op_sel:[1,0,0] op_sel_hi:[1,1,1]
    v_pk_fma_f32 v[18:19], v[132:133], v[106:107], v[18:19] op_sel:[1,0,0] op_sel_hi:[1,1,1]
    v_pk_fma_f32 v[20:21], v[134:135], v[108:109], v[20:21] op_sel:[1,0,0] op_sel_hi:[1,1,1]
    v_pk_fma_f32 v[22:23], v[134:135], v[110:111], v[22:23] op_sel:[1,0,0] op_sel_hi:[1,1,1]
    s_set_gpr_idx_off
A_8:
    s_sub_u32 s31, s31, 4
    s_cbranch_scc1 B_8
    v_mfma_f32_4x4x4_16b_bf16 v[124:127], v[172:173], v[178:179], 0 cbsz:4 abid:3
    v_lshlrev_b32_sdwa v136, v15, v114 dst_sel:DWORD dst_unused:UNUSED_PAD src0_sel:DWORD src1_sel:WORD_1
    s_waitcnt vmcnt(4)
    v_mfma_f32_4x4x4_16b_bf16 v[104:107], v[142:143], v[68:69], 0 cbsz:4 abid:2
    v_readlane_b32 s62, v164, 14
    v_mfma_f32_4x4x4_16b_bf16 v[108:111], v[142:143], v[70:71], 0 cbsz:4 abid:2
    v_lshlrev_b32_sdwa v137, v15, v115 dst_sel:DWORD dst_unused:UNUSED_PAD src0_sel:DWORD src1_sel:WORD_1
    ds_read_u16_d16_hi v132, v136 offset:32768
    ds_read_u16_d16_hi v133, v137 offset:32768
    s_and_b32 s33, s62, s34
    buffer_load_dwordx4 v[88:91], v1, s[12:15], s33 offen
    s_waitcnt lgkmcnt(2)
    s_set_gpr_idx_on s56, 0xc
    v_pk_fma_f32 v[16:17], v[128:129], v[96:97], v[16:17] op_sel:[0,0,0] op_sel_hi:[0,1,1]
    v_pk_fma_f32 v[18:19], v[128:129], v[98:99], v[18:19] op_sel:[0,0,0] op_sel_hi:[0,1,1]
    v_pk_fma_f32 v[20:21], v[130:131], v[100:101], v[20:21] op_sel:[0,0,0] op_sel_hi:[0,1,1]
    v_pk_fma_f32 v[22:23], v[130:131], v[102:103], v[22:23] op_sel:[0,0,0] op_sel_hi:[0,1,1]
    s_set_gpr_idx_off
    ds_read_b32 v165, v5
    v_lshlrev_b32_sdwa v138, v15, v118 dst_sel:DWORD dst_unused:UNUSED_PAD src0_sel:DWORD src1_sel:WORD_1
    s_waitcnt vmcnt(4)
    v_mfma_f32_4x4x4_16b_bf16 v[96:99], v[144:145], v[72:73], 0 cbsz:4 abid:2
    v_readlane_b32 s63, v164, 15
    v_mfma_f32_4x4x4_16b_bf16 v[100:103], v[144:145], v[74:75], 0 cbsz:4 abid:2
    v_lshlrev_b32_sdwa v139, v15, v119 dst_sel:DWORD dst_unused:UNUSED_PAD src0_sel:DWORD src1_sel:WORD_1
    ds_read_u16_d16_hi v134, v138 offset:32768
    ds_read_u16_d16_hi v135, v139 offset:32768
    s_and_b32 s33, s63, s34
    buffer_load_dwordx4 v[92:95], v1, s[12:15], s33 offen
    s_set_gpr_idx_on s57, 0xc
    v_pk_fma_f32 v[16:17], v[128:129], v[104:105], v[16:17] op_sel:[1,0,0] op_sel_hi:[1,1,1]
    v_pk_fma_f32 v[18:19], v[128:129], v[106:107], v[18:19] op_sel:[1,0,0] op_sel_hi:[1,1,1]
    v_pk_fma_f32 v[20:21], v[130:131], v[108:109], v[20:21] op_sel:[1,0,0] op_sel_hi:[1,1,1]
    v_pk_fma_f32 v[22:23], v[130:131], v[110:111], v[22:23] op_sel:[1,0,0] op_sel_hi:[1,1,1]
    s_set_gpr_idx_off
    v_mfma_f32_4x4x4_16b_bf16 v[112:115], v[172:173], v[176:177], 0 cbsz:4 abid:4
    v_lshlrev_b32_sdwa v136, v15, v120 dst_sel:DWORD dst_unused:UNUSED_PAD src0_sel:DWORD src1_sel:WORD_1
    s_waitcnt vmcnt(4)
    v_mfma_f32_4x4x4_16b_bf16 v[104:107], v[146:147], v[76:77], 0 cbsz:4 abid:2
    v_readlane_b32 s48, v164, 16
    v_mfma_f32_4x4x4_16b_bf16 v[108:111], v[146:147], v[78:79], 0 cbsz:4 abid:2
    v_lshlrev_b32_sdwa v137, v15, v121 dst_sel:DWORD dst_unused:UNUSED_PAD src0_sel:DWORD src1_sel:WORD_1
    ds_read_u16_d16_hi v128, v136 offset:32768
    ds_read_u16_d16_hi v129, v137 offset:32768
    s_and_b32 s33, s48, s34
    buffer_load_dwordx4 v[64:67], v1, s[12:15], s33 offen
    s_waitcnt lgkmcnt(2)
    s_set_gpr_idx_on s58, 0xc
    v_pk_fma_f32 v[16:17], v[132:133], v[96:97], v[16:17] op_sel:[0,0,0] op_sel_hi:[0,1,1]
    v_pk_fma_f32 v[18:19], v[132:133], v[98:99], v[18:19] op_sel:[0,0,0] op_sel_hi:[0,1,1]
    v_pk_fma_f32 v[20:21], v[134:135], v[100:101], v[20:21] op_sel:[0,0,0] op_sel_hi:[0,1,1]
    v_pk_fma_f32 v[22:23], v[134:135], v[102:103], v[22:23] op_sel:[0,0,0] op_sel_hi:[0,1,1]
    s_set_gpr_idx_off
    v_lshlrev_b32_sdwa v138, v15, v124 dst_sel:DWORD dst_unused:UNUSED_PAD src0_sel:DWORD src1_sel:WORD_1
    s_waitcnt vmcnt(4)
    v_mfma_f32_4x4x4_16b_bf16 v[96:99], v[140:141], v[80:81], 0 cbsz:4 abid:3
    v_readlane_b32 s49, v164, 17
    v_mfma_f32_4x4x4_16b_bf16 v[100:103], v[140:141], v[82:83], 0 cbsz:4 abid:3
    v_lshlrev_b32_sdwa v139, v15, v125 dst_sel:DWORD dst_unused:UNUSED_PAD src0_sel:DWORD src1_sel:WORD_1
    ds_read_u16_d16_hi v130, v138 offset:32768
    ds_read_u16_d16_hi v131, v139 offset:32768
    s_and_b32 s33, s49, s34
    buffer_load_dwordx4 v[68:71], v1, s[12:15], s33 offen
    s_set_gpr_idx_on s59, 0xc
    v_pk_fma_f32 v[16:17], v[132:133], v[104:105], v[16:17] op_sel:[1,0,0] op_sel_hi:[1,1,1]
    v_pk_fma_f32 v[18:19], v[132:133], v[106:107], v[18:19] op_sel:[1,0,0] op_sel_hi:[1,1,1]
    v_pk_fma_f32 v[20:21], v[134:135], v[108:109], v[20:21] op_sel:[1,0,0] op_sel_hi:[1,1,1]
    v_pk_fma_f32 v[22:23], v[134:135], v[110:111], v[22:23] op_sel:[1,0,0] op_sel_hi:[1,1,1]
    s_set_gpr_idx_off
A_12:
    s_sub_u32 s31, s31, 4
    s_cbranch_scc1 B_12
    v_mfma_f32_4x4x4_16b_bf16 v[116:119], v[172:173], v[178:179], 0 cbsz:4 abid:4
    v_lshlrev_b32_sdwa v136, v15, v122 dst_sel:DWORD dst_unused:UNUSED_PAD src0_sel:DWORD src1_sel:WORD_1
    s_waitcnt vmcnt(4)
    v_mfma_f32_4x4x4_16b_bf16 v[104:107], v[142:143], v[84:85], 0 cbsz:4 abid:3
    v_readlane_b32 s50, v164, 18
    v_mfma_f32_4x4x4_16b_bf16 v[108:111], v[142:143], v[86:87], 0 cbsz:4 abid:3
    v_lshlrev_b32_sdwa v137, v15, v123 dst_sel:DWORD dst_unused:UNUSED_PAD src0_sel:DWORD src1_sel:WORD_1
    ds_read_u16_d16_hi v132, v136 offset:32768
    ds_read_u16_d16_hi v133, v137 offset:32768
    s_and_b32 s33, s50, s34
    buffer_load_dwordx4 v[72:75], v1, s[12:15], s33 offen
    s_waitcnt lgkmcnt(2)
    s_set_gpr_idx_on s60, 0xc
    v_pk_fma_f32 v[16:17], v[128:129], v[96:97], v[16:17] op_sel:[0,0,0] op_sel_hi:[0,1,1]
    v_pk_fma_f32 v[18:19], v[128:129], v[98:99], v[18:19] op_sel:[0,0,0] op_sel_hi:[0,1,1]
    v_pk_fma_f32 v[20:21], v[130:131], v[100:101], v[20:21] op_sel:[0,0,0] op_sel_hi:[0,1,1]
    v_pk_fma_f32 v[22:23], v[130:131], v[102:103], v[22:23] op_sel:[0,0,0] op_sel_hi:[0,1,1]
    s_set_gpr_idx_off
    v_cmp_gt_u32 vcc, s30, v6
    v_add_u32 v6, 64, v6
    v_add_u32 v5, 256, v5
    v_cndmask_b32 v165, 40, v165, vcc
    v_lshrrev_b32 v8, 21, v165
    v_lshlrev_b32 v8, 4, v8
    v_lshlrev_b32 v9, 3, v165
    ds_read_b128 v[168:171], v8 offset:8704
    v_and_b32 v9, 0xfffc00, v9
    v_and_or_b32 v165, v165, 56, v9
    v_lshlrev_b32_sdwa v138, v15, v126 dst_sel:DWORD dst_unused:UNUSED_PAD src0_sel:DWORD src1_sel:WORD_1
    s_waitcnt vmcnt(4)
    v_mfma_f32_4x4x4_16b_bf16 v[96:99], v[144:145], v[88:89], 0 cbsz:4 abid:3
    v_readlane_b32 s51, v164, 19
    v_mfma_f32_4x4x4_16b_bf16 v[100:103], v[144:145], v[90:91], 0 cbsz:4 abid:3
    v_lshlrev_b32_sdwa v139, v15, v127 dst_sel:DWORD dst_unused:UNUSED_PAD src0_sel:DWORD src1_sel:WORD_1
    ds_read_u16_d16_hi v134, v138 offset:32768
    ds_read_u16_d16_hi v135, v139 offset:32768
    s_and_b32 s33, s51, s34
    buffer_load_dwordx4 v[76:79], v1, s[12:15], s33 offen
    s_set_gpr_idx_on s61, 0xc
    v_pk_fma_f32 v[16:17], v[128:129], v[104:105], v[16:17] op_sel:[1,0,0] op_sel_hi:[1,1,1]
    v_pk_fma_f32 v[18:19], v[128:129], v[106:107], v[18:19] op_sel:[1,0,0] op_sel_hi:[1,1,1]
    v_pk_fma_f32 v[20:21], v[130:131], v[108:109], v[20:21] op_sel:[1,0,0] op_sel_hi:[1,1,1]
    v_pk_fma_f32 v[22:23], v[130:131], v[110:111], v[22:23] op_sel:[1,0,0] op_sel_hi:[1,1,1]
    s_set_gpr_idx_off
    v_mfma_f32_4x4x4_16b_bf16 v[120:123], v[172:173], v[176:177], 0 cbsz:4 abid:5
    v_lshlrev_b32_sdwa v136, v15, v112 dst_sel:DWORD dst_unused:UNUSED_PAD src0_sel:DWORD src1_sel:WORD_1
    s_waitcnt vmcnt(4)
    v_mfma_f32_4x4x4_16b_bf16 v[104:107], v[146:147], v[92:93], 0 cbsz:4 abid:3
    v_readlane_b32 s52, v164, 20
    v_mfma_f32_4x4x4_16b_bf16 v[108:111], v[146:147], v[94:95], 0 cbsz:4 abid:3
    v_lshlrev_b32_sdwa v137, v15, v113 dst_sel:DWORD dst_unused:UNUSED_PAD src0_sel:DWORD src1_sel:WORD_1
    ds_read_u16_d16_hi v128, v136 offset:32768
    ds_read_u16_d16_hi v129, v137 offset:32768
    s_and_b32 s33, s52, s34
    buffer_load_dwordx4 v[80:83], v1, s[12:15], s33 offen
    s_waitcnt lgkmcnt(2)
    s_set_gpr_idx_on s62, 0xc
    v_pk_fma_f32 v[16:17], v[132:133], v[96:97], v[16:17] op_sel:[0,0,0] op_sel_hi:[0,1,1]
    v_pk_fma_f32 v[18:19], v[132:133], v[98:99], v[18:19] op_sel:[0,0,0] op_sel_hi:[0,1,1]
    v_pk_fma_f32 v[20:21], v[134:135], v[100:101], v[20:21] op_sel:[0,0,0] op_sel_hi:[0,1,1]
    v_pk_fma_f32 v[22:23], v[134:135], v[102:103], v[22:23] op_sel:[0,0,0] op_sel_hi:[0,1,1]
    s_set_gpr_idx_off
    v_lshlrev_b32_sdwa v138, v15, v116 dst_sel:DWORD dst_unused:UNUSED_PAD src0_sel:DWORD src1_sel:WORD_1
    s_waitcnt vmcnt(4)
    v_mfma_f32_4x4x4_16b_bf16 v[96:99], v[140:141], v[64:65], 0 cbsz:4 abid:4
    v_readlane_b32 s53, v164, 21
    v_mfma_f32_4x4x4_16b_bf16 v[100:103], v[140:141], v[66:67], 0 cbsz:4 abid:4
    v_lshlrev_b32_sdwa v139, v15, v117 dst_sel:DWORD dst_unused:UNUSED_PAD src0_sel:DWORD src1_sel:WORD_1
    ds_read_u16_d16_hi v130, v138 offset:32768
    ds_read_u16_d16_hi v131, v139 offset:32768
    s_and_b32 s33, s53, s34
    buffer_load_dwordx4 v[84:87], v1, s[12:15], s33 offen
    s_set_gpr_idx_on s63, 0xc
    v_pk_fma_f32 v[16:17], v[132:133], v[104:105], v[16:17] op_sel:[1,0,0] op_sel_hi:[1,1,1]
    v_pk_fma_f32 v[18:19], v[132:133], v[106:107], v[18:19] op_sel:[1,0,0] op_sel_hi:[1,1,1]
    v_pk_fma_f32 v[20:21], v[134:135], v[108:109], v[20:21] op_sel:[1,0,0] op_sel_hi:[1,1,1]
    v_pk_fma_f32 v[22:23], v[134:135], v[110:111], v[22:23] op_sel:[1,0,0] op_sel_hi:[1,1,1]
    s_set_gpr_idx_off
A_16:
    s_sub_u32 s31, s31, 4
    s_cbranch_scc1 B_16
    v_mfma_f32_4x4x4_16b_bf16 v[124:127], v[172:173], v[178:179], 0 cbsz:4 abid:5
    v_lshlrev_b32_sdwa v136, v15, v114 dst_sel:DWORD dst_unused:UNUSED_PAD src0_sel:DWORD src1_sel:WORD_1
    s_waitcnt vmcnt(4)
    v_mfma_f32_4x4x4_16b_bf16 v[104:107], v[142:143], v[68:69], 0 cbsz:4 abid:4
    v_readlane_b32 s54, v164, 22
    v_mfma_f32_4x4x4_16b_bf16 v[108:111], v[142:143], v[70:71], 0 cbsz:4 abid:4
    v_lshlrev_b32_sdwa v137, v15, v115 dst_sel:DWORD dst_unused:UNUSED_PAD src0_sel:DWORD src1_sel:WORD_1
    ds_read_u16_d16_hi v132, v136 offset:32768
    ds_read_u16_d16_hi v133, v137 offset:32768
    s_and_b32 s33, s54, s34
    buffer_load_dwordx4 v[88:91], v1, s[12:15], s33 offen
    s_waitcnt lgkmcnt(2)
    s_set_gpr_idx_on s48, 0xc
    v_pk_fma_f32 v[16:17], v[128:129], v[96:97], v[16:17] op_sel:[0,0,0] op_sel_hi:[0,1,1]
    v_pk_fma_f32 v[18:19], v[128:129], v[98:99], v[18:19] op_sel:[0,0,0] op_sel_hi:[0,1,1]
    v_pk_fma_f32 v[20:21], v[130:131], v[100:101], v[20:21] op_sel:[0,0,0] op_sel_hi:[0,1,1]
    v_pk_fma_f32 v[22:23], v[130:131], v[102:103], v[22:23] op_sel:[0,0,0] op_sel_hi:[0,1,1]
    s_set_gpr_idx_off
    v_lshlrev_b32_sdwa v138, v15, v118 dst_sel:DWORD dst_unused:UNUSED_PAD src0_sel:DWORD src1_sel:WORD_1
    s_waitcnt vmcnt(4)
    v_mfma_f32_4x4x4_16b_bf16 v[96:99], v[144:145], v[72:73], 0 cbsz:4 abid:4
    v_readlane_b32 s55, v164, 23
    v_mfma_f32_4x4x4_16b_bf16 v[100:103], v[144:145], v[74:75], 0 cbsz:4 abid:4
    v_lshlrev_b32_sdwa v139, v15, v119 dst_sel:DWORD dst_unused:UNUSED_PAD src0_sel:DWORD src1_sel:WORD_1
    ds_read_u16_d16_hi v134, v138 offset:32768
    ds_read_u16_d16_hi v135, v139 offset:32768
    s_and_b32 s33, s55, s34
    buffer_load_dwordx4 v[92:95], v1, s[12:15], s33 offen
    s_set_gpr_idx_on s49, 0xc
    v_pk_fma_f32 v[16:17], v[128:129], v[104:105], v[16:17] op_sel:[1,0,0] op_sel_hi:[1,1,1]
    v_pk_fma_f32 v[18:19], v[128:129], v[106:107], v[18:19] op_sel:[1,0,0] op_sel_hi:[1,1,1]
    v_pk_fma_f32 v[20:21], v[130:131], v[108:109], v[20:21] op_sel:[1,0,0] op_sel_hi:[1,1,1]
    v_pk_fma_f32 v[22:23], v[130:131], v[110:111], v[22:23] op_sel:[1,0,0] op_sel_hi:[1,1,1]
    s_set_gpr_idx_off
    v_mfma_f32_4x4x4_16b_bf16 v[112:115], v[172:173], v[176:177], 0 cbsz:4 abid:6
    v_lshlrev_b32_sdwa v136, v15, v120 dst_sel:DWORD dst_unused:UNUSED_PAD src0_sel:DWORD src1_sel:WORD_1
    s_waitcnt vmcnt(4)
    v_mfma_f32_4x4x4_16b_bf16 v[104:107], v[146:147], v[76:77], 0 cbsz:4 abid:4
    v_readlane_b32 s56, v164, 24
    v_mfma_f32_4x4x4_16b_bf16 v[108:111], v[146:147], v[78:79], 0 cbsz:4 abid:4
    v_lshlrev_b32_sdwa v137, v15, v121 dst_sel:DWORD dst_unused:UNUSED_PAD src0_sel:DWORD src1_sel:WORD_1
    ds_read_u16_d16_hi v128, v136 offset:32768
    ds_read_u16_d16_hi v129, v137 offset:32768
    s_and_b32 s33, s56, s34
    buffer_load_dwordx4 v[64:67], v1, s[12:15], s33 offen
    s_waitcnt lgkmcnt(2)
    s_set_gpr_idx_on s50, 0xc
    v_pk_fma_f32 v[16:17], v[132:133], v[96:97], v[16:17] op_sel:[0,0,0] op_sel_hi:[0,1,1]
    v_pk_fma_f32 v[18:19], v[132:133], v[98:99], v[18:19] op_sel:[0,0,0] op_sel_hi:[0,1,1]
    v_pk_fma_f32 v[20:21], v[134:135], v[100:101], v[20:21] op_sel:[0,0,0] op_sel_hi:[0,1,1]
    v_pk_fma_f32 v[22:23], v[134:135], v[102:103], v[22:23] op_sel:[0,0,0] op_sel_hi:[0,1,1]
    s_set_gpr_idx_off
    v_lshlrev_b32_sdwa v138, v15, v124 dst_sel:DWORD dst_unused:UNUSED_PAD src0_sel:DWORD src1_sel:WORD_1
    s_waitcnt vmcnt(4)
    v_mfma_f32_4x4x4_16b_bf16 v[96:99], v[140:141], v[80:81], 0 cbsz:4 abid:5
    v_readlane_b32 s57, v164, 25
    v_mfma_f32_4x4x4_16b_bf16 v[100:103], v[140:141], v[82:83], 0 cbsz:4 abid:5
    v_lshlrev_b32_sdwa v139, v15, v125 dst_sel:DWORD dst_unused:UNUSED_PAD src0_sel:DWORD src1_sel:WORD_1
    ds_read_u16_d16_hi v130, v138 offset:32768
    ds_read_u16_d16_hi v131, v139 offset:32768
    s_and_b32 s33, s57, s34
    buffer_load_dwordx4 v[68:71], v1, s[12:15], s33 offen
    s_set_gpr_idx_on s51, 0xc
    v_pk_fma_f32 v[16:17], v[132:133], v[104:105], v[16:17] op_sel:[1,0,0] op_sel_hi:[1,1,1]
    v_pk_fma_f32 v[18:19], v[132:133], v[106:107], v[18:19] op_sel:[1,0,0] op_sel_hi:[1,1,1]
    v_pk_fma_f32 v[20:21], v[134:135], v[108:109], v[20:21] op_sel:[1,0,0] op_sel_hi:[1,1,1]
    v_pk_fma_f32 v[22:23], v[134:135], v[110:111], v[22:23] op_sel:[1,0,0] op_sel_hi:[1,1,1]
    s_set_gpr_idx_off
A_20:
    s_sub_u32 s31, s31, 4
    s_cbranch_scc1 B_20
    v_mfma_f32_4x4x4_16b_bf16 v[116:119], v[172:173], v[178:179], 0 cbsz:4 abid:6
    v_lshlrev_b32_sdwa v136, v15, v122 dst_sel:DWORD dst_unused:UNUSED_PAD src0_sel:DWORD src1_sel:WORD_1
    s_waitcnt vmcnt(4)
    v_mfma_f32_4x4x4_16b_bf16 v[104:107], v[142:143], v[84:85], 0 cbsz:4 abid:5
    v_readlane_b32 s58, v164, 26
    v_mfma_f32_4x4x4_16b_bf16 v[108:111], v[142:143], v[86:87], 0 cbsz:4 abid:5
    v_lshlrev_b32_sdwa v137, v15, v123 dst_sel:DWORD dst_unused:UNUSED_PAD src0_sel:DWORD src1_sel:WORD_1
    ds_read_u16_d16_hi v132, v136 offset:32768
    ds_read_u16_d16_hi v133, v137 offset:32768
    s_and_b32 s33, s58, s34
    buffer_load_dwordx4 v[72:75], v1, s[12:15], s33 offen
    s_waitcnt lgkmcnt(2)
    s_set_gpr_idx_on s52, 0xc
    v_pk_fma_f32 v[16:17], v[128:129], v[96:97], v[16:17] op_sel:[0,0,0] op_sel_hi:[0,1,1]
    v_pk_fma_f32 v[18:19], v[128:129], v[98:99], v[18:19] op_sel:[0,0,0] op_sel_hi:[0,1,1]
    v_pk_fma_f32 v[20:21], v[130:131], v[100:101], v[20:21] op_sel:[0,0,0] op_sel_hi:[0,1,1]
    v_pk_fma_f32 v[22:23], v[130:131], v[102:103], v[22:23] op_sel:[0,0,0] op_sel_hi:[0,1,1]
    s_set_gpr_idx_off
    v_lshlrev_b32_sdwa v138, v15, v126 dst_sel:DWORD dst_unused:UNUSED_PAD src0_sel:DWORD src1_sel:WORD_1
    s_waitcnt vmcnt(4)
    v_mfma_f32_4x4x4_16b_bf16 v[96:99], v[144:145], v[88:89], 0 cbsz:4 abid:5
    v_readlane_b32 s59, v164, 27
    v_mfma_f32_4x4x4_16b_bf16 v[100:103], v[144:145], v[90:91], 0 cbsz:4 abid:5
    v_lshlrev_b32_sdwa v139, v15, v127 dst_sel:DWORD dst_unused:UNUSED_PAD src0_sel:DWORD src1_sel:WORD_1
    ds_read_u16_d16_hi v134, v138 offset:32768
    ds_read_u16_d16_hi v135, v139 offset:32768
    s_and_b32 s33, s59, s34
    buffer_load_dwordx4 v[76:79], v1, s[12:15], s33 offen
    s_set_gpr_idx_on s53, 0xc
    v_pk_fma_f32 v[16:17], v[128:129], v[104:105], v[16:17] op_sel:[1,0,0] op_sel_hi:[1,1,1]
    v_pk_fma_f32 v[18:19], v[128:129], v[106:107], v[18:19] op_sel:[1,0,0] op_sel_hi:[1,1,1]
    v_pk_fma_f32 v[20:21], v[130:131], v[108:109], v[20:21] op_sel:[1,0,0] op_sel_hi:[1,1,1]
    v_pk_fma_f32 v[22:23], v[130:131], v[110:111], v[22:23] op_sel:[1,0,0] op_sel_hi:[1,1,1]
    s_set_gpr_idx_off
    v_mfma_f32_4x4x4_16b_bf16 v[120:123], v[172:173], v[176:177], 0 cbsz:4 abid:7
    v_lshlrev_b32_sdwa v136, v15, v112 dst_sel:DWORD dst_unused:UNUSED_PAD src0_sel:DWORD src1_sel:WORD_1
    s_waitcnt vmcnt(4)
    v_mfma_f32_4x4x4_16b_bf16 v[104:107], v[146:147], v[92:93], 0 cbsz:4 abid:5
    v_readlane_b32 s60, v164, 28
    v_mfma_f32_4x4x4_16b_bf16 v[108:111], v[146:147], v[94:95], 0 cbsz:4 abid:5
    v_lshlrev_b32_sdwa v137, v15, v113 dst_sel:DWORD dst_unused:UNUSED_PAD src0_sel:DWORD src1_sel:WORD_1
    ds_read_u16_d16_hi v128, v136 offset:32768
    ds_read_u16_d16_hi v129, v137 offset:32768
    s_and_b32 s33, s60, s34
    buffer_load_dwordx4 v[80:83], v1, s[12:15], s33 offen
    s_waitcnt lgkmcnt(2)
    s_set_gpr_idx_on s54, 0xc
    v_pk_fma_f32 v[16:17], v[132:133], v[96:97], v[16:17] op_sel:[0,0,0] op_sel_hi:[0,1,1]
    v_pk_fma_f32 v[18:19], v[132:133], v[98:99], v[18:19] op_sel:[0,0,0] op_sel_hi:[0,1,1]
    v_pk_fma_f32 v[20:21], v[134:135], v[100:101], v[20:21] op_sel:[0,0,0] op_sel_hi:[0,1,1]
    v_pk_fma_f32 v[22:23], v[134:135], v[102:103], v[22:23] op_sel:[0,0,0] op_sel_hi:[0,1,1]
    s_set_gpr_idx_off
    v_lshlrev_b32_sdwa v138, v15, v116 dst_sel:DWORD dst_unused:UNUSED_PAD src0_sel:DWORD src1_sel:WORD_1
    s_waitcnt vmcnt(4)
    v_mfma_f32_4x4x4_16b_bf16 v[96:99], v[140:141], v[64:65], 0 cbsz:4 abid:6
    v_readlane_b32 s61, v164, 29
    v_mfma_f32_4x4x4_16b_bf16 v[100:103], v[140:141], v[66:67], 0 cbsz:4 abid:6
    v_lshlrev_b32_sdwa v139, v15, v117 dst_sel:DWORD dst_unused:UNUSED_PAD src0_sel:DWORD src1_sel:WORD_1
    ds_read_u16_d16_hi v130, v138 offset:32768
    ds_read_u16_d16_hi v131, v139 offset:32768
    s_and_b32 s33, s61, s34
    buffer_load_dwordx4 v[84:87], v1, s[12:15], s33 offen
    s_set_gpr_idx_on s55, 0xc
    v_pk_fma_f32 v[16:17], v[132:133], v[104:105], v[16:17] op_sel:[1,0,0] op_sel_hi:[1,1,1]
    v_pk_fma_f32 v[18:19], v[132:133], v[106:107], v[18:19] op_sel:[1,0,0] op_sel_hi:[1,1,1]
    v_pk_fma_f32 v[20:21], v[134:135], v[108:109], v[20:21] op_sel:[1,0,0] op_sel_hi:[1,1,1]
    v_pk_fma_f32 v[22:23], v[134:135], v[110:111], v[22:23] op_sel:[1,0,0] op_sel_hi:[1,1,1]
    s_set_gpr_idx_off
A_24:
    s_sub_u32 s31, s31, 4
    s_cbranch_scc1 B_24
    v_mfma_f32_4x4x4_16b_bf16 v[124:127], v[172:173], v[178:179], 0 cbsz:4 abid:7
    v_lshlrev_b32_sdwa v136, v15, v114 dst_sel:DWORD dst_unused:UNUSED_PAD src0_sel:DWORD src1_sel:WORD_1
    s_waitcnt vmcnt(4)
    v_mfma_f32_4x4x4_16b_bf16 v[104:107], v[142:143], v[68:69], 0 cbsz:4 abid:6
    v_readlane_b32 s62, v164, 30
    v_mfma_f32_4x4x4_16b_bf16 v[108:111], v[142:143], v[70:71], 0 cbsz:4 abid:6
    v_lshlrev_b32_sdwa v137, v15, v115 dst_sel:DWORD dst_unused:UNUSED_PAD src0_sel:DWORD src1_sel:WORD_1
    ds_read_u16_d16_hi v132, v136 offset:32768
    ds_read_u16_d16_hi v133, v137 offset:32768
    s_and_b32 s33, s62, s34
    buffer_load_dwordx4 v[88:91], v1, s[12:15], s33 offen
    s_waitcnt lgkmcnt(2)
    s_set_gpr_idx_on s56, 0xc
    v_pk_fma_f32 v[16:17], v[128:129], v[96:97], v[16:17] op_sel:[0,0,0] op_sel_hi:[0,1,1]
    v_pk_fma_f32 v[18:19], v[128:129], v[98:99], v[18:19] op_sel:[0,0,0] op_sel_hi:[0,1,1]
    v_pk_fma_f32 v[20:21], v[130:131], v[100:101], v[20:21] op_sel:[0,0,0] op_sel_hi:[0,1,1]
    v_pk_fma_f32 v[22:23], v[130:131], v[102:103], v[22:23] op_sel:[0,0,0] op_sel_hi:[0,1,1]
    s_set_gpr_idx_off
    v_lshlrev_b32_sdwa v138, v15, v118 dst_sel:DWORD dst_unused:UNUSED_PAD src0_sel:DWORD src1_sel:WORD_1
    s_waitcnt vmcnt(4)
    v_mfma_f32_4x4x4_16b_bf16 v[96:99], v[144:145], v[72:73], 0 cbsz:4 abid:6
    v_readlane_b32 s63, v164, 31
    v_mfma_f32_4x4x4_16b_bf16 v[100:103], v[144:145], v[74:75], 0 cbsz:4 abid:6
    v_lshlrev_b32_sdwa v139, v15, v119 dst_sel:DWORD dst_unused:UNUSED_PAD src0_sel:DWORD src1_sel:WORD_1
    ds_read_u16_d16_hi v134, v138 offset:32768
    ds_read_u16_d16_hi v135, v139 offset:32768
    s_and_b32 s33, s63, s34
    buffer_load_dwordx4 v[92:95], v1, s[12:15], s33 offen
    s_set_gpr_idx_on s57, 0xc
    v_pk_fma_f32 v[16:17], v[128:129], v[104:105], v[16:17] op_sel:[1,0,0] op_sel_hi:[1,1,1]
    v_pk_fma_f32 v[18:19], v[128:129], v[106:107], v[18:19] op_sel:[1,0,0] op_sel_hi:[1,1,1]
    v_pk_fma_f32 v[20:21], v[130:131], v[108:109], v[20:21] op_sel:[1,0,0] op_sel_hi:[1,1,1]
    v_pk_fma_f32 v[22:23], v[130:131], v[110:111], v[22:23] op_sel:[1,0,0] op_sel_hi:[1,1,1]
    s_set_gpr_idx_off
    v_mfma_f32_4x4x4_16b_bf16 v[112:115], v[172:173], v[176:177], 0 cbsz:4 abid:8
    v_lshlrev_b32_sdwa v136, v15, v120 dst_sel:DWORD dst_unused:UNUSED_PAD src0_sel:DWORD src1_sel:WORD_1
    s_waitcnt vmcnt(4)
    v_mfma_f32_4x4x4_16b_bf16 v[104:107], v[146:147], v[76:77], 0 cbsz:4 abid:6
    v_readlane_b32 s48, v164, 32
    v_mfma_f32_4x4x4_16b_bf16 v[108:111], v[146:147], v[78:79], 0 cbsz:4 abid:6
    v_lshlrev_b32_sdwa v137, v15, v121 dst_sel:DWORD dst_unused:UNUSED_PAD src0_sel:DWORD src1_sel:WORD_1
    ds_read_u16_d16_hi v128, v136 offset:32768
    ds_read_u16_d16_hi v129, v137 offset:32768
    s_and_b32 s33, s48, s34
    buffer_load_dwordx4 v[64:67], v1, s[12:15], s33 offen
    s_waitcnt lgkmcnt(2)
    s_set_gpr_idx_on s58, 0xc
    v_pk_fma_f32 v[16:17], v[132:133], v[96:97], v[16:17] op_sel:[0,0,0] op_sel_hi:[0,1,1]
    v_pk_fma_f32 v[18:19], v[132:133], v[98:99], v[18:19] op_sel:[0,0,0] op_sel_hi:[0,1,1]
    v_pk_fma_f32 v[20:21], v[134:135], v[100:101], v[20:21] op_sel:[0,0,0] op_sel_hi:[0,1,1]
    v_pk_fma_f32 v[22:23], v[134:135], v[102:103], v[22:23] op_sel:[0,0,0] op_sel_hi:[0,1,1]
    s_set_gpr_idx_off
    v_lshlrev_b32_sdwa v138, v15, v124 dst_sel:DWORD dst_unused:UNUSED_PAD src0_sel:DWORD src1_sel:WORD_1
    s_waitcnt vmcnt(4)
    v_mfma_f32_4x4x4_16b_bf16 v[96:99], v[140:141], v[80:81], 0 cbsz:4 abid:7
    v_readlane_b32 s49, v164, 33
    v_mfma_f32_4x4x4_16b_bf16 v[100:103], v[140:141], v[82:83], 0 cbsz:4 abid:7
    v_lshlrev_b32_sdwa v139, v15, v125 dst_sel:DWORD dst_unused:UNUSED_PAD src0_sel:DWORD src1_sel:WORD_1
    ds_read_u16_d16_hi v130, v138 offset:32768
    ds_read_u16_d16_hi v131, v139 offset:32768
    s_and_b32 s33, s49, s34
    buffer_load_dwordx4 v[68:71], v1, s[12:15], s33 offen
    s_set_gpr_idx_on s59, 0xc
    v_pk_fma_f32 v[16:17], v[132:133], v[104:105], v[16:17] op_sel:[1,0,0] op_sel_hi:[1,1,1]
    v_pk_fma_f32 v[18:19], v[132:133], v[106:107], v[18:19] op_sel:[1,0,0] op_sel_hi:[1,1,1]
    v_pk_fma_f32 v[20:21], v[134:135], v[108:109], v[20:21] op_sel:[1,0,0] op_sel_hi:[1,1,1]
    v_pk_fma_f32 v[22:23], v[134:135], v[110:111], v[22:23] op_sel:[1,0,0] op_sel_hi:[1,1,1]
    s_set_gpr_idx_off
A_28:
    s_sub_u32 s31, s31, 4
    s_cbranch_scc1 B_28
    v_mfma_f32_4x4x4_16b_bf16 v[116:119], v[172:173], v[178:179], 0 cbsz:4 abid:8
    v_lshlrev_b32_sdwa v136, v15, v122 dst_sel:DWORD dst_unused:UNUSED_PAD src0_sel:DWORD src1_sel:WORD_1
    s_waitcnt vmcnt(4)
    v_mfma_f32_4x4x4_16b_bf16 v[104:107], v[142:143], v[84:85], 0 cbsz:4 abid:7
    v_readlane_b32 s50, v164, 34
    v_mfma_f32_4x4x4_16b_bf16 v[108:111], v[142:143], v[86:87], 0 cbsz:4 abid:7
    v_lshlrev_b32_sdwa v137, v15, v123 dst_sel:DWORD dst_unused:UNUSED_PAD src0_sel:DWORD src1_sel:WORD_1
    ds_read_u16_d16_hi v132, v136 offset:32768
    ds_read_u16_d16_hi v133, v137 offset:32768
    s_and_b32 s33, s50, s34
    buffer_load_dwordx4 v[72:75], v1, s[12:15], s33 offen
    s_waitcnt lgkmcnt(2)
    s_set_gpr_idx_on s60, 0xc
    v_pk_fma_f32 v[16:17], v[128:129], v[96:97], v[16:17] op_sel:[0,0,0] op_sel_hi:[0,1,1]
    v_pk_fma_f32 v[18:19], v[128:129], v[98:99], v[18:19] op_sel:[0,0,0] op_sel_hi:[0,1,1]
    v_pk_fma_f32 v[20:21], v[130:131], v[100:101], v[20:21] op_sel:[0,0,0] op_sel_hi:[0,1,1]
    v_pk_fma_f32 v[22:23], v[130:131], v[102:103], v[22:23] op_sel:[0,0,0] op_sel_hi:[0,1,1]
    s_set_gpr_idx_off
    v_lshlrev_b32_sdwa v138, v15, v126 dst_sel:DWORD dst_unused:UNUSED_PAD src0_sel:DWORD src1_sel:WORD_1
    s_waitcnt vmcnt(4)
    v_mfma_f32_4x4x4_16b_bf16 v[96:99], v[144:145], v[88:89], 0 cbsz:4 abid:7
    v_readlane_b32 s51, v164, 35
    v_mfma_f32_4x4x4_16b_bf16 v[100:103], v[144:145], v[90:91], 0 cbsz:4 abid:7
    v_lshlrev_b32_sdwa v139, v15, v127 dst_sel:DWORD dst_unused:UNUSED_PAD src0_sel:DWORD src1_sel:WORD_1
    ds_read_u16_d16_hi v134, v138 offset:32768
    ds_read_u16_d16_hi v135, v139 offset:32768
    s_and_b32 s33, s51, s34
    buffer_load_dwordx4 v[76:79], v1, s[12:15], s33 offen
    s_set_gpr_idx_on s61, 0xc
    v_pk_fma_f32 v[16:17], v[128:129], v[104:105], v[16:17] op_sel:[1,0,0] op_sel_hi:[1,1,1]
    v_pk_fma_f32 v[18:19], v[128:129], v[106:107], v[18:19] op_sel:[1,0,0] op_sel_hi:[1,1,1]
    v_pk_fma_f32 v[20:21], v[130:131], v[108:109], v[20:21] op_sel:[1,0,0] op_sel_hi:[1,1,1]
    v_pk_fma_f32 v[22:23], v[130:131], v[110:111], v[22:23] op_sel:[1,0,0] op_sel_hi:[1,1,1]
    s_set_gpr_idx_off
    v_mfma_f32_4x4x4_16b_bf16 v[120:123], v[172:173], v[176:177], 0 cbsz:4 abid:9
    v_lshlrev_b32_sdwa v136, v15, v112 dst_sel:DWORD dst_unused:UNUSED_PAD src0_sel:DWORD src1_sel:WORD_1
    s_waitcnt vmcnt(4)
    v_mfma_f32_4x4x4_16b_bf16 v[104:107], v[146:147], v[92:93], 0 cbsz:4 abid:7
    v_readlane_b32 s52, v164, 36
    v_mfma_f32_4x4x4_16b_bf16 v[108:111], v[146:147], v[94:95], 0 cbsz:4 abid:7
    v_lshlrev_b32_sdwa v137, v15, v113 dst_sel:DWORD dst_unused:UNUSED_PAD src0_sel:DWORD src1_sel:WORD_1
    ds_read_u16_d16_hi v128, v136 offset:32768
    ds_read_u16_d16_hi v129, v137 offset:32768
    s_and_b32 s33, s52, s34
    buffer_load_dwordx4 v[80:83], v1, s[12:15], s33 offen
    s_waitcnt lgkmcnt(2)
    s_set_gpr_idx_on s62, 0xc
    v_pk_fma_f32 v[16:17], v[132:133], v[96:97], v[16:17] op_sel:[0,0,0] op_sel_hi:[0,1,1]
    v_pk_fma_f32 v[18:19], v[132:133], v[98:99], v[18:19] op_sel:[0,0,0] op_sel_hi:[0,1,1]
    v_pk_fma_f32 v[20:21], v[134:135], v[100:101], v[20:21] op_sel:[0,0,0] op_sel_hi:[0,1,1]
    v_pk_fma_f32 v[22:23], v[134:135], v[102:103], v[22:23] op_sel:[0,0,0] op_sel_hi:[0,1,1]
    s_set_gpr_idx_off
    v_lshlrev_b32_sdwa v138, v15, v116 dst_sel:DWORD dst_unused:UNUSED_PAD src0_sel:DWORD src1_sel:WORD_1
    s_waitcnt vmcnt(4)
    v_mfma_f32_4x4x4_16b_bf16 v[96:99], v[140:141], v[64:65], 0 cbsz:4 abid:8
    v_readlane_b32 s53, v164, 37
    v_mfma_f32_4x4x4_16b_bf16 v[100:103], v[140:141], v[66:67], 0 cbsz:4 abid:8
    v_lshlrev_b32_sdwa v139, v15, v117 dst_sel:DWORD dst_unused:UNUSED_PAD src0_sel:DWORD src1_sel:WORD_1
    ds_read_u16_d16_hi v130, v138 offset:32768
    ds_read_u16_d16_hi v131, v139 offset:32768
    s_and_b32 s33, s53, s34
    buffer_load_dwordx4 v[84:87], v1, s[12:15], s33 offen
    s_set_gpr_idx_on s63, 0xc
    v_pk_fma_f32 v[16:17], v[132:133], v[104:105], v[16:17] op_sel:[1,0,0] op_sel_hi:[1,1,1]
    v_pk_fma_f32 v[18:19], v[132:133], v[106:107], v[18:19] op_sel:[1,0,0] op_sel_hi:[1,1,1]
    v_pk_fma_f32 v[20:21], v[134:135], v[108:109], v[20:21] op_sel:[1,0,0] op_sel_hi:[1,1,1]
    v_pk_fma_f32 v[22:23], v[134:135], v[110:111], v[22:23] op_sel:[1,0,0] op_sel_hi:[1,1,1]
    s_set_gpr_idx_off
A_32:
    s_sub_u32 s31, s31, 4
    s_cbranch_scc1 B_32
    v_mfma_f32_4x4x4_16b_bf16 v[124:127], v[172:173], v[178:179], 0 cbsz:4 abid:9
    v_lshlrev_b32_sdwa v136, v15, v114 dst_sel:DWORD dst_unused:UNUSED_PAD src0_sel:DWORD src1_sel:WORD_1
    s_waitcnt vmcnt(4)
    v_mfma_f32_4x4x4_16b_bf16 v[104:107], v[142:143], v[68:69], 0 cbsz:4 abid:8
    v_readlane_b32 s54, v164, 38
    v_mfma_f32_4x4x4_16b_bf16 v[108:111], v[142:143], v[70:71], 0 cbsz:4 abid:8
    v_lshlrev_b32_sdwa v137, v15, v115 dst_sel:DWORD dst_unused:UNUSED_PAD src0_sel:DWORD src1_sel:WORD_1
    ds_read_u16_d16_hi v132, v136 offset:32768
    ds_read_u16_d16_hi v133, v137 offset:32768
    s_and_b32 s33, s54, s34
    buffer_load_dwordx4 v[88:91], v1, s[12:15], s33 offen
    s_waitcnt lgkmcnt(2)
    s_set_gpr_idx_on s48, 0xc
    v_pk_fma_f32 v[16:17], v[128:129], v[96:97], v[16:17] op_sel:[0,0,0] op_sel_hi:[0,1,1]
    v_pk_fma_f32 v[18:19], v[128:129], v[98:99], v[18:19] op_sel:[0,0,0] op_sel_hi:[0,1,1]
    v_pk_fma_f32 v[20:21], v[130:131], v[100:101], v[20:21] op_sel:[0,0,0] op_sel_hi:[0,1,1]
    v_pk_fma_f32 v[22:23], v[130:131], v[102:103], v[22:23] op_sel:[0,0,0] op_sel_hi:[0,1,1]
    s_set_gpr_idx_off
    v_lshlrev_b32_sdwa v138, v15, v118 dst_sel:DWORD dst_unused:UNUSED_PAD src0_sel:DWORD src1_sel:WORD_1
    s_waitcnt vmcnt(4)
    v_mfma_f32_4x4x4_16b_bf16 v[96:99], v[144:145], v[72:73], 0 cbsz:4 abid:8
    v_readlane_b32 s55, v164, 39
    v_mfma_f32_4x4x4_16b_bf16 v[100:103], v[144:145], v[74:75], 0 cbsz:4 abid:8
    v_lshlrev_b32_sdwa v139, v15, v119 dst_sel:DWORD dst_unused:UNUSED_PAD src0_sel:DWORD src1_sel:WORD_1
    ds_read_u16_d16_hi v134, v138 offset:32768
    ds_read_u16_d16_hi v135, v139 offset:32768
    s_and_b32 s33, s55, s34
    buffer_load_dwordx4 v[92:95], v1, s[12:15], s33 offen
    s_set_gpr_idx_on s49, 0xc
    v_pk_fma_f32 v[16:17], v[128:129], v[104:105], v[16:17] op_sel:[1,0,0] op_sel_hi:[1,1,1]
    v_pk_fma_f32 v[18:19], v[128:129], v[106:107], v[18:19] op_sel:[1,0,0] op_sel_hi:[1,1,1]
    v_pk_fma_f32 v[20:21], v[130:131], v[108:109], v[20:21] op_sel:[1,0,0] op_sel_hi:[1,1,1]
    v_pk_fma_f32 v[22:23], v[130:131], v[110:111], v[22:23] op_sel:[1,0,0] op_sel_hi:[1,1,1]
    s_set_gpr_idx_off
    v_mfma_f32_4x4x4_16b_bf16 v[112:115], v[172:173], v[176:177], 0 cbsz:4 abid:10
    v_lshlrev_b32_sdwa v136, v15, v120 dst_sel:DWORD dst_unused:UNUSED_PAD src0_sel:DWORD src1_sel:WORD_1
    s_waitcnt vmcnt(4)
    v_mfma_f32_4x4x4_16b_bf16 v[104:107], v[146:147], v[76:77], 0 cbsz:4 abid:8
    v_readlane_b32 s56, v164, 40
    v_mfma_f32_4x4x4_16b_bf16 v[108:111], v[146:147], v[78:79], 0 cbsz:4 abid:8
    v_lshlrev_b32_sdwa v137, v15, v121 dst_sel:DWORD dst_unused:UNUSED_PAD src0_sel:DWORD src1_sel:WORD_1
    ds_read_u16_d16_hi v128, v136 offset:32768
    ds_read_u16_d16_hi v129, v137 offset:32768
    s_and_b32 s33, s56, s34
    buffer_load_dwordx4 v[64:67], v1, s[12:15], s33 offen
    s_waitcnt lgkmcnt(2)
    s_set_gpr_idx_on s50, 0xc
    v_pk_fma_f32 v[16:17], v[132:133], v[96:97], v[16:17] op_sel:[0,0,0] op_sel_hi:[0,1,1]
    v_pk_fma_f32 v[18:19], v[132:133], v[98:99], v[18:19] op_sel:[0,0,0] op_sel_hi:[0,1,1]
    v_pk_fma_f32 v[20:21], v[134:135], v[100:101], v[20:21] op_sel:[0,0,0] op_sel_hi:[0,1,1]
    v_pk_fma_f32 v[22:23], v[134:135], v[102:103], v[22:23] op_sel:[0,0,0] op_sel_hi:[0,1,1]
    s_set_gpr_idx_off
    v_lshlrev_b32_sdwa v138, v15, v124 dst_sel:DWORD dst_unused:UNUSED_PAD src0_sel:DWORD src1_sel:WORD_1
    s_waitcnt vmcnt(4)
    v_mfma_f32_4x4x4_16b_bf16 v[96:99], v[140:141], v[80:81], 0 cbsz:4 abid:9
    v_readlane_b32 s57, v164, 41
    v_mfma_f32_4x4x4_16b_bf16 v[100:103], v[140:141], v[82:83], 0 cbsz:4 abid:9
    v_lshlrev_b32_sdwa v139, v15, v125 dst_sel:DWORD dst_unused:UNUSED_PAD src0_sel:DWORD src1_sel:WORD_1
    ds_read_u16_d16_hi v130, v138 offset:32768
    ds_read_u16_d16_hi v131, v139 offset:32768
    s_and_b32 s33, s57, s34
    buffer_load_dwordx4 v[68:71], v1, s[12:15], s33 offen
    s_set_gpr_idx_on s51, 0xc
    v_pk_fma_f32 v[16:17], v[132:133], v[104:105], v[16:17] op_sel:[1,0,0] op_sel_hi:[1,1,1]
    v_pk_fma_f32 v[18:19], v[132:133], v[106:107], v[18:19] op_sel:[1,0,0] op_sel_hi:[1,1,1]
    v_pk_fma_f32 v[20:21], v[134:135], v[108:109], v[20:21] op_sel:[1,0,0] op_sel_hi:[1,1,1]
    v_pk_fma_f32 v[22:23], v[134:135], v[110:111], v[22:23] op_sel:[1,0,0] op_sel_hi:[1,1,1]
    s_set_gpr_idx_off
A_36:
    s_sub_u32 s31, s31, 4
    s_cbranch_scc1 B_36
    v_mfma_f32_4x4x4_16b_bf16 v[116:119], v[172:173], v[178:179], 0 cbsz:4 abid:10
    v_lshlrev_b32_sdwa v136, v15, v122 dst_sel:DWORD dst_unused:UNUSED_PAD src0_sel:DWORD src1_sel:WORD_1
    s_waitcnt vmcnt(4)
    v_mfma_f32_4x4x4_16b_bf16 v[104:107], v[142:143], v[84:85], 0 cbsz:4 abid:9
    v_readlane_b32 s58, v164, 42
    v_mfma_f32_4x4x4_16b_bf16 v[108:111], v[142:143], v[86:87], 0 cbsz:4 abid:9
    v_lshlrev_b32_sdwa v137, v15, v123 dst_sel:DWORD dst_unused:UNUSED_PAD src0_sel:DWORD src1_sel:WORD_1
    ds_read_u16_d16_hi v132, v136 offset:32768
    ds_read_u16_d16_hi v133, v137 offset:32768
    s_and_b32 s33, s58, s34
    buffer_load_dwordx4 v[72:75], v1, s[12:15], s33 offen
    s_waitcnt lgkmcnt(2)
    s_set_gpr_idx_on s52, 0xc
    v_pk_fma_f32 v[16:17], v[128:129], v[96:97], v[16:17] op_sel:[0,0,0] op_sel_hi:[0,1,1]
    v_pk_fma_f32 v[18:19], v[128:129], v[98:99], v[18:19] op_sel:[0,0,0] op_sel_hi:[0,1,1]
    v_pk_fma_f32 v[20:21], v[130:131], v[100:101], v[20:21] op_sel:[0,0,0] op_sel_hi:[0,1,1]
    v_pk_fma_f32 v[22:23], v[130:131], v[102:103], v[22:23] op_sel:[0,0,0] op_sel_hi:[0,1,1]
    s_set_gpr_idx_off
    v_lshlrev_b32_sdwa v138, v15, v126 dst_sel:DWORD dst_unused:UNUSED_PAD src0_sel:DWORD src1_sel:WORD_1
    s_waitcnt vmcnt(4)
    v_mfma_f32_4x4x4_16b_bf16 v[96:99], v[144:145], v[88:89], 0 cbsz:4 abid:9
    v_readlane_b32 s59, v164, 43
    v_mfma_f32_4x4x4_16b_bf16 v[100:103], v[144:145], v[90:91], 0 cbsz:4 abid:9
    v_lshlrev_b32_sdwa v139, v15, v127 dst_sel:DWORD dst_unused:UNUSED_PAD src0_sel:DWORD src1_sel:WORD_1
    ds_read_u16_d16_hi v134, v138 offset:32768
    ds_read_u16_d16_hi v135, v139 offset:32768
    s_and_b32 s33, s59, s34
    buffer_load_dwordx4 v[76:79], v1, s[12:15], s33 offen
    s_set_gpr_idx_on s53, 0xc
    v_pk_fma_f32 v[16:17], v[128:129], v[104:105], v[16:17] op_sel:[1,0,0] op_sel_hi:[1,1,1]
    v_pk_fma_f32 v[18:19], v[128:129], v[106:107], v[18:19] op_sel:[1,0,0] op_sel_hi:[1,1,1]
    v_pk_fma_f32 v[20:21], v[130:131], v[108:109], v[20:21] op_sel:[1,0,0] op_sel_hi:[1,1,1]
    v_pk_fma_f32 v[22:23], v[130:131], v[110:111], v[22:23] op_sel:[1,0,0] op_sel_hi:[1,1,1]
    s_set_gpr_idx_off
    v_mfma_f32_4x4x4_16b_bf16 v[120:123], v[172:173], v[176:177], 0 cbsz:4 abid:11
    v_lshlrev_b32_sdwa v136, v15, v112 dst_sel:DWORD dst_unused:UNUSED_PAD src0_sel:DWORD src1_sel:WORD_1
    s_waitcnt vmcnt(4)
    v_mfma_f32_4x4x4_16b_bf16 v[104:107], v[146:147], v[92:93], 0 cbsz:4 abid:9
    v_readlane_b32 s60, v164, 44
    v_mfma_f32_4x4x4_16b_bf16 v[108:111], v[146:147], v[94:95], 0 cbsz:4 abid:9
    v_lshlrev_b32_sdwa v137, v15, v113 dst_sel:DWORD dst_unused:UNUSED_PAD src0_sel:DWORD src1_sel:WORD_1
    ds_read_u16_d16_hi v128, v136 offset:32768
    ds_read_u16_d16_hi v129, v137 offset:32768
    s_and_b32 s33, s60, s34
    buffer_load_dwordx4 v[80:83], v1, s[12:15], s33 offen
    s_waitcnt lgkmcnt(2)
    s_set_gpr_idx_on s54, 0xc
    v_pk_fma_f32 v[16:17], v[132:133], v[96:97], v[16:17] op_sel:[0,0,0] op_sel_hi:[0,1,1]
    v_pk_fma_f32 v[18:19], v[132:133], v[98:99], v[18:19] op_sel:[0,0,0] op_sel_hi:[0,1,1]
    v_pk_fma_f32 v[20:21], v[134:135], v[100:101], v[20:21] op_sel:[0,0,0] op_sel_hi:[0,1,1]
    v_pk_fma_f32 v[22:23], v[134:135], v[102:103], v[22:23] op_sel:[0,0,0] op_sel_hi:[0,1,1]
    s_set_gpr_idx_off
    v_lshlrev_b32_sdwa v138, v15, v116 dst_sel:DWORD dst_unused:UNUSED_PAD src0_sel:DWORD src1_sel:WORD_1
    s_waitcnt vmcnt(4)
    v_mfma_f32_4x4x4_16b_bf16 v[96:99], v[140:141], v[64:65], 0 cbsz:4 abid:10
    v_readlane_b32 s61, v164, 45
    v_mfma_f32_4x4x4_16b_bf16 v[100:103], v[140:141], v[66:67], 0 cbsz:4 abid:10
    v_lshlrev_b32_sdwa v139, v15, v117 dst_sel:DWORD dst_unused:UNUSED_PAD src0_sel:DWORD src1_sel:WORD_1
    ds_read_u16_d16_hi v130, v138 offset:32768
    ds_read_u16_d16_hi v131, v139 offset:32768
    s_and_b32 s33, s61, s34
    buffer_load_dwordx4 v[84:87], v1, s[12:15], s33 offen
    s_set_gpr_idx_on s55, 0xc
    v_pk_fma_f32 v[16:17], v[132:133], v[104:105], v[16:17] op_sel:[1,0,0] op_sel_hi:[1,1,1]
    v_pk_fma_f32 v[18:19], v[132:133], v[106:107], v[18:19] op_sel:[1,0,0] op_sel_hi:[1,1,1]
    v_pk_fma_f32 v[20:21], v[134:135], v[108:109], v[20:21] op_sel:[1,0,0] op_sel_hi:[1,1,1]
    v_pk_fma_f32 v[22:23], v[134:135], v[110:111], v[22:23] op_sel:[1,0,0] op_sel_hi:[1,1,1]
    s_set_gpr_idx_off
A_40:
    s_sub_u32 s31, s31, 4
    s_cbranch_scc1 B_40
    v_mfma_f32_4x4x4_16b_bf16 v[124:127], v[172:173], v[178:179], 0 cbsz:4 abid:11
    v_lshlrev_b32_sdwa v136, v15, v114 dst_sel:DWORD dst_unused:UNUSED_PAD src0_sel:DWORD src1_sel:WORD_1
    s_waitcnt vmcnt(4)
    v_mfma_f32_4x4x4_16b_bf16 v[104:107], v[142:143], v[68:69], 0 cbsz:4 abid:10
    v_readlane_b32 s62, v164, 46
    v_mfma_f32_4x4x4_16b_bf16 v[108:111], v[142:143], v[70:71], 0 cbsz:4 abid:10
    v_lshlrev_b32_sdwa v137, v15, v115 dst_sel:DWORD dst_unused:UNUSED_PAD src0_sel:DWORD src1_sel:WORD_1
    ds_read_u16_d16_hi v132, v136 offset:32768
    ds_read_u16_d16_hi v133, v137 offset:32768
    s_and_b32 s33, s62, s34
    buffer_load_dwordx4 v[88:91], v1, s[12:15], s33 offen
    s_waitcnt lgkmcnt(2)
    s_set_gpr_idx_on s56, 0xc
    v_pk_fma_f32 v[16:17], v[128:129], v[96:97], v[16:17] op_sel:[0,0,0] op_sel_hi:[0,1,1]
    v_pk_fma_f32 v[18:19], v[128:129], v[98:99], v[18:19] op_sel:[0,0,0] op_sel_hi:[0,1,1]
    v_pk_fma_f32 v[20:21], v[130:131], v[100:101], v[20:21] op_sel:[0,0,0] op_sel_hi:[0,1,1]
    v_pk_fma_f32 v[22:23], v[130:131], v[102:103], v[22:23] op_sel:[0,0,0] op_sel_hi:[0,1,1]
    s_set_gpr_idx_off
    v_mfma_f32_4x4x4_16b_bf16 v[148:151], v[168:169], v[180:181], 0
    v_lshlrev_b32_sdwa v138, v15, v118 dst_sel:DWORD dst_unused:UNUSED_PAD src0_sel:DWORD src1_sel:WORD_1
    s_waitcnt vmcnt(4)
    v_mfma_f32_4x4x4_16b_bf16 v[96:99], v[144:145], v[72:73], 0 cbsz:4 abid:10
    v_readlane_b32 s63, v164, 47
    v_mfma_f32_4x4x4_16b_bf16 v[100:103], v[144:145], v[74:75], 0 cbsz:4 abid:10
    v_lshlrev_b32_sdwa v139, v15, v119 dst_sel:DWORD dst_unused:UNUSED_PAD src0_sel:DWORD src1_sel:WORD_1
    ds_read_u16_d16_hi v134, v138 offset:32768
    ds_read_u16_d16_hi v135, v139 offset:32768
    s_and_b32 s33, s63, s34
    buffer_load_dwordx4 v[92:95], v1, s[12:15], s33 offen
    s_set_gpr_idx_on s57, 0xc
    v_pk_fma_f32 v[16:17], v[128:129], v[104:105], v[16:17] op_sel:[1,0,0] op_sel_hi:[1,1,1]
    v_pk_fma_f32 v[18:19], v[128:129], v[106:107], v[18:19] op_sel:[1,0,0] op_sel_hi:[1,1,1]
    v_pk_fma_f32 v[20:21], v[130:131], v[108:109], v[20:21] op_sel:[1,0,0] op_sel_hi:[1,1,1]
    v_pk_fma_f32 v[22:23], v[130:131], v[110:111], v[22:23] op_sel:[1,0,0] op_sel_hi:[1,1,1]
    s_set_gpr_idx_off
    v_mfma_f32_4x4x4_16b_bf16 v[112:115], v[172:173], v[176:177], 0 cbsz:4 abid:12
    v_lshlrev_b32_sdwa v136, v15, v120 dst_sel:DWORD dst_unused:UNUSED_PAD src0_sel:DWORD src1_sel:WORD_1
    s_waitcnt vmcnt(4)
    v_mfma_f32_4x4x4_16b_bf16 v[104:107], v[146:147], v[76:77], 0 cbsz:4 abid:10
    v_readlane_b32 s48, v164, 48
    v_mfma_f32_4x4x4_16b_bf16 v[108:111], v[146:147], v[78:79], 0 cbsz:4 abid:10
    v_lshlrev_b32_sdwa v137, v15, v121 dst_sel:DWORD dst_unused:UNUSED_PAD src0_sel:DWORD src1_sel:WORD_1
    ds_read_u16_d16_hi v128, v136 offset:32768
    ds_read_u16_d16_hi v129, v137 offset:32768
    s_and_b32 s33, s48, s34
    buffer_load_dwordx4 v[64:67], v1, s[12:15], s33 offen
    s_waitcnt lgkmcnt(2)
    s_set_gpr_idx_on s58, 0xc
    v_pk_fma_f32 v[16:17], v[132:133], v[96:97], v[16:17] op_sel:[0,0,0] op_sel_hi:[0,1,1]
    v_pk_fma_f32 v[18:19], v[132:133], v[98:99], v[18:19] op_sel:[0,0,0] op_sel_hi:[0,1,1]
    v_pk_fma_f32 v[20:21], v[134:135], v[100:101], v[20:21] op_sel:[0,0,0] op_sel_hi:[0,1,1]
    v_pk_fma_f32 v[22:23], v[134:135], v[102:103], v[22:23] op_sel:[0,0,0] op_sel_hi:[0,1,1]
    s_set_gpr_idx_off
    v_mfma_f32_4x4x4_16b_bf16 v[152:155], v[168:169], v[182:183], 0
    v_lshlrev_b32_sdwa v138, v15, v124 dst_sel:DWORD dst_unused:UNUSED_PAD src0_sel:DWORD src1_sel:WORD_1
    s_waitcnt vmcnt(4)
    v_mfma_f32_4x4x4_16b_bf16 v[96:99], v[140:141], v[80:81], 0 cbsz:4 abid:11
    v_readlane_b32 s49, v164, 49
    v_mfma_f32_4x4x4_16b_bf16 v[100:103], v[140:141], v[82:83], 0 cbsz:4 abid:11
    v_lshlrev_b32_sdwa v139, v15, v125 dst_sel:DWORD dst_unused:UNUSED_PAD src0_sel:DWORD src1_sel:WORD_1
    ds_read_u16_d16_hi v130, v138 offset:32768
    ds_read_u16_d16_hi v131, v139 offset:32768
    s_and_b32 s33, s49, s34
    buffer_load_dwordx4 v[68:71], v1, s[12:15], s33 offen
    s_set_gpr_idx_on s59, 0xc
    v_pk_fma_f32 v[16:17], v[132:133], v[104:105], v[16:17] op_sel:[1,0,0] op_sel_hi:[1,1,1]
    v_pk_fma_f32 v[18:19], v[132:133], v[106:107], v[18:19] op_sel:[1,0,0] op_sel_hi:[1,1,1]
    v_pk_fma_f32 v[20:21], v[134:135], v[108:109], v[20:21] op_sel:[1,0,0] op_sel_hi:[1,1,1]
    v_pk_fma_f32 v[22:23], v[134:135], v[110:111], v[22:23] op_sel:[1,0,0] op_sel_hi:[1,1,1]
    s_set_gpr_idx_off
A_44:
    s_sub_u32 s31, s31, 4
    s_cbranch_scc1 B_44
    v_mfma_f32_4x4x4_16b_bf16 v[116:119], v[172:173], v[178:179], 0 cbsz:4 abid:12
    v_lshlrev_b32_sdwa v136, v15, v122 dst_sel:DWORD dst_unused:UNUSED_PAD src0_sel:DWORD src1_sel:WORD_1
    s_waitcnt vmcnt(4)
    v_mfma_f32_4x4x4_16b_bf16 v[104:107], v[142:143], v[84:85], 0 cbsz:4 abid:11
    v_readlane_b32 s50, v164, 50
    v_mfma_f32_4x4x4_16b_bf16 v[108:111], v[142:143], v[86:87], 0 cbsz:4 abid:11
    v_lshlrev_b32_sdwa v137, v15, v123 dst_sel:DWORD dst_unused:UNUSED_PAD src0_sel:DWORD src1_sel:WORD_1
    ds_read_u16_d16_hi v132, v136 offset:32768
    ds_read_u16_d16_hi v133, v137 offset:32768
    s_and_b32 s33, s50, s34
    buffer_load_dwordx4 v[72:75], v1, s[12:15], s33 offen
    s_waitcnt lgkmcnt(2)
    s_set_gpr_idx_on s60, 0xc
    v_pk_fma_f32 v[16:17], v[128:129], v[96:97], v[16:17] op_sel:[0,0,0] op_sel_hi:[0,1,1]
    v_pk_fma_f32 v[18:19], v[128:129], v[98:99], v[18:19] op_sel:[0,0,0] op_sel_hi:[0,1,1]
    v_pk_fma_f32 v[20:21], v[130:131], v[100:101], v[20:21] op_sel:[0,0,0] op_sel_hi:[0,1,1]
    v_pk_fma_f32 v[22:23], v[130:131], v[102:103], v[22:23] op_sel:[0,0,0] op_sel_hi:[0,1,1]
    s_set_gpr_idx_off
    v_mfma_f32_4x4x4_16b_bf16 v[156:159], v[168:169], v[184:185], 0
    v_lshlrev_b32_sdwa v138, v15, v126 dst_sel:DWORD dst_unused:UNUSED_PAD src0_sel:DWORD src1_sel:WORD_1
    s_waitcnt vmcnt(4)
    v_mfma_f32_4x4x4_16b_bf16 v[96:99], v[144:145], v[88:89], 0 cbsz:4 abid:11
    v_readlane_b32 s51, v164, 51
    v_mfma_f32_4x4x4_16b_bf16 v[100:103], v[144:145], v[90:91], 0 cbsz:4 abid:11
    v_lshlrev_b32_sdwa v139, v15, v127 dst_sel:DWORD dst_unused:UNUSED_PAD src0_sel:DWORD src1_sel:WORD_1
    ds_read_u16_d16_hi v134, v138 offset:32768
    ds_read_u16_d16_hi v135, v139 offset:32768
    s_and_b32 s33, s51, s34
    buffer_load_dwordx4 v[76:79], v1, s[12:15], s33 offen
    s_set_gpr_idx_on s61, 0xc
    v_pk_fma_f32 v[16:17], v[128:129], v[104:105], v[16:17] op_sel:[1,0,0] op_sel_hi:[1,1,1]
    v_pk_fma_f32 v[18:19], v[128:129], v[106:107], v[18:19] op_sel:[1,0,0] op_sel_hi:[1,1,1]
    v_pk_fma_f32 v[20:21], v[130:131], v[108:109], v[20:21] op_sel:[1,0,0] op_sel_hi:[1,1,1]
    v_pk_fma_f32 v[22:23], v[130:131], v[110:111], v[22:23] op_sel:[1,0,0] op_sel_hi:[1,1,1]
    s_set_gpr_idx_off
    v_mfma_f32_4x4x4_16b_bf16 v[120:123], v[172:173], v[176:177], 0 cbsz:4 abid:13
    v_lshlrev_b32_sdwa v136, v15, v112 dst_sel:DWORD dst_unused:UNUSED_PAD src0_sel:DWORD src1_sel:WORD_1
    s_waitcnt vmcnt(4)
    v_mfma_f32_4x4x4_16b_bf16 v[104:107], v[146:147], v[92:93], 0 cbsz:4 abid:11
    v_readlane_b32 s52, v164, 52
    v_mfma_f32_4x4x4_16b_bf16 v[108:111], v[146:147], v[94:95], 0 cbsz:4 abid:11
    v_lshlrev_b32_sdwa v137, v15, v113 dst_sel:DWORD dst_unused:UNUSED_PAD src0_sel:DWORD src1_sel:WORD_1
    ds_read_u16_d16_hi v128, v136 offset:32768
    ds_read_u16_d16_hi v129, v137 offset:32768
    s_and_b32 s33, s52, s34
    buffer_load_dwordx4 v[80:83], v1, s[12:15], s33 offen
    s_waitcnt lgkmcnt(2)
    s_set_gpr_idx_on s62, 0xc
    v_pk_fma_f32 v[16:17], v[132:133], v[96:97], v[16:17] op_sel:[0,0,0] op_sel_hi:[0,1,1]
    v_pk_fma_f32 v[18:19], v[132:133], v[98:99], v[18:19] op_sel:[0,0,0] op_sel_hi:[0,1,1]
    v_pk_fma_f32 v[20:21], v[134:135], v[100:101], v[20:21] op_sel:[0,0,0] op_sel_hi:[0,1,1]
    v_pk_fma_f32 v[22:23], v[134:135], v[102:103], v[22:23] op_sel:[0,0,0] op_sel_hi:[0,1,1]
    s_set_gpr_idx_off
    v_mfma_f32_4x4x4_16b_bf16 v[160:163], v[168:169], v[186:187], 0
    v_lshlrev_b32_sdwa v138, v15, v116 dst_sel:DWORD dst_unused:UNUSED_PAD src0_sel:DWORD src1_sel:WORD_1
    s_waitcnt vmcnt(4)
    v_mfma_f32_4x4x4_16b_bf16 v[96:99], v[140:141], v[64:65], 0 cbsz:4 abid:12
    v_readlane_b32 s53, v164, 53
    v_mfma_f32_4x4x4_16b_bf16 v[100:103], v[140:141], v[66:67], 0 cbsz:4 abid:12
    v_lshlrev_b32_sdwa v139, v15, v117 dst_sel:DWORD dst_unused:UNUSED_PAD src0_sel:DWORD src1_sel:WORD_1
    ds_read_u16_d16_hi v130, v138 offset:32768
    ds_read_u16_d16_hi v131, v139 offset:32768
    s_and_b32 s33, s53, s34
    buffer_load_dwordx4 v[84:87], v1, s[12:15], s33 offen
    s_set_gpr_idx_on s63, 0xc
    v_pk_fma_f32 v[16:17], v[132:133], v[104:105], v[16:17] op_sel:[1,0,0] op_sel_hi:[1,1,1]
    v_pk_fma_f32 v[18:19], v[132:133], v[106:107], v[18:19] op_sel:[1,0,0] op_sel_hi:[1,1,1]
    v_pk_fma_f32 v[20:21], v[134:135], v[108:109], v[20:21] op_sel:[1,0,0] op_sel_hi:[1,1,1]
    v_pk_fma_f32 v[22:23], v[134:135], v[110:111], v[22:23] op_sel:[1,0,0] op_sel_hi:[1,1,1]
    s_set_gpr_idx_off
A_48:
    s_sub_u32 s31, s31, 4
    s_cbranch_scc1 B_48
    v_mfma_f32_4x4x4_16b_bf16 v[124:127], v[172:173], v[178:179], 0 cbsz:4 abid:13
    v_lshlrev_b32_sdwa v136, v15, v114 dst_sel:DWORD dst_unused:UNUSED_PAD src0_sel:DWORD src1_sel:WORD_1
    s_waitcnt vmcnt(4)
    v_mfma_f32_4x4x4_16b_bf16 v[104:107], v[142:143], v[68:69], 0 cbsz:4 abid:12
    v_readlane_b32 s54, v164, 54
    v_mfma_f32_4x4x4_16b_bf16 v[108:111], v[142:143], v[70:71], 0 cbsz:4 abid:12
    v_lshlrev_b32_sdwa v137, v15, v115 dst_sel:DWORD dst_unused:UNUSED_PAD src0_sel:DWORD src1_sel:WORD_1
    ds_read_u16_d16_hi v132, v136 offset:32768
    ds_read_u16_d16_hi v133, v137 offset:32768
    s_and_b32 s33, s54, s34
    buffer_load_dwordx4 v[88:91], v1, s[12:15], s33 offen
    s_waitcnt lgkmcnt(2)
    s_set_gpr_idx_on s48, 0xc
    v_pk_fma_f32 v[16:17], v[128:129], v[96:97], v[16:17] op_sel:[0,0,0] op_sel_hi:[0,1,1]
    v_pk_fma_f32 v[18:19], v[128:129], v[98:99], v[18:19] op_sel:[0,0,0] op_sel_hi:[0,1,1]
    v_pk_fma_f32 v[20:21], v[130:131], v[100:101], v[20:21] op_sel:[0,0,0] op_sel_hi:[0,1,1]
    v_pk_fma_f32 v[22:23], v[130:131], v[102:103], v[22:23] op_sel:[0,0,0] op_sel_hi:[0,1,1]
    s_set_gpr_idx_off
    v_lshlrev_b32_sdwa v138, v15, v118 dst_sel:DWORD dst_unused:UNUSED_PAD src0_sel:DWORD src1_sel:WORD_1
    s_waitcnt vmcnt(4)
    v_mfma_f32_4x4x4_16b_bf16 v[96:99], v[144:145], v[72:73], 0 cbsz:4 abid:12
    v_readlane_b32 s55, v164, 55
    v_mfma_f32_4x4x4_16b_bf16 v[100:103], v[144:145], v[74:75], 0 cbsz:4 abid:12
    v_lshlrev_b32_sdwa v139, v15, v119 dst_sel:DWORD dst_unused:UNUSED_PAD src0_sel:DWORD src1_sel:WORD_1
    ds_read_u16_d16_hi v134, v138 offset:32768
    ds_read_u16_d16_hi v135, v139 offset:32768
    s_and_b32 s33, s55, s34
    buffer_load_dwordx4 v[92:95], v1, s[12:15], s33 offen
    s_set_gpr_idx_on s49, 0xc
    v_pk_fma_f32 v[16:17], v[128:129], v[104:105], v[16:17] op_sel:[1,0,0] op_sel_hi:[1,1,1]
    v_pk_fma_f32 v[18:19], v[128:129], v[106:107], v[18:19] op_sel:[1,0,0] op_sel_hi:[1,1,1]
    v_pk_fma_f32 v[20:21], v[130:131], v[108:109], v[20:21] op_sel:[1,0,0] op_sel_hi:[1,1,1]
    v_pk_fma_f32 v[22:23], v[130:131], v[110:111], v[22:23] op_sel:[1,0,0] op_sel_hi:[1,1,1]
    s_set_gpr_idx_off
    v_mfma_f32_4x4x4_16b_bf16 v[112:115], v[172:173], v[176:177], 0 cbsz:4 abid:14
    v_lshlrev_b32_sdwa v136, v15, v120 dst_sel:DWORD dst_unused:UNUSED_PAD src0_sel:DWORD src1_sel:WORD_1
    s_waitcnt vmcnt(4)
    v_mfma_f32_4x4x4_16b_bf16 v[104:107], v[146:147], v[76:77], 0 cbsz:4 abid:12
    v_readlane_b32 s56, v164, 56
    v_mfma_f32_4x4x4_16b_bf16 v[108:111], v[146:147], v[78:79], 0 cbsz:4 abid:12
    v_lshlrev_b32_sdwa v137, v15, v121 dst_sel:DWORD dst_unused:UNUSED_PAD src0_sel:DWORD src1_sel:WORD_1
    ds_read_u16_d16_hi v128, v136 offset:32768
    ds_read_u16_d16_hi v129, v137 offset:32768
    s_and_b32 s33, s56, s34
    buffer_load_dwordx4 v[64:67], v1, s[12:15], s33 offen
    s_waitcnt lgkmcnt(2)
    s_set_gpr_idx_on s50, 0xc
    v_pk_fma_f32 v[16:17], v[132:133], v[96:97], v[16:17] op_sel:[0,0,0] op_sel_hi:[0,1,1]
    v_pk_fma_f32 v[18:19], v[132:133], v[98:99], v[18:19] op_sel:[0,0,0] op_sel_hi:[0,1,1]
    v_pk_fma_f32 v[20:21], v[134:135], v[100:101], v[20:21] op_sel:[0,0,0] op_sel_hi:[0,1,1]
    v_pk_fma_f32 v[22:23], v[134:135], v[102:103], v[22:23] op_sel:[0,0,0] op_sel_hi:[0,1,1]
    s_set_gpr_idx_off
    v_lshlrev_b32_sdwa v138, v15, v124 dst_sel:DWORD dst_unused:UNUSED_PAD src0_sel:DWORD src1_sel:WORD_1
    s_waitcnt vmcnt(4)
    v_mfma_f32_4x4x4_16b_bf16 v[96:99], v[140:141], v[80:81], 0 cbsz:4 abid:13
    v_readlane_b32 s57, v164, 57
    v_mfma_f32_4x4x4_16b_bf16 v[100:103], v[140:141], v[82:83], 0 cbsz:4 abid:13
    v_lshlrev_b32_sdwa v139, v15, v125 dst_sel:DWORD dst_unused:UNUSED_PAD src0_sel:DWORD src1_sel:WORD_1
    ds_read_u16_d16_hi v130, v138 offset:32768
    ds_read_u16_d16_hi v131, v139 offset:32768
    s_and_b32 s33, s57, s34
    buffer_load_dwordx4 v[68:71], v1, s[12:15], s33 offen
    s_set_gpr_idx_on s51, 0xc
    v_pk_fma_f32 v[16:17], v[132:133], v[104:105], v[16:17] op_sel:[1,0,0] op_sel_hi:[1,1,1]
    v_pk_fma_f32 v[18:19], v[132:133], v[106:107], v[18:19] op_sel:[1,0,0] op_sel_hi:[1,1,1]
    v_pk_fma_f32 v[20:21], v[134:135], v[108:109], v[20:21] op_sel:[1,0,0] op_sel_hi:[1,1,1]
    v_pk_fma_f32 v[22:23], v[134:135], v[110:111], v[22:23] op_sel:[1,0,0] op_sel_hi:[1,1,1]
    s_set_gpr_idx_off
A_52:
    s_sub_u32 s31, s31, 4
    s_cbranch_scc1 B_52
    v_mfma_f32_4x4x4_16b_bf16 v[116:119], v[172:173], v[178:179], 0 cbsz:4 abid:14
    v_lshlrev_b32_sdwa v136, v15, v122 dst_sel:DWORD dst_unused:UNUSED_PAD src0_sel:DWORD src1_sel:WORD_1
    s_waitcnt vmcnt(4)
    v_mfma_f32_4x4x4_16b_bf16 v[104:107], v[142:143], v[84:85], 0 cbsz:4 abid:13
    v_readlane_b32 s58, v164, 58
    v_mfma_f32_4x4x4_16b_bf16 v[108:111], v[142:143], v[86:87], 0 cbsz:4 abid:13
    v_lshlrev_b32_sdwa v137, v15, v123 dst_sel:DWORD dst_unused:UNUSED_PAD src0_sel:DWORD src1_sel:WORD_1
    ds_read_u16_d16_hi v132, v136 offset:32768
    ds_read_u16_d16_hi v133, v137 offset:32768
    s_and_b32 s33, s58, s34
    buffer_load_dwordx4 v[72:75], v1, s[12:15], s33 offen
    s_waitcnt lgkmcnt(2)
    s_set_gpr_idx_on s52, 0xc
    v_pk_fma_f32 v[16:17], v[128:129], v[96:97], v[16:17] op_sel:[0,0,0] op_sel_hi:[0,1,1]
    v_pk_fma_f32 v[18:19], v[128:129], v[98:99], v[18:19] op_sel:[0,0,0] op_sel_hi:[0,1,1]
    v_pk_fma_f32 v[20:21], v[130:131], v[100:101], v[20:21] op_sel:[0,0,0] op_sel_hi:[0,1,1]
    v_pk_fma_f32 v[22:23], v[130:131], v[102:103], v[22:23] op_sel:[0,0,0] op_sel_hi:[0,1,1]
    s_set_gpr_idx_off
    v_lshlrev_b32_sdwa v138, v15, v126 dst_sel:DWORD dst_unused:UNUSED_PAD src0_sel:DWORD src1_sel:WORD_1
    s_waitcnt vmcnt(4)
    v_mfma_f32_4x4x4_16b_bf16 v[96:99], v[144:145], v[88:89], 0 cbsz:4 abid:13
    v_readlane_b32 s59, v164, 59
    v_mfma_f32_4x4x4_16b_bf16 v[100:103], v[144:145], v[90:91], 0 cbsz:4 abid:13
    v_lshlrev_b32_sdwa v139, v15, v127 dst_sel:DWORD dst_unused:UNUSED_PAD src0_sel:DWORD src1_sel:WORD_1
    ds_read_u16_d16_hi v134, v138 offset:32768
    ds_read_u16_d16_hi v135, v139 offset:32768
    s_and_b32 s33, s59, s34
    buffer_load_dwordx4 v[76:79], v1, s[12:15], s33 offen
    s_set_gpr_idx_on s53, 0xc
    v_pk_fma_f32 v[16:17], v[128:129], v[104:105], v[16:17] op_sel:[1,0,0] op_sel_hi:[1,1,1]
    v_pk_fma_f32 v[18:19], v[128:129], v[106:107], v[18:19] op_sel:[1,0,0] op_sel_hi:[1,1,1]
    v_pk_fma_f32 v[20:21], v[130:131], v[108:109], v[20:21] op_sel:[1,0,0] op_sel_hi:[1,1,1]
    v_pk_fma_f32 v[22:23], v[130:131], v[110:111], v[22:23] op_sel:[1,0,0] op_sel_hi:[1,1,1]
    s_set_gpr_idx_off
    v_mfma_f32_4x4x4_16b_bf16 v[120:123], v[172:173], v[176:177], 0 cbsz:4 abid:15
    v_lshlrev_b32_sdwa v136, v15, v112 dst_sel:DWORD dst_unused:UNUSED_PAD src0_sel:DWORD src1_sel:WORD_1
    s_waitcnt vmcnt(4)
    v_mfma_f32_4x4x4_16b_bf16 v[104:107], v[146:147], v[92:93], 0 cbsz:4 abid:13
    v_readlane_b32 s60, v164, 60
    v_mfma_f32_4x4x4_16b_bf16 v[108:111], v[146:147], v[94:95], 0 cbsz:4 abid:13
    v_lshlrev_b32_sdwa v137, v15, v113 dst_sel:DWORD dst_unused:UNUSED_PAD src0_sel:DWORD src1_sel:WORD_1
    ds_read_u16_d16_hi v128, v136 offset:32768
    ds_read_u16_d16_hi v129, v137 offset:32768
    s_and_b32 s33, s60, s34
    buffer_load_dwordx4 v[80:83], v1, s[12:15], s33 offen
    s_waitcnt lgkmcnt(2)
    s_set_gpr_idx_on s54, 0xc
    v_pk_fma_f32 v[16:17], v[132:133], v[96:97], v[16:17] op_sel:[0,0,0] op_sel_hi:[0,1,1]
    v_pk_fma_f32 v[18:19], v[132:133], v[98:99], v[18:19] op_sel:[0,0,0] op_sel_hi:[0,1,1]
    v_pk_fma_f32 v[20:21], v[134:135], v[100:101], v[20:21] op_sel:[0,0,0] op_sel_hi:[0,1,1]
    v_pk_fma_f32 v[22:23], v[134:135], v[102:103], v[22:23] op_sel:[0,0,0] op_sel_hi:[0,1,1]
    s_set_gpr_idx_off
    v_lshlrev_b32_sdwa v138, v15, v116 dst_sel:DWORD dst_unused:UNUSED_PAD src0_sel:DWORD src1_sel:WORD_1
    s_waitcnt vmcnt(4)
    v_mfma_f32_4x4x4_16b_bf16 v[96:99], v[140:141], v[64:65], 0 cbsz:4 abid:14
    v_readlane_b32 s61, v164, 61
    v_mfma_f32_4x4x4_16b_bf16 v[100:103], v[140:141], v[66:67], 0 cbsz:4 abid:14
    v_lshlrev_b32_sdwa v139, v15, v117 dst_sel:DWORD dst_unused:UNUSED_PAD src0_sel:DWORD src1_sel:WORD_1
    ds_read_u16_d16_hi v130, v138 offset:32768
    ds_read_u16_d16_hi v131, v139 offset:32768
    s_and_b32 s33, s61, s34
    buffer_load_dwordx4 v[84:87], v1, s[12:15], s33 offen
    s_set_gpr_idx_on s55, 0xc
    v_pk_fma_f32 v[16:17], v[132:133], v[104:105], v[16:17] op_sel:[1,0,0] op_sel_hi:[1,1,1]
    v_pk_fma_f32 v[18:19], v[132:133], v[106:107], v[18:19] op_sel:[1,0,0] op_sel_hi:[1,1,1]
    v_pk_fma_f32 v[20:21], v[134:135], v[108:109], v[20:21] op_sel:[1,0,0] op_sel_hi:[1,1,1]
    v_pk_fma_f32 v[22:23], v[134:135], v[110:111], v[22:23] op_sel:[1,0,0] op_sel_hi:[1,1,1]
    s_set_gpr_idx_off
A_56:
    s_sub_u32 s31, s31, 4
    s_cbranch_scc1 B_56
    v_mfma_f32_4x4x4_16b_bf16 v[124:127], v[172:173], v[178:179], 0 cbsz:4 abid:15
    v_lshlrev_b32_sdwa v136, v15, v114 dst_sel:DWORD dst_unused:UNUSED_PAD src0_sel:DWORD src1_sel:WORD_1
    s_waitcnt vmcnt(4)
    v_mfma_f32_4x4x4_16b_bf16 v[104:107], v[142:143], v[68:69], 0 cbsz:4 abid:14
    v_readlane_b32 s62, v164, 62
    v_mfma_f32_4x4x4_16b_bf16 v[108:111], v[142:143], v[70:71], 0 cbsz:4 abid:14
    v_lshlrev_b32_sdwa v137, v15, v115 dst_sel:DWORD dst_unused:UNUSED_PAD src0_sel:DWORD src1_sel:WORD_1
    ds_read_u16_d16_hi v132, v136 offset:32768
    ds_read_u16_d16_hi v133, v137 offset:32768
    s_and_b32 s33, s62, s34
    buffer_load_dwordx4 v[88:91], v1, s[12:15], s33 offen
    s_waitcnt lgkmcnt(2)
    s_set_gpr_idx_on s56, 0xc
    v_pk_fma_f32 v[16:17], v[128:129], v[96:97], v[16:17] op_sel:[0,0,0] op_sel_hi:[0,1,1]
    v_pk_fma_f32 v[18:19], v[128:129], v[98:99], v[18:19] op_sel:[0,0,0] op_sel_hi:[0,1,1]
    v_pk_fma_f32 v[20:21], v[130:131], v[100:101], v[20:21] op_sel:[0,0,0] op_sel_hi:[0,1,1]
    v_pk_fma_f32 v[22:23], v[130:131], v[102:103], v[22:23] op_sel:[0,0,0] op_sel_hi:[0,1,1]
    s_set_gpr_idx_off
    v_lshlrev_b32_sdwa v138, v15, v118 dst_sel:DWORD dst_unused:UNUSED_PAD src0_sel:DWORD src1_sel:WORD_1
    s_waitcnt vmcnt(4)
    v_mfma_f32_4x4x4_16b_bf16 v[96:99], v[144:145], v[72:73], 0 cbsz:4 abid:14
    v_readlane_b32 s63, v164, 63
    v_mfma_f32_4x4x4_16b_bf16 v[100:103], v[144:145], v[74:75], 0 cbsz:4 abid:14
    v_lshlrev_b32_sdwa v139, v15, v119 dst_sel:DWORD dst_unused:UNUSED_PAD src0_sel:DWORD src1_sel:WORD_1
    ds_read_u16_d16_hi v134, v138 offset:32768
    ds_read_u16_d16_hi v135, v139 offset:32768
    s_and_b32 s33, s63, s34
    buffer_load_dwordx4 v[92:95], v1, s[12:15], s33 offen
    s_set_gpr_idx_on s57, 0xc
    v_pk_fma_f32 v[16:17], v[128:129], v[104:105], v[16:17] op_sel:[1,0,0] op_sel_hi:[1,1,1]
    v_pk_fma_f32 v[18:19], v[128:129], v[106:107], v[18:19] op_sel:[1,0,0] op_sel_hi:[1,1,1]
    v_pk_fma_f32 v[20:21], v[130:131], v[108:109], v[20:21] op_sel:[1,0,0] op_sel_hi:[1,1,1]
    v_pk_fma_f32 v[22:23], v[130:131], v[110:111], v[22:23] op_sel:[1,0,0] op_sel_hi:[1,1,1]
    s_set_gpr_idx_off
    v_mov_b32 v172, v170
    v_mov_b32 v173, v171
    s_nop 1
    v_mfma_f32_4x4x4_16b_bf16 v[112:115], v[172:173], v[176:177], 0 cbsz:4 abid:0
    v_lshlrev_b32_sdwa v136, v15, v120 dst_sel:DWORD dst_unused:UNUSED_PAD src0_sel:DWORD src1_sel:WORD_1
    s_waitcnt vmcnt(4)
    v_mfma_f32_4x4x4_16b_bf16 v[104:107], v[146:147], v[76:77], 0 cbsz:4 abid:14
    v_readlane_b32 s48, v165, 0
    v_mfma_f32_4x4x4_16b_bf16 v[108:111], v[146:147], v[78:79], 0 cbsz:4 abid:14
    v_lshlrev_b32_sdwa v137, v15, v121 dst_sel:DWORD dst_unused:UNUSED_PAD src0_sel:DWORD src1_sel:WORD_1
    ds_read_u16_d16_hi v128, v136 offset:32768
    ds_read_u16_d16_hi v129, v137 offset:32768
    s_and_b32 s33, s48, s34
    buffer_load_dwordx4 v[64:67], v1, s[12:15], s33 offen
    s_waitcnt lgkmcnt(2)
    s_set_gpr_idx_on s58, 0xc
    v_pk_fma_f32 v[16:17], v[132:133], v[96:97], v[16:17] op_sel:[0,0,0] op_sel_hi:[0,1,1]
    v_pk_fma_f32 v[18:19], v[132:133], v[98:99], v[18:19] op_sel:[0,0,0] op_sel_hi:[0,1,1]
    v_pk_fma_f32 v[20:21], v[134:135], v[100:101], v[20:21] op_sel:[0,0,0] op_sel_hi:[0,1,1]
    v_pk_fma_f32 v[22:23], v[134:135], v[102:103], v[22:23] op_sel:[0,0,0] op_sel_hi:[0,1,1]
    s_set_gpr_idx_off
    v_lshlrev_b32_sdwa v138, v15, v124 dst_sel:DWORD dst_unused:UNUSED_PAD src0_sel:DWORD src1_sel:WORD_1
    s_waitcnt vmcnt(4)
    v_mfma_f32_4x4x4_16b_bf16 v[96:99], v[140:141], v[80:81], 0 cbsz:4 abid:15
    v_readlane_b32 s49, v165, 1
    v_mfma_f32_4x4x4_16b_bf16 v[100:103], v[140:141], v[82:83], 0 cbsz:4 abid:15
    v_lshlrev_b32_sdwa v139, v15, v125 dst_sel:DWORD dst_unused:UNUSED_PAD src0_sel:DWORD src1_sel:WORD_1
    ds_read_u16_d16_hi v130, v138 offset:32768
    ds_read_u16_d16_hi v131, v139 offset:32768
    s_and_b32 s33, s49, s34
    buffer_load_dwordx4 v[68:71], v1, s[12:15], s33 offen
    s_set_gpr_idx_on s59, 0xc
    v_pk_fma_f32 v[16:17], v[132:133], v[104:105], v[16:17] op_sel:[1,0,0] op_sel_hi:[1,1,1]
    v_pk_fma_f32 v[18:19], v[132:133], v[106:107], v[18:19] op_sel:[1,0,0] op_sel_hi:[1,1,1]
    v_pk_fma_f32 v[20:21], v[134:135], v[108:109], v[20:21] op_sel:[1,0,0] op_sel_hi:[1,1,1]
    v_pk_fma_f32 v[22:23], v[134:135], v[110:111], v[22:23] op_sel:[1,0,0] op_sel_hi:[1,1,1]
    s_set_gpr_idx_off
A_60:
    s_sub_u32 s31, s31, 4
    s_cbranch_scc1 B_60
    v_mfma_f32_4x4x4_16b_bf16 v[116:119], v[172:173], v[178:179], 0 cbsz:4 abid:0
    v_lshlrev_b32_sdwa v136, v15, v122 dst_sel:DWORD dst_unused:UNUSED_PAD src0_sel:DWORD src1_sel:WORD_1
    s_waitcnt vmcnt(4)
    v_mfma_f32_4x4x4_16b_bf16 v[104:107], v[142:143], v[84:85], 0 cbsz:4 abid:15
    v_readlane_b32 s50, v165, 2
    v_mfma_f32_4x4x4_16b_bf16 v[108:111], v[142:143], v[86:87], 0 cbsz:4 abid:15
    v_lshlrev_b32_sdwa v137, v15, v123 dst_sel:DWORD dst_unused:UNUSED_PAD src0_sel:DWORD src1_sel:WORD_1
    ds_read_u16_d16_hi v132, v136 offset:32768
    ds_read_u16_d16_hi v133, v137 offset:32768
    v_cvt_pk_bf16_f32 v140, v148, v152
    v_cvt_pk_bf16_f32 v141, v156, v160
    s_and_b32 s33, s50, s34
    buffer_load_dwordx4 v[72:75], v1, s[12:15], s33 offen
    s_waitcnt lgkmcnt(2)
    s_set_gpr_idx_on s60, 0xc
    v_pk_fma_f32 v[16:17], v[128:129], v[96:97], v[16:17] op_sel:[0,0,0] op_sel_hi:[0,1,1]
    v_pk_fma_f32 v[18:19], v[128:129], v[98:99], v[18:19] op_sel:[0,0,0] op_sel_hi:[0,1,1]
    v_pk_fma_f32 v[20:21], v[130:131], v[100:101], v[20:21] op_sel:[0,0,0] op_sel_hi:[0,1,1]
    v_pk_fma_f32 v[22:23], v[130:131], v[102:103], v[22:23] op_sel:[0,0,0] op_sel_hi:[0,1,1]
    s_set_gpr_idx_off
    v_lshlrev_b32_sdwa v138, v15, v126 dst_sel:DWORD dst_unused:UNUSED_PAD src0_sel:DWORD src1_sel:WORD_1
    s_waitcnt vmcnt(4)
    v_mfma_f32_4x4x4_16b_bf16 v[96:99], v[144:145], v[88:89], 0 cbsz:4 abid:15
    v_readlane_b32 s51, v165, 3
    v_mfma_f32_4x4x4_16b_bf16 v[100:103], v[144:145], v[90:91], 0 cbsz:4 abid:15
    v_lshlrev_b32_sdwa v139, v15, v127 dst_sel:DWORD dst_unused:UNUSED_PAD src0_sel:DWORD src1_sel:WORD_1
    ds_read_u16_d16_hi v134, v138 offset:32768
    ds_read_u16_d16_hi v135, v139 offset:32768
    v_cvt_pk_bf16_f32 v142, v149, v153
    v_cvt_pk_bf16_f32 v143, v157, v161
    s_and_b32 s33, s51, s34
    buffer_load_dwordx4 v[76:79], v1, s[12:15], s33 offen
    s_set_gpr_idx_on s61, 0xc
    v_pk_fma_f32 v[16:17], v[128:129], v[104:105], v[16:17] op_sel:[1,0,0] op_sel_hi:[1,1,1]
    v_pk_fma_f32 v[18:19], v[128:129], v[106:107], v[18:19] op_sel:[1,0,0] op_sel_hi:[1,1,1]
    v_pk_fma_f32 v[20:21], v[130:131], v[108:109], v[20:21] op_sel:[1,0,0] op_sel_hi:[1,1,1]
    v_pk_fma_f32 v[22:23], v[130:131], v[110:111], v[22:23] op_sel:[1,0,0] op_sel_hi:[1,1,1]
    s_set_gpr_idx_off
    v_mfma_f32_4x4x4_16b_bf16 v[120:123], v[172:173], v[176:177], 0 cbsz:4 abid:1
    v_lshlrev_b32_sdwa v136, v15, v112 dst_sel:DWORD dst_unused:UNUSED_PAD src0_sel:DWORD src1_sel:WORD_1
    s_waitcnt vmcnt(4)
    v_mfma_f32_4x4x4_16b_bf16 v[104:107], v[146:147], v[92:93], 0 cbsz:4 abid:15
    v_readlane_b32 s52, v165, 4
    v_mfma_f32_4x4x4_16b_bf16 v[108:111], v[146:147], v[94:95], 0 cbsz:4 abid:15
    v_lshlrev_b32_sdwa v137, v15, v113 dst_sel:DWORD dst_unused:UNUSED_PAD src0_sel:DWORD src1_sel:WORD_1
    ds_read_u16_d16_hi v128, v136 offset:32768
    ds_read_u16_d16_hi v129, v137 offset:32768
    v_cvt_pk_bf16_f32 v144, v150, v154
    v_cvt_pk_bf16_f32 v145, v158, v162
    s_and_b32 s33, s52, s34
    buffer_load_dwordx4 v[80:83], v1, s[12:15], s33 offen
    s_waitcnt lgkmcnt(2)
    s_set_gpr_idx_on s62, 0xc
    v_pk_fma_f32 v[16:17], v[132:133], v[96:97], v[16:17] op_sel:[0,0,0] op_sel_hi:[0,1,1]
    v_pk_fma_f32 v[18:19], v[132:133], v[98:99], v[18:19] op_sel:[0,0,0] op_sel_hi:[0,1,1]
    v_pk_fma_f32 v[20:21], v[134:135], v[100:101], v[20:21] op_sel:[0,0,0] op_sel_hi:[0,1,1]
    v_pk_fma_f32 v[22:23], v[134:135], v[102:103], v[22:23] op_sel:[0,0,0] op_sel_hi:[0,1,1]
    s_set_gpr_idx_off
    v_lshlrev_b32_sdwa v138, v15, v116 dst_sel:DWORD dst_unused:UNUSED_PAD src0_sel:DWORD src1_sel:WORD_1
    s_waitcnt vmcnt(4)
    v_mfma_f32_4x4x4_16b_bf16 v[96:99], v[140:141], v[64:65], 0 cbsz:4 abid:0
    v_readlane_b32 s53, v165, 5
    v_mfma_f32_4x4x4_16b_bf16 v[100:103], v[140:141], v[66:67], 0 cbsz:4 abid:0
    v_lshlrev_b32_sdwa v139, v15, v117 dst_sel:DWORD dst_unused:UNUSED_PAD src0_sel:DWORD src1_sel:WORD_1
    ds_read_u16_d16_hi v130, v138 offset:32768
    ds_read_u16_d16_hi v131, v139 offset:32768
    v_cvt_pk_bf16_f32 v146, v151, v155
    v_cvt_pk_bf16_f32 v147, v159, v163
    s_and_b32 s33, s53, s34
    buffer_load_dwordx4 v[84:87], v1, s[12:15], s33 offen
    s_set_gpr_idx_on s63, 0xc
    v_pk_fma_f32 v[16:17], v[132:133], v[104:105], v[16:17] op_sel:[1,0,0] op_sel_hi:[1,1,1]
    v_pk_fma_f32 v[18:19], v[132:133], v[106:107], v[18:19] op_sel:[1,0,0] op_sel_hi:[1,1,1]
    v_pk_fma_f32 v[20:21], v[134:135], v[108:109], v[20:21] op_sel:[1,0,0] op_sel_hi:[1,1,1]
    v_pk_fma_f32 v[22:23], v[134:135], v[110:111], v[22:23] op_sel:[1,0,0] op_sel_hi:[1,1,1]
    s_set_gpr_idx_off
    v_mov_b32 v164, v165
    s_branch A_0
B_0:
    buffer_load_dwordx4 v[188:191], v1, s[16:19], s10 offen offset:0 sc1
    buffer_load_dwordx4 v[192:195], v1, s[16:19], s10 offen offset:1024 sc1
    buffer_load_dwordx4 v[196:199], v1, s[16:19], s10 offen offset:2048 sc1
    buffer_load_dwordx4 v[200:203], v1, s[16:19], s10 offen offset:3072 sc1
    buffer_load_dwordx4 v[204:207], v1, s[16:19], s11 offen offset:0 sc1
    buffer_load_dwordx4 v[208:211], v1, s[16:19], s11 offen offset:1024 sc1
    buffer_load_dwordx4 v[212:215], v1, s[16:19], s11 offen offset:2048 sc1
    buffer_load_dwordx4 v[216:219], v1, s[16:19], s11 offen offset:3072 sc1
    s_sub_u32 s32, s32, 1
    s_cbranch_scc1 MAIN_DONE
    v_mfma_f32_4x4x4_16b_bf16 v[124:127], v[172:173], v[178:179], 0 cbsz:4 abid:1
    v_lshlrev_b32_sdwa v136, v15, v114 dst_sel:DWORD dst_unused:UNUSED_PAD src0_sel:DWORD src1_sel:WORD_1
    s_waitcnt vmcnt(12)
    v_mfma_f32_4x4x4_16b_bf16 v[104:107], v[142:143], v[68:69], 0 cbsz:4 abid:0
    s_nop 0
    v_mfma_f32_4x4x4_16b_bf16 v[108:111], v[142:143], v[70:71], 0 cbsz:4 abid:0
    v_lshlrev_b32_sdwa v137, v15, v115 dst_sel:DWORD dst_unused:UNUSED_PAD src0_sel:DWORD src1_sel:WORD_1
    ds_read_u16_d16_hi v132, v136 offset:32768
    ds_read_u16_d16_hi v133, v137 offset:32768
    s_waitcnt lgkmcnt(2)
    s_set_gpr_idx_on s48, 0xc
    v_pk_fma_f32 v[16:17], v[128:129], v[96:97], v[16:17] op_sel:[0,0,0] op_sel_hi:[0,1,1]
    v_pk_fma_f32 v[18:19], v[128:129], v[98:99], v[18:19] op_sel:[0,0,0] op_sel_hi:[0,1,1]
    v_pk_fma_f32 v[20:21], v[130:131], v[100:101], v[20:21] op_sel:[0,0,0] op_sel_hi:[0,1,1]
    v_pk_fma_f32 v[22:23], v[130:131], v[102:103], v[22:23] op_sel:[0,0,0] op_sel_hi:[0,1,1]
    s_set_gpr_idx_off
    s_sub_u32 s32, s32, 1
    s_cbranch_scc1 MAIN_DONE
    v_lshlrev_b32_sdwa v138, v15, v118 dst_sel:DWORD dst_unused:UNUSED_PAD src0_sel:DWORD src1_sel:WORD_1
    s_waitcnt vmcnt(11)
    v_mfma_f32_4x4x4_16b_bf16 v[96:99], v[144:145], v[72:73], 0 cbsz:4 abid:0
    s_nop 0
    v_mfma_f32_4x4x4_16b_bf16 v[100:103], v[144:145], v[74:75], 0 cbsz:4 abid:0
    v_lshlrev_b32_sdwa v139, v15, v119 dst_sel:DWORD dst_unused:UNUSED_PAD src0_sel:DWORD src1_sel:WORD_1
    ds_read_u16_d16_hi v134, v138 offset:32768
    ds_read_u16_d16_hi v135, v139 offset:32768
    s_set_gpr_idx_on s49, 0xc
    v_pk_fma_f32 v[16:17], v[128:129], v[104:105], v[16:17] op_sel:[1,0,0] op_sel_hi:[1,1,1]
    v_pk_fma_f32 v[18:19], v[128:129], v[106:107], v[18:19] op_sel:[1,0,0] op_sel_hi:[1,1,1]
    v_pk_fma_f32 v[20:21], v[130:131], v[108:109], v[20:21] op_sel:[1,0,0] op_sel_hi:[1,1,1]
    v_pk_fma_f32 v[22:23], v[130:131], v[110:111], v[22:23] op_sel:[1,0,0] op_sel_hi:[1,1,1]
    s_set_gpr_idx_off
    s_sub_u32 s32, s32, 1
    s_cbranch_scc1 MAIN_DONE
    v_mfma_f32_4x4x4_16b_bf16 v[112:115], v[172:173], v[176:177], 0 cbsz:4 abid:2
    v_lshlrev_b32_sdwa v136, v15, v120 dst_sel:DWORD dst_unused:UNUSED_PAD src0_sel:DWORD src1_sel:WORD_1
    s_waitcnt vmcnt(10)
    v_mfma_f32_4x4x4_16b_bf16 v[104:107], v[146:147], v[76:77], 0 cbsz:4 abid:0
    s_nop 0
    v_mfma_f32_4x4x4_16b_bf16 v[108:111], v[146:147], v[78:79], 0 cbsz:4 abid:0
    v_lshlrev_b32_sdwa v137, v15, v121 dst_sel:DWORD dst_unused:UNUSED_PAD src0_sel:DWORD src1_sel:WORD_1
    ds_read_u16_d16_hi v128, v136 offset:32768
    ds_read_u16_d16_hi v129, v137 offset:32768
    s_waitcnt lgkmcnt(2)
    s_set_gpr_idx_on s50, 0xc
    v_pk_fma_f32 v[16:17], v[132:133], v[96:97], v[16:17] op_sel:[0,0,0] op_sel_hi:[0,1,1]
    v_pk_fma_f32 v[18:19], v[132:133], v[98:99], v[18:19] op_sel:[0,0,0] op_sel_hi:[0,1,1]
    v_pk_fma_f32 v[20:21], v[134:135], v[100:101], v[20:21] op_sel:[0,0,0] op_sel_hi:[0,1,1]
    v_pk_fma_f32 v[22:23], v[134:135], v[102:103], v[22:23] op_sel:[0,0,0] op_sel_hi:[0,1,1]
    s_set_gpr_idx_off
    s_sub_u32 s32, s32, 1
    s_cbranch_scc1 MAIN_DONE
    v_lshlrev_b32_sdwa v138, v15, v124 dst_sel:DWORD dst_unused:UNUSED_PAD src0_sel:DWORD src1_sel:WORD_1
    s_waitcnt vmcnt(9)
    v_mfma_f32_4x4x4_16b_bf16 v[96:99], v[140:141], v[80:81], 0 cbsz:4 abid:1
    s_nop 0
    v_mfma_f32_4x4x4_16b_bf16 v[100:103], v[140:141], v[82:83], 0 cbsz:4 abid:1
    v_lshlrev_b32_sdwa v139, v15, v125 dst_sel:DWORD dst_unused:UNUSED_PAD src0_sel:DWORD src1_sel:WORD_1
    ds_read_u16_d16_hi v130, v138 offset:32768
    ds_read_u16_d16_hi v131, v139 offset:32768
    s_set_gpr_idx_on s51, 0xc
    v_pk_fma_f32 v[16:17], v[132:133], v[104:105], v[16:17] op_sel:[1,0,0] op_sel_hi:[1,1,1]
    v_pk_fma_f32 v[18:19], v[132:133], v[106:107], v[18:19] op_sel:[1,0,0] op_sel_hi:[1,1,1]
    v_pk_fma_f32 v[20:21], v[134:135], v[108:109], v[20:21] op_sel:[1,0,0] op_sel_hi:[1,1,1]
    v_pk_fma_f32 v[22:23], v[134:135], v[110:111], v[22:23] op_sel:[1,0,0] op_sel_hi:[1,1,1]
    s_set_gpr_idx_off
    s_sub_u32 s32, s32, 1
    s_cbranch_scc1 MAIN_DONE
    v_mfma_f32_4x4x4_16b_bf16 v[116:119], v[172:173], v[178:179], 0 cbsz:4 abid:2
    v_lshlrev_b32_sdwa v136, v15, v122 dst_sel:DWORD dst_unused:UNUSED_PAD src0_sel:DWORD src1_sel:WORD_1
    s_waitcnt vmcnt(8)
    v_mfma_f32_4x4x4_16b_bf16 v[104:107], v[142:143], v[84:85], 0 cbsz:4 abid:1
    s_nop 0
    v_mfma_f32_4x4x4_16b_bf16 v[108:111], v[142:143], v[86:87], 0 cbsz:4 abid:1
    v_lshlrev_b32_sdwa v137, v15, v123 dst_sel:DWORD dst_unused:UNUSED_PAD src0_sel:DWORD src1_sel:WORD_1
    ds_read_u16_d16_hi v132, v136 offset:32768
    ds_read_u16_d16_hi v133, v137 offset:32768
    s_waitcnt lgkmcnt(2)
    s_set_gpr_idx_on s52, 0xc
    v_pk_fma_f32 v[16:17], v[128:129], v[96:97], v[16:17] op_sel:[0,0,0] op_sel_hi:[0,1,1]
    v_pk_fma_f32 v[18:19], v[128:129], v[98:99], v[18:19] op_sel:[0,0,0] op_sel_hi:[0,1,1]
    v_pk_fma_f32 v[20:21], v[130:131], v[100:101], v[20:21] op_sel:[0,0,0] op_sel_hi:[0,1,1]
    v_pk_fma_f32 v[22:23], v[130:131], v[102:103], v[22:23] op_sel:[0,0,0] op_sel_hi:[0,1,1]
    s_set_gpr_idx_off
    s_sub_u32 s32, s32, 1
    s_cbranch_scc1 MAIN_DONE
    v_lshlrev_b32_sdwa v138, v15, v126 dst_sel:DWORD dst_unused:UNUSED_PAD src0_sel:DWORD src1_sel:WORD_1
    v_mfma_f32_4x4x4_16b_bf16 v[96:99], v[144:145], v[88:89], 0 cbsz:4 abid:1
    s_nop 0
    v_mfma_f32_4x4x4_16b_bf16 v[100:103], v[144:145], v[90:91], 0 cbsz:4 abid:1
    v_lshlrev_b32_sdwa v139, v15, v127 dst_sel:DWORD dst_unused:UNUSED_PAD src0_sel:DWORD src1_sel:WORD_1
    ds_read_u16_d16_hi v134, v138 offset:32768
    ds_read_u16_d16_hi v135, v139 offset:32768
    s_set_gpr_idx_on s53, 0xc
    v_pk_fma_f32 v[16:17], v[128:129], v[104:105], v[16:17] op_sel:[1,0,0] op_sel_hi:[1,1,1]
    v_pk_fma_f32 v[18:19], v[128:129], v[106:107], v[18:19] op_sel:[1,0,0] op_sel_hi:[1,1,1]
    v_pk_fma_f32 v[20:21], v[130:131], v[108:109], v[20:21] op_sel:[1,0,0] op_sel_hi:[1,1,1]
    v_pk_fma_f32 v[22:23], v[130:131], v[110:111], v[22:23] op_sel:[1,0,0] op_sel_hi:[1,1,1]
    s_set_gpr_idx_off
    s_branch MAIN_DONE
B_4:
    buffer_load_dwordx4 v[188:191], v1, s[16:19], s10 offen offset:0 sc1
    buffer_load_dwordx4 v[192:195], v1, s[16:19], s10 offen offset:1024 sc1
    buffer_load_dwordx4 v[196:199], v1, s[16:19], s10 offen offset:2048 sc1
    buffer_load_dwordx4 v[200:203], v1, s[16:19], s10 offen offset:3072 sc1
    buffer_load_dwordx4 v[204:207], v1, s[16:19], s11 offen offset:0 sc1
    buffer_load_dwordx4 v[208:211], v1, s[16:19], s11 offen offset:1024 sc1
    buffer_load_dwordx4 v[212:215], v1, s[16:19], s11 offen offset:2048 sc1
    buffer_load_dwordx4 v[216:219], v1, s[16:19], s11 offen offset:3072 sc1
    s_sub_u32 s32, s32, 1
    s_cbranch_scc1 MAIN_DONE
    v_mfma_f32_4x4x4_16b_bf16 v[116:119], v[172:173], v[178:179], 0 cbsz:4 abid:2
    v_lshlrev_b32_sdwa v136, v15, v122 dst_sel:DWORD dst_unused:UNUSED_PAD src0_sel:DWORD src1_sel:WORD_1
    s_waitcnt vmcnt(12)
    v_mfma_f32_4x4x4_16b_bf16 v[104:107], v[142:143], v[84:85], 0 cbsz:4 abid:1
    s_nop 0
    v_mfma_f32_4x4x4_16b_bf16 v[108:111], v[142:143], v[86:87], 0 cbsz:4 abid:1
    v_lshlrev_b32_sdwa v137, v15, v123 dst_sel:DWORD dst_unused:UNUSED_PAD src0_sel:DWORD src1_sel:WORD_1
    ds_read_u16_d16_hi v132, v136 offset:32768
    ds_read_u16_d16_hi v133, v137 offset:32768
    s_waitcnt lgkmcnt(2)
    s_set_gpr_idx_on s52, 0xc
    v_pk_fma_f32 v[16:17], v[128:129], v[96:97], v[16:17] op_sel:[0,0,0] op_sel_hi:[0,1,1]
    v_pk_fma_f32 v[18:19], v[128:129], v[98:99], v[18:19] op_sel:[0,0,0] op_sel_hi:[0,1,1]
    v_pk_fma_f32 v[20:21], v[130:131], v[100:101], v[20:21] op_sel:[0,0,0] op_sel_hi:[0,1,1]
    v_pk_fma_f32 v[22:23], v[130:131], v[102:103], v[22:23] op_sel:[0,0,0] op_sel_hi:[0,1,1]
    s_set_gpr_idx_off
    s_sub_u32 s32, s32, 1
    s_cbranch_scc1 MAIN_DONE
    v_lshlrev_b32_sdwa v138, v15, v126 dst_sel:DWORD dst_unused:UNUSED_PAD src0_sel:DWORD src1_sel:WORD_1
    s_waitcnt vmcnt(11)
    v_mfma_f32_4x4x4_16b_bf16 v[96:99], v[144:145], v[88:89], 0 cbsz:4 abid:1
    s_nop 0
    v_mfma_f32_4x4x4_16b_bf16 v[100:103], v[144:145], v[90:91], 0 cbsz:4 abid:1
    v_lshlrev_b32_sdwa v139, v15, v127 dst_sel:DWORD dst_unused:UNUSED_PAD src0_sel:DWORD src1_sel:WORD_1
    ds_read_u16_d16_hi v134, v138 offset:32768
    ds_read_u16_d16_hi v135, v139 offset:32768
    s_set_gpr_idx_on s53, 0xc
    v_pk_fma_f32 v[16:17], v[128:129], v[104:105], v[16:17] op_sel:[1,0,0] op_sel_hi:[1,1,1]
    v_pk_fma_f32 v[18:19], v[128:129], v[106:107], v[18:19] op_sel:[1,0,0] op_sel_hi:[1,1,1]
    v_pk_fma_f32 v[20:21], v[130:131], v[108:109], v[20:21] op_sel:[1,0,0] op_sel_hi:[1,1,1]
    v_pk_fma_f32 v[22:23], v[130:131], v[110:111], v[22:23] op_sel:[1,0,0] op_sel_hi:[1,1,1]
    s_set_gpr_idx_off
    s_sub_u32 s32, s32, 1
    s_cbranch_scc1 MAIN_DONE
    v_mfma_f32_4x4x4_16b_bf16 v[120:123], v[172:173], v[176:177], 0 cbsz:4 abid:3
    v_lshlrev_b32_sdwa v136, v15, v112 dst_sel:DWORD dst_unused:UNUSED_PAD src0_sel:DWORD src1_sel:WORD_1
    s_waitcnt vmcnt(10)
    v_mfma_f32_4x4x4_16b_bf16 v[104:107], v[146:147], v[92:93], 0 cbsz:4 abid:1
    s_nop 0
    v_mfma_f32_4x4x4_16b_bf16 v[108:111], v[146:147], v[94:95], 0 cbsz:4 abid:1
    v_lshlrev_b32_sdwa v137, v15, v113 dst_sel:DWORD dst_unused:UNUSED_PAD src0_sel:DWORD src1_sel:WORD_1
    ds_read_u16_d16_hi v128, v136 offset:32768
    ds_read_u16_d16_hi v129, v137 offset:32768
    s_waitcnt lgkmcnt(2)
    s_set_gpr_idx_on s54, 0xc
    v_pk_fma_f32 v[16:17], v[132:133], v[96:97], v[16:17] op_sel:[0,0,0] op_sel_hi:[0,1,1]
    v_pk_fma_f32 v[18:19], v[132:133], v[98:99], v[18:19] op_sel:[0,0,0] op_sel_hi:[0,1,1]
    v_pk_fma_f32 v[20:21], v[134:135], v[100:101], v[20:21] op_sel:[0,0,0] op_sel_hi:[0,1,1]
    v_pk_fma_f32 v[22:23], v[134:135], v[102:103], v[22:23] op_sel:[0,0,0] op_sel_hi:[0,1,1]
    s_set_gpr_idx_off
    s_sub_u32 s32, s32, 1
    s_cbranch_scc1 MAIN_DONE
    v_lshlrev_b32_sdwa v138, v15, v116 dst_sel:DWORD dst_unused:UNUSED_PAD src0_sel:DWORD src1_sel:WORD_1
    s_waitcnt vmcnt(9)
    v_mfma_f32_4x4x4_16b_bf16 v[96:99], v[140:141], v[64:65], 0 cbsz:4 abid:2
    s_nop 0
    v_mfma_f32_4x4x4_16b_bf16 v[100:103], v[140:141], v[66:67], 0 cbsz:4 abid:2
    v_lshlrev_b32_sdwa v139, v15, v117 dst_sel:DWORD dst_unused:UNUSED_PAD src0_sel:DWORD src1_sel:WORD_1
    ds_read_u16_d16_hi v130, v138 offset:32768
    ds_read_u16_d16_hi v131, v139 offset:32768
    s_set_gpr_idx_on s55, 0xc
    v_pk_fma_f32 v[16:17], v[132:133], v[104:105], v[16:17] op_sel:[1,0,0] op_sel_hi:[1,1,1]
    v_pk_fma_f32 v[18:19], v[132:133], v[106:107], v[18:19] op_sel:[1,0,0] op_sel_hi:[1,1,1]
    v_pk_fma_f32 v[20:21], v[134:135], v[108:109], v[20:21] op_sel:[1,0,0] op_sel_hi:[1,1,1]
    v_pk_fma_f32 v[22:23], v[134:135], v[110:111], v[22:23] op_sel:[1,0,0] op_sel_hi:[1,1,1]
    s_set_gpr_idx_off
    s_sub_u32 s32, s32, 1
    s_cbranch_scc1 MAIN_DONE
    v_mfma_f32_4x4x4_16b_bf16 v[124:127], v[172:173], v[178:179], 0 cbsz:4 abid:3
    v_lshlrev_b32_sdwa v136, v15, v114 dst_sel:DWORD dst_unused:UNUSED_PAD src0_sel:DWORD src1_sel:WORD_1
    s_waitcnt vmcnt(8)
    v_mfma_f32_4x4x4_16b_bf16 v[104:107], v[142:143], v[68:69], 0 cbsz:4 abid:2
    s_nop 0
    v_mfma_f32_4x4x4_16b_bf16 v[108:111], v[142:143], v[70:71], 0 cbsz:4 abid:2
    v_lshlrev_b32_sdwa v137, v15, v115 dst_sel:DWORD dst_unused:UNUSED_PAD src0_sel:DWORD src1_sel:WORD_1
    ds_read_u16_d16_hi v132, v136 offset:32768
    ds_read_u16_d16_hi v133, v137 offset:32768
    s_waitcnt lgkmcnt(2)
    s_set_gpr_idx_on s56, 0xc
    v_pk_fma_f32 v[16:17], v[128:129], v[96:97], v[16:17] op_sel:[0,0,0] op_sel_hi:[0,1,1]
    v_pk_fma_f32 v[18:19], v[128:129], v[98:99], v[18:19] op_sel:[0,0,0] op_sel_hi:[0,1,1]
    v_pk_fma_f32 v[20:21], v[130:131], v[100:101], v[20:21] op_sel:[0,0,0] op_sel_hi:[0,1,1]
    v_pk_fma_f32 v[22:23], v[130:131], v[102:103], v[22:23] op_sel:[0,0,0] op_sel_hi:[0,1,1]
    s_set_gpr_idx_off
    s_sub_u32 s32, s32, 1
    s_cbranch_scc1 MAIN_DONE
    v_lshlrev_b32_sdwa v138, v15, v118 dst_sel:DWORD dst_unused:UNUSED_PAD src0_sel:DWORD src1_sel:WORD_1
    v_mfma_f32_4x4x4_16b_bf16 v[96:99], v[144:145], v[72:73], 0 cbsz:4 abid:2
    s_nop 0
    v_mfma_f32_4x4x4_16b_bf16 v[100:103], v[144:145], v[74:75], 0 cbsz:4 abid:2
    v_lshlrev_b32_sdwa v139, v15, v119 dst_sel:DWORD dst_unused:UNUSED_PAD src0_sel:DWORD src1_sel:WORD_1
    ds_read_u16_d16_hi v134, v138 offset:32768
    ds_read_u16_d16_hi v135, v139 offset:32768
    s_set_gpr_idx_on s57, 0xc
    v_pk_fma_f32 v[16:17], v[128:129], v[104:105], v[16:17] op_sel:[1,0,0] op_sel_hi:[1,1,1]
    v_pk_fma_f32 v[18:19], v[128:129], v[106:107], v[18:19] op_sel:[1,0,0] op_sel_hi:[1,1,1]
    v_pk_fma_f32 v[20:21], v[130:131], v[108:109], v[20:21] op_sel:[1,0,0] op_sel_hi:[1,1,1]
    v_pk_fma_f32 v[22:23], v[130:131], v[110:111], v[22:23] op_sel:[1,0,0] op_sel_hi:[1,1,1]
    s_set_gpr_idx_off
    s_branch MAIN_DONE
B_8:
    buffer_load_dwordx4 v[188:191], v1, s[16:19], s10 offen offset:0 sc1
    buffer_load_dwordx4 v[192:195], v1, s[16:19], s10 offen offset:1024 sc1
    buffer_load_dwordx4 v[196:199], v1, s[16:19], s10 offen offset:2048 sc1
    buffer_load_dwordx4 v[200:203], v1, s[16:19], s10 offen offset:3072 sc1
    buffer_load_dwordx4 v[204:207], v1, s[16:19], s11 offen offset:0 sc1
    buffer_load_dwordx4 v[208:211], v1, s[16:19], s11 offen offset:1024 sc1
    buffer_load_dwordx4 v[212:215], v1, s[16:19], s11 offen offset:2048 sc1
    buffer_load_dwordx4 v[216:219], v1, s[16:19], s11 offen offset:3072 sc1
    s_sub_u32 s32, s32, 1
    s_cbranch_scc1 MAIN_DONE
    v_mfma_f32_4x4x4_16b_bf16 v[124:127], v[172:173], v[178:179], 0 cbsz:4 abid:3
    v_lshlrev_b32_sdwa v136, v15, v114 dst_sel:DWORD dst_unused:UNUSED_PAD src0_sel:DWORD src1_sel:WORD_1
    s_waitcnt vmcnt(12)
    v_mfma_f32_4x4x4_16b_bf16 v[104:107], v[142:143], v[68:69], 0 cbsz:4 abid:2
    s_nop 0
    v_mfma_f32_4x4x4_16b_bf16 v[108:111], v[142:143], v[70:71], 0 cbsz:4 abid:2
    v_lshlrev_b32_sdwa v137, v15, v115 dst_sel:DWORD dst_unused:UNUSED_PAD src0_sel:DWORD src1_sel:WORD_1
    ds_read_u16_d16_hi v132, v136 offset:32768
    ds_read_u16_d16_hi v133, v137 offset:32768
    s_waitcnt lgkmcnt(2)
    s_set_gpr_idx_on s56, 0xc
    v_pk_fma_f32 v[16:17], v[128:129], v[96:97], v[16:17] op_sel:[0,0,0] op_sel_hi:[0,1,1]
    v_pk_fma_f32 v[18:19], v[128:129], v[98:99], v[18:19] op_sel:[0,0,0] op_sel_hi:[0,1,1]
    v_pk_fma_f32 v[20:21], v[130:131], v[100:101], v[20:21] op_sel:[0,0,0] op_sel_hi:[0,1,1]
    v_pk_fma_f32 v[22:23], v[130:131], v[102:103], v[22:23] op_sel:[0,0,0] op_sel_hi:[0,1,1]
    s_set_gpr_idx_off
    s_sub_u32 s32, s32, 1
    s_cbranch_scc1 MAIN_DONE
    v_lshlrev_b32_sdwa v138, v15, v118 dst_sel:DWORD dst_unused:UNUSED_PAD src0_sel:DWORD src1_sel:WORD_1
    s_waitcnt vmcnt(11)
    v_mfma_f32_4x4x4_16b_bf16 v[96:99], v[144:145], v[72:73], 0 cbsz:4 abid:2
    s_nop 0
    v_mfma_f32_4x4x4_16b_bf16 v[100:103], v[144:145], v[74:75], 0 cbsz:4 abid:2
    v_lshlrev_b32_sdwa v139, v15, v119 dst_sel:DWORD dst_unused:UNUSED_PAD src0_sel:DWORD src1_sel:WORD_1
    ds_read_u16_d16_hi v134, v138 offset:32768
    ds_read_u16_d16_hi v135, v139 offset:32768
    s_set_gpr_idx_on s57, 0xc
    v_pk_fma_f32 v[16:17], v[128:129], v[104:105], v[16:17] op_sel:[1,0,0] op_sel_hi:[1,1,1]
    v_pk_fma_f32 v[18:19], v[128:129], v[106:107], v[18:19] op_sel:[1,0,0] op_sel_hi:[1,1,1]
    v_pk_fma_f32 v[20:21], v[130:131], v[108:109], v[20:21] op_sel:[1,0,0] op_sel_hi:[1,1,1]
    v_pk_fma_f32 v[22:23], v[130:131], v[110:111], v[22:23] op_sel:[1,0,0] op_sel_hi:[1,1,1]
    s_set_gpr_idx_off
    s_sub_u32 s32, s32, 1
    s_cbranch_scc1 MAIN_DONE
    v_mfma_f32_4x4x4_16b_bf16 v[112:115], v[172:173], v[176:177], 0 cbsz:4 abid:4
    v_lshlrev_b32_sdwa v136, v15, v120 dst_sel:DWORD dst_unused:UNUSED_PAD src0_sel:DWORD src1_sel:WORD_1
    s_waitcnt vmcnt(10)
    v_mfma_f32_4x4x4_16b_bf16 v[104:107], v[146:147], v[76:77], 0 cbsz:4 abid:2
    s_nop 0
    v_mfma_f32_4x4x4_16b_bf16 v[108:111], v[146:147], v[78:79], 0 cbsz:4 abid:2
    v_lshlrev_b32_sdwa v137, v15, v121 dst_sel:DWORD dst_unused:UNUSED_PAD src0_sel:DWORD src1_sel:WORD_1
    ds_read_u16_d16_hi v128, v136 offset:32768
    ds_read_u16_d16_hi v129, v137 offset:32768
    s_waitcnt lgkmcnt(2)
    s_set_gpr_idx_on s58, 0xc
    v_pk_fma_f32 v[16:17], v[132:133], v[96:97], v[16:17] op_sel:[0,0,0] op_sel_hi:[0,1,1]
    v_pk_fma_f32 v[18:19], v[132:133], v[98:99], v[18:19] op_sel:[0,0,0] op_sel_hi:[0,1,1]
    v_pk_fma_f32 v[20:21], v[134:135], v[100:101], v[20:21] op_sel:[0,0,0] op_sel_hi:[0,1,1]
    v_pk_fma_f32 v[22:23], v[134:135], v[102:103], v[22:23] op_sel:[0,0,0] op_sel_hi:[0,1,1]
    s_set_gpr_idx_off
    s_sub_u32 s32, s32, 1
    s_cbranch_scc1 MAIN_DONE
    v_lshlrev_b32_sdwa v138, v15, v124 dst_sel:DWORD dst_unused:UNUSED_PAD src0_sel:DWORD src1_sel:WORD_1
    s_waitcnt vmcnt(9)
    v_mfma_f32_4x4x4_16b_bf16 v[96:99], v[140:141], v[80:81], 0 cbsz:4 abid:3
    s_nop 0
    v_mfma_f32_4x4x4_16b_bf16 v[100:103], v[140:141], v[82:83], 0 cbsz:4 abid:3
    v_lshlrev_b32_sdwa v139, v15, v125 dst_sel:DWORD dst_unused:UNUSED_PAD src0_sel:DWORD src1_sel:WORD_1
    ds_read_u16_d16_hi v130, v138 offset:32768
    ds_read_u16_d16_hi v131, v139 offset:32768
    s_set_gpr_idx_on s59, 0xc
    v_pk_fma_f32 v[16:17], v[132:133], v[104:105], v[16:17] op_sel:[1,0,0] op_sel_hi:[1,1,1]
    v_pk_fma_f32 v[18:19], v[132:133], v[106:107], v[18:19] op_sel:[1,0,0] op_sel_hi:[1,1,1]
    v_pk_fma_f32 v[20:21], v[134:135], v[108:109], v[20:21] op_sel:[1,0,0] op_sel_hi:[1,1,1]
    v_pk_fma_f32 v[22:23], v[134:135], v[110:111], v[22:23] op_sel:[1,0,0] op_sel_hi:[1,1,1]
    s_set_gpr_idx_off
    s_sub_u32 s32, s32, 1
    s_cbranch_scc1 MAIN_DONE
    v_mfma_f32_4x4x4_16b_bf16 v[116:119], v[172:173], v[178:179], 0 cbsz:4 abid:4
    v_lshlrev_b32_sdwa v136, v15, v122 dst_sel:DWORD dst_unused:UNUSED_PAD src0_sel:DWORD src1_sel:WORD_1
    s_waitcnt vmcnt(8)
    v_mfma_f32_4x4x4_16b_bf16 v[104:107], v[142:143], v[84:85], 0 cbsz:4 abid:3
    s_nop 0
    v_mfma_f32_4x4x4_16b_bf16 v[108:111], v[142:143], v[86:87], 0 cbsz:4 abid:3
    v_lshlrev_b32_sdwa v137, v15, v123 dst_sel:DWORD dst_unused:UNUSED_PAD src0_sel:DWORD src1_sel:WORD_1
    ds_read_u16_d16_hi v132, v136 offset:32768
    ds_read_u16_d16_hi v133, v137 offset:32768
    s_waitcnt lgkmcnt(2)
    s_set_gpr_idx_on s60, 0xc
    v_pk_fma_f32 v[16:17], v[128:129], v[96:97], v[16:17] op_sel:[0,0,0] op_sel_hi:[0,1,1]
    v_pk_fma_f32 v[18:19], v[128:129], v[98:99], v[18:19] op_sel:[0,0,0] op_sel_hi:[0,1,1]
    v_pk_fma_f32 v[20:21], v[130:131], v[100:101], v[20:21] op_sel:[0,0,0] op_sel_hi:[0,1,1]
    v_pk_fma_f32 v[22:23], v[130:131], v[102:103], v[22:23] op_sel:[0,0,0] op_sel_hi:[0,1,1]
    s_set_gpr_idx_off
    s_sub_u32 s32, s32, 1
    s_cbranch_scc1 MAIN_DONE
    v_lshlrev_b32_sdwa v138, v15, v126 dst_sel:DWORD dst_unused:UNUSED_PAD src0_sel:DWORD src1_sel:WORD_1
    v_mfma_f32_4x4x4_16b_bf16 v[96:99], v[144:145], v[88:89], 0 cbsz:4 abid:3
    s_nop 0
    v_mfma_f32_4x4x4_16b_bf16 v[100:103], v[144:145], v[90:91], 0 cbsz:4 abid:3
    v_lshlrev_b32_sdwa v139, v15, v127 dst_sel:DWORD dst_unused:UNUSED_PAD src0_sel:DWORD src1_sel:WORD_1
    ds_read_u16_d16_hi v134, v138 offset:32768
    ds_read_u16_d16_hi v135, v139 offset:32768
    s_set_gpr_idx_on s61, 0xc
    v_pk_fma_f32 v[16:17], v[128:129], v[104:105], v[16:17] op_sel:[1,0,0] op_sel_hi:[1,1,1]
    v_pk_fma_f32 v[18:19], v[128:129], v[106:107], v[18:19] op_sel:[1,0,0] op_sel_hi:[1,1,1]
    v_pk_fma_f32 v[20:21], v[130:131], v[108:109], v[20:21] op_sel:[1,0,0] op_sel_hi:[1,1,1]
    v_pk_fma_f32 v[22:23], v[130:131], v[110:111], v[22:23] op_sel:[1,0,0] op_sel_hi:[1,1,1]
    s_set_gpr_idx_off
    s_branch MAIN_DONE
B_12:
    buffer_load_dwordx4 v[188:191], v1, s[16:19], s10 offen offset:0 sc1
    buffer_load_dwordx4 v[192:195], v1, s[16:19], s10 offen offset:1024 sc1
    buffer_load_dwordx4 v[196:199], v1, s[16:19], s10 offen offset:2048 sc1
    buffer_load_dwordx4 v[200:203], v1, s[16:19], s10 offen offset:3072 sc1
    buffer_load_dwordx4 v[204:207], v1, s[16:19], s11 offen offset:0 sc1
    buffer_load_dwordx4 v[208:211], v1, s[16:19], s11 offen offset:1024 sc1
    buffer_load_dwordx4 v[212:215], v1, s[16:19], s11 offen offset:2048 sc1
    buffer_load_dwordx4 v[216:219], v1, s[16:19], s11 offen offset:3072 sc1
    s_sub_u32 s32, s32, 1
    s_cbranch_scc1 MAIN_DONE
    v_mfma_f32_4x4x4_16b_bf16 v[116:119], v[172:173], v[178:179], 0 cbsz:4 abid:4
    v_lshlrev_b32_sdwa v136, v15, v122 dst_sel:DWORD dst_unused:UNUSED_PAD src0_sel:DWORD src1_sel:WORD_1
    s_waitcnt vmcnt(12)
    v_mfma_f32_4x4x4_16b_bf16 v[104:107], v[142:143], v[84:85], 0 cbsz:4 abid:3
    s_nop 0
    v_mfma_f32_4x4x4_16b_bf16 v[108:111], v[142:143], v[86:87], 0 cbsz:4 abid:3
    v_lshlrev_b32_sdwa v137, v15, v123 dst_sel:DWORD dst_unused:UNUSED_PAD src0_sel:DWORD src1_sel:WORD_1
    ds_read_u16_d16_hi v132, v136 offset:32768
    ds_read_u16_d16_hi v133, v137 offset:32768
    s_waitcnt lgkmcnt(2)
    s_set_gpr_idx_on s60, 0xc
    v_pk_fma_f32 v[16:17], v[128:129], v[96:97], v[16:17] op_sel:[0,0,0] op_sel_hi:[0,1,1]
    v_pk_fma_f32 v[18:19], v[128:129], v[98:99], v[18:19] op_sel:[0,0,0] op_sel_hi:[0,1,1]
    v_pk_fma_f32 v[20:21], v[130:131], v[100:101], v[20:21] op_sel:[0,0,0] op_sel_hi:[0,1,1]
    v_pk_fma_f32 v[22:23], v[130:131], v[102:103], v[22:23] op_sel:[0,0,0] op_sel_hi:[0,1,1]
    s_set_gpr_idx_off
    s_sub_u32 s32, s32, 1
    s_cbranch_scc1 MAIN_DONE
    v_lshlrev_b32_sdwa v138, v15, v126 dst_sel:DWORD dst_unused:UNUSED_PAD src0_sel:DWORD src1_sel:WORD_1
    s_waitcnt vmcnt(11)
    v_mfma_f32_4x4x4_16b_bf16 v[96:99], v[144:145], v[88:89], 0 cbsz:4 abid:3
    s_nop 0
    v_mfma_f32_4x4x4_16b_bf16 v[100:103], v[144:145], v[90:91], 0 cbsz:4 abid:3
    v_lshlrev_b32_sdwa v139, v15, v127 dst_sel:DWORD dst_unused:UNUSED_PAD src0_sel:DWORD src1_sel:WORD_1
    ds_read_u16_d16_hi v134, v138 offset:32768
    ds_read_u16_d16_hi v135, v139 offset:32768
    s_set_gpr_idx_on s61, 0xc
    v_pk_fma_f32 v[16:17], v[128:129], v[104:105], v[16:17] op_sel:[1,0,0] op_sel_hi:[1,1,1]
    v_pk_fma_f32 v[18:19], v[128:129], v[106:107], v[18:19] op_sel:[1,0,0] op_sel_hi:[1,1,1]
    v_pk_fma_f32 v[20:21], v[130:131], v[108:109], v[20:21] op_sel:[1,0,0] op_sel_hi:[1,1,1]
    v_pk_fma_f32 v[22:23], v[130:131], v[110:111], v[22:23] op_sel:[1,0,0] op_sel_hi:[1,1,1]
    s_set_gpr_idx_off
    s_sub_u32 s32, s32, 1
    s_cbranch_scc1 MAIN_DONE
    v_mfma_f32_4x4x4_16b_bf16 v[120:123], v[172:173], v[176:177], 0 cbsz:4 abid:5
    v_lshlrev_b32_sdwa v136, v15, v112 dst_sel:DWORD dst_unused:UNUSED_PAD src0_sel:DWORD src1_sel:WORD_1
    s_waitcnt vmcnt(10)
    v_mfma_f32_4x4x4_16b_bf16 v[104:107], v[146:147], v[92:93], 0 cbsz:4 abid:3
    s_nop 0
    v_mfma_f32_4x4x4_16b_bf16 v[108:111], v[146:147], v[94:95], 0 cbsz:4 abid:3
    v_lshlrev_b32_sdwa v137, v15, v113 dst_sel:DWORD dst_unused:UNUSED_PAD src0_sel:DWORD src1_sel:WORD_1
    ds_read_u16_d16_hi v128, v136 offset:32768
    ds_read_u16_d16_hi v129, v137 offset:32768
    s_waitcnt lgkmcnt(2)
    s_set_gpr_idx_on s62, 0xc
    v_pk_fma_f32 v[16:17], v[132:133], v[96:97], v[16:17] op_sel:[0,0,0] op_sel_hi:[0,1,1]
    v_pk_fma_f32 v[18:19], v[132:133], v[98:99], v[18:19] op_sel:[0,0,0] op_sel_hi:[0,1,1]
    v_pk_fma_f32 v[20:21], v[134:135], v[100:101], v[20:21] op_sel:[0,0,0] op_sel_hi:[0,1,1]
    v_pk_fma_f32 v[22:23], v[134:135], v[102:103], v[22:23] op_sel:[0,0,0] op_sel_hi:[0,1,1]
    s_set_gpr_idx_off
    s_sub_u32 s32, s32, 1
    s_cbranch_scc1 MAIN_DONE
    v_lshlrev_b32_sdwa v138, v15, v116 dst_sel:DWORD dst_unused:UNUSED_PAD src0_sel:DWORD src1_sel:WORD_1
    s_waitcnt vmcnt(9)
    v_mfma_f32_4x4x4_16b_bf16 v[96:99], v[140:141], v[64:65], 0 cbsz:4 abid:4
    s_nop 0
    v_mfma_f32_4x4x4_16b_bf16 v[100:103], v[140:141], v[66:67], 0 cbsz:4 abid:4
    v_lshlrev_b32_sdwa v139, v15, v117 dst_sel:DWORD dst_unused:UNUSED_PAD src0_sel:DWORD src1_sel:WORD_1
    ds_read_u16_d16_hi v130, v138 offset:32768
    ds_read_u16_d16_hi v131, v139 offset:32768
    s_set_gpr_idx_on s63, 0xc
    v_pk_fma_f32 v[16:17], v[132:133], v[104:105], v[16:17] op_sel:[1,0,0] op_sel_hi:[1,1,1]
    v_pk_fma_f32 v[18:19], v[132:133], v[106:107], v[18:19] op_sel:[1,0,0] op_sel_hi:[1,1,1]
    v_pk_fma_f32 v[20:21], v[134:135], v[108:109], v[20:21] op_sel:[1,0,0] op_sel_hi:[1,1,1]
    v_pk_fma_f32 v[22:23], v[134:135], v[110:111], v[22:23] op_sel:[1,0,0] op_sel_hi:[1,1,1]
    s_set_gpr_idx_off
    s_sub_u32 s32, s32, 1
    s_cbranch_scc1 MAIN_DONE
    v_mfma_f32_4x4x4_16b_bf16 v[124:127], v[172:173], v[178:179], 0 cbsz:4 abid:5
    v_lshlrev_b32_sdwa v136, v15, v114 dst_sel:DWORD dst_unused:UNUSED_PAD src0_sel:DWORD src1_sel:WORD_1
    s_waitcnt vmcnt(8)
    v_mfma_f32_4x4x4_16b_bf16 v[104:107], v[142:143], v[68:69], 0 cbsz:4 abid:4
    s_nop 0
    v_mfma_f32_4x4x4_16b_bf16 v[108:111], v[142:143], v[70:71], 0 cbsz:4 abid:4
    v_lshlrev_b32_sdwa v137, v15, v115 dst_sel:DWORD dst_unused:UNUSED_PAD src0_sel:DWORD src1_sel:WORD_1
    ds_read_u16_d16_hi v132, v136 offset:32768
    ds_read_u16_d16_hi v133, v137 offset:32768
    s_waitcnt lgkmcnt(2)
    s_set_gpr_idx_on s48, 0xc
    v_pk_fma_f32 v[16:17], v[128:129], v[96:97], v[16:17] op_sel:[0,0,0] op_sel_hi:[0,1,1]
    v_pk_fma_f32 v[18:19], v[128:129], v[98:99], v[18:19] op_sel:[0,0,0] op_sel_hi:[0,1,1]
    v_pk_fma_f32 v[20:21], v[130:131], v[100:101], v[20:21] op_sel:[0,0,0] op_sel_hi:[0,1,1]
    v_pk_fma_f32 v[22:23], v[130:131], v[102:103], v[22:23] op_sel:[0,0,0] op_sel_hi:[0,1,1]
    s_set_gpr_idx_off
    s_sub_u32 s32, s32, 1
    s_cbranch_scc1 MAIN_DONE
    v_lshlrev_b32_sdwa v138, v15, v118 dst_sel:DWORD dst_unused:UNUSED_PAD src0_sel:DWORD src1_sel:WORD_1
    v_mfma_f32_4x4x4_16b_bf16 v[96:99], v[144:145], v[72:73], 0 cbsz:4 abid:4
    s_nop 0
    v_mfma_f32_4x4x4_16b_bf16 v[100:103], v[144:145], v[74:75], 0 cbsz:4 abid:4
    v_lshlrev_b32_sdwa v139, v15, v119 dst_sel:DWORD dst_unused:UNUSED_PAD src0_sel:DWORD src1_sel:WORD_1
    ds_read_u16_d16_hi v134, v138 offset:32768
    ds_read_u16_d16_hi v135, v139 offset:32768
    s_set_gpr_idx_on s49, 0xc
    v_pk_fma_f32 v[16:17], v[128:129], v[104:105], v[16:17] op_sel:[1,0,0] op_sel_hi:[1,1,1]
    v_pk_fma_f32 v[18:19], v[128:129], v[106:107], v[18:19] op_sel:[1,0,0] op_sel_hi:[1,1,1]
    v_pk_fma_f32 v[20:21], v[130:131], v[108:109], v[20:21] op_sel:[1,0,0] op_sel_hi:[1,1,1]
    v_pk_fma_f32 v[22:23], v[130:131], v[110:111], v[22:23] op_sel:[1,0,0] op_sel_hi:[1,1,1]
    s_set_gpr_idx_off
    s_branch MAIN_DONE
B_16:
    buffer_load_dwordx4 v[188:191], v1, s[16:19], s10 offen offset:0 sc1
    buffer_load_dwordx4 v[192:195], v1, s[16:19], s10 offen offset:1024 sc1
    buffer_load_dwordx4 v[196:199], v1, s[16:19], s10 offen offset:2048 sc1
    buffer_load_dwordx4 v[200:203], v1, s[16:19], s10 offen offset:3072 sc1
    buffer_load_dwordx4 v[204:207], v1, s[16:19], s11 offen offset:0 sc1
    buffer_load_dwordx4 v[208:211], v1, s[16:19], s11 offen offset:1024 sc1
    buffer_load_dwordx4 v[212:215], v1, s[16:19], s11 offen offset:2048 sc1
    buffer_load_dwordx4 v[216:219], v1, s[16:19], s11 offen offset:3072 sc1
    s_sub_u32 s32, s32, 1
    s_cbranch_scc1 MAIN_DONE
    v_mfma_f32_4x4x4_16b_bf16 v[124:127], v[172:173], v[178:179], 0 cbsz:4 abid:5
    v_lshlrev_b32_sdwa v136, v15, v114 dst_sel:DWORD dst_unused:UNUSED_PAD src0_sel:DWORD src1_sel:WORD_1
    s_waitcnt vmcnt(12)
    v_mfma_f32_4x4x4_16b_bf16 v[104:107], v[142:143], v[68:69], 0 cbsz:4 abid:4
    s_nop 0
    v_mfma_f32_4x4x4_16b_bf16 v[108:111], v[142:143], v[70:71], 0 cbsz:4 abid:4
    v_lshlrev_b32_sdwa v137, v15, v115 dst_sel:DWORD dst_unused:UNUSED_PAD src0_sel:DWORD src1_sel:WORD_1
    ds_read_u16_d16_hi v132, v136 offset:32768
    ds_read_u16_d16_hi v133, v137 offset:32768
    s_waitcnt lgkmcnt(2)
    s_set_gpr_idx_on s48, 0xc
    v_pk_fma_f32 v[16:17], v[128:129], v[96:97], v[16:17] op_sel:[0,0,0] op_sel_hi:[0,1,1]
    v_pk_fma_f32 v[18:19], v[128:129], v[98:99], v[18:19] op_sel:[0,0,0] op_sel_hi:[0,1,1]
    v_pk_fma_f32 v[20:21], v[130:131], v[100:101], v[20:21] op_sel:[0,0,0] op_sel_hi:[0,1,1]
    v_pk_fma_f32 v[22:23], v[130:131], v[102:103], v[22:23] op_sel:[0,0,0] op_sel_hi:[0,1,1]
    s_set_gpr_idx_off
    s_sub_u32 s32, s32, 1
    s_cbranch_scc1 MAIN_DONE
    v_lshlrev_b32_sdwa v138, v15, v118 dst_sel:DWORD dst_unused:UNUSED_PAD src0_sel:DWORD src1_sel:WORD_1
    s_waitcnt vmcnt(11)
    v_mfma_f32_4x4x4_16b_bf16 v[96:99], v[144:145], v[72:73], 0 cbsz:4 abid:4
    s_nop 0
    v_mfma_f32_4x4x4_16b_bf16 v[100:103], v[144:145], v[74:75], 0 cbsz:4 abid:4
    v_lshlrev_b32_sdwa v139, v15, v119 dst_sel:DWORD dst_unused:UNUSED_PAD src0_sel:DWORD src1_sel:WORD_1
    ds_read_u16_d16_hi v134, v138 offset:32768
    ds_read_u16_d16_hi v135, v139 offset:32768
    s_set_gpr_idx_on s49, 0xc
    v_pk_fma_f32 v[16:17], v[128:129], v[104:105], v[16:17] op_sel:[1,0,0] op_sel_hi:[1,1,1]
    v_pk_fma_f32 v[18:19], v[128:129], v[106:107], v[18:19] op_sel:[1,0,0] op_sel_hi:[1,1,1]
    v_pk_fma_f32 v[20:21], v[130:131], v[108:109], v[20:21] op_sel:[1,0,0] op_sel_hi:[1,1,1]
    v_pk_fma_f32 v[22:23], v[130:131], v[110:111], v[22:23] op_sel:[1,0,0] op_sel_hi:[1,1,1]
    s_set_gpr_idx_off
    s_sub_u32 s32, s32, 1
    s_cbranch_scc1 MAIN_DONE
    v_mfma_f32_4x4x4_16b_bf16 v[112:115], v[172:173], v[176:177], 0 cbsz:4 abid:6
    v_lshlrev_b32_sdwa v136, v15, v120 dst_sel:DWORD dst_unused:UNUSED_PAD src0_sel:DWORD src1_sel:WORD_1
    s_waitcnt vmcnt(10)
    v_mfma_f32_4x4x4_16b_bf16 v[104:107], v[146:147], v[76:77], 0 cbsz:4 abid:4
    s_nop 0
    v_mfma_f32_4x4x4_16b_bf16 v[108:111], v[146:147], v[78:79], 0 cbsz:4 abid:4
    v_lshlrev_b32_sdwa v137, v15, v121 dst_sel:DWORD dst_unused:UNUSED_PAD src0_sel:DWORD src1_sel:WORD_1
    ds_read_u16_d16_hi v128, v136 offset:32768
    ds_read_u16_d16_hi v129, v137 offset:32768
    s_waitcnt lgkmcnt(2)
    s_set_gpr_idx_on s50, 0xc
    v_pk_fma_f32 v[16:17], v[132:133], v[96:97], v[16:17] op_sel:[0,0,0] op_sel_hi:[0,1,1]
    v_pk_fma_f32 v[18:19], v[132:133], v[98:99], v[18:19] op_sel:[0,0,0] op_sel_hi:[0,1,1]
    v_pk_fma_f32 v[20:21], v[134:135], v[100:101], v[20:21] op_sel:[0,0,0] op_sel_hi:[0,1,1]
    v_pk_fma_f32 v[22:23], v[134:135], v[102:103], v[22:23] op_sel:[0,0,0] op_sel_hi:[0,1,1]
    s_set_gpr_idx_off
    s_sub_u32 s32, s32, 1
    s_cbranch_scc1 MAIN_DONE
    v_lshlrev_b32_sdwa v138, v15, v124 dst_sel:DWORD dst_unused:UNUSED_PAD src0_sel:DWORD src1_sel:WORD_1
    s_waitcnt vmcnt(9)
    v_mfma_f32_4x4x4_16b_bf16 v[96:99], v[140:141], v[80:81], 0 cbsz:4 abid:5
    s_nop 0
    v_mfma_f32_4x4x4_16b_bf16 v[100:103], v[140:141], v[82:83], 0 cbsz:4 abid:5
    v_lshlrev_b32_sdwa v139, v15, v125 dst_sel:DWORD dst_unused:UNUSED_PAD src0_sel:DWORD src1_sel:WORD_1
    ds_read_u16_d16_hi v130, v138 offset:32768
    ds_read_u16_d16_hi v131, v139 offset:32768
    s_set_gpr_idx_on s51, 0xc
    v_pk_fma_f32 v[16:17], v[132:133], v[104:105], v[16:17] op_sel:[1,0,0] op_sel_hi:[1,1,1]
    v_pk_fma_f32 v[18:19], v[132:133], v[106:107], v[18:19] op_sel:[1,0,0] op_sel_hi:[1,1,1]
    v_pk_fma_f32 v[20:21], v[134:135], v[108:109], v[20:21] op_sel:[1,0,0] op_sel_hi:[1,1,1]
    v_pk_fma_f32 v[22:23], v[134:135], v[110:111], v[22:23] op_sel:[1,0,0] op_sel_hi:[1,1,1]
    s_set_gpr_idx_off
    s_sub_u32 s32, s32, 1
    s_cbranch_scc1 MAIN_DONE
    v_mfma_f32_4x4x4_16b_bf16 v[116:119], v[172:173], v[178:179], 0 cbsz:4 abid:6
    v_lshlrev_b32_sdwa v136, v15, v122 dst_sel:DWORD dst_unused:UNUSED_PAD src0_sel:DWORD src1_sel:WORD_1
    s_waitcnt vmcnt(8)
    v_mfma_f32_4x4x4_16b_bf16 v[104:107], v[142:143], v[84:85], 0 cbsz:4 abid:5
    s_nop 0
    v_mfma_f32_4x4x4_16b_bf16 v[108:111], v[142:143], v[86:87], 0 cbsz:4 abid:5
    v_lshlrev_b32_sdwa v137, v15, v123 dst_sel:DWORD dst_unused:UNUSED_PAD src0_sel:DWORD src1_sel:WORD_1
    ds_read_u16_d16_hi v132, v136 offset:32768
    ds_read_u16_d16_hi v133, v137 offset:32768
    s_waitcnt lgkmcnt(2)
    s_set_gpr_idx_on s52, 0xc
    v_pk_fma_f32 v[16:17], v[128:129], v[96:97], v[16:17] op_sel:[0,0,0] op_sel_hi:[0,1,1]
    v_pk_fma_f32 v[18:19], v[128:129], v[98:99], v[18:19] op_sel:[0,0,0] op_sel_hi:[0,1,1]
    v_pk_fma_f32 v[20:21], v[130:131], v[100:101], v[20:21] op_sel:[0,0,0] op_sel_hi:[0,1,1]
    v_pk_fma_f32 v[22:23], v[130:131], v[102:103], v[22:23] op_sel:[0,0,0] op_sel_hi:[0,1,1]
    s_set_gpr_idx_off
    s_sub_u32 s32, s32, 1
    s_cbranch_scc1 MAIN_DONE
    v_lshlrev_b32_sdwa v138, v15, v126 dst_sel:DWORD dst_unused:UNUSED_PAD src0_sel:DWORD src1_sel:WORD_1
    v_mfma_f32_4x4x4_16b_bf16 v[96:99], v[144:145], v[88:89], 0 cbsz:4 abid:5
    s_nop 0
    v_mfma_f32_4x4x4_16b_bf16 v[100:103], v[144:145], v[90:91], 0 cbsz:4 abid:5
    v_lshlrev_b32_sdwa v139, v15, v127 dst_sel:DWORD dst_unused:UNUSED_PAD src0_sel:DWORD src1_sel:WORD_1
    ds_read_u16_d16_hi v134, v138 offset:32768
    ds_read_u16_d16_hi v135, v139 offset:32768
    s_set_gpr_idx_on s53, 0xc
    v_pk_fma_f32 v[16:17], v[128:129], v[104:105], v[16:17] op_sel:[1,0,0] op_sel_hi:[1,1,1]
    v_pk_fma_f32 v[18:19], v[128:129], v[106:107], v[18:19] op_sel:[1,0,0] op_sel_hi:[1,1,1]
    v_pk_fma_f32 v[20:21], v[130:131], v[108:109], v[20:21] op_sel:[1,0,0] op_sel_hi:[1,1,1]
    v_pk_fma_f32 v[22:23], v[130:131], v[110:111], v[22:23] op_sel:[1,0,0] op_sel_hi:[1,1,1]
    s_set_gpr_idx_off
    s_branch MAIN_DONE
B_20:
    buffer_load_dwordx4 v[188:191], v1, s[16:19], s10 offen offset:0 sc1
    buffer_load_dwordx4 v[192:195], v1, s[16:19], s10 offen offset:1024 sc1
    buffer_load_dwordx4 v[196:199], v1, s[16:19], s10 offen offset:2048 sc1
    buffer_load_dwordx4 v[200:203], v1, s[16:19], s10 offen offset:3072 sc1
    buffer_load_dwordx4 v[204:207], v1, s[16:19], s11 offen offset:0 sc1
    buffer_load_dwordx4 v[208:211], v1, s[16:19], s11 offen offset:1024 sc1
    buffer_load_dwordx4 v[212:215], v1, s[16:19], s11 offen offset:2048 sc1
    buffer_load_dwordx4 v[216:219], v1, s[16:19], s11 offen offset:3072 sc1
    s_sub_u32 s32, s32, 1
    s_cbranch_scc1 MAIN_DONE
    v_mfma_f32_4x4x4_16b_bf16 v[116:119], v[172:173], v[178:179], 0 cbsz:4 abid:6
    v_lshlrev_b32_sdwa v136, v15, v122 dst_sel:DWORD dst_unused:UNUSED_PAD src0_sel:DWORD src1_sel:WORD_1
    s_waitcnt vmcnt(12)
    v_mfma_f32_4x4x4_16b_bf16 v[104:107], v[142:143], v[84:85], 0 cbsz:4 abid:5
    s_nop 0
    v_mfma_f32_4x4x4_16b_bf16 v[108:111], v[142:143], v[86:87], 0 cbsz:4 abid:5
    v_lshlrev_b32_sdwa v137, v15, v123 dst_sel:DWORD dst_unused:UNUSED_PAD src0_sel:DWORD src1_sel:WORD_1
    ds_read_u16_d16_hi v132, v136 offset:32768
    ds_read_u16_d16_hi v133, v137 offset:32768
    s_waitcnt lgkmcnt(2)
    s_set_gpr_idx_on s52, 0xc
    v_pk_fma_f32 v[16:17], v[128:129], v[96:97], v[16:17] op_sel:[0,0,0] op_sel_hi:[0,1,1]
    v_pk_fma_f32 v[18:19], v[128:129], v[98:99], v[18:19] op_sel:[0,0,0] op_sel_hi:[0,1,1]
    v_pk_fma_f32 v[20:21], v[130:131], v[100:101], v[20:21] op_sel:[0,0,0] op_sel_hi:[0,1,1]
    v_pk_fma_f32 v[22:23], v[130:131], v[102:103], v[22:23] op_sel:[0,0,0] op_sel_hi:[0,1,1]
    s_set_gpr_idx_off
    s_sub_u32 s32, s32, 1
    s_cbranch_scc1 MAIN_DONE
    v_lshlrev_b32_sdwa v138, v15, v126 dst_sel:DWORD dst_unused:UNUSED_PAD src0_sel:DWORD src1_sel:WORD_1
    s_waitcnt vmcnt(11)
    v_mfma_f32_4x4x4_16b_bf16 v[96:99], v[144:145], v[88:89], 0 cbsz:4 abid:5
    s_nop 0
    v_mfma_f32_4x4x4_16b_bf16 v[100:103], v[144:145], v[90:91], 0 cbsz:4 abid:5
    v_lshlrev_b32_sdwa v139, v15, v127 dst_sel:DWORD dst_unused:UNUSED_PAD src0_sel:DWORD src1_sel:WORD_1
    ds_read_u16_d16_hi v134, v138 offset:32768
    ds_read_u16_d16_hi v135, v139 offset:32768
    s_set_gpr_idx_on s53, 0xc
    v_pk_fma_f32 v[16:17], v[128:129], v[104:105], v[16:17] op_sel:[1,0,0] op_sel_hi:[1,1,1]
    v_pk_fma_f32 v[18:19], v[128:129], v[106:107], v[18:19] op_sel:[1,0,0] op_sel_hi:[1,1,1]
    v_pk_fma_f32 v[20:21], v[130:131], v[108:109], v[20:21] op_sel:[1,0,0] op_sel_hi:[1,1,1]
    v_pk_fma_f32 v[22:23], v[130:131], v[110:111], v[22:23] op_sel:[1,0,0] op_sel_hi:[1,1,1]
    s_set_gpr_idx_off
    s_sub_u32 s32, s32, 1
    s_cbranch_scc1 MAIN_DONE
    v_mfma_f32_4x4x4_16b_bf16 v[120:123], v[172:173], v[176:177], 0 cbsz:4 abid:7
    v_lshlrev_b32_sdwa v136, v15, v112 dst_sel:DWORD dst_unused:UNUSED_PAD src0_sel:DWORD src1_sel:WORD_1
    s_waitcnt vmcnt(10)
    v_mfma_f32_4x4x4_16b_bf16 v[104:107], v[146:147], v[92:93], 0 cbsz:4 abid:5
    s_nop 0
    v_mfma_f32_4x4x4_16b_bf16 v[108:111], v[146:147], v[94:95], 0 cbsz:4 abid:5
    v_lshlrev_b32_sdwa v137, v15, v113 dst_sel:DWORD dst_unused:UNUSED_PAD src0_sel:DWORD src1_sel:WORD_1
    ds_read_u16_d16_hi v128, v136 offset:32768
    ds_read_u16_d16_hi v129, v137 offset:32768
    s_waitcnt lgkmcnt(2)
    s_set_gpr_idx_on s54, 0xc
    v_pk_fma_f32 v[16:17], v[132:133], v[96:97], v[16:17] op_sel:[0,0,0] op_sel_hi:[0,1,1]
    v_pk_fma_f32 v[18:19], v[132:133], v[98:99], v[18:19] op_sel:[0,0,0] op_sel_hi:[0,1,1]
    v_pk_fma_f32 v[20:21], v[134:135], v[100:101], v[20:21] op_sel:[0,0,0] op_sel_hi:[0,1,1]
    v_pk_fma_f32 v[22:23], v[134:135], v[102:103], v[22:23] op_sel:[0,0,0] op_sel_hi:[0,1,1]
    s_set_gpr_idx_off
    s_sub_u32 s32, s32, 1
    s_cbranch_scc1 MAIN_DONE
    v_lshlrev_b32_sdwa v138, v15, v116 dst_sel:DWORD dst_unused:UNUSED_PAD src0_sel:DWORD src1_sel:WORD_1
    s_waitcnt vmcnt(9)
    v_mfma_f32_4x4x4_16b_bf16 v[96:99], v[140:141], v[64:65], 0 cbsz:4 abid:6
    s_nop 0
    v_mfma_f32_4x4x4_16b_bf16 v[100:103], v[140:141], v[66:67], 0 cbsz:4 abid:6
    v_lshlrev_b32_sdwa v139, v15, v117 dst_sel:DWORD dst_unused:UNUSED_PAD src0_sel:DWORD src1_sel:WORD_1
    ds_read_u16_d16_hi v130, v138 offset:32768
    ds_read_u16_d16_hi v131, v139 offset:32768
    s_set_gpr_idx_on s55, 0xc
    v_pk_fma_f32 v[16:17], v[132:133], v[104:105], v[16:17] op_sel:[1,0,0] op_sel_hi:[1,1,1]
    v_pk_fma_f32 v[18:19], v[132:133], v[106:107], v[18:19] op_sel:[1,0,0] op_sel_hi:[1,1,1]
    v_pk_fma_f32 v[20:21], v[134:135], v[108:109], v[20:21] op_sel:[1,0,0] op_sel_hi:[1,1,1]
    v_pk_fma_f32 v[22:23], v[134:135], v[110:111], v[22:23] op_sel:[1,0,0] op_sel_hi:[1,1,1]
    s_set_gpr_idx_off
    s_sub_u32 s32, s32, 1
    s_cbranch_scc1 MAIN_DONE
    v_mfma_f32_4x4x4_16b_bf16 v[124:127], v[172:173], v[178:179], 0 cbsz:4 abid:7
    v_lshlrev_b32_sdwa v136, v15, v114 dst_sel:DWORD dst_unused:UNUSED_PAD src0_sel:DWORD src1_sel:WORD_1
    s_waitcnt vmcnt(8)
    v_mfma_f32_4x4x4_16b_bf16 v[104:107], v[142:143], v[68:69], 0 cbsz:4 abid:6
    s_nop 0
    v_mfma_f32_4x4x4_16b_bf16 v[108:111], v[142:143], v[70:71], 0 cbsz:4 abid:6
    v_lshlrev_b32_sdwa v137, v15, v115 dst_sel:DWORD dst_unused:UNUSED_PAD src0_sel:DWORD src1_sel:WORD_1
    ds_read_u16_d16_hi v132, v136 offset:32768
    ds_read_u16_d16_hi v133, v137 offset:32768
    s_waitcnt lgkmcnt(2)
    s_set_gpr_idx_on s56, 0xc
    v_pk_fma_f32 v[16:17], v[128:129], v[96:97], v[16:17] op_sel:[0,0,0] op_sel_hi:[0,1,1]
    v_pk_fma_f32 v[18:19], v[128:129], v[98:99], v[18:19] op_sel:[0,0,0] op_sel_hi:[0,1,1]
    v_pk_fma_f32 v[20:21], v[130:131], v[100:101], v[20:21] op_sel:[0,0,0] op_sel_hi:[0,1,1]
    v_pk_fma_f32 v[22:23], v[130:131], v[102:103], v[22:23] op_sel:[0,0,0] op_sel_hi:[0,1,1]
    s_set_gpr_idx_off
    s_sub_u32 s32, s32, 1
    s_cbranch_scc1 MAIN_DONE
    v_lshlrev_b32_sdwa v138, v15, v118 dst_sel:DWORD dst_unused:UNUSED_PAD src0_sel:DWORD src1_sel:WORD_1
    v_mfma_f32_4x4x4_16b_bf16 v[96:99], v[144:145], v[72:73], 0 cbsz:4 abid:6
    s_nop 0
    v_mfma_f32_4x4x4_16b_bf16 v[100:103], v[144:145], v[74:75], 0 cbsz:4 abid:6
    v_lshlrev_b32_sdwa v139, v15, v119 dst_sel:DWORD dst_unused:UNUSED_PAD src0_sel:DWORD src1_sel:WORD_1
    ds_read_u16_d16_hi v134, v138 offset:32768
    ds_read_u16_d16_hi v135, v139 offset:32768
    s_set_gpr_idx_on s57, 0xc
    v_pk_fma_f32 v[16:17], v[128:129], v[104:105], v[16:17] op_sel:[1,0,0] op_sel_hi:[1,1,1]
    v_pk_fma_f32 v[18:19], v[128:129], v[106:107], v[18:19] op_sel:[1,0,0] op_sel_hi:[1,1,1]
    v_pk_fma_f32 v[20:21], v[130:131], v[108:109], v[20:21] op_sel:[1,0,0] op_sel_hi:[1,1,1]
    v_pk_fma_f32 v[22:23], v[130:131], v[110:111], v[22:23] op_sel:[1,0,0] op_sel_hi:[1,1,1]
    s_set_gpr_idx_off
    s_branch MAIN_DONE
B_24:
    buffer_load_dwordx4 v[188:191], v1, s[16:19], s10 offen offset:0 sc1
    buffer_load_dwordx4 v[192:195], v1, s[16:19], s10 offen offset:1024 sc1
    buffer_load_dwordx4 v[196:199], v1, s[16:19], s10 offen offset:2048 sc1
    buffer_load_dwordx4 v[200:203], v1, s[16:19], s10 offen offset:3072 sc1
    buffer_load_dwordx4 v[204:207], v1, s[16:19], s11 offen offset:0 sc1
    buffer_load_dwordx4 v[208:211], v1, s[16:19], s11 offen offset:1024 sc1
    buffer_load_dwordx4 v[212:215], v1, s[16:19], s11 offen offset:2048 sc1
    buffer_load_dwordx4 v[216:219], v1, s[16:19], s11 offen offset:3072 sc1
    s_sub_u32 s32, s32, 1
    s_cbranch_scc1 MAIN_DONE
    v_mfma_f32_4x4x4_16b_bf16 v[124:127], v[172:173], v[178:179], 0 cbsz:4 abid:7
    v_lshlrev_b32_sdwa v136, v15, v114 dst_sel:DWORD dst_unused:UNUSED_PAD src0_sel:DWORD src1_sel:WORD_1
    s_waitcnt vmcnt(12)
    v_mfma_f32_4x4x4_16b_bf16 v[104:107], v[142:143], v[68:69], 0 cbsz:4 abid:6
    s_nop 0
    v_mfma_f32_4x4x4_16b_bf16 v[108:111], v[142:143], v[70:71], 0 cbsz:4 abid:6
    v_lshlrev_b32_sdwa v137, v15, v115 dst_sel:DWORD dst_unused:UNUSED_PAD src0_sel:DWORD src1_sel:WORD_1
    ds_read_u16_d16_hi v132, v136 offset:32768
    ds_read_u16_d16_hi v133, v137 offset:32768
    s_waitcnt lgkmcnt(2)
    s_set_gpr_idx_on s56, 0xc
    v_pk_fma_f32 v[16:17], v[128:129], v[96:97], v[16:17] op_sel:[0,0,0] op_sel_hi:[0,1,1]
    v_pk_fma_f32 v[18:19], v[128:129], v[98:99], v[18:19] op_sel:[0,0,0] op_sel_hi:[0,1,1]
    v_pk_fma_f32 v[20:21], v[130:131], v[100:101], v[20:21] op_sel:[0,0,0] op_sel_hi:[0,1,1]
    v_pk_fma_f32 v[22:23], v[130:131], v[102:103], v[22:23] op_sel:[0,0,0] op_sel_hi:[0,1,1]
    s_set_gpr_idx_off
    s_sub_u32 s32, s32, 1
    s_cbranch_scc1 MAIN_DONE
    v_lshlrev_b32_sdwa v138, v15, v118 dst_sel:DWORD dst_unused:UNUSED_PAD src0_sel:DWORD src1_sel:WORD_1
    s_waitcnt vmcnt(11)
    v_mfma_f32_4x4x4_16b_bf16 v[96:99], v[144:145], v[72:73], 0 cbsz:4 abid:6
    s_nop 0
    v_mfma_f32_4x4x4_16b_bf16 v[100:103], v[144:145], v[74:75], 0 cbsz:4 abid:6
    v_lshlrev_b32_sdwa v139, v15, v119 dst_sel:DWORD dst_unused:UNUSED_PAD src0_sel:DWORD src1_sel:WORD_1
    ds_read_u16_d16_hi v134, v138 offset:32768
    ds_read_u16_d16_hi v135, v139 offset:32768
    s_set_gpr_idx_on s57, 0xc
    v_pk_fma_f32 v[16:17], v[128:129], v[104:105], v[16:17] op_sel:[1,0,0] op_sel_hi:[1,1,1]
    v_pk_fma_f32 v[18:19], v[128:129], v[106:107], v[18:19] op_sel:[1,0,0] op_sel_hi:[1,1,1]
    v_pk_fma_f32 v[20:21], v[130:131], v[108:109], v[20:21] op_sel:[1,0,0] op_sel_hi:[1,1,1]
    v_pk_fma_f32 v[22:23], v[130:131], v[110:111], v[22:23] op_sel:[1,0,0] op_sel_hi:[1,1,1]
    s_set_gpr_idx_off
    s_sub_u32 s32, s32, 1
    s_cbranch_scc1 MAIN_DONE
    v_mfma_f32_4x4x4_16b_bf16 v[112:115], v[172:173], v[176:177], 0 cbsz:4 abid:8
    v_lshlrev_b32_sdwa v136, v15, v120 dst_sel:DWORD dst_unused:UNUSED_PAD src0_sel:DWORD src1_sel:WORD_1
    s_waitcnt vmcnt(10)
    v_mfma_f32_4x4x4_16b_bf16 v[104:107], v[146:147], v[76:77], 0 cbsz:4 abid:6
    s_nop 0
    v_mfma_f32_4x4x4_16b_bf16 v[108:111], v[146:147], v[78:79], 0 cbsz:4 abid:6
    v_lshlrev_b32_sdwa v137, v15, v121 dst_sel:DWORD dst_unused:UNUSED_PAD src0_sel:DWORD src1_sel:WORD_1
    ds_read_u16_d16_hi v128, v136 offset:32768
    ds_read_u16_d16_hi v129, v137 offset:32768
    s_waitcnt lgkmcnt(2)
    s_set_gpr_idx_on s58, 0xc
    v_pk_fma_f32 v[16:17], v[132:133], v[96:97], v[16:17] op_sel:[0,0,0] op_sel_hi:[0,1,1]
    v_pk_fma_f32 v[18:19], v[132:133], v[98:99], v[18:19] op_sel:[0,0,0] op_sel_hi:[0,1,1]
    v_pk_fma_f32 v[20:21], v[134:135], v[100:101], v[20:21] op_sel:[0,0,0] op_sel_hi:[0,1,1]
    v_pk_fma_f32 v[22:23], v[134:135], v[102:103], v[22:23] op_sel:[0,0,0] op_sel_hi:[0,1,1]
    s_set_gpr_idx_off
    s_sub_u32 s32, s32, 1
    s_cbranch_scc1 MAIN_DONE
    v_lshlrev_b32_sdwa v138, v15, v124 dst_sel:DWORD dst_unused:UNUSED_PAD src0_sel:DWORD src1_sel:WORD_1
    s_waitcnt vmcnt(9)
    v_mfma_f32_4x4x4_16b_bf16 v[96:99], v[140:141], v[80:81], 0 cbsz:4 abid:7
    s_nop 0
    v_mfma_f32_4x4x4_16b_bf16 v[100:103], v[140:141], v[82:83], 0 cbsz:4 abid:7
    v_lshlrev_b32_sdwa v139, v15, v125 dst_sel:DWORD dst_unused:UNUSED_PAD src0_sel:DWORD src1_sel:WORD_1
    ds_read_u16_d16_hi v130, v138 offset:32768
    ds_read_u16_d16_hi v131, v139 offset:32768
    s_set_gpr_idx_on s59, 0xc
    v_pk_fma_f32 v[16:17], v[132:133], v[104:105], v[16:17] op_sel:[1,0,0] op_sel_hi:[1,1,1]
    v_pk_fma_f32 v[18:19], v[132:133], v[106:107], v[18:19] op_sel:[1,0,0] op_sel_hi:[1,1,1]
    v_pk_fma_f32 v[20:21], v[134:135], v[108:109], v[20:21] op_sel:[1,0,0] op_sel_hi:[1,1,1]
    v_pk_fma_f32 v[22:23], v[134:135], v[110:111], v[22:23] op_sel:[1,0,0] op_sel_hi:[1,1,1]
    s_set_gpr_idx_off
    s_sub_u32 s32, s32, 1
    s_cbranch_scc1 MAIN_DONE
    v_mfma_f32_4x4x4_16b_bf16 v[116:119], v[172:173], v[178:179], 0 cbsz:4 abid:8
    v_lshlrev_b32_sdwa v136, v15, v122 dst_sel:DWORD dst_unused:UNUSED_PAD src0_sel:DWORD src1_sel:WORD_1
    s_waitcnt vmcnt(8)
    v_mfma_f32_4x4x4_16b_bf16 v[104:107], v[142:143], v[84:85], 0 cbsz:4 abid:7
    s_nop 0
    v_mfma_f32_4x4x4_16b_bf16 v[108:111], v[142:143], v[86:87], 0 cbsz:4 abid:7
    v_lshlrev_b32_sdwa v137, v15, v123 dst_sel:DWORD dst_unused:UNUSED_PAD src0_sel:DWORD src1_sel:WORD_1
    ds_read_u16_d16_hi v132, v136 offset:32768
    ds_read_u16_d16_hi v133, v137 offset:32768
    s_waitcnt lgkmcnt(2)
    s_set_gpr_idx_on s60, 0xc
    v_pk_fma_f32 v[16:17], v[128:129], v[96:97], v[16:17] op_sel:[0,0,0] op_sel_hi:[0,1,1]
    v_pk_fma_f32 v[18:19], v[128:129], v[98:99], v[18:19] op_sel:[0,0,0] op_sel_hi:[0,1,1]
    v_pk_fma_f32 v[20:21], v[130:131], v[100:101], v[20:21] op_sel:[0,0,0] op_sel_hi:[0,1,1]
    v_pk_fma_f32 v[22:23], v[130:131], v[102:103], v[22:23] op_sel:[0,0,0] op_sel_hi:[0,1,1]
    s_set_gpr_idx_off
    s_sub_u32 s32, s32, 1
    s_cbranch_scc1 MAIN_DONE
    v_lshlrev_b32_sdwa v138, v15, v126 dst_sel:DWORD dst_unused:UNUSED_PAD src0_sel:DWORD src1_sel:WORD_1
    v_mfma_f32_4x4x4_16b_bf16 v[96:99], v[144:145], v[88:89], 0 cbsz:4 abid:7
    s_nop 0
    v_mfma_f32_4x4x4_16b_bf16 v[100:103], v[144:145], v[90:91], 0 cbsz:4 abid:7
    v_lshlrev_b32_sdwa v139, v15, v127 dst_sel:DWORD dst_unused:UNUSED_PAD src0_sel:DWORD src1_sel:WORD_1
    ds_read_u16_d16_hi v134, v138 offset:32768
    ds_read_u16_d16_hi v135, v139 offset:32768
    s_set_gpr_idx_on s61, 0xc
    v_pk_fma_f32 v[16:17], v[128:129], v[104:105], v[16:17] op_sel:[1,0,0] op_sel_hi:[1,1,1]
    v_pk_fma_f32 v[18:19], v[128:129], v[106:107], v[18:19] op_sel:[1,0,0] op_sel_hi:[1,1,1]
    v_pk_fma_f32 v[20:21], v[130:131], v[108:109], v[20:21] op_sel:[1,0,0] op_sel_hi:[1,1,1]
    v_pk_fma_f32 v[22:23], v[130:131], v[110:111], v[22:23] op_sel:[1,0,0] op_sel_hi:[1,1,1]
    s_set_gpr_idx_off
    s_branch MAIN_DONE
B_28:
    buffer_load_dwordx4 v[188:191], v1, s[16:19], s10 offen offset:0 sc1
    buffer_load_dwordx4 v[192:195], v1, s[16:19], s10 offen offset:1024 sc1
    buffer_load_dwordx4 v[196:199], v1, s[16:19], s10 offen offset:2048 sc1
    buffer_load_dwordx4 v[200:203], v1, s[16:19], s10 offen offset:3072 sc1
    buffer_load_dwordx4 v[204:207], v1, s[16:19], s11 offen offset:0 sc1
    buffer_load_dwordx4 v[208:211], v1, s[16:19], s11 offen offset:1024 sc1
    buffer_load_dwordx4 v[212:215], v1, s[16:19], s11 offen offset:2048 sc1
    buffer_load_dwordx4 v[216:219], v1, s[16:19], s11 offen offset:3072 sc1
    s_sub_u32 s32, s32, 1
    s_cbranch_scc1 MAIN_DONE
    v_mfma_f32_4x4x4_16b_bf16 v[116:119], v[172:173], v[178:179], 0 cbsz:4 abid:8
    v_lshlrev_b32_sdwa v136, v15, v122 dst_sel:DWORD dst_unused:UNUSED_PAD src0_sel:DWORD src1_sel:WORD_1
    s_waitcnt vmcnt(12)
    v_mfma_f32_4x4x4_16b_bf16 v[104:107], v[142:143], v[84:85], 0 cbsz:4 abid:7
    s_nop 0
    v_mfma_f32_4x4x4_16b_bf16 v[108:111], v[142:143], v[86:87], 0 cbsz:4 abid:7
    v_lshlrev_b32_sdwa v137, v15, v123 dst_sel:DWORD dst_unused:UNUSED_PAD src0_sel:DWORD src1_sel:WORD_1
    ds_read_u16_d16_hi v132, v136 offset:32768
    ds_read_u16_d16_hi v133, v137 offset:32768
    s_waitcnt lgkmcnt(2)
    s_set_gpr_idx_on s60, 0xc
    v_pk_fma_f32 v[16:17], v[128:129], v[96:97], v[16:17] op_sel:[0,0,0] op_sel_hi:[0,1,1]
    v_pk_fma_f32 v[18:19], v[128:129], v[98:99], v[18:19] op_sel:[0,0,0] op_sel_hi:[0,1,1]
    v_pk_fma_f32 v[20:21], v[130:131], v[100:101], v[20:21] op_sel:[0,0,0] op_sel_hi:[0,1,1]
    v_pk_fma_f32 v[22:23], v[130:131], v[102:103], v[22:23] op_sel:[0,0,0] op_sel_hi:[0,1,1]
    s_set_gpr_idx_off
    s_sub_u32 s32, s32, 1
    s_cbranch_scc1 MAIN_DONE
    v_lshlrev_b32_sdwa v138, v15, v126 dst_sel:DWORD dst_unused:UNUSED_PAD src0_sel:DWORD src1_sel:WORD_1
    s_waitcnt vmcnt(11)
    v_mfma_f32_4x4x4_16b_bf16 v[96:99], v[144:145], v[88:89], 0 cbsz:4 abid:7
    s_nop 0
    v_mfma_f32_4x4x4_16b_bf16 v[100:103], v[144:145], v[90:91], 0 cbsz:4 abid:7
    v_lshlrev_b32_sdwa v139, v15, v127 dst_sel:DWORD dst_unused:UNUSED_PAD src0_sel:DWORD src1_sel:WORD_1
    ds_read_u16_d16_hi v134, v138 offset:32768
    ds_read_u16_d16_hi v135, v139 offset:32768
    s_set_gpr_idx_on s61, 0xc
    v_pk_fma_f32 v[16:17], v[128:129], v[104:105], v[16:17] op_sel:[1,0,0] op_sel_hi:[1,1,1]
    v_pk_fma_f32 v[18:19], v[128:129], v[106:107], v[18:19] op_sel:[1,0,0] op_sel_hi:[1,1,1]
    v_pk_fma_f32 v[20:21], v[130:131], v[108:109], v[20:21] op_sel:[1,0,0] op_sel_hi:[1,1,1]
    v_pk_fma_f32 v[22:23], v[130:131], v[110:111], v[22:23] op_sel:[1,0,0] op_sel_hi:[1,1,1]
    s_set_gpr_idx_off
    s_sub_u32 s32, s32, 1
    s_cbranch_scc1 MAIN_DONE
    v_mfma_f32_4x4x4_16b_bf16 v[120:123], v[172:173], v[176:177], 0 cbsz:4 abid:9
    v_lshlrev_b32_sdwa v136, v15, v112 dst_sel:DWORD dst_unused:UNUSED_PAD src0_sel:DWORD src1_sel:WORD_1
    s_waitcnt vmcnt(10)
    v_mfma_f32_4x4x4_16b_bf16 v[104:107], v[146:147], v[92:93], 0 cbsz:4 abid:7
    s_nop 0
    v_mfma_f32_4x4x4_16b_bf16 v[108:111], v[146:147], v[94:95], 0 cbsz:4 abid:7
    v_lshlrev_b32_sdwa v137, v15, v113 dst_sel:DWORD dst_unused:UNUSED_PAD src0_sel:DWORD src1_sel:WORD_1
    ds_read_u16_d16_hi v128, v136 offset:32768
    ds_read_u16_d16_hi v129, v137 offset:32768
    s_waitcnt lgkmcnt(2)
    s_set_gpr_idx_on s62, 0xc
    v_pk_fma_f32 v[16:17], v[132:133], v[96:97], v[16:17] op_sel:[0,0,0] op_sel_hi:[0,1,1]
    v_pk_fma_f32 v[18:19], v[132:133], v[98:99], v[18:19] op_sel:[0,0,0] op_sel_hi:[0,1,1]
    v_pk_fma_f32 v[20:21], v[134:135], v[100:101], v[20:21] op_sel:[0,0,0] op_sel_hi:[0,1,1]
    v_pk_fma_f32 v[22:23], v[134:135], v[102:103], v[22:23] op_sel:[0,0,0] op_sel_hi:[0,1,1]
    s_set_gpr_idx_off
    s_sub_u32 s32, s32, 1
    s_cbranch_scc1 MAIN_DONE
    v_lshlrev_b32_sdwa v138, v15, v116 dst_sel:DWORD dst_unused:UNUSED_PAD src0_sel:DWORD src1_sel:WORD_1
    s_waitcnt vmcnt(9)
    v_mfma_f32_4x4x4_16b_bf16 v[96:99], v[140:141], v[64:65], 0 cbsz:4 abid:8
    s_nop 0
    v_mfma_f32_4x4x4_16b_bf16 v[100:103], v[140:141], v[66:67], 0 cbsz:4 abid:8
    v_lshlrev_b32_sdwa v139, v15, v117 dst_sel:DWORD dst_unused:UNUSED_PAD src0_sel:DWORD src1_sel:WORD_1
    ds_read_u16_d16_hi v130, v138 offset:32768
    ds_read_u16_d16_hi v131, v139 offset:32768
    s_set_gpr_idx_on s63, 0xc
    v_pk_fma_f32 v[16:17], v[132:133], v[104:105], v[16:17] op_sel:[1,0,0] op_sel_hi:[1,1,1]
    v_pk_fma_f32 v[18:19], v[132:133], v[106:107], v[18:19] op_sel:[1,0,0] op_sel_hi:[1,1,1]
    v_pk_fma_f32 v[20:21], v[134:135], v[108:109], v[20:21] op_sel:[1,0,0] op_sel_hi:[1,1,1]
    v_pk_fma_f32 v[22:23], v[134:135], v[110:111], v[22:23] op_sel:[1,0,0] op_sel_hi:[1,1,1]
    s_set_gpr_idx_off
    s_sub_u32 s32, s32, 1
    s_cbranch_scc1 MAIN_DONE
    v_mfma_f32_4x4x4_16b_bf16 v[124:127], v[172:173], v[178:179], 0 cbsz:4 abid:9
    v_lshlrev_b32_sdwa v136, v15, v114 dst_sel:DWORD dst_unused:UNUSED_PAD src0_sel:DWORD src1_sel:WORD_1
    s_waitcnt vmcnt(8)
    v_mfma_f32_4x4x4_16b_bf16 v[104:107], v[142:143], v[68:69], 0 cbsz:4 abid:8
    s_nop 0
    v_mfma_f32_4x4x4_16b_bf16 v[108:111], v[142:143], v[70:71], 0 cbsz:4 abid:8
    v_lshlrev_b32_sdwa v137, v15, v115 dst_sel:DWORD dst_unused:UNUSED_PAD src0_sel:DWORD src1_sel:WORD_1
    ds_read_u16_d16_hi v132, v136 offset:32768
    ds_read_u16_d16_hi v133, v137 offset:32768
    s_waitcnt lgkmcnt(2)
    s_set_gpr_idx_on s48, 0xc
    v_pk_fma_f32 v[16:17], v[128:129], v[96:97], v[16:17] op_sel:[0,0,0] op_sel_hi:[0,1,1]
    v_pk_fma_f32 v[18:19], v[128:129], v[98:99], v[18:19] op_sel:[0,0,0] op_sel_hi:[0,1,1]
    v_pk_fma_f32 v[20:21], v[130:131], v[100:101], v[20:21] op_sel:[0,0,0] op_sel_hi:[0,1,1]
    v_pk_fma_f32 v[22:23], v[130:131], v[102:103], v[22:23] op_sel:[0,0,0] op_sel_hi:[0,1,1]
    s_set_gpr_idx_off
    s_sub_u32 s32, s32, 1
    s_cbranch_scc1 MAIN_DONE
    v_lshlrev_b32_sdwa v138, v15, v118 dst_sel:DWORD dst_unused:UNUSED_PAD src0_sel:DWORD src1_sel:WORD_1
    v_mfma_f32_4x4x4_16b_bf16 v[96:99], v[144:145], v[72:73], 0 cbsz:4 abid:8
    s_nop 0
    v_mfma_f32_4x4x4_16b_bf16 v[100:103], v[144:145], v[74:75], 0 cbsz:4 abid:8
    v_lshlrev_b32_sdwa v139, v15, v119 dst_sel:DWORD dst_unused:UNUSED_PAD src0_sel:DWORD src1_sel:WORD_1
    ds_read_u16_d16_hi v134, v138 offset:32768
    ds_read_u16_d16_hi v135, v139 offset:32768
    s_set_gpr_idx_on s49, 0xc
    v_pk_fma_f32 v[16:17], v[128:129], v[104:105], v[16:17] op_sel:[1,0,0] op_sel_hi:[1,1,1]
    v_pk_fma_f32 v[18:19], v[128:129], v[106:107], v[18:19] op_sel:[1,0,0] op_sel_hi:[1,1,1]
    v_pk_fma_f32 v[20:21], v[130:131], v[108:109], v[20:21] op_sel:[1,0,0] op_sel_hi:[1,1,1]
    v_pk_fma_f32 v[22:23], v[130:131], v[110:111], v[22:23] op_sel:[1,0,0] op_sel_hi:[1,1,1]
    s_set_gpr_idx_off
    s_branch MAIN_DONE
B_32:
    buffer_load_dwordx4 v[188:191], v1, s[16:19], s10 offen offset:0 sc1
    buffer_load_dwordx4 v[192:195], v1, s[16:19], s10 offen offset:1024 sc1
    buffer_load_dwordx4 v[196:199], v1, s[16:19], s10 offen offset:2048 sc1
    buffer_load_dwordx4 v[200:203], v1, s[16:19], s10 offen offset:3072 sc1
    buffer_load_dwordx4 v[204:207], v1, s[16:19], s11 offen offset:0 sc1
    buffer_load_dwordx4 v[208:211], v1, s[16:19], s11 offen offset:1024 sc1
    buffer_load_dwordx4 v[212:215], v1, s[16:19], s11 offen offset:2048 sc1
    buffer_load_dwordx4 v[216:219], v1, s[16:19], s11 offen offset:3072 sc1
    s_sub_u32 s32, s32, 1
    s_cbranch_scc1 MAIN_DONE
    v_mfma_f32_4x4x4_16b_bf16 v[124:127], v[172:173], v[178:179], 0 cbsz:4 abid:9
    v_lshlrev_b32_sdwa v136, v15, v114 dst_sel:DWORD dst_unused:UNUSED_PAD src0_sel:DWORD src1_sel:WORD_1
    s_waitcnt vmcnt(12)
    v_mfma_f32_4x4x4_16b_bf16 v[104:107], v[142:143], v[68:69], 0 cbsz:4 abid:8
    s_nop 0
    v_mfma_f32_4x4x4_16b_bf16 v[108:111], v[142:143], v[70:71], 0 cbsz:4 abid:8
    v_lshlrev_b32_sdwa v137, v15, v115 dst_sel:DWORD dst_unused:UNUSED_PAD src0_sel:DWORD src1_sel:WORD_1
    ds_read_u16_d16_hi v132, v136 offset:32768
    ds_read_u16_d16_hi v133, v137 offset:32768
    s_waitcnt lgkmcnt(2)
    s_set_gpr_idx_on s48, 0xc
    v_pk_fma_f32 v[16:17], v[128:129], v[96:97], v[16:17] op_sel:[0,0,0] op_sel_hi:[0,1,1]
    v_pk_fma_f32 v[18:19], v[128:129], v[98:99], v[18:19] op_sel:[0,0,0] op_sel_hi:[0,1,1]
    v_pk_fma_f32 v[20:21], v[130:131], v[100:101], v[20:21] op_sel:[0,0,0] op_sel_hi:[0,1,1]
    v_pk_fma_f32 v[22:23], v[130:131], v[102:103], v[22:23] op_sel:[0,0,0] op_sel_hi:[0,1,1]
    s_set_gpr_idx_off
    s_sub_u32 s32, s32, 1
    s_cbranch_scc1 MAIN_DONE
    v_lshlrev_b32_sdwa v138, v15, v118 dst_sel:DWORD dst_unused:UNUSED_PAD src0_sel:DWORD src1_sel:WORD_1
    s_waitcnt vmcnt(11)
    v_mfma_f32_4x4x4_16b_bf16 v[96:99], v[144:145], v[72:73], 0 cbsz:4 abid:8
    s_nop 0
    v_mfma_f32_4x4x4_16b_bf16 v[100:103], v[144:145], v[74:75], 0 cbsz:4 abid:8
    v_lshlrev_b32_sdwa v139, v15, v119 dst_sel:DWORD dst_unused:UNUSED_PAD src0_sel:DWORD src1_sel:WORD_1
    ds_read_u16_d16_hi v134, v138 offset:32768
    ds_read_u16_d16_hi v135, v139 offset:32768
    s_set_gpr_idx_on s49, 0xc
    v_pk_fma_f32 v[16:17], v[128:129], v[104:105], v[16:17] op_sel:[1,0,0] op_sel_hi:[1,1,1]
    v_pk_fma_f32 v[18:19], v[128:129], v[106:107], v[18:19] op_sel:[1,0,0] op_sel_hi:[1,1,1]
    v_pk_fma_f32 v[20:21], v[130:131], v[108:109], v[20:21] op_sel:[1,0,0] op_sel_hi:[1,1,1]
    v_pk_fma_f32 v[22:23], v[130:131], v[110:111], v[22:23] op_sel:[1,0,0] op_sel_hi:[1,1,1]
    s_set_gpr_idx_off
    s_sub_u32 s32, s32, 1
    s_cbranch_scc1 MAIN_DONE
    v_mfma_f32_4x4x4_16b_bf16 v[112:115], v[172:173], v[176:177], 0 cbsz:4 abid:10
    v_lshlrev_b32_sdwa v136, v15, v120 dst_sel:DWORD dst_unused:UNUSED_PAD src0_sel:DWORD src1_sel:WORD_1
    s_waitcnt vmcnt(10)
    v_mfma_f32_4x4x4_16b_bf16 v[104:107], v[146:147], v[76:77], 0 cbsz:4 abid:8
    s_nop 0
    v_mfma_f32_4x4x4_16b_bf16 v[108:111], v[146:147], v[78:79], 0 cbsz:4 abid:8
    v_lshlrev_b32_sdwa v137, v15, v121 dst_sel:DWORD dst_unused:UNUSED_PAD src0_sel:DWORD src1_sel:WORD_1
    ds_read_u16_d16_hi v128, v136 offset:32768
    ds_read_u16_d16_hi v129, v137 offset:32768
    s_waitcnt lgkmcnt(2)
    s_set_gpr_idx_on s50, 0xc
    v_pk_fma_f32 v[16:17], v[132:133], v[96:97], v[16:17] op_sel:[0,0,0] op_sel_hi:[0,1,1]
    v_pk_fma_f32 v[18:19], v[132:133], v[98:99], v[18:19] op_sel:[0,0,0] op_sel_hi:[0,1,1]
    v_pk_fma_f32 v[20:21], v[134:135], v[100:101], v[20:21] op_sel:[0,0,0] op_sel_hi:[0,1,1]
    v_pk_fma_f32 v[22:23], v[134:135], v[102:103], v[22:23] op_sel:[0,0,0] op_sel_hi:[0,1,1]
    s_set_gpr_idx_off
    s_sub_u32 s32, s32, 1
    s_cbranch_scc1 MAIN_DONE
    v_lshlrev_b32_sdwa v138, v15, v124 dst_sel:DWORD dst_unused:UNUSED_PAD src0_sel:DWORD src1_sel:WORD_1
    s_waitcnt vmcnt(9)
    v_mfma_f32_4x4x4_16b_bf16 v[96:99], v[140:141], v[80:81], 0 cbsz:4 abid:9
    s_nop 0
    v_mfma_f32_4x4x4_16b_bf16 v[100:103], v[140:141], v[82:83], 0 cbsz:4 abid:9
    v_lshlrev_b32_sdwa v139, v15, v125 dst_sel:DWORD dst_unused:UNUSED_PAD src0_sel:DWORD src1_sel:WORD_1
    ds_read_u16_d16_hi v130, v138 offset:32768
    ds_read_u16_d16_hi v131, v139 offset:32768
    s_set_gpr_idx_on s51, 0xc
    v_pk_fma_f32 v[16:17], v[132:133], v[104:105], v[16:17] op_sel:[1,0,0] op_sel_hi:[1,1,1]
    v_pk_fma_f32 v[18:19], v[132:133], v[106:107], v[18:19] op_sel:[1,0,0] op_sel_hi:[1,1,1]
    v_pk_fma_f32 v[20:21], v[134:135], v[108:109], v[20:21] op_sel:[1,0,0] op_sel_hi:[1,1,1]
    v_pk_fma_f32 v[22:23], v[134:135], v[110:111], v[22:23] op_sel:[1,0,0] op_sel_hi:[1,1,1]
    s_set_gpr_idx_off
    s_sub_u32 s32, s32, 1
    s_cbranch_scc1 MAIN_DONE
    v_mfma_f32_4x4x4_16b_bf16 v[116:119], v[172:173], v[178:179], 0 cbsz:4 abid:10
    v_lshlrev_b32_sdwa v136, v15, v122 dst_sel:DWORD dst_unused:UNUSED_PAD src0_sel:DWORD src1_sel:WORD_1
    s_waitcnt vmcnt(8)
    v_mfma_f32_4x4x4_16b_bf16 v[104:107], v[142:143], v[84:85], 0 cbsz:4 abid:9
    s_nop 0
    v_mfma_f32_4x4x4_16b_bf16 v[108:111], v[142:143], v[86:87], 0 cbsz:4 abid:9
    v_lshlrev_b32_sdwa v137, v15, v123 dst_sel:DWORD dst_unused:UNUSED_PAD src0_sel:DWORD src1_sel:WORD_1
    ds_read_u16_d16_hi v132, v136 offset:32768
    ds_read_u16_d16_hi v133, v137 offset:32768
    s_waitcnt lgkmcnt(2)
    s_set_gpr_idx_on s52, 0xc
    v_pk_fma_f32 v[16:17], v[128:129], v[96:97], v[16:17] op_sel:[0,0,0] op_sel_hi:[0,1,1]
    v_pk_fma_f32 v[18:19], v[128:129], v[98:99], v[18:19] op_sel:[0,0,0] op_sel_hi:[0,1,1]
    v_pk_fma_f32 v[20:21], v[130:131], v[100:101], v[20:21] op_sel:[0,0,0] op_sel_hi:[0,1,1]
    v_pk_fma_f32 v[22:23], v[130:131], v[102:103], v[22:23] op_sel:[0,0,0] op_sel_hi:[0,1,1]
    s_set_gpr_idx_off
    s_sub_u32 s32, s32, 1
    s_cbranch_scc1 MAIN_DONE
    v_lshlrev_b32_sdwa v138, v15, v126 dst_sel:DWORD dst_unused:UNUSED_PAD src0_sel:DWORD src1_sel:WORD_1
    v_mfma_f32_4x4x4_16b_bf16 v[96:99], v[144:145], v[88:89], 0 cbsz:4 abid:9
    s_nop 0
    v_mfma_f32_4x4x4_16b_bf16 v[100:103], v[144:145], v[90:91], 0 cbsz:4 abid:9
    v_lshlrev_b32_sdwa v139, v15, v127 dst_sel:DWORD dst_unused:UNUSED_PAD src0_sel:DWORD src1_sel:WORD_1
    ds_read_u16_d16_hi v134, v138 offset:32768
    ds_read_u16_d16_hi v135, v139 offset:32768
    s_set_gpr_idx_on s53, 0xc
    v_pk_fma_f32 v[16:17], v[128:129], v[104:105], v[16:17] op_sel:[1,0,0] op_sel_hi:[1,1,1]
    v_pk_fma_f32 v[18:19], v[128:129], v[106:107], v[18:19] op_sel:[1,0,0] op_sel_hi:[1,1,1]
    v_pk_fma_f32 v[20:21], v[130:131], v[108:109], v[20:21] op_sel:[1,0,0] op_sel_hi:[1,1,1]
    v_pk_fma_f32 v[22:23], v[130:131], v[110:111], v[22:23] op_sel:[1,0,0] op_sel_hi:[1,1,1]
    s_set_gpr_idx_off
    s_branch MAIN_DONE
B_36:
    buffer_load_dwordx4 v[188:191], v1, s[16:19], s10 offen offset:0 sc1
    buffer_load_dwordx4 v[192:195], v1, s[16:19], s10 offen offset:1024 sc1
    buffer_load_dwordx4 v[196:199], v1, s[16:19], s10 offen offset:2048 sc1
    buffer_load_dwordx4 v[200:203], v1, s[16:19], s10 offen offset:3072 sc1
    buffer_load_dwordx4 v[204:207], v1, s[16:19], s11 offen offset:0 sc1
    buffer_load_dwordx4 v[208:211], v1, s[16:19], s11 offen offset:1024 sc1
    buffer_load_dwordx4 v[212:215], v1, s[16:19], s11 offen offset:2048 sc1
    buffer_load_dwordx4 v[216:219], v1, s[16:19], s11 offen offset:3072 sc1
    s_sub_u32 s32, s32, 1
    s_cbranch_scc1 MAIN_DONE
    v_mfma_f32_4x4x4_16b_bf16 v[116:119], v[172:173], v[178:179], 0 cbsz:4 abid:10
    v_lshlrev_b32_sdwa v136, v15, v122 dst_sel:DWORD dst_unused:UNUSED_PAD src0_sel:DWORD src1_sel:WORD_1
    s_waitcnt vmcnt(12)
    v_mfma_f32_4x4x4_16b_bf16 v[104:107], v[142:143], v[84:85], 0 cbsz:4 abid:9
    s_nop 0
    v_mfma_f32_4x4x4_16b_bf16 v[108:111], v[142:143], v[86:87], 0 cbsz:4 abid:9
    v_lshlrev_b32_sdwa v137, v15, v123 dst_sel:DWORD dst_unused:UNUSED_PAD src0_sel:DWORD src1_sel:WORD_1
    ds_read_u16_d16_hi v132, v136 offset:32768
    ds_read_u16_d16_hi v133, v137 offset:32768
    s_waitcnt lgkmcnt(2)
    s_set_gpr_idx_on s52, 0xc
    v_pk_fma_f32 v[16:17], v[128:129], v[96:97], v[16:17] op_sel:[0,0,0] op_sel_hi:[0,1,1]
    v_pk_fma_f32 v[18:19], v[128:129], v[98:99], v[18:19] op_sel:[0,0,0] op_sel_hi:[0,1,1]
    v_pk_fma_f32 v[20:21], v[130:131], v[100:101], v[20:21] op_sel:[0,0,0] op_sel_hi:[0,1,1]
    v_pk_fma_f32 v[22:23], v[130:131], v[102:103], v[22:23] op_sel:[0,0,0] op_sel_hi:[0,1,1]
    s_set_gpr_idx_off
    s_sub_u32 s32, s32, 1
    s_cbranch_scc1 MAIN_DONE
    v_lshlrev_b32_sdwa v138, v15, v126 dst_sel:DWORD dst_unused:UNUSED_PAD src0_sel:DWORD src1_sel:WORD_1
    s_waitcnt vmcnt(11)
    v_mfma_f32_4x4x4_16b_bf16 v[96:99], v[144:145], v[88:89], 0 cbsz:4 abid:9
    s_nop 0
    v_mfma_f32_4x4x4_16b_bf16 v[100:103], v[144:145], v[90:91], 0 cbsz:4 abid:9
    v_lshlrev_b32_sdwa v139, v15, v127 dst_sel:DWORD dst_unused:UNUSED_PAD src0_sel:DWORD src1_sel:WORD_1
    ds_read_u16_d16_hi v134, v138 offset:32768
    ds_read_u16_d16_hi v135, v139 offset:32768
    s_set_gpr_idx_on s53, 0xc
    v_pk_fma_f32 v[16:17], v[128:129], v[104:105], v[16:17] op_sel:[1,0,0] op_sel_hi:[1,1,1]
    v_pk_fma_f32 v[18:19], v[128:129], v[106:107], v[18:19] op_sel:[1,0,0] op_sel_hi:[1,1,1]
    v_pk_fma_f32 v[20:21], v[130:131], v[108:109], v[20:21] op_sel:[1,0,0] op_sel_hi:[1,1,1]
    v_pk_fma_f32 v[22:23], v[130:131], v[110:111], v[22:23] op_sel:[1,0,0] op_sel_hi:[1,1,1]
    s_set_gpr_idx_off
    s_sub_u32 s32, s32, 1
    s_cbranch_scc1 MAIN_DONE
    v_mfma_f32_4x4x4_16b_bf16 v[120:123], v[172:173], v[176:177], 0 cbsz:4 abid:11
    v_lshlrev_b32_sdwa v136, v15, v112 dst_sel:DWORD dst_unused:UNUSED_PAD src0_sel:DWORD src1_sel:WORD_1
    s_waitcnt vmcnt(10)
    v_mfma_f32_4x4x4_16b_bf16 v[104:107], v[146:147], v[92:93], 0 cbsz:4 abid:9
    s_nop 0
    v_mfma_f32_4x4x4_16b_bf16 v[108:111], v[146:147], v[94:95], 0 cbsz:4 abid:9
    v_lshlrev_b32_sdwa v137, v15, v113 dst_sel:DWORD dst_unused:UNUSED_PAD src0_sel:DWORD src1_sel:WORD_1
    ds_read_u16_d16_hi v128, v136 offset:32768
    ds_read_u16_d16_hi v129, v137 offset:32768
    s_waitcnt lgkmcnt(2)
    s_set_gpr_idx_on s54, 0xc
    v_pk_fma_f32 v[16:17], v[132:133], v[96:97], v[16:17] op_sel:[0,0,0] op_sel_hi:[0,1,1]
    v_pk_fma_f32 v[18:19], v[132:133], v[98:99], v[18:19] op_sel:[0,0,0] op_sel_hi:[0,1,1]
    v_pk_fma_f32 v[20:21], v[134:135], v[100:101], v[20:21] op_sel:[0,0,0] op_sel_hi:[0,1,1]
    v_pk_fma_f32 v[22:23], v[134:135], v[102:103], v[22:23] op_sel:[0,0,0] op_sel_hi:[0,1,1]
    s_set_gpr_idx_off
    s_sub_u32 s32, s32, 1
    s_cbranch_scc1 MAIN_DONE
    v_lshlrev_b32_sdwa v138, v15, v116 dst_sel:DWORD dst_unused:UNUSED_PAD src0_sel:DWORD src1_sel:WORD_1
    s_waitcnt vmcnt(9)
    v_mfma_f32_4x4x4_16b_bf16 v[96:99], v[140:141], v[64:65], 0 cbsz:4 abid:10
    s_nop 0
    v_mfma_f32_4x4x4_16b_bf16 v[100:103], v[140:141], v[66:67], 0 cbsz:4 abid:10
    v_lshlrev_b32_sdwa v139, v15, v117 dst_sel:DWORD dst_unused:UNUSED_PAD src0_sel:DWORD src1_sel:WORD_1
    ds_read_u16_d16_hi v130, v138 offset:32768
    ds_read_u16_d16_hi v131, v139 offset:32768
    s_set_gpr_idx_on s55, 0xc
    v_pk_fma_f32 v[16:17], v[132:133], v[104:105], v[16:17] op_sel:[1,0,0] op_sel_hi:[1,1,1]
    v_pk_fma_f32 v[18:19], v[132:133], v[106:107], v[18:19] op_sel:[1,0,0] op_sel_hi:[1,1,1]
    v_pk_fma_f32 v[20:21], v[134:135], v[108:109], v[20:21] op_sel:[1,0,0] op_sel_hi:[1,1,1]
    v_pk_fma_f32 v[22:23], v[134:135], v[110:111], v[22:23] op_sel:[1,0,0] op_sel_hi:[1,1,1]
    s_set_gpr_idx_off
    s_sub_u32 s32, s32, 1
    s_cbranch_scc1 MAIN_DONE
    v_mfma_f32_4x4x4_16b_bf16 v[124:127], v[172:173], v[178:179], 0 cbsz:4 abid:11
    v_lshlrev_b32_sdwa v136, v15, v114 dst_sel:DWORD dst_unused:UNUSED_PAD src0_sel:DWORD src1_sel:WORD_1
    s_waitcnt vmcnt(8)
    v_mfma_f32_4x4x4_16b_bf16 v[104:107], v[142:143], v[68:69], 0 cbsz:4 abid:10
    s_nop 0
    v_mfma_f32_4x4x4_16b_bf16 v[108:111], v[142:143], v[70:71], 0 cbsz:4 abid:10
    v_lshlrev_b32_sdwa v137, v15, v115 dst_sel:DWORD dst_unused:UNUSED_PAD src0_sel:DWORD src1_sel:WORD_1
    ds_read_u16_d16_hi v132, v136 offset:32768
    ds_read_u16_d16_hi v133, v137 offset:32768
    s_waitcnt lgkmcnt(2)
    s_set_gpr_idx_on s56, 0xc
    v_pk_fma_f32 v[16:17], v[128:129], v[96:97], v[16:17] op_sel:[0,0,0] op_sel_hi:[0,1,1]
    v_pk_fma_f32 v[18:19], v[128:129], v[98:99], v[18:19] op_sel:[0,0,0] op_sel_hi:[0,1,1]
    v_pk_fma_f32 v[20:21], v[130:131], v[100:101], v[20:21] op_sel:[0,0,0] op_sel_hi:[0,1,1]
    v_pk_fma_f32 v[22:23], v[130:131], v[102:103], v[22:23] op_sel:[0,0,0] op_sel_hi:[0,1,1]
    s_set_gpr_idx_off
    s_sub_u32 s32, s32, 1
    s_cbranch_scc1 MAIN_DONE
    v_mfma_f32_4x4x4_16b_bf16 v[148:151], v[168:169], v[180:181], 0
    v_lshlrev_b32_sdwa v138, v15, v118 dst_sel:DWORD dst_unused:UNUSED_PAD src0_sel:DWORD src1_sel:WORD_1
    v_mfma_f32_4x4x4_16b_bf16 v[96:99], v[144:145], v[72:73], 0 cbsz:4 abid:10
    s_nop 0
    v_mfma_f32_4x4x4_16b_bf16 v[100:103], v[144:145], v[74:75], 0 cbsz:4 abid:10
    v_lshlrev_b32_sdwa v139, v15, v119 dst_sel:DWORD dst_unused:UNUSED_PAD src0_sel:DWORD src1_sel:WORD_1
    ds_read_u16_d16_hi v134, v138 offset:32768
    ds_read_u16_d16_hi v135, v139 offset:32768
    s_set_gpr_idx_on s57, 0xc
    v_pk_fma_f32 v[16:17], v[128:129], v[104:105], v[16:17] op_sel:[1,0,0] op_sel_hi:[1,1,1]
    v_pk_fma_f32 v[18:19], v[128:129], v[106:107], v[18:19] op_sel:[1,0,0] op_sel_hi:[1,1,1]
    v_pk_fma_f32 v[20:21], v[130:131], v[108:109], v[20:21] op_sel:[1,0,0] op_sel_hi:[1,1,1]
    v_pk_fma_f32 v[22:23], v[130:131], v[110:111], v[22:23] op_sel:[1,0,0] op_sel_hi:[1,1,1]
    s_set_gpr_idx_off
    s_branch MAIN_DONE
B_40:
    buffer_load_dwordx4 v[188:191], v1, s[16:19], s10 offen offset:0 sc1
    buffer_load_dwordx4 v[192:195], v1, s[16:19], s10 offen offset:1024 sc1
    buffer_load_dwordx4 v[196:199], v1, s[16:19], s10 offen offset:2048 sc1
    buffer_load_dwordx4 v[200:203], v1, s[16:19], s10 offen offset:3072 sc1
    buffer_load_dwordx4 v[204:207], v1, s[16:19], s11 offen offset:0 sc1
    buffer_load_dwordx4 v[208:211], v1, s[16:19], s11 offen offset:1024 sc1
    buffer_load_dwordx4 v[212:215], v1, s[16:19], s11 offen offset:2048 sc1
    buffer_load_dwordx4 v[216:219], v1, s[16:19], s11 offen offset:3072 sc1
    s_sub_u32 s32, s32, 1
    s_cbranch_scc1 MAIN_DONE
    v_mfma_f32_4x4x4_16b_bf16 v[124:127], v[172:173], v[178:179], 0 cbsz:4 abid:11
    v_lshlrev_b32_sdwa v136, v15, v114 dst_sel:DWORD dst_unused:UNUSED_PAD src0_sel:DWORD src1_sel:WORD_1
    s_waitcnt vmcnt(12)
    v_mfma_f32_4x4x4_16b_bf16 v[104:107], v[142:143], v[68:69], 0 cbsz:4 abid:10
    s_nop 0
    v_mfma_f32_4x4x4_16b_bf16 v[108:111], v[142:143], v[70:71], 0 cbsz:4 abid:10
    v_lshlrev_b32_sdwa v137, v15, v115 dst_sel:DWORD dst_unused:UNUSED_PAD src0_sel:DWORD src1_sel:WORD_1
    ds_read_u16_d16_hi v132, v136 offset:32768
    ds_read_u16_d16_hi v133, v137 offset:32768
    s_waitcnt lgkmcnt(2)
    s_set_gpr_idx_on s56, 0xc
    v_pk_fma_f32 v[16:17], v[128:129], v[96:97], v[16:17] op_sel:[0,0,0] op_sel_hi:[0,1,1]
    v_pk_fma_f32 v[18:19], v[128:129], v[98:99], v[18:19] op_sel:[0,0,0] op_sel_hi:[0,1,1]
    v_pk_fma_f32 v[20:21], v[130:131], v[100:101], v[20:21] op_sel:[0,0,0] op_sel_hi:[0,1,1]
    v_pk_fma_f32 v[22:23], v[130:131], v[102:103], v[22:23] op_sel:[0,0,0] op_sel_hi:[0,1,1]
    s_set_gpr_idx_off
    s_sub_u32 s32, s32, 1
    s_cbranch_scc1 MAIN_DONE
    v_mfma_f32_4x4x4_16b_bf16 v[148:151], v[168:169], v[180:181], 0
    v_lshlrev_b32_sdwa v138, v15, v118 dst_sel:DWORD dst_unused:UNUSED_PAD src0_sel:DWORD src1_sel:WORD_1
    s_waitcnt vmcnt(11)
    v_mfma_f32_4x4x4_16b_bf16 v[96:99], v[144:145], v[72:73], 0 cbsz:4 abid:10
    s_nop 0
    v_mfma_f32_4x4x4_16b_bf16 v[100:103], v[144:145], v[74:75], 0 cbsz:4 abid:10
    v_lshlrev_b32_sdwa v139, v15, v119 dst_sel:DWORD dst_unused:UNUSED_PAD src0_sel:DWORD src1_sel:WORD_1
    ds_read_u16_d16_hi v134, v138 offset:32768
    ds_read_u16_d16_hi v135, v139 offset:32768
    s_set_gpr_idx_on s57, 0xc
    v_pk_fma_f32 v[16:17], v[128:129], v[104:105], v[16:17] op_sel:[1,0,0] op_sel_hi:[1,1,1]
    v_pk_fma_f32 v[18:19], v[128:129], v[106:107], v[18:19] op_sel:[1,0,0] op_sel_hi:[1,1,1]
    v_pk_fma_f32 v[20:21], v[130:131], v[108:109], v[20:21] op_sel:[1,0,0] op_sel_hi:[1,1,1]
    v_pk_fma_f32 v[22:23], v[130:131], v[110:111], v[22:23] op_sel:[1,0,0] op_sel_hi:[1,1,1]
    s_set_gpr_idx_off
    s_sub_u32 s32, s32, 1
    s_cbranch_scc1 MAIN_DONE
    v_mfma_f32_4x4x4_16b_bf16 v[112:115], v[172:173], v[176:177], 0 cbsz:4 abid:12
    v_lshlrev_b32_sdwa v136, v15, v120 dst_sel:DWORD dst_unused:UNUSED_PAD src0_sel:DWORD src1_sel:WORD_1
    s_waitcnt vmcnt(10)
    v_mfma_f32_4x4x4_16b_bf16 v[104:107], v[146:147], v[76:77], 0 cbsz:4 abid:10
    s_nop 0
    v_mfma_f32_4x4x4_16b_bf16 v[108:111], v[146:147], v[78:79], 0 cbsz:4 abid:10
    v_lshlrev_b32_sdwa v137, v15, v121 dst_sel:DWORD dst_unused:UNUSED_PAD src0_sel:DWORD src1_sel:WORD_1
    ds_read_u16_d16_hi v128, v136 offset:32768
    ds_read_u16_d16_hi v129, v137 offset:32768
    s_waitcnt lgkmcnt(2)
    s_set_gpr_idx_on s58, 0xc
    v_pk_fma_f32 v[16:17], v[132:133], v[96:97], v[16:17] op_sel:[0,0,0] op_sel_hi:[0,1,1]
    v_pk_fma_f32 v[18:19], v[132:133], v[98:99], v[18:19] op_sel:[0,0,0] op_sel_hi:[0,1,1]
    v_pk_fma_f32 v[20:21], v[134:135], v[100:101], v[20:21] op_sel:[0,0,0] op_sel_hi:[0,1,1]
    v_pk_fma_f32 v[22:23], v[134:135], v[102:103], v[22:23] op_sel:[0,0,0] op_sel_hi:[0,1,1]
    s_set_gpr_idx_off
    s_sub_u32 s32, s32, 1
    s_cbranch_scc1 MAIN_DONE
    v_mfma_f32_4x4x4_16b_bf16 v[152:155], v[168:169], v[182:183], 0
    v_lshlrev_b32_sdwa v138, v15, v124 dst_sel:DWORD dst_unused:UNUSED_PAD src0_sel:DWORD src1_sel:WORD_1
    s_waitcnt vmcnt(9)
    v_mfma_f32_4x4x4_16b_bf16 v[96:99], v[140:141], v[80:81], 0 cbsz:4 abid:11
    s_nop 0
    v_mfma_f32_4x4x4_16b_bf16 v[100:103], v[140:141], v[82:83], 0 cbsz:4 abid:11
    v_lshlrev_b32_sdwa v139, v15, v125 dst_sel:DWORD dst_unused:UNUSED_PAD src0_sel:DWORD src1_sel:WORD_1
    ds_read_u16_d16_hi v130, v138 offset:32768
    ds_read_u16_d16_hi v131, v139 offset:32768
    s_set_gpr_idx_on s59, 0xc
    v_pk_fma_f32 v[16:17], v[132:133], v[104:105], v[16:17] op_sel:[1,0,0] op_sel_hi:[1,1,1]
    v_pk_fma_f32 v[18:19], v[132:133], v[106:107], v[18:19] op_sel:[1,0,0] op_sel_hi:[1,1,1]
    v_pk_fma_f32 v[20:21], v[134:135], v[108:109], v[20:21] op_sel:[1,0,0] op_sel_hi:[1,1,1]
    v_pk_fma_f32 v[22:23], v[134:135], v[110:111], v[22:23] op_sel:[1,0,0] op_sel_hi:[1,1,1]
    s_set_gpr_idx_off
    s_sub_u32 s32, s32, 1
    s_cbranch_scc1 MAIN_DONE
    v_mfma_f32_4x4x4_16b_bf16 v[116:119], v[172:173], v[178:179], 0 cbsz:4 abid:12
    v_lshlrev_b32_sdwa v136, v15, v122 dst_sel:DWORD dst_unused:UNUSED_PAD src0_sel:DWORD src1_sel:WORD_1
    s_waitcnt vmcnt(8)
    v_mfma_f32_4x4x4_16b_bf16 v[104:107], v[142:143], v[84:85], 0 cbsz:4 abid:11
    s_nop 0
    v_mfma_f32_4x4x4_16b_bf16 v[108:111], v[142:143], v[86:87], 0 cbsz:4 abid:11
    v_lshlrev_b32_sdwa v137, v15, v123 dst_sel:DWORD dst_unused:UNUSED_PAD src0_sel:DWORD src1_sel:WORD_1
    ds_read_u16_d16_hi v132, v136 offset:32768
    ds_read_u16_d16_hi v133, v137 offset:32768
    s_waitcnt lgkmcnt(2)
    s_set_gpr_idx_on s60, 0xc
    v_pk_fma_f32 v[16:17], v[128:129], v[96:97], v[16:17] op_sel:[0,0,0] op_sel_hi:[0,1,1]
    v_pk_fma_f32 v[18:19], v[128:129], v[98:99], v[18:19] op_sel:[0,0,0] op_sel_hi:[0,1,1]
    v_pk_fma_f32 v[20:21], v[130:131], v[100:101], v[20:21] op_sel:[0,0,0] op_sel_hi:[0,1,1]
    v_pk_fma_f32 v[22:23], v[130:131], v[102:103], v[22:23] op_sel:[0,0,0] op_sel_hi:[0,1,1]
    s_set_gpr_idx_off
    s_sub_u32 s32, s32, 1
    s_cbranch_scc1 MAIN_DONE
    v_mfma_f32_4x4x4_16b_bf16 v[156:159], v[168:169], v[184:185], 0
    v_lshlrev_b32_sdwa v138, v15, v126 dst_sel:DWORD dst_unused:UNUSED_PAD src0_sel:DWORD src1_sel:WORD_1
    v_mfma_f32_4x4x4_16b_bf16 v[96:99], v[144:145], v[88:89], 0 cbsz:4 abid:11
    s_nop 0
    v_mfma_f32_4x4x4_16b_bf16 v[100:103], v[144:145], v[90:91], 0 cbsz:4 abid:11
    v_lshlrev_b32_sdwa v139, v15, v127 dst_sel:DWORD dst_unused:UNUSED_PAD src0_sel:DWORD src1_sel:WORD_1
    ds_read_u16_d16_hi v134, v138 offset:32768
    ds_read_u16_d16_hi v135, v139 offset:32768
    s_set_gpr_idx_on s61, 0xc
    v_pk_fma_f32 v[16:17], v[128:129], v[104:105], v[16:17] op_sel:[1,0,0] op_sel_hi:[1,1,1]
    v_pk_fma_f32 v[18:19], v[128:129], v[106:107], v[18:19] op_sel:[1,0,0] op_sel_hi:[1,1,1]
    v_pk_fma_f32 v[20:21], v[130:131], v[108:109], v[20:21] op_sel:[1,0,0] op_sel_hi:[1,1,1]
    v_pk_fma_f32 v[22:23], v[130:131], v[110:111], v[22:23] op_sel:[1,0,0] op_sel_hi:[1,1,1]
    s_set_gpr_idx_off
    s_branch MAIN_DONE
B_44:
    buffer_load_dwordx4 v[188:191], v1, s[16:19], s10 offen offset:0 sc1
    buffer_load_dwordx4 v[192:195], v1, s[16:19], s10 offen offset:1024 sc1
    buffer_load_dwordx4 v[196:199], v1, s[16:19], s10 offen offset:2048 sc1
    buffer_load_dwordx4 v[200:203], v1, s[16:19], s10 offen offset:3072 sc1
    buffer_load_dwordx4 v[204:207], v1, s[16:19], s11 offen offset:0 sc1
    buffer_load_dwordx4 v[208:211], v1, s[16:19], s11 offen offset:1024 sc1
    buffer_load_dwordx4 v[212:215], v1, s[16:19], s11 offen offset:2048 sc1
    buffer_load_dwordx4 v[216:219], v1, s[16:19], s11 offen offset:3072 sc1
    s_sub_u32 s32, s32, 1
    s_cbranch_scc1 MAIN_DONE
    v_mfma_f32_4x4x4_16b_bf16 v[116:119], v[172:173], v[178:179], 0 cbsz:4 abid:12
    v_lshlrev_b32_sdwa v136, v15, v122 dst_sel:DWORD dst_unused:UNUSED_PAD src0_sel:DWORD src1_sel:WORD_1
    s_waitcnt vmcnt(12)
    v_mfma_f32_4x4x4_16b_bf16 v[104:107], v[142:143], v[84:85], 0 cbsz:4 abid:11
    s_nop 0
    v_mfma_f32_4x4x4_16b_bf16 v[108:111], v[142:143], v[86:87], 0 cbsz:4 abid:11
    v_lshlrev_b32_sdwa v137, v15, v123 dst_sel:DWORD dst_unused:UNUSED_PAD src0_sel:DWORD src1_sel:WORD_1
    ds_read_u16_d16_hi v132, v136 offset:32768
    ds_read_u16_d16_hi v133, v137 offset:32768
    s_waitcnt lgkmcnt(2)
    s_set_gpr_idx_on s60, 0xc
    v_pk_fma_f32 v[16:17], v[128:129], v[96:97], v[16:17] op_sel:[0,0,0] op_sel_hi:[0,1,1]
    v_pk_fma_f32 v[18:19], v[128:129], v[98:99], v[18:19] op_sel:[0,0,0] op_sel_hi:[0,1,1]
    v_pk_fma_f32 v[20:21], v[130:131], v[100:101], v[20:21] op_sel:[0,0,0] op_sel_hi:[0,1,1]
    v_pk_fma_f32 v[22:23], v[130:131], v[102:103], v[22:23] op_sel:[0,0,0] op_sel_hi:[0,1,1]
    s_set_gpr_idx_off
    s_sub_u32 s32, s32, 1
    s_cbranch_scc1 MAIN_DONE
    v_mfma_f32_4x4x4_16b_bf16 v[156:159], v[168:169], v[184:185], 0
    v_lshlrev_b32_sdwa v138, v15, v126 dst_sel:DWORD dst_unused:UNUSED_PAD src0_sel:DWORD src1_sel:WORD_1
    s_waitcnt vmcnt(11)
    v_mfma_f32_4x4x4_16b_bf16 v[96:99], v[144:145], v[88:89], 0 cbsz:4 abid:11
    s_nop 0
    v_mfma_f32_4x4x4_16b_bf16 v[100:103], v[144:145], v[90:91], 0 cbsz:4 abid:11
    v_lshlrev_b32_sdwa v139, v15, v127 dst_sel:DWORD dst_unused:UNUSED_PAD src0_sel:DWORD src1_sel:WORD_1
    ds_read_u16_d16_hi v134, v138 offset:32768
    ds_read_u16_d16_hi v135, v139 offset:32768
    s_set_gpr_idx_on s61, 0xc
    v_pk_fma_f32 v[16:17], v[128:129], v[104:105], v[16:17] op_sel:[1,0,0] op_sel_hi:[1,1,1]
    v_pk_fma_f32 v[18:19], v[128:129], v[106:107], v[18:19] op_sel:[1,0,0] op_sel_hi:[1,1,1]
    v_pk_fma_f32 v[20:21], v[130:131], v[108:109], v[20:21] op_sel:[1,0,0] op_sel_hi:[1,1,1]
    v_pk_fma_f32 v[22:23], v[130:131], v[110:111], v[22:23] op_sel:[1,0,0] op_sel_hi:[1,1,1]
    s_set_gpr_idx_off
    s_sub_u32 s32, s32, 1
    s_cbranch_scc1 MAIN_DONE
    v_mfma_f32_4x4x4_16b_bf16 v[120:123], v[172:173], v[176:177], 0 cbsz:4 abid:13
    v_lshlrev_b32_sdwa v136, v15, v112 dst_sel:DWORD dst_unused:UNUSED_PAD src0_sel:DWORD src1_sel:WORD_1
    s_waitcnt vmcnt(10)
    v_mfma_f32_4x4x4_16b_bf16 v[104:107], v[146:147], v[92:93], 0 cbsz:4 abid:11
    s_nop 0
    v_mfma_f32_4x4x4_16b_bf16 v[108:111], v[146:147], v[94:95], 0 cbsz:4 abid:11
    v_lshlrev_b32_sdwa v137, v15, v113 dst_sel:DWORD dst_unused:UNUSED_PAD src0_sel:DWORD src1_sel:WORD_1
    ds_read_u16_d16_hi v128, v136 offset:32768
    ds_read_u16_d16_hi v129, v137 offset:32768
    s_waitcnt lgkmcnt(2)
    s_set_gpr_idx_on s62, 0xc
    v_pk_fma_f32 v[16:17], v[132:133], v[96:97], v[16:17] op_sel:[0,0,0] op_sel_hi:[0,1,1]
    v_pk_fma_f32 v[18:19], v[132:133], v[98:99], v[18:19] op_sel:[0,0,0] op_sel_hi:[0,1,1]
    v_pk_fma_f32 v[20:21], v[134:135], v[100:101], v[20:21] op_sel:[0,0,0] op_sel_hi:[0,1,1]
    v_pk_fma_f32 v[22:23], v[134:135], v[102:103], v[22:23] op_sel:[0,0,0] op_sel_hi:[0,1,1]
    s_set_gpr_idx_off
    s_sub_u32 s32, s32, 1
    s_cbranch_scc1 MAIN_DONE
    v_mfma_f32_4x4x4_16b_bf16 v[160:163], v[168:169], v[186:187], 0
    v_lshlrev_b32_sdwa v138, v15, v116 dst_sel:DWORD dst_unused:UNUSED_PAD src0_sel:DWORD src1_sel:WORD_1
    s_waitcnt vmcnt(9)
    v_mfma_f32_4x4x4_16b_bf16 v[96:99], v[140:141], v[64:65], 0 cbsz:4 abid:12
    s_nop 0
    v_mfma_f32_4x4x4_16b_bf16 v[100:103], v[140:141], v[66:67], 0 cbsz:4 abid:12
    v_lshlrev_b32_sdwa v139, v15, v117 dst_sel:DWORD dst_unused:UNUSED_PAD src0_sel:DWORD src1_sel:WORD_1
    ds_read_u16_d16_hi v130, v138 offset:32768
    ds_read_u16_d16_hi v131, v139 offset:32768
    s_set_gpr_idx_on s63, 0xc
    v_pk_fma_f32 v[16:17], v[132:133], v[104:105], v[16:17] op_sel:[1,0,0] op_sel_hi:[1,1,1]
    v_pk_fma_f32 v[18:19], v[132:133], v[106:107], v[18:19] op_sel:[1,0,0] op_sel_hi:[1,1,1]
    v_pk_fma_f32 v[20:21], v[134:135], v[108:109], v[20:21] op_sel:[1,0,0] op_sel_hi:[1,1,1]
    v_pk_fma_f32 v[22:23], v[134:135], v[110:111], v[22:23] op_sel:[1,0,0] op_sel_hi:[1,1,1]
    s_set_gpr_idx_off
    s_sub_u32 s32, s32, 1
    s_cbranch_scc1 MAIN_DONE
    v_mfma_f32_4x4x4_16b_bf16 v[124:127], v[172:173], v[178:179], 0 cbsz:4 abid:13
    v_lshlrev_b32_sdwa v136, v15, v114 dst_sel:DWORD dst_unused:UNUSED_PAD src0_sel:DWORD src1_sel:WORD_1
    s_waitcnt vmcnt(8)
    v_mfma_f32_4x4x4_16b_bf16 v[104:107], v[142:143], v[68:69], 0 cbsz:4 abid:12
    s_nop 0
    v_mfma_f32_4x4x4_16b_bf16 v[108:111], v[142:143], v[70:71], 0 cbsz:4 abid:12
    v_lshlrev_b32_sdwa v137, v15, v115 dst_sel:DWORD dst_unused:UNUSED_PAD src0_sel:DWORD src1_sel:WORD_1
    ds_read_u16_d16_hi v132, v136 offset:32768
    ds_read_u16_d16_hi v133, v137 offset:32768
    s_waitcnt lgkmcnt(2)
    s_set_gpr_idx_on s48, 0xc
    v_pk_fma_f32 v[16:17], v[128:129], v[96:97], v[16:17] op_sel:[0,0,0] op_sel_hi:[0,1,1]
    v_pk_fma_f32 v[18:19], v[128:129], v[98:99], v[18:19] op_sel:[0,0,0] op_sel_hi:[0,1,1]
    v_pk_fma_f32 v[20:21], v[130:131], v[100:101], v[20:21] op_sel:[0,0,0] op_sel_hi:[0,1,1]
    v_pk_fma_f32 v[22:23], v[130:131], v[102:103], v[22:23] op_sel:[0,0,0] op_sel_hi:[0,1,1]
    s_set_gpr_idx_off
    s_sub_u32 s32, s32, 1
    s_cbranch_scc1 MAIN_DONE
    v_lshlrev_b32_sdwa v138, v15, v118 dst_sel:DWORD dst_unused:UNUSED_PAD src0_sel:DWORD src1_sel:WORD_1
    v_mfma_f32_4x4x4_16b_bf16 v[96:99], v[144:145], v[72:73], 0 cbsz:4 abid:12
    s_nop 0
    v_mfma_f32_4x4x4_16b_bf16 v[100:103], v[144:145], v[74:75], 0 cbsz:4 abid:12
    v_lshlrev_b32_sdwa v139, v15, v119 dst_sel:DWORD dst_unused:UNUSED_PAD src0_sel:DWORD src1_sel:WORD_1
    ds_read_u16_d16_hi v134, v138 offset:32768
    ds_read_u16_d16_hi v135, v139 offset:32768
    s_set_gpr_idx_on s49, 0xc
    v_pk_fma_f32 v[16:17], v[128:129], v[104:105], v[16:17] op_sel:[1,0,0] op_sel_hi:[1,1,1]
    v_pk_fma_f32 v[18:19], v[128:129], v[106:107], v[18:19] op_sel:[1,0,0] op_sel_hi:[1,1,1]
    v_pk_fma_f32 v[20:21], v[130:131], v[108:109], v[20:21] op_sel:[1,0,0] op_sel_hi:[1,1,1]
    v_pk_fma_f32 v[22:23], v[130:131], v[110:111], v[22:23] op_sel:[1,0,0] op_sel_hi:[1,1,1]
    s_set_gpr_idx_off
    s_branch MAIN_DONE
B_48:
    buffer_load_dwordx4 v[188:191], v1, s[16:19], s10 offen offset:0 sc1
    buffer_load_dwordx4 v[192:195], v1, s[16:19], s10 offen offset:1024 sc1
    buffer_load_dwordx4 v[196:199], v1, s[16:19], s10 offen offset:2048 sc1
    buffer_load_dwordx4 v[200:203], v1, s[16:19], s10 offen offset:3072 sc1
    buffer_load_dwordx4 v[204:207], v1, s[16:19], s11 offen offset:0 sc1
    buffer_load_dwordx4 v[208:211], v1, s[16:19], s11 offen offset:1024 sc1
    buffer_load_dwordx4 v[212:215], v1, s[16:19], s11 offen offset:2048 sc1
    buffer_load_dwordx4 v[216:219], v1, s[16:19], s11 offen offset:3072 sc1
    s_sub_u32 s32, s32, 1
    s_cbranch_scc1 MAIN_DONE
    v_mfma_f32_4x4x4_16b_bf16 v[124:127], v[172:173], v[178:179], 0 cbsz:4 abid:13
    v_lshlrev_b32_sdwa v136, v15, v114 dst_sel:DWORD dst_unused:UNUSED_PAD src0_sel:DWORD src1_sel:WORD_1
    s_waitcnt vmcnt(12)
    v_mfma_f32_4x4x4_16b_bf16 v[104:107], v[142:143], v[68:69], 0 cbsz:4 abid:12
    s_nop 0
    v_mfma_f32_4x4x4_16b_bf16 v[108:111], v[142:143], v[70:71], 0 cbsz:4 abid:12
    v_lshlrev_b32_sdwa v137, v15, v115 dst_sel:DWORD dst_unused:UNUSED_PAD src0_sel:DWORD src1_sel:WORD_1
    ds_read_u16_d16_hi v132, v136 offset:32768
    ds_read_u16_d16_hi v133, v137 offset:32768
    s_waitcnt lgkmcnt(2)
    s_set_gpr_idx_on s48, 0xc
    v_pk_fma_f32 v[16:17], v[128:129], v[96:97], v[16:17] op_sel:[0,0,0] op_sel_hi:[0,1,1]
    v_pk_fma_f32 v[18:19], v[128:129], v[98:99], v[18:19] op_sel:[0,0,0] op_sel_hi:[0,1,1]
    v_pk_fma_f32 v[20:21], v[130:131], v[100:101], v[20:21] op_sel:[0,0,0] op_sel_hi:[0,1,1]
    v_pk_fma_f32 v[22:23], v[130:131], v[102:103], v[22:23] op_sel:[0,0,0] op_sel_hi:[0,1,1]
    s_set_gpr_idx_off
    s_sub_u32 s32, s32, 1
    s_cbranch_scc1 MAIN_DONE
    v_lshlrev_b32_sdwa v138, v15, v118 dst_sel:DWORD dst_unused:UNUSED_PAD src0_sel:DWORD src1_sel:WORD_1
    s_waitcnt vmcnt(11)
    v_mfma_f32_4x4x4_16b_bf16 v[96:99], v[144:145], v[72:73], 0 cbsz:4 abid:12
    s_nop 0
    v_mfma_f32_4x4x4_16b_bf16 v[100:103], v[144:145], v[74:75], 0 cbsz:4 abid:12
    v_lshlrev_b32_sdwa v139, v15, v119 dst_sel:DWORD dst_unused:UNUSED_PAD src0_sel:DWORD src1_sel:WORD_1
    ds_read_u16_d16_hi v134, v138 offset:32768
    ds_read_u16_d16_hi v135, v139 offset:32768
    s_set_gpr_idx_on s49, 0xc
    v_pk_fma_f32 v[16:17], v[128:129], v[104:105], v[16:17] op_sel:[1,0,0] op_sel_hi:[1,1,1]
    v_pk_fma_f32 v[18:19], v[128:129], v[106:107], v[18:19] op_sel:[1,0,0] op_sel_hi:[1,1,1]
    v_pk_fma_f32 v[20:21], v[130:131], v[108:109], v[20:21] op_sel:[1,0,0] op_sel_hi:[1,1,1]
    v_pk_fma_f32 v[22:23], v[130:131], v[110:111], v[22:23] op_sel:[1,0,0] op_sel_hi:[1,1,1]
    s_set_gpr_idx_off
    s_sub_u32 s32, s32, 1
    s_cbranch_scc1 MAIN_DONE
    v_mfma_f32_4x4x4_16b_bf16 v[112:115], v[172:173], v[176:177], 0 cbsz:4 abid:14
    v_lshlrev_b32_sdwa v136, v15, v120 dst_sel:DWORD dst_unused:UNUSED_PAD src0_sel:DWORD src1_sel:WORD_1
    s_waitcnt vmcnt(10)
    v_mfma_f32_4x4x4_16b_bf16 v[104:107], v[146:147], v[76:77], 0 cbsz:4 abid:12
    s_nop 0
    v_mfma_f32_4x4x4_16b_bf16 v[108:111], v[146:147], v[78:79], 0 cbsz:4 abid:12
    v_lshlrev_b32_sdwa v137, v15, v121 dst_sel:DWORD dst_unused:UNUSED_PAD src0_sel:DWORD src1_sel:WORD_1
    ds_read_u16_d16_hi v128, v136 offset:32768
    ds_read_u16_d16_hi v129, v137 offset:32768
    s_waitcnt lgkmcnt(2)
    s_set_gpr_idx_on s50, 0xc
    v_pk_fma_f32 v[16:17], v[132:133], v[96:97], v[16:17] op_sel:[0,0,0] op_sel_hi:[0,1,1]
    v_pk_fma_f32 v[18:19], v[132:133], v[98:99], v[18:19] op_sel:[0,0,0] op_sel_hi:[0,1,1]
    v_pk_fma_f32 v[20:21], v[134:135], v[100:101], v[20:21] op_sel:[0,0,0] op_sel_hi:[0,1,1]
    v_pk_fma_f32 v[22:23], v[134:135], v[102:103], v[22:23] op_sel:[0,0,0] op_sel_hi:[0,1,1]
    s_set_gpr_idx_off
    s_sub_u32 s32, s32, 1
    s_cbranch_scc1 MAIN_DONE
    v_lshlrev_b32_sdwa v138, v15, v124 dst_sel:DWORD dst_unused:UNUSED_PAD src0_sel:DWORD src1_sel:WORD_1
    s_waitcnt vmcnt(9)
    v_mfma_f32_4x4x4_16b_bf16 v[96:99], v[140:141], v[80:81], 0 cbsz:4 abid:13
    s_nop 0
    v_mfma_f32_4x4x4_16b_bf16 v[100:103], v[140:141], v[82:83], 0 cbsz:4 abid:13
    v_lshlrev_b32_sdwa v139, v15, v125 dst_sel:DWORD dst_unused:UNUSED_PAD src0_sel:DWORD src1_sel:WORD_1
    ds_read_u16_d16_hi v130, v138 offset:32768
    ds_read_u16_d16_hi v131, v139 offset:32768
    s_set_gpr_idx_on s51, 0xc
    v_pk_fma_f32 v[16:17], v[132:133], v[104:105], v[16:17] op_sel:[1,0,0] op_sel_hi:[1,1,1]
    v_pk_fma_f32 v[18:19], v[132:133], v[106:107], v[18:19] op_sel:[1,0,0] op_sel_hi:[1,1,1]
    v_pk_fma_f32 v[20:21], v[134:135], v[108:109], v[20:21] op_sel:[1,0,0] op_sel_hi:[1,1,1]
    v_pk_fma_f32 v[22:23], v[134:135], v[110:111], v[22:23] op_sel:[1,0,0] op_sel_hi:[1,1,1]
    s_set_gpr_idx_off
    s_sub_u32 s32, s32, 1
    s_cbranch_scc1 MAIN_DONE
    v_mfma_f32_4x4x4_16b_bf16 v[116:119], v[172:173], v[178:179], 0 cbsz:4 abid:14
    v_lshlrev_b32_sdwa v136, v15, v122 dst_sel:DWORD dst_unused:UNUSED_PAD src0_sel:DWORD src1_sel:WORD_1
    s_waitcnt vmcnt(8)
    v_mfma_f32_4x4x4_16b_bf16 v[104:107], v[142:143], v[84:85], 0 cbsz:4 abid:13
    s_nop 0
    v_mfma_f32_4x4x4_16b_bf16 v[108:111], v[142:143], v[86:87], 0 cbsz:4 abid:13
    v_lshlrev_b32_sdwa v137, v15, v123 dst_sel:DWORD dst_unused:UNUSED_PAD src0_sel:DWORD src1_sel:WORD_1
    ds_read_u16_d16_hi v132, v136 offset:32768
    ds_read_u16_d16_hi v133, v137 offset:32768
    s_waitcnt lgkmcnt(2)
    s_set_gpr_idx_on s52, 0xc
    v_pk_fma_f32 v[16:17], v[128:129], v[96:97], v[16:17] op_sel:[0,0,0] op_sel_hi:[0,1,1]
    v_pk_fma_f32 v[18:19], v[128:129], v[98:99], v[18:19] op_sel:[0,0,0] op_sel_hi:[0,1,1]
    v_pk_fma_f32 v[20:21], v[130:131], v[100:101], v[20:21] op_sel:[0,0,0] op_sel_hi:[0,1,1]
    v_pk_fma_f32 v[22:23], v[130:131], v[102:103], v[22:23] op_sel:[0,0,0] op_sel_hi:[0,1,1]
    s_set_gpr_idx_off
    s_sub_u32 s32, s32, 1
    s_cbranch_scc1 MAIN_DONE
    v_lshlrev_b32_sdwa v138, v15, v126 dst_sel:DWORD dst_unused:UNUSED_PAD src0_sel:DWORD src1_sel:WORD_1
    v_mfma_f32_4x4x4_16b_bf16 v[96:99], v[144:145], v[88:89], 0 cbsz:4 abid:13
    s_nop 0
    v_mfma_f32_4x4x4_16b_bf16 v[100:103], v[144:145], v[90:91], 0 cbsz:4 abid:13
    v_lshlrev_b32_sdwa v139, v15, v127 dst_sel:DWORD dst_unused:UNUSED_PAD src0_sel:DWORD src1_sel:WORD_1
    ds_read_u16_d16_hi v134, v138 offset:32768
    ds_read_u16_d16_hi v135, v139 offset:32768
    s_set_gpr_idx_on s53, 0xc
    v_pk_fma_f32 v[16:17], v[128:129], v[104:105], v[16:17] op_sel:[1,0,0] op_sel_hi:[1,1,1]
    v_pk_fma_f32 v[18:19], v[128:129], v[106:107], v[18:19] op_sel:[1,0,0] op_sel_hi:[1,1,1]
    v_pk_fma_f32 v[20:21], v[130:131], v[108:109], v[20:21] op_sel:[1,0,0] op_sel_hi:[1,1,1]
    v_pk_fma_f32 v[22:23], v[130:131], v[110:111], v[22:23] op_sel:[1,0,0] op_sel_hi:[1,1,1]
    s_set_gpr_idx_off
    s_branch MAIN_DONE
B_52:
    buffer_load_dwordx4 v[188:191], v1, s[16:19], s10 offen offset:0 sc1
    buffer_load_dwordx4 v[192:195], v1, s[16:19], s10 offen offset:1024 sc1
    buffer_load_dwordx4 v[196:199], v1, s[16:19], s10 offen offset:2048 sc1
    buffer_load_dwordx4 v[200:203], v1, s[16:19], s10 offen offset:3072 sc1
    buffer_load_dwordx4 v[204:207], v1, s[16:19], s11 offen offset:0 sc1
    buffer_load_dwordx4 v[208:211], v1, s[16:19], s11 offen offset:1024 sc1
    buffer_load_dwordx4 v[212:215], v1, s[16:19], s11 offen offset:2048 sc1
    buffer_load_dwordx4 v[216:219], v1, s[16:19], s11 offen offset:3072 sc1
    s_sub_u32 s32, s32, 1
    s_cbranch_scc1 MAIN_DONE
    v_mfma_f32_4x4x4_16b_bf16 v[116:119], v[172:173], v[178:179], 0 cbsz:4 abid:14
    v_lshlrev_b32_sdwa v136, v15, v122 dst_sel:DWORD dst_unused:UNUSED_PAD src0_sel:DWORD src1_sel:WORD_1
    s_waitcnt vmcnt(12)
    v_mfma_f32_4x4x4_16b_bf16 v[104:107], v[142:143], v[84:85], 0 cbsz:4 abid:13
    s_nop 0
    v_mfma_f32_4x4x4_16b_bf16 v[108:111], v[142:143], v[86:87], 0 cbsz:4 abid:13
    v_lshlrev_b32_sdwa v137, v15, v123 dst_sel:DWORD dst_unused:UNUSED_PAD src0_sel:DWORD src1_sel:WORD_1
    ds_read_u16_d16_hi v132, v136 offset:32768
    ds_read_u16_d16_hi v133, v137 offset:32768
    s_waitcnt lgkmcnt(2)
    s_set_gpr_idx_on s52, 0xc
    v_pk_fma_f32 v[16:17], v[128:129], v[96:97], v[16:17] op_sel:[0,0,0] op_sel_hi:[0,1,1]
    v_pk_fma_f32 v[18:19], v[128:129], v[98:99], v[18:19] op_sel:[0,0,0] op_sel_hi:[0,1,1]
    v_pk_fma_f32 v[20:21], v[130:131], v[100:101], v[20:21] op_sel:[0,0,0] op_sel_hi:[0,1,1]
    v_pk_fma_f32 v[22:23], v[130:131], v[102:103], v[22:23] op_sel:[0,0,0] op_sel_hi:[0,1,1]
    s_set_gpr_idx_off
    s_sub_u32 s32, s32, 1
    s_cbranch_scc1 MAIN_DONE
    v_lshlrev_b32_sdwa v138, v15, v126 dst_sel:DWORD dst_unused:UNUSED_PAD src0_sel:DWORD src1_sel:WORD_1
    s_waitcnt vmcnt(11)
    v_mfma_f32_4x4x4_16b_bf16 v[96:99], v[144:145], v[88:89], 0 cbsz:4 abid:13
    s_nop 0
    v_mfma_f32_4x4x4_16b_bf16 v[100:103], v[144:145], v[90:91], 0 cbsz:4 abid:13
    v_lshlrev_b32_sdwa v139, v15, v127 dst_sel:DWORD dst_unused:UNUSED_PAD src0_sel:DWORD src1_sel:WORD_1
    ds_read_u16_d16_hi v134, v138 offset:32768
    ds_read_u16_d16_hi v135, v139 offset:32768
    s_set_gpr_idx_on s53, 0xc
    v_pk_fma_f32 v[16:17], v[128:129], v[104:105], v[16:17] op_sel:[1,0,0] op_sel_hi:[1,1,1]
    v_pk_fma_f32 v[18:19], v[128:129], v[106:107], v[18:19] op_sel:[1,0,0] op_sel_hi:[1,1,1]
    v_pk_fma_f32 v[20:21], v[130:131], v[108:109], v[20:21] op_sel:[1,0,0] op_sel_hi:[1,1,1]
    v_pk_fma_f32 v[22:23], v[130:131], v[110:111], v[22:23] op_sel:[1,0,0] op_sel_hi:[1,1,1]
    s_set_gpr_idx_off
    s_sub_u32 s32, s32, 1
    s_cbranch_scc1 MAIN_DONE
    v_mfma_f32_4x4x4_16b_bf16 v[120:123], v[172:173], v[176:177], 0 cbsz:4 abid:15
    v_lshlrev_b32_sdwa v136, v15, v112 dst_sel:DWORD dst_unused:UNUSED_PAD src0_sel:DWORD src1_sel:WORD_1
    s_waitcnt vmcnt(10)
    v_mfma_f32_4x4x4_16b_bf16 v[104:107], v[146:147], v[92:93], 0 cbsz:4 abid:13
    s_nop 0
    v_mfma_f32_4x4x4_16b_bf16 v[108:111], v[146:147], v[94:95], 0 cbsz:4 abid:13
    v_lshlrev_b32_sdwa v137, v15, v113 dst_sel:DWORD dst_unused:UNUSED_PAD src0_sel:DWORD src1_sel:WORD_1
    ds_read_u16_d16_hi v128, v136 offset:32768
    ds_read_u16_d16_hi v129, v137 offset:32768
    s_waitcnt lgkmcnt(2)
    s_set_gpr_idx_on s54, 0xc
    v_pk_fma_f32 v[16:17], v[132:133], v[96:97], v[16:17] op_sel:[0,0,0] op_sel_hi:[0,1,1]
    v_pk_fma_f32 v[18:19], v[132:133], v[98:99], v[18:19] op_sel:[0,0,0] op_sel_hi:[0,1,1]
    v_pk_fma_f32 v[20:21], v[134:135], v[100:101], v[20:21] op_sel:[0,0,0] op_sel_hi:[0,1,1]
    v_pk_fma_f32 v[22:23], v[134:135], v[102:103], v[22:23] op_sel:[0,0,0] op_sel_hi:[0,1,1]
    s_set_gpr_idx_off
    s_sub_u32 s32, s32, 1
    s_cbranch_scc1 MAIN_DONE
    v_lshlrev_b32_sdwa v138, v15, v116 dst_sel:DWORD dst_unused:UNUSED_PAD src0_sel:DWORD src1_sel:WORD_1
    s_waitcnt vmcnt(9)
    v_mfma_f32_4x4x4_16b_bf16 v[96:99], v[140:141], v[64:65], 0 cbsz:4 abid:14
    s_nop 0
    v_mfma_f32_4x4x4_16b_bf16 v[100:103], v[140:141], v[66:67], 0 cbsz:4 abid:14
    v_lshlrev_b32_sdwa v139, v15, v117 dst_sel:DWORD dst_unused:UNUSED_PAD src0_sel:DWORD src1_sel:WORD_1
    ds_read_u16_d16_hi v130, v138 offset:32768
    ds_read_u16_d16_hi v131, v139 offset:32768
    s_set_gpr_idx_on s55, 0xc
    v_pk_fma_f32 v[16:17], v[132:133], v[104:105], v[16:17] op_sel:[1,0,0] op_sel_hi:[1,1,1]
    v_pk_fma_f32 v[18:19], v[132:133], v[106:107], v[18:19] op_sel:[1,0,0] op_sel_hi:[1,1,1]
    v_pk_fma_f32 v[20:21], v[134:135], v[108:109], v[20:21] op_sel:[1,0,0] op_sel_hi:[1,1,1]
    v_pk_fma_f32 v[22:23], v[134:135], v[110:111], v[22:23] op_sel:[1,0,0] op_sel_hi:[1,1,1]
    s_set_gpr_idx_off
    s_sub_u32 s32, s32, 1
    s_cbranch_scc1 MAIN_DONE
    v_mfma_f32_4x4x4_16b_bf16 v[124:127], v[172:173], v[178:179], 0 cbsz:4 abid:15
    v_lshlrev_b32_sdwa v136, v15, v114 dst_sel:DWORD dst_unused:UNUSED_PAD src0_sel:DWORD src1_sel:WORD_1
    s_waitcnt vmcnt(8)
    v_mfma_f32_4x4x4_16b_bf16 v[104:107], v[142:143], v[68:69], 0 cbsz:4 abid:14
    s_nop 0
    v_mfma_f32_4x4x4_16b_bf16 v[108:111], v[142:143], v[70:71], 0 cbsz:4 abid:14
    v_lshlrev_b32_sdwa v137, v15, v115 dst_sel:DWORD dst_unused:UNUSED_PAD src0_sel:DWORD src1_sel:WORD_1
    ds_read_u16_d16_hi v132, v136 offset:32768
    ds_read_u16_d16_hi v133, v137 offset:32768
    s_waitcnt lgkmcnt(2)
    s_set_gpr_idx_on s56, 0xc
    v_pk_fma_f32 v[16:17], v[128:129], v[96:97], v[16:17] op_sel:[0,0,0] op_sel_hi:[0,1,1]
    v_pk_fma_f32 v[18:19], v[128:129], v[98:99], v[18:19] op_sel:[0,0,0] op_sel_hi:[0,1,1]
    v_pk_fma_f32 v[20:21], v[130:131], v[100:101], v[20:21] op_sel:[0,0,0] op_sel_hi:[0,1,1]
    v_pk_fma_f32 v[22:23], v[130:131], v[102:103], v[22:23] op_sel:[0,0,0] op_sel_hi:[0,1,1]
    s_set_gpr_idx_off
    s_sub_u32 s32, s32, 1
    s_cbranch_scc1 MAIN_DONE
    v_lshlrev_b32_sdwa v138, v15, v118 dst_sel:DWORD dst_unused:UNUSED_PAD src0_sel:DWORD src1_sel:WORD_1
    v_mfma_f32_4x4x4_16b_bf16 v[96:99], v[144:145], v[72:73], 0 cbsz:4 abid:14
    s_nop 0
    v_mfma_f32_4x4x4_16b_bf16 v[100:103], v[144:145], v[74:75], 0 cbsz:4 abid:14
    v_lshlrev_b32_sdwa v139, v15, v119 dst_sel:DWORD dst_unused:UNUSED_PAD src0_sel:DWORD src1_sel:WORD_1
    ds_read_u16_d16_hi v134, v138 offset:32768
    ds_read_u16_d16_hi v135, v139 offset:32768
    s_set_gpr_idx_on s57, 0xc
    v_pk_fma_f32 v[16:17], v[128:129], v[104:105], v[16:17] op_sel:[1,0,0] op_sel_hi:[1,1,1]
    v_pk_fma_f32 v[18:19], v[128:129], v[106:107], v[18:19] op_sel:[1,0,0] op_sel_hi:[1,1,1]
    v_pk_fma_f32 v[20:21], v[130:131], v[108:109], v[20:21] op_sel:[1,0,0] op_sel_hi:[1,1,1]
    v_pk_fma_f32 v[22:23], v[130:131], v[110:111], v[22:23] op_sel:[1,0,0] op_sel_hi:[1,1,1]
    s_set_gpr_idx_off
    v_mov_b32 v172, v170
    v_mov_b32 v173, v171
    s_nop 1
    s_branch MAIN_DONE
B_56:
    buffer_load_dwordx4 v[188:191], v1, s[16:19], s10 offen offset:0 sc1
    buffer_load_dwordx4 v[192:195], v1, s[16:19], s10 offen offset:1024 sc1
    buffer_load_dwordx4 v[196:199], v1, s[16:19], s10 offen offset:2048 sc1
    buffer_load_dwordx4 v[200:203], v1, s[16:19], s10 offen offset:3072 sc1
    buffer_load_dwordx4 v[204:207], v1, s[16:19], s11 offen offset:0 sc1
    buffer_load_dwordx4 v[208:211], v1, s[16:19], s11 offen offset:1024 sc1
    buffer_load_dwordx4 v[212:215], v1, s[16:19], s11 offen offset:2048 sc1
    buffer_load_dwordx4 v[216:219], v1, s[16:19], s11 offen offset:3072 sc1
    s_sub_u32 s32, s32, 1
    s_cbranch_scc1 MAIN_DONE
    v_mfma_f32_4x4x4_16b_bf16 v[124:127], v[172:173], v[178:179], 0 cbsz:4 abid:15
    v_lshlrev_b32_sdwa v136, v15, v114 dst_sel:DWORD dst_unused:UNUSED_PAD src0_sel:DWORD src1_sel:WORD_1
    s_waitcnt vmcnt(12)
    v_mfma_f32_4x4x4_16b_bf16 v[104:107], v[142:143], v[68:69], 0 cbsz:4 abid:14
    s_nop 0
    v_mfma_f32_4x4x4_16b_bf16 v[108:111], v[142:143], v[70:71], 0 cbsz:4 abid:14
    v_lshlrev_b32_sdwa v137, v15, v115 dst_sel:DWORD dst_unused:UNUSED_PAD src0_sel:DWORD src1_sel:WORD_1
    ds_read_u16_d16_hi v132, v136 offset:32768
    ds_read_u16_d16_hi v133, v137 offset:32768
    s_waitcnt lgkmcnt(2)
    s_set_gpr_idx_on s56, 0xc
    v_pk_fma_f32 v[16:17], v[128:129], v[96:97], v[16:17] op_sel:[0,0,0] op_sel_hi:[0,1,1]
    v_pk_fma_f32 v[18:19], v[128:129], v[98:99], v[18:19] op_sel:[0,0,0] op_sel_hi:[0,1,1]
    v_pk_fma_f32 v[20:21], v[130:131], v[100:101], v[20:21] op_sel:[0,0,0] op_sel_hi:[0,1,1]
    v_pk_fma_f32 v[22:23], v[130:131], v[102:103], v[22:23] op_sel:[0,0,0] op_sel_hi:[0,1,1]
    s_set_gpr_idx_off
    s_sub_u32 s32, s32, 1
    s_cbranch_scc1 MAIN_DONE
    v_lshlrev_b32_sdwa v138, v15, v118 dst_sel:DWORD dst_unused:UNUSED_PAD src0_sel:DWORD src1_sel:WORD_1
    s_waitcnt vmcnt(11)
    v_mfma_f32_4x4x4_16b_bf16 v[96:99], v[144:145], v[72:73], 0 cbsz:4 abid:14
    s_nop 0
    v_mfma_f32_4x4x4_16b_bf16 v[100:103], v[144:145], v[74:75], 0 cbsz:4 abid:14
    v_lshlrev_b32_sdwa v139, v15, v119 dst_sel:DWORD dst_unused:UNUSED_PAD src0_sel:DWORD src1_sel:WORD_1
    ds_read_u16_d16_hi v134, v138 offset:32768
    ds_read_u16_d16_hi v135, v139 offset:32768
    s_set_gpr_idx_on s57, 0xc
    v_pk_fma_f32 v[16:17], v[128:129], v[104:105], v[16:17] op_sel:[1,0,0] op_sel_hi:[1,1,1]
    v_pk_fma_f32 v[18:19], v[128:129], v[106:107], v[18:19] op_sel:[1,0,0] op_sel_hi:[1,1,1]
    v_pk_fma_f32 v[20:21], v[130:131], v[108:109], v[20:21] op_sel:[1,0,0] op_sel_hi:[1,1,1]
    v_pk_fma_f32 v[22:23], v[130:131], v[110:111], v[22:23] op_sel:[1,0,0] op_sel_hi:[1,1,1]
    s_set_gpr_idx_off
    v_mov_b32 v172, v170
    v_mov_b32 v173, v171
    s_nop 1
    s_sub_u32 s32, s32, 1
    s_cbranch_scc1 MAIN_DONE
    v_mfma_f32_4x4x4_16b_bf16 v[112:115], v[172:173], v[176:177], 0 cbsz:4 abid:0
    v_lshlrev_b32_sdwa v136, v15, v120 dst_sel:DWORD dst_unused:UNUSED_PAD src0_sel:DWORD src1_sel:WORD_1
    s_waitcnt vmcnt(10)
    v_mfma_f32_4x4x4_16b_bf16 v[104:107], v[146:147], v[76:77], 0 cbsz:4 abid:14
    s_nop 0
    v_mfma_f32_4x4x4_16b_bf16 v[108:111], v[146:147], v[78:79], 0 cbsz:4 abid:14
    v_lshlrev_b32_sdwa v137, v15, v121 dst_sel:DWORD dst_unused:UNUSED_PAD src0_sel:DWORD src1_sel:WORD_1
    ds_read_u16_d16_hi v128, v136 offset:32768
    ds_read_u16_d16_hi v129, v137 offset:32768
    s_waitcnt lgkmcnt(2)
    s_set_gpr_idx_on s58, 0xc
    v_pk_fma_f32 v[16:17], v[132:133], v[96:97], v[16:17] op_sel:[0,0,0] op_sel_hi:[0,1,1]
    v_pk_fma_f32 v[18:19], v[132:133], v[98:99], v[18:19] op_sel:[0,0,0] op_sel_hi:[0,1,1]
    v_pk_fma_f32 v[20:21], v[134:135], v[100:101], v[20:21] op_sel:[0,0,0] op_sel_hi:[0,1,1]
    v_pk_fma_f32 v[22:23], v[134:135], v[102:103], v[22:23] op_sel:[0,0,0] op_sel_hi:[0,1,1]
    s_set_gpr_idx_off
    s_sub_u32 s32, s32, 1
    s_cbranch_scc1 MAIN_DONE
    v_lshlrev_b32_sdwa v138, v15, v124 dst_sel:DWORD dst_unused:UNUSED_PAD src0_sel:DWORD src1_sel:WORD_1
    s_waitcnt vmcnt(9)
    v_mfma_f32_4x4x4_16b_bf16 v[96:99], v[140:141], v[80:81], 0 cbsz:4 abid:15
    s_nop 0
    v_mfma_f32_4x4x4_16b_bf16 v[100:103], v[140:141], v[82:83], 0 cbsz:4 abid:15
    v_lshlrev_b32_sdwa v139, v15, v125 dst_sel:DWORD dst_unused:UNUSED_PAD src0_sel:DWORD src1_sel:WORD_1
    ds_read_u16_d16_hi v130, v138 offset:32768
    ds_read_u16_d16_hi v131, v139 offset:32768
    s_set_gpr_idx_on s59, 0xc
    v_pk_fma_f32 v[16:17], v[132:133], v[104:105], v[16:17] op_sel:[1,0,0] op_sel_hi:[1,1,1]
    v_pk_fma_f32 v[18:19], v[132:133], v[106:107], v[18:19] op_sel:[1,0,0] op_sel_hi:[1,1,1]
    v_pk_fma_f32 v[20:21], v[134:135], v[108:109], v[20:21] op_sel:[1,0,0] op_sel_hi:[1,1,1]
    v_pk_fma_f32 v[22:23], v[134:135], v[110:111], v[22:23] op_sel:[1,0,0] op_sel_hi:[1,1,1]
    s_set_gpr_idx_off
    s_sub_u32 s32, s32, 1
    s_cbranch_scc1 MAIN_DONE
    v_mfma_f32_4x4x4_16b_bf16 v[116:119], v[172:173], v[178:179], 0 cbsz:4 abid:0
    v_lshlrev_b32_sdwa v136, v15, v122 dst_sel:DWORD dst_unused:UNUSED_PAD src0_sel:DWORD src1_sel:WORD_1
    s_waitcnt vmcnt(8)
    v_mfma_f32_4x4x4_16b_bf16 v[104:107], v[142:143], v[84:85], 0 cbsz:4 abid:15
    s_nop 0
    v_mfma_f32_4x4x4_16b_bf16 v[108:111], v[142:143], v[86:87], 0 cbsz:4 abid:15
    v_lshlrev_b32_sdwa v137, v15, v123 dst_sel:DWORD dst_unused:UNUSED_PAD src0_sel:DWORD src1_sel:WORD_1
    ds_read_u16_d16_hi v132, v136 offset:32768
    ds_read_u16_d16_hi v133, v137 offset:32768
    v_cvt_pk_bf16_f32 v140, v148, v152
    v_cvt_pk_bf16_f32 v141, v156, v160
    s_waitcnt lgkmcnt(2)
    s_set_gpr_idx_on s60, 0xc
    v_pk_fma_f32 v[16:17], v[128:129], v[96:97], v[16:17] op_sel:[0,0,0] op_sel_hi:[0,1,1]
    v_pk_fma_f32 v[18:19], v[128:129], v[98:99], v[18:19] op_sel:[0,0,0] op_sel_hi:[0,1,1]
    v_pk_fma_f32 v[20:21], v[130:131], v[100:101], v[20:21] op_sel:[0,0,0] op_sel_hi:[0,1,1]
    v_pk_fma_f32 v[22:23], v[130:131], v[102:103], v[22:23] op_sel:[0,0,0] op_sel_hi:[0,1,1]
    s_set_gpr_idx_off
    s_sub_u32 s32, s32, 1
    s_cbranch_scc1 MAIN_DONE
    v_lshlrev_b32_sdwa v138, v15, v126 dst_sel:DWORD dst_unused:UNUSED_PAD src0_sel:DWORD src1_sel:WORD_1
    v_mfma_f32_4x4x4_16b_bf16 v[96:99], v[144:145], v[88:89], 0 cbsz:4 abid:15
    s_nop 0
    v_mfma_f32_4x4x4_16b_bf16 v[100:103], v[144:145], v[90:91], 0 cbsz:4 abid:15
    v_lshlrev_b32_sdwa v139, v15, v127 dst_sel:DWORD dst_unused:UNUSED_PAD src0_sel:DWORD src1_sel:WORD_1
    ds_read_u16_d16_hi v134, v138 offset:32768
    ds_read_u16_d16_hi v135, v139 offset:32768
    v_cvt_pk_bf16_f32 v142, v149, v153
    v_cvt_pk_bf16_f32 v143, v157, v161
    s_set_gpr_idx_on s61, 0xc
    v_pk_fma_f32 v[16:17], v[128:129], v[104:105], v[16:17] op_sel:[1,0,0] op_sel_hi:[1,1,1]
    v_pk_fma_f32 v[18:19], v[128:129], v[106:107], v[18:19] op_sel:[1,0,0] op_sel_hi:[1,1,1]
    v_pk_fma_f32 v[20:21], v[130:131], v[108:109], v[20:21] op_sel:[1,0,0] op_sel_hi:[1,1,1]
    v_pk_fma_f32 v[22:23], v[130:131], v[110:111], v[22:23] op_sel:[1,0,0] op_sel_hi:[1,1,1]
    s_set_gpr_idx_off
    s_branch MAIN_DONE
B_60:
    buffer_load_dwordx4 v[188:191], v1, s[16:19], s10 offen offset:0 sc1
    buffer_load_dwordx4 v[192:195], v1, s[16:19], s10 offen offset:1024 sc1
    buffer_load_dwordx4 v[196:199], v1, s[16:19], s10 offen offset:2048 sc1
    buffer_load_dwordx4 v[200:203], v1, s[16:19], s10 offen offset:3072 sc1
    buffer_load_dwordx4 v[204:207], v1, s[16:19], s11 offen offset:0 sc1
    buffer_load_dwordx4 v[208:211], v1, s[16:19], s11 offen offset:1024 sc1
    buffer_load_dwordx4 v[212:215], v1, s[16:19], s11 offen offset:2048 sc1
    buffer_load_dwordx4 v[216:219], v1, s[16:19], s11 offen offset:3072 sc1
    s_sub_u32 s32, s32, 1
    s_cbranch_scc1 MAIN_DONE
    v_mfma_f32_4x4x4_16b_bf16 v[116:119], v[172:173], v[178:179], 0 cbsz:4 abid:0
    v_lshlrev_b32_sdwa v136, v15, v122 dst_sel:DWORD dst_unused:UNUSED_PAD src0_sel:DWORD src1_sel:WORD_1
    s_waitcnt vmcnt(12)
    v_mfma_f32_4x4x4_16b_bf16 v[104:107], v[142:143], v[84:85], 0 cbsz:4 abid:15
    s_nop 0
    v_mfma_f32_4x4x4_16b_bf16 v[108:111], v[142:143], v[86:87], 0 cbsz:4 abid:15
    v_lshlrev_b32_sdwa v137, v15, v123 dst_sel:DWORD dst_unused:UNUSED_PAD src0_sel:DWORD src1_sel:WORD_1
    ds_read_u16_d16_hi v132, v136 offset:32768
    ds_read_u16_d16_hi v133, v137 offset:32768
    v_cvt_pk_bf16_f32 v140, v148, v152
    v_cvt_pk_bf16_f32 v141, v156, v160
    s_waitcnt lgkmcnt(2)
    s_set_gpr_idx_on s60, 0xc
    v_pk_fma_f32 v[16:17], v[128:129], v[96:97], v[16:17] op_sel:[0,0,0] op_sel_hi:[0,1,1]
    v_pk_fma_f32 v[18:19], v[128:129], v[98:99], v[18:19] op_sel:[0,0,0] op_sel_hi:[0,1,1]
    v_pk_fma_f32 v[20:21], v[130:131], v[100:101], v[20:21] op_sel:[0,0,0] op_sel_hi:[0,1,1]
    v_pk_fma_f32 v[22:23], v[130:131], v[102:103], v[22:23] op_sel:[0,0,0] op_sel_hi:[0,1,1]
    s_set_gpr_idx_off
    s_sub_u32 s32, s32, 1
    s_cbranch_scc1 MAIN_DONE
    v_lshlrev_b32_sdwa v138, v15, v126 dst_sel:DWORD dst_unused:UNUSED_PAD src0_sel:DWORD src1_sel:WORD_1
    s_waitcnt vmcnt(11)
    v_mfma_f32_4x4x4_16b_bf16 v[96:99], v[144:145], v[88:89], 0 cbsz:4 abid:15
    s_nop 0
    v_mfma_f32_4x4x4_16b_bf16 v[100:103], v[144:145], v[90:91], 0 cbsz:4 abid:15
    v_lshlrev_b32_sdwa v139, v15, v127 dst_sel:DWORD dst_unused:UNUSED_PAD src0_sel:DWORD src1_sel:WORD_1
    ds_read_u16_d16_hi v134, v138 offset:32768
    ds_read_u16_d16_hi v135, v139 offset:32768
    v_cvt_pk_bf16_f32 v142, v149, v153
    v_cvt_pk_bf16_f32 v143, v157, v161
    s_set_gpr_idx_on s61, 0xc
    v_pk_fma_f32 v[16:17], v[128:129], v[104:105], v[16:17] op_sel:[1,0,0] op_sel_hi:[1,1,1]
    v_pk_fma_f32 v[18:19], v[128:129], v[106:107], v[18:19] op_sel:[1,0,0] op_sel_hi:[1,1,1]
    v_pk_fma_f32 v[20:21], v[130:131], v[108:109], v[20:21] op_sel:[1,0,0] op_sel_hi:[1,1,1]
    v_pk_fma_f32 v[22:23], v[130:131], v[110:111], v[22:23] op_sel:[1,0,0] op_sel_hi:[1,1,1]
    s_set_gpr_idx_off
    s_sub_u32 s32, s32, 1
    s_cbranch_scc1 MAIN_DONE
    v_mfma_f32_4x4x4_16b_bf16 v[120:123], v[172:173], v[176:177], 0 cbsz:4 abid:1
    v_lshlrev_b32_sdwa v136, v15, v112 dst_sel:DWORD dst_unused:UNUSED_PAD src0_sel:DWORD src1_sel:WORD_1
    s_waitcnt vmcnt(10)
    v_mfma_f32_4x4x4_16b_bf16 v[104:107], v[146:147], v[92:93], 0 cbsz:4 abid:15
    s_nop 0
    v_mfma_f32_4x4x4_16b_bf16 v[108:111], v[146:147], v[94:95], 0 cbsz:4 abid:15
    v_lshlrev_b32_sdwa v137, v15, v113 dst_sel:DWORD dst_unused:UNUSED_PAD src0_sel:DWORD src1_sel:WORD_1
    ds_read_u16_d16_hi v128, v136 offset:32768
    ds_read_u16_d16_hi v129, v137 offset:32768
    v_cvt_pk_bf16_f32 v144, v150, v154
    v_cvt_pk_bf16_f32 v145, v158, v162
    s_waitcnt lgkmcnt(2)
    s_set_gpr_idx_on s62, 0xc
    v_pk_fma_f32 v[16:17], v[132:133], v[96:97], v[16:17] op_sel:[0,0,0] op_sel_hi:[0,1,1]
    v_pk_fma_f32 v[18:19], v[132:133], v[98:99], v[18:19] op_sel:[0,0,0] op_sel_hi:[0,1,1]
    v_pk_fma_f32 v[20:21], v[134:135], v[100:101], v[20:21] op_sel:[0,0,0] op_sel_hi:[0,1,1]
    v_pk_fma_f32 v[22:23], v[134:135], v[102:103], v[22:23] op_sel:[0,0,0] op_sel_hi:[0,1,1]
    s_set_gpr_idx_off
    s_sub_u32 s32, s32, 1
    s_cbranch_scc1 MAIN_DONE
    v_lshlrev_b32_sdwa v138, v15, v116 dst_sel:DWORD dst_unused:UNUSED_PAD src0_sel:DWORD src1_sel:WORD_1
    s_waitcnt vmcnt(9)
    v_mfma_f32_4x4x4_16b_bf16 v[96:99], v[140:141], v[64:65], 0 cbsz:4 abid:0
    s_nop 0
    v_mfma_f32_4x4x4_16b_bf16 v[100:103], v[140:141], v[66:67], 0 cbsz:4 abid:0
    v_lshlrev_b32_sdwa v139, v15, v117 dst_sel:DWORD dst_unused:UNUSED_PAD src0_sel:DWORD src1_sel:WORD_1
    ds_read_u16_d16_hi v130, v138 offset:32768
    ds_read_u16_d16_hi v131, v139 offset:32768
    v_cvt_pk_bf16_f32 v146, v151, v155
    v_cvt_pk_bf16_f32 v147, v159, v163
    s_set_gpr_idx_on s63, 0xc
    v_pk_fma_f32 v[16:17], v[132:133], v[104:105], v[16:17] op_sel:[1,0,0] op_sel_hi:[1,1,1]
    v_pk_fma_f32 v[18:19], v[132:133], v[106:107], v[18:19] op_sel:[1,0,0] op_sel_hi:[1,1,1]
    v_pk_fma_f32 v[20:21], v[134:135], v[108:109], v[20:21] op_sel:[1,0,0] op_sel_hi:[1,1,1]
    v_pk_fma_f32 v[22:23], v[134:135], v[110:111], v[22:23] op_sel:[1,0,0] op_sel_hi:[1,1,1]
    s_set_gpr_idx_off
    s_sub_u32 s32, s32, 1
    s_cbranch_scc1 MAIN_DONE
    v_mfma_f32_4x4x4_16b_bf16 v[124:127], v[172:173], v[178:179], 0 cbsz:4 abid:1
    v_lshlrev_b32_sdwa v136, v15, v114 dst_sel:DWORD dst_unused:UNUSED_PAD src0_sel:DWORD src1_sel:WORD_1
    s_waitcnt vmcnt(8)
    v_mfma_f32_4x4x4_16b_bf16 v[104:107], v[142:143], v[68:69], 0 cbsz:4 abid:0
    s_nop 0
    v_mfma_f32_4x4x4_16b_bf16 v[108:111], v[142:143], v[70:71], 0 cbsz:4 abid:0
    v_lshlrev_b32_sdwa v137, v15, v115 dst_sel:DWORD dst_unused:UNUSED_PAD src0_sel:DWORD src1_sel:WORD_1
    ds_read_u16_d16_hi v132, v136 offset:32768
    ds_read_u16_d16_hi v133, v137 offset:32768
    s_waitcnt lgkmcnt(2)
    s_set_gpr_idx_on s48, 0xc
    v_pk_fma_f32 v[16:17], v[128:129], v[96:97], v[16:17] op_sel:[0,0,0] op_sel_hi:[0,1,1]
    v_pk_fma_f32 v[18:19], v[128:129], v[98:99], v[18:19] op_sel:[0,0,0] op_sel_hi:[0,1,1]
    v_pk_fma_f32 v[20:21], v[130:131], v[100:101], v[20:21] op_sel:[0,0,0] op_sel_hi:[0,1,1]
    v_pk_fma_f32 v[22:23], v[130:131], v[102:103], v[22:23] op_sel:[0,0,0] op_sel_hi:[0,1,1]
    s_set_gpr_idx_off
    s_sub_u32 s32, s32, 1
    s_cbranch_scc1 MAIN_DONE
    v_lshlrev_b32_sdwa v138, v15, v118 dst_sel:DWORD dst_unused:UNUSED_PAD src0_sel:DWORD src1_sel:WORD_1
    v_mfma_f32_4x4x4_16b_bf16 v[96:99], v[144:145], v[72:73], 0 cbsz:4 abid:0
    s_nop 0
    v_mfma_f32_4x4x4_16b_bf16 v[100:103], v[144:145], v[74:75], 0 cbsz:4 abid:0
    v_lshlrev_b32_sdwa v139, v15, v119 dst_sel:DWORD dst_unused:UNUSED_PAD src0_sel:DWORD src1_sel:WORD_1
    ds_read_u16_d16_hi v134, v138 offset:32768
    ds_read_u16_d16_hi v135, v139 offset:32768
    s_set_gpr_idx_on s49, 0xc
    v_pk_fma_f32 v[16:17], v[128:129], v[104:105], v[16:17] op_sel:[1,0,0] op_sel_hi:[1,1,1]
    v_pk_fma_f32 v[18:19], v[128:129], v[106:107], v[18:19] op_sel:[1,0,0] op_sel_hi:[1,1,1]
    v_pk_fma_f32 v[20:21], v[130:131], v[108:109], v[20:21] op_sel:[1,0,0] op_sel_hi:[1,1,1]
    v_pk_fma_f32 v[22:23], v[130:131], v[110:111], v[22:23] op_sel:[1,0,0] op_sel_hi:[1,1,1]
    s_set_gpr_idx_off
    s_branch MAIN_DONE
MAIN_DONE:
    s_add_u32 s27, s27, 1472
    s_cmp_ge_u32 s27, s26
    s_cbranch_scc1 ALL_DONE
    s_waitcnt vmcnt(0) lgkmcnt(0)
    v_lshlrev_b32 v11, 2, v0
    v_mov_b32 v12, 0
    v_cmp_gt_u32 vcc, 0x100, v0
    s_and_saveexec_b64 s[42:43], vcc
    ds_write_b32 v11, v12 offset:0
    s_mov_b64 exec, s[42:43]
    s_waitcnt lgkmcnt(0)
    s_barrier
    s_branch ROUND
ALL_DONE:
    v_lshrrev_b32 v11, 8, v1
    s_lshr_b32 s42, s25, 2
    s_mul_i32 s43, s42, 80
    v_mul_u32_u24 v9, 20, v11
    v_add_u32 v9, s43, v9
    ds_read_b32 v112, v9 offset:1344
    ds_read_b32 v113, v9 offset:1348
    ds_read_b32 v114, v9 offset:1352
    ds_read_b32 v115, v9 offset:1356
    ds_read_b32 v116, v9 offset:1360
    v_cvt_pk_bf16_f32 v140, v16, v20
    v_cvt_pk_bf16_f32 v141, v17, v21
    v_cvt_pk_bf16_f32 v142, v18, v22
    v_cvt_pk_bf16_f32 v143, v19, v23
    v_cvt_pk_bf16_f32 v144, v24, v28
    v_cvt_pk_bf16_f32 v145, v25, v29
    v_cvt_pk_bf16_f32 v146, v26, v30
    v_cvt_pk_bf16_f32 v147, v27, v31
    v_cvt_pk_bf16_f32 v148, v32, v36
    v_cvt_pk_bf16_f32 v149, v33, v37
    v_cvt_pk_bf16_f32 v150, v34, v38
    v_cvt_pk_bf16_f32 v151, v35, v39
    v_cvt_pk_bf16_f32 v152, v40, v44
    v_cvt_pk_bf16_f32 v153, v41, v45
    v_cvt_pk_bf16_f32 v154, v42, v46
    v_cvt_pk_bf16_f32 v155, v43, v47
    v_cvt_pk_bf16_f32 v156, v48, v52
    v_cvt_pk_bf16_f32 v157, v49, v53
    v_cvt_pk_bf16_f32 v158, v50, v54
    v_cvt_pk_bf16_f32 v159, v51, v55
    s_mul_i32 s43, s25, 1152
    s_add_u32 s43, s43, 32768
    v_lshrrev_b32 v12, 2, v1
    v_add_u32 v12, s43, v12
    v_bfe_u32 v10, v1, 4, 4
    s_mul_i32 s43, s42, 4608
    s_add_u32 s43, s43, 32768
    v_mul_u32_u24 v8, 288, v10
    v_lshl_add_u32 v8, v11, 4, v8
    v_add_u32 v8, s43, v8
    s_lshl_b32 s42, s24, 10
    s_and_b32 s43, s25, 3
    s_lshl_b32 s43, s43, 8
    s_add_u32 s42, s42, s43
    v_lshl_add_u32 v10, v10, 4, s42
    s_waitcnt lgkmcnt(0)
    v_lshl_add_u32 v112, v112, 18, v10
    v_lshl_add_u32 v113, v113, 18, v10
    v_lshl_add_u32 v114, v114, 18, v10
    v_lshl_add_u32 v115, v115, 18, v10
    v_lshl_add_u32 v116, v116, 18, v10
    s_barrier
    ds_write_b32 v12, v140 offset:0
    ds_write_b32 v12, v141 offset:288
    ds_write_b32 v12, v142 offset:576
    ds_write_b32 v12, v143 offset:864
    ds_write_b32 v12, v144 offset:9216
    ds_write_b32 v12, v145 offset:9504
    ds_write_b32 v12, v146 offset:9792
    ds_write_b32 v12, v147 offset:10080
    s_waitcnt vmcnt(0) lgkmcnt(0)
    s_barrier
    ds_read_b128 v[64:67], v8 offset:0
    ds_read_b128 v[68:71], v8 offset:64
    ds_read_b128 v[72:75], v8 offset:128
    ds_read_b128 v[76:79], v8 offset:192
    ds_read_b128 v[80:83], v8 offset:9216
    ds_read_b128 v[84:87], v8 offset:9280
    ds_read_b128 v[88:91], v8 offset:9344
    ds_read_b128 v[92:95], v8 offset:9408
    s_waitcnt lgkmcnt(7)
    v_mfma_f32_16x16x32_bf16 v[16:19], v[64:67], v[188:191], 0
    v_mfma_f32_16x16x32_bf16 v[20:23], v[64:67], v[204:207], 0
    ds_write_b32 v12, v148 offset:18432
    ds_write_b32 v12, v149 offset:18720
    ds_write_b32 v12, v150 offset:19008
    s_waitcnt lgkmcnt(9)
    v_mfma_f32_16x16x32_bf16 v[16:19], v[68:71], v[192:195], v[16:19]
    v_mfma_f32_16x16x32_bf16 v[20:23], v[68:71], v[208:211], v[20:23]
    ds_write_b32 v12, v151 offset:19296
    ds_write_b32 v12, v152 offset:27648
    ds_write_b32 v12, v153 offset:27936
    s_waitcnt lgkmcnt(11)
    v_mfma_f32_16x16x32_bf16 v[16:19], v[72:75], v[196:199], v[16:19]
    v_mfma_f32_16x16x32_bf16 v[20:23], v[72:75], v[212:215], v[20:23]
    ds_write_b32 v12, v154 offset:28224
    ds_write_b32 v12, v155 offset:28512
    ds_write_b32 v12, v156 offset:36864
    s_waitcnt lgkmcnt(13)
    v_mfma_f32_16x16x32_bf16 v[16:19], v[76:79], v[200:203], v[16:19]
    v_mfma_f32_16x16x32_bf16 v[20:23], v[76:79], v[216:219], v[20:23]
    ds_write_b32 v12, v157 offset:37152
    ds_write_b32 v12, v158 offset:37440
    ds_write_b32 v12, v159 offset:37728
    s_waitcnt lgkmcnt(0)
    s_barrier
    ds_read_b128 v[64:67], v8 offset:18432
    ds_read_b128 v[68:71], v8 offset:18496
    ds_read_b128 v[72:75], v8 offset:18560
    ds_read_b128 v[76:79], v8 offset:18624
    v_mfma_f32_16x16x32_bf16 v[24:27], v[80:83], v[188:191], 0
    v_mfma_f32_16x16x32_bf16 v[28:31], v[80:83], v[204:207], 0
    v_mfma_f32_16x16x32_bf16 v[24:27], v[84:87], v[192:195], v[24:27]
    v_mfma_f32_16x16x32_bf16 v[28:31], v[84:87], v[208:211], v[28:31]
    v_mfma_f32_16x16x32_bf16 v[24:27], v[88:91], v[196:199], v[24:27]
    v_mfma_f32_16x16x32_bf16 v[28:31], v[88:91], v[212:215], v[28:31]
    v_mfma_f32_16x16x32_bf16 v[24:27], v[92:95], v[200:203], v[24:27]
    v_mfma_f32_16x16x32_bf16 v[28:31], v[92:95], v[216:219], v[28:31]
    v_cvt_pk_bf16_f32 v128, v16, v17
    v_cvt_pk_bf16_f32 v129, v18, v19
    v_cvt_pk_bf16_f32 v130, v20, v21
    v_cvt_pk_bf16_f32 v131, v22, v23
    buffer_store_dwordx4 v[128:131], v112, s[20:23], 0 offen sc0 sc1
    ds_read_b128 v[80:83], v8 offset:27648
    ds_read_b128 v[84:87], v8 offset:27712
    ds_read_b128 v[88:91], v8 offset:27776
    ds_read_b128 v[92:95], v8 offset:27840
    s_waitcnt lgkmcnt(7)
    v_mfma_f32_16x16x32_bf16 v[32:35], v[64:67], v[188:191], 0
    v_mfma_f32_16x16x32_bf16 v[36:39], v[64:67], v[204:207], 0
    s_waitcnt lgkmcnt(6)
    v_mfma_f32_16x16x32_bf16 v[32:35], v[68:71], v[192:195], v[32:35]
    v_mfma_f32_16x16x32_bf16 v[36:39], v[68:71], v[208:211], v[36:39]
    s_waitcnt lgkmcnt(5)
    v_mfma_f32_16x16x32_bf16 v[32:35], v[72:75], v[196:199], v[32:35]
    v_mfma_f32_16x16x32_bf16 v[36:39], v[72:75], v[212:215], v[36:39]
    s_waitcnt lgkmcnt(4)
    v_mfma_f32_16x16x32_bf16 v[32:35], v[76:79], v[200:203], v[32:35]
    v_mfma_f32_16x16x32_bf16 v[36:39], v[76:79], v[216:219], v[36:39]
    v_cvt_pk_bf16_f32 v132, v24, v25
    v_cvt_pk_bf16_f32 v133, v26, v27
    v_cvt_pk_bf16_f32 v134, v28, v29
    v_cvt_pk_bf16_f32 v135, v30, v31
    buffer_store_dwordx4 v[132:135], v113, s[20:23], 0 offen sc0 sc1
    ds_read_b128 v[64:67], v8 offset:36864
    ds_read_b128 v[68:71], v8 offset:36928
    ds_read_b128 v[72:75], v8 offset:36992
    ds_read_b128 v[76:79], v8 offset:37056
    s_waitcnt lgkmcnt(7)
    v_mfma_f32_16x16x32_bf16 v[40:43], v[80:83], v[188:191], 0
    v_mfma_f32_16x16x32_bf16 v[44:47], v[80:83], v[204:207], 0
    s_waitcnt lgkmcnt(6)
    v_mfma_f32_16x16x32_bf16 v[40:43], v[84:87], v[192:195], v[40:43]
    v_mfma_f32_16x16x32_bf16 v[44:47], v[84:87], v[208:211], v[44:47]
    s_waitcnt lgkmcnt(5)
    v_mfma_f32_16x16x32_bf16 v[40:43], v[88:91], v[196:199], v[40:43]
    v_mfma_f32_16x16x32_bf16 v[44:47], v[88:91], v[212:215], v[44:47]
    s_waitcnt lgkmcnt(4)
    v_mfma_f32_16x16x32_bf16 v[40:43], v[92:95], v[200:203], v[40:43]
    v_mfma_f32_16x16x32_bf16 v[44:47], v[92:95], v[216:219], v[44:47]
    v_cvt_pk_bf16_f32 v128, v32, v33
    v_cvt_pk_bf16_f32 v129, v34, v35
    v_cvt_pk_bf16_f32 v130, v36, v37
    v_cvt_pk_bf16_f32 v131, v38, v39
    buffer_store_dwordx4 v[128:131], v114, s[20:23], 0 offen sc0 sc1
    s_waitcnt lgkmcnt(3)
    v_mfma_f32_16x16x32_bf16 v[48:51], v[64:67], v[188:191], 0
    v_mfma_f32_16x16x32_bf16 v[52:55], v[64:67], v[204:207], 0
    s_waitcnt lgkmcnt(2)
    v_mfma_f32_16x16x32_bf16 v[48:51], v[68:71], v[192:195], v[48:51]
    v_mfma_f32_16x16x32_bf16 v[52:55], v[68:71], v[208:211], v[52:55]
    s_waitcnt lgkmcnt(1)
    v_mfma_f32_16x16x32_bf16 v[48:51], v[72:75], v[196:199], v[48:51]
    v_mfma_f32_16x16x32_bf16 v[52:55], v[72:75], v[212:215], v[52:55]
    s_waitcnt lgkmcnt(0)
    v_mfma_f32_16x16x32_bf16 v[48:51], v[76:79], v[200:203], v[48:51]
    v_mfma_f32_16x16x32_bf16 v[52:55], v[76:79], v[216:219], v[52:55]
    v_cvt_pk_bf16_f32 v132, v40, v41
    v_cvt_pk_bf16_f32 v133, v42, v43
    v_cvt_pk_bf16_f32 v134, v44, v45
    v_cvt_pk_bf16_f32 v135, v46, v47
    buffer_store_dwordx4 v[132:135], v115, s[20:23], 0 offen sc0 sc1
    s_nop 3
    v_cvt_pk_bf16_f32 v128, v48, v49
    v_cvt_pk_bf16_f32 v129, v50, v51
    v_cvt_pk_bf16_f32 v130, v52, v53
    v_cvt_pk_bf16_f32 v131, v54, v55
    buffer_store_dwordx4 v[128:131], v116, s[20:23], 0 offen sc0 sc1
END:
    s_endpgm
    .p2align 6
    .type DEAL_TABLE,@object
DEAL_TABLE:
    .short 8272, 4136, 8532, 14476, 12408, 6204, 2068, 10340, 0, 8792, 4396, 12668, 2328, 14736, 6464, 10600, 260, 9052, 14996, 6724, 520, 2588, 10860, 12928, 4656, 11120, 780, 2848, 13188, 15256, 6984, 4916, 1040, 11380, 7244, 3108, 13448, 15516, 5176, 9312, 0, 0, 0, 0, 0, 0, 0, 0, 0, 0, 0, 0, 0, 0, 0, 0, 0, 0, 0, 0, 0, 0, 0, 0, 0, 4136, 14476, 2068, 8272, 12408, 10340, 6204, 12668, 6464, 2328, 14736, 8532, 260, 4396, 10600, 8792, 6724, 10860, 12928, 14996, 2588, 520, 4656, 15256, 11120, 4916, 9052, 6984, 13188, 780, 2848, 11380, 3108, 7244, 13448, 9312, 5176, 15516, 1040, 0, 0, 0, 0, 0, 0, 0, 0, 0, 0, 0, 0, 0, 0, 0, 0, 0, 0, 0, 0, 0, 0, 0, 0
    .size DEAL_TABLE, 256
.section .rodata,"a"
.p2align 6
.amdhsa_kernel gather_scatter__tensor_product_equiv_tfn__graph_kernel
  .amdhsa_next_free_vgpr 220
  .amdhsa_next_free_sgpr 66
  .amdhsa_accum_offset 220
  .amdhsa_group_segment_fixed_size 0
  .amdhsa_kernarg_size 88
  .amdhsa_user_sgpr_count 2
  .amdhsa_user_sgpr_kernarg_segment_ptr 1
  .amdhsa_system_sgpr_workgroup_id_x 1
  .amdhsa_float_denorm_mode_32 3
.end_amdhsa_kernel
```

```asm
; @launch grid=(256,1,1) block=(512,1,1) lds=163840
.amdgcn_target "amdgcn-amd-amdhsa--gfx950"
.text
.globl gather_scatter__tensor_product_equiv_tfn__graph_kernel
.p2align 8
.type gather_scatter__tensor_product_equiv_tfn__graph_kernel,@function
gather_scatter__tensor_product_equiv_tfn__graph_kernel:
    s_cmp_ge_u32 s2, 256
    s_cbranch_scc1 END
    s_load_dwordx16 s[40:55], s[0:1], 0
    s_load_dwordx2 s[16:17], s[0:1], 80
    s_load_dwordx2 s[12:13], s[0:1], 0
    s_load_dwordx2 s[20:21], s[0:1], 64
    s_getpc_b64 s[6:7]
CODE_HERE:
    v_lshrrev_b32 v8, 6, v0
    s_lshr_b32 s5, s2, 3
    s_lshl_b32 s4, s5, 10
    v_readfirstlane_b32 s25, v8
    v_and_b32 v10, 7, v0
    v_lshl_add_u32 v10, v10, 7, s4
    v_min_u32 v10, END-CODE_HERE, v10
    s_cmp_lg_u32 s25, 7
    s_cbranch_scc1 NO_CODE_TOUCH
    global_load_dword v167, v10, s[6:7]
NO_CODE_TOUCH:
    s_mul_i32 s3, s2, 5120
    v_lshl_add_u32 v8, v0, 4, s3
    v_and_b32 v10, 63, v0
    v_lshlrev_b32 v1, 4, v10
    v_lshlrev_b32 v193, 2, v10
    v_lshlrev_b32 v11, 4, v0
    v_mov_b32 v12, 0
    v_mov_b32 v13, 0
    v_pk_mov_b32 v[16:17], v[12:13], v[12:13]
    v_pk_mov_b32 v[18:19], v[12:13], v[12:13]
    ds_write_b128 v11, v[16:19]
    s_cmp_ge_u32 s25, 5
    s_waitcnt lgkmcnt(0)
    s_cbranch_scc1 NO_EDGES
    s_cmp_ge_u32 s2, 250
    s_cbranch_scc1 AUX_LOAD
    s_setprio 1
    global_load_dwordx4 v[64:67], v8, s[44:45]
    global_load_dwordx4 v[68:71], v8, s[42:43]
NO_EDGES:
    s_add_u32 s4, s16, 8912896
    s_addc_u32 s5, s17, 0
    s_load_dwordx2 s[64:65], s[4:5], 0
    global_load_dword v188, v193, s[50:51] offset:0
    global_load_dword v189, v193, s[50:51] offset:256
    global_load_dword v190, v193, s[50:51] offset:512
    global_load_dword v191, v193, s[50:51] offset:768
    v_and_b32 v193, 0x7f, v193
    global_load_dword v192, v193, s[52:53]
    s_and_b32 s3, s2, 0x87
    s_cmp_eq_u32 s3, 0
    s_cselect_b32 s3, 128, 0
    s_add_u32 s3, s3, DEAL_TABLE-CODE_HERE
    v_lshl_add_u32 v174, v10, 1, s3
    global_load_ushort v174, v174, s[6:7]
    s_mov_b32 s14, 10240000
    s_mov_b32 s15, 0x20000
    v_lshlrev_b32 v9, 1, v8
    s_and_b32 s4, s2, 7
    s_lshl_b32 s4, s4, 5
    s_lshr_b32 s5, s2, 3
    s_or_b32 s24, s4, s5
    v_mov_b32 v15, 1
    s_mov_b32 s18, 8913024
    s_mov_b32 s19, 0x20000
    s_mov_b32 s22, 10240000
    s_mov_b32 s23, 0x20000
    s_mov_b32 s34, 0xfffffc00
    s_mov_b32 s27, 0
    s_mov_b32 s10, 0xbfb8aa3b
    s_mov_b32 s11, 0xbfb8aa3b
    s_mov_b32 s35, 2097152
    s_sub_u32 s61, 0, s2
    s_and_b32 s61, s61, 7
    s_mul_i32 s61, s61, 1280000
    v_and_b32 v4, 0xff, v0
    s_lshl_b32 s3, s24, 4
    s_add_u32 s3, s3, 7864320
    v_lshl_add_u32 v6, v4, 12, s3
    v_mul_u32_u24 v4, 1280, v4
    v_mul_u32_u24 v138, 0x8000, v1
    v_lshl_add_u32 v138, v10, 3, v138
    v_pk_mov_b32 v[20:21], v[12:13], v[12:13]
    v_pk_mov_b32 v[22:23], v[12:13], v[12:13]
    v_pk_mov_b32 v[24:25], v[12:13], v[12:13]
    v_pk_mov_b32 v[26:27], v[12:13], v[12:13]
    v_pk_mov_b32 v[28:29], v[12:13], v[12:13]
    v_pk_mov_b32 v[30:31], v[12:13], v[12:13]
    v_pk_mov_b32 v[32:33], v[12:13], v[12:13]
    v_pk_mov_b32 v[34:35], v[12:13], v[12:13]
    v_pk_mov_b32 v[36:37], v[12:13], v[12:13]
    v_pk_mov_b32 v[38:39], v[12:13], v[12:13]
    v_pk_mov_b32 v[40:41], v[12:13], v[12:13]
    v_pk_mov_b32 v[42:43], v[12:13], v[12:13]
    v_pk_mov_b32 v[44:45], v[12:13], v[12:13]
    v_pk_mov_b32 v[46:47], v[12:13], v[12:13]
    v_pk_mov_b32 v[48:49], v[12:13], v[12:13]
    v_pk_mov_b32 v[50:51], v[12:13], v[12:13]
    v_pk_mov_b32 v[52:53], v[12:13], v[12:13]
    v_pk_mov_b32 v[54:55], v[12:13], v[12:13]
    v_pk_mov_b32 v[56:57], v[12:13], v[12:13]
    v_pk_mov_b32 v[58:59], v[12:13], v[12:13]
    v_pk_mov_b32 v[60:61], v[12:13], v[12:13]
    v_pk_mov_b32 v[62:63], v[12:13], v[12:13]
    s_barrier
    s_cmp_ge_u32 s25, 5
    s_cbranch_scc1 HELP
    s_add_u32 s62, s25, 1
LUTP_W0L:
    s_mul_i32 s3, s62, 33554944
    s_add_u32 s3, s3, 4286709632
    v_add_u32 v128, s3, v138
    s_lshl_b32 s3, s62, 10
    v_add_u32 v136, s3, v1
    v_add_u32 v129, 131074, v128
    v_add_u32 v130, 262148, v128
    v_add_u32 v131, 393222, v128
    v_add_u32 v137, 0x10000, v136
    v_or_b32 v132, 0x80008000, v128
    v_or_b32 v133, 0x80008000, v129
    v_or_b32 v134, 0x80008000, v130
    v_or_b32 v135, 0x80008000, v131
    ds_write_b128 v136, v[128:131] offset:32768
    ds_write_b128 v137, v[132:135] offset:32768
    s_add_u32 s62, s62, 5
    s_cmp_le_u32 s62, 5
    s_cbranch_scc1 LUTP_W0L
LUTP_END_W0:
    s_cmp_ge_u32 s2, 250
    s_cbranch_scc1 AUX
    global_load_dwordx4 v[72:75], v9, s[46:47]
    global_load_dwordx4 v[76:79], v9, s[46:47] offset:16
    global_load_dwordx4 v[80:83], v9, s[48:49]
    global_load_dwordx4 v[84:87], v9, s[48:49] offset:16
    s_waitcnt vmcnt(11)
    v_and_b32 v88, 0xff, v64
    v_lshlrev_b32 v88, 2, v88
    ds_add_rtn_u32 v92, v88, v15 offset:2816
    v_and_b32 v89, 0xff, v65
    v_lshlrev_b32 v89, 2, v89
    ds_add_rtn_u32 v93, v89, v15 offset:2816
    v_and_b32 v90, 0xff, v66
    v_lshlrev_b32 v90, 2, v90
    ds_add_rtn_u32 v94, v90, v15 offset:2816
    v_and_b32 v91, 0xff, v67
    v_lshlrev_b32 v91, 2, v91
    ds_add_rtn_u32 v95, v91, v15 offset:2816
    s_waitcnt vmcnt(10)
    v_lshrrev_b32 v64, 8, v64
    v_lshl_or_b32 v108, v68, 10, v64
    v_lshrrev_b32 v65, 8, v65
    v_lshl_or_b32 v110, v69, 10, v65
    v_lshrrev_b32 v66, 8, v66
    v_lshl_or_b32 v112, v70, 10, v66
    v_lshrrev_b32 v67, 8, v67
    v_lshl_or_b32 v114, v71, 10, v67
    s_mov_b32 s9, 87040
    s_waitcnt lgkmcnt(0)
    s_barrier
    ds_read_b128 v[96:99], v1 offset:2816
    s_add_u32 s64, s64, 1
    s_and_b32 s65, s65, 0x3ff
    v_mov_b32 v109, s64
    v_mov_b32 v111, s64
    v_mov_b32 v113, s64
    v_mov_b32 v115, s64
    v_mov_b32 v119, 0
    v_cmp_gt_u32 vcc, 10, v92
    v_mul_u32_u24 v116, 6, v92
    v_lshlrev_b32 v117, 1, v88
    v_cndmask_b32 v118, 0, v64, vcc
    v_lshlrev_b64 v[120:121], v116, v[118:119]
    ds_or_b64 v117, v[120:121] offset:3840
    v_cmp_gt_u32 vcc, 10, v93
    v_mul_u32_u24 v116, 6, v93
    v_lshlrev_b32 v117, 1, v89
    v_cndmask_b32 v118, 0, v65, vcc
    v_lshlrev_b64 v[122:123], v116, v[118:119]
    ds_or_b64 v117, v[122:123] offset:3840
    v_cmp_gt_u32 vcc, 10, v94
    v_mul_u32_u24 v116, 6, v94
    v_lshlrev_b32 v117, 1, v90
    v_cndmask_b32 v118, 0, v66, vcc
    v_lshlrev_b64 v[120:121], v116, v[118:119]
    ds_or_b64 v117, v[120:121] offset:3840
    v_cmp_gt_u32 vcc, 10, v95
    v_mul_u32_u24 v116, 6, v95
    v_lshlrev_b32 v117, 1, v91
    v_cndmask_b32 v118, 0, v67, vcc
    v_lshlrev_b64 v[122:123], v116, v[118:119]
    ds_or_b64 v117, v[122:123] offset:3840
    s_waitcnt lgkmcnt(4)
    v_add_u32 v10, v96, v97
    v_add3_u32 v10, v10, v98, v99
    v_mov_b32 v11, v10
    s_nop 1
    v_add_u32_dpp v11, v11, v11 row_shr:1 row_mask:0xf bank_mask:0xf bound_ctrl:0
    s_nop 1
    v_add_u32_dpp v11, v11, v11 row_shr:2 row_mask:0xf bank_mask:0xf bound_ctrl:0
    s_nop 1
    v_add_u32_dpp v11, v11, v11 row_shr:4 row_mask:0xf bank_mask:0xf bound_ctrl:0
    s_nop 1
    v_add_u32_dpp v11, v11, v11 row_shr:8 row_mask:0xf bank_mask:0xf bound_ctrl:0
    s_nop 1
    v_add_u32_dpp v11, v11, v11 row_bcast:15 row_mask:0xa bank_mask:0xf
    s_nop 1
    v_add_u32_dpp v11, v11, v11 row_bcast:31 row_mask:0xc bank_mask:0xf
    v_sub_u32 v100, v11, v10
    v_add_u32 v101, v100, v96
    v_add_u32 v102, v101, v97
    v_add_u32 v103, v102, v98
    ds_write_b128 v1, v[100:103] offset:5888
    ds_read_b32 v96, v88 offset:5888
    ds_read_b32 v97, v89 offset:5888
    ds_read_b32 v98, v90 offset:5888
    ds_read_b32 v99, v91 offset:5888
    s_waitcnt lgkmcnt(3)
    v_add_u32 v92, v92, v96
    v_lshl_add_u32 v88, v92, 3, s9
    ds_write_b64 v88, v[108:109]
    s_waitcnt lgkmcnt(3)
    v_add_u32 v93, v93, v97
    v_lshl_add_u32 v89, v93, 3, s9
    ds_write_b64 v89, v[110:111]
    s_waitcnt lgkmcnt(3)
    v_add_u32 v94, v94, v98
    v_lshl_add_u32 v90, v94, 3, s9
    ds_write_b64 v90, v[112:113]
    s_waitcnt lgkmcnt(3)
    v_add_u32 v95, v95, v99
    v_lshl_add_u32 v91, v95, 3, s9
    ds_write_b64 v91, v[114:115]
    v_lshlrev_b32 v92, 4, v92
    v_add_u32 v92, 8704, v92
    v_lshlrev_b32 v93, 4, v93
    v_add_u32 v93, 8704, v93
    v_lshlrev_b32 v94, 4, v94
    v_add_u32 v94, 8704, v94
    v_lshlrev_b32 v95, 4, v95
    v_add_u32 v95, 8704, v95
    s_waitcnt lgkmcnt(0)
    s_barrier
    s_waitcnt vmcnt(0)
    s_cmp_eq_u32 s25, 4
    s_cbranch_scc1 NO_X_TOUCH_9
    s_lshr_b32 s33, s2, 3
    s_lshl_b32 s33, s33, 2
    s_add_u32 s33, s33, s25
    s_lshl_b32 s33, s33, 7
    s_add_u32 s33, s33, s61
    s_add_u32 s33, s33, 0
    v_min_u32 v166, 112, v1
    v_lshl_add_u32 v166, v166, 10, s33
    buffer_load_dword v167, v166, s[12:15], 0 offen
NO_X_TOUCH_9:
    ds_write2_b64 v92, v[72:73], v[80:81] offset0:0 offset1:1
    ds_write2_b64 v93, v[74:75], v[82:83] offset0:0 offset1:1
    ds_write2_b64 v94, v[76:77], v[84:85] offset0:0 offset1:1
    ds_write2_b64 v95, v[78:79], v[86:87] offset0:0 offset1:1
BINNED:
    s_setprio 0
    s_waitcnt lgkmcnt(0)
    s_barrier
    v_mov_b32 v2, 0
    s_call_b64 s[6:7], CONST_SUB
    s_cmp_gt_u32 s62, 24
    s_cbranch_scc1 LUTP_END_W
LUTP_WL:
    s_mul_i32 s3, s62, 33554944
    s_add_u32 s3, s3, 4286709632
    v_add_u32 v128, s3, v138
    s_lshl_b32 s3, s62, 10
    v_add_u32 v136, s3, v1
    v_add_u32 v129, 131074, v128
    v_add_u32 v130, 262148, v128
    v_add_u32 v131, 393222, v128
    v_add_u32 v137, 0x10000, v136
    v_or_b32 v132, 0x80008000, v128
    v_or_b32 v133, 0x80008000, v129
    v_or_b32 v134, 0x80008000, v130
    v_or_b32 v135, 0x80008000, v131
    ds_write_b128 v136, v[128:131] offset:32768
    ds_write_b128 v137, v[132:135] offset:32768
    s_add_u32 s62, s62, 5
    s_cmp_le_u32 s62, 24
    s_cbranch_scc1 LUTP_WL
LUTP_END_W:
    s_cmp_eq_u32 s25, 4
    s_cbranch_scc1 WAVE4
    s_add_u32 s62, s25, 34
    v_mov_b32 v132, 0x80008000
    v_mov_b32 v133, 0x80008000
    v_mov_b32 v134, 0x80008000
    v_mov_b32 v135, 0x80008000
LUTP_UH:
    s_mul_i32 s3, s62, 33554944
    s_add_u32 s3, s3, 131072
    v_add_u32 v128, s3, v138
    s_lshl_b32 s3, s62, 10
    v_add_u32 v136, s3, v1
    v_add_u32 v129, 131074, v128
    v_add_u32 v130, 262148, v128
    v_add_u32 v131, 393222, v128
    v_add_u32 v137, 0x10000, v136
    ds_write_b128 v136, v[128:131] offset:32768
    ds_write_b128 v137, v[132:135] offset:32768
    s_add_u32 s62, s62, 4
    s_cmp_le_u32 s62, 62
    s_cbranch_scc1 LUTP_UH
LUTP_END_U:
    buffer_load_dwordx4 v[168:171], v6, s[16:19], 0 offen sc1
POLL_TAB:
    s_waitcnt vmcnt(0)
CHECK_TAB:
    v_lshrrev_b32 v11, 22, v168
    v_cmp_ne_u32 vcc, s64, v169
    v_cmp_ne_u32 s[42:43], s65, v11
    s_or_b64 vcc, vcc, s[42:43]
    s_and_b64 exec, exec, vcc
    s_cbranch_execz POLLED_TAB
    s_sub_u32 s35, s35, 1
    s_cbranch_scc1 END
    buffer_load_dwordx4 v[168:171], v6, s[16:19], 0 offen sc1
    s_branch POLL_TAB
POLLED_TAB:
    s_mov_b64 exec, -1
    s_branch TAB_DONE
LUT_SUB:
    s_lshl_b32 s3, s62, 25
    s_add_u32 s3, s3, 0x8000
    v_lshl_add_u32 v128, v1, 15, s3
    v_add_u32 v129, 0x10000, v128
    v_add_u32 v130, 0x10000, v129
    v_add_u32 v131, 0x10000, v130
    v_add_u32 v132, 0x10000, v131
    v_add_u32 v133, 0x10000, v132
    v_add_u32 v134, 0x10000, v133
    v_add_u32 v135, 0x10000, v134
    v_pk_mul_f32 v[136:137], v[128:129], s[10:11]
    v_pk_mul_f32 v[138:139], v[130:131], s[10:11]
    v_pk_mul_f32 v[140:141], v[132:133], s[10:11]
    v_pk_mul_f32 v[142:143], v[134:135], s[10:11]
    v_exp_f32 v136, v136
    v_exp_f32 v137, v137
    v_exp_f32 v138, v138
    v_exp_f32 v139, v139
    v_exp_f32 v140, v140
    v_exp_f32 v141, v141
    v_exp_f32 v142, v142
    v_exp_f32 v143, v143
    s_lshl_b32 s3, s62, 10
    v_pk_add_f32 v[144:145], v[136:137], 1.0 op_sel_hi:[1,0]
    v_pk_add_f32 v[146:147], v[138:139], 1.0 op_sel_hi:[1,0]
    v_pk_add_f32 v[148:149], v[140:141], 1.0 op_sel_hi:[1,0]
    v_pk_add_f32 v[150:151], v[142:143], 1.0 op_sel_hi:[1,0]
    v_rcp_f32 v144, v144
    v_rcp_f32 v145, v145
    v_rcp_f32 v146, v146
    v_rcp_f32 v147, v147
    v_rcp_f32 v148, v148
    v_rcp_f32 v149, v149
    v_rcp_f32 v150, v150
    v_rcp_f32 v151, v151
    v_add_u32 v160, s3, v1
    v_pk_mul_f32 v[128:129], v[128:129], v[144:145]
    v_pk_mul_f32 v[130:131], v[130:131], v[146:147]
    v_pk_mul_f32 v[132:133], v[132:133], v[148:149]
    v_pk_mul_f32 v[134:135], v[134:135], v[150:151]
    v_add_u32 v161, 0x10000, v160
    v_pk_mul_f32 v[136:137], v[128:129], v[136:137] neg_lo:[1,0] neg_hi:[1,0]
    v_pk_mul_f32 v[138:139], v[130:131], v[138:139] neg_lo:[1,0] neg_hi:[1,0]
    v_pk_mul_f32 v[140:141], v[132:133], v[140:141] neg_lo:[1,0] neg_hi:[1,0]
    v_pk_mul_f32 v[142:143], v[134:135], v[142:143] neg_lo:[1,0] neg_hi:[1,0]
    v_cvt_pk_bf16_f32 v152, v128, v129
    v_cvt_pk_bf16_f32 v153, v130, v131
    v_cvt_pk_bf16_f32 v154, v132, v133
    v_cvt_pk_bf16_f32 v155, v134, v135
    v_cvt_pk_bf16_f32 v156, v136, v137
    v_cvt_pk_bf16_f32 v157, v138, v139
    v_cvt_pk_bf16_f32 v158, v140, v141
    v_cvt_pk_bf16_f32 v159, v142, v143
    ds_write_b128 v160, v[152:155] offset:32768
    ds_write_b128 v161, v[156:159] offset:32768
    s_add_u32 s62, s62, 1
    s_sub_u32 s63, s63, 1
    s_cmp_lg_u32 s63, 0
    s_cbranch_scc1 LUT_SUB
    s_setpc_b64 s[6:7]
CONST_SUB:
    ds_write_b32 v193, v192 offset:32256
    v_lshrrev_b32 v193, 3, v1
    v_and_b32 v193, 24, v193
    s_mov_b32 s4, 0x05040100
    s_mov_b32 s5, 0x07060302
    ds_read_b64_tr_b16 v[180:181], v193 offset:32256
    ds_read_b64_tr_b16 v[182:183], v193 offset:32288
    ds_read_b64_tr_b16 v[184:185], v193 offset:32320
    ds_read_b64_tr_b16 v[186:187], v193 offset:32352
    v_perm_b32 v176, v189, v188, s4
    v_perm_b32 v178, v189, v188, s5
    v_perm_b32 v177, v191, v190, s4
    v_perm_b32 v179, v191, v190, s5
    s_setpc_b64 s[6:7]
HELP:
    s_sub_u32 s8, s25, 5
    s_mul_i32 s4, s8, 3072
    s_cmp_eq_u32 s8, 1
    s_cselect_b32 s4, 4096, s4
    s_mul_i32 s3, s2, 10240
    s_add_u32 s3, s3, s4
    v_add_u32 v8, s3, v1
    s_add_u32 s4, s4, 87040
    v_add_u32 v9, s4, v1
    s_mul_i32 s4, s8, 7168
    s_mul_i32 s3, s2, 20480
    s_add_u32 s3, s3, s4
    s_add_u32 s3, s3, 2621440
    v_add_u32 v12, s3, v1
    v_add_u32 v13, s4, v1
    s_lshl_b32 s3, s2, 12
    s_add_u32 s3, s3, 7864320
    v_add_u32 v117, s3, v1
    s_waitcnt lgkmcnt(0)
    s_add_u32 s64, s64, 1
    s_and_b32 s65, s65, 0x3ff
    s_barrier
    s_cmp_eq_u32 s25, 6
    s_cbranch_scc1 ROW
    s_cmp_eq_u32 s25, 7
    s_cselect_b32 s62, 63, 0
    s_mov_b32 s63, 1
    s_call_b64 s[6:7], LUT_SUB
    s_waitcnt vmcnt(0)
    s_call_b64 s[6:7], CONST_SUB
    v_mov_b32 v10, 65280
    v_mov_b32 v11, 0x7f80
    s_cmp_lg_u32 s25, 7
    s_cbranch_scc1 NO_ROW
    ds_write_b16 v10, v11 offset:32768
    s_branch NO_ROW
ROW:
    v_lshrrev_b32 v116, 2, v1
    ds_read_b32 v100, v116 offset:2816
    ds_read_b32 v101, v116 offset:3072
    ds_read_b32 v102, v116 offset:3328
    ds_read_b32 v103, v116 offset:3584
    s_lshl_b32 s3, s2, 12
    s_add_u32 s3, s3, 7864320
    v_add_u32 v117, s3, v1
    v_lshrrev_b32 v116, 1, v1
    s_lshl_b32 s3, s65, 22
    s_waitcnt lgkmcnt(0)
    v_mov_b32 v104, v100
    v_mov_b32 v105, v101
    v_mov_b32 v106, v102
    v_mov_b32 v107, v103
    s_nop 0
    v_add_u32_dpp v104, v104, v104 row_shr:1 row_mask:0xf bank_mask:0xf bound_ctrl:0
    v_add_u32_dpp v105, v105, v105 row_shr:1 row_mask:0xf bank_mask:0xf bound_ctrl:0
    v_add_u32_dpp v106, v106, v106 row_shr:1 row_mask:0xf bank_mask:0xf bound_ctrl:0
    v_add_u32_dpp v107, v107, v107 row_shr:1 row_mask:0xf bank_mask:0xf bound_ctrl:0
    s_nop 0
    v_add_u32_dpp v104, v104, v104 row_shr:2 row_mask:0xf bank_mask:0xf bound_ctrl:0
    v_add_u32_dpp v105, v105, v105 row_shr:2 row_mask:0xf bank_mask:0xf bound_ctrl:0
    v_add_u32_dpp v106, v106, v106 row_shr:2 row_mask:0xf bank_mask:0xf bound_ctrl:0
    v_add_u32_dpp v107, v107, v107 row_shr:2 row_mask:0xf bank_mask:0xf bound_ctrl:0
    s_nop 0
    v_add_u32_dpp v104, v104, v104 row_shr:4 row_mask:0xf bank_mask:0xf bound_ctrl:0
    v_add_u32_dpp v105, v105, v105 row_shr:4 row_mask:0xf bank_mask:0xf bound_ctrl:0
    v_add_u32_dpp v106, v106, v106 row_shr:4 row_mask:0xf bank_mask:0xf bound_ctrl:0
    v_add_u32_dpp v107, v107, v107 row_shr:4 row_mask:0xf bank_mask:0xf bound_ctrl:0
    s_nop 0
    v_add_u32_dpp v104, v104, v104 row_shr:8 row_mask:0xf bank_mask:0xf bound_ctrl:0
    v_add_u32_dpp v105, v105, v105 row_shr:8 row_mask:0xf bank_mask:0xf bound_ctrl:0
    v_add_u32_dpp v106, v106, v106 row_shr:8 row_mask:0xf bank_mask:0xf bound_ctrl:0
    v_add_u32_dpp v107, v107, v107 row_shr:8 row_mask:0xf bank_mask:0xf bound_ctrl:0
    s_nop 0
    v_add_u32_dpp v104, v104, v104 row_bcast:15 row_mask:0xa bank_mask:0xf
    v_add_u32_dpp v105, v105, v105 row_bcast:15 row_mask:0xa bank_mask:0xf
    v_add_u32_dpp v106, v106, v106 row_bcast:15 row_mask:0xa bank_mask:0xf
    v_add_u32_dpp v107, v107, v107 row_bcast:15 row_mask:0xa bank_mask:0xf
    s_nop 0
    v_add_u32_dpp v104, v104, v104 row_bcast:31 row_mask:0xc bank_mask:0xf
    v_add_u32_dpp v105, v105, v105 row_bcast:31 row_mask:0xc bank_mask:0xf
    v_add_u32_dpp v106, v106, v106 row_bcast:31 row_mask:0xc bank_mask:0xf
    v_add_u32_dpp v107, v107, v107 row_bcast:31 row_mask:0xc bank_mask:0xf
    v_readlane_b32 s4, v104, 63
    v_readlane_b32 s5, v105, 63
    v_readlane_b32 s9, v106, 63
    v_sub_u32 v104, v104, v100
    v_sub_u32 v105, v105, v101
    v_sub_u32 v106, v106, v102
    v_sub_u32 v107, v107, v103
    s_add_u32 s5, s5, s4
    s_add_u32 s9, s9, s5
    v_add_u32 v105, s4, v105
    v_add_u32 v106, s5, v106
    v_add_u32 v107, s9, v107
    v_lshl_or_b32 v84, v100, 11, v104
    v_or_b32 v84, s3, v84
    v_mov_b32 v85, s64
    v_lshl_or_b32 v88, v101, 11, v105
    v_or_b32 v88, s3, v88
    v_mov_b32 v89, s64
    v_lshl_or_b32 v92, v102, 11, v106
    v_or_b32 v92, s3, v92
    v_mov_b32 v93, s64
    v_lshl_or_b32 v96, v103, 11, v107
    v_or_b32 v96, s3, v96
    v_mov_b32 v97, s64
    s_waitcnt vmcnt(0)
    s_call_b64 s[6:7], CONST_SUB
NO_ROW:
    s_barrier
    s_cmp_lg_u32 s25, 6
    s_cbranch_scc1 ROW_DONE
    ds_read_b64 v[86:87], v116 offset:3840
    ds_read_b64 v[90:91], v116 offset:4352
    ds_read_b64 v[94:95], v116 offset:4864
    ds_read_b64 v[98:99], v116 offset:5376
    s_waitcnt lgkmcnt(3)
    global_store_dwordx4 v117, v[84:87], s[16:17] offset:0 sc0 sc1
    s_waitcnt lgkmcnt(2)
    global_store_dwordx4 v117, v[88:91], s[16:17] offset:1024 sc0 sc1
    s_waitcnt lgkmcnt(1)
    global_store_dwordx4 v117, v[92:95], s[16:17] offset:2048 sc0 sc1
    s_waitcnt lgkmcnt(0)
    global_store_dwordx4 v117, v[96:99], s[16:17] offset:3072 sc0 sc1
ROW_DONE:
    ds_read_b128 v[64:67], v9 offset:0
    ds_read_b128 v[68:71], v9 offset:1024
    ds_read_b128 v[72:75], v9 offset:2048
    ds_read_b128 v[76:79], v9 offset:3072
    v_mov_b32 v2, 0
    s_add_u32 s62, s8, s8
    s_add_u32 s62, s62, 27
    s_cmp_eq_u32 s8, 2
    s_addc_u32 s62, s62, 0
    s_cmp_eq_u32 s8, 1
    s_cselect_b32 s63, 3, 2
    s_waitcnt lgkmcnt(0)
    s_barrier
    s_cmp_ge_u32 s2, 250
    s_cbranch_scc1 RECS_STORED
    ds_read_b128 v[84:87], v13 offset:8704
    ds_read_b128 v[88:91], v13 offset:9728
    ds_read_b128 v[92:95], v13 offset:10752
    ds_read_b128 v[96:99], v13 offset:11776
    ds_read_b128 v[100:103], v13 offset:12800
    ds_read_b128 v[104:107], v13 offset:13824
    ds_read_b128 v[108:111], v13 offset:14848
    s_waitcnt lgkmcnt(6)
    global_store_dwordx4 v12, v[84:87], s[16:17] offset:0 sc0 sc1
    s_waitcnt lgkmcnt(5)
    global_store_dwordx4 v12, v[88:91], s[16:17] offset:1024 sc0 sc1
    s_waitcnt lgkmcnt(4)
    global_store_dwordx4 v12, v[92:95], s[16:17] offset:2048 sc0 sc1
    s_waitcnt lgkmcnt(3)
    global_store_dwordx4 v12, v[96:99], s[16:17] offset:3072 sc0 sc1
    v_add_u32 v12, 4096, v12
    s_waitcnt lgkmcnt(2)
    global_store_dwordx4 v12, v[100:103], s[16:17] offset:0 sc0 sc1
    s_waitcnt lgkmcnt(1)
    global_store_dwordx4 v12, v[104:107], s[16:17] offset:1024 sc0 sc1
    s_cmp_eq_u32 s8, 2
    s_cbranch_scc1 RECS_STORED
    s_waitcnt lgkmcnt(0)
    global_store_dwordx4 v12, v[108:111], s[16:17] offset:2048 sc0 sc1
RECS_STORED:
    s_call_b64 s[6:7], LUT_SUB
    s_cmp_ge_u32 s2, 250
    s_cbranch_scc1 TAB_DONE
    v_mov_b32 v10, 0
    s_waitcnt vmcnt(0)
    s_mov_b64 exec, 1
    ds_add_u32 v10, v15 offset:1296
    s_mov_b64 exec, -1
WAIT_ACK:
    ds_read_b32 v11, v10 offset:1296
    s_waitcnt lgkmcnt(0)
    v_readfirstlane_b32 s3, v11
    s_cmp_eq_u32 s3, 3
    s_cbranch_scc0 WAIT_ACK
    global_store_dwordx4 v8, v[64:67], s[16:17] offset:0 sc0 sc1
    global_store_dwordx4 v8, v[68:71], s[16:17] offset:1024 sc0 sc1
    s_cmp_eq_u32 s8, 1
    s_cbranch_scc1 KEYS_OUT
    global_store_dwordx4 v8, v[72:75], s[16:17] offset:2048 sc0 sc1
    global_store_dwordx4 v8, v[76:79], s[16:17] offset:3072 sc0 sc1
KEYS_OUT:
    s_lshr_b32 s33, s2, 3
    s_mul_i32 s33, s33, 3
    s_add_u32 s33, s33, s8
    s_lshl_b32 s33, s33, 7
    s_add_u32 s33, s33, s61
    s_add_u32 s33, s33, 131072
    v_min_u32 v166, 416, v1
    v_mul_u32_u24 v166, 768, v166
    buffer_load_dword v167, v166, s[12:15], s33 offen
    s_branch TAB_DONE
AUX_LOAD:
    s_sub_u32 s4, s2, 250
    s_cmp_ge_u32 s4, 4
    s_cbranch_scc1 NO_EDGES
    s_cmp_ge_u32 s25, 4
    s_cbranch_scc1 NO_EDGES
    s_lshl_b32 s5, s25, 13
    s_lshl_b32 s8, s4, 6
    s_add_u32 s5, s5, s8
    v_lshrrev_b32 v80, 8, v1
    v_lshlrev_b32 v80, 11, v80
    v_bfe_u32 v81, v1, 4, 4
    v_lshl_add_u32 v80, v81, 2, v80
    v_add_u32 v80, s5, v80
    global_load_dword v64, v80, s[54:55] offset:0
    global_load_dword v65, v80, s[54:55] offset:256
    global_load_dword v66, v80, s[54:55] offset:512
    global_load_dword v67, v80, s[54:55] offset:768
    global_load_dword v68, v80, s[54:55] offset:1024
    global_load_dword v69, v80, s[54:55] offset:1280
    global_load_dword v70, v80, s[54:55] offset:1536
    global_load_dword v71, v80, s[54:55] offset:1792
    s_branch NO_EDGES
AUX:
    s_cmp_ge_u32 s2, 254
    s_cbranch_scc1 AUX_DONE
    s_cmp_ge_u32 s25, 4
    s_cbranch_scc1 AUX_DONE
    s_sub_u32 s4, s2, 250
    s_lshl_b32 s5, s4, 13
    s_lshl_b32 s8, s25, 10
    s_add_u32 s5, s5, s8
    s_add_u32 s5, s5, 7802880
    v_add_u32 v81, s5, v1
    s_mov_b32 s4, 0x05040100
    s_mov_b32 s5, 0x07060302
    s_waitcnt vmcnt(6)
    v_perm_b32 v72, v65, v64, s4
    v_perm_b32 v76, v65, v64, s5
    v_perm_b32 v73, v67, v66, s4
    v_perm_b32 v77, v67, v66, s5
    v_perm_b32 v74, v69, v68, s4
    v_perm_b32 v78, v69, v68, s5
    v_perm_b32 v75, v71, v70, s4
    v_perm_b32 v79, v71, v70, s5
    global_store_dwordx4 v81, v[72:75], s[16:17] sc0 sc1
    v_add_u32 v81, 4096, v81
    global_store_dwordx4 v81, v[76:79], s[16:17] sc0 sc1
AUX_DONE:
    s_waitcnt lgkmcnt(0)
    s_add_u32 s64, s64, 1
    s_and_b32 s65, s65, 0x3ff
    s_barrier
    s_waitcnt vmcnt(0)
    s_barrier
    s_branch BINNED
WAVE4:
    s_mov_b32 s62, 25
    s_mov_b32 s63, 2
    s_call_b64 s[6:7], LUT_SUB
TAB_DONE:
    s_cmp_ge_u32 s25, 4
    s_cbranch_scc1 TOTALS
    v_and_b32 v13, 0x7ff, v168
    v_bfe_u32 v2, v168, 11, 11
    v_add_u32 v4, v4, v13
    v_mov_b32 v3, v2
    s_nop 1
    v_add_u32_dpp v3, v3, v3 row_shr:1 row_mask:0xf bank_mask:0xf bound_ctrl:0
    s_nop 1
    v_add_u32_dpp v3, v3, v3 row_shr:2 row_mask:0xf bank_mask:0xf bound_ctrl:0
    s_nop 1
    v_add_u32_dpp v3, v3, v3 row_shr:4 row_mask:0xf bank_mask:0xf bound_ctrl:0
    s_nop 1
    v_add_u32_dpp v3, v3, v3 row_shr:8 row_mask:0xf bank_mask:0xf bound_ctrl:0
    s_nop 1
    v_add_u32_dpp v3, v3, v3 row_bcast:15 row_mask:0xa bank_mask:0xf
    s_nop 1
    v_add_u32_dpp v3, v3, v3 row_bcast:31 row_mask:0xc bank_mask:0xf
    s_lshl_b32 s3, s25, 2
    v_mov_b32 v10, s3
    v_add_u32 v11, 1, v3
    v_sub_u32 v3, v3, v2
    s_mov_b32 exec_lo, 0
    s_mov_b32 exec_hi, 0x80000000
    ds_write_b32 v10, v11 offset:1280
    s_mov_b64 exec, -1
TOTALS:
    v_mov_b32 v10, 0
TOTALS_SPIN:
    ds_read_b128 v[64:67], v10 offset:1280
    s_waitcnt lgkmcnt(0)
    v_readfirstlane_b32 s4, v64
    v_readfirstlane_b32 s5, v65
    v_readfirstlane_b32 s6, v66
    v_readfirstlane_b32 s7, v67
    s_min_u32 s3, s4, s5
    s_min_u32 s8, s6, s7
    s_min_u32 s3, s3, s8
    s_cmp_eq_u32 s3, 0
    s_cbranch_scc0 TOTALS_OK
    s_sub_u32 s35, s35, 1
    s_cbranch_scc0 TOTALS_SPIN
    s_endpgm
TOTALS_OK:
    s_add_u32 s5, s5, s4
    s_add_u32 s6, s6, s5
    s_add_u32 s7, s7, s6
    s_sub_u32 s26, s7, 4
    s_cmp_eq_u32 s25, 1
    s_cselect_b32 s3, s4, 0
    s_cmp_eq_u32 s25, 2
    s_cselect_b32 s3, s5, s3
    s_cmp_eq_u32 s25, 3
    s_cselect_b32 s3, s6, s3
    s_sub_u32 s3, s3, s25
    v_add_u32 v3, s3, v3
    s_cmp_lg_u32 s25, 4
    s_cbranch_scc1 EPOCH_DONE
    s_cmp_lg_u32 s2, 0
    s_cbranch_scc1 EPOCH_DONE
    v_mov_b32 v12, s64
    v_mov_b32 v10, 8912896
    s_mov_b64 exec, 1
    global_store_dword v10, v12, s[16:17] sc0 sc1
    s_mov_b64 exec, -1
EPOCH_DONE:
    s_lshr_b32 s33, s2, 3
    s_lshl_b32 s33, s33, 3
    s_add_u32 s33, s33, s25
    s_lshl_b32 s33, s33, 7
    s_add_u32 s33, s33, s61
    s_add_u32 s33, s33, 458752
    v_min_u32 v166, 208, v1
    v_lshl_add_u32 v166, v166, 11, s33
    buffer_load_dword v167, v166, s[12:15], 0 offen
NO_X_TOUCH_3:
ROUND:
    v_mov_b32 v8, 0
    v_subrev_u32 v9, s27, v3
    v_mov_b32 v10, v4
    s_mov_b32 s3, 1472
    s_cmp_gt_u32 s26, 1472
    s_cbranch_scc1 EXPAND
    v_lshlrev_b32 v11, 2, v3
    v_cmpx_lt_u32 vcc, 0, v2
    ds_write_b32 v11, v10 offset:2816
    v_add_u32 v10, 1, v10
    v_cmpx_lt_u32 vcc, 1, v2
    ds_write_b32 v11, v10 offset:2820
    v_add_u32 v10, 1, v10
    v_cmpx_lt_u32 vcc, 2, v2
    ds_write_b32 v11, v10 offset:2824
    v_add_u32 v10, 1, v10
    v_cmpx_lt_u32 vcc, 3, v2
    ds_write_b32 v11, v10 offset:2828
    v_add_u32 v10, 1, v10
    v_cmpx_lt_u32 vcc, 4, v2
    ds_write_b32 v11, v10 offset:2832
    v_add_u32 v10, 1, v10
    v_cmpx_lt_u32 vcc, 5, v2
    ds_write_b32 v11, v10 offset:2836
    v_add_u32 v10, 1, v10
    v_cmpx_lt_u32 vcc, 6, v2
    s_cbranch_execz EXPAND_DONE
    ds_write_b32 v11, v10 offset:2840
    v_add_u32 v10, 1, v10
    v_cmpx_lt_u32 vcc, 7, v2
    ds_write_b32 v11, v10 offset:2844
    v_add_u32 v10, 1, v10
    v_cmpx_lt_u32 vcc, 8, v2
    s_cbranch_execz EXPAND_DONE
    ds_write_b32 v11, v10 offset:2848
    v_add_u32 v10, 1, v10
    v_cmpx_lt_u32 vcc, 9, v2
    ds_write_b32 v11, v10 offset:2852
    v_add_u32 v10, 1, v10
    v_cmpx_lt_u32 vcc, 10, v2
    s_cbranch_execz EXPAND_DONE
    ds_write_b32 v11, v10 offset:2856
    v_add_u32 v10, 1, v10
    v_cmpx_lt_u32 vcc, 11, v2
    ds_write_b32 v11, v10 offset:2860
    v_add_u32 v10, 1, v10
    v_cmpx_lt_u32 vcc, 12, v2
    s_cbranch_execz EXPAND_DONE
    ds_write_b32 v11, v10 offset:2864
    v_add_u32 v10, 1, v10
    v_cmpx_lt_u32 vcc, 13, v2
    ds_write_b32 v11, v10 offset:2868
    v_add_u32 v10, 1, v10
    v_cmpx_lt_u32 vcc, 14, v2
    s_cbranch_execz EXPAND_DONE
    ds_write_b32 v11, v10 offset:2872
    v_add_u32 v10, 1, v10
    v_cmpx_lt_u32 vcc, 15, v2
    ds_write_b32 v11, v10 offset:2876
    v_add_u32 v10, 1, v10
    v_mov_b32 v8, 16
    v_add_u32 v9, 16, v9
EXPAND:
    v_cmp_lt_u32 vcc, v8, v2
    s_and_b64 exec, exec, vcc
    s_cbranch_execz EXPAND_DONE
    v_cmp_gt_u32 vcc, s3, v9
    v_lshlrev_b32 v11, 2, v9
    s_and_saveexec_b64 s[42:43], vcc
    ds_write_b32 v11, v10 offset:2816
    s_mov_b64 exec, s[42:43]
    v_add_u32 v8, 1, v8
    v_add_u32 v9, 1, v9
    v_add_u32 v10, 1, v10
    s_branch EXPAND
EXPAND_DONE:
    s_mov_b64 exec, -1
    s_sub_u32 s28, s26, s27
    s_min_u32 s28, s28, 1472
    v_lshlrev_b32 v8, 2, v0
    v_add_u32 v9, 0, v0
    v_cmp_gt_u32 s[36:37], s28, v9
    v_add_u32 v9, 512, v0
    v_cmp_gt_u32 s[38:39], s28, v9
    v_add_u32 v9, 1024, v0
    v_cmp_gt_u32 s[40:41], s28, v9
    s_waitcnt lgkmcnt(0)
    s_barrier
    ds_read_b32 v64, v8 offset:2816
    ds_read_b32 v65, v8 offset:4864
    ds_read_b32 v66, v8 offset:6912
    s_mov_b32 s44, 13421
    s_and_b32 s45, s2, 7
    s_mul_i32 s45, s45, 4
    s_waitcnt lgkmcnt(0)
    v_lshlrev_b32 v68, 3, v64
    v_lshlrev_b32 v64, 4, v64
    v_lshlrev_b32 v69, 3, v65
    v_lshlrev_b32 v65, 4, v65
    v_lshlrev_b32 v70, 3, v66
    v_lshlrev_b32 v66, 4, v66
    s_mov_b64 exec, s[40:41]
    s_cbranch_execz SKIP3
    buffer_load_dwordx2 v[100:101], v70, s[16:19], 0 offen sc1
SKIP3:
    s_mov_b64 exec, s[36:37]
    buffer_load_dwordx2 v[96:97], v68, s[16:19], 0 offen sc1
    s_mov_b64 exec, s[38:39]
    buffer_load_dwordx2 v[98:99], v69, s[16:19], 0 offen sc1
    s_mov_b64 exec, -1
    v_lshrrev_b32 v8, 4, v1
    s_cmp_lg_u32 s27, 0
    s_cbranch_scc1 KEY_WAIT
    s_cmp_ge_u32 s25, 4
    s_cbranch_scc1 DEG_DONE
    v_bfe_u32 v9, v170, 0, 6
    v_lshlrev_b32 v9, 2, v9
    v_cmpx_lt_u32 vcc, 0, v2
    ds_add_u32 v9, v15 offset:1024
    v_bfe_u32 v10, v170, 6, 6
    v_lshlrev_b32 v10, 2, v10
    v_cmpx_lt_u32 vcc, 1, v2
    ds_add_u32 v10, v15 offset:1024
    v_bfe_u32 v9, v170, 12, 6
    v_lshlrev_b32 v9, 2, v9
    v_cmpx_lt_u32 vcc, 2, v2
    ds_add_u32 v9, v15 offset:1024
    v_bfe_u32 v10, v170, 18, 6
    v_lshlrev_b32 v10, 2, v10
    v_cmpx_lt_u32 vcc, 3, v2
    ds_add_u32 v10, v15 offset:1024
    v_bfe_u32 v9, v170, 24, 6
    v_lshlrev_b32 v9, 2, v9
    v_cmpx_lt_u32 vcc, 4, v2
    ds_add_u32 v9, v15 offset:1024
    v_alignbit_b32 v10, v171, v170, 30
    v_and_b32 v10, 63, v10
    v_lshlrev_b32 v10, 2, v10
    v_cmpx_lt_u32 vcc, 5, v2
    ds_add_u32 v10, v15 offset:1024
    v_bfe_u32 v9, v171, 4, 6
    v_lshlrev_b32 v9, 2, v9
    v_cmpx_lt_u32 vcc, 6, v2
    ds_add_u32 v9, v15 offset:1024
    v_bfe_u32 v10, v171, 10, 6
    v_lshlrev_b32 v10, 2, v10
    v_cmpx_lt_u32 vcc, 7, v2
    ds_add_u32 v10, v15 offset:1024
    v_bfe_u32 v9, v171, 16, 6
    v_lshlrev_b32 v9, 2, v9
    v_cmpx_lt_u32 vcc, 8, v2
    ds_add_u32 v9, v15 offset:1024
    v_bfe_u32 v10, v171, 22, 6
    v_lshlrev_b32 v10, 2, v10
    v_cmpx_lt_u32 vcc, 9, v2
    ds_add_u32 v10, v15 offset:1024
    s_mov_b64 exec, -1
DEG_DONE:
    v_lshlrev_b32 v9, 2, v8
    v_cmp_gt_u32 s[42:43], 40, v8
    v_sub_u32 v10, 63, v8
    s_mul_i32 s10, s25, 5
    s_waitcnt lgkmcnt(0)
    s_barrier
    ds_read_b32 v84, v9 offset:1024
    v_add_u32 v11, s10, v8
    v_lshlrev_b32 v12, 2, v11
    s_waitcnt lgkmcnt(0)
    v_lshl_or_b32 v84, v84, 6, v10
    v_cndmask_b32 v84, 0, v84, s[42:43]
    s_nop 0
    v_readlane_b32 s4, v84, s10
    s_add_u32 s10, s10, 1
    v_readlane_b32 s5, v84, s10
    s_add_u32 s10, s10, 1
    v_readlane_b32 s6, v84, s10
    s_add_u32 s10, s10, 1
    v_readlane_b32 s7, v84, s10
    s_add_u32 s10, s10, 1
    v_readlane_b32 s8, v84, s10
    v_cmp_lt_u32 s[48:49], s4, v84
    v_cmp_lt_u32 s[50:51], s5, v84
    v_cmp_lt_u32 s[52:53], s6, v84
    v_cmp_lt_u32 s[54:55], s7, v84
    v_cmp_lt_u32 s[56:57], s8, v84
    s_bcnt1_i32_b64 s4, s[48:49]
    s_bcnt1_i32_b64 s5, s[50:51]
    s_bcnt1_i32_b64 s6, s[52:53]
    s_bcnt1_i32_b64 s7, s[54:55]
    s_bcnt1_i32_b64 s8, s[56:57]
    v_readlane_b32 s4, v174, s4
    v_readlane_b32 s5, v174, s5
    v_readlane_b32 s6, v174, s6
    v_readlane_b32 s7, v174, s7
    v_readlane_b32 s8, v174, s8
    s_nop 0
    v_writelane_b32 v9, s4, 0
    v_writelane_b32 v9, s5, 1
    v_writelane_b32 v9, s6, 2
    v_writelane_b32 v9, s7, 3
    v_writelane_b32 v9, s8, 4
    v_lshrrev_b32 v10, 11, v9
    v_bfe_u32 v13, v9, 8, 3
    v_lshlrev_b32 v10, 7, v10
    v_and_b32 v9, 0xff, v9
    v_lshl_or_b32 v10, v13, 19, v10
    s_mov_b64 exec, 0x1f
    ds_write_b32 v9, v11 offset:1344
    ds_write_b32 v12, v10 offset:1536
    s_mov_b64 exec, -1
    s_waitcnt lgkmcnt(0)
    s_barrier
KEY_WAIT:
    s_lshl_b32 s3, s25, 10
    s_add_u32 s3, s3, 8704
    s_mov_b32 s9, 2621440
KEY_WAIT0:
    s_waitcnt vmcnt(0)
    v_cmp_ne_u32 s[48:49], s64, v97
    v_cmp_ne_u32 s[50:51], s64, v99
    v_cmp_ne_u32 s[52:53], s64, v101
    v_and_b32 v72, 63, v96
    v_lshlrev_b32 v72, 2, v72
    v_and_b32 v73, 63, v98
    v_lshlrev_b32 v73, 2, v73
    v_and_b32 v74, 63, v100
    v_lshlrev_b32 v74, 2, v74
    s_and_b64 s[48:49], s[48:49], s[36:37]
    s_and_b64 s[50:51], s[50:51], s[38:39]
    s_and_b64 s[52:53], s[52:53], s[40:41]
    s_or_b64 s[48:49], s[48:49], s[50:51]
    s_or_b64 s[48:49], s[48:49], s[52:53]
    s_cbranch_scc0 KEYS_OK
    s_sub_u32 s35, s35, 1
    s_cbranch_scc1 END
    s_mov_b64 exec, s[40:41]
    s_cbranch_execz SKIP3R
    buffer_load_dwordx2 v[100:101], v70, s[16:19], 0 offen sc1
SKIP3R:
    s_mov_b64 exec, s[36:37]
    buffer_load_dwordx2 v[96:97], v68, s[16:19], 0 offen sc1
    s_mov_b64 exec, s[38:39]
    buffer_load_dwordx2 v[98:99], v69, s[16:19], 0 offen sc1
    s_mov_b64 exec, -1
    s_branch KEY_WAIT0
KEYS_OK:
    ds_read_b32 v72, v72 offset:1536
    ds_read_b32 v73, v73 offset:1536
    ds_read_b32 v74, v74 offset:1536
    s_add_u32 m0, s3, 16384
    s_mov_b64 exec, s[40:41]
    s_cbranch_execz SKIP3D
    buffer_load_dwordx4 v66, s[16:19], s9 offen sc1 lds
SKIP3D:
    s_add_u32 m0, s3, 0
    s_mov_b64 exec, s[36:37]
    buffer_load_dwordx4 v64, s[16:19], s9 offen sc1 lds
    s_mov_b64 exec, -1
    v_mul_hi_u32 v76, s44, v96
    v_add_u32 v76, s45, v76
    v_and_b32 v76, 31, v76
    v_add_u32 v9, 0, v0
    v_lshlrev_b32 v9, 21, v9
    v_lshrrev_b32 v80, 10, v96
    v_lshl_or_b32 v80, v80, 7, v9
    v_mul_hi_u32 v77, s44, v98
    v_add_u32 v77, s45, v77
    v_and_b32 v77, 31, v77
    v_add_u32 v9, 512, v0
    v_lshlrev_b32 v9, 21, v9
    v_lshrrev_b32 v81, 10, v98
    v_lshl_or_b32 v81, v81, 7, v9
    v_mul_hi_u32 v78, s44, v100
    v_add_u32 v78, s45, v78
    v_and_b32 v78, 31, v78
    v_add_u32 v9, 1024, v0
    v_lshlrev_b32 v9, 21, v9
    v_lshrrev_b32 v82, 10, v100
    v_lshl_or_b32 v82, v82, 7, v9
    s_waitcnt lgkmcnt(2)
    v_lshrrev_b32 v9, 16, v72
    v_and_b32 v72, 0x380, v72
    v_or_b32 v80, v80, v9
    v_lshl_add_u32 v72, v76, 2, v72
    s_waitcnt lgkmcnt(1)
    v_lshrrev_b32 v9, 16, v73
    v_and_b32 v73, 0x380, v73
    v_or_b32 v81, v81, v9
    v_lshl_add_u32 v73, v77, 2, v73
    s_waitcnt lgkmcnt(0)
    v_lshrrev_b32 v9, 16, v74
    v_and_b32 v74, 0x380, v74
    v_or_b32 v82, v82, v9
    v_lshl_add_u32 v74, v78, 2, v74
    s_mov_b64 exec, s[36:37]
    ds_add_rtn_u32 v76, v72, v15 offset:0
    s_mov_b64 exec, s[38:39]
    ds_add_rtn_u32 v77, v73, v15 offset:0
    s_mov_b64 exec, s[40:41]
    ds_add_rtn_u32 v78, v74, v15 offset:0
    s_mov_b64 exec, -1
    s_add_u32 m0, s3, 8192
    s_mov_b64 exec, s[38:39]
    buffer_load_dwordx4 v65, s[16:19], s9 offen sc1 lds
    s_mov_b64 exec, -1
    s_lshl_b32 s10, s25, 3
    s_add_u32 s11, s10, 8
    s_and_b32 s11, s11, 63
    s_waitcnt lgkmcnt(0)
    s_barrier
    ds_read_b128 v[84:87], v1 offset:0
    s_cmp_lg_u32 s27, 0
    s_cbranch_scc1 NO_X_TOUCH_8
    s_lshr_b32 s33, s2, 3
    s_lshl_b32 s33, s33, 3
    s_add_u32 s33, s33, s25
    s_lshl_b32 s33, s33, 7
    s_add_u32 s33, s33, s61
    s_add_u32 s33, s33, 917504
    v_min_u32 v166, 160, v1
    v_lshl_add_u32 v166, v166, 11, s33
    buffer_load_dword v167, v166, s[12:15], 0 offen
NO_X_TOUCH_8:
    s_waitcnt lgkmcnt(0)
    v_add_u32 v10, v84, v85
    v_add3_u32 v10, v10, v86, v87
    v_mov_b32 v11, v10
    s_nop 1
    v_add_u32_dpp v11, v11, v11 row_shr:1 row_mask:0xf bank_mask:0xf bound_ctrl:0
    s_nop 1
    v_add_u32_dpp v11, v11, v11 row_shr:2 row_mask:0xf bank_mask:0xf bound_ctrl:0
    s_nop 1
    v_add_u32_dpp v11, v11, v11 row_shr:4 row_mask:0xf bank_mask:0xf bound_ctrl:0
    s_nop 1
    v_add_u32_dpp v11, v11, v11 row_shr:8 row_mask:0xf bank_mask:0xf bound_ctrl:0
    s_nop 1
    v_add_u32_dpp v11, v11, v11 row_bcast:15 row_mask:0xa bank_mask:0xf
    s_nop 1
    v_add_u32_dpp v11, v11, v11 row_bcast:31 row_mask:0xc bank_mask:0xf
    v_sub_u32 v88, v11, v10
    v_add_u32 v89, v88, v84
    v_add_u32 v90, v89, v85
    v_add_u32 v91, v90, v86
    ds_write_b128 v1, v[88:91] offset:1792
    v_readlane_b32 s29, v88, s10
    v_readlane_b32 s30, v88, s11
    ds_read_b32 v72, v72 offset:1792
    ds_read_b32 v73, v73 offset:1792
    ds_read_b32 v74, v74 offset:1792
    s_cmp_eq_u32 s25, 7
    s_cselect_b32 s30, s28, s30
    v_add_u32 v6, s29, v8
    v_lshlrev_b32 v5, 2, v6
    v_add_u32 v5, 2816, v5
    s_sub_u32 s11, s30, s29
    s_max_u32 s10, s11, 6
    s_add_u32 s10, s10, -3
    s_and_b32 s31, s10, -4
    s_max_u32 s10, s11, s31
    s_sub_u32 s32, s10, s31
    s_waitcnt lgkmcnt(2)
    v_add_lshl_u32 v72, v72, v76, 2
    s_mov_b64 exec, s[36:37]
    ds_write_b32 v72, v80 offset:2816
    s_mov_b64 exec, -1
    s_waitcnt lgkmcnt(2)
    v_add_lshl_u32 v73, v73, v77, 2
    s_mov_b64 exec, s[38:39]
    ds_write_b32 v73, v81 offset:2816
    s_mov_b64 exec, -1
    s_waitcnt lgkmcnt(2)
    v_add_lshl_u32 v74, v74, v78, 2
    s_mov_b64 exec, s[40:41]
    ds_write_b32 v74, v82 offset:2816
    s_mov_b64 exec, -1
    s_waitcnt lgkmcnt(0)
    s_barrier
    ds_read_b32 v165, v5
    s_and_b32 s10, s25, 3
    s_lshl_b32 s10, s10, 13
    s_add_u32 s10, s10, 7802880
    s_add_u32 s11, s10, 4096
    v_mov_b32 v128, 0
    v_mov_b32 v129, 0
    v_mov_b32 v130, 0
    v_mov_b32 v131, 0
    v_mov_b32 v132, 0
    v_mov_b32 v133, 0
    v_mov_b32 v134, 0
    v_mov_b32 v135, 0
    s_waitcnt lgkmcnt(0)
    v_cmp_gt_u32 vcc, s30, v6
    v_add_u32 v6, 64, v6
    v_add_u32 v5, 256, v5
    v_cndmask_b32 v165, 40, v165, vcc
    v_lshrrev_b32 v8, 21, v165
    v_lshlrev_b32 v8, 4, v8
    v_lshlrev_b32 v9, 3, v165
    v_and_b32 v9, 0xfffc00, v9
    v_and_or_b32 v165, v165, 56, v9
    s_nop 0
    v_readlane_b32 s48, v165, 0
    s_and_b32 s33, s48, s34
    buffer_load_dwordx4 v[64:67], v1, s[12:15], s33 offen
    v_readlane_b32 s49, v165, 1
    s_and_b32 s33, s49, s34
    buffer_load_dwordx4 v[68:71], v1, s[12:15], s33 offen
    s_cmp_lg_u32 s27, 0
    s_cbranch_scc1 REC_WAIT
    s_waitcnt vmcnt(3)
    s_branch REC_IN
REC_WAIT:
    s_waitcnt vmcnt(2)
REC_IN:
    s_barrier
    ds_read_b128 v[168:171], v8 offset:8704
    v_readlane_b32 s50, v165, 2
    s_and_b32 s33, s50, s34
    buffer_load_dwordx4 v[72:75], v1, s[12:15], s33 offen
    v_readlane_b32 s51, v165, 3
    s_and_b32 s33, s51, s34
    buffer_load_dwordx4 v[76:79], v1, s[12:15], s33 offen
    v_readlane_b32 s52, v165, 4
    s_and_b32 s33, s52, s34
    buffer_load_dwordx4 v[80:83], v1, s[12:15], s33 offen
    v_readlane_b32 s53, v165, 5
    s_and_b32 s33, s53, s34
    buffer_load_dwordx4 v[84:87], v1, s[12:15], s33 offen
    v_mov_b32 v164, v165
    s_waitcnt lgkmcnt(0)
    v_mov_b32 v172, v170
    v_mov_b32 v173, v171
    v_mfma_f32_4x4x4_16b_bf16 v[148:151], v[168:169], v[180:181], 0
    v_mfma_f32_4x4x4_16b_bf16 v[152:155], v[168:169], v[182:183], 0
    v_mfma_f32_4x4x4_16b_bf16 v[156:159], v[168:169], v[184:185], 0
    v_mfma_f32_4x4x4_16b_bf16 v[160:163], v[168:169], v[186:187], 0
    v_mfma_f32_4x4x4_16b_bf16 v[112:115], v[172:173], v[176:177], 0 cbsz:4 abid:0
    v_mfma_f32_4x4x4_16b_bf16 v[116:119], v[172:173], v[178:179], 0 cbsz:4 abid:0
    v_mfma_f32_4x4x4_16b_bf16 v[120:123], v[172:173], v[176:177], 0 cbsz:4 abid:1
    s_nop 1
    v_cvt_pk_bf16_f32 v140, v148, v152
    v_cvt_pk_bf16_f32 v141, v156, v160
    v_cvt_pk_bf16_f32 v142, v149, v153
    v_cvt_pk_bf16_f32 v143, v157, v161
    v_cvt_pk_bf16_f32 v144, v150, v154
    v_cvt_pk_bf16_f32 v145, v158, v162
    v_cvt_pk_bf16_f32 v146, v151, v155
    v_cvt_pk_bf16_f32 v147, v159, v163
    v_lshlrev_b32_sdwa v136, v15, v112 dst_sel:DWORD dst_unused:UNUSED_PAD src0_sel:DWORD src1_sel:WORD_1
    v_lshlrev_b32_sdwa v137, v15, v113 dst_sel:DWORD dst_unused:UNUSED_PAD src0_sel:DWORD src1_sel:WORD_1
    ds_read_u16_d16_hi v128, v136 offset:32768
    ds_read_u16_d16_hi v129, v137 offset:32768
    v_lshlrev_b32_sdwa v138, v15, v116 dst_sel:DWORD dst_unused:UNUSED_PAD src0_sel:DWORD src1_sel:WORD_1
    v_lshlrev_b32_sdwa v139, v15, v117 dst_sel:DWORD dst_unused:UNUSED_PAD src0_sel:DWORD src1_sel:WORD_1
    ds_read_u16_d16_hi v130, v138 offset:32768
    ds_read_u16_d16_hi v131, v139 offset:32768
    s_waitcnt vmcnt(5)
    v_mfma_f32_4x4x4_16b_bf16 v[96:99], v[140:141], v[64:65], 0 cbsz:4 abid:0
    v_mfma_f32_4x4x4_16b_bf16 v[100:103], v[140:141], v[66:67], 0 cbsz:4 abid:0
A_0:
    s_sub_u32 s31, s31, 4
    s_cbranch_scc1 B_0
    v_mfma_f32_4x4x4_16b_bf16 v[124:127], v[172:173], v[178:179], 0 cbsz:4 abid:1
    v_lshlrev_b32_sdwa v136, v15, v114 dst_sel:DWORD dst_unused:UNUSED_PAD src0_sel:DWORD src1_sel:WORD_1
    s_waitcnt vmcnt(4)
    v_mfma_f32_4x4x4_16b_bf16 v[104:107], v[142:143], v[68:69], 0 cbsz:4 abid:0
    v_readlane_b32 s54, v164, 6
    v_mfma_f32_4x4x4_16b_bf16 v[108:111], v[142:143], v[70:71], 0 cbsz:4 abid:0
    v_lshlrev_b32_sdwa v137, v15, v115 dst_sel:DWORD dst_unused:UNUSED_PAD src0_sel:DWORD src1_sel:WORD_1
    ds_read_u16_d16_hi v132, v136 offset:32768
    ds_read_u16_d16_hi v133, v137 offset:32768
    s_and_b32 s33, s54, s34
    buffer_load_dwordx4 v[88:91], v1, s[12:15], s33 offen
    s_waitcnt lgkmcnt(2)
    s_set_gpr_idx_on s48, 0xc
    v_pk_fma_f32 v[16:17], v[128:129], v[96:97], v[16:17] op_sel:[0,0,0] op_sel_hi:[0,1,1]
    v_pk_fma_f32 v[18:19], v[128:129], v[98:99], v[18:19] op_sel:[0,0,0] op_sel_hi:[0,1,1]
    v_pk_fma_f32 v[20:21], v[130:131], v[100:101], v[20:21] op_sel:[0,0,0] op_sel_hi:[0,1,1]
    v_pk_fma_f32 v[22:23], v[130:131], v[102:103], v[22:23] op_sel:[0,0,0] op_sel_hi:[0,1,1]
    s_set_gpr_idx_off
    v_lshlrev_b32_sdwa v138, v15, v118 dst_sel:DWORD dst_unused:UNUSED_PAD src0_sel:DWORD src1_sel:WORD_1
    s_waitcnt vmcnt(4)
    v_mfma_f32_4x4x4_16b_bf16 v[96:99], v[144:145], v[72:73], 0 cbsz:4 abid:0
    v_readlane_b32 s55, v164, 7
    v_mfma_f32_4x4x4_16b_bf16 v[100:103], v[144:145], v[74:75], 0 cbsz:4 abid:0
    v_lshlrev_b32_sdwa v139, v15, v119 dst_sel:DWORD dst_unused:UNUSED_PAD src0_sel:DWORD src1_sel:WORD_1
    ds_read_u16_d16_hi v134, v138 offset:32768
    ds_read_u16_d16_hi v135, v139 offset:32768
    s_and_b32 s33, s55, s34
    buffer_load_dwordx4 v[92:95], v1, s[12:15], s33 offen
    s_set_gpr_idx_on s49, 0xc
    v_pk_fma_f32 v[16:17], v[128:129], v[104:105], v[16:17] op_sel:[1,0,0] op_sel_hi:[1,1,1]
    v_pk_fma_f32 v[18:19], v[128:129], v[106:107], v[18:19] op_sel:[1,0,0] op_sel_hi:[1,1,1]
    v_pk_fma_f32 v[20:21], v[130:131], v[108:109], v[20:21] op_sel:[1,0,0] op_sel_hi:[1,1,1]
    v_pk_fma_f32 v[22:23], v[130:131], v[110:111], v[22:23] op_sel:[1,0,0] op_sel_hi:[1,1,1]
    s_set_gpr_idx_off
    v_mfma_f32_4x4x4_16b_bf16 v[112:115], v[172:173], v[176:177], 0 cbsz:4 abid:2
    v_lshlrev_b32_sdwa v136, v15, v120 dst_sel:DWORD dst_unused:UNUSED_PAD src0_sel:DWORD src1_sel:WORD_1
    s_waitcnt vmcnt(4)
    v_mfma_f32_4x4x4_16b_bf16 v[104:107], v[146:147], v[76:77], 0 cbsz:4 abid:0
    v_readlane_b32 s56, v164, 8
    v_mfma_f32_4x4x4_16b_bf16 v[108:111], v[146:147], v[78:79], 0 cbsz:4 abid:0
    v_lshlrev_b32_sdwa v137, v15, v121 dst_sel:DWORD dst_unused:UNUSED_PAD src0_sel:DWORD src1_sel:WORD_1
    ds_read_u16_d16_hi v128, v136 offset:32768
    ds_read_u16_d16_hi v129, v137 offset:32768
    s_and_b32 s33, s56, s34
    buffer_load_dwordx4 v[64:67], v1, s[12:15], s33 offen
    s_waitcnt lgkmcnt(2)
    s_set_gpr_idx_on s50, 0xc
    v_pk_fma_f32 v[16:17], v[132:133], v[96:97], v[16:17] op_sel:[0,0,0] op_sel_hi:[0,1,1]
    v_pk_fma_f32 v[18:19], v[132:133], v[98:99], v[18:19] op_sel:[0,0,0] op_sel_hi:[0,1,1]
    v_pk_fma_f32 v[20:21], v[134:135], v[100:101], v[20:21] op_sel:[0,0,0] op_sel_hi:[0,1,1]
    v_pk_fma_f32 v[22:23], v[134:135], v[102:103], v[22:23] op_sel:[0,0,0] op_sel_hi:[0,1,1]
    s_set_gpr_idx_off
    v_lshlrev_b32_sdwa v138, v15, v124 dst_sel:DWORD dst_unused:UNUSED_PAD src0_sel:DWORD src1_sel:WORD_1
    s_waitcnt vmcnt(4)
    v_mfma_f32_4x4x4_16b_bf16 v[96:99], v[140:141], v[80:81], 0 cbsz:4 abid:1
    v_readlane_b32 s57, v164, 9
    v_mfma_f32_4x4x4_16b_bf16 v[100:103], v[140:141], v[82:83], 0 cbsz:4 abid:1
    v_lshlrev_b32_sdwa v139, v15, v125 dst_sel:DWORD dst_unused:UNUSED_PAD src0_sel:DWORD src1_sel:WORD_1
    ds_read_u16_d16_hi v130, v138 offset:32768
    ds_read_u16_d16_hi v131, v139 offset:32768
    s_and_b32 s33, s57, s34
    buffer_load_dwordx4 v[68:71], v1, s[12:15], s33 offen
    s_set_gpr_idx_on s51, 0xc
    v_pk_fma_f32 v[16:17], v[132:133], v[104:105], v[16:17] op_sel:[1,0,0] op_sel_hi:[1,1,1]
    v_pk_fma_f32 v[18:19], v[132:133], v[106:107], v[18:19] op_sel:[1,0,0] op_sel_hi:[1,1,1]
    v_pk_fma_f32 v[20:21], v[134:135], v[108:109], v[20:21] op_sel:[1,0,0] op_sel_hi:[1,1,1]
    v_pk_fma_f32 v[22:23], v[134:135], v[110:111], v[22:23] op_sel:[1,0,0] op_sel_hi:[1,1,1]
    s_set_gpr_idx_off
A_4:
    s_sub_u32 s31, s31, 4
    s_cbranch_scc1 B_4
    v_mfma_f32_4x4x4_16b_bf16 v[116:119], v[172:173], v[178:179], 0 cbsz:4 abid:2
    v_lshlrev_b32_sdwa v136, v15, v122 dst_sel:DWORD dst_unused:UNUSED_PAD src0_sel:DWORD src1_sel:WORD_1
    s_waitcnt vmcnt(4)
    v_mfma_f32_4x4x4_16b_bf16 v[104:107], v[142:143], v[84:85], 0 cbsz:4 abid:1
    v_readlane_b32 s58, v164, 10
    v_mfma_f32_4x4x4_16b_bf16 v[108:111], v[142:143], v[86:87], 0 cbsz:4 abid:1
    v_lshlrev_b32_sdwa v137, v15, v123 dst_sel:DWORD dst_unused:UNUSED_PAD src0_sel:DWORD src1_sel:WORD_1
    ds_read_u16_d16_hi v132, v136 offset:32768
    ds_read_u16_d16_hi v133, v137 offset:32768
    s_and_b32 s33, s58, s34
    buffer_load_dwordx4 v[72:75], v1, s[12:15], s33 offen
    s_waitcnt lgkmcnt(2)
    s_set_gpr_idx_on s52, 0xc
    v_pk_fma_f32 v[16:17], v[128:129], v[96:97], v[16:17] op_sel:[0,0,0] op_sel_hi:[0,1,1]
    v_pk_fma_f32 v[18:19], v[128:129], v[98:99], v[18:19] op_sel:[0,0,0] op_sel_hi:[0,1,1]
    v_pk_fma_f32 v[20:21], v[130:131], v[100:101], v[20:21] op_sel:[0,0,0] op_sel_hi:[0,1,1]
    v_pk_fma_f32 v[22:23], v[130:131], v[102:103], v[22:23] op_sel:[0,0,0] op_sel_hi:[0,1,1]
    s_set_gpr_idx_off
    v_lshlrev_b32_sdwa v138, v15, v126 dst_sel:DWORD dst_unused:UNUSED_PAD src0_sel:DWORD src1_sel:WORD_1
    s_waitcnt vmcnt(4)
    v_mfma_f32_4x4x4_16b_bf16 v[96:99], v[144:145], v[88:89], 0 cbsz:4 abid:1
    v_readlane_b32 s59, v164, 11
    v_mfma_f32_4x4x4_16b_bf16 v[100:103], v[144:145], v[90:91], 0 cbsz:4 abid:1
    v_lshlrev_b32_sdwa v139, v15, v127 dst_sel:DWORD dst_unused:UNUSED_PAD src0_sel:DWORD src1_sel:WORD_1
    ds_read_u16_d16_hi v134, v138 offset:32768
    ds_read_u16_d16_hi v135, v139 offset:32768
    s_and_b32 s33, s59, s34
    buffer_load_dwordx4 v[76:79], v1, s[12:15], s33 offen
    s_set_gpr_idx_on s53, 0xc
    v_pk_fma_f32 v[16:17], v[128:129], v[104:105], v[16:17] op_sel:[1,0,0] op_sel_hi:[1,1,1]
    v_pk_fma_f32 v[18:19], v[128:129], v[106:107], v[18:19] op_sel:[1,0,0] op_sel_hi:[1,1,1]
    v_pk_fma_f32 v[20:21], v[130:131], v[108:109], v[20:21] op_sel:[1,0,0] op_sel_hi:[1,1,1]
    v_pk_fma_f32 v[22:23], v[130:131], v[110:111], v[22:23] op_sel:[1,0,0] op_sel_hi:[1,1,1]
    s_set_gpr_idx_off
    v_mfma_f32_4x4x4_16b_bf16 v[120:123], v[172:173], v[176:177], 0 cbsz:4 abid:3
    v_lshlrev_b32_sdwa v136, v15, v112 dst_sel:DWORD dst_unused:UNUSED_PAD src0_sel:DWORD src1_sel:WORD_1
    s_waitcnt vmcnt(4)
    v_mfma_f32_4x4x4_16b_bf16 v[104:107], v[146:147], v[92:93], 0 cbsz:4 abid:1
    v_readlane_b32 s60, v164, 12
    v_mfma_f32_4x4x4_16b_bf16 v[108:111], v[146:147], v[94:95], 0 cbsz:4 abid:1
    v_lshlrev_b32_sdwa v137, v15, v113 dst_sel:DWORD dst_unused:UNUSED_PAD src0_sel:DWORD src1_sel:WORD_1
    ds_read_u16_d16_hi v128, v136 offset:32768
    ds_read_u16_d16_hi v129, v137 offset:32768
    s_and_b32 s33, s60, s34
    buffer_load_dwordx4 v[80:83], v1, s[12:15], s33 offen
    s_waitcnt lgkmcnt(2)
    s_set_gpr_idx_on s54, 0xc
    v_pk_fma_f32 v[16:17], v[132:133], v[96:97], v[16:17] op_sel:[0,0,0] op_sel_hi:[0,1,1]
    v_pk_fma_f32 v[18:19], v[132:133], v[98:99], v[18:19] op_sel:[0,0,0] op_sel_hi:[0,1,1]
    v_pk_fma_f32 v[20:21], v[134:135], v[100:101], v[20:21] op_sel:[0,0,0] op_sel_hi:[0,1,1]
    v_pk_fma_f32 v[22:23], v[134:135], v[102:103], v[22:23] op_sel:[0,0,0] op_sel_hi:[0,1,1]
    s_set_gpr_idx_off
    v_lshlrev_b32_sdwa v138, v15, v116 dst_sel:DWORD dst_unused:UNUSED_PAD src0_sel:DWORD src1_sel:WORD_1
    s_waitcnt vmcnt(4)
    v_mfma_f32_4x4x4_16b_bf16 v[96:99], v[140:141], v[64:65], 0 cbsz:4 abid:2
    v_readlane_b32 s61, v164, 13
    v_mfma_f32_4x4x4_16b_bf16 v[100:103], v[140:141], v[66:67], 0 cbsz:4 abid:2
    v_lshlrev_b32_sdwa v139, v15, v117 dst_sel:DWORD dst_unused:UNUSED_PAD src0_sel:DWORD src1_sel:WORD_1
    ds_read_u16_d16_hi v130, v138 offset:32768
    ds_read_u16_d16_hi v131, v139 offset:32768
    s_and_b32 s33, s61, s34
    buffer_load_dwordx4 v[84:87], v1, s[12:15], s33 offen
    s_set_gpr_idx_on s55, 0xc
    v_pk_fma_f32 v[16:17], v[132:133], v[104:105], v[16:17] op_sel:[1,0,0] op_sel_hi:[1,1,1]
    v_pk_fma_f32 v[18:19], v[132:133], v[106:107], v[18:19] op_sel:[1,0,0] op_sel_hi:[1,1,1]
    v_pk_fma_f32 v[20:21], v[134:135], v[108:109], v[20:21] op_sel:[1,0,0] op_sel_hi:[1,1,1]
    v_pk_fma_f32 v[22:23], v[134:135], v[110:111], v[22:23] op_sel:[1,0,0] op_sel_hi:[1,1,1]
    s_set_gpr_idx_off
A_8:
    s_sub_u32 s31, s31, 4
    s_cbranch_scc1 B_8
    v_mfma_f32_4x4x4_16b_bf16 v[124:127], v[172:173], v[178:179], 0 cbsz:4 abid:3
    v_lshlrev_b32_sdwa v136, v15, v114 dst_sel:DWORD dst_unused:UNUSED_PAD src0_sel:DWORD src1_sel:WORD_1
    s_waitcnt vmcnt(4)
    v_mfma_f32_4x4x4_16b_bf16 v[104:107], v[142:143], v[68:69], 0 cbsz:4 abid:2
    v_readlane_b32 s62, v164, 14
    v_mfma_f32_4x4x4_16b_bf16 v[108:111], v[142:143], v[70:71], 0 cbsz:4 abid:2
    v_lshlrev_b32_sdwa v137, v15, v115 dst_sel:DWORD dst_unused:UNUSED_PAD src0_sel:DWORD src1_sel:WORD_1
    ds_read_u16_d16_hi v132, v136 offset:32768
    ds_read_u16_d16_hi v133, v137 offset:32768
    s_and_b32 s33, s62, s34
    buffer_load_dwordx4 v[88:91], v1, s[12:15], s33 offen
    s_waitcnt lgkmcnt(2)
    s_set_gpr_idx_on s56, 0xc
    v_pk_fma_f32 v[16:17], v[128:129], v[96:97], v[16:17] op_sel:[0,0,0] op_sel_hi:[0,1,1]
    v_pk_fma_f32 v[18:19], v[128:129], v[98:99], v[18:19] op_sel:[0,0,0] op_sel_hi:[0,1,1]
    v_pk_fma_f32 v[20:21], v[130:131], v[100:101], v[20:21] op_sel:[0,0,0] op_sel_hi:[0,1,1]
    v_pk_fma_f32 v[22:23], v[130:131], v[102:103], v[22:23] op_sel:[0,0,0] op_sel_hi:[0,1,1]
    s_set_gpr_idx_off
    ds_read_b32 v165, v5
    v_lshlrev_b32_sdwa v138, v15, v118 dst_sel:DWORD dst_unused:UNUSED_PAD src0_sel:DWORD src1_sel:WORD_1
    s_waitcnt vmcnt(4)
    v_mfma_f32_4x4x4_16b_bf16 v[96:99], v[144:145], v[72:73], 0 cbsz:4 abid:2
    v_readlane_b32 s63, v164, 15
    v_mfma_f32_4x4x4_16b_bf16 v[100:103], v[144:145], v[74:75], 0 cbsz:4 abid:2
    v_lshlrev_b32_sdwa v139, v15, v119 dst_sel:DWORD dst_unused:UNUSED_PAD src0_sel:DWORD src1_sel:WORD_1
    ds_read_u16_d16_hi v134, v138 offset:32768
    ds_read_u16_d16_hi v135, v139 offset:32768
    s_and_b32 s33, s63, s34
    buffer_load_dwordx4 v[92:95], v1, s[12:15], s33 offen
    s_set_gpr_idx_on s57, 0xc
    v_pk_fma_f32 v[16:17], v[128:129], v[104:105], v[16:17] op_sel:[1,0,0] op_sel_hi:[1,1,1]
    v_pk_fma_f32 v[18:19], v[128:129], v[106:107], v[18:19] op_sel:[1,0,0] op_sel_hi:[1,1,1]
    v_pk_fma_f32 v[20:21], v[130:131], v[108:109], v[20:21] op_sel:[1,0,0] op_sel_hi:[1,1,1]
    v_pk_fma_f32 v[22:23], v[130:131], v[110:111], v[22:23] op_sel:[1,0,0] op_sel_hi:[1,1,1]
    s_set_gpr_idx_off
    v_mfma_f32_4x4x4_16b_bf16 v[112:115], v[172:173], v[176:177], 0 cbsz:4 abid:4
    v_lshlrev_b32_sdwa v136, v15, v120 dst_sel:DWORD dst_unused:UNUSED_PAD src0_sel:DWORD src1_sel:WORD_1
    s_waitcnt vmcnt(4)
    v_mfma_f32_4x4x4_16b_bf16 v[104:107], v[146:147], v[76:77], 0 cbsz:4 abid:2
    v_readlane_b32 s48, v164, 16
    v_mfma_f32_4x4x4_16b_bf16 v[108:111], v[146:147], v[78:79], 0 cbsz:4 abid:2
    v_lshlrev_b32_sdwa v137, v15, v121 dst_sel:DWORD dst_unused:UNUSED_PAD src0_sel:DWORD src1_sel:WORD_1
    ds_read_u16_d16_hi v128, v136 offset:32768
    ds_read_u16_d16_hi v129, v137 offset:32768
    s_and_b32 s33, s48, s34
    buffer_load_dwordx4 v[64:67], v1, s[12:15], s33 offen
    s_waitcnt lgkmcnt(2)
    s_set_gpr_idx_on s58, 0xc
    v_pk_fma_f32 v[16:17], v[132:133], v[96:97], v[16:17] op_sel:[0,0,0] op_sel_hi:[0,1,1]
    v_pk_fma_f32 v[18:19], v[132:133], v[98:99], v[18:19] op_sel:[0,0,0] op_sel_hi:[0,1,1]
    v_pk_fma_f32 v[20:21], v[134:135], v[100:101], v[20:21] op_sel:[0,0,0] op_sel_hi:[0,1,1]
    v_pk_fma_f32 v[22:23], v[134:135], v[102:103], v[22:23] op_sel:[0,0,0] op_sel_hi:[0,1,1]
    s_set_gpr_idx_off
    v_lshlrev_b32_sdwa v138, v15, v124 dst_sel:DWORD dst_unused:UNUSED_PAD src0_sel:DWORD src1_sel:WORD_1
    s_waitcnt vmcnt(4)
    v_mfma_f32_4x4x4_16b_bf16 v[96:99], v[140:141], v[80:81], 0 cbsz:4 abid:3
    v_readlane_b32 s49, v164, 17
    v_mfma_f32_4x4x4_16b_bf16 v[100:103], v[140:141], v[82:83], 0 cbsz:4 abid:3
    v_lshlrev_b32_sdwa v139, v15, v125 dst_sel:DWORD dst_unused:UNUSED_PAD src0_sel:DWORD src1_sel:WORD_1
    ds_read_u16_d16_hi v130, v138 offset:32768
    ds_read_u16_d16_hi v131, v139 offset:32768
    s_and_b32 s33, s49, s34
    buffer_load_dwordx4 v[68:71], v1, s[12:15], s33 offen
    s_set_gpr_idx_on s59, 0xc
    v_pk_fma_f32 v[16:17], v[132:133], v[104:105], v[16:17] op_sel:[1,0,0] op_sel_hi:[1,1,1]
    v_pk_fma_f32 v[18:19], v[132:133], v[106:107], v[18:19] op_sel:[1,0,0] op_sel_hi:[1,1,1]
    v_pk_fma_f32 v[20:21], v[134:135], v[108:109], v[20:21] op_sel:[1,0,0] op_sel_hi:[1,1,1]
    v_pk_fma_f32 v[22:23], v[134:135], v[110:111], v[22:23] op_sel:[1,0,0] op_sel_hi:[1,1,1]
    s_set_gpr_idx_off
A_12:
    s_sub_u32 s31, s31, 4
    s_cbranch_scc1 B_12
    v_mfma_f32_4x4x4_16b_bf16 v[116:119], v[172:173], v[178:179], 0 cbsz:4 abid:4
    v_lshlrev_b32_sdwa v136, v15, v122 dst_sel:DWORD dst_unused:UNUSED_PAD src0_sel:DWORD src1_sel:WORD_1
    s_waitcnt vmcnt(4)
    v_mfma_f32_4x4x4_16b_bf16 v[104:107], v[142:143], v[84:85], 0 cbsz:4 abid:3
    v_readlane_b32 s50, v164, 18
    v_mfma_f32_4x4x4_16b_bf16 v[108:111], v[142:143], v[86:87], 0 cbsz:4 abid:3
    v_lshlrev_b32_sdwa v137, v15, v123 dst_sel:DWORD dst_unused:UNUSED_PAD src0_sel:DWORD src1_sel:WORD_1
    ds_read_u16_d16_hi v132, v136 offset:32768
    ds_read_u16_d16_hi v133, v137 offset:32768
    s_and_b32 s33, s50, s34
    buffer_load_dwordx4 v[72:75], v1, s[12:15], s33 offen
    s_waitcnt lgkmcnt(2)
    s_set_gpr_idx_on s60, 0xc
    v_pk_fma_f32 v[16:17], v[128:129], v[96:97], v[16:17] op_sel:[0,0,0] op_sel_hi:[0,1,1]
    v_pk_fma_f32 v[18:19], v[128:129], v[98:99], v[18:19] op_sel:[0,0,0] op_sel_hi:[0,1,1]
    v_pk_fma_f32 v[20:21], v[130:131], v[100:101], v[20:21] op_sel:[0,0,0] op_sel_hi:[0,1,1]
    v_pk_fma_f32 v[22:23], v[130:131], v[102:103], v[22:23] op_sel:[0,0,0] op_sel_hi:[0,1,1]
    s_set_gpr_idx_off
    v_cmp_gt_u32 vcc, s30, v6
    v_add_u32 v6, 64, v6
    v_add_u32 v5, 256, v5
    v_cndmask_b32 v165, 40, v165, vcc
    v_lshrrev_b32 v8, 21, v165
    v_lshlrev_b32 v8, 4, v8
    v_lshlrev_b32 v9, 3, v165
    ds_read_b128 v[168:171], v8 offset:8704
    v_and_b32 v9, 0xfffc00, v9
    v_and_or_b32 v165, v165, 56, v9
    v_lshlrev_b32_sdwa v138, v15, v126 dst_sel:DWORD dst_unused:UNUSED_PAD src0_sel:DWORD src1_sel:WORD_1
    s_waitcnt vmcnt(4)
    v_mfma_f32_4x4x4_16b_bf16 v[96:99], v[144:145], v[88:89], 0 cbsz:4 abid:3
    v_readlane_b32 s51, v164, 19
    v_mfma_f32_4x4x4_16b_bf16 v[100:103], v[144:145], v[90:91], 0 cbsz:4 abid:3
    v_lshlrev_b32_sdwa v139, v15, v127 dst_sel:DWORD dst_unused:UNUSED_PAD src0_sel:DWORD src1_sel:WORD_1
    ds_read_u16_d16_hi v134, v138 offset:32768
    ds_read_u16_d16_hi v135, v139 offset:32768
    s_and_b32 s33, s51, s34
    buffer_load_dwordx4 v[76:79], v1, s[12:15], s33 offen
    s_set_gpr_idx_on s61, 0xc
    v_pk_fma_f32 v[16:17], v[128:129], v[104:105], v[16:17] op_sel:[1,0,0] op_sel_hi:[1,1,1]
    v_pk_fma_f32 v[18:19], v[128:129], v[106:107], v[18:19] op_sel:[1,0,0] op_sel_hi:[1,1,1]
    v_pk_fma_f32 v[20:21], v[130:131], v[108:109], v[20:21] op_sel:[1,0,0] op_sel_hi:[1,1,1]
    v_pk_fma_f32 v[22:23], v[130:131], v[110:111], v[22:23] op_sel:[1,0,0] op_sel_hi:[1,1,1]
    s_set_gpr_idx_off
    v_mfma_f32_4x4x4_16b_bf16 v[120:123], v[172:173], v[176:177], 0 cbsz:4 abid:5
    v_lshlrev_b32_sdwa v136, v15, v112 dst_sel:DWORD dst_unused:UNUSED_PAD src0_sel:DWORD src1_sel:WORD_1
    s_waitcnt vmcnt(4)
    v_mfma_f32_4x4x4_16b_bf16 v[104:107], v[146:147], v[92:93], 0 cbsz:4 abid:3
    v_readlane_b32 s52, v164, 20
    v_mfma_f32_4x4x4_16b_bf16 v[108:111], v[146:147], v[94:95], 0 cbsz:4 abid:3
    v_lshlrev_b32_sdwa v137, v15, v113 dst_sel:DWORD dst_unused:UNUSED_PAD src0_sel:DWORD src1_sel:WORD_1
    ds_read_u16_d16_hi v128, v136 offset:32768
    ds_read_u16_d16_hi v129, v137 offset:32768
    s_and_b32 s33, s52, s34
    buffer_load_dwordx4 v[80:83], v1, s[12:15], s33 offen
    s_waitcnt lgkmcnt(2)
    s_set_gpr_idx_on s62, 0xc
    v_pk_fma_f32 v[16:17], v[132:133], v[96:97], v[16:17] op_sel:[0,0,0] op_sel_hi:[0,1,1]
    v_pk_fma_f32 v[18:19], v[132:133], v[98:99], v[18:19] op_sel:[0,0,0] op_sel_hi:[0,1,1]
    v_pk_fma_f32 v[20:21], v[134:135], v[100:101], v[20:21] op_sel:[0,0,0] op_sel_hi:[0,1,1]
    v_pk_fma_f32 v[22:23], v[134:135], v[102:103], v[22:23] op_sel:[0,0,0] op_sel_hi:[0,1,1]
    s_set_gpr_idx_off
    v_lshlrev_b32_sdwa v138, v15, v116 dst_sel:DWORD dst_unused:UNUSED_PAD src0_sel:DWORD src1_sel:WORD_1
    s_waitcnt vmcnt(4)
    v_mfma_f32_4x4x4_16b_bf16 v[96:99], v[140:141], v[64:65], 0 cbsz:4 abid:4
    v_readlane_b32 s53, v164, 21
    v_mfma_f32_4x4x4_16b_bf16 v[100:103], v[140:141], v[66:67], 0 cbsz:4 abid:4
    v_lshlrev_b32_sdwa v139, v15, v117 dst_sel:DWORD dst_unused:UNUSED_PAD src0_sel:DWORD src1_sel:WORD_1
    ds_read_u16_d16_hi v130, v138 offset:32768
    ds_read_u16_d16_hi v131, v139 offset:32768
    s_and_b32 s33, s53, s34
    buffer_load_dwordx4 v[84:87], v1, s[12:15], s33 offen
    s_set_gpr_idx_on s63, 0xc
    v_pk_fma_f32 v[16:17], v[132:133], v[104:105], v[16:17] op_sel:[1,0,0] op_sel_hi:[1,1,1]
    v_pk_fma_f32 v[18:19], v[132:133], v[106:107], v[18:19] op_sel:[1,0,0] op_sel_hi:[1,1,1]
    v_pk_fma_f32 v[20:21], v[134:135], v[108:109], v[20:21] op_sel:[1,0,0] op_sel_hi:[1,1,1]
    v_pk_fma_f32 v[22:23], v[134:135], v[110:111], v[22:23] op_sel:[1,0,0] op_sel_hi:[1,1,1]
    s_set_gpr_idx_off
A_16:
    s_sub_u32 s31, s31, 4
    s_cbranch_scc1 B_16
    v_mfma_f32_4x4x4_16b_bf16 v[124:127], v[172:173], v[178:179], 0 cbsz:4 abid:5
    v_lshlrev_b32_sdwa v136, v15, v114 dst_sel:DWORD dst_unused:UNUSED_PAD src0_sel:DWORD src1_sel:WORD_1
    s_waitcnt vmcnt(4)
    v_mfma_f32_4x4x4_16b_bf16 v[104:107], v[142:143], v[68:69], 0 cbsz:4 abid:4
    v_readlane_b32 s54, v164, 22
    v_mfma_f32_4x4x4_16b_bf16 v[108:111], v[142:143], v[70:71], 0 cbsz:4 abid:4
    v_lshlrev_b32_sdwa v137, v15, v115 dst_sel:DWORD dst_unused:UNUSED_PAD src0_sel:DWORD src1_sel:WORD_1
    ds_read_u16_d16_hi v132, v136 offset:32768
    ds_read_u16_d16_hi v133, v137 offset:32768
    s_and_b32 s33, s54, s34
    buffer_load_dwordx4 v[88:91], v1, s[12:15], s33 offen
    s_waitcnt lgkmcnt(2)
    s_set_gpr_idx_on s48, 0xc
    v_pk_fma_f32 v[16:17], v[128:129], v[96:97], v[16:17] op_sel:[0,0,0] op_sel_hi:[0,1,1]
    v_pk_fma_f32 v[18:19], v[128:129], v[98:99], v[18:19] op_sel:[0,0,0] op_sel_hi:[0,1,1]
    v_pk_fma_f32 v[20:21], v[130:131], v[100:101], v[20:21] op_sel:[0,0,0] op_sel_hi:[0,1,1]
    v_pk_fma_f32 v[22:23], v[130:131], v[102:103], v[22:23] op_sel:[0,0,0] op_sel_hi:[0,1,1]
    s_set_gpr_idx_off
    v_lshlrev_b32_sdwa v138, v15, v118 dst_sel:DWORD dst_unused:UNUSED_PAD src0_sel:DWORD src1_sel:WORD_1
    s_waitcnt vmcnt(4)
    v_mfma_f32_4x4x4_16b_bf16 v[96:99], v[144:145], v[72:73], 0 cbsz:4 abid:4
    v_readlane_b32 s55, v164, 23
    v_mfma_f32_4x4x4_16b_bf16 v[100:103], v[144:145], v[74:75], 0 cbsz:4 abid:4
    v_lshlrev_b32_sdwa v139, v15, v119 dst_sel:DWORD dst_unused:UNUSED_PAD src0_sel:DWORD src1_sel:WORD_1
    ds_read_u16_d16_hi v134, v138 offset:32768
    ds_read_u16_d16_hi v135, v139 offset:32768
    s_and_b32 s33, s55, s34
    buffer_load_dwordx4 v[92:95], v1, s[12:15], s33 offen
    s_set_gpr_idx_on s49, 0xc
    v_pk_fma_f32 v[16:17], v[128:129], v[104:105], v[16:17] op_sel:[1,0,0] op_sel_hi:[1,1,1]
    v_pk_fma_f32 v[18:19], v[128:129], v[106:107], v[18:19] op_sel:[1,0,0] op_sel_hi:[1,1,1]
    v_pk_fma_f32 v[20:21], v[130:131], v[108:109], v[20:21] op_sel:[1,0,0] op_sel_hi:[1,1,1]
    v_pk_fma_f32 v[22:23], v[130:131], v[110:111], v[22:23] op_sel:[1,0,0] op_sel_hi:[1,1,1]
    s_set_gpr_idx_off
    v_mfma_f32_4x4x4_16b_bf16 v[112:115], v[172:173], v[176:177], 0 cbsz:4 abid:6
    v_lshlrev_b32_sdwa v136, v15, v120 dst_sel:DWORD dst_unused:UNUSED_PAD src0_sel:DWORD src1_sel:WORD_1
    s_waitcnt vmcnt(4)
    v_mfma_f32_4x4x4_16b_bf16 v[104:107], v[146:147], v[76:77], 0 cbsz:4 abid:4
    v_readlane_b32 s56, v164, 24
    v_mfma_f32_4x4x4_16b_bf16 v[108:111], v[146:147], v[78:79], 0 cbsz:4 abid:4
    v_lshlrev_b32_sdwa v137, v15, v121 dst_sel:DWORD dst_unused:UNUSED_PAD src0_sel:DWORD src1_sel:WORD_1
    ds_read_u16_d16_hi v128, v136 offset:32768
    ds_read_u16_d16_hi v129, v137 offset:32768
    s_and_b32 s33, s56, s34
    buffer_load_dwordx4 v[64:67], v1, s[12:15], s33 offen
    s_waitcnt lgkmcnt(2)
    s_set_gpr_idx_on s50, 0xc
    v_pk_fma_f32 v[16:17], v[132:133], v[96:97], v[16:17] op_sel:[0,0,0] op_sel_hi:[0,1,1]
    v_pk_fma_f32 v[18:19], v[132:133], v[98:99], v[18:19] op_sel:[0,0,0] op_sel_hi:[0,1,1]
    v_pk_fma_f32 v[20:21], v[134:135], v[100:101], v[20:21] op_sel:[0,0,0] op_sel_hi:[0,1,1]
    v_pk_fma_f32 v[22:23], v[134:135], v[102:103], v[22:23] op_sel:[0,0,0] op_sel_hi:[0,1,1]
    s_set_gpr_idx_off
    v_lshlrev_b32_sdwa v138, v15, v124 dst_sel:DWORD dst_unused:UNUSED_PAD src0_sel:DWORD src1_sel:WORD_1
    s_waitcnt vmcnt(4)
    v_mfma_f32_4x4x4_16b_bf16 v[96:99], v[140:141], v[80:81], 0 cbsz:4 abid:5
    v_readlane_b32 s57, v164, 25
    v_mfma_f32_4x4x4_16b_bf16 v[100:103], v[140:141], v[82:83], 0 cbsz:4 abid:5
    v_lshlrev_b32_sdwa v139, v15, v125 dst_sel:DWORD dst_unused:UNUSED_PAD src0_sel:DWORD src1_sel:WORD_1
    ds_read_u16_d16_hi v130, v138 offset:32768
    ds_read_u16_d16_hi v131, v139 offset:32768
    s_and_b32 s33, s57, s34
    buffer_load_dwordx4 v[68:71], v1, s[12:15], s33 offen
    s_set_gpr_idx_on s51, 0xc
    v_pk_fma_f32 v[16:17], v[132:133], v[104:105], v[16:17] op_sel:[1,0,0] op_sel_hi:[1,1,1]
    v_pk_fma_f32 v[18:19], v[132:133], v[106:107], v[18:19] op_sel:[1,0,0] op_sel_hi:[1,1,1]
    v_pk_fma_f32 v[20:21], v[134:135], v[108:109], v[20:21] op_sel:[1,0,0] op_sel_hi:[1,1,1]
    v_pk_fma_f32 v[22:23], v[134:135], v[110:111], v[22:23] op_sel:[1,0,0] op_sel_hi:[1,1,1]
    s_set_gpr_idx_off
A_20:
    s_sub_u32 s31, s31, 4
    s_cbranch_scc1 B_20
    v_mfma_f32_4x4x4_16b_bf16 v[116:119], v[172:173], v[178:179], 0 cbsz:4 abid:6
    v_lshlrev_b32_sdwa v136, v15, v122 dst_sel:DWORD dst_unused:UNUSED_PAD src0_sel:DWORD src1_sel:WORD_1
    s_waitcnt vmcnt(4)
    v_mfma_f32_4x4x4_16b_bf16 v[104:107], v[142:143], v[84:85], 0 cbsz:4 abid:5
    v_readlane_b32 s58, v164, 26
    v_mfma_f32_4x4x4_16b_bf16 v[108:111], v[142:143], v[86:87], 0 cbsz:4 abid:5
    v_lshlrev_b32_sdwa v137, v15, v123 dst_sel:DWORD dst_unused:UNUSED_PAD src0_sel:DWORD src1_sel:WORD_1
    ds_read_u16_d16_hi v132, v136 offset:32768
    ds_read_u16_d16_hi v133, v137 offset:32768
    s_and_b32 s33, s58, s34
    buffer_load_dwordx4 v[72:75], v1, s[12:15], s33 offen
    s_waitcnt lgkmcnt(2)
    s_set_gpr_idx_on s52, 0xc
    v_pk_fma_f32 v[16:17], v[128:129], v[96:97], v[16:17] op_sel:[0,0,0] op_sel_hi:[0,1,1]
    v_pk_fma_f32 v[18:19], v[128:129], v[98:99], v[18:19] op_sel:[0,0,0] op_sel_hi:[0,1,1]
    v_pk_fma_f32 v[20:21], v[130:131], v[100:101], v[20:21] op_sel:[0,0,0] op_sel_hi:[0,1,1]
    v_pk_fma_f32 v[22:23], v[130:131], v[102:103], v[22:23] op_sel:[0,0,0] op_sel_hi:[0,1,1]
    s_set_gpr_idx_off
    v_lshlrev_b32_sdwa v138, v15, v126 dst_sel:DWORD dst_unused:UNUSED_PAD src0_sel:DWORD src1_sel:WORD_1
    s_waitcnt vmcnt(4)
    v_mfma_f32_4x4x4_16b_bf16 v[96:99], v[144:145], v[88:89], 0 cbsz:4 abid:5
    v_readlane_b32 s59, v164, 27
    v_mfma_f32_4x4x4_16b_bf16 v[100:103], v[144:145], v[90:91], 0 cbsz:4 abid:5
    v_lshlrev_b32_sdwa v139, v15, v127 dst_sel:DWORD dst_unused:UNUSED_PAD src0_sel:DWORD src1_sel:WORD_1
    ds_read_u16_d16_hi v134, v138 offset:32768
    ds_read_u16_d16_hi v135, v139 offset:32768
    s_and_b32 s33, s59, s34
    buffer_load_dwordx4 v[76:79], v1, s[12:15], s33 offen
    s_set_gpr_idx_on s53, 0xc
    v_pk_fma_f32 v[16:17], v[128:129], v[104:105], v[16:17] op_sel:[1,0,0] op_sel_hi:[1,1,1]
    v_pk_fma_f32 v[18:19], v[128:129], v[106:107], v[18:19] op_sel:[1,0,0] op_sel_hi:[1,1,1]
    v_pk_fma_f32 v[20:21], v[130:131], v[108:109], v[20:21] op_sel:[1,0,0] op_sel_hi:[1,1,1]
    v_pk_fma_f32 v[22:23], v[130:131], v[110:111], v[22:23] op_sel:[1,0,0] op_sel_hi:[1,1,1]
    s_set_gpr_idx_off
    v_mfma_f32_4x4x4_16b_bf16 v[120:123], v[172:173], v[176:177], 0 cbsz:4 abid:7
    v_lshlrev_b32_sdwa v136, v15, v112 dst_sel:DWORD dst_unused:UNUSED_PAD src0_sel:DWORD src1_sel:WORD_1
    s_waitcnt vmcnt(4)
    v_mfma_f32_4x4x4_16b_bf16 v[104:107], v[146:147], v[92:93], 0 cbsz:4 abid:5
    v_readlane_b32 s60, v164, 28
    v_mfma_f32_4x4x4_16b_bf16 v[108:111], v[146:147], v[94:95], 0 cbsz:4 abid:5
    v_lshlrev_b32_sdwa v137, v15, v113 dst_sel:DWORD dst_unused:UNUSED_PAD src0_sel:DWORD src1_sel:WORD_1
    ds_read_u16_d16_hi v128, v136 offset:32768
    ds_read_u16_d16_hi v129, v137 offset:32768
    s_and_b32 s33, s60, s34
    buffer_load_dwordx4 v[80:83], v1, s[12:15], s33 offen
    s_waitcnt lgkmcnt(2)
    s_set_gpr_idx_on s54, 0xc
    v_pk_fma_f32 v[16:17], v[132:133], v[96:97], v[16:17] op_sel:[0,0,0] op_sel_hi:[0,1,1]
    v_pk_fma_f32 v[18:19], v[132:133], v[98:99], v[18:19] op_sel:[0,0,0] op_sel_hi:[0,1,1]
    v_pk_fma_f32 v[20:21], v[134:135], v[100:101], v[20:21] op_sel:[0,0,0] op_sel_hi:[0,1,1]
    v_pk_fma_f32 v[22:23], v[134:135], v[102:103], v[22:23] op_sel:[0,0,0] op_sel_hi:[0,1,1]
    s_set_gpr_idx_off
    v_lshlrev_b32_sdwa v138, v15, v116 dst_sel:DWORD dst_unused:UNUSED_PAD src0_sel:DWORD src1_sel:WORD_1
    s_waitcnt vmcnt(4)
    v_mfma_f32_4x4x4_16b_bf16 v[96:99], v[140:141], v[64:65], 0 cbsz:4 abid:6
    v_readlane_b32 s61, v164, 29
    v_mfma_f32_4x4x4_16b_bf16 v[100:103], v[140:141], v[66:67], 0 cbsz:4 abid:6
    v_lshlrev_b32_sdwa v139, v15, v117 dst_sel:DWORD dst_unused:UNUSED_PAD src0_sel:DWORD src1_sel:WORD_1
    ds_read_u16_d16_hi v130, v138 offset:32768
    ds_read_u16_d16_hi v131, v139 offset:32768
    s_and_b32 s33, s61, s34
    buffer_load_dwordx4 v[84:87], v1, s[12:15], s33 offen
    s_set_gpr_idx_on s55, 0xc
    v_pk_fma_f32 v[16:17], v[132:133], v[104:105], v[16:17] op_sel:[1,0,0] op_sel_hi:[1,1,1]
    v_pk_fma_f32 v[18:19], v[132:133], v[106:107], v[18:19] op_sel:[1,0,0] op_sel_hi:[1,1,1]
    v_pk_fma_f32 v[20:21], v[134:135], v[108:109], v[20:21] op_sel:[1,0,0] op_sel_hi:[1,1,1]
    v_pk_fma_f32 v[22:23], v[134:135], v[110:111], v[22:23] op_sel:[1,0,0] op_sel_hi:[1,1,1]
    s_set_gpr_idx_off
A_24:
    s_sub_u32 s31, s31, 4
    s_cbranch_scc1 B_24
    v_mfma_f32_4x4x4_16b_bf16 v[124:127], v[172:173], v[178:179], 0 cbsz:4 abid:7
    v_lshlrev_b32_sdwa v136, v15, v114 dst_sel:DWORD dst_unused:UNUSED_PAD src0_sel:DWORD src1_sel:WORD_1
    s_waitcnt vmcnt(4)
    v_mfma_f32_4x4x4_16b_bf16 v[104:107], v[142:143], v[68:69], 0 cbsz:4 abid:6
    v_readlane_b32 s62, v164, 30
    v_mfma_f32_4x4x4_16b_bf16 v[108:111], v[142:143], v[70:71], 0 cbsz:4 abid:6
    v_lshlrev_b32_sdwa v137, v15, v115 dst_sel:DWORD dst_unused:UNUSED_PAD src0_sel:DWORD src1_sel:WORD_1
    ds_read_u16_d16_hi v132, v136 offset:32768
    ds_read_u16_d16_hi v133, v137 offset:32768
    s_and_b32 s33, s62, s34
    buffer_load_dwordx4 v[88:91], v1, s[12:15], s33 offen
    s_waitcnt lgkmcnt(2)
    s_set_gpr_idx_on s56, 0xc
    v_pk_fma_f32 v[16:17], v[128:129], v[96:97], v[16:17] op_sel:[0,0,0] op_sel_hi:[0,1,1]
    v_pk_fma_f32 v[18:19], v[128:129], v[98:99], v[18:19] op_sel:[0,0,0] op_sel_hi:[0,1,1]
    v_pk_fma_f32 v[20:21], v[130:131], v[100:101], v[20:21] op_sel:[0,0,0] op_sel_hi:[0,1,1]
    v_pk_fma_f32 v[22:23], v[130:131], v[102:103], v[22:23] op_sel:[0,0,0] op_sel_hi:[0,1,1]
    s_set_gpr_idx_off
    v_lshlrev_b32_sdwa v138, v15, v118 dst_sel:DWORD dst_unused:UNUSED_PAD src0_sel:DWORD src1_sel:WORD_1
    s_waitcnt vmcnt(4)
    v_mfma_f32_4x4x4_16b_bf16 v[96:99], v[144:145], v[72:73], 0 cbsz:4 abid:6
    v_readlane_b32 s63, v164, 31
    v_mfma_f32_4x4x4_16b_bf16 v[100:103], v[144:145], v[74:75], 0 cbsz:4 abid:6
    v_lshlrev_b32_sdwa v139, v15, v119 dst_sel:DWORD dst_unused:UNUSED_PAD src0_sel:DWORD src1_sel:WORD_1
    ds_read_u16_d16_hi v134, v138 offset:32768
    ds_read_u16_d16_hi v135, v139 offset:32768
    s_and_b32 s33, s63, s34
    buffer_load_dwordx4 v[92:95], v1, s[12:15], s33 offen
    s_set_gpr_idx_on s57, 0xc
    v_pk_fma_f32 v[16:17], v[128:129], v[104:105], v[16:17] op_sel:[1,0,0] op_sel_hi:[1,1,1]
    v_pk_fma_f32 v[18:19], v[128:129], v[106:107], v[18:19] op_sel:[1,0,0] op_sel_hi:[1,1,1]
    v_pk_fma_f32 v[20:21], v[130:131], v[108:109], v[20:21] op_sel:[1,0,0] op_sel_hi:[1,1,1]
    v_pk_fma_f32 v[22:23], v[130:131], v[110:111], v[22:23] op_sel:[1,0,0] op_sel_hi:[1,1,1]
    s_set_gpr_idx_off
    v_mfma_f32_4x4x4_16b_bf16 v[112:115], v[172:173], v[176:177], 0 cbsz:4 abid:8
    v_lshlrev_b32_sdwa v136, v15, v120 dst_sel:DWORD dst_unused:UNUSED_PAD src0_sel:DWORD src1_sel:WORD_1
    s_waitcnt vmcnt(4)
    v_mfma_f32_4x4x4_16b_bf16 v[104:107], v[146:147], v[76:77], 0 cbsz:4 abid:6
    v_readlane_b32 s48, v164, 32
    v_mfma_f32_4x4x4_16b_bf16 v[108:111], v[146:147], v[78:79], 0 cbsz:4 abid:6
    v_lshlrev_b32_sdwa v137, v15, v121 dst_sel:DWORD dst_unused:UNUSED_PAD src0_sel:DWORD src1_sel:WORD_1
    ds_read_u16_d16_hi v128, v136 offset:32768
    ds_read_u16_d16_hi v129, v137 offset:32768
    s_and_b32 s33, s48, s34
    buffer_load_dwordx4 v[64:67], v1, s[12:15], s33 offen
    s_waitcnt lgkmcnt(2)
    s_set_gpr_idx_on s58, 0xc
    v_pk_fma_f32 v[16:17], v[132:133], v[96:97], v[16:17] op_sel:[0,0,0] op_sel_hi:[0,1,1]
    v_pk_fma_f32 v[18:19], v[132:133], v[98:99], v[18:19] op_sel:[0,0,0] op_sel_hi:[0,1,1]
    v_pk_fma_f32 v[20:21], v[134:135], v[100:101], v[20:21] op_sel:[0,0,0] op_sel_hi:[0,1,1]
    v_pk_fma_f32 v[22:23], v[134:135], v[102:103], v[22:23] op_sel:[0,0,0] op_sel_hi:[0,1,1]
    s_set_gpr_idx_off
    v_lshlrev_b32_sdwa v138, v15, v124 dst_sel:DWORD dst_unused:UNUSED_PAD src0_sel:DWORD src1_sel:WORD_1
    s_waitcnt vmcnt(4)
    v_mfma_f32_4x4x4_16b_bf16 v[96:99], v[140:141], v[80:81], 0 cbsz:4 abid:7
    v_readlane_b32 s49, v164, 33
    v_mfma_f32_4x4x4_16b_bf16 v[100:103], v[140:141], v[82:83], 0 cbsz:4 abid:7
    v_lshlrev_b32_sdwa v139, v15, v125 dst_sel:DWORD dst_unused:UNUSED_PAD src0_sel:DWORD src1_sel:WORD_1
    ds_read_u16_d16_hi v130, v138 offset:32768
    ds_read_u16_d16_hi v131, v139 offset:32768
    s_and_b32 s33, s49, s34
    buffer_load_dwordx4 v[68:71], v1, s[12:15], s33 offen
    s_set_gpr_idx_on s59, 0xc
    v_pk_fma_f32 v[16:17], v[132:133], v[104:105], v[16:17] op_sel:[1,0,0] op_sel_hi:[1,1,1]
    v_pk_fma_f32 v[18:19], v[132:133], v[106:107], v[18:19] op_sel:[1,0,0] op_sel_hi:[1,1,1]
    v_pk_fma_f32 v[20:21], v[134:135], v[108:109], v[20:21] op_sel:[1,0,0] op_sel_hi:[1,1,1]
    v_pk_fma_f32 v[22:23], v[134:135], v[110:111], v[22:23] op_sel:[1,0,0] op_sel_hi:[1,1,1]
    s_set_gpr_idx_off
A_28:
    s_sub_u32 s31, s31, 4
    s_cbranch_scc1 B_28
    v_mfma_f32_4x4x4_16b_bf16 v[116:119], v[172:173], v[178:179], 0 cbsz:4 abid:8
    v_lshlrev_b32_sdwa v136, v15, v122 dst_sel:DWORD dst_unused:UNUSED_PAD src0_sel:DWORD src1_sel:WORD_1
    s_waitcnt vmcnt(4)
    v_mfma_f32_4x4x4_16b_bf16 v[104:107], v[142:143], v[84:85], 0 cbsz:4 abid:7
    v_readlane_b32 s50, v164, 34
    v_mfma_f32_4x4x4_16b_bf16 v[108:111], v[142:143], v[86:87], 0 cbsz:4 abid:7
    v_lshlrev_b32_sdwa v137, v15, v123 dst_sel:DWORD dst_unused:UNUSED_PAD src0_sel:DWORD src1_sel:WORD_1
    ds_read_u16_d16_hi v132, v136 offset:32768
    ds_read_u16_d16_hi v133, v137 offset:32768
    s_and_b32 s33, s50, s34
    buffer_load_dwordx4 v[72:75], v1, s[12:15], s33 offen
    s_waitcnt lgkmcnt(2)
    s_set_gpr_idx_on s60, 0xc
    v_pk_fma_f32 v[16:17], v[128:129], v[96:97], v[16:17] op_sel:[0,0,0] op_sel_hi:[0,1,1]
    v_pk_fma_f32 v[18:19], v[128:129], v[98:99], v[18:19] op_sel:[0,0,0] op_sel_hi:[0,1,1]
    v_pk_fma_f32 v[20:21], v[130:131], v[100:101], v[20:21] op_sel:[0,0,0] op_sel_hi:[0,1,1]
    v_pk_fma_f32 v[22:23], v[130:131], v[102:103], v[22:23] op_sel:[0,0,0] op_sel_hi:[0,1,1]
    s_set_gpr_idx_off
    v_lshlrev_b32_sdwa v138, v15, v126 dst_sel:DWORD dst_unused:UNUSED_PAD src0_sel:DWORD src1_sel:WORD_1
    s_waitcnt vmcnt(4)
    v_mfma_f32_4x4x4_16b_bf16 v[96:99], v[144:145], v[88:89], 0 cbsz:4 abid:7
    v_readlane_b32 s51, v164, 35
    v_mfma_f32_4x4x4_16b_bf16 v[100:103], v[144:145], v[90:91], 0 cbsz:4 abid:7
    v_lshlrev_b32_sdwa v139, v15, v127 dst_sel:DWORD dst_unused:UNUSED_PAD src0_sel:DWORD src1_sel:WORD_1
    ds_read_u16_d16_hi v134, v138 offset:32768
    ds_read_u16_d16_hi v135, v139 offset:32768
    s_and_b32 s33, s51, s34
    buffer_load_dwordx4 v[76:79], v1, s[12:15], s33 offen
    s_set_gpr_idx_on s61, 0xc
    v_pk_fma_f32 v[16:17], v[128:129], v[104:105], v[16:17] op_sel:[1,0,0] op_sel_hi:[1,1,1]
    v_pk_fma_f32 v[18:19], v[128:129], v[106:107], v[18:19] op_sel:[1,0,0] op_sel_hi:[1,1,1]
    v_pk_fma_f32 v[20:21], v[130:131], v[108:109], v[20:21] op_sel:[1,0,0] op_sel_hi:[1,1,1]
    v_pk_fma_f32 v[22:23], v[130:131], v[110:111], v[22:23] op_sel:[1,0,0] op_sel_hi:[1,1,1]
    s_set_gpr_idx_off
    v_mfma_f32_4x4x4_16b_bf16 v[120:123], v[172:173], v[176:177], 0 cbsz:4 abid:9
    v_lshlrev_b32_sdwa v136, v15, v112 dst_sel:DWORD dst_unused:UNUSED_PAD src0_sel:DWORD src1_sel:WORD_1
    s_waitcnt vmcnt(4)
    v_mfma_f32_4x4x4_16b_bf16 v[104:107], v[146:147], v[92:93], 0 cbsz:4 abid:7
    v_readlane_b32 s52, v164, 36
    v_mfma_f32_4x4x4_16b_bf16 v[108:111], v[146:147], v[94:95], 0 cbsz:4 abid:7
    v_lshlrev_b32_sdwa v137, v15, v113 dst_sel:DWORD dst_unused:UNUSED_PAD src0_sel:DWORD src1_sel:WORD_1
    ds_read_u16_d16_hi v128, v136 offset:32768
    ds_read_u16_d16_hi v129, v137 offset:32768
    s_and_b32 s33, s52, s34
    buffer_load_dwordx4 v[80:83], v1, s[12:15], s33 offen
    s_waitcnt lgkmcnt(2)
    s_set_gpr_idx_on s62, 0xc
    v_pk_fma_f32 v[16:17], v[132:133], v[96:97], v[16:17] op_sel:[0,0,0] op_sel_hi:[0,1,1]
    v_pk_fma_f32 v[18:19], v[132:133], v[98:99], v[18:19] op_sel:[0,0,0] op_sel_hi:[0,1,1]
    v_pk_fma_f32 v[20:21], v[134:135], v[100:101], v[20:21] op_sel:[0,0,0] op_sel_hi:[0,1,1]
    v_pk_fma_f32 v[22:23], v[134:135], v[102:103], v[22:23] op_sel:[0,0,0] op_sel_hi:[0,1,1]
    s_set_gpr_idx_off
    v_lshlrev_b32_sdwa v138, v15, v116 dst_sel:DWORD dst_unused:UNUSED_PAD src0_sel:DWORD src1_sel:WORD_1
    s_waitcnt vmcnt(4)
    v_mfma_f32_4x4x4_16b_bf16 v[96:99], v[140:141], v[64:65], 0 cbsz:4 abid:8
    v_readlane_b32 s53, v164, 37
    v_mfma_f32_4x4x4_16b_bf16 v[100:103], v[140:141], v[66:67], 0 cbsz:4 abid:8
    v_lshlrev_b32_sdwa v139, v15, v117 dst_sel:DWORD dst_unused:UNUSED_PAD src0_sel:DWORD src1_sel:WORD_1
    ds_read_u16_d16_hi v130, v138 offset:32768
    ds_read_u16_d16_hi v131, v139 offset:32768
    s_and_b32 s33, s53, s34
    buffer_load_dwordx4 v[84:87], v1, s[12:15], s33 offen
    s_set_gpr_idx_on s63, 0xc
    v_pk_fma_f32 v[16:17], v[132:133], v[104:105], v[16:17] op_sel:[1,0,0] op_sel_hi:[1,1,1]
    v_pk_fma_f32 v[18:19], v[132:133], v[106:107], v[18:19] op_sel:[1,0,0] op_sel_hi:[1,1,1]
    v_pk_fma_f32 v[20:21], v[134:135], v[108:109], v[20:21] op_sel:[1,0,0] op_sel_hi:[1,1,1]
    v_pk_fma_f32 v[22:23], v[134:135], v[110:111], v[22:23] op_sel:[1,0,0] op_sel_hi:[1,1,1]
    s_set_gpr_idx_off
A_32:
    s_sub_u32 s31, s31, 4
    s_cbranch_scc1 B_32
    v_mfma_f32_4x4x4_16b_bf16 v[124:127], v[172:173], v[178:179], 0 cbsz:4 abid:9
    v_lshlrev_b32_sdwa v136, v15, v114 dst_sel:DWORD dst_unused:UNUSED_PAD src0_sel:DWORD src1_sel:WORD_1
    s_waitcnt vmcnt(4)
    v_mfma_f32_4x4x4_16b_bf16 v[104:107], v[142:143], v[68:69], 0 cbsz:4 abid:8
    v_readlane_b32 s54, v164, 38
    v_mfma_f32_4x4x4_16b_bf16 v[108:111], v[142:143], v[70:71], 0 cbsz:4 abid:8
    v_lshlrev_b32_sdwa v137, v15, v115 dst_sel:DWORD dst_unused:UNUSED_PAD src0_sel:DWORD src1_sel:WORD_1
    ds_read_u16_d16_hi v132, v136 offset:32768
    ds_read_u16_d16_hi v133, v137 offset:32768
    s_and_b32 s33, s54, s34
    buffer_load_dwordx4 v[88:91], v1, s[12:15], s33 offen
    s_waitcnt lgkmcnt(2)
    s_set_gpr_idx_on s48, 0xc
    v_pk_fma_f32 v[16:17], v[128:129], v[96:97], v[16:17] op_sel:[0,0,0] op_sel_hi:[0,1,1]
    v_pk_fma_f32 v[18:19], v[128:129], v[98:99], v[18:19] op_sel:[0,0,0] op_sel_hi:[0,1,1]
    v_pk_fma_f32 v[20:21], v[130:131], v[100:101], v[20:21] op_sel:[0,0,0] op_sel_hi:[0,1,1]
    v_pk_fma_f32 v[22:23], v[130:131], v[102:103], v[22:23] op_sel:[0,0,0] op_sel_hi:[0,1,1]
    s_set_gpr_idx_off
    v_lshlrev_b32_sdwa v138, v15, v118 dst_sel:DWORD dst_unused:UNUSED_PAD src0_sel:DWORD src1_sel:WORD_1
    s_waitcnt vmcnt(4)
    v_mfma_f32_4x4x4_16b_bf16 v[96:99], v[144:145], v[72:73], 0 cbsz:4 abid:8
    v_readlane_b32 s55, v164, 39
    v_mfma_f32_4x4x4_16b_bf16 v[100:103], v[144:145], v[74:75], 0 cbsz:4 abid:8
    v_lshlrev_b32_sdwa v139, v15, v119 dst_sel:DWORD dst_unused:UNUSED_PAD src0_sel:DWORD src1_sel:WORD_1
    ds_read_u16_d16_hi v134, v138 offset:32768
    ds_read_u16_d16_hi v135, v139 offset:32768
    s_and_b32 s33, s55, s34
    buffer_load_dwordx4 v[92:95], v1, s[12:15], s33 offen
    s_set_gpr_idx_on s49, 0xc
    v_pk_fma_f32 v[16:17], v[128:129], v[104:105], v[16:17] op_sel:[1,0,0] op_sel_hi:[1,1,1]
    v_pk_fma_f32 v[18:19], v[128:129], v[106:107], v[18:19] op_sel:[1,0,0] op_sel_hi:[1,1,1]
    v_pk_fma_f32 v[20:21], v[130:131], v[108:109], v[20:21] op_sel:[1,0,0] op_sel_hi:[1,1,1]
    v_pk_fma_f32 v[22:23], v[130:131], v[110:111], v[22:23] op_sel:[1,0,0] op_sel_hi:[1,1,1]
    s_set_gpr_idx_off
    v_mfma_f32_4x4x4_16b_bf16 v[112:115], v[172:173], v[176:177], 0 cbsz:4 abid:10
    v_lshlrev_b32_sdwa v136, v15, v120 dst_sel:DWORD dst_unused:UNUSED_PAD src0_sel:DWORD src1_sel:WORD_1
    s_waitcnt vmcnt(4)
    v_mfma_f32_4x4x4_16b_bf16 v[104:107], v[146:147], v[76:77], 0 cbsz:4 abid:8
    v_readlane_b32 s56, v164, 40
    v_mfma_f32_4x4x4_16b_bf16 v[108:111], v[146:147], v[78:79], 0 cbsz:4 abid:8
    v_lshlrev_b32_sdwa v137, v15, v121 dst_sel:DWORD dst_unused:UNUSED_PAD src0_sel:DWORD src1_sel:WORD_1
    ds_read_u16_d16_hi v128, v136 offset:32768
    ds_read_u16_d16_hi v129, v137 offset:32768
    s_and_b32 s33, s56, s34
    buffer_load_dwordx4 v[64:67], v1, s[12:15], s33 offen
    s_waitcnt lgkmcnt(2)
    s_set_gpr_idx_on s50, 0xc
    v_pk_fma_f32 v[16:17], v[132:133], v[96:97], v[16:17] op_sel:[0,0,0] op_sel_hi:[0,1,1]
    v_pk_fma_f32 v[18:19], v[132:133], v[98:99], v[18:19] op_sel:[0,0,0] op_sel_hi:[0,1,1]
    v_pk_fma_f32 v[20:21], v[134:135], v[100:101], v[20:21] op_sel:[0,0,0] op_sel_hi:[0,1,1]
    v_pk_fma_f32 v[22:23], v[134:135], v[102:103], v[22:23] op_sel:[0,0,0] op_sel_hi:[0,1,1]
    s_set_gpr_idx_off
    v_lshlrev_b32_sdwa v138, v15, v124 dst_sel:DWORD dst_unused:UNUSED_PAD src0_sel:DWORD src1_sel:WORD_1
    s_waitcnt vmcnt(4)
    v_mfma_f32_4x4x4_16b_bf16 v[96:99], v[140:141], v[80:81], 0 cbsz:4 abid:9
    v_readlane_b32 s57, v164, 41
    v_mfma_f32_4x4x4_16b_bf16 v[100:103], v[140:141], v[82:83], 0 cbsz:4 abid:9
    v_lshlrev_b32_sdwa v139, v15, v125 dst_sel:DWORD dst_unused:UNUSED_PAD src0_sel:DWORD src1_sel:WORD_1
    ds_read_u16_d16_hi v130, v138 offset:32768
    ds_read_u16_d16_hi v131, v139 offset:32768
    s_and_b32 s33, s57, s34
    buffer_load_dwordx4 v[68:71], v1, s[12:15], s33 offen
    s_set_gpr_idx_on s51, 0xc
    v_pk_fma_f32 v[16:17], v[132:133], v[104:105], v[16:17] op_sel:[1,0,0] op_sel_hi:[1,1,1]
    v_pk_fma_f32 v[18:19], v[132:133], v[106:107], v[18:19] op_sel:[1,0,0] op_sel_hi:[1,1,1]
    v_pk_fma_f32 v[20:21], v[134:135], v[108:109], v[20:21] op_sel:[1,0,0] op_sel_hi:[1,1,1]
    v_pk_fma_f32 v[22:23], v[134:135], v[110:111], v[22:23] op_sel:[1,0,0] op_sel_hi:[1,1,1]
    s_set_gpr_idx_off
A_36:
    s_sub_u32 s31, s31, 4
    s_cbranch_scc1 B_36
    v_mfma_f32_4x4x4_16b_bf16 v[116:119], v[172:173], v[178:179], 0 cbsz:4 abid:10
    v_lshlrev_b32_sdwa v136, v15, v122 dst_sel:DWORD dst_unused:UNUSED_PAD src0_sel:DWORD src1_sel:WORD_1
    s_waitcnt vmcnt(4)
    v_mfma_f32_4x4x4_16b_bf16 v[104:107], v[142:143], v[84:85], 0 cbsz:4 abid:9
    v_readlane_b32 s58, v164, 42
    v_mfma_f32_4x4x4_16b_bf16 v[108:111], v[142:143], v[86:87], 0 cbsz:4 abid:9
    v_lshlrev_b32_sdwa v137, v15, v123 dst_sel:DWORD dst_unused:UNUSED_PAD src0_sel:DWORD src1_sel:WORD_1
    ds_read_u16_d16_hi v132, v136 offset:32768
    ds_read_u16_d16_hi v133, v137 offset:32768
    s_and_b32 s33, s58, s34
    buffer_load_dwordx4 v[72:75], v1, s[12:15], s33 offen
    s_waitcnt lgkmcnt(2)
    s_set_gpr_idx_on s52, 0xc
    v_pk_fma_f32 v[16:17], v[128:129], v[96:97], v[16:17] op_sel:[0,0,0] op_sel_hi:[0,1,1]
    v_pk_fma_f32 v[18:19], v[128:129], v[98:99], v[18:19] op_sel:[0,0,0] op_sel_hi:[0,1,1]
    v_pk_fma_f32 v[20:21], v[130:131], v[100:101], v[20:21] op_sel:[0,0,0] op_sel_hi:[0,1,1]
    v_pk_fma_f32 v[22:23], v[130:131], v[102:103], v[22:23] op_sel:[0,0,0] op_sel_hi:[0,1,1]
    s_set_gpr_idx_off
    v_lshlrev_b32_sdwa v138, v15, v126 dst_sel:DWORD dst_unused:UNUSED_PAD src0_sel:DWORD src1_sel:WORD_1
    s_waitcnt vmcnt(4)
    v_mfma_f32_4x4x4_16b_bf16 v[96:99], v[144:145], v[88:89], 0 cbsz:4 abid:9
    v_readlane_b32 s59, v164, 43
    v_mfma_f32_4x4x4_16b_bf16 v[100:103], v[144:145], v[90:91], 0 cbsz:4 abid:9
    v_lshlrev_b32_sdwa v139, v15, v127 dst_sel:DWORD dst_unused:UNUSED_PAD src0_sel:DWORD src1_sel:WORD_1
    ds_read_u16_d16_hi v134, v138 offset:32768
    ds_read_u16_d16_hi v135, v139 offset:32768
    s_and_b32 s33, s59, s34
    buffer_load_dwordx4 v[76:79], v1, s[12:15], s33 offen
    s_set_gpr_idx_on s53, 0xc
    v_pk_fma_f32 v[16:17], v[128:129], v[104:105], v[16:17] op_sel:[1,0,0] op_sel_hi:[1,1,1]
    v_pk_fma_f32 v[18:19], v[128:129], v[106:107], v[18:19] op_sel:[1,0,0] op_sel_hi:[1,1,1]
    v_pk_fma_f32 v[20:21], v[130:131], v[108:109], v[20:21] op_sel:[1,0,0] op_sel_hi:[1,1,1]
    v_pk_fma_f32 v[22:23], v[130:131], v[110:111], v[22:23] op_sel:[1,0,0] op_sel_hi:[1,1,1]
    s_set_gpr_idx_off
    v_mfma_f32_4x4x4_16b_bf16 v[120:123], v[172:173], v[176:177], 0 cbsz:4 abid:11
    v_lshlrev_b32_sdwa v136, v15, v112 dst_sel:DWORD dst_unused:UNUSED_PAD src0_sel:DWORD src1_sel:WORD_1
    s_waitcnt vmcnt(4)
    v_mfma_f32_4x4x4_16b_bf16 v[104:107], v[146:147], v[92:93], 0 cbsz:4 abid:9
    v_readlane_b32 s60, v164, 44
    v_mfma_f32_4x4x4_16b_bf16 v[108:111], v[146:147], v[94:95], 0 cbsz:4 abid:9
    v_lshlrev_b32_sdwa v137, v15, v113 dst_sel:DWORD dst_unused:UNUSED_PAD src0_sel:DWORD src1_sel:WORD_1
    ds_read_u16_d16_hi v128, v136 offset:32768
    ds_read_u16_d16_hi v129, v137 offset:32768
    s_and_b32 s33, s60, s34
    buffer_load_dwordx4 v[80:83], v1, s[12:15], s33 offen
    s_waitcnt lgkmcnt(2)
    s_set_gpr_idx_on s54, 0xc
    v_pk_fma_f32 v[16:17], v[132:133], v[96:97], v[16:17] op_sel:[0,0,0] op_sel_hi:[0,1,1]
    v_pk_fma_f32 v[18:19], v[132:133], v[98:99], v[18:19] op_sel:[0,0,0] op_sel_hi:[0,1,1]
    v_pk_fma_f32 v[20:21], v[134:135], v[100:101], v[20:21] op_sel:[0,0,0] op_sel_hi:[0,1,1]
    v_pk_fma_f32 v[22:23], v[134:135], v[102:103], v[22:23] op_sel:[0,0,0] op_sel_hi:[0,1,1]
    s_set_gpr_idx_off
    v_lshlrev_b32_sdwa v138, v15, v116 dst_sel:DWORD dst_unused:UNUSED_PAD src0_sel:DWORD src1_sel:WORD_1
    s_waitcnt vmcnt(4)
    v_mfma_f32_4x4x4_16b_bf16 v[96:99], v[140:141], v[64:65], 0 cbsz:4 abid:10
    v_readlane_b32 s61, v164, 45
    v_mfma_f32_4x4x4_16b_bf16 v[100:103], v[140:141], v[66:67], 0 cbsz:4 abid:10
    v_lshlrev_b32_sdwa v139, v15, v117 dst_sel:DWORD dst_unused:UNUSED_PAD src0_sel:DWORD src1_sel:WORD_1
    ds_read_u16_d16_hi v130, v138 offset:32768
    ds_read_u16_d16_hi v131, v139 offset:32768
    s_and_b32 s33, s61, s34
    buffer_load_dwordx4 v[84:87], v1, s[12:15], s33 offen
    s_set_gpr_idx_on s55, 0xc
    v_pk_fma_f32 v[16:17], v[132:133], v[104:105], v[16:17] op_sel:[1,0,0] op_sel_hi:[1,1,1]
    v_pk_fma_f32 v[18:19], v[132:133], v[106:107], v[18:19] op_sel:[1,0,0] op_sel_hi:[1,1,1]
    v_pk_fma_f32 v[20:21], v[134:135], v[108:109], v[20:21] op_sel:[1,0,0] op_sel_hi:[1,1,1]
    v_pk_fma_f32 v[22:23], v[134:135], v[110:111], v[22:23] op_sel:[1,0,0] op_sel_hi:[1,1,1]
    s_set_gpr_idx_off
A_40:
    s_sub_u32 s31, s31, 4
    s_cbranch_scc1 B_40
    v_mfma_f32_4x4x4_16b_bf16 v[124:127], v[172:173], v[178:179], 0 cbsz:4 abid:11
    v_lshlrev_b32_sdwa v136, v15, v114 dst_sel:DWORD dst_unused:UNUSED_PAD src0_sel:DWORD src1_sel:WORD_1
    s_waitcnt vmcnt(4)
    v_mfma_f32_4x4x4_16b_bf16 v[104:107], v[142:143], v[68:69], 0 cbsz:4 abid:10
    v_readlane_b32 s62, v164, 46
    v_mfma_f32_4x4x4_16b_bf16 v[108:111], v[142:143], v[70:71], 0 cbsz:4 abid:10
    v_lshlrev_b32_sdwa v137, v15, v115 dst_sel:DWORD dst_unused:UNUSED_PAD src0_sel:DWORD src1_sel:WORD_1
    ds_read_u16_d16_hi v132, v136 offset:32768
    ds_read_u16_d16_hi v133, v137 offset:32768
    s_and_b32 s33, s62, s34
    buffer_load_dwordx4 v[88:91], v1, s[12:15], s33 offen
    s_waitcnt lgkmcnt(2)
    s_set_gpr_idx_on s56, 0xc
    v_pk_fma_f32 v[16:17], v[128:129], v[96:97], v[16:17] op_sel:[0,0,0] op_sel_hi:[0,1,1]
    v_pk_fma_f32 v[18:19], v[128:129], v[98:99], v[18:19] op_sel:[0,0,0] op_sel_hi:[0,1,1]
    v_pk_fma_f32 v[20:21], v[130:131], v[100:101], v[20:21] op_sel:[0,0,0] op_sel_hi:[0,1,1]
    v_pk_fma_f32 v[22:23], v[130:131], v[102:103], v[22:23] op_sel:[0,0,0] op_sel_hi:[0,1,1]
    s_set_gpr_idx_off
    v_mfma_f32_4x4x4_16b_bf16 v[148:151], v[168:169], v[180:181], 0
    v_lshlrev_b32_sdwa v138, v15, v118 dst_sel:DWORD dst_unused:UNUSED_PAD src0_sel:DWORD src1_sel:WORD_1
    s_waitcnt vmcnt(4)
    v_mfma_f32_4x4x4_16b_bf16 v[96:99], v[144:145], v[72:73], 0 cbsz:4 abid:10
    v_readlane_b32 s63, v164, 47
    v_mfma_f32_4x4x4_16b_bf16 v[100:103], v[144:145], v[74:75], 0 cbsz:4 abid:10
    v_lshlrev_b32_sdwa v139, v15, v119 dst_sel:DWORD dst_unused:UNUSED_PAD src0_sel:DWORD src1_sel:WORD_1
    ds_read_u16_d16_hi v134, v138 offset:32768
    ds_read_u16_d16_hi v135, v139 offset:32768
    s_and_b32 s33, s63, s34
    buffer_load_dwordx4 v[92:95], v1, s[12:15], s33 offen
    s_set_gpr_idx_on s57, 0xc
    v_pk_fma_f32 v[16:17], v[128:129], v[104:105], v[16:17] op_sel:[1,0,0] op_sel_hi:[1,1,1]
    v_pk_fma_f32 v[18:19], v[128:129], v[106:107], v[18:19] op_sel:[1,0,0] op_sel_hi:[1,1,1]
    v_pk_fma_f32 v[20:21], v[130:131], v[108:109], v[20:21] op_sel:[1,0,0] op_sel_hi:[1,1,1]
    v_pk_fma_f32 v[22:23], v[130:131], v[110:111], v[22:23] op_sel:[1,0,0] op_sel_hi:[1,1,1]
    s_set_gpr_idx_off
    v_mfma_f32_4x4x4_16b_bf16 v[112:115], v[172:173], v[176:177], 0 cbsz:4 abid:12
    v_lshlrev_b32_sdwa v136, v15, v120 dst_sel:DWORD dst_unused:UNUSED_PAD src0_sel:DWORD src1_sel:WORD_1
    s_waitcnt vmcnt(4)
    v_mfma_f32_4x4x4_16b_bf16 v[104:107], v[146:147], v[76:77], 0 cbsz:4 abid:10
    v_readlane_b32 s48, v164, 48
    v_mfma_f32_4x4x4_16b_bf16 v[108:111], v[146:147], v[78:79], 0 cbsz:4 abid:10
    v_lshlrev_b32_sdwa v137, v15, v121 dst_sel:DWORD dst_unused:UNUSED_PAD src0_sel:DWORD src1_sel:WORD_1
    ds_read_u16_d16_hi v128, v136 offset:32768
    ds_read_u16_d16_hi v129, v137 offset:32768
    s_and_b32 s33, s48, s34
    buffer_load_dwordx4 v[64:67], v1, s[12:15], s33 offen
    s_waitcnt lgkmcnt(2)
    s_set_gpr_idx_on s58, 0xc
    v_pk_fma_f32 v[16:17], v[132:133], v[96:97], v[16:17] op_sel:[0,0,0] op_sel_hi:[0,1,1]
    v_pk_fma_f32 v[18:19], v[132:133], v[98:99], v[18:19] op_sel:[0,0,0] op_sel_hi:[0,1,1]
    v_pk_fma_f32 v[20:21], v[134:135], v[100:101], v[20:21] op_sel:[0,0,0] op_sel_hi:[0,1,1]
    v_pk_fma_f32 v[22:23], v[134:135], v[102:103], v[22:23] op_sel:[0,0,0] op_sel_hi:[0,1,1]
    s_set_gpr_idx_off
    v_mfma_f32_4x4x4_16b_bf16 v[152:155], v[168:169], v[182:183], 0
    v_lshlrev_b32_sdwa v138, v15, v124 dst_sel:DWORD dst_unused:UNUSED_PAD src0_sel:DWORD src1_sel:WORD_1
    s_waitcnt vmcnt(4)
    v_mfma_f32_4x4x4_16b_bf16 v[96:99], v[140:141], v[80:81], 0 cbsz:4 abid:11
    v_readlane_b32 s49, v164, 49
    v_mfma_f32_4x4x4_16b_bf16 v[100:103], v[140:141], v[82:83], 0 cbsz:4 abid:11
    v_lshlrev_b32_sdwa v139, v15, v125 dst_sel:DWORD dst_unused:UNUSED_PAD src0_sel:DWORD src1_sel:WORD_1
    ds_read_u16_d16_hi v130, v138 offset:32768
    ds_read_u16_d16_hi v131, v139 offset:32768
    s_and_b32 s33, s49, s34
    buffer_load_dwordx4 v[68:71], v1, s[12:15], s33 offen
    s_set_gpr_idx_on s59, 0xc
    v_pk_fma_f32 v[16:17], v[132:133], v[104:105], v[16:17] op_sel:[1,0,0] op_sel_hi:[1,1,1]
    v_pk_fma_f32 v[18:19], v[132:133], v[106:107], v[18:19] op_sel:[1,0,0] op_sel_hi:[1,1,1]
    v_pk_fma_f32 v[20:21], v[134:135], v[108:109], v[20:21] op_sel:[1,0,0] op_sel_hi:[1,1,1]
    v_pk_fma_f32 v[22:23], v[134:135], v[110:111], v[22:23] op_sel:[1,0,0] op_sel_hi:[1,1,1]
    s_set_gpr_idx_off
A_44:
    s_sub_u32 s31, s31, 4
    s_cbranch_scc1 B_44
    v_mfma_f32_4x4x4_16b_bf16 v[116:119], v[172:173], v[178:179], 0 cbsz:4 abid:12
    v_lshlrev_b32_sdwa v136, v15, v122 dst_sel:DWORD dst_unused:UNUSED_PAD src0_sel:DWORD src1_sel:WORD_1
    s_waitcnt vmcnt(4)
    v_mfma_f32_4x4x4_16b_bf16 v[104:107], v[142:143], v[84:85], 0 cbsz:4 abid:11
    v_readlane_b32 s50, v164, 50
    v_mfma_f32_4x4x4_16b_bf16 v[108:111], v[142:143], v[86:87], 0 cbsz:4 abid:11
    v_lshlrev_b32_sdwa v137, v15, v123 dst_sel:DWORD dst_unused:UNUSED_PAD src0_sel:DWORD src1_sel:WORD_1
    ds_read_u16_d16_hi v132, v136 offset:32768
    ds_read_u16_d16_hi v133, v137 offset:32768
    s_and_b32 s33, s50, s34
    buffer_load_dwordx4 v[72:75], v1, s[12:15], s33 offen
    s_waitcnt lgkmcnt(2)
    s_set_gpr_idx_on s60, 0xc
    v_pk_fma_f32 v[16:17], v[128:129], v[96:97], v[16:17] op_sel:[0,0,0] op_sel_hi:[0,1,1]
    v_pk_fma_f32 v[18:19], v[128:129], v[98:99], v[18:19] op_sel:[0,0,0] op_sel_hi:[0,1,1]
    v_pk_fma_f32 v[20:21], v[130:131], v[100:101], v[20:21] op_sel:[0,0,0] op_sel_hi:[0,1,1]
    v_pk_fma_f32 v[22:23], v[130:131], v[102:103], v[22:23] op_sel:[0,0,0] op_sel_hi:[0,1,1]
    s_set_gpr_idx_off
    v_mfma_f32_4x4x4_16b_bf16 v[156:159], v[168:169], v[184:185], 0
    v_lshlrev_b32_sdwa v138, v15, v126 dst_sel:DWORD dst_unused:UNUSED_PAD src0_sel:DWORD src1_sel:WORD_1
    s_waitcnt vmcnt(4)
    v_mfma_f32_4x4x4_16b_bf16 v[96:99], v[144:145], v[88:89], 0 cbsz:4 abid:11
    v_readlane_b32 s51, v164, 51
    v_mfma_f32_4x4x4_16b_bf16 v[100:103], v[144:145], v[90:91], 0 cbsz:4 abid:11
    v_lshlrev_b32_sdwa v139, v15, v127 dst_sel:DWORD dst_unused:UNUSED_PAD src0_sel:DWORD src1_sel:WORD_1
    ds_read_u16_d16_hi v134, v138 offset:32768
    ds_read_u16_d16_hi v135, v139 offset:32768
    s_and_b32 s33, s51, s34
    buffer_load_dwordx4 v[76:79], v1, s[12:15], s33 offen
    s_set_gpr_idx_on s61, 0xc
    v_pk_fma_f32 v[16:17], v[128:129], v[104:105], v[16:17] op_sel:[1,0,0] op_sel_hi:[1,1,1]
    v_pk_fma_f32 v[18:19], v[128:129], v[106:107], v[18:19] op_sel:[1,0,0] op_sel_hi:[1,1,1]
    v_pk_fma_f32 v[20:21], v[130:131], v[108:109], v[20:21] op_sel:[1,0,0] op_sel_hi:[1,1,1]
    v_pk_fma_f32 v[22:23], v[130:131], v[110:111], v[22:23] op_sel:[1,0,0] op_sel_hi:[1,1,1]
    s_set_gpr_idx_off
    v_mfma_f32_4x4x4_16b_bf16 v[120:123], v[172:173], v[176:177], 0 cbsz:4 abid:13
    v_lshlrev_b32_sdwa v136, v15, v112 dst_sel:DWORD dst_unused:UNUSED_PAD src0_sel:DWORD src1_sel:WORD_1
    s_waitcnt vmcnt(4)
    v_mfma_f32_4x4x4_16b_bf16 v[104:107], v[146:147], v[92:93], 0 cbsz:4 abid:11
    v_readlane_b32 s52, v164, 52
    v_mfma_f32_4x4x4_16b_bf16 v[108:111], v[146:147], v[94:95], 0 cbsz:4 abid:11
    v_lshlrev_b32_sdwa v137, v15, v113 dst_sel:DWORD dst_unused:UNUSED_PAD src0_sel:DWORD src1_sel:WORD_1
    ds_read_u16_d16_hi v128, v136 offset:32768
    ds_read_u16_d16_hi v129, v137 offset:32768
    s_and_b32 s33, s52, s34
    buffer_load_dwordx4 v[80:83], v1, s[12:15], s33 offen
    s_waitcnt lgkmcnt(2)
    s_set_gpr_idx_on s62, 0xc
    v_pk_fma_f32 v[16:17], v[132:133], v[96:97], v[16:17] op_sel:[0,0,0] op_sel_hi:[0,1,1]
    v_pk_fma_f32 v[18:19], v[132:133], v[98:99], v[18:19] op_sel:[0,0,0] op_sel_hi:[0,1,1]
    v_pk_fma_f32 v[20:21], v[134:135], v[100:101], v[20:21] op_sel:[0,0,0] op_sel_hi:[0,1,1]
    v_pk_fma_f32 v[22:23], v[134:135], v[102:103], v[22:23] op_sel:[0,0,0] op_sel_hi:[0,1,1]
    s_set_gpr_idx_off
    v_mfma_f32_4x4x4_16b_bf16 v[160:163], v[168:169], v[186:187], 0
    v_lshlrev_b32_sdwa v138, v15, v116 dst_sel:DWORD dst_unused:UNUSED_PAD src0_sel:DWORD src1_sel:WORD_1
    s_waitcnt vmcnt(4)
    v_mfma_f32_4x4x4_16b_bf16 v[96:99], v[140:141], v[64:65], 0 cbsz:4 abid:12
    v_readlane_b32 s53, v164, 53
    v_mfma_f32_4x4x4_16b_bf16 v[100:103], v[140:141], v[66:67], 0 cbsz:4 abid:12
    v_lshlrev_b32_sdwa v139, v15, v117 dst_sel:DWORD dst_unused:UNUSED_PAD src0_sel:DWORD src1_sel:WORD_1
    ds_read_u16_d16_hi v130, v138 offset:32768
    ds_read_u16_d16_hi v131, v139 offset:32768
    s_and_b32 s33, s53, s34
    buffer_load_dwordx4 v[84:87], v1, s[12:15], s33 offen
    s_set_gpr_idx_on s63, 0xc
    v_pk_fma_f32 v[16:17], v[132:133], v[104:105], v[16:17] op_sel:[1,0,0] op_sel_hi:[1,1,1]
    v_pk_fma_f32 v[18:19], v[132:133], v[106:107], v[18:19] op_sel:[1,0,0] op_sel_hi:[1,1,1]
    v_pk_fma_f32 v[20:21], v[134:135], v[108:109], v[20:21] op_sel:[1,0,0] op_sel_hi:[1,1,1]
    v_pk_fma_f32 v[22:23], v[134:135], v[110:111], v[22:23] op_sel:[1,0,0] op_sel_hi:[1,1,1]
    s_set_gpr_idx_off
A_48:
    s_sub_u32 s31, s31, 4
    s_cbranch_scc1 B_48
    v_mfma_f32_4x4x4_16b_bf16 v[124:127], v[172:173], v[178:179], 0 cbsz:4 abid:13
    v_lshlrev_b32_sdwa v136, v15, v114 dst_sel:DWORD dst_unused:UNUSED_PAD src0_sel:DWORD src1_sel:WORD_1
    s_waitcnt vmcnt(4)
    v_mfma_f32_4x4x4_16b_bf16 v[104:107], v[142:143], v[68:69], 0 cbsz:4 abid:12
    v_readlane_b32 s54, v164, 54
    v_mfma_f32_4x4x4_16b_bf16 v[108:111], v[142:143], v[70:71], 0 cbsz:4 abid:12
    v_lshlrev_b32_sdwa v137, v15, v115 dst_sel:DWORD dst_unused:UNUSED_PAD src0_sel:DWORD src1_sel:WORD_1
    ds_read_u16_d16_hi v132, v136 offset:32768
    ds_read_u16_d16_hi v133, v137 offset:32768
    s_and_b32 s33, s54, s34
    buffer_load_dwordx4 v[88:91], v1, s[12:15], s33 offen
    s_waitcnt lgkmcnt(2)
    s_set_gpr_idx_on s48, 0xc
    v_pk_fma_f32 v[16:17], v[128:129], v[96:97], v[16:17] op_sel:[0,0,0] op_sel_hi:[0,1,1]
    v_pk_fma_f32 v[18:19], v[128:129], v[98:99], v[18:19] op_sel:[0,0,0] op_sel_hi:[0,1,1]
    v_pk_fma_f32 v[20:21], v[130:131], v[100:101], v[20:21] op_sel:[0,0,0] op_sel_hi:[0,1,1]
    v_pk_fma_f32 v[22:23], v[130:131], v[102:103], v[22:23] op_sel:[0,0,0] op_sel_hi:[0,1,1]
    s_set_gpr_idx_off
    v_lshlrev_b32_sdwa v138, v15, v118 dst_sel:DWORD dst_unused:UNUSED_PAD src0_sel:DWORD src1_sel:WORD_1
    s_waitcnt vmcnt(4)
    v_mfma_f32_4x4x4_16b_bf16 v[96:99], v[144:145], v[72:73], 0 cbsz:4 abid:12
    v_readlane_b32 s55, v164, 55
    v_mfma_f32_4x4x4_16b_bf16 v[100:103], v[144:145], v[74:75], 0 cbsz:4 abid:12
    v_lshlrev_b32_sdwa v139, v15, v119 dst_sel:DWORD dst_unused:UNUSED_PAD src0_sel:DWORD src1_sel:WORD_1
    ds_read_u16_d16_hi v134, v138 offset:32768
    ds_read_u16_d16_hi v135, v139 offset:32768
    s_and_b32 s33, s55, s34
    buffer_load_dwordx4 v[92:95], v1, s[12:15], s33 offen
    s_set_gpr_idx_on s49, 0xc
    v_pk_fma_f32 v[16:17], v[128:129], v[104:105], v[16:17] op_sel:[1,0,0] op_sel_hi:[1,1,1]
    v_pk_fma_f32 v[18:19], v[128:129], v[106:107], v[18:19] op_sel:[1,0,0] op_sel_hi:[1,1,1]
    v_pk_fma_f32 v[20:21], v[130:131], v[108:109], v[20:21] op_sel:[1,0,0] op_sel_hi:[1,1,1]
    v_pk_fma_f32 v[22:23], v[130:131], v[110:111], v[22:23] op_sel:[1,0,0] op_sel_hi:[1,1,1]
    s_set_gpr_idx_off
    v_mfma_f32_4x4x4_16b_bf16 v[112:115], v[172:173], v[176:177], 0 cbsz:4 abid:14
    v_lshlrev_b32_sdwa v136, v15, v120 dst_sel:DWORD dst_unused:UNUSED_PAD src0_sel:DWORD src1_sel:WORD_1
    s_waitcnt vmcnt(4)
    v_mfma_f32_4x4x4_16b_bf16 v[104:107], v[146:147], v[76:77], 0 cbsz:4 abid:12
    v_readlane_b32 s56, v164, 56
    v_mfma_f32_4x4x4_16b_bf16 v[108:111], v[146:147], v[78:79], 0 cbsz:4 abid:12
    v_lshlrev_b32_sdwa v137, v15, v121 dst_sel:DWORD dst_unused:UNUSED_PAD src0_sel:DWORD src1_sel:WORD_1
    ds_read_u16_d16_hi v128, v136 offset:32768
    ds_read_u16_d16_hi v129, v137 offset:32768
    s_and_b32 s33, s56, s34
    buffer_load_dwordx4 v[64:67], v1, s[12:15], s33 offen
    s_waitcnt lgkmcnt(2)
    s_set_gpr_idx_on s50, 0xc
    v_pk_fma_f32 v[16:17], v[132:133], v[96:97], v[16:17] op_sel:[0,0,0] op_sel_hi:[0,1,1]
    v_pk_fma_f32 v[18:19], v[132:133], v[98:99], v[18:19] op_sel:[0,0,0] op_sel_hi:[0,1,1]
    v_pk_fma_f32 v[20:21], v[134:135], v[100:101], v[20:21] op_sel:[0,0,0] op_sel_hi:[0,1,1]
    v_pk_fma_f32 v[22:23], v[134:135], v[102:103], v[22:23] op_sel:[0,0,0] op_sel_hi:[0,1,1]
    s_set_gpr_idx_off
    v_lshlrev_b32_sdwa v138, v15, v124 dst_sel:DWORD dst_unused:UNUSED_PAD src0_sel:DWORD src1_sel:WORD_1
    s_waitcnt vmcnt(4)
    v_mfma_f32_4x4x4_16b_bf16 v[96:99], v[140:141], v[80:81], 0 cbsz:4 abid:13
    v_readlane_b32 s57, v164, 57
    v_mfma_f32_4x4x4_16b_bf16 v[100:103], v[140:141], v[82:83], 0 cbsz:4 abid:13
    v_lshlrev_b32_sdwa v139, v15, v125 dst_sel:DWORD dst_unused:UNUSED_PAD src0_sel:DWORD src1_sel:WORD_1
    ds_read_u16_d16_hi v130, v138 offset:32768
    ds_read_u16_d16_hi v131, v139 offset:32768
    s_and_b32 s33, s57, s34
    buffer_load_dwordx4 v[68:71], v1, s[12:15], s33 offen
    s_set_gpr_idx_on s51, 0xc
    v_pk_fma_f32 v[16:17], v[132:133], v[104:105], v[16:17] op_sel:[1,0,0] op_sel_hi:[1,1,1]
    v_pk_fma_f32 v[18:19], v[132:133], v[106:107], v[18:19] op_sel:[1,0,0] op_sel_hi:[1,1,1]
    v_pk_fma_f32 v[20:21], v[134:135], v[108:109], v[20:21] op_sel:[1,0,0] op_sel_hi:[1,1,1]
    v_pk_fma_f32 v[22:23], v[134:135], v[110:111], v[22:23] op_sel:[1,0,0] op_sel_hi:[1,1,1]
    s_set_gpr_idx_off
A_52:
    s_sub_u32 s31, s31, 4
    s_cbranch_scc1 B_52
    v_mfma_f32_4x4x4_16b_bf16 v[116:119], v[172:173], v[178:179], 0 cbsz:4 abid:14
    v_lshlrev_b32_sdwa v136, v15, v122 dst_sel:DWORD dst_unused:UNUSED_PAD src0_sel:DWORD src1_sel:WORD_1
    s_waitcnt vmcnt(4)
    v_mfma_f32_4x4x4_16b_bf16 v[104:107], v[142:143], v[84:85], 0 cbsz:4 abid:13
    v_readlane_b32 s58, v164, 58
    v_mfma_f32_4x4x4_16b_bf16 v[108:111], v[142:143], v[86:87], 0 cbsz:4 abid:13
    v_lshlrev_b32_sdwa v137, v15, v123 dst_sel:DWORD dst_unused:UNUSED_PAD src0_sel:DWORD src1_sel:WORD_1
    ds_read_u16_d16_hi v132, v136 offset:32768
    ds_read_u16_d16_hi v133, v137 offset:32768
    s_and_b32 s33, s58, s34
    buffer_load_dwordx4 v[72:75], v1, s[12:15], s33 offen
    s_waitcnt lgkmcnt(2)
    s_set_gpr_idx_on s52, 0xc
    v_pk_fma_f32 v[16:17], v[128:129], v[96:97], v[16:17] op_sel:[0,0,0] op_sel_hi:[0,1,1]
    v_pk_fma_f32 v[18:19], v[128:129], v[98:99], v[18:19] op_sel:[0,0,0] op_sel_hi:[0,1,1]
    v_pk_fma_f32 v[20:21], v[130:131], v[100:101], v[20:21] op_sel:[0,0,0] op_sel_hi:[0,1,1]
    v_pk_fma_f32 v[22:23], v[130:131], v[102:103], v[22:23] op_sel:[0,0,0] op_sel_hi:[0,1,1]
    s_set_gpr_idx_off
    v_lshlrev_b32_sdwa v138, v15, v126 dst_sel:DWORD dst_unused:UNUSED_PAD src0_sel:DWORD src1_sel:WORD_1
    s_waitcnt vmcnt(4)
    v_mfma_f32_4x4x4_16b_bf16 v[96:99], v[144:145], v[88:89], 0 cbsz:4 abid:13
    v_readlane_b32 s59, v164, 59
    v_mfma_f32_4x4x4_16b_bf16 v[100:103], v[144:145], v[90:91], 0 cbsz:4 abid:13
    v_lshlrev_b32_sdwa v139, v15, v127 dst_sel:DWORD dst_unused:UNUSED_PAD src0_sel:DWORD src1_sel:WORD_1
    ds_read_u16_d16_hi v134, v138 offset:32768
    ds_read_u16_d16_hi v135, v139 offset:32768
    s_and_b32 s33, s59, s34
    buffer_load_dwordx4 v[76:79], v1, s[12:15], s33 offen
    s_set_gpr_idx_on s53, 0xc
    v_pk_fma_f32 v[16:17], v[128:129], v[104:105], v[16:17] op_sel:[1,0,0] op_sel_hi:[1,1,1]
    v_pk_fma_f32 v[18:19], v[128:129], v[106:107], v[18:19] op_sel:[1,0,0] op_sel_hi:[1,1,1]
    v_pk_fma_f32 v[20:21], v[130:131], v[108:109], v[20:21] op_sel:[1,0,0] op_sel_hi:[1,1,1]
    v_pk_fma_f32 v[22:23], v[130:131], v[110:111], v[22:23] op_sel:[1,0,0] op_sel_hi:[1,1,1]
    s_set_gpr_idx_off
    v_mfma_f32_4x4x4_16b_bf16 v[120:123], v[172:173], v[176:177], 0 cbsz:4 abid:15
    v_lshlrev_b32_sdwa v136, v15, v112 dst_sel:DWORD dst_unused:UNUSED_PAD src0_sel:DWORD src1_sel:WORD_1
    s_waitcnt vmcnt(4)
    v_mfma_f32_4x4x4_16b_bf16 v[104:107], v[146:147], v[92:93], 0 cbsz:4 abid:13
    v_readlane_b32 s60, v164, 60
    v_mfma_f32_4x4x4_16b_bf16 v[108:111], v[146:147], v[94:95], 0 cbsz:4 abid:13
    v_lshlrev_b32_sdwa v137, v15, v113 dst_sel:DWORD dst_unused:UNUSED_PAD src0_sel:DWORD src1_sel:WORD_1
    ds_read_u16_d16_hi v128, v136 offset:32768
    ds_read_u16_d16_hi v129, v137 offset:32768
    s_and_b32 s33, s60, s34
    buffer_load_dwordx4 v[80:83], v1, s[12:15], s33 offen
    s_waitcnt lgkmcnt(2)
    s_set_gpr_idx_on s54, 0xc
    v_pk_fma_f32 v[16:17], v[132:133], v[96:97], v[16:17] op_sel:[0,0,0] op_sel_hi:[0,1,1]
    v_pk_fma_f32 v[18:19], v[132:133], v[98:99], v[18:19] op_sel:[0,0,0] op_sel_hi:[0,1,1]
    v_pk_fma_f32 v[20:21], v[134:135], v[100:101], v[20:21] op_sel:[0,0,0] op_sel_hi:[0,1,1]
    v_pk_fma_f32 v[22:23], v[134:135], v[102:103], v[22:23] op_sel:[0,0,0] op_sel_hi:[0,1,1]
    s_set_gpr_idx_off
    v_lshlrev_b32_sdwa v138, v15, v116 dst_sel:DWORD dst_unused:UNUSED_PAD src0_sel:DWORD src1_sel:WORD_1
    s_waitcnt vmcnt(4)
    v_mfma_f32_4x4x4_16b_bf16 v[96:99], v[140:141], v[64:65], 0 cbsz:4 abid:14
    v_readlane_b32 s61, v164, 61
    v_mfma_f32_4x4x4_16b_bf16 v[100:103], v[140:141], v[66:67], 0 cbsz:4 abid:14
    v_lshlrev_b32_sdwa v139, v15, v117 dst_sel:DWORD dst_unused:UNUSED_PAD src0_sel:DWORD src1_sel:WORD_1
    ds_read_u16_d16_hi v130, v138 offset:32768
    ds_read_u16_d16_hi v131, v139 offset:32768
    s_and_b32 s33, s61, s34
    buffer_load_dwordx4 v[84:87], v1, s[12:15], s33 offen
    s_set_gpr_idx_on s55, 0xc
    v_pk_fma_f32 v[16:17], v[132:133], v[104:105], v[16:17] op_sel:[1,0,0] op_sel_hi:[1,1,1]
    v_pk_fma_f32 v[18:19], v[132:133], v[106:107], v[18:19] op_sel:[1,0,0] op_sel_hi:[1,1,1]
    v_pk_fma_f32 v[20:21], v[134:135], v[108:109], v[20:21] op_sel:[1,0,0] op_sel_hi:[1,1,1]
    v_pk_fma_f32 v[22:23], v[134:135], v[110:111], v[22:23] op_sel:[1,0,0] op_sel_hi:[1,1,1]
    s_set_gpr_idx_off
A_56:
    s_sub_u32 s31, s31, 4
    s_cbranch_scc1 B_56
    v_mfma_f32_4x4x4_16b_bf16 v[124:127], v[172:173], v[178:179], 0 cbsz:4 abid:15
    v_lshlrev_b32_sdwa v136, v15, v114 dst_sel:DWORD dst_unused:UNUSED_PAD src0_sel:DWORD src1_sel:WORD_1
    s_waitcnt vmcnt(4)
    v_mfma_f32_4x4x4_16b_bf16 v[104:107], v[142:143], v[68:69], 0 cbsz:4 abid:14
    v_readlane_b32 s62, v164, 62
    v_mfma_f32_4x4x4_16b_bf16 v[108:111], v[142:143], v[70:71], 0 cbsz:4 abid:14
    v_lshlrev_b32_sdwa v137, v15, v115 dst_sel:DWORD dst_unused:UNUSED_PAD src0_sel:DWORD src1_sel:WORD_1
    ds_read_u16_d16_hi v132, v136 offset:32768
    ds_read_u16_d16_hi v133, v137 offset:32768
    s_and_b32 s33, s62, s34
    buffer_load_dwordx4 v[88:91], v1, s[12:15], s33 offen
    s_waitcnt lgkmcnt(2)
    s_set_gpr_idx_on s56, 0xc
    v_pk_fma_f32 v[16:17], v[128:129], v[96:97], v[16:17] op_sel:[0,0,0] op_sel_hi:[0,1,1]
    v_pk_fma_f32 v[18:19], v[128:129], v[98:99], v[18:19] op_sel:[0,0,0] op_sel_hi:[0,1,1]
    v_pk_fma_f32 v[20:21], v[130:131], v[100:101], v[20:21] op_sel:[0,0,0] op_sel_hi:[0,1,1]
    v_pk_fma_f32 v[22:23], v[130:131], v[102:103], v[22:23] op_sel:[0,0,0] op_sel_hi:[0,1,1]
    s_set_gpr_idx_off
    v_lshlrev_b32_sdwa v138, v15, v118 dst_sel:DWORD dst_unused:UNUSED_PAD src0_sel:DWORD src1_sel:WORD_1
    s_waitcnt vmcnt(4)
    v_mfma_f32_4x4x4_16b_bf16 v[96:99], v[144:145], v[72:73], 0 cbsz:4 abid:14
    v_readlane_b32 s63, v164, 63
    v_mfma_f32_4x4x4_16b_bf16 v[100:103], v[144:145], v[74:75], 0 cbsz:4 abid:14
    v_lshlrev_b32_sdwa v139, v15, v119 dst_sel:DWORD dst_unused:UNUSED_PAD src0_sel:DWORD src1_sel:WORD_1
    ds_read_u16_d16_hi v134, v138 offset:32768
    ds_read_u16_d16_hi v135, v139 offset:32768
    s_and_b32 s33, s63, s34
    buffer_load_dwordx4 v[92:95], v1, s[12:15], s33 offen
    s_set_gpr_idx_on s57, 0xc
    v_pk_fma_f32 v[16:17], v[128:129], v[104:105], v[16:17] op_sel:[1,0,0] op_sel_hi:[1,1,1]
    v_pk_fma_f32 v[18:19], v[128:129], v[106:107], v[18:19] op_sel:[1,0,0] op_sel_hi:[1,1,1]
    v_pk_fma_f32 v[20:21], v[130:131], v[108:109], v[20:21] op_sel:[1,0,0] op_sel_hi:[1,1,1]
    v_pk_fma_f32 v[22:23], v[130:131], v[110:111], v[22:23] op_sel:[1,0,0] op_sel_hi:[1,1,1]
    s_set_gpr_idx_off
    v_mov_b32 v172, v170
    v_mov_b32 v173, v171
    s_nop 1
    v_mfma_f32_4x4x4_16b_bf16 v[112:115], v[172:173], v[176:177], 0 cbsz:4 abid:0
    v_lshlrev_b32_sdwa v136, v15, v120 dst_sel:DWORD dst_unused:UNUSED_PAD src0_sel:DWORD src1_sel:WORD_1
    s_waitcnt vmcnt(4)
    v_mfma_f32_4x4x4_16b_bf16 v[104:107], v[146:147], v[76:77], 0 cbsz:4 abid:14
    v_readlane_b32 s48, v165, 0
    v_mfma_f32_4x4x4_16b_bf16 v[108:111], v[146:147], v[78:79], 0 cbsz:4 abid:14
    v_lshlrev_b32_sdwa v137, v15, v121 dst_sel:DWORD dst_unused:UNUSED_PAD src0_sel:DWORD src1_sel:WORD_1
    ds_read_u16_d16_hi v128, v136 offset:32768
    ds_read_u16_d16_hi v129, v137 offset:32768
    s_and_b32 s33, s48, s34
    buffer_load_dwordx4 v[64:67], v1, s[12:15], s33 offen
    s_waitcnt lgkmcnt(2)
    s_set_gpr_idx_on s58, 0xc
    v_pk_fma_f32 v[16:17], v[132:133], v[96:97], v[16:17] op_sel:[0,0,0] op_sel_hi:[0,1,1]
    v_pk_fma_f32 v[18:19], v[132:133], v[98:99], v[18:19] op_sel:[0,0,0] op_sel_hi:[0,1,1]
    v_pk_fma_f32 v[20:21], v[134:135], v[100:101], v[20:21] op_sel:[0,0,0] op_sel_hi:[0,1,1]
    v_pk_fma_f32 v[22:23], v[134:135], v[102:103], v[22:23] op_sel:[0,0,0] op_sel_hi:[0,1,1]
    s_set_gpr_idx_off
    v_lshlrev_b32_sdwa v138, v15, v124 dst_sel:DWORD dst_unused:UNUSED_PAD src0_sel:DWORD src1_sel:WORD_1
    s_waitcnt vmcnt(4)
    v_mfma_f32_4x4x4_16b_bf16 v[96:99], v[140:141], v[80:81], 0 cbsz:4 abid:15
    v_readlane_b32 s49, v165, 1
    v_mfma_f32_4x4x4_16b_bf16 v[100:103], v[140:141], v[82:83], 0 cbsz:4 abid:15
    v_lshlrev_b32_sdwa v139, v15, v125 dst_sel:DWORD dst_unused:UNUSED_PAD src0_sel:DWORD src1_sel:WORD_1
    ds_read_u16_d16_hi v130, v138 offset:32768
    ds_read_u16_d16_hi v131, v139 offset:32768
    s_and_b32 s33, s49, s34
    buffer_load_dwordx4 v[68:71], v1, s[12:15], s33 offen
    s_set_gpr_idx_on s59, 0xc
    v_pk_fma_f32 v[16:17], v[132:133], v[104:105], v[16:17] op_sel:[1,0,0] op_sel_hi:[1,1,1]
    v_pk_fma_f32 v[18:19], v[132:133], v[106:107], v[18:19] op_sel:[1,0,0] op_sel_hi:[1,1,1]
    v_pk_fma_f32 v[20:21], v[134:135], v[108:109], v[20:21] op_sel:[1,0,0] op_sel_hi:[1,1,1]
    v_pk_fma_f32 v[22:23], v[134:135], v[110:111], v[22:23] op_sel:[1,0,0] op_sel_hi:[1,1,1]
    s_set_gpr_idx_off
A_60:
    s_sub_u32 s31, s31, 4
    s_cbranch_scc1 B_60
    v_mfma_f32_4x4x4_16b_bf16 v[116:119], v[172:173], v[178:179], 0 cbsz:4 abid:0
    v_lshlrev_b32_sdwa v136, v15, v122 dst_sel:DWORD dst_unused:UNUSED_PAD src0_sel:DWORD src1_sel:WORD_1
    s_waitcnt vmcnt(4)
    v_mfma_f32_4x4x4_16b_bf16 v[104:107], v[142:143], v[84:85], 0 cbsz:4 abid:15
    v_readlane_b32 s50, v165, 2
    v_mfma_f32_4x4x4_16b_bf16 v[108:111], v[142:143], v[86:87], 0 cbsz:4 abid:15
    v_lshlrev_b32_sdwa v137, v15, v123 dst_sel:DWORD dst_unused:UNUSED_PAD src0_sel:DWORD src1_sel:WORD_1
    ds_read_u16_d16_hi v132, v136 offset:32768
    ds_read_u16_d16_hi v133, v137 offset:32768
    v_cvt_pk_bf16_f32 v140, v148, v152
    v_cvt_pk_bf16_f32 v141, v156, v160
    s_and_b32 s33, s50, s34
    buffer_load_dwordx4 v[72:75], v1, s[12:15], s33 offen
    s_waitcnt lgkmcnt(2)
    s_set_gpr_idx_on s60, 0xc
    v_pk_fma_f32 v[16:17], v[128:129], v[96:97], v[16:17] op_sel:[0,0,0] op_sel_hi:[0,1,1]
    v_pk_fma_f32 v[18:19], v[128:129], v[98:99], v[18:19] op_sel:[0,0,0] op_sel_hi:[0,1,1]
    v_pk_fma_f32 v[20:21], v[130:131], v[100:101], v[20:21] op_sel:[0,0,0] op_sel_hi:[0,1,1]
    v_pk_fma_f32 v[22:23], v[130:131], v[102:103], v[22:23] op_sel:[0,0,0] op_sel_hi:[0,1,1]
    s_set_gpr_idx_off
    v_lshlrev_b32_sdwa v138, v15, v126 dst_sel:DWORD dst_unused:UNUSED_PAD src0_sel:DWORD src1_sel:WORD_1
    s_waitcnt vmcnt(4)
    v_mfma_f32_4x4x4_16b_bf16 v[96:99], v[144:145], v[88:89], 0 cbsz:4 abid:15
    v_readlane_b32 s51, v165, 3
    v_mfma_f32_4x4x4_16b_bf16 v[100:103], v[144:145], v[90:91], 0 cbsz:4 abid:15
    v_lshlrev_b32_sdwa v139, v15, v127 dst_sel:DWORD dst_unused:UNUSED_PAD src0_sel:DWORD src1_sel:WORD_1
    ds_read_u16_d16_hi v134, v138 offset:32768
    ds_read_u16_d16_hi v135, v139 offset:32768
    v_cvt_pk_bf16_f32 v142, v149, v153
    v_cvt_pk_bf16_f32 v143, v157, v161
    s_and_b32 s33, s51, s34
    buffer_load_dwordx4 v[76:79], v1, s[12:15], s33 offen
    s_set_gpr_idx_on s61, 0xc
    v_pk_fma_f32 v[16:17], v[128:129], v[104:105], v[16:17] op_sel:[1,0,0] op_sel_hi:[1,1,1]
    v_pk_fma_f32 v[18:19], v[128:129], v[106:107], v[18:19] op_sel:[1,0,0] op_sel_hi:[1,1,1]
    v_pk_fma_f32 v[20:21], v[130:131], v[108:109], v[20:21] op_sel:[1,0,0] op_sel_hi:[1,1,1]
    v_pk_fma_f32 v[22:23], v[130:131], v[110:111], v[22:23] op_sel:[1,0,0] op_sel_hi:[1,1,1]
    s_set_gpr_idx_off
    v_mfma_f32_4x4x4_16b_bf16 v[120:123], v[172:173], v[176:177], 0 cbsz:4 abid:1
    v_lshlrev_b32_sdwa v136, v15, v112 dst_sel:DWORD dst_unused:UNUSED_PAD src0_sel:DWORD src1_sel:WORD_1
    s_waitcnt vmcnt(4)
    v_mfma_f32_4x4x4_16b_bf16 v[104:107], v[146:147], v[92:93], 0 cbsz:4 abid:15
    v_readlane_b32 s52, v165, 4
    v_mfma_f32_4x4x4_16b_bf16 v[108:111], v[146:147], v[94:95], 0 cbsz:4 abid:15
    v_lshlrev_b32_sdwa v137, v15, v113 dst_sel:DWORD dst_unused:UNUSED_PAD src0_sel:DWORD src1_sel:WORD_1
    ds_read_u16_d16_hi v128, v136 offset:32768
    ds_read_u16_d16_hi v129, v137 offset:32768
    v_cvt_pk_bf16_f32 v144, v150, v154
    v_cvt_pk_bf16_f32 v145, v158, v162
    s_and_b32 s33, s52, s34
    buffer_load_dwordx4 v[80:83], v1, s[12:15], s33 offen
    s_waitcnt lgkmcnt(2)
    s_set_gpr_idx_on s62, 0xc
    v_pk_fma_f32 v[16:17], v[132:133], v[96:97], v[16:17] op_sel:[0,0,0] op_sel_hi:[0,1,1]
    v_pk_fma_f32 v[18:19], v[132:133], v[98:99], v[18:19] op_sel:[0,0,0] op_sel_hi:[0,1,1]
    v_pk_fma_f32 v[20:21], v[134:135], v[100:101], v[20:21] op_sel:[0,0,0] op_sel_hi:[0,1,1]
    v_pk_fma_f32 v[22:23], v[134:135], v[102:103], v[22:23] op_sel:[0,0,0] op_sel_hi:[0,1,1]
    s_set_gpr_idx_off
    v_lshlrev_b32_sdwa v138, v15, v116 dst_sel:DWORD dst_unused:UNUSED_PAD src0_sel:DWORD src1_sel:WORD_1
    s_waitcnt vmcnt(4)
    v_mfma_f32_4x4x4_16b_bf16 v[96:99], v[140:141], v[64:65], 0 cbsz:4 abid:0
    v_readlane_b32 s53, v165, 5
    v_mfma_f32_4x4x4_16b_bf16 v[100:103], v[140:141], v[66:67], 0 cbsz:4 abid:0
    v_lshlrev_b32_sdwa v139, v15, v117 dst_sel:DWORD dst_unused:UNUSED_PAD src0_sel:DWORD src1_sel:WORD_1
    ds_read_u16_d16_hi v130, v138 offset:32768
    ds_read_u16_d16_hi v131, v139 offset:32768
    v_cvt_pk_bf16_f32 v146, v151, v155
    v_cvt_pk_bf16_f32 v147, v159, v163
    s_and_b32 s33, s53, s34
    buffer_load_dwordx4 v[84:87], v1, s[12:15], s33 offen
    s_set_gpr_idx_on s63, 0xc
    v_pk_fma_f32 v[16:17], v[132:133], v[104:105], v[16:17] op_sel:[1,0,0] op_sel_hi:[1,1,1]
    v_pk_fma_f32 v[18:19], v[132:133], v[106:107], v[18:19] op_sel:[1,0,0] op_sel_hi:[1,1,1]
    v_pk_fma_f32 v[20:21], v[134:135], v[108:109], v[20:21] op_sel:[1,0,0] op_sel_hi:[1,1,1]
    v_pk_fma_f32 v[22:23], v[134:135], v[110:111], v[22:23] op_sel:[1,0,0] op_sel_hi:[1,1,1]
    s_set_gpr_idx_off
    v_mov_b32 v164, v165
    s_branch A_0
B_0:
    buffer_load_dwordx4 v[188:191], v1, s[16:19], s10 offen offset:0 sc1
    buffer_load_dwordx4 v[192:195], v1, s[16:19], s10 offen offset:1024 sc1
    buffer_load_dwordx4 v[196:199], v1, s[16:19], s10 offen offset:2048 sc1
    buffer_load_dwordx4 v[200:203], v1, s[16:19], s10 offen offset:3072 sc1
    buffer_load_dwordx4 v[204:207], v1, s[16:19], s11 offen offset:0 sc1
    buffer_load_dwordx4 v[208:211], v1, s[16:19], s11 offen offset:1024 sc1
    buffer_load_dwordx4 v[212:215], v1, s[16:19], s11 offen offset:2048 sc1
    buffer_load_dwordx4 v[216:219], v1, s[16:19], s11 offen offset:3072 sc1
    s_sub_u32 s32, s32, 1
    s_cbranch_scc1 MAIN_DONE
    v_mfma_f32_4x4x4_16b_bf16 v[124:127], v[172:173], v[178:179], 0 cbsz:4 abid:1
    v_lshlrev_b32_sdwa v136, v15, v114 dst_sel:DWORD dst_unused:UNUSED_PAD src0_sel:DWORD src1_sel:WORD_1
    s_waitcnt vmcnt(12)
    v_mfma_f32_4x4x4_16b_bf16 v[104:107], v[142:143], v[68:69], 0 cbsz:4 abid:0
    s_nop 0
    v_mfma_f32_4x4x4_16b_bf16 v[108:111], v[142:143], v[70:71], 0 cbsz:4 abid:0
    v_lshlrev_b32_sdwa v137, v15, v115 dst_sel:DWORD dst_unused:UNUSED_PAD src0_sel:DWORD src1_sel:WORD_1
    ds_read_u16_d16_hi v132, v136 offset:32768
    ds_read_u16_d16_hi v133, v137 offset:32768
    s_waitcnt lgkmcnt(2)
    s_set_gpr_idx_on s48, 0xc
    v_pk_fma_f32 v[16:17], v[128:129], v[96:97], v[16:17] op_sel:[0,0,0] op_sel_hi:[0,1,1]
    v_pk_fma_f32 v[18:19], v[128:129], v[98:99], v[18:19] op_sel:[0,0,0] op_sel_hi:[0,1,1]
    v_pk_fma_f32 v[20:21], v[130:131], v[100:101], v[20:21] op_sel:[0,0,0] op_sel_hi:[0,1,1]
    v_pk_fma_f32 v[22:23], v[130:131], v[102:103], v[22:23] op_sel:[0,0,0] op_sel_hi:[0,1,1]
    s_set_gpr_idx_off
    s_sub_u32 s32, s32, 1
    s_cbranch_scc1 MAIN_DONE
    v_lshlrev_b32_sdwa v138, v15, v118 dst_sel:DWORD dst_unused:UNUSED_PAD src0_sel:DWORD src1_sel:WORD_1
    s_waitcnt vmcnt(11)
    v_mfma_f32_4x4x4_16b_bf16 v[96:99], v[144:145], v[72:73], 0 cbsz:4 abid:0
    s_nop 0
    v_mfma_f32_4x4x4_16b_bf16 v[100:103], v[144:145], v[74:75], 0 cbsz:4 abid:0
    v_lshlrev_b32_sdwa v139, v15, v119 dst_sel:DWORD dst_unused:UNUSED_PAD src0_sel:DWORD src1_sel:WORD_1
    ds_read_u16_d16_hi v134, v138 offset:32768
    ds_read_u16_d16_hi v135, v139 offset:32768
    s_set_gpr_idx_on s49, 0xc
    v_pk_fma_f32 v[16:17], v[128:129], v[104:105], v[16:17] op_sel:[1,0,0] op_sel_hi:[1,1,1]
    v_pk_fma_f32 v[18:19], v[128:129], v[106:107], v[18:19] op_sel:[1,0,0] op_sel_hi:[1,1,1]
    v_pk_fma_f32 v[20:21], v[130:131], v[108:109], v[20:21] op_sel:[1,0,0] op_sel_hi:[1,1,1]
    v_pk_fma_f32 v[22:23], v[130:131], v[110:111], v[22:23] op_sel:[1,0,0] op_sel_hi:[1,1,1]
    s_set_gpr_idx_off
    s_sub_u32 s32, s32, 1
    s_cbranch_scc1 MAIN_DONE
    v_mfma_f32_4x4x4_16b_bf16 v[112:115], v[172:173], v[176:177], 0 cbsz:4 abid:2
    v_lshlrev_b32_sdwa v136, v15, v120 dst_sel:DWORD dst_unused:UNUSED_PAD src0_sel:DWORD src1_sel:WORD_1
    s_waitcnt vmcnt(10)
    v_mfma_f32_4x4x4_16b_bf16 v[104:107], v[146:147], v[76:77], 0 cbsz:4 abid:0
    s_nop 0
    v_mfma_f32_4x4x4_16b_bf16 v[108:111], v[146:147], v[78:79], 0 cbsz:4 abid:0
    v_lshlrev_b32_sdwa v137, v15, v121 dst_sel:DWORD dst_unused:UNUSED_PAD src0_sel:DWORD src1_sel:WORD_1
    ds_read_u16_d16_hi v128, v136 offset:32768
    ds_read_u16_d16_hi v129, v137 offset:32768
    s_waitcnt lgkmcnt(2)
    s_set_gpr_idx_on s50, 0xc
    v_pk_fma_f32 v[16:17], v[132:133], v[96:97], v[16:17] op_sel:[0,0,0] op_sel_hi:[0,1,1]
    v_pk_fma_f32 v[18:19], v[132:133], v[98:99], v[18:19] op_sel:[0,0,0] op_sel_hi:[0,1,1]
    v_pk_fma_f32 v[20:21], v[134:135], v[100:101], v[20:21] op_sel:[0,0,0] op_sel_hi:[0,1,1]
    v_pk_fma_f32 v[22:23], v[134:135], v[102:103], v[22:23] op_sel:[0,0,0] op_sel_hi:[0,1,1]
    s_set_gpr_idx_off
    s_sub_u32 s32, s32, 1
    s_cbranch_scc1 MAIN_DONE
    v_lshlrev_b32_sdwa v138, v15, v124 dst_sel:DWORD dst_unused:UNUSED_PAD src0_sel:DWORD src1_sel:WORD_1
    s_waitcnt vmcnt(9)
    v_mfma_f32_4x4x4_16b_bf16 v[96:99], v[140:141], v[80:81], 0 cbsz:4 abid:1
    s_nop 0
    v_mfma_f32_4x4x4_16b_bf16 v[100:103], v[140:141], v[82:83], 0 cbsz:4 abid:1
    v_lshlrev_b32_sdwa v139, v15, v125 dst_sel:DWORD dst_unused:UNUSED_PAD src0_sel:DWORD src1_sel:WORD_1
    ds_read_u16_d16_hi v130, v138 offset:32768
    ds_read_u16_d16_hi v131, v139 offset:32768
    s_set_gpr_idx_on s51, 0xc
    v_pk_fma_f32 v[16:17], v[132:133], v[104:105], v[16:17] op_sel:[1,0,0] op_sel_hi:[1,1,1]
    v_pk_fma_f32 v[18:19], v[132:133], v[106:107], v[18:19] op_sel:[1,0,0] op_sel_hi:[1,1,1]
    v_pk_fma_f32 v[20:21], v[134:135], v[108:109], v[20:21] op_sel:[1,0,0] op_sel_hi:[1,1,1]
    v_pk_fma_f32 v[22:23], v[134:135], v[110:111], v[22:23] op_sel:[1,0,0] op_sel_hi:[1,1,1]
    s_set_gpr_idx_off
    s_sub_u32 s32, s32, 1
    s_cbranch_scc1 MAIN_DONE
    v_mfma_f32_4x4x4_16b_bf16 v[116:119], v[172:173], v[178:179], 0 cbsz:4 abid:2
    v_lshlrev_b32_sdwa v136, v15, v122 dst_sel:DWORD dst_unused:UNUSED_PAD src0_sel:DWORD src1_sel:WORD_1
    s_waitcnt vmcnt(8)
    v_mfma_f32_4x4x4_16b_bf16 v[104:107], v[142:143], v[84:85], 0 cbsz:4 abid:1
    s_nop 0
    v_mfma_f32_4x4x4_16b_bf16 v[108:111], v[142:143], v[86:87], 0 cbsz:4 abid:1
    v_lshlrev_b32_sdwa v137, v15, v123 dst_sel:DWORD dst_unused:UNUSED_PAD src0_sel:DWORD src1_sel:WORD_1
    ds_read_u16_d16_hi v132, v136 offset:32768
    ds_read_u16_d16_hi v133, v137 offset:32768
    s_waitcnt lgkmcnt(2)
    s_set_gpr_idx_on s52, 0xc
    v_pk_fma_f32 v[16:17], v[128:129], v[96:97], v[16:17] op_sel:[0,0,0] op_sel_hi:[0,1,1]
    v_pk_fma_f32 v[18:19], v[128:129], v[98:99], v[18:19] op_sel:[0,0,0] op_sel_hi:[0,1,1]
    v_pk_fma_f32 v[20:21], v[130:131], v[100:101], v[20:21] op_sel:[0,0,0] op_sel_hi:[0,1,1]
    v_pk_fma_f32 v[22:23], v[130:131], v[102:103], v[22:23] op_sel:[0,0,0] op_sel_hi:[0,1,1]
    s_set_gpr_idx_off
    s_sub_u32 s32, s32, 1
    s_cbranch_scc1 MAIN_DONE
    v_lshlrev_b32_sdwa v138, v15, v126 dst_sel:DWORD dst_unused:UNUSED_PAD src0_sel:DWORD src1_sel:WORD_1
    v_mfma_f32_4x4x4_16b_bf16 v[96:99], v[144:145], v[88:89], 0 cbsz:4 abid:1
    s_nop 0
    v_mfma_f32_4x4x4_16b_bf16 v[100:103], v[144:145], v[90:91], 0 cbsz:4 abid:1
    v_lshlrev_b32_sdwa v139, v15, v127 dst_sel:DWORD dst_unused:UNUSED_PAD src0_sel:DWORD src1_sel:WORD_1
    ds_read_u16_d16_hi v134, v138 offset:32768
    ds_read_u16_d16_hi v135, v139 offset:32768
    s_set_gpr_idx_on s53, 0xc
    v_pk_fma_f32 v[16:17], v[128:129], v[104:105], v[16:17] op_sel:[1,0,0] op_sel_hi:[1,1,1]
    v_pk_fma_f32 v[18:19], v[128:129], v[106:107], v[18:19] op_sel:[1,0,0] op_sel_hi:[1,1,1]
    v_pk_fma_f32 v[20:21], v[130:131], v[108:109], v[20:21] op_sel:[1,0,0] op_sel_hi:[1,1,1]
    v_pk_fma_f32 v[22:23], v[130:131], v[110:111], v[22:23] op_sel:[1,0,0] op_sel_hi:[1,1,1]
    s_set_gpr_idx_off
    s_branch MAIN_DONE
B_4:
    buffer_load_dwordx4 v[188:191], v1, s[16:19], s10 offen offset:0 sc1
    buffer_load_dwordx4 v[192:195], v1, s[16:19], s10 offen offset:1024 sc1
    buffer_load_dwordx4 v[196:199], v1, s[16:19], s10 offen offset:2048 sc1
    buffer_load_dwordx4 v[200:203], v1, s[16:19], s10 offen offset:3072 sc1
    buffer_load_dwordx4 v[204:207], v1, s[16:19], s11 offen offset:0 sc1
    buffer_load_dwordx4 v[208:211], v1, s[16:19], s11 offen offset:1024 sc1
    buffer_load_dwordx4 v[212:215], v1, s[16:19], s11 offen offset:2048 sc1
    buffer_load_dwordx4 v[216:219], v1, s[16:19], s11 offen offset:3072 sc1
    s_sub_u32 s32, s32, 1
    s_cbranch_scc1 MAIN_DONE
    v_mfma_f32_4x4x4_16b_bf16 v[116:119], v[172:173], v[178:179], 0 cbsz:4 abid:2
    v_lshlrev_b32_sdwa v136, v15, v122 dst_sel:DWORD dst_unused:UNUSED_PAD src0_sel:DWORD src1_sel:WORD_1
    s_waitcnt vmcnt(12)
    v_mfma_f32_4x4x4_16b_bf16 v[104:107], v[142:143], v[84:85], 0 cbsz:4 abid:1
    s_nop 0
    v_mfma_f32_4x4x4_16b_bf16 v[108:111], v[142:143], v[86:87], 0 cbsz:4 abid:1
    v_lshlrev_b32_sdwa v137, v15, v123 dst_sel:DWORD dst_unused:UNUSED_PAD src0_sel:DWORD src1_sel:WORD_1
    ds_read_u16_d16_hi v132, v136 offset:32768
    ds_read_u16_d16_hi v133, v137 offset:32768
    s_waitcnt lgkmcnt(2)
    s_set_gpr_idx_on s52, 0xc
    v_pk_fma_f32 v[16:17], v[128:129], v[96:97], v[16:17] op_sel:[0,0,0] op_sel_hi:[0,1,1]
    v_pk_fma_f32 v[18:19], v[128:129], v[98:99], v[18:19] op_sel:[0,0,0] op_sel_hi:[0,1,1]
    v_pk_fma_f32 v[20:21], v[130:131], v[100:101], v[20:21] op_sel:[0,0,0] op_sel_hi:[0,1,1]
    v_pk_fma_f32 v[22:23], v[130:131], v[102:103], v[22:23] op_sel:[0,0,0] op_sel_hi:[0,1,1]
    s_set_gpr_idx_off
    s_sub_u32 s32, s32, 1
    s_cbranch_scc1 MAIN_DONE
    v_lshlrev_b32_sdwa v138, v15, v126 dst_sel:DWORD dst_unused:UNUSED_PAD src0_sel:DWORD src1_sel:WORD_1
    s_waitcnt vmcnt(11)
    v_mfma_f32_4x4x4_16b_bf16 v[96:99], v[144:145], v[88:89], 0 cbsz:4 abid:1
    s_nop 0
    v_mfma_f32_4x4x4_16b_bf16 v[100:103], v[144:145], v[90:91], 0 cbsz:4 abid:1
    v_lshlrev_b32_sdwa v139, v15, v127 dst_sel:DWORD dst_unused:UNUSED_PAD src0_sel:DWORD src1_sel:WORD_1
    ds_read_u16_d16_hi v134, v138 offset:32768
    ds_read_u16_d16_hi v135, v139 offset:32768
    s_set_gpr_idx_on s53, 0xc
    v_pk_fma_f32 v[16:17], v[128:129], v[104:105], v[16:17] op_sel:[1,0,0] op_sel_hi:[1,1,1]
    v_pk_fma_f32 v[18:19], v[128:129], v[106:107], v[18:19] op_sel:[1,0,0] op_sel_hi:[1,1,1]
    v_pk_fma_f32 v[20:21], v[130:131], v[108:109], v[20:21] op_sel:[1,0,0] op_sel_hi:[1,1,1]
    v_pk_fma_f32 v[22:23], v[130:131], v[110:111], v[22:23] op_sel:[1,0,0] op_sel_hi:[1,1,1]
    s_set_gpr_idx_off
    s_sub_u32 s32, s32, 1
    s_cbranch_scc1 MAIN_DONE
    v_mfma_f32_4x4x4_16b_bf16 v[120:123], v[172:173], v[176:177], 0 cbsz:4 abid:3
    v_lshlrev_b32_sdwa v136, v15, v112 dst_sel:DWORD dst_unused:UNUSED_PAD src0_sel:DWORD src1_sel:WORD_1
    s_waitcnt vmcnt(10)
    v_mfma_f32_4x4x4_16b_bf16 v[104:107], v[146:147], v[92:93], 0 cbsz:4 abid:1
    s_nop 0
    v_mfma_f32_4x4x4_16b_bf16 v[108:111], v[146:147], v[94:95], 0 cbsz:4 abid:1
    v_lshlrev_b32_sdwa v137, v15, v113 dst_sel:DWORD dst_unused:UNUSED_PAD src0_sel:DWORD src1_sel:WORD_1
    ds_read_u16_d16_hi v128, v136 offset:32768
    ds_read_u16_d16_hi v129, v137 offset:32768
    s_waitcnt lgkmcnt(2)
    s_set_gpr_idx_on s54, 0xc
    v_pk_fma_f32 v[16:17], v[132:133], v[96:97], v[16:17] op_sel:[0,0,0] op_sel_hi:[0,1,1]
    v_pk_fma_f32 v[18:19], v[132:133], v[98:99], v[18:19] op_sel:[0,0,0] op_sel_hi:[0,1,1]
    v_pk_fma_f32 v[20:21], v[134:135], v[100:101], v[20:21] op_sel:[0,0,0] op_sel_hi:[0,1,1]
    v_pk_fma_f32 v[22:23], v[134:135], v[102:103], v[22:23] op_sel:[0,0,0] op_sel_hi:[0,1,1]
    s_set_gpr_idx_off
    s_sub_u32 s32, s32, 1
    s_cbranch_scc1 MAIN_DONE
    v_lshlrev_b32_sdwa v138, v15, v116 dst_sel:DWORD dst_unused:UNUSED_PAD src0_sel:DWORD src1_sel:WORD_1
    s_waitcnt vmcnt(9)
    v_mfma_f32_4x4x4_16b_bf16 v[96:99], v[140:141], v[64:65], 0 cbsz:4 abid:2
    s_nop 0
    v_mfma_f32_4x4x4_16b_bf16 v[100:103], v[140:141], v[66:67], 0 cbsz:4 abid:2
    v_lshlrev_b32_sdwa v139, v15, v117 dst_sel:DWORD dst_unused:UNUSED_PAD src0_sel:DWORD src1_sel:WORD_1
    ds_read_u16_d16_hi v130, v138 offset:32768
    ds_read_u16_d16_hi v131, v139 offset:32768
    s_set_gpr_idx_on s55, 0xc
    v_pk_fma_f32 v[16:17], v[132:133], v[104:105], v[16:17] op_sel:[1,0,0] op_sel_hi:[1,1,1]
    v_pk_fma_f32 v[18:19], v[132:133], v[106:107], v[18:19] op_sel:[1,0,0] op_sel_hi:[1,1,1]
    v_pk_fma_f32 v[20:21], v[134:135], v[108:109], v[20:21] op_sel:[1,0,0] op_sel_hi:[1,1,1]
    v_pk_fma_f32 v[22:23], v[134:135], v[110:111], v[22:23] op_sel:[1,0,0] op_sel_hi:[1,1,1]
    s_set_gpr_idx_off
    s_sub_u32 s32, s32, 1
    s_cbranch_scc1 MAIN_DONE
    v_mfma_f32_4x4x4_16b_bf16 v[124:127], v[172:173], v[178:179], 0 cbsz:4 abid:3
    v_lshlrev_b32_sdwa v136, v15, v114 dst_sel:DWORD dst_unused:UNUSED_PAD src0_sel:DWORD src1_sel:WORD_1
    s_waitcnt vmcnt(8)
    v_mfma_f32_4x4x4_16b_bf16 v[104:107], v[142:143], v[68:69], 0 cbsz:4 abid:2
    s_nop 0
    v_mfma_f32_4x4x4_16b_bf16 v[108:111], v[142:143], v[70:71], 0 cbsz:4 abid:2
    v_lshlrev_b32_sdwa v137, v15, v115 dst_sel:DWORD dst_unused:UNUSED_PAD src0_sel:DWORD src1_sel:WORD_1
    ds_read_u16_d16_hi v132, v136 offset:32768
    ds_read_u16_d16_hi v133, v137 offset:32768
    s_waitcnt lgkmcnt(2)
    s_set_gpr_idx_on s56, 0xc
    v_pk_fma_f32 v[16:17], v[128:129], v[96:97], v[16:17] op_sel:[0,0,0] op_sel_hi:[0,1,1]
    v_pk_fma_f32 v[18:19], v[128:129], v[98:99], v[18:19] op_sel:[0,0,0] op_sel_hi:[0,1,1]
    v_pk_fma_f32 v[20:21], v[130:131], v[100:101], v[20:21] op_sel:[0,0,0] op_sel_hi:[0,1,1]
    v_pk_fma_f32 v[22:23], v[130:131], v[102:103], v[22:23] op_sel:[0,0,0] op_sel_hi:[0,1,1]
    s_set_gpr_idx_off
    s_sub_u32 s32, s32, 1
    s_cbranch_scc1 MAIN_DONE
    v_lshlrev_b32_sdwa v138, v15, v118 dst_sel:DWORD dst_unused:UNUSED_PAD src0_sel:DWORD src1_sel:WORD_1
    v_mfma_f32_4x4x4_16b_bf16 v[96:99], v[144:145], v[72:73], 0 cbsz:4 abid:2
    s_nop 0
    v_mfma_f32_4x4x4_16b_bf16 v[100:103], v[144:145], v[74:75], 0 cbsz:4 abid:2
    v_lshlrev_b32_sdwa v139, v15, v119 dst_sel:DWORD dst_unused:UNUSED_PAD src0_sel:DWORD src1_sel:WORD_1
    ds_read_u16_d16_hi v134, v138 offset:32768
    ds_read_u16_d16_hi v135, v139 offset:32768
    s_set_gpr_idx_on s57, 0xc
    v_pk_fma_f32 v[16:17], v[128:129], v[104:105], v[16:17] op_sel:[1,0,0] op_sel_hi:[1,1,1]
    v_pk_fma_f32 v[18:19], v[128:129], v[106:107], v[18:19] op_sel:[1,0,0] op_sel_hi:[1,1,1]
    v_pk_fma_f32 v[20:21], v[130:131], v[108:109], v[20:21] op_sel:[1,0,0] op_sel_hi:[1,1,1]
    v_pk_fma_f32 v[22:23], v[130:131], v[110:111], v[22:23] op_sel:[1,0,0] op_sel_hi:[1,1,1]
    s_set_gpr_idx_off
    s_branch MAIN_DONE
B_8:
    buffer_load_dwordx4 v[188:191], v1, s[16:19], s10 offen offset:0 sc1
    buffer_load_dwordx4 v[192:195], v1, s[16:19], s10 offen offset:1024 sc1
    buffer_load_dwordx4 v[196:199], v1, s[16:19], s10 offen offset:2048 sc1
    buffer_load_dwordx4 v[200:203], v1, s[16:19], s10 offen offset:3072 sc1
    buffer_load_dwordx4 v[204:207], v1, s[16:19], s11 offen offset:0 sc1
    buffer_load_dwordx4 v[208:211], v1, s[16:19], s11 offen offset:1024 sc1
    buffer_load_dwordx4 v[212:215], v1, s[16:19], s11 offen offset:2048 sc1
    buffer_load_dwordx4 v[216:219], v1, s[16:19], s11 offen offset:3072 sc1
    s_sub_u32 s32, s32, 1
    s_cbranch_scc1 MAIN_DONE
    v_mfma_f32_4x4x4_16b_bf16 v[124:127], v[172:173], v[178:179], 0 cbsz:4 abid:3
    v_lshlrev_b32_sdwa v136, v15, v114 dst_sel:DWORD dst_unused:UNUSED_PAD src0_sel:DWORD src1_sel:WORD_1
    s_waitcnt vmcnt(12)
    v_mfma_f32_4x4x4_16b_bf16 v[104:107], v[142:143], v[68:69], 0 cbsz:4 abid:2
    s_nop 0
    v_mfma_f32_4x4x4_16b_bf16 v[108:111], v[142:143], v[70:71], 0 cbsz:4 abid:2
    v_lshlrev_b32_sdwa v137, v15, v115 dst_sel:DWORD dst_unused:UNUSED_PAD src0_sel:DWORD src1_sel:WORD_1
    ds_read_u16_d16_hi v132, v136 offset:32768
    ds_read_u16_d16_hi v133, v137 offset:32768
    s_waitcnt lgkmcnt(2)
    s_set_gpr_idx_on s56, 0xc
    v_pk_fma_f32 v[16:17], v[128:129], v[96:97], v[16:17] op_sel:[0,0,0] op_sel_hi:[0,1,1]
    v_pk_fma_f32 v[18:19], v[128:129], v[98:99], v[18:19] op_sel:[0,0,0] op_sel_hi:[0,1,1]
    v_pk_fma_f32 v[20:21], v[130:131], v[100:101], v[20:21] op_sel:[0,0,0] op_sel_hi:[0,1,1]
    v_pk_fma_f32 v[22:23], v[130:131], v[102:103], v[22:23] op_sel:[0,0,0] op_sel_hi:[0,1,1]
    s_set_gpr_idx_off
    s_sub_u32 s32, s32, 1
    s_cbranch_scc1 MAIN_DONE
    v_lshlrev_b32_sdwa v138, v15, v118 dst_sel:DWORD dst_unused:UNUSED_PAD src0_sel:DWORD src1_sel:WORD_1
    s_waitcnt vmcnt(11)
    v_mfma_f32_4x4x4_16b_bf16 v[96:99], v[144:145], v[72:73], 0 cbsz:4 abid:2
    s_nop 0
    v_mfma_f32_4x4x4_16b_bf16 v[100:103], v[144:145], v[74:75], 0 cbsz:4 abid:2
    v_lshlrev_b32_sdwa v139, v15, v119 dst_sel:DWORD dst_unused:UNUSED_PAD src0_sel:DWORD src1_sel:WORD_1
    ds_read_u16_d16_hi v134, v138 offset:32768
    ds_read_u16_d16_hi v135, v139 offset:32768
    s_set_gpr_idx_on s57, 0xc
    v_pk_fma_f32 v[16:17], v[128:129], v[104:105], v[16:17] op_sel:[1,0,0] op_sel_hi:[1,1,1]
    v_pk_fma_f32 v[18:19], v[128:129], v[106:107], v[18:19] op_sel:[1,0,0] op_sel_hi:[1,1,1]
    v_pk_fma_f32 v[20:21], v[130:131], v[108:109], v[20:21] op_sel:[1,0,0] op_sel_hi:[1,1,1]
    v_pk_fma_f32 v[22:23], v[130:131], v[110:111], v[22:23] op_sel:[1,0,0] op_sel_hi:[1,1,1]
    s_set_gpr_idx_off
    s_sub_u32 s32, s32, 1
    s_cbranch_scc1 MAIN_DONE
    v_mfma_f32_4x4x4_16b_bf16 v[112:115], v[172:173], v[176:177], 0 cbsz:4 abid:4
    v_lshlrev_b32_sdwa v136, v15, v120 dst_sel:DWORD dst_unused:UNUSED_PAD src0_sel:DWORD src1_sel:WORD_1
    s_waitcnt vmcnt(10)
    v_mfma_f32_4x4x4_16b_bf16 v[104:107], v[146:147], v[76:77], 0 cbsz:4 abid:2
    s_nop 0
    v_mfma_f32_4x4x4_16b_bf16 v[108:111], v[146:147], v[78:79], 0 cbsz:4 abid:2
    v_lshlrev_b32_sdwa v137, v15, v121 dst_sel:DWORD dst_unused:UNUSED_PAD src0_sel:DWORD src1_sel:WORD_1
    ds_read_u16_d16_hi v128, v136 offset:32768
    ds_read_u16_d16_hi v129, v137 offset:32768
    s_waitcnt lgkmcnt(2)
    s_set_gpr_idx_on s58, 0xc
    v_pk_fma_f32 v[16:17], v[132:133], v[96:97], v[16:17] op_sel:[0,0,0] op_sel_hi:[0,1,1]
    v_pk_fma_f32 v[18:19], v[132:133], v[98:99], v[18:19] op_sel:[0,0,0] op_sel_hi:[0,1,1]
    v_pk_fma_f32 v[20:21], v[134:135], v[100:101], v[20:21] op_sel:[0,0,0] op_sel_hi:[0,1,1]
    v_pk_fma_f32 v[22:23], v[134:135], v[102:103], v[22:23] op_sel:[0,0,0] op_sel_hi:[0,1,1]
    s_set_gpr_idx_off
    s_sub_u32 s32, s32, 1
    s_cbranch_scc1 MAIN_DONE
    v_lshlrev_b32_sdwa v138, v15, v124 dst_sel:DWORD dst_unused:UNUSED_PAD src0_sel:DWORD src1_sel:WORD_1
    s_waitcnt vmcnt(9)
    v_mfma_f32_4x4x4_16b_bf16 v[96:99], v[140:141], v[80:81], 0 cbsz:4 abid:3
    s_nop 0
    v_mfma_f32_4x4x4_16b_bf16 v[100:103], v[140:141], v[82:83], 0 cbsz:4 abid:3
    v_lshlrev_b32_sdwa v139, v15, v125 dst_sel:DWORD dst_unused:UNUSED_PAD src0_sel:DWORD src1_sel:WORD_1
    ds_read_u16_d16_hi v130, v138 offset:32768
    ds_read_u16_d16_hi v131, v139 offset:32768
    s_set_gpr_idx_on s59, 0xc
    v_pk_fma_f32 v[16:17], v[132:133], v[104:105], v[16:17] op_sel:[1,0,0] op_sel_hi:[1,1,1]
    v_pk_fma_f32 v[18:19], v[132:133], v[106:107], v[18:19] op_sel:[1,0,0] op_sel_hi:[1,1,1]
    v_pk_fma_f32 v[20:21], v[134:135], v[108:109], v[20:21] op_sel:[1,0,0] op_sel_hi:[1,1,1]
    v_pk_fma_f32 v[22:23], v[134:135], v[110:111], v[22:23] op_sel:[1,0,0] op_sel_hi:[1,1,1]
    s_set_gpr_idx_off
    s_sub_u32 s32, s32, 1
    s_cbranch_scc1 MAIN_DONE
    v_mfma_f32_4x4x4_16b_bf16 v[116:119], v[172:173], v[178:179], 0 cbsz:4 abid:4
    v_lshlrev_b32_sdwa v136, v15, v122 dst_sel:DWORD dst_unused:UNUSED_PAD src0_sel:DWORD src1_sel:WORD_1
    s_waitcnt vmcnt(8)
    v_mfma_f32_4x4x4_16b_bf16 v[104:107], v[142:143], v[84:85], 0 cbsz:4 abid:3
    s_nop 0
    v_mfma_f32_4x4x4_16b_bf16 v[108:111], v[142:143], v[86:87], 0 cbsz:4 abid:3
    v_lshlrev_b32_sdwa v137, v15, v123 dst_sel:DWORD dst_unused:UNUSED_PAD src0_sel:DWORD src1_sel:WORD_1
    ds_read_u16_d16_hi v132, v136 offset:32768
    ds_read_u16_d16_hi v133, v137 offset:32768
    s_waitcnt lgkmcnt(2)
    s_set_gpr_idx_on s60, 0xc
    v_pk_fma_f32 v[16:17], v[128:129], v[96:97], v[16:17] op_sel:[0,0,0] op_sel_hi:[0,1,1]
    v_pk_fma_f32 v[18:19], v[128:129], v[98:99], v[18:19] op_sel:[0,0,0] op_sel_hi:[0,1,1]
    v_pk_fma_f32 v[20:21], v[130:131], v[100:101], v[20:21] op_sel:[0,0,0] op_sel_hi:[0,1,1]
    v_pk_fma_f32 v[22:23], v[130:131], v[102:103], v[22:23] op_sel:[0,0,0] op_sel_hi:[0,1,1]
    s_set_gpr_idx_off
    s_sub_u32 s32, s32, 1
    s_cbranch_scc1 MAIN_DONE
    v_lshlrev_b32_sdwa v138, v15, v126 dst_sel:DWORD dst_unused:UNUSED_PAD src0_sel:DWORD src1_sel:WORD_1
    v_mfma_f32_4x4x4_16b_bf16 v[96:99], v[144:145], v[88:89], 0 cbsz:4 abid:3
    s_nop 0
    v_mfma_f32_4x4x4_16b_bf16 v[100:103], v[144:145], v[90:91], 0 cbsz:4 abid:3
    v_lshlrev_b32_sdwa v139, v15, v127 dst_sel:DWORD dst_unused:UNUSED_PAD src0_sel:DWORD src1_sel:WORD_1
    ds_read_u16_d16_hi v134, v138 offset:32768
    ds_read_u16_d16_hi v135, v139 offset:32768
    s_set_gpr_idx_on s61, 0xc
    v_pk_fma_f32 v[16:17], v[128:129], v[104:105], v[16:17] op_sel:[1,0,0] op_sel_hi:[1,1,1]
    v_pk_fma_f32 v[18:19], v[128:129], v[106:107], v[18:19] op_sel:[1,0,0] op_sel_hi:[1,1,1]
    v_pk_fma_f32 v[20:21], v[130:131], v[108:109], v[20:21] op_sel:[1,0,0] op_sel_hi:[1,1,1]
    v_pk_fma_f32 v[22:23], v[130:131], v[110:111], v[22:23] op_sel:[1,0,0] op_sel_hi:[1,1,1]
    s_set_gpr_idx_off
    s_branch MAIN_DONE
B_12:
    buffer_load_dwordx4 v[188:191], v1, s[16:19], s10 offen offset:0 sc1
    buffer_load_dwordx4 v[192:195], v1, s[16:19], s10 offen offset:1024 sc1
    buffer_load_dwordx4 v[196:199], v1, s[16:19], s10 offen offset:2048 sc1
    buffer_load_dwordx4 v[200:203], v1, s[16:19], s10 offen offset:3072 sc1
    buffer_load_dwordx4 v[204:207], v1, s[16:19], s11 offen offset:0 sc1
    buffer_load_dwordx4 v[208:211], v1, s[16:19], s11 offen offset:1024 sc1
    buffer_load_dwordx4 v[212:215], v1, s[16:19], s11 offen offset:2048 sc1
    buffer_load_dwordx4 v[216:219], v1, s[16:19], s11 offen offset:3072 sc1
    s_sub_u32 s32, s32, 1
    s_cbranch_scc1 MAIN_DONE
    v_mfma_f32_4x4x4_16b_bf16 v[116:119], v[172:173], v[178:179], 0 cbsz:4 abid:4
    v_lshlrev_b32_sdwa v136, v15, v122 dst_sel:DWORD dst_unused:UNUSED_PAD src0_sel:DWORD src1_sel:WORD_1
    s_waitcnt vmcnt(12)
    v_mfma_f32_4x4x4_16b_bf16 v[104:107], v[142:143], v[84:85], 0 cbsz:4 abid:3
    s_nop 0
    v_mfma_f32_4x4x4_16b_bf16 v[108:111], v[142:143], v[86:87], 0 cbsz:4 abid:3
    v_lshlrev_b32_sdwa v137, v15, v123 dst_sel:DWORD dst_unused:UNUSED_PAD src0_sel:DWORD src1_sel:WORD_1
    ds_read_u16_d16_hi v132, v136 offset:32768
    ds_read_u16_d16_hi v133, v137 offset:32768
    s_waitcnt lgkmcnt(2)
    s_set_gpr_idx_on s60, 0xc
    v_pk_fma_f32 v[16:17], v[128:129], v[96:97], v[16:17] op_sel:[0,0,0] op_sel_hi:[0,1,1]
    v_pk_fma_f32 v[18:19], v[128:129], v[98:99], v[18:19] op_sel:[0,0,0] op_sel_hi:[0,1,1]
    v_pk_fma_f32 v[20:21], v[130:131], v[100:101], v[20:21] op_sel:[0,0,0] op_sel_hi:[0,1,1]
    v_pk_fma_f32 v[22:23], v[130:131], v[102:103], v[22:23] op_sel:[0,0,0] op_sel_hi:[0,1,1]
    s_set_gpr_idx_off
    s_sub_u32 s32, s32, 1
    s_cbranch_scc1 MAIN_DONE
    v_lshlrev_b32_sdwa v138, v15, v126 dst_sel:DWORD dst_unused:UNUSED_PAD src0_sel:DWORD src1_sel:WORD_1
    s_waitcnt vmcnt(11)
    v_mfma_f32_4x4x4_16b_bf16 v[96:99], v[144:145], v[88:89], 0 cbsz:4 abid:3
    s_nop 0
    v_mfma_f32_4x4x4_16b_bf16 v[100:103], v[144:145], v[90:91], 0 cbsz:4 abid:3
    v_lshlrev_b32_sdwa v139, v15, v127 dst_sel:DWORD dst_unused:UNUSED_PAD src0_sel:DWORD src1_sel:WORD_1
    ds_read_u16_d16_hi v134, v138 offset:32768
    ds_read_u16_d16_hi v135, v139 offset:32768
    s_set_gpr_idx_on s61, 0xc
    v_pk_fma_f32 v[16:17], v[128:129], v[104:105], v[16:17] op_sel:[1,0,0] op_sel_hi:[1,1,1]
    v_pk_fma_f32 v[18:19], v[128:129], v[106:107], v[18:19] op_sel:[1,0,0] op_sel_hi:[1,1,1]
    v_pk_fma_f32 v[20:21], v[130:131], v[108:109], v[20:21] op_sel:[1,0,0] op_sel_hi:[1,1,1]
    v_pk_fma_f32 v[22:23], v[130:131], v[110:111], v[22:23] op_sel:[1,0,0] op_sel_hi:[1,1,1]
    s_set_gpr_idx_off
    s_sub_u32 s32, s32, 1
    s_cbranch_scc1 MAIN_DONE
    v_mfma_f32_4x4x4_16b_bf16 v[120:123], v[172:173], v[176:177], 0 cbsz:4 abid:5
    v_lshlrev_b32_sdwa v136, v15, v112 dst_sel:DWORD dst_unused:UNUSED_PAD src0_sel:DWORD src1_sel:WORD_1
    s_waitcnt vmcnt(10)
    v_mfma_f32_4x4x4_16b_bf16 v[104:107], v[146:147], v[92:93], 0 cbsz:4 abid:3
    s_nop 0
    v_mfma_f32_4x4x4_16b_bf16 v[108:111], v[146:147], v[94:95], 0 cbsz:4 abid:3
    v_lshlrev_b32_sdwa v137, v15, v113 dst_sel:DWORD dst_unused:UNUSED_PAD src0_sel:DWORD src1_sel:WORD_1
    ds_read_u16_d16_hi v128, v136 offset:32768
    ds_read_u16_d16_hi v129, v137 offset:32768
    s_waitcnt lgkmcnt(2)
    s_set_gpr_idx_on s62, 0xc
    v_pk_fma_f32 v[16:17], v[132:133], v[96:97], v[16:17] op_sel:[0,0,0] op_sel_hi:[0,1,1]
    v_pk_fma_f32 v[18:19], v[132:133], v[98:99], v[18:19] op_sel:[0,0,0] op_sel_hi:[0,1,1]
    v_pk_fma_f32 v[20:21], v[134:135], v[100:101], v[20:21] op_sel:[0,0,0] op_sel_hi:[0,1,1]
    v_pk_fma_f32 v[22:23], v[134:135], v[102:103], v[22:23] op_sel:[0,0,0] op_sel_hi:[0,1,1]
    s_set_gpr_idx_off
    s_sub_u32 s32, s32, 1
    s_cbranch_scc1 MAIN_DONE
    v_lshlrev_b32_sdwa v138, v15, v116 dst_sel:DWORD dst_unused:UNUSED_PAD src0_sel:DWORD src1_sel:WORD_1
    s_waitcnt vmcnt(9)
    v_mfma_f32_4x4x4_16b_bf16 v[96:99], v[140:141], v[64:65], 0 cbsz:4 abid:4
    s_nop 0
    v_mfma_f32_4x4x4_16b_bf16 v[100:103], v[140:141], v[66:67], 0 cbsz:4 abid:4
    v_lshlrev_b32_sdwa v139, v15, v117 dst_sel:DWORD dst_unused:UNUSED_PAD src0_sel:DWORD src1_sel:WORD_1
    ds_read_u16_d16_hi v130, v138 offset:32768
    ds_read_u16_d16_hi v131, v139 offset:32768
    s_set_gpr_idx_on s63, 0xc
    v_pk_fma_f32 v[16:17], v[132:133], v[104:105], v[16:17] op_sel:[1,0,0] op_sel_hi:[1,1,1]
    v_pk_fma_f32 v[18:19], v[132:133], v[106:107], v[18:19] op_sel:[1,0,0] op_sel_hi:[1,1,1]
    v_pk_fma_f32 v[20:21], v[134:135], v[108:109], v[20:21] op_sel:[1,0,0] op_sel_hi:[1,1,1]
    v_pk_fma_f32 v[22:23], v[134:135], v[110:111], v[22:23] op_sel:[1,0,0] op_sel_hi:[1,1,1]
    s_set_gpr_idx_off
    s_sub_u32 s32, s32, 1
    s_cbranch_scc1 MAIN_DONE
    v_mfma_f32_4x4x4_16b_bf16 v[124:127], v[172:173], v[178:179], 0 cbsz:4 abid:5
    v_lshlrev_b32_sdwa v136, v15, v114 dst_sel:DWORD dst_unused:UNUSED_PAD src0_sel:DWORD src1_sel:WORD_1
    s_waitcnt vmcnt(8)
    v_mfma_f32_4x4x4_16b_bf16 v[104:107], v[142:143], v[68:69], 0 cbsz:4 abid:4
    s_nop 0
    v_mfma_f32_4x4x4_16b_bf16 v[108:111], v[142:143], v[70:71], 0 cbsz:4 abid:4
    v_lshlrev_b32_sdwa v137, v15, v115 dst_sel:DWORD dst_unused:UNUSED_PAD src0_sel:DWORD src1_sel:WORD_1
    ds_read_u16_d16_hi v132, v136 offset:32768
    ds_read_u16_d16_hi v133, v137 offset:32768
    s_waitcnt lgkmcnt(2)
    s_set_gpr_idx_on s48, 0xc
    v_pk_fma_f32 v[16:17], v[128:129], v[96:97], v[16:17] op_sel:[0,0,0] op_sel_hi:[0,1,1]
    v_pk_fma_f32 v[18:19], v[128:129], v[98:99], v[18:19] op_sel:[0,0,0] op_sel_hi:[0,1,1]
    v_pk_fma_f32 v[20:21], v[130:131], v[100:101], v[20:21] op_sel:[0,0,0] op_sel_hi:[0,1,1]
    v_pk_fma_f32 v[22:23], v[130:131], v[102:103], v[22:23] op_sel:[0,0,0] op_sel_hi:[0,1,1]
    s_set_gpr_idx_off
    s_sub_u32 s32, s32, 1
    s_cbranch_scc1 MAIN_DONE
    v_lshlrev_b32_sdwa v138, v15, v118 dst_sel:DWORD dst_unused:UNUSED_PAD src0_sel:DWORD src1_sel:WORD_1
    v_mfma_f32_4x4x4_16b_bf16 v[96:99], v[144:145], v[72:73], 0 cbsz:4 abid:4
    s_nop 0
    v_mfma_f32_4x4x4_16b_bf16 v[100:103], v[144:145], v[74:75], 0 cbsz:4 abid:4
    v_lshlrev_b32_sdwa v139, v15, v119 dst_sel:DWORD dst_unused:UNUSED_PAD src0_sel:DWORD src1_sel:WORD_1
    ds_read_u16_d16_hi v134, v138 offset:32768
    ds_read_u16_d16_hi v135, v139 offset:32768
    s_set_gpr_idx_on s49, 0xc
    v_pk_fma_f32 v[16:17], v[128:129], v[104:105], v[16:17] op_sel:[1,0,0] op_sel_hi:[1,1,1]
    v_pk_fma_f32 v[18:19], v[128:129], v[106:107], v[18:19] op_sel:[1,0,0] op_sel_hi:[1,1,1]
    v_pk_fma_f32 v[20:21], v[130:131], v[108:109], v[20:21] op_sel:[1,0,0] op_sel_hi:[1,1,1]
    v_pk_fma_f32 v[22:23], v[130:131], v[110:111], v[22:23] op_sel:[1,0,0] op_sel_hi:[1,1,1]
    s_set_gpr_idx_off
    s_branch MAIN_DONE
B_16:
    buffer_load_dwordx4 v[188:191], v1, s[16:19], s10 offen offset:0 sc1
    buffer_load_dwordx4 v[192:195], v1, s[16:19], s10 offen offset:1024 sc1
    buffer_load_dwordx4 v[196:199], v1, s[16:19], s10 offen offset:2048 sc1
    buffer_load_dwordx4 v[200:203], v1, s[16:19], s10 offen offset:3072 sc1
    buffer_load_dwordx4 v[204:207], v1, s[16:19], s11 offen offset:0 sc1
    buffer_load_dwordx4 v[208:211], v1, s[16:19], s11 offen offset:1024 sc1
    buffer_load_dwordx4 v[212:215], v1, s[16:19], s11 offen offset:2048 sc1
    buffer_load_dwordx4 v[216:219], v1, s[16:19], s11 offen offset:3072 sc1
    s_sub_u32 s32, s32, 1
    s_cbranch_scc1 MAIN_DONE
    v_mfma_f32_4x4x4_16b_bf16 v[124:127], v[172:173], v[178:179], 0 cbsz:4 abid:5
    v_lshlrev_b32_sdwa v136, v15, v114 dst_sel:DWORD dst_unused:UNUSED_PAD src0_sel:DWORD src1_sel:WORD_1
    s_waitcnt vmcnt(12)
    v_mfma_f32_4x4x4_16b_bf16 v[104:107], v[142:143], v[68:69], 0 cbsz:4 abid:4
    s_nop 0
    v_mfma_f32_4x4x4_16b_bf16 v[108:111], v[142:143], v[70:71], 0 cbsz:4 abid:4
    v_lshlrev_b32_sdwa v137, v15, v115 dst_sel:DWORD dst_unused:UNUSED_PAD src0_sel:DWORD src1_sel:WORD_1
    ds_read_u16_d16_hi v132, v136 offset:32768
    ds_read_u16_d16_hi v133, v137 offset:32768
    s_waitcnt lgkmcnt(2)
    s_set_gpr_idx_on s48, 0xc
    v_pk_fma_f32 v[16:17], v[128:129], v[96:97], v[16:17] op_sel:[0,0,0] op_sel_hi:[0,1,1]
    v_pk_fma_f32 v[18:19], v[128:129], v[98:99], v[18:19] op_sel:[0,0,0] op_sel_hi:[0,1,1]
    v_pk_fma_f32 v[20:21], v[130:131], v[100:101], v[20:21] op_sel:[0,0,0] op_sel_hi:[0,1,1]
    v_pk_fma_f32 v[22:23], v[130:131], v[102:103], v[22:23] op_sel:[0,0,0] op_sel_hi:[0,1,1]
    s_set_gpr_idx_off
    s_sub_u32 s32, s32, 1
    s_cbranch_scc1 MAIN_DONE
    v_lshlrev_b32_sdwa v138, v15, v118 dst_sel:DWORD dst_unused:UNUSED_PAD src0_sel:DWORD src1_sel:WORD_1
    s_waitcnt vmcnt(11)
    v_mfma_f32_4x4x4_16b_bf16 v[96:99], v[144:145], v[72:73], 0 cbsz:4 abid:4
    s_nop 0
    v_mfma_f32_4x4x4_16b_bf16 v[100:103], v[144:145], v[74:75], 0 cbsz:4 abid:4
    v_lshlrev_b32_sdwa v139, v15, v119 dst_sel:DWORD dst_unused:UNUSED_PAD src0_sel:DWORD src1_sel:WORD_1
    ds_read_u16_d16_hi v134, v138 offset:32768
    ds_read_u16_d16_hi v135, v139 offset:32768
    s_set_gpr_idx_on s49, 0xc
    v_pk_fma_f32 v[16:17], v[128:129], v[104:105], v[16:17] op_sel:[1,0,0] op_sel_hi:[1,1,1]
    v_pk_fma_f32 v[18:19], v[128:129], v[106:107], v[18:19] op_sel:[1,0,0] op_sel_hi:[1,1,1]
    v_pk_fma_f32 v[20:21], v[130:131], v[108:109], v[20:21] op_sel:[1,0,0] op_sel_hi:[1,1,1]
    v_pk_fma_f32 v[22:23], v[130:131], v[110:111], v[22:23] op_sel:[1,0,0] op_sel_hi:[1,1,1]
    s_set_gpr_idx_off
    s_sub_u32 s32, s32, 1
    s_cbranch_scc1 MAIN_DONE
    v_mfma_f32_4x4x4_16b_bf16 v[112:115], v[172:173], v[176:177], 0 cbsz:4 abid:6
    v_lshlrev_b32_sdwa v136, v15, v120 dst_sel:DWORD dst_unused:UNUSED_PAD src0_sel:DWORD src1_sel:WORD_1
    s_waitcnt vmcnt(10)
    v_mfma_f32_4x4x4_16b_bf16 v[104:107], v[146:147], v[76:77], 0 cbsz:4 abid:4
    s_nop 0
    v_mfma_f32_4x4x4_16b_bf16 v[108:111], v[146:147], v[78:79], 0 cbsz:4 abid:4
    v_lshlrev_b32_sdwa v137, v15, v121 dst_sel:DWORD dst_unused:UNUSED_PAD src0_sel:DWORD src1_sel:WORD_1
    ds_read_u16_d16_hi v128, v136 offset:32768
    ds_read_u16_d16_hi v129, v137 offset:32768
    s_waitcnt lgkmcnt(2)
    s_set_gpr_idx_on s50, 0xc
    v_pk_fma_f32 v[16:17], v[132:133], v[96:97], v[16:17] op_sel:[0,0,0] op_sel_hi:[0,1,1]
    v_pk_fma_f32 v[18:19], v[132:133], v[98:99], v[18:19] op_sel:[0,0,0] op_sel_hi:[0,1,1]
    v_pk_fma_f32 v[20:21], v[134:135], v[100:101], v[20:21] op_sel:[0,0,0] op_sel_hi:[0,1,1]
    v_pk_fma_f32 v[22:23], v[134:135], v[102:103], v[22:23] op_sel:[0,0,0] op_sel_hi:[0,1,1]
    s_set_gpr_idx_off
    s_sub_u32 s32, s32, 1
    s_cbranch_scc1 MAIN_DONE
    v_lshlrev_b32_sdwa v138, v15, v124 dst_sel:DWORD dst_unused:UNUSED_PAD src0_sel:DWORD src1_sel:WORD_1
    s_waitcnt vmcnt(9)
    v_mfma_f32_4x4x4_16b_bf16 v[96:99], v[140:141], v[80:81], 0 cbsz:4 abid:5
    s_nop 0
    v_mfma_f32_4x4x4_16b_bf16 v[100:103], v[140:141], v[82:83], 0 cbsz:4 abid:5
    v_lshlrev_b32_sdwa v139, v15, v125 dst_sel:DWORD dst_unused:UNUSED_PAD src0_sel:DWORD src1_sel:WORD_1
    ds_read_u16_d16_hi v130, v138 offset:32768
    ds_read_u16_d16_hi v131, v139 offset:32768
    s_set_gpr_idx_on s51, 0xc
    v_pk_fma_f32 v[16:17], v[132:133], v[104:105], v[16:17] op_sel:[1,0,0] op_sel_hi:[1,1,1]
    v_pk_fma_f32 v[18:19], v[132:133], v[106:107], v[18:19] op_sel:[1,0,0] op_sel_hi:[1,1,1]
    v_pk_fma_f32 v[20:21], v[134:135], v[108:109], v[20:21] op_sel:[1,0,0] op_sel_hi:[1,1,1]
    v_pk_fma_f32 v[22:23], v[134:135], v[110:111], v[22:23] op_sel:[1,0,0] op_sel_hi:[1,1,1]
    s_set_gpr_idx_off
    s_sub_u32 s32, s32, 1
    s_cbranch_scc1 MAIN_DONE
    v_mfma_f32_4x4x4_16b_bf16 v[116:119], v[172:173], v[178:179], 0 cbsz:4 abid:6
    v_lshlrev_b32_sdwa v136, v15, v122 dst_sel:DWORD dst_unused:UNUSED_PAD src0_sel:DWORD src1_sel:WORD_1
    s_waitcnt vmcnt(8)
    v_mfma_f32_4x4x4_16b_bf16 v[104:107], v[142:143], v[84:85], 0 cbsz:4 abid:5
    s_nop 0
    v_mfma_f32_4x4x4_16b_bf16 v[108:111], v[142:143], v[86:87], 0 cbsz:4 abid:5
    v_lshlrev_b32_sdwa v137, v15, v123 dst_sel:DWORD dst_unused:UNUSED_PAD src0_sel:DWORD src1_sel:WORD_1
    ds_read_u16_d16_hi v132, v136 offset:32768
    ds_read_u16_d16_hi v133, v137 offset:32768
    s_waitcnt lgkmcnt(2)
    s_set_gpr_idx_on s52, 0xc
    v_pk_fma_f32 v[16:17], v[128:129], v[96:97], v[16:17] op_sel:[0,0,0] op_sel_hi:[0,1,1]
    v_pk_fma_f32 v[18:19], v[128:129], v[98:99], v[18:19] op_sel:[0,0,0] op_sel_hi:[0,1,1]
    v_pk_fma_f32 v[20:21], v[130:131], v[100:101], v[20:21] op_sel:[0,0,0] op_sel_hi:[0,1,1]
    v_pk_fma_f32 v[22:23], v[130:131], v[102:103], v[22:23] op_sel:[0,0,0] op_sel_hi:[0,1,1]
    s_set_gpr_idx_off
    s_sub_u32 s32, s32, 1
    s_cbranch_scc1 MAIN_DONE
    v_lshlrev_b32_sdwa v138, v15, v126 dst_sel:DWORD dst_unused:UNUSED_PAD src0_sel:DWORD src1_sel:WORD_1
    v_mfma_f32_4x4x4_16b_bf16 v[96:99], v[144:145], v[88:89], 0 cbsz:4 abid:5
    s_nop 0
    v_mfma_f32_4x4x4_16b_bf16 v[100:103], v[144:145], v[90:91], 0 cbsz:4 abid:5
    v_lshlrev_b32_sdwa v139, v15, v127 dst_sel:DWORD dst_unused:UNUSED_PAD src0_sel:DWORD src1_sel:WORD_1
    ds_read_u16_d16_hi v134, v138 offset:32768
    ds_read_u16_d16_hi v135, v139 offset:32768
    s_set_gpr_idx_on s53, 0xc
    v_pk_fma_f32 v[16:17], v[128:129], v[104:105], v[16:17] op_sel:[1,0,0] op_sel_hi:[1,1,1]
    v_pk_fma_f32 v[18:19], v[128:129], v[106:107], v[18:19] op_sel:[1,0,0] op_sel_hi:[1,1,1]
    v_pk_fma_f32 v[20:21], v[130:131], v[108:109], v[20:21] op_sel:[1,0,0] op_sel_hi:[1,1,1]
    v_pk_fma_f32 v[22:23], v[130:131], v[110:111], v[22:23] op_sel:[1,0,0] op_sel_hi:[1,1,1]
    s_set_gpr_idx_off
    s_branch MAIN_DONE
B_20:
    buffer_load_dwordx4 v[188:191], v1, s[16:19], s10 offen offset:0 sc1
    buffer_load_dwordx4 v[192:195], v1, s[16:19], s10 offen offset:1024 sc1
    buffer_load_dwordx4 v[196:199], v1, s[16:19], s10 offen offset:2048 sc1
    buffer_load_dwordx4 v[200:203], v1, s[16:19], s10 offen offset:3072 sc1
    buffer_load_dwordx4 v[204:207], v1, s[16:19], s11 offen offset:0 sc1
    buffer_load_dwordx4 v[208:211], v1, s[16:19], s11 offen offset:1024 sc1
    buffer_load_dwordx4 v[212:215], v1, s[16:19], s11 offen offset:2048 sc1
    buffer_load_dwordx4 v[216:219], v1, s[16:19], s11 offen offset:3072 sc1
    s_sub_u32 s32, s32, 1
    s_cbranch_scc1 MAIN_DONE
    v_mfma_f32_4x4x4_16b_bf16 v[116:119], v[172:173], v[178:179], 0 cbsz:4 abid:6
    v_lshlrev_b32_sdwa v136, v15, v122 dst_sel:DWORD dst_unused:UNUSED_PAD src0_sel:DWORD src1_sel:WORD_1
    s_waitcnt vmcnt(12)
    v_mfma_f32_4x4x4_16b_bf16 v[104:107], v[142:143], v[84:85], 0 cbsz:4 abid:5
    s_nop 0
    v_mfma_f32_4x4x4_16b_bf16 v[108:111], v[142:143], v[86:87], 0 cbsz:4 abid:5
    v_lshlrev_b32_sdwa v137, v15, v123 dst_sel:DWORD dst_unused:UNUSED_PAD src0_sel:DWORD src1_sel:WORD_1
    ds_read_u16_d16_hi v132, v136 offset:32768
    ds_read_u16_d16_hi v133, v137 offset:32768
    s_waitcnt lgkmcnt(2)
    s_set_gpr_idx_on s52, 0xc
    v_pk_fma_f32 v[16:17], v[128:129], v[96:97], v[16:17] op_sel:[0,0,0] op_sel_hi:[0,1,1]
    v_pk_fma_f32 v[18:19], v[128:129], v[98:99], v[18:19] op_sel:[0,0,0] op_sel_hi:[0,1,1]
    v_pk_fma_f32 v[20:21], v[130:131], v[100:101], v[20:21] op_sel:[0,0,0] op_sel_hi:[0,1,1]
    v_pk_fma_f32 v[22:23], v[130:131], v[102:103], v[22:23] op_sel:[0,0,0] op_sel_hi:[0,1,1]
    s_set_gpr_idx_off
    s_sub_u32 s32, s32, 1
    s_cbranch_scc1 MAIN_DONE
    v_lshlrev_b32_sdwa v138, v15, v126 dst_sel:DWORD dst_unused:UNUSED_PAD src0_sel:DWORD src1_sel:WORD_1
    s_waitcnt vmcnt(11)
    v_mfma_f32_4x4x4_16b_bf16 v[96:99], v[144:145], v[88:89], 0 cbsz:4 abid:5
    s_nop 0
    v_mfma_f32_4x4x4_16b_bf16 v[100:103], v[144:145], v[90:91], 0 cbsz:4 abid:5
    v_lshlrev_b32_sdwa v139, v15, v127 dst_sel:DWORD dst_unused:UNUSED_PAD src0_sel:DWORD src1_sel:WORD_1
    ds_read_u16_d16_hi v134, v138 offset:32768
    ds_read_u16_d16_hi v135, v139 offset:32768
    s_set_gpr_idx_on s53, 0xc
    v_pk_fma_f32 v[16:17], v[128:129], v[104:105], v[16:17] op_sel:[1,0,0] op_sel_hi:[1,1,1]
    v_pk_fma_f32 v[18:19], v[128:129], v[106:107], v[18:19] op_sel:[1,0,0] op_sel_hi:[1,1,1]
    v_pk_fma_f32 v[20:21], v[130:131], v[108:109], v[20:21] op_sel:[1,0,0] op_sel_hi:[1,1,1]
    v_pk_fma_f32 v[22:23], v[130:131], v[110:111], v[22:23] op_sel:[1,0,0] op_sel_hi:[1,1,1]
    s_set_gpr_idx_off
    s_sub_u32 s32, s32, 1
    s_cbranch_scc1 MAIN_DONE
    v_mfma_f32_4x4x4_16b_bf16 v[120:123], v[172:173], v[176:177], 0 cbsz:4 abid:7
    v_lshlrev_b32_sdwa v136, v15, v112 dst_sel:DWORD dst_unused:UNUSED_PAD src0_sel:DWORD src1_sel:WORD_1
    s_waitcnt vmcnt(10)
    v_mfma_f32_4x4x4_16b_bf16 v[104:107], v[146:147], v[92:93], 0 cbsz:4 abid:5
    s_nop 0
    v_mfma_f32_4x4x4_16b_bf16 v[108:111], v[146:147], v[94:95], 0 cbsz:4 abid:5
    v_lshlrev_b32_sdwa v137, v15, v113 dst_sel:DWORD dst_unused:UNUSED_PAD src0_sel:DWORD src1_sel:WORD_1
    ds_read_u16_d16_hi v128, v136 offset:32768
    ds_read_u16_d16_hi v129, v137 offset:32768
    s_waitcnt lgkmcnt(2)
    s_set_gpr_idx_on s54, 0xc
    v_pk_fma_f32 v[16:17], v[132:133], v[96:97], v[16:17] op_sel:[0,0,0] op_sel_hi:[0,1,1]
    v_pk_fma_f32 v[18:19], v[132:133], v[98:99], v[18:19] op_sel:[0,0,0] op_sel_hi:[0,1,1]
    v_pk_fma_f32 v[20:21], v[134:135], v[100:101], v[20:21] op_sel:[0,0,0] op_sel_hi:[0,1,1]
    v_pk_fma_f32 v[22:23], v[134:135], v[102:103], v[22:23] op_sel:[0,0,0] op_sel_hi:[0,1,1]
    s_set_gpr_idx_off
    s_sub_u32 s32, s32, 1
    s_cbranch_scc1 MAIN_DONE
    v_lshlrev_b32_sdwa v138, v15, v116 dst_sel:DWORD dst_unused:UNUSED_PAD src0_sel:DWORD src1_sel:WORD_1
    s_waitcnt vmcnt(9)
    v_mfma_f32_4x4x4_16b_bf16 v[96:99], v[140:141], v[64:65], 0 cbsz:4 abid:6
    s_nop 0
    v_mfma_f32_4x4x4_16b_bf16 v[100:103], v[140:141], v[66:67], 0 cbsz:4 abid:6
    v_lshlrev_b32_sdwa v139, v15, v117 dst_sel:DWORD dst_unused:UNUSED_PAD src0_sel:DWORD src1_sel:WORD_1
    ds_read_u16_d16_hi v130, v138 offset:32768
    ds_read_u16_d16_hi v131, v139 offset:32768
    s_set_gpr_idx_on s55, 0xc
    v_pk_fma_f32 v[16:17], v[132:133], v[104:105], v[16:17] op_sel:[1,0,0] op_sel_hi:[1,1,1]
    v_pk_fma_f32 v[18:19], v[132:133], v[106:107], v[18:19] op_sel:[1,0,0] op_sel_hi:[1,1,1]
    v_pk_fma_f32 v[20:21], v[134:135], v[108:109], v[20:21] op_sel:[1,0,0] op_sel_hi:[1,1,1]
    v_pk_fma_f32 v[22:23], v[134:135], v[110:111], v[22:23] op_sel:[1,0,0] op_sel_hi:[1,1,1]
    s_set_gpr_idx_off
    s_sub_u32 s32, s32, 1
    s_cbranch_scc1 MAIN_DONE
    v_mfma_f32_4x4x4_16b_bf16 v[124:127], v[172:173], v[178:179], 0 cbsz:4 abid:7
    v_lshlrev_b32_sdwa v136, v15, v114 dst_sel:DWORD dst_unused:UNUSED_PAD src0_sel:DWORD src1_sel:WORD_1
    s_waitcnt vmcnt(8)
    v_mfma_f32_4x4x4_16b_bf16 v[104:107], v[142:143], v[68:69], 0 cbsz:4 abid:6
    s_nop 0
    v_mfma_f32_4x4x4_16b_bf16 v[108:111], v[142:143], v[70:71], 0 cbsz:4 abid:6
    v_lshlrev_b32_sdwa v137, v15, v115 dst_sel:DWORD dst_unused:UNUSED_PAD src0_sel:DWORD src1_sel:WORD_1
    ds_read_u16_d16_hi v132, v136 offset:32768
    ds_read_u16_d16_hi v133, v137 offset:32768
    s_waitcnt lgkmcnt(2)
    s_set_gpr_idx_on s56, 0xc
    v_pk_fma_f32 v[16:17], v[128:129], v[96:97], v[16:17] op_sel:[0,0,0] op_sel_hi:[0,1,1]
    v_pk_fma_f32 v[18:19], v[128:129], v[98:99], v[18:19] op_sel:[0,0,0] op_sel_hi:[0,1,1]
    v_pk_fma_f32 v[20:21], v[130:131], v[100:101], v[20:21] op_sel:[0,0,0] op_sel_hi:[0,1,1]
    v_pk_fma_f32 v[22:23], v[130:131], v[102:103], v[22:23] op_sel:[0,0,0] op_sel_hi:[0,1,1]
    s_set_gpr_idx_off
    s_sub_u32 s32, s32, 1
    s_cbranch_scc1 MAIN_DONE
    v_lshlrev_b32_sdwa v138, v15, v118 dst_sel:DWORD dst_unused:UNUSED_PAD src0_sel:DWORD src1_sel:WORD_1
    v_mfma_f32_4x4x4_16b_bf16 v[96:99], v[144:145], v[72:73], 0 cbsz:4 abid:6
    s_nop 0
    v_mfma_f32_4x4x4_16b_bf16 v[100:103], v[144:145], v[74:75], 0 cbsz:4 abid:6
    v_lshlrev_b32_sdwa v139, v15, v119 dst_sel:DWORD dst_unused:UNUSED_PAD src0_sel:DWORD src1_sel:WORD_1
    ds_read_u16_d16_hi v134, v138 offset:32768
    ds_read_u16_d16_hi v135, v139 offset:32768
    s_set_gpr_idx_on s57, 0xc
    v_pk_fma_f32 v[16:17], v[128:129], v[104:105], v[16:17] op_sel:[1,0,0] op_sel_hi:[1,1,1]
    v_pk_fma_f32 v[18:19], v[128:129], v[106:107], v[18:19] op_sel:[1,0,0] op_sel_hi:[1,1,1]
    v_pk_fma_f32 v[20:21], v[130:131], v[108:109], v[20:21] op_sel:[1,0,0] op_sel_hi:[1,1,1]
    v_pk_fma_f32 v[22:23], v[130:131], v[110:111], v[22:23] op_sel:[1,0,0] op_sel_hi:[1,1,1]
    s_set_gpr_idx_off
    s_branch MAIN_DONE
B_24:
    buffer_load_dwordx4 v[188:191], v1, s[16:19], s10 offen offset:0 sc1
    buffer_load_dwordx4 v[192:195], v1, s[16:19], s10 offen offset:1024 sc1
    buffer_load_dwordx4 v[196:199], v1, s[16:19], s10 offen offset:2048 sc1
    buffer_load_dwordx4 v[200:203], v1, s[16:19], s10 offen offset:3072 sc1
    buffer_load_dwordx4 v[204:207], v1, s[16:19], s11 offen offset:0 sc1
    buffer_load_dwordx4 v[208:211], v1, s[16:19], s11 offen offset:1024 sc1
    buffer_load_dwordx4 v[212:215], v1, s[16:19], s11 offen offset:2048 sc1
    buffer_load_dwordx4 v[216:219], v1, s[16:19], s11 offen offset:3072 sc1
    s_sub_u32 s32, s32, 1
    s_cbranch_scc1 MAIN_DONE
    v_mfma_f32_4x4x4_16b_bf16 v[124:127], v[172:173], v[178:179], 0 cbsz:4 abid:7
    v_lshlrev_b32_sdwa v136, v15, v114 dst_sel:DWORD dst_unused:UNUSED_PAD src0_sel:DWORD src1_sel:WORD_1
    s_waitcnt vmcnt(12)
    v_mfma_f32_4x4x4_16b_bf16 v[104:107], v[142:143], v[68:69], 0 cbsz:4 abid:6
    s_nop 0
    v_mfma_f32_4x4x4_16b_bf16 v[108:111], v[142:143], v[70:71], 0 cbsz:4 abid:6
    v_lshlrev_b32_sdwa v137, v15, v115 dst_sel:DWORD dst_unused:UNUSED_PAD src0_sel:DWORD src1_sel:WORD_1
    ds_read_u16_d16_hi v132, v136 offset:32768
    ds_read_u16_d16_hi v133, v137 offset:32768
    s_waitcnt lgkmcnt(2)
    s_set_gpr_idx_on s56, 0xc
    v_pk_fma_f32 v[16:17], v[128:129], v[96:97], v[16:17] op_sel:[0,0,0] op_sel_hi:[0,1,1]
    v_pk_fma_f32 v[18:19], v[128:129], v[98:99], v[18:19] op_sel:[0,0,0] op_sel_hi:[0,1,1]
    v_pk_fma_f32 v[20:21], v[130:131], v[100:101], v[20:21] op_sel:[0,0,0] op_sel_hi:[0,1,1]
    v_pk_fma_f32 v[22:23], v[130:131], v[102:103], v[22:23] op_sel:[0,0,0] op_sel_hi:[0,1,1]
    s_set_gpr_idx_off
    s_sub_u32 s32, s32, 1
    s_cbranch_scc1 MAIN_DONE
    v_lshlrev_b32_sdwa v138, v15, v118 dst_sel:DWORD dst_unused:UNUSED_PAD src0_sel:DWORD src1_sel:WORD_1
    s_waitcnt vmcnt(11)
    v_mfma_f32_4x4x4_16b_bf16 v[96:99], v[144:145], v[72:73], 0 cbsz:4 abid:6
    s_nop 0
    v_mfma_f32_4x4x4_16b_bf16 v[100:103], v[144:145], v[74:75], 0 cbsz:4 abid:6
    v_lshlrev_b32_sdwa v139, v15, v119 dst_sel:DWORD dst_unused:UNUSED_PAD src0_sel:DWORD src1_sel:WORD_1
    ds_read_u16_d16_hi v134, v138 offset:32768
    ds_read_u16_d16_hi v135, v139 offset:32768
    s_set_gpr_idx_on s57, 0xc
    v_pk_fma_f32 v[16:17], v[128:129], v[104:105], v[16:17] op_sel:[1,0,0] op_sel_hi:[1,1,1]
    v_pk_fma_f32 v[18:19], v[128:129], v[106:107], v[18:19] op_sel:[1,0,0] op_sel_hi:[1,1,1]
    v_pk_fma_f32 v[20:21], v[130:131], v[108:109], v[20:21] op_sel:[1,0,0] op_sel_hi:[1,1,1]
    v_pk_fma_f32 v[22:23], v[130:131], v[110:111], v[22:23] op_sel:[1,0,0] op_sel_hi:[1,1,1]
    s_set_gpr_idx_off
    s_sub_u32 s32, s32, 1
    s_cbranch_scc1 MAIN_DONE
    v_mfma_f32_4x4x4_16b_bf16 v[112:115], v[172:173], v[176:177], 0 cbsz:4 abid:8
    v_lshlrev_b32_sdwa v136, v15, v120 dst_sel:DWORD dst_unused:UNUSED_PAD src0_sel:DWORD src1_sel:WORD_1
    s_waitcnt vmcnt(10)
    v_mfma_f32_4x4x4_16b_bf16 v[104:107], v[146:147], v[76:77], 0 cbsz:4 abid:6
    s_nop 0
    v_mfma_f32_4x4x4_16b_bf16 v[108:111], v[146:147], v[78:79], 0 cbsz:4 abid:6
    v_lshlrev_b32_sdwa v137, v15, v121 dst_sel:DWORD dst_unused:UNUSED_PAD src0_sel:DWORD src1_sel:WORD_1
    ds_read_u16_d16_hi v128, v136 offset:32768
    ds_read_u16_d16_hi v129, v137 offset:32768
    s_waitcnt lgkmcnt(2)
    s_set_gpr_idx_on s58, 0xc
    v_pk_fma_f32 v[16:17], v[132:133], v[96:97], v[16:17] op_sel:[0,0,0] op_sel_hi:[0,1,1]
    v_pk_fma_f32 v[18:19], v[132:133], v[98:99], v[18:19] op_sel:[0,0,0] op_sel_hi:[0,1,1]
    v_pk_fma_f32 v[20:21], v[134:135], v[100:101], v[20:21] op_sel:[0,0,0] op_sel_hi:[0,1,1]
    v_pk_fma_f32 v[22:23], v[134:135], v[102:103], v[22:23] op_sel:[0,0,0] op_sel_hi:[0,1,1]
    s_set_gpr_idx_off
    s_sub_u32 s32, s32, 1
    s_cbranch_scc1 MAIN_DONE
    v_lshlrev_b32_sdwa v138, v15, v124 dst_sel:DWORD dst_unused:UNUSED_PAD src0_sel:DWORD src1_sel:WORD_1
    s_waitcnt vmcnt(9)
    v_mfma_f32_4x4x4_16b_bf16 v[96:99], v[140:141], v[80:81], 0 cbsz:4 abid:7
    s_nop 0
    v_mfma_f32_4x4x4_16b_bf16 v[100:103], v[140:141], v[82:83], 0 cbsz:4 abid:7
    v_lshlrev_b32_sdwa v139, v15, v125 dst_sel:DWORD dst_unused:UNUSED_PAD src0_sel:DWORD src1_sel:WORD_1
    ds_read_u16_d16_hi v130, v138 offset:32768
    ds_read_u16_d16_hi v131, v139 offset:32768
    s_set_gpr_idx_on s59, 0xc
    v_pk_fma_f32 v[16:17], v[132:133], v[104:105], v[16:17] op_sel:[1,0,0] op_sel_hi:[1,1,1]
    v_pk_fma_f32 v[18:19], v[132:133], v[106:107], v[18:19] op_sel:[1,0,0] op_sel_hi:[1,1,1]
    v_pk_fma_f32 v[20:21], v[134:135], v[108:109], v[20:21] op_sel:[1,0,0] op_sel_hi:[1,1,1]
    v_pk_fma_f32 v[22:23], v[134:135], v[110:111], v[22:23] op_sel:[1,0,0] op_sel_hi:[1,1,1]
    s_set_gpr_idx_off
    s_sub_u32 s32, s32, 1
    s_cbranch_scc1 MAIN_DONE
    v_mfma_f32_4x4x4_16b_bf16 v[116:119], v[172:173], v[178:179], 0 cbsz:4 abid:8
    v_lshlrev_b32_sdwa v136, v15, v122 dst_sel:DWORD dst_unused:UNUSED_PAD src0_sel:DWORD src1_sel:WORD_1
    s_waitcnt vmcnt(8)
    v_mfma_f32_4x4x4_16b_bf16 v[104:107], v[142:143], v[84:85], 0 cbsz:4 abid:7
    s_nop 0
    v_mfma_f32_4x4x4_16b_bf16 v[108:111], v[142:143], v[86:87], 0 cbsz:4 abid:7
    v_lshlrev_b32_sdwa v137, v15, v123 dst_sel:DWORD dst_unused:UNUSED_PAD src0_sel:DWORD src1_sel:WORD_1
    ds_read_u16_d16_hi v132, v136 offset:32768
    ds_read_u16_d16_hi v133, v137 offset:32768
    s_waitcnt lgkmcnt(2)
    s_set_gpr_idx_on s60, 0xc
    v_pk_fma_f32 v[16:17], v[128:129], v[96:97], v[16:17] op_sel:[0,0,0] op_sel_hi:[0,1,1]
    v_pk_fma_f32 v[18:19], v[128:129], v[98:99], v[18:19] op_sel:[0,0,0] op_sel_hi:[0,1,1]
    v_pk_fma_f32 v[20:21], v[130:131], v[100:101], v[20:21] op_sel:[0,0,0] op_sel_hi:[0,1,1]
    v_pk_fma_f32 v[22:23], v[130:131], v[102:103], v[22:23] op_sel:[0,0,0] op_sel_hi:[0,1,1]
    s_set_gpr_idx_off
    s_sub_u32 s32, s32, 1
    s_cbranch_scc1 MAIN_DONE
    v_lshlrev_b32_sdwa v138, v15, v126 dst_sel:DWORD dst_unused:UNUSED_PAD src0_sel:DWORD src1_sel:WORD_1
    v_mfma_f32_4x4x4_16b_bf16 v[96:99], v[144:145], v[88:89], 0 cbsz:4 abid:7
    s_nop 0
    v_mfma_f32_4x4x4_16b_bf16 v[100:103], v[144:145], v[90:91], 0 cbsz:4 abid:7
    v_lshlrev_b32_sdwa v139, v15, v127 dst_sel:DWORD dst_unused:UNUSED_PAD src0_sel:DWORD src1_sel:WORD_1
    ds_read_u16_d16_hi v134, v138 offset:32768
    ds_read_u16_d16_hi v135, v139 offset:32768
    s_set_gpr_idx_on s61, 0xc
    v_pk_fma_f32 v[16:17], v[128:129], v[104:105], v[16:17] op_sel:[1,0,0] op_sel_hi:[1,1,1]
    v_pk_fma_f32 v[18:19], v[128:129], v[106:107], v[18:19] op_sel:[1,0,0] op_sel_hi:[1,1,1]
    v_pk_fma_f32 v[20:21], v[130:131], v[108:109], v[20:21] op_sel:[1,0,0] op_sel_hi:[1,1,1]
    v_pk_fma_f32 v[22:23], v[130:131], v[110:111], v[22:23] op_sel:[1,0,0] op_sel_hi:[1,1,1]
    s_set_gpr_idx_off
    s_branch MAIN_DONE
B_28:
    buffer_load_dwordx4 v[188:191], v1, s[16:19], s10 offen offset:0 sc1
    buffer_load_dwordx4 v[192:195], v1, s[16:19], s10 offen offset:1024 sc1
    buffer_load_dwordx4 v[196:199], v1, s[16:19], s10 offen offset:2048 sc1
    buffer_load_dwordx4 v[200:203], v1, s[16:19], s10 offen offset:3072 sc1
    buffer_load_dwordx4 v[204:207], v1, s[16:19], s11 offen offset:0 sc1
    buffer_load_dwordx4 v[208:211], v1, s[16:19], s11 offen offset:1024 sc1
    buffer_load_dwordx4 v[212:215], v1, s[16:19], s11 offen offset:2048 sc1
    buffer_load_dwordx4 v[216:219], v1, s[16:19], s11 offen offset:3072 sc1
    s_sub_u32 s32, s32, 1
    s_cbranch_scc1 MAIN_DONE
    v_mfma_f32_4x4x4_16b_bf16 v[116:119], v[172:173], v[178:179], 0 cbsz:4 abid:8
    v_lshlrev_b32_sdwa v136, v15, v122 dst_sel:DWORD dst_unused:UNUSED_PAD src0_sel:DWORD src1_sel:WORD_1
    s_waitcnt vmcnt(12)
    v_mfma_f32_4x4x4_16b_bf16 v[104:107], v[142:143], v[84:85], 0 cbsz:4 abid:7
    s_nop 0
    v_mfma_f32_4x4x4_16b_bf16 v[108:111], v[142:143], v[86:87], 0 cbsz:4 abid:7
    v_lshlrev_b32_sdwa v137, v15, v123 dst_sel:DWORD dst_unused:UNUSED_PAD src0_sel:DWORD src1_sel:WORD_1
    ds_read_u16_d16_hi v132, v136 offset:32768
    ds_read_u16_d16_hi v133, v137 offset:32768
    s_waitcnt lgkmcnt(2)
    s_set_gpr_idx_on s60, 0xc
    v_pk_fma_f32 v[16:17], v[128:129], v[96:97], v[16:17] op_sel:[0,0,0] op_sel_hi:[0,1,1]
    v_pk_fma_f32 v[18:19], v[128:129], v[98:99], v[18:19] op_sel:[0,0,0] op_sel_hi:[0,1,1]
    v_pk_fma_f32 v[20:21], v[130:131], v[100:101], v[20:21] op_sel:[0,0,0] op_sel_hi:[0,1,1]
    v_pk_fma_f32 v[22:23], v[130:131], v[102:103], v[22:23] op_sel:[0,0,0] op_sel_hi:[0,1,1]
    s_set_gpr_idx_off
    s_sub_u32 s32, s32, 1
    s_cbranch_scc1 MAIN_DONE
    v_lshlrev_b32_sdwa v138, v15, v126 dst_sel:DWORD dst_unused:UNUSED_PAD src0_sel:DWORD src1_sel:WORD_1
    s_waitcnt vmcnt(11)
    v_mfma_f32_4x4x4_16b_bf16 v[96:99], v[144:145], v[88:89], 0 cbsz:4 abid:7
    s_nop 0
    v_mfma_f32_4x4x4_16b_bf16 v[100:103], v[144:145], v[90:91], 0 cbsz:4 abid:7
    v_lshlrev_b32_sdwa v139, v15, v127 dst_sel:DWORD dst_unused:UNUSED_PAD src0_sel:DWORD src1_sel:WORD_1
    ds_read_u16_d16_hi v134, v138 offset:32768
    ds_read_u16_d16_hi v135, v139 offset:32768
    s_set_gpr_idx_on s61, 0xc
    v_pk_fma_f32 v[16:17], v[128:129], v[104:105], v[16:17] op_sel:[1,0,0] op_sel_hi:[1,1,1]
    v_pk_fma_f32 v[18:19], v[128:129], v[106:107], v[18:19] op_sel:[1,0,0] op_sel_hi:[1,1,1]
    v_pk_fma_f32 v[20:21], v[130:131], v[108:109], v[20:21] op_sel:[1,0,0] op_sel_hi:[1,1,1]
    v_pk_fma_f32 v[22:23], v[130:131], v[110:111], v[22:23] op_sel:[1,0,0] op_sel_hi:[1,1,1]
    s_set_gpr_idx_off
    s_sub_u32 s32, s32, 1
    s_cbranch_scc1 MAIN_DONE
    v_mfma_f32_4x4x4_16b_bf16 v[120:123], v[172:173], v[176:177], 0 cbsz:4 abid:9
    v_lshlrev_b32_sdwa v136, v15, v112 dst_sel:DWORD dst_unused:UNUSED_PAD src0_sel:DWORD src1_sel:WORD_1
    s_waitcnt vmcnt(10)
    v_mfma_f32_4x4x4_16b_bf16 v[104:107], v[146:147], v[92:93], 0 cbsz:4 abid:7
    s_nop 0
    v_mfma_f32_4x4x4_16b_bf16 v[108:111], v[146:147], v[94:95], 0 cbsz:4 abid:7
    v_lshlrev_b32_sdwa v137, v15, v113 dst_sel:DWORD dst_unused:UNUSED_PAD src0_sel:DWORD src1_sel:WORD_1
    ds_read_u16_d16_hi v128, v136 offset:32768
    ds_read_u16_d16_hi v129, v137 offset:32768
    s_waitcnt lgkmcnt(2)
    s_set_gpr_idx_on s62, 0xc
    v_pk_fma_f32 v[16:17], v[132:133], v[96:97], v[16:17] op_sel:[0,0,0] op_sel_hi:[0,1,1]
    v_pk_fma_f32 v[18:19], v[132:133], v[98:99], v[18:19] op_sel:[0,0,0] op_sel_hi:[0,1,1]
    v_pk_fma_f32 v[20:21], v[134:135], v[100:101], v[20:21] op_sel:[0,0,0] op_sel_hi:[0,1,1]
    v_pk_fma_f32 v[22:23], v[134:135], v[102:103], v[22:23] op_sel:[0,0,0] op_sel_hi:[0,1,1]
    s_set_gpr_idx_off
    s_sub_u32 s32, s32, 1
    s_cbranch_scc1 MAIN_DONE
    v_lshlrev_b32_sdwa v138, v15, v116 dst_sel:DWORD dst_unused:UNUSED_PAD src0_sel:DWORD src1_sel:WORD_1
    s_waitcnt vmcnt(9)
    v_mfma_f32_4x4x4_16b_bf16 v[96:99], v[140:141], v[64:65], 0 cbsz:4 abid:8
    s_nop 0
    v_mfma_f32_4x4x4_16b_bf16 v[100:103], v[140:141], v[66:67], 0 cbsz:4 abid:8
    v_lshlrev_b32_sdwa v139, v15, v117 dst_sel:DWORD dst_unused:UNUSED_PAD src0_sel:DWORD src1_sel:WORD_1
    ds_read_u16_d16_hi v130, v138 offset:32768
    ds_read_u16_d16_hi v131, v139 offset:32768
    s_set_gpr_idx_on s63, 0xc
    v_pk_fma_f32 v[16:17], v[132:133], v[104:105], v[16:17] op_sel:[1,0,0] op_sel_hi:[1,1,1]
    v_pk_fma_f32 v[18:19], v[132:133], v[106:107], v[18:19] op_sel:[1,0,0] op_sel_hi:[1,1,1]
    v_pk_fma_f32 v[20:21], v[134:135], v[108:109], v[20:21] op_sel:[1,0,0] op_sel_hi:[1,1,1]
    v_pk_fma_f32 v[22:23], v[134:135], v[110:111], v[22:23] op_sel:[1,0,0] op_sel_hi:[1,1,1]
    s_set_gpr_idx_off
    s_sub_u32 s32, s32, 1
    s_cbranch_scc1 MAIN_DONE
    v_mfma_f32_4x4x4_16b_bf16 v[124:127], v[172:173], v[178:179], 0 cbsz:4 abid:9
    v_lshlrev_b32_sdwa v136, v15, v114 dst_sel:DWORD dst_unused:UNUSED_PAD src0_sel:DWORD src1_sel:WORD_1
    s_waitcnt vmcnt(8)
    v_mfma_f32_4x4x4_16b_bf16 v[104:107], v[142:143], v[68:69], 0 cbsz:4 abid:8
    s_nop 0
    v_mfma_f32_4x4x4_16b_bf16 v[108:111], v[142:143], v[70:71], 0 cbsz:4 abid:8
    v_lshlrev_b32_sdwa v137, v15, v115 dst_sel:DWORD dst_unused:UNUSED_PAD src0_sel:DWORD src1_sel:WORD_1
    ds_read_u16_d16_hi v132, v136 offset:32768
    ds_read_u16_d16_hi v133, v137 offset:32768
    s_waitcnt lgkmcnt(2)
    s_set_gpr_idx_on s48, 0xc
    v_pk_fma_f32 v[16:17], v[128:129], v[96:97], v[16:17] op_sel:[0,0,0] op_sel_hi:[0,1,1]
    v_pk_fma_f32 v[18:19], v[128:129], v[98:99], v[18:19] op_sel:[0,0,0] op_sel_hi:[0,1,1]
    v_pk_fma_f32 v[20:21], v[130:131], v[100:101], v[20:21] op_sel:[0,0,0] op_sel_hi:[0,1,1]
    v_pk_fma_f32 v[22:23], v[130:131], v[102:103], v[22:23] op_sel:[0,0,0] op_sel_hi:[0,1,1]
    s_set_gpr_idx_off
    s_sub_u32 s32, s32, 1
    s_cbranch_scc1 MAIN_DONE
    v_lshlrev_b32_sdwa v138, v15, v118 dst_sel:DWORD dst_unused:UNUSED_PAD src0_sel:DWORD src1_sel:WORD_1
    v_mfma_f32_4x4x4_16b_bf16 v[96:99], v[144:145], v[72:73], 0 cbsz:4 abid:8
    s_nop 0
    v_mfma_f32_4x4x4_16b_bf16 v[100:103], v[144:145], v[74:75], 0 cbsz:4 abid:8
    v_lshlrev_b32_sdwa v139, v15, v119 dst_sel:DWORD dst_unused:UNUSED_PAD src0_sel:DWORD src1_sel:WORD_1
    ds_read_u16_d16_hi v134, v138 offset:32768
    ds_read_u16_d16_hi v135, v139 offset:32768
    s_set_gpr_idx_on s49, 0xc
    v_pk_fma_f32 v[16:17], v[128:129], v[104:105], v[16:17] op_sel:[1,0,0] op_sel_hi:[1,1,1]
    v_pk_fma_f32 v[18:19], v[128:129], v[106:107], v[18:19] op_sel:[1,0,0] op_sel_hi:[1,1,1]
    v_pk_fma_f32 v[20:21], v[130:131], v[108:109], v[20:21] op_sel:[1,0,0] op_sel_hi:[1,1,1]
    v_pk_fma_f32 v[22:23], v[130:131], v[110:111], v[22:23] op_sel:[1,0,0] op_sel_hi:[1,1,1]
    s_set_gpr_idx_off
    s_branch MAIN_DONE
B_32:
    buffer_load_dwordx4 v[188:191], v1, s[16:19], s10 offen offset:0 sc1
    buffer_load_dwordx4 v[192:195], v1, s[16:19], s10 offen offset:1024 sc1
    buffer_load_dwordx4 v[196:199], v1, s[16:19], s10 offen offset:2048 sc1
    buffer_load_dwordx4 v[200:203], v1, s[16:19], s10 offen offset:3072 sc1
    buffer_load_dwordx4 v[204:207], v1, s[16:19], s11 offen offset:0 sc1
    buffer_load_dwordx4 v[208:211], v1, s[16:19], s11 offen offset:1024 sc1
    buffer_load_dwordx4 v[212:215], v1, s[16:19], s11 offen offset:2048 sc1
    buffer_load_dwordx4 v[216:219], v1, s[16:19], s11 offen offset:3072 sc1
    s_sub_u32 s32, s32, 1
    s_cbranch_scc1 MAIN_DONE
    v_mfma_f32_4x4x4_16b_bf16 v[124:127], v[172:173], v[178:179], 0 cbsz:4 abid:9
    v_lshlrev_b32_sdwa v136, v15, v114 dst_sel:DWORD dst_unused:UNUSED_PAD src0_sel:DWORD src1_sel:WORD_1
    s_waitcnt vmcnt(12)
    v_mfma_f32_4x4x4_16b_bf16 v[104:107], v[142:143], v[68:69], 0 cbsz:4 abid:8
    s_nop 0
    v_mfma_f32_4x4x4_16b_bf16 v[108:111], v[142:143], v[70:71], 0 cbsz:4 abid:8
    v_lshlrev_b32_sdwa v137, v15, v115 dst_sel:DWORD dst_unused:UNUSED_PAD src0_sel:DWORD src1_sel:WORD_1
    ds_read_u16_d16_hi v132, v136 offset:32768
    ds_read_u16_d16_hi v133, v137 offset:32768
    s_waitcnt lgkmcnt(2)
    s_set_gpr_idx_on s48, 0xc
    v_pk_fma_f32 v[16:17], v[128:129], v[96:97], v[16:17] op_sel:[0,0,0] op_sel_hi:[0,1,1]
    v_pk_fma_f32 v[18:19], v[128:129], v[98:99], v[18:19] op_sel:[0,0,0] op_sel_hi:[0,1,1]
    v_pk_fma_f32 v[20:21], v[130:131], v[100:101], v[20:21] op_sel:[0,0,0] op_sel_hi:[0,1,1]
    v_pk_fma_f32 v[22:23], v[130:131], v[102:103], v[22:23] op_sel:[0,0,0] op_sel_hi:[0,1,1]
    s_set_gpr_idx_off
    s_sub_u32 s32, s32, 1
    s_cbranch_scc1 MAIN_DONE
    v_lshlrev_b32_sdwa v138, v15, v118 dst_sel:DWORD dst_unused:UNUSED_PAD src0_sel:DWORD src1_sel:WORD_1
    s_waitcnt vmcnt(11)
    v_mfma_f32_4x4x4_16b_bf16 v[96:99], v[144:145], v[72:73], 0 cbsz:4 abid:8
    s_nop 0
    v_mfma_f32_4x4x4_16b_bf16 v[100:103], v[144:145], v[74:75], 0 cbsz:4 abid:8
    v_lshlrev_b32_sdwa v139, v15, v119 dst_sel:DWORD dst_unused:UNUSED_PAD src0_sel:DWORD src1_sel:WORD_1
    ds_read_u16_d16_hi v134, v138 offset:32768
    ds_read_u16_d16_hi v135, v139 offset:32768
    s_set_gpr_idx_on s49, 0xc
    v_pk_fma_f32 v[16:17], v[128:129], v[104:105], v[16:17] op_sel:[1,0,0] op_sel_hi:[1,1,1]
    v_pk_fma_f32 v[18:19], v[128:129], v[106:107], v[18:19] op_sel:[1,0,0] op_sel_hi:[1,1,1]
    v_pk_fma_f32 v[20:21], v[130:131], v[108:109], v[20:21] op_sel:[1,0,0] op_sel_hi:[1,1,1]
    v_pk_fma_f32 v[22:23], v[130:131], v[110:111], v[22:23] op_sel:[1,0,0] op_sel_hi:[1,1,1]
    s_set_gpr_idx_off
    s_sub_u32 s32, s32, 1
    s_cbranch_scc1 MAIN_DONE
    v_mfma_f32_4x4x4_16b_bf16 v[112:115], v[172:173], v[176:177], 0 cbsz:4 abid:10
    v_lshlrev_b32_sdwa v136, v15, v120 dst_sel:DWORD dst_unused:UNUSED_PAD src0_sel:DWORD src1_sel:WORD_1
    s_waitcnt vmcnt(10)
    v_mfma_f32_4x4x4_16b_bf16 v[104:107], v[146:147], v[76:77], 0 cbsz:4 abid:8
    s_nop 0
    v_mfma_f32_4x4x4_16b_bf16 v[108:111], v[146:147], v[78:79], 0 cbsz:4 abid:8
    v_lshlrev_b32_sdwa v137, v15, v121 dst_sel:DWORD dst_unused:UNUSED_PAD src0_sel:DWORD src1_sel:WORD_1
    ds_read_u16_d16_hi v128, v136 offset:32768
    ds_read_u16_d16_hi v129, v137 offset:32768
    s_waitcnt lgkmcnt(2)
    s_set_gpr_idx_on s50, 0xc
    v_pk_fma_f32 v[16:17], v[132:133], v[96:97], v[16:17] op_sel:[0,0,0] op_sel_hi:[0,1,1]
    v_pk_fma_f32 v[18:19], v[132:133], v[98:99], v[18:19] op_sel:[0,0,0] op_sel_hi:[0,1,1]
    v_pk_fma_f32 v[20:21], v[134:135], v[100:101], v[20:21] op_sel:[0,0,0] op_sel_hi:[0,1,1]
    v_pk_fma_f32 v[22:23], v[134:135], v[102:103], v[22:23] op_sel:[0,0,0] op_sel_hi:[0,1,1]
    s_set_gpr_idx_off
    s_sub_u32 s32, s32, 1
    s_cbranch_scc1 MAIN_DONE
    v_lshlrev_b32_sdwa v138, v15, v124 dst_sel:DWORD dst_unused:UNUSED_PAD src0_sel:DWORD src1_sel:WORD_1
    s_waitcnt vmcnt(9)
    v_mfma_f32_4x4x4_16b_bf16 v[96:99], v[140:141], v[80:81], 0 cbsz:4 abid:9
    s_nop 0
    v_mfma_f32_4x4x4_16b_bf16 v[100:103], v[140:141], v[82:83], 0 cbsz:4 abid:9
    v_lshlrev_b32_sdwa v139, v15, v125 dst_sel:DWORD dst_unused:UNUSED_PAD src0_sel:DWORD src1_sel:WORD_1
    ds_read_u16_d16_hi v130, v138 offset:32768
    ds_read_u16_d16_hi v131, v139 offset:32768
    s_set_gpr_idx_on s51, 0xc
    v_pk_fma_f32 v[16:17], v[132:133], v[104:105], v[16:17] op_sel:[1,0,0] op_sel_hi:[1,1,1]
    v_pk_fma_f32 v[18:19], v[132:133], v[106:107], v[18:19] op_sel:[1,0,0] op_sel_hi:[1,1,1]
    v_pk_fma_f32 v[20:21], v[134:135], v[108:109], v[20:21] op_sel:[1,0,0] op_sel_hi:[1,1,1]
    v_pk_fma_f32 v[22:23], v[134:135], v[110:111], v[22:23] op_sel:[1,0,0] op_sel_hi:[1,1,1]
    s_set_gpr_idx_off
    s_sub_u32 s32, s32, 1
    s_cbranch_scc1 MAIN_DONE
    v_mfma_f32_4x4x4_16b_bf16 v[116:119], v[172:173], v[178:179], 0 cbsz:4 abid:10
    v_lshlrev_b32_sdwa v136, v15, v122 dst_sel:DWORD dst_unused:UNUSED_PAD src0_sel:DWORD src1_sel:WORD_1
    s_waitcnt vmcnt(8)
    v_mfma_f32_4x4x4_16b_bf16 v[104:107], v[142:143], v[84:85], 0 cbsz:4 abid:9
    s_nop 0
    v_mfma_f32_4x4x4_16b_bf16 v[108:111], v[142:143], v[86:87], 0 cbsz:4 abid:9
    v_lshlrev_b32_sdwa v137, v15, v123 dst_sel:DWORD dst_unused:UNUSED_PAD src0_sel:DWORD src1_sel:WORD_1
    ds_read_u16_d16_hi v132, v136 offset:32768
    ds_read_u16_d16_hi v133, v137 offset:32768
    s_waitcnt lgkmcnt(2)
    s_set_gpr_idx_on s52, 0xc
    v_pk_fma_f32 v[16:17], v[128:129], v[96:97], v[16:17] op_sel:[0,0,0] op_sel_hi:[0,1,1]
    v_pk_fma_f32 v[18:19], v[128:129], v[98:99], v[18:19] op_sel:[0,0,0] op_sel_hi:[0,1,1]
    v_pk_fma_f32 v[20:21], v[130:131], v[100:101], v[20:21] op_sel:[0,0,0] op_sel_hi:[0,1,1]
    v_pk_fma_f32 v[22:23], v[130:131], v[102:103], v[22:23] op_sel:[0,0,0] op_sel_hi:[0,1,1]
    s_set_gpr_idx_off
    s_sub_u32 s32, s32, 1
    s_cbranch_scc1 MAIN_DONE
    v_lshlrev_b32_sdwa v138, v15, v126 dst_sel:DWORD dst_unused:UNUSED_PAD src0_sel:DWORD src1_sel:WORD_1
    v_mfma_f32_4x4x4_16b_bf16 v[96:99], v[144:145], v[88:89], 0 cbsz:4 abid:9
    s_nop 0
    v_mfma_f32_4x4x4_16b_bf16 v[100:103], v[144:145], v[90:91], 0 cbsz:4 abid:9
    v_lshlrev_b32_sdwa v139, v15, v127 dst_sel:DWORD dst_unused:UNUSED_PAD src0_sel:DWORD src1_sel:WORD_1
    ds_read_u16_d16_hi v134, v138 offset:32768
    ds_read_u16_d16_hi v135, v139 offset:32768
    s_set_gpr_idx_on s53, 0xc
    v_pk_fma_f32 v[16:17], v[128:129], v[104:105], v[16:17] op_sel:[1,0,0] op_sel_hi:[1,1,1]
    v_pk_fma_f32 v[18:19], v[128:129], v[106:107], v[18:19] op_sel:[1,0,0] op_sel_hi:[1,1,1]
    v_pk_fma_f32 v[20:21], v[130:131], v[108:109], v[20:21] op_sel:[1,0,0] op_sel_hi:[1,1,1]
    v_pk_fma_f32 v[22:23], v[130:131], v[110:111], v[22:23] op_sel:[1,0,0] op_sel_hi:[1,1,1]
    s_set_gpr_idx_off
    s_branch MAIN_DONE
B_36:
    buffer_load_dwordx4 v[188:191], v1, s[16:19], s10 offen offset:0 sc1
    buffer_load_dwordx4 v[192:195], v1, s[16:19], s10 offen offset:1024 sc1
    buffer_load_dwordx4 v[196:199], v1, s[16:19], s10 offen offset:2048 sc1
    buffer_load_dwordx4 v[200:203], v1, s[16:19], s10 offen offset:3072 sc1
    buffer_load_dwordx4 v[204:207], v1, s[16:19], s11 offen offset:0 sc1
    buffer_load_dwordx4 v[208:211], v1, s[16:19], s11 offen offset:1024 sc1
    buffer_load_dwordx4 v[212:215], v1, s[16:19], s11 offen offset:2048 sc1
    buffer_load_dwordx4 v[216:219], v1, s[16:19], s11 offen offset:3072 sc1
    s_sub_u32 s32, s32, 1
    s_cbranch_scc1 MAIN_DONE
    v_mfma_f32_4x4x4_16b_bf16 v[116:119], v[172:173], v[178:179], 0 cbsz:4 abid:10
    v_lshlrev_b32_sdwa v136, v15, v122 dst_sel:DWORD dst_unused:UNUSED_PAD src0_sel:DWORD src1_sel:WORD_1
    s_waitcnt vmcnt(12)
    v_mfma_f32_4x4x4_16b_bf16 v[104:107], v[142:143], v[84:85], 0 cbsz:4 abid:9
    s_nop 0
    v_mfma_f32_4x4x4_16b_bf16 v[108:111], v[142:143], v[86:87], 0 cbsz:4 abid:9
    v_lshlrev_b32_sdwa v137, v15, v123 dst_sel:DWORD dst_unused:UNUSED_PAD src0_sel:DWORD src1_sel:WORD_1
    ds_read_u16_d16_hi v132, v136 offset:32768
    ds_read_u16_d16_hi v133, v137 offset:32768
    s_waitcnt lgkmcnt(2)
    s_set_gpr_idx_on s52, 0xc
    v_pk_fma_f32 v[16:17], v[128:129], v[96:97], v[16:17] op_sel:[0,0,0] op_sel_hi:[0,1,1]
    v_pk_fma_f32 v[18:19], v[128:129], v[98:99], v[18:19] op_sel:[0,0,0] op_sel_hi:[0,1,1]
    v_pk_fma_f32 v[20:21], v[130:131], v[100:101], v[20:21] op_sel:[0,0,0] op_sel_hi:[0,1,1]
    v_pk_fma_f32 v[22:23], v[130:131], v[102:103], v[22:23] op_sel:[0,0,0] op_sel_hi:[0,1,1]
    s_set_gpr_idx_off
    s_sub_u32 s32, s32, 1
    s_cbranch_scc1 MAIN_DONE
    v_lshlrev_b32_sdwa v138, v15, v126 dst_sel:DWORD dst_unused:UNUSED_PAD src0_sel:DWORD src1_sel:WORD_1
    s_waitcnt vmcnt(11)
    v_mfma_f32_4x4x4_16b_bf16 v[96:99], v[144:145], v[88:89], 0 cbsz:4 abid:9
    s_nop 0
    v_mfma_f32_4x4x4_16b_bf16 v[100:103], v[144:145], v[90:91], 0 cbsz:4 abid:9
    v_lshlrev_b32_sdwa v139, v15, v127 dst_sel:DWORD dst_unused:UNUSED_PAD src0_sel:DWORD src1_sel:WORD_1
    ds_read_u16_d16_hi v134, v138 offset:32768
    ds_read_u16_d16_hi v135, v139 offset:32768
    s_set_gpr_idx_on s53, 0xc
    v_pk_fma_f32 v[16:17], v[128:129], v[104:105], v[16:17] op_sel:[1,0,0] op_sel_hi:[1,1,1]
    v_pk_fma_f32 v[18:19], v[128:129], v[106:107], v[18:19] op_sel:[1,0,0] op_sel_hi:[1,1,1]
    v_pk_fma_f32 v[20:21], v[130:131], v[108:109], v[20:21] op_sel:[1,0,0] op_sel_hi:[1,1,1]
    v_pk_fma_f32 v[22:23], v[130:131], v[110:111], v[22:23] op_sel:[1,0,0] op_sel_hi:[1,1,1]
    s_set_gpr_idx_off
    s_sub_u32 s32, s32, 1
    s_cbranch_scc1 MAIN_DONE
    v_mfma_f32_4x4x4_16b_bf16 v[120:123], v[172:173], v[176:177], 0 cbsz:4 abid:11
    v_lshlrev_b32_sdwa v136, v15, v112 dst_sel:DWORD dst_unused:UNUSED_PAD src0_sel:DWORD src1_sel:WORD_1
    s_waitcnt vmcnt(10)
    v_mfma_f32_4x4x4_16b_bf16 v[104:107], v[146:147], v[92:93], 0 cbsz:4 abid:9
    s_nop 0
    v_mfma_f32_4x4x4_16b_bf16 v[108:111], v[146:147], v[94:95], 0 cbsz:4 abid:9
    v_lshlrev_b32_sdwa v137, v15, v113 dst_sel:DWORD dst_unused:UNUSED_PAD src0_sel:DWORD src1_sel:WORD_1
    ds_read_u16_d16_hi v128, v136 offset:32768
    ds_read_u16_d16_hi v129, v137 offset:32768
    s_waitcnt lgkmcnt(2)
    s_set_gpr_idx_on s54, 0xc
    v_pk_fma_f32 v[16:17], v[132:133], v[96:97], v[16:17] op_sel:[0,0,0] op_sel_hi:[0,1,1]
    v_pk_fma_f32 v[18:19], v[132:133], v[98:99], v[18:19] op_sel:[0,0,0] op_sel_hi:[0,1,1]
    v_pk_fma_f32 v[20:21], v[134:135], v[100:101], v[20:21] op_sel:[0,0,0] op_sel_hi:[0,1,1]
    v_pk_fma_f32 v[22:23], v[134:135], v[102:103], v[22:23] op_sel:[0,0,0] op_sel_hi:[0,1,1]
    s_set_gpr_idx_off
    s_sub_u32 s32, s32, 1
    s_cbranch_scc1 MAIN_DONE
    v_lshlrev_b32_sdwa v138, v15, v116 dst_sel:DWORD dst_unused:UNUSED_PAD src0_sel:DWORD src1_sel:WORD_1
    s_waitcnt vmcnt(9)
    v_mfma_f32_4x4x4_16b_bf16 v[96:99], v[140:141], v[64:65], 0 cbsz:4 abid:10
    s_nop 0
    v_mfma_f32_4x4x4_16b_bf16 v[100:103], v[140:141], v[66:67], 0 cbsz:4 abid:10
    v_lshlrev_b32_sdwa v139, v15, v117 dst_sel:DWORD dst_unused:UNUSED_PAD src0_sel:DWORD src1_sel:WORD_1
    ds_read_u16_d16_hi v130, v138 offset:32768
    ds_read_u16_d16_hi v131, v139 offset:32768
    s_set_gpr_idx_on s55, 0xc
    v_pk_fma_f32 v[16:17], v[132:133], v[104:105], v[16:17] op_sel:[1,0,0] op_sel_hi:[1,1,1]
    v_pk_fma_f32 v[18:19], v[132:133], v[106:107], v[18:19] op_sel:[1,0,0] op_sel_hi:[1,1,1]
    v_pk_fma_f32 v[20:21], v[134:135], v[108:109], v[20:21] op_sel:[1,0,0] op_sel_hi:[1,1,1]
    v_pk_fma_f32 v[22:23], v[134:135], v[110:111], v[22:23] op_sel:[1,0,0] op_sel_hi:[1,1,1]
    s_set_gpr_idx_off
    s_sub_u32 s32, s32, 1
    s_cbranch_scc1 MAIN_DONE
    v_mfma_f32_4x4x4_16b_bf16 v[124:127], v[172:173], v[178:179], 0 cbsz:4 abid:11
    v_lshlrev_b32_sdwa v136, v15, v114 dst_sel:DWORD dst_unused:UNUSED_PAD src0_sel:DWORD src1_sel:WORD_1
    s_waitcnt vmcnt(8)
    v_mfma_f32_4x4x4_16b_bf16 v[104:107], v[142:143], v[68:69], 0 cbsz:4 abid:10
    s_nop 0
    v_mfma_f32_4x4x4_16b_bf16 v[108:111], v[142:143], v[70:71], 0 cbsz:4 abid:10
    v_lshlrev_b32_sdwa v137, v15, v115 dst_sel:DWORD dst_unused:UNUSED_PAD src0_sel:DWORD src1_sel:WORD_1
    ds_read_u16_d16_hi v132, v136 offset:32768
    ds_read_u16_d16_hi v133, v137 offset:32768
    s_waitcnt lgkmcnt(2)
    s_set_gpr_idx_on s56, 0xc
    v_pk_fma_f32 v[16:17], v[128:129], v[96:97], v[16:17] op_sel:[0,0,0] op_sel_hi:[0,1,1]
    v_pk_fma_f32 v[18:19], v[128:129], v[98:99], v[18:19] op_sel:[0,0,0] op_sel_hi:[0,1,1]
    v_pk_fma_f32 v[20:21], v[130:131], v[100:101], v[20:21] op_sel:[0,0,0] op_sel_hi:[0,1,1]
    v_pk_fma_f32 v[22:23], v[130:131], v[102:103], v[22:23] op_sel:[0,0,0] op_sel_hi:[0,1,1]
    s_set_gpr_idx_off
    s_sub_u32 s32, s32, 1
    s_cbranch_scc1 MAIN_DONE
    v_mfma_f32_4x4x4_16b_bf16 v[148:151], v[168:169], v[180:181], 0
    v_lshlrev_b32_sdwa v138, v15, v118 dst_sel:DWORD dst_unused:UNUSED_PAD src0_sel:DWORD src1_sel:WORD_1
    v_mfma_f32_4x4x4_16b_bf16 v[96:99], v[144:145], v[72:73], 0 cbsz:4 abid:10
    s_nop 0
    v_mfma_f32_4x4x4_16b_bf16 v[100:103], v[144:145], v[74:75], 0 cbsz:4 abid:10
    v_lshlrev_b32_sdwa v139, v15, v119 dst_sel:DWORD dst_unused:UNUSED_PAD src0_sel:DWORD src1_sel:WORD_1
    ds_read_u16_d16_hi v134, v138 offset:32768
    ds_read_u16_d16_hi v135, v139 offset:32768
    s_set_gpr_idx_on s57, 0xc
    v_pk_fma_f32 v[16:17], v[128:129], v[104:105], v[16:17] op_sel:[1,0,0] op_sel_hi:[1,1,1]
    v_pk_fma_f32 v[18:19], v[128:129], v[106:107], v[18:19] op_sel:[1,0,0] op_sel_hi:[1,1,1]
    v_pk_fma_f32 v[20:21], v[130:131], v[108:109], v[20:21] op_sel:[1,0,0] op_sel_hi:[1,1,1]
    v_pk_fma_f32 v[22:23], v[130:131], v[110:111], v[22:23] op_sel:[1,0,0] op_sel_hi:[1,1,1]
    s_set_gpr_idx_off
    s_branch MAIN_DONE
B_40:
    buffer_load_dwordx4 v[188:191], v1, s[16:19], s10 offen offset:0 sc1
    buffer_load_dwordx4 v[192:195], v1, s[16:19], s10 offen offset:1024 sc1
    buffer_load_dwordx4 v[196:199], v1, s[16:19], s10 offen offset:2048 sc1
    buffer_load_dwordx4 v[200:203], v1, s[16:19], s10 offen offset:3072 sc1
    buffer_load_dwordx4 v[204:207], v1, s[16:19], s11 offen offset:0 sc1
    buffer_load_dwordx4 v[208:211], v1, s[16:19], s11 offen offset:1024 sc1
    buffer_load_dwordx4 v[212:215], v1, s[16:19], s11 offen offset:2048 sc1
    buffer_load_dwordx4 v[216:219], v1, s[16:19], s11 offen offset:3072 sc1
    s_sub_u32 s32, s32, 1
    s_cbranch_scc1 MAIN_DONE
    v_mfma_f32_4x4x4_16b_bf16 v[124:127], v[172:173], v[178:179], 0 cbsz:4 abid:11
    v_lshlrev_b32_sdwa v136, v15, v114 dst_sel:DWORD dst_unused:UNUSED_PAD src0_sel:DWORD src1_sel:WORD_1
    s_waitcnt vmcnt(12)
    v_mfma_f32_4x4x4_16b_bf16 v[104:107], v[142:143], v[68:69], 0 cbsz:4 abid:10
    s_nop 0
    v_mfma_f32_4x4x4_16b_bf16 v[108:111], v[142:143], v[70:71], 0 cbsz:4 abid:10
    v_lshlrev_b32_sdwa v137, v15, v115 dst_sel:DWORD dst_unused:UNUSED_PAD src0_sel:DWORD src1_sel:WORD_1
    ds_read_u16_d16_hi v132, v136 offset:32768
    ds_read_u16_d16_hi v133, v137 offset:32768
    s_waitcnt lgkmcnt(2)
    s_set_gpr_idx_on s56, 0xc
    v_pk_fma_f32 v[16:17], v[128:129], v[96:97], v[16:17] op_sel:[0,0,0] op_sel_hi:[0,1,1]
    v_pk_fma_f32 v[18:19], v[128:129], v[98:99], v[18:19] op_sel:[0,0,0] op_sel_hi:[0,1,1]
    v_pk_fma_f32 v[20:21], v[130:131], v[100:101], v[20:21] op_sel:[0,0,0] op_sel_hi:[0,1,1]
    v_pk_fma_f32 v[22:23], v[130:131], v[102:103], v[22:23] op_sel:[0,0,0] op_sel_hi:[0,1,1]
    s_set_gpr_idx_off
    s_sub_u32 s32, s32, 1
    s_cbranch_scc1 MAIN_DONE
    v_mfma_f32_4x4x4_16b_bf16 v[148:151], v[168:169], v[180:181], 0
    v_lshlrev_b32_sdwa v138, v15, v118 dst_sel:DWORD dst_unused:UNUSED_PAD src0_sel:DWORD src1_sel:WORD_1
    s_waitcnt vmcnt(11)
    v_mfma_f32_4x4x4_16b_bf16 v[96:99], v[144:145], v[72:73], 0 cbsz:4 abid:10
    s_nop 0
    v_mfma_f32_4x4x4_16b_bf16 v[100:103], v[144:145], v[74:75], 0 cbsz:4 abid:10
    v_lshlrev_b32_sdwa v139, v15, v119 dst_sel:DWORD dst_unused:UNUSED_PAD src0_sel:DWORD src1_sel:WORD_1
    ds_read_u16_d16_hi v134, v138 offset:32768
    ds_read_u16_d16_hi v135, v139 offset:32768
    s_set_gpr_idx_on s57, 0xc
    v_pk_fma_f32 v[16:17], v[128:129], v[104:105], v[16:17] op_sel:[1,0,0] op_sel_hi:[1,1,1]
    v_pk_fma_f32 v[18:19], v[128:129], v[106:107], v[18:19] op_sel:[1,0,0] op_sel_hi:[1,1,1]
    v_pk_fma_f32 v[20:21], v[130:131], v[108:109], v[20:21] op_sel:[1,0,0] op_sel_hi:[1,1,1]
    v_pk_fma_f32 v[22:23], v[130:131], v[110:111], v[22:23] op_sel:[1,0,0] op_sel_hi:[1,1,1]
    s_set_gpr_idx_off
    s_sub_u32 s32, s32, 1
    s_cbranch_scc1 MAIN_DONE
    v_mfma_f32_4x4x4_16b_bf16 v[112:115], v[172:173], v[176:177], 0 cbsz:4 abid:12
    v_lshlrev_b32_sdwa v136, v15, v120 dst_sel:DWORD dst_unused:UNUSED_PAD src0_sel:DWORD src1_sel:WORD_1
    s_waitcnt vmcnt(10)
    v_mfma_f32_4x4x4_16b_bf16 v[104:107], v[146:147], v[76:77], 0 cbsz:4 abid:10
    s_nop 0
    v_mfma_f32_4x4x4_16b_bf16 v[108:111], v[146:147], v[78:79], 0 cbsz:4 abid:10
    v_lshlrev_b32_sdwa v137, v15, v121 dst_sel:DWORD dst_unused:UNUSED_PAD src0_sel:DWORD src1_sel:WORD_1
    ds_read_u16_d16_hi v128, v136 offset:32768
    ds_read_u16_d16_hi v129, v137 offset:32768
    s_waitcnt lgkmcnt(2)
    s_set_gpr_idx_on s58, 0xc
    v_pk_fma_f32 v[16:17], v[132:133], v[96:97], v[16:17] op_sel:[0,0,0] op_sel_hi:[0,1,1]
    v_pk_fma_f32 v[18:19], v[132:133], v[98:99], v[18:19] op_sel:[0,0,0] op_sel_hi:[0,1,1]
    v_pk_fma_f32 v[20:21], v[134:135], v[100:101], v[20:21] op_sel:[0,0,0] op_sel_hi:[0,1,1]
    v_pk_fma_f32 v[22:23], v[134:135], v[102:103], v[22:23] op_sel:[0,0,0] op_sel_hi:[0,1,1]
    s_set_gpr_idx_off
    s_sub_u32 s32, s32, 1
    s_cbranch_scc1 MAIN_DONE
    v_mfma_f32_4x4x4_16b_bf16 v[152:155], v[168:169], v[182:183], 0
    v_lshlrev_b32_sdwa v138, v15, v124 dst_sel:DWORD dst_unused:UNUSED_PAD src0_sel:DWORD src1_sel:WORD_1
    s_waitcnt vmcnt(9)
    v_mfma_f32_4x4x4_16b_bf16 v[96:99], v[140:141], v[80:81], 0 cbsz:4 abid:11
    s_nop 0
    v_mfma_f32_4x4x4_16b_bf16 v[100:103], v[140:141], v[82:83], 0 cbsz:4 abid:11
    v_lshlrev_b32_sdwa v139, v15, v125 dst_sel:DWORD dst_unused:UNUSED_PAD src0_sel:DWORD src1_sel:WORD_1
    ds_read_u16_d16_hi v130, v138 offset:32768
    ds_read_u16_d16_hi v131, v139 offset:32768
    s_set_gpr_idx_on s59, 0xc
    v_pk_fma_f32 v[16:17], v[132:133], v[104:105], v[16:17] op_sel:[1,0,0] op_sel_hi:[1,1,1]
    v_pk_fma_f32 v[18:19], v[132:133], v[106:107], v[18:19] op_sel:[1,0,0] op_sel_hi:[1,1,1]
    v_pk_fma_f32 v[20:21], v[134:135], v[108:109], v[20:21] op_sel:[1,0,0] op_sel_hi:[1,1,1]
    v_pk_fma_f32 v[22:23], v[134:135], v[110:111], v[22:23] op_sel:[1,0,0] op_sel_hi:[1,1,1]
    s_set_gpr_idx_off
    s_sub_u32 s32, s32, 1
    s_cbranch_scc1 MAIN_DONE
    v_mfma_f32_4x4x4_16b_bf16 v[116:119], v[172:173], v[178:179], 0 cbsz:4 abid:12
    v_lshlrev_b32_sdwa v136, v15, v122 dst_sel:DWORD dst_unused:UNUSED_PAD src0_sel:DWORD src1_sel:WORD_1
    s_waitcnt vmcnt(8)
    v_mfma_f32_4x4x4_16b_bf16 v[104:107], v[142:143], v[84:85], 0 cbsz:4 abid:11
    s_nop 0
    v_mfma_f32_4x4x4_16b_bf16 v[108:111], v[142:143], v[86:87], 0 cbsz:4 abid:11
    v_lshlrev_b32_sdwa v137, v15, v123 dst_sel:DWORD dst_unused:UNUSED_PAD src0_sel:DWORD src1_sel:WORD_1
    ds_read_u16_d16_hi v132, v136 offset:32768
    ds_read_u16_d16_hi v133, v137 offset:32768
    s_waitcnt lgkmcnt(2)
    s_set_gpr_idx_on s60, 0xc
    v_pk_fma_f32 v[16:17], v[128:129], v[96:97], v[16:17] op_sel:[0,0,0] op_sel_hi:[0,1,1]
    v_pk_fma_f32 v[18:19], v[128:129], v[98:99], v[18:19] op_sel:[0,0,0] op_sel_hi:[0,1,1]
    v_pk_fma_f32 v[20:21], v[130:131], v[100:101], v[20:21] op_sel:[0,0,0] op_sel_hi:[0,1,1]
    v_pk_fma_f32 v[22:23], v[130:131], v[102:103], v[22:23] op_sel:[0,0,0] op_sel_hi:[0,1,1]
    s_set_gpr_idx_off
    s_sub_u32 s32, s32, 1
    s_cbranch_scc1 MAIN_DONE
    v_mfma_f32_4x4x4_16b_bf16 v[156:159], v[168:169], v[184:185], 0
    v_lshlrev_b32_sdwa v138, v15, v126 dst_sel:DWORD dst_unused:UNUSED_PAD src0_sel:DWORD src1_sel:WORD_1
    v_mfma_f32_4x4x4_16b_bf16 v[96:99], v[144:145], v[88:89], 0 cbsz:4 abid:11
    s_nop 0
    v_mfma_f32_4x4x4_16b_bf16 v[100:103], v[144:145], v[90:91], 0 cbsz:4 abid:11
    v_lshlrev_b32_sdwa v139, v15, v127 dst_sel:DWORD dst_unused:UNUSED_PAD src0_sel:DWORD src1_sel:WORD_1
    ds_read_u16_d16_hi v134, v138 offset:32768
    ds_read_u16_d16_hi v135, v139 offset:32768
    s_set_gpr_idx_on s61, 0xc
    v_pk_fma_f32 v[16:17], v[128:129], v[104:105], v[16:17] op_sel:[1,0,0] op_sel_hi:[1,1,1]
    v_pk_fma_f32 v[18:19], v[128:129], v[106:107], v[18:19] op_sel:[1,0,0] op_sel_hi:[1,1,1]
    v_pk_fma_f32 v[20:21], v[130:131], v[108:109], v[20:21] op_sel:[1,0,0] op_sel_hi:[1,1,1]
    v_pk_fma_f32 v[22:23], v[130:131], v[110:111], v[22:23] op_sel:[1,0,0] op_sel_hi:[1,1,1]
    s_set_gpr_idx_off
    s_branch MAIN_DONE
B_44:
    buffer_load_dwordx4 v[188:191], v1, s[16:19], s10 offen offset:0 sc1
    buffer_load_dwordx4 v[192:195], v1, s[16:19], s10 offen offset:1024 sc1
    buffer_load_dwordx4 v[196:199], v1, s[16:19], s10 offen offset:2048 sc1
    buffer_load_dwordx4 v[200:203], v1, s[16:19], s10 offen offset:3072 sc1
    buffer_load_dwordx4 v[204:207], v1, s[16:19], s11 offen offset:0 sc1
    buffer_load_dwordx4 v[208:211], v1, s[16:19], s11 offen offset:1024 sc1
    buffer_load_dwordx4 v[212:215], v1, s[16:19], s11 offen offset:2048 sc1
    buffer_load_dwordx4 v[216:219], v1, s[16:19], s11 offen offset:3072 sc1
    s_sub_u32 s32, s32, 1
    s_cbranch_scc1 MAIN_DONE
    v_mfma_f32_4x4x4_16b_bf16 v[116:119], v[172:173], v[178:179], 0 cbsz:4 abid:12
    v_lshlrev_b32_sdwa v136, v15, v122 dst_sel:DWORD dst_unused:UNUSED_PAD src0_sel:DWORD src1_sel:WORD_1
    s_waitcnt vmcnt(12)
    v_mfma_f32_4x4x4_16b_bf16 v[104:107], v[142:143], v[84:85], 0 cbsz:4 abid:11
    s_nop 0
    v_mfma_f32_4x4x4_16b_bf16 v[108:111], v[142:143], v[86:87], 0 cbsz:4 abid:11
    v_lshlrev_b32_sdwa v137, v15, v123 dst_sel:DWORD dst_unused:UNUSED_PAD src0_sel:DWORD src1_sel:WORD_1
    ds_read_u16_d16_hi v132, v136 offset:32768
    ds_read_u16_d16_hi v133, v137 offset:32768
    s_waitcnt lgkmcnt(2)
    s_set_gpr_idx_on s60, 0xc
    v_pk_fma_f32 v[16:17], v[128:129], v[96:97], v[16:17] op_sel:[0,0,0] op_sel_hi:[0,1,1]
    v_pk_fma_f32 v[18:19], v[128:129], v[98:99], v[18:19] op_sel:[0,0,0] op_sel_hi:[0,1,1]
    v_pk_fma_f32 v[20:21], v[130:131], v[100:101], v[20:21] op_sel:[0,0,0] op_sel_hi:[0,1,1]
    v_pk_fma_f32 v[22:23], v[130:131], v[102:103], v[22:23] op_sel:[0,0,0] op_sel_hi:[0,1,1]
    s_set_gpr_idx_off
    s_sub_u32 s32, s32, 1
    s_cbranch_scc1 MAIN_DONE
    v_mfma_f32_4x4x4_16b_bf16 v[156:159], v[168:169], v[184:185], 0
    v_lshlrev_b32_sdwa v138, v15, v126 dst_sel:DWORD dst_unused:UNUSED_PAD src0_sel:DWORD src1_sel:WORD_1
    s_waitcnt vmcnt(11)
    v_mfma_f32_4x4x4_16b_bf16 v[96:99], v[144:145], v[88:89], 0 cbsz:4 abid:11
    s_nop 0
    v_mfma_f32_4x4x4_16b_bf16 v[100:103], v[144:145], v[90:91], 0 cbsz:4 abid:11
    v_lshlrev_b32_sdwa v139, v15, v127 dst_sel:DWORD dst_unused:UNUSED_PAD src0_sel:DWORD src1_sel:WORD_1
    ds_read_u16_d16_hi v134, v138 offset:32768
    ds_read_u16_d16_hi v135, v139 offset:32768
    s_set_gpr_idx_on s61, 0xc
    v_pk_fma_f32 v[16:17], v[128:129], v[104:105], v[16:17] op_sel:[1,0,0] op_sel_hi:[1,1,1]
    v_pk_fma_f32 v[18:19], v[128:129], v[106:107], v[18:19] op_sel:[1,0,0] op_sel_hi:[1,1,1]
    v_pk_fma_f32 v[20:21], v[130:131], v[108:109], v[20:21] op_sel:[1,0,0] op_sel_hi:[1,1,1]
    v_pk_fma_f32 v[22:23], v[130:131], v[110:111], v[22:23] op_sel:[1,0,0] op_sel_hi:[1,1,1]
    s_set_gpr_idx_off
    s_sub_u32 s32, s32, 1
    s_cbranch_scc1 MAIN_DONE
    v_mfma_f32_4x4x4_16b_bf16 v[120:123], v[172:173], v[176:177], 0 cbsz:4 abid:13
    v_lshlrev_b32_sdwa v136, v15, v112 dst_sel:DWORD dst_unused:UNUSED_PAD src0_sel:DWORD src1_sel:WORD_1
    s_waitcnt vmcnt(10)
    v_mfma_f32_4x4x4_16b_bf16 v[104:107], v[146:147], v[92:93], 0 cbsz:4 abid:11
    s_nop 0
    v_mfma_f32_4x4x4_16b_bf16 v[108:111], v[146:147], v[94:95], 0 cbsz:4 abid:11
    v_lshlrev_b32_sdwa v137, v15, v113 dst_sel:DWORD dst_unused:UNUSED_PAD src0_sel:DWORD src1_sel:WORD_1
    ds_read_u16_d16_hi v128, v136 offset:32768
    ds_read_u16_d16_hi v129, v137 offset:32768
    s_waitcnt lgkmcnt(2)
    s_set_gpr_idx_on s62, 0xc
    v_pk_fma_f32 v[16:17], v[132:133], v[96:97], v[16:17] op_sel:[0,0,0] op_sel_hi:[0,1,1]
    v_pk_fma_f32 v[18:19], v[132:133], v[98:99], v[18:19] op_sel:[0,0,0] op_sel_hi:[0,1,1]
    v_pk_fma_f32 v[20:21], v[134:135], v[100:101], v[20:21] op_sel:[0,0,0] op_sel_hi:[0,1,1]
    v_pk_fma_f32 v[22:23], v[134:135], v[102:103], v[22:23] op_sel:[0,0,0] op_sel_hi:[0,1,1]
    s_set_gpr_idx_off
    s_sub_u32 s32, s32, 1
    s_cbranch_scc1 MAIN_DONE
    v_mfma_f32_4x4x4_16b_bf16 v[160:163], v[168:169], v[186:187], 0
    v_lshlrev_b32_sdwa v138, v15, v116 dst_sel:DWORD dst_unused:UNUSED_PAD src0_sel:DWORD src1_sel:WORD_1
    s_waitcnt vmcnt(9)
    v_mfma_f32_4x4x4_16b_bf16 v[96:99], v[140:141], v[64:65], 0 cbsz:4 abid:12
    s_nop 0
    v_mfma_f32_4x4x4_16b_bf16 v[100:103], v[140:141], v[66:67], 0 cbsz:4 abid:12
    v_lshlrev_b32_sdwa v139, v15, v117 dst_sel:DWORD dst_unused:UNUSED_PAD src0_sel:DWORD src1_sel:WORD_1
    ds_read_u16_d16_hi v130, v138 offset:32768
    ds_read_u16_d16_hi v131, v139 offset:32768
    s_set_gpr_idx_on s63, 0xc
    v_pk_fma_f32 v[16:17], v[132:133], v[104:105], v[16:17] op_sel:[1,0,0] op_sel_hi:[1,1,1]
    v_pk_fma_f32 v[18:19], v[132:133], v[106:107], v[18:19] op_sel:[1,0,0] op_sel_hi:[1,1,1]
    v_pk_fma_f32 v[20:21], v[134:135], v[108:109], v[20:21] op_sel:[1,0,0] op_sel_hi:[1,1,1]
    v_pk_fma_f32 v[22:23], v[134:135], v[110:111], v[22:23] op_sel:[1,0,0] op_sel_hi:[1,1,1]
    s_set_gpr_idx_off
    s_sub_u32 s32, s32, 1
    s_cbranch_scc1 MAIN_DONE
    v_mfma_f32_4x4x4_16b_bf16 v[124:127], v[172:173], v[178:179], 0 cbsz:4 abid:13
    v_lshlrev_b32_sdwa v136, v15, v114 dst_sel:DWORD dst_unused:UNUSED_PAD src0_sel:DWORD src1_sel:WORD_1
    s_waitcnt vmcnt(8)
    v_mfma_f32_4x4x4_16b_bf16 v[104:107], v[142:143], v[68:69], 0 cbsz:4 abid:12
    s_nop 0
    v_mfma_f32_4x4x4_16b_bf16 v[108:111], v[142:143], v[70:71], 0 cbsz:4 abid:12
    v_lshlrev_b32_sdwa v137, v15, v115 dst_sel:DWORD dst_unused:UNUSED_PAD src0_sel:DWORD src1_sel:WORD_1
    ds_read_u16_d16_hi v132, v136 offset:32768
    ds_read_u16_d16_hi v133, v137 offset:32768
    s_waitcnt lgkmcnt(2)
    s_set_gpr_idx_on s48, 0xc
    v_pk_fma_f32 v[16:17], v[128:129], v[96:97], v[16:17] op_sel:[0,0,0] op_sel_hi:[0,1,1]
    v_pk_fma_f32 v[18:19], v[128:129], v[98:99], v[18:19] op_sel:[0,0,0] op_sel_hi:[0,1,1]
    v_pk_fma_f32 v[20:21], v[130:131], v[100:101], v[20:21] op_sel:[0,0,0] op_sel_hi:[0,1,1]
    v_pk_fma_f32 v[22:23], v[130:131], v[102:103], v[22:23] op_sel:[0,0,0] op_sel_hi:[0,1,1]
    s_set_gpr_idx_off
    s_sub_u32 s32, s32, 1
    s_cbranch_scc1 MAIN_DONE
    v_lshlrev_b32_sdwa v138, v15, v118 dst_sel:DWORD dst_unused:UNUSED_PAD src0_sel:DWORD src1_sel:WORD_1
    v_mfma_f32_4x4x4_16b_bf16 v[96:99], v[144:145], v[72:73], 0 cbsz:4 abid:12
    s_nop 0
    v_mfma_f32_4x4x4_16b_bf16 v[100:103], v[144:145], v[74:75], 0 cbsz:4 abid:12
    v_lshlrev_b32_sdwa v139, v15, v119 dst_sel:DWORD dst_unused:UNUSED_PAD src0_sel:DWORD src1_sel:WORD_1
    ds_read_u16_d16_hi v134, v138 offset:32768
    ds_read_u16_d16_hi v135, v139 offset:32768
    s_set_gpr_idx_on s49, 0xc
    v_pk_fma_f32 v[16:17], v[128:129], v[104:105], v[16:17] op_sel:[1,0,0] op_sel_hi:[1,1,1]
    v_pk_fma_f32 v[18:19], v[128:129], v[106:107], v[18:19] op_sel:[1,0,0] op_sel_hi:[1,1,1]
    v_pk_fma_f32 v[20:21], v[130:131], v[108:109], v[20:21] op_sel:[1,0,0] op_sel_hi:[1,1,1]
    v_pk_fma_f32 v[22:23], v[130:131], v[110:111], v[22:23] op_sel:[1,0,0] op_sel_hi:[1,1,1]
    s_set_gpr_idx_off
    s_branch MAIN_DONE
B_48:
    buffer_load_dwordx4 v[188:191], v1, s[16:19], s10 offen offset:0 sc1
    buffer_load_dwordx4 v[192:195], v1, s[16:19], s10 offen offset:1024 sc1
    buffer_load_dwordx4 v[196:199], v1, s[16:19], s10 offen offset:2048 sc1
    buffer_load_dwordx4 v[200:203], v1, s[16:19], s10 offen offset:3072 sc1
    buffer_load_dwordx4 v[204:207], v1, s[16:19], s11 offen offset:0 sc1
    buffer_load_dwordx4 v[208:211], v1, s[16:19], s11 offen offset:1024 sc1
    buffer_load_dwordx4 v[212:215], v1, s[16:19], s11 offen offset:2048 sc1
    buffer_load_dwordx4 v[216:219], v1, s[16:19], s11 offen offset:3072 sc1
    s_sub_u32 s32, s32, 1
    s_cbranch_scc1 MAIN_DONE
    v_mfma_f32_4x4x4_16b_bf16 v[124:127], v[172:173], v[178:179], 0 cbsz:4 abid:13
    v_lshlrev_b32_sdwa v136, v15, v114 dst_sel:DWORD dst_unused:UNUSED_PAD src0_sel:DWORD src1_sel:WORD_1
    s_waitcnt vmcnt(12)
    v_mfma_f32_4x4x4_16b_bf16 v[104:107], v[142:143], v[68:69], 0 cbsz:4 abid:12
    s_nop 0
    v_mfma_f32_4x4x4_16b_bf16 v[108:111], v[142:143], v[70:71], 0 cbsz:4 abid:12
    v_lshlrev_b32_sdwa v137, v15, v115 dst_sel:DWORD dst_unused:UNUSED_PAD src0_sel:DWORD src1_sel:WORD_1
    ds_read_u16_d16_hi v132, v136 offset:32768
    ds_read_u16_d16_hi v133, v137 offset:32768
    s_waitcnt lgkmcnt(2)
    s_set_gpr_idx_on s48, 0xc
    v_pk_fma_f32 v[16:17], v[128:129], v[96:97], v[16:17] op_sel:[0,0,0] op_sel_hi:[0,1,1]
    v_pk_fma_f32 v[18:19], v[128:129], v[98:99], v[18:19] op_sel:[0,0,0] op_sel_hi:[0,1,1]
    v_pk_fma_f32 v[20:21], v[130:131], v[100:101], v[20:21] op_sel:[0,0,0] op_sel_hi:[0,1,1]
    v_pk_fma_f32 v[22:23], v[130:131], v[102:103], v[22:23] op_sel:[0,0,0] op_sel_hi:[0,1,1]
    s_set_gpr_idx_off
    s_sub_u32 s32, s32, 1
    s_cbranch_scc1 MAIN_DONE
    v_lshlrev_b32_sdwa v138, v15, v118 dst_sel:DWORD dst_unused:UNUSED_PAD src0_sel:DWORD src1_sel:WORD_1
    s_waitcnt vmcnt(11)
    v_mfma_f32_4x4x4_16b_bf16 v[96:99], v[144:145], v[72:73], 0 cbsz:4 abid:12
    s_nop 0
    v_mfma_f32_4x4x4_16b_bf16 v[100:103], v[144:145], v[74:75], 0 cbsz:4 abid:12
    v_lshlrev_b32_sdwa v139, v15, v119 dst_sel:DWORD dst_unused:UNUSED_PAD src0_sel:DWORD src1_sel:WORD_1
    ds_read_u16_d16_hi v134, v138 offset:32768
    ds_read_u16_d16_hi v135, v139 offset:32768
    s_set_gpr_idx_on s49, 0xc
    v_pk_fma_f32 v[16:17], v[128:129], v[104:105], v[16:17] op_sel:[1,0,0] op_sel_hi:[1,1,1]
    v_pk_fma_f32 v[18:19], v[128:129], v[106:107], v[18:19] op_sel:[1,0,0] op_sel_hi:[1,1,1]
    v_pk_fma_f32 v[20:21], v[130:131], v[108:109], v[20:21] op_sel:[1,0,0] op_sel_hi:[1,1,1]
    v_pk_fma_f32 v[22:23], v[130:131], v[110:111], v[22:23] op_sel:[1,0,0] op_sel_hi:[1,1,1]
    s_set_gpr_idx_off
    s_sub_u32 s32, s32, 1
    s_cbranch_scc1 MAIN_DONE
    v_mfma_f32_4x4x4_16b_bf16 v[112:115], v[172:173], v[176:177], 0 cbsz:4 abid:14
    v_lshlrev_b32_sdwa v136, v15, v120 dst_sel:DWORD dst_unused:UNUSED_PAD src0_sel:DWORD src1_sel:WORD_1
    s_waitcnt vmcnt(10)
    v_mfma_f32_4x4x4_16b_bf16 v[104:107], v[146:147], v[76:77], 0 cbsz:4 abid:12
    s_nop 0
    v_mfma_f32_4x4x4_16b_bf16 v[108:111], v[146:147], v[78:79], 0 cbsz:4 abid:12
    v_lshlrev_b32_sdwa v137, v15, v121 dst_sel:DWORD dst_unused:UNUSED_PAD src0_sel:DWORD src1_sel:WORD_1
    ds_read_u16_d16_hi v128, v136 offset:32768
    ds_read_u16_d16_hi v129, v137 offset:32768
    s_waitcnt lgkmcnt(2)
    s_set_gpr_idx_on s50, 0xc
    v_pk_fma_f32 v[16:17], v[132:133], v[96:97], v[16:17] op_sel:[0,0,0] op_sel_hi:[0,1,1]
    v_pk_fma_f32 v[18:19], v[132:133], v[98:99], v[18:19] op_sel:[0,0,0] op_sel_hi:[0,1,1]
    v_pk_fma_f32 v[20:21], v[134:135], v[100:101], v[20:21] op_sel:[0,0,0] op_sel_hi:[0,1,1]
    v_pk_fma_f32 v[22:23], v[134:135], v[102:103], v[22:23] op_sel:[0,0,0] op_sel_hi:[0,1,1]
    s_set_gpr_idx_off
    s_sub_u32 s32, s32, 1
    s_cbranch_scc1 MAIN_DONE
    v_lshlrev_b32_sdwa v138, v15, v124 dst_sel:DWORD dst_unused:UNUSED_PAD src0_sel:DWORD src1_sel:WORD_1
    s_waitcnt vmcnt(9)
    v_mfma_f32_4x4x4_16b_bf16 v[96:99], v[140:141], v[80:81], 0 cbsz:4 abid:13
    s_nop 0
    v_mfma_f32_4x4x4_16b_bf16 v[100:103], v[140:141], v[82:83], 0 cbsz:4 abid:13
    v_lshlrev_b32_sdwa v139, v15, v125 dst_sel:DWORD dst_unused:UNUSED_PAD src0_sel:DWORD src1_sel:WORD_1
    ds_read_u16_d16_hi v130, v138 offset:32768
    ds_read_u16_d16_hi v131, v139 offset:32768
    s_set_gpr_idx_on s51, 0xc
    v_pk_fma_f32 v[16:17], v[132:133], v[104:105], v[16:17] op_sel:[1,0,0] op_sel_hi:[1,1,1]
    v_pk_fma_f32 v[18:19], v[132:133], v[106:107], v[18:19] op_sel:[1,0,0] op_sel_hi:[1,1,1]
    v_pk_fma_f32 v[20:21], v[134:135], v[108:109], v[20:21] op_sel:[1,0,0] op_sel_hi:[1,1,1]
    v_pk_fma_f32 v[22:23], v[134:135], v[110:111], v[22:23] op_sel:[1,0,0] op_sel_hi:[1,1,1]
    s_set_gpr_idx_off
    s_sub_u32 s32, s32, 1
    s_cbranch_scc1 MAIN_DONE
    v_mfma_f32_4x4x4_16b_bf16 v[116:119], v[172:173], v[178:179], 0 cbsz:4 abid:14
    v_lshlrev_b32_sdwa v136, v15, v122 dst_sel:DWORD dst_unused:UNUSED_PAD src0_sel:DWORD src1_sel:WORD_1
    s_waitcnt vmcnt(8)
    v_mfma_f32_4x4x4_16b_bf16 v[104:107], v[142:143], v[84:85], 0 cbsz:4 abid:13
    s_nop 0
    v_mfma_f32_4x4x4_16b_bf16 v[108:111], v[142:143], v[86:87], 0 cbsz:4 abid:13
    v_lshlrev_b32_sdwa v137, v15, v123 dst_sel:DWORD dst_unused:UNUSED_PAD src0_sel:DWORD src1_sel:WORD_1
    ds_read_u16_d16_hi v132, v136 offset:32768
    ds_read_u16_d16_hi v133, v137 offset:32768
    s_waitcnt lgkmcnt(2)
    s_set_gpr_idx_on s52, 0xc
    v_pk_fma_f32 v[16:17], v[128:129], v[96:97], v[16:17] op_sel:[0,0,0] op_sel_hi:[0,1,1]
    v_pk_fma_f32 v[18:19], v[128:129], v[98:99], v[18:19] op_sel:[0,0,0] op_sel_hi:[0,1,1]
    v_pk_fma_f32 v[20:21], v[130:131], v[100:101], v[20:21] op_sel:[0,0,0] op_sel_hi:[0,1,1]
    v_pk_fma_f32 v[22:23], v[130:131], v[102:103], v[22:23] op_sel:[0,0,0] op_sel_hi:[0,1,1]
    s_set_gpr_idx_off
    s_sub_u32 s32, s32, 1
    s_cbranch_scc1 MAIN_DONE
    v_lshlrev_b32_sdwa v138, v15, v126 dst_sel:DWORD dst_unused:UNUSED_PAD src0_sel:DWORD src1_sel:WORD_1
    v_mfma_f32_4x4x4_16b_bf16 v[96:99], v[144:145], v[88:89], 0 cbsz:4 abid:13
    s_nop 0
    v_mfma_f32_4x4x4_16b_bf16 v[100:103], v[144:145], v[90:91], 0 cbsz:4 abid:13
    v_lshlrev_b32_sdwa v139, v15, v127 dst_sel:DWORD dst_unused:UNUSED_PAD src0_sel:DWORD src1_sel:WORD_1
    ds_read_u16_d16_hi v134, v138 offset:32768
    ds_read_u16_d16_hi v135, v139 offset:32768
    s_set_gpr_idx_on s53, 0xc
    v_pk_fma_f32 v[16:17], v[128:129], v[104:105], v[16:17] op_sel:[1,0,0] op_sel_hi:[1,1,1]
    v_pk_fma_f32 v[18:19], v[128:129], v[106:107], v[18:19] op_sel:[1,0,0] op_sel_hi:[1,1,1]
    v_pk_fma_f32 v[20:21], v[130:131], v[108:109], v[20:21] op_sel:[1,0,0] op_sel_hi:[1,1,1]
    v_pk_fma_f32 v[22:23], v[130:131], v[110:111], v[22:23] op_sel:[1,0,0] op_sel_hi:[1,1,1]
    s_set_gpr_idx_off
    s_branch MAIN_DONE
B_52:
    buffer_load_dwordx4 v[188:191], v1, s[16:19], s10 offen offset:0 sc1
    buffer_load_dwordx4 v[192:195], v1, s[16:19], s10 offen offset:1024 sc1
    buffer_load_dwordx4 v[196:199], v1, s[16:19], s10 offen offset:2048 sc1
    buffer_load_dwordx4 v[200:203], v1, s[16:19], s10 offen offset:3072 sc1
    buffer_load_dwordx4 v[204:207], v1, s[16:19], s11 offen offset:0 sc1
    buffer_load_dwordx4 v[208:211], v1, s[16:19], s11 offen offset:1024 sc1
    buffer_load_dwordx4 v[212:215], v1, s[16:19], s11 offen offset:2048 sc1
    buffer_load_dwordx4 v[216:219], v1, s[16:19], s11 offen offset:3072 sc1
    s_sub_u32 s32, s32, 1
    s_cbranch_scc1 MAIN_DONE
    v_mfma_f32_4x4x4_16b_bf16 v[116:119], v[172:173], v[178:179], 0 cbsz:4 abid:14
    v_lshlrev_b32_sdwa v136, v15, v122 dst_sel:DWORD dst_unused:UNUSED_PAD src0_sel:DWORD src1_sel:WORD_1
    s_waitcnt vmcnt(12)
    v_mfma_f32_4x4x4_16b_bf16 v[104:107], v[142:143], v[84:85], 0 cbsz:4 abid:13
    s_nop 0
    v_mfma_f32_4x4x4_16b_bf16 v[108:111], v[142:143], v[86:87], 0 cbsz:4 abid:13
    v_lshlrev_b32_sdwa v137, v15, v123 dst_sel:DWORD dst_unused:UNUSED_PAD src0_sel:DWORD src1_sel:WORD_1
    ds_read_u16_d16_hi v132, v136 offset:32768
    ds_read_u16_d16_hi v133, v137 offset:32768
    s_waitcnt lgkmcnt(2)
    s_set_gpr_idx_on s52, 0xc
    v_pk_fma_f32 v[16:17], v[128:129], v[96:97], v[16:17] op_sel:[0,0,0] op_sel_hi:[0,1,1]
    v_pk_fma_f32 v[18:19], v[128:129], v[98:99], v[18:19] op_sel:[0,0,0] op_sel_hi:[0,1,1]
    v_pk_fma_f32 v[20:21], v[130:131], v[100:101], v[20:21] op_sel:[0,0,0] op_sel_hi:[0,1,1]
    v_pk_fma_f32 v[22:23], v[130:131], v[102:103], v[22:23] op_sel:[0,0,0] op_sel_hi:[0,1,1]
    s_set_gpr_idx_off
    s_sub_u32 s32, s32, 1
    s_cbranch_scc1 MAIN_DONE
    v_lshlrev_b32_sdwa v138, v15, v126 dst_sel:DWORD dst_unused:UNUSED_PAD src0_sel:DWORD src1_sel:WORD_1
    s_waitcnt vmcnt(11)
    v_mfma_f32_4x4x4_16b_bf16 v[96:99], v[144:145], v[88:89], 0 cbsz:4 abid:13
    s_nop 0
    v_mfma_f32_4x4x4_16b_bf16 v[100:103], v[144:145], v[90:91], 0 cbsz:4 abid:13
    v_lshlrev_b32_sdwa v139, v15, v127 dst_sel:DWORD dst_unused:UNUSED_PAD src0_sel:DWORD src1_sel:WORD_1
    ds_read_u16_d16_hi v134, v138 offset:32768
    ds_read_u16_d16_hi v135, v139 offset:32768
    s_set_gpr_idx_on s53, 0xc
    v_pk_fma_f32 v[16:17], v[128:129], v[104:105], v[16:17] op_sel:[1,0,0] op_sel_hi:[1,1,1]
    v_pk_fma_f32 v[18:19], v[128:129], v[106:107], v[18:19] op_sel:[1,0,0] op_sel_hi:[1,1,1]
    v_pk_fma_f32 v[20:21], v[130:131], v[108:109], v[20:21] op_sel:[1,0,0] op_sel_hi:[1,1,1]
    v_pk_fma_f32 v[22:23], v[130:131], v[110:111], v[22:23] op_sel:[1,0,0] op_sel_hi:[1,1,1]
    s_set_gpr_idx_off
    s_sub_u32 s32, s32, 1
    s_cbranch_scc1 MAIN_DONE
    v_mfma_f32_4x4x4_16b_bf16 v[120:123], v[172:173], v[176:177], 0 cbsz:4 abid:15
    v_lshlrev_b32_sdwa v136, v15, v112 dst_sel:DWORD dst_unused:UNUSED_PAD src0_sel:DWORD src1_sel:WORD_1
    s_waitcnt vmcnt(10)
    v_mfma_f32_4x4x4_16b_bf16 v[104:107], v[146:147], v[92:93], 0 cbsz:4 abid:13
    s_nop 0
    v_mfma_f32_4x4x4_16b_bf16 v[108:111], v[146:147], v[94:95], 0 cbsz:4 abid:13
    v_lshlrev_b32_sdwa v137, v15, v113 dst_sel:DWORD dst_unused:UNUSED_PAD src0_sel:DWORD src1_sel:WORD_1
    ds_read_u16_d16_hi v128, v136 offset:32768
    ds_read_u16_d16_hi v129, v137 offset:32768
    s_waitcnt lgkmcnt(2)
    s_set_gpr_idx_on s54, 0xc
    v_pk_fma_f32 v[16:17], v[132:133], v[96:97], v[16:17] op_sel:[0,0,0] op_sel_hi:[0,1,1]
    v_pk_fma_f32 v[18:19], v[132:133], v[98:99], v[18:19] op_sel:[0,0,0] op_sel_hi:[0,1,1]
    v_pk_fma_f32 v[20:21], v[134:135], v[100:101], v[20:21] op_sel:[0,0,0] op_sel_hi:[0,1,1]
    v_pk_fma_f32 v[22:23], v[134:135], v[102:103], v[22:23] op_sel:[0,0,0] op_sel_hi:[0,1,1]
    s_set_gpr_idx_off
    s_sub_u32 s32, s32, 1
    s_cbranch_scc1 MAIN_DONE
    v_lshlrev_b32_sdwa v138, v15, v116 dst_sel:DWORD dst_unused:UNUSED_PAD src0_sel:DWORD src1_sel:WORD_1
    s_waitcnt vmcnt(9)
    v_mfma_f32_4x4x4_16b_bf16 v[96:99], v[140:141], v[64:65], 0 cbsz:4 abid:14
    s_nop 0
    v_mfma_f32_4x4x4_16b_bf16 v[100:103], v[140:141], v[66:67], 0 cbsz:4 abid:14
    v_lshlrev_b32_sdwa v139, v15, v117 dst_sel:DWORD dst_unused:UNUSED_PAD src0_sel:DWORD src1_sel:WORD_1
    ds_read_u16_d16_hi v130, v138 offset:32768
    ds_read_u16_d16_hi v131, v139 offset:32768
    s_set_gpr_idx_on s55, 0xc
    v_pk_fma_f32 v[16:17], v[132:133], v[104:105], v[16:17] op_sel:[1,0,0] op_sel_hi:[1,1,1]
    v_pk_fma_f32 v[18:19], v[132:133], v[106:107], v[18:19] op_sel:[1,0,0] op_sel_hi:[1,1,1]
    v_pk_fma_f32 v[20:21], v[134:135], v[108:109], v[20:21] op_sel:[1,0,0] op_sel_hi:[1,1,1]
    v_pk_fma_f32 v[22:23], v[134:135], v[110:111], v[22:23] op_sel:[1,0,0] op_sel_hi:[1,1,1]
    s_set_gpr_idx_off
    s_sub_u32 s32, s32, 1
    s_cbranch_scc1 MAIN_DONE
    v_mfma_f32_4x4x4_16b_bf16 v[124:127], v[172:173], v[178:179], 0 cbsz:4 abid:15
    v_lshlrev_b32_sdwa v136, v15, v114 dst_sel:DWORD dst_unused:UNUSED_PAD src0_sel:DWORD src1_sel:WORD_1
    s_waitcnt vmcnt(8)
    v_mfma_f32_4x4x4_16b_bf16 v[104:107], v[142:143], v[68:69], 0 cbsz:4 abid:14
    s_nop 0
    v_mfma_f32_4x4x4_16b_bf16 v[108:111], v[142:143], v[70:71], 0 cbsz:4 abid:14
    v_lshlrev_b32_sdwa v137, v15, v115 dst_sel:DWORD dst_unused:UNUSED_PAD src0_sel:DWORD src1_sel:WORD_1
    ds_read_u16_d16_hi v132, v136 offset:32768
    ds_read_u16_d16_hi v133, v137 offset:32768
    s_waitcnt lgkmcnt(2)
    s_set_gpr_idx_on s56, 0xc
    v_pk_fma_f32 v[16:17], v[128:129], v[96:97], v[16:17] op_sel:[0,0,0] op_sel_hi:[0,1,1]
    v_pk_fma_f32 v[18:19], v[128:129], v[98:99], v[18:19] op_sel:[0,0,0] op_sel_hi:[0,1,1]
    v_pk_fma_f32 v[20:21], v[130:131], v[100:101], v[20:21] op_sel:[0,0,0] op_sel_hi:[0,1,1]
    v_pk_fma_f32 v[22:23], v[130:131], v[102:103], v[22:23] op_sel:[0,0,0] op_sel_hi:[0,1,1]
    s_set_gpr_idx_off
    s_sub_u32 s32, s32, 1
    s_cbranch_scc1 MAIN_DONE
    v_lshlrev_b32_sdwa v138, v15, v118 dst_sel:DWORD dst_unused:UNUSED_PAD src0_sel:DWORD src1_sel:WORD_1
    v_mfma_f32_4x4x4_16b_bf16 v[96:99], v[144:145], v[72:73], 0 cbsz:4 abid:14
    s_nop 0
    v_mfma_f32_4x4x4_16b_bf16 v[100:103], v[144:145], v[74:75], 0 cbsz:4 abid:14
    v_lshlrev_b32_sdwa v139, v15, v119 dst_sel:DWORD dst_unused:UNUSED_PAD src0_sel:DWORD src1_sel:WORD_1
    ds_read_u16_d16_hi v134, v138 offset:32768
    ds_read_u16_d16_hi v135, v139 offset:32768
    s_set_gpr_idx_on s57, 0xc
    v_pk_fma_f32 v[16:17], v[128:129], v[104:105], v[16:17] op_sel:[1,0,0] op_sel_hi:[1,1,1]
    v_pk_fma_f32 v[18:19], v[128:129], v[106:107], v[18:19] op_sel:[1,0,0] op_sel_hi:[1,1,1]
    v_pk_fma_f32 v[20:21], v[130:131], v[108:109], v[20:21] op_sel:[1,0,0] op_sel_hi:[1,1,1]
    v_pk_fma_f32 v[22:23], v[130:131], v[110:111], v[22:23] op_sel:[1,0,0] op_sel_hi:[1,1,1]
    s_set_gpr_idx_off
    v_mov_b32 v172, v170
    v_mov_b32 v173, v171
    s_nop 1
    s_branch MAIN_DONE
B_56:
    buffer_load_dwordx4 v[188:191], v1, s[16:19], s10 offen offset:0 sc1
    buffer_load_dwordx4 v[192:195], v1, s[16:19], s10 offen offset:1024 sc1
    buffer_load_dwordx4 v[196:199], v1, s[16:19], s10 offen offset:2048 sc1
    buffer_load_dwordx4 v[200:203], v1, s[16:19], s10 offen offset:3072 sc1
    buffer_load_dwordx4 v[204:207], v1, s[16:19], s11 offen offset:0 sc1
    buffer_load_dwordx4 v[208:211], v1, s[16:19], s11 offen offset:1024 sc1
    buffer_load_dwordx4 v[212:215], v1, s[16:19], s11 offen offset:2048 sc1
    buffer_load_dwordx4 v[216:219], v1, s[16:19], s11 offen offset:3072 sc1
    s_sub_u32 s32, s32, 1
    s_cbranch_scc1 MAIN_DONE
    v_mfma_f32_4x4x4_16b_bf16 v[124:127], v[172:173], v[178:179], 0 cbsz:4 abid:15
    v_lshlrev_b32_sdwa v136, v15, v114 dst_sel:DWORD dst_unused:UNUSED_PAD src0_sel:DWORD src1_sel:WORD_1
    s_waitcnt vmcnt(12)
    v_mfma_f32_4x4x4_16b_bf16 v[104:107], v[142:143], v[68:69], 0 cbsz:4 abid:14
    s_nop 0
    v_mfma_f32_4x4x4_16b_bf16 v[108:111], v[142:143], v[70:71], 0 cbsz:4 abid:14
    v_lshlrev_b32_sdwa v137, v15, v115 dst_sel:DWORD dst_unused:UNUSED_PAD src0_sel:DWORD src1_sel:WORD_1
    ds_read_u16_d16_hi v132, v136 offset:32768
    ds_read_u16_d16_hi v133, v137 offset:32768
    s_waitcnt lgkmcnt(2)
    s_set_gpr_idx_on s56, 0xc
    v_pk_fma_f32 v[16:17], v[128:129], v[96:97], v[16:17] op_sel:[0,0,0] op_sel_hi:[0,1,1]
    v_pk_fma_f32 v[18:19], v[128:129], v[98:99], v[18:19] op_sel:[0,0,0] op_sel_hi:[0,1,1]
    v_pk_fma_f32 v[20:21], v[130:131], v[100:101], v[20:21] op_sel:[0,0,0] op_sel_hi:[0,1,1]
    v_pk_fma_f32 v[22:23], v[130:131], v[102:103], v[22:23] op_sel:[0,0,0] op_sel_hi:[0,1,1]
    s_set_gpr_idx_off
    s_sub_u32 s32, s32, 1
    s_cbranch_scc1 MAIN_DONE
    v_lshlrev_b32_sdwa v138, v15, v118 dst_sel:DWORD dst_unused:UNUSED_PAD src0_sel:DWORD src1_sel:WORD_1
    s_waitcnt vmcnt(11)
    v_mfma_f32_4x4x4_16b_bf16 v[96:99], v[144:145], v[72:73], 0 cbsz:4 abid:14
    s_nop 0
    v_mfma_f32_4x4x4_16b_bf16 v[100:103], v[144:145], v[74:75], 0 cbsz:4 abid:14
    v_lshlrev_b32_sdwa v139, v15, v119 dst_sel:DWORD dst_unused:UNUSED_PAD src0_sel:DWORD src1_sel:WORD_1
    ds_read_u16_d16_hi v134, v138 offset:32768
    ds_read_u16_d16_hi v135, v139 offset:32768
    s_set_gpr_idx_on s57, 0xc
    v_pk_fma_f32 v[16:17], v[128:129], v[104:105], v[16:17] op_sel:[1,0,0] op_sel_hi:[1,1,1]
    v_pk_fma_f32 v[18:19], v[128:129], v[106:107], v[18:19] op_sel:[1,0,0] op_sel_hi:[1,1,1]
    v_pk_fma_f32 v[20:21], v[130:131], v[108:109], v[20:21] op_sel:[1,0,0] op_sel_hi:[1,1,1]
    v_pk_fma_f32 v[22:23], v[130:131], v[110:111], v[22:23] op_sel:[1,0,0] op_sel_hi:[1,1,1]
    s_set_gpr_idx_off
    v_mov_b32 v172, v170
    v_mov_b32 v173, v171
    s_nop 1
    s_sub_u32 s32, s32, 1
    s_cbranch_scc1 MAIN_DONE
    v_mfma_f32_4x4x4_16b_bf16 v[112:115], v[172:173], v[176:177], 0 cbsz:4 abid:0
    v_lshlrev_b32_sdwa v136, v15, v120 dst_sel:DWORD dst_unused:UNUSED_PAD src0_sel:DWORD src1_sel:WORD_1
    s_waitcnt vmcnt(10)
    v_mfma_f32_4x4x4_16b_bf16 v[104:107], v[146:147], v[76:77], 0 cbsz:4 abid:14
    s_nop 0
    v_mfma_f32_4x4x4_16b_bf16 v[108:111], v[146:147], v[78:79], 0 cbsz:4 abid:14
    v_lshlrev_b32_sdwa v137, v15, v121 dst_sel:DWORD dst_unused:UNUSED_PAD src0_sel:DWORD src1_sel:WORD_1
    ds_read_u16_d16_hi v128, v136 offset:32768
    ds_read_u16_d16_hi v129, v137 offset:32768
    s_waitcnt lgkmcnt(2)
    s_set_gpr_idx_on s58, 0xc
    v_pk_fma_f32 v[16:17], v[132:133], v[96:97], v[16:17] op_sel:[0,0,0] op_sel_hi:[0,1,1]
    v_pk_fma_f32 v[18:19], v[132:133], v[98:99], v[18:19] op_sel:[0,0,0] op_sel_hi:[0,1,1]
    v_pk_fma_f32 v[20:21], v[134:135], v[100:101], v[20:21] op_sel:[0,0,0] op_sel_hi:[0,1,1]
    v_pk_fma_f32 v[22:23], v[134:135], v[102:103], v[22:23] op_sel:[0,0,0] op_sel_hi:[0,1,1]
    s_set_gpr_idx_off
    s_sub_u32 s32, s32, 1
    s_cbranch_scc1 MAIN_DONE
    v_lshlrev_b32_sdwa v138, v15, v124 dst_sel:DWORD dst_unused:UNUSED_PAD src0_sel:DWORD src1_sel:WORD_1
    s_waitcnt vmcnt(9)
    v_mfma_f32_4x4x4_16b_bf16 v[96:99], v[140:141], v[80:81], 0 cbsz:4 abid:15
    s_nop 0
    v_mfma_f32_4x4x4_16b_bf16 v[100:103], v[140:141], v[82:83], 0 cbsz:4 abid:15
    v_lshlrev_b32_sdwa v139, v15, v125 dst_sel:DWORD dst_unused:UNUSED_PAD src0_sel:DWORD src1_sel:WORD_1
    ds_read_u16_d16_hi v130, v138 offset:32768
    ds_read_u16_d16_hi v131, v139 offset:32768
    s_set_gpr_idx_on s59, 0xc
    v_pk_fma_f32 v[16:17], v[132:133], v[104:105], v[16:17] op_sel:[1,0,0] op_sel_hi:[1,1,1]
    v_pk_fma_f32 v[18:19], v[132:133], v[106:107], v[18:19] op_sel:[1,0,0] op_sel_hi:[1,1,1]
    v_pk_fma_f32 v[20:21], v[134:135], v[108:109], v[20:21] op_sel:[1,0,0] op_sel_hi:[1,1,1]
    v_pk_fma_f32 v[22:23], v[134:135], v[110:111], v[22:23] op_sel:[1,0,0] op_sel_hi:[1,1,1]
    s_set_gpr_idx_off
    s_sub_u32 s32, s32, 1
    s_cbranch_scc1 MAIN_DONE
    v_mfma_f32_4x4x4_16b_bf16 v[116:119], v[172:173], v[178:179], 0 cbsz:4 abid:0
    v_lshlrev_b32_sdwa v136, v15, v122 dst_sel:DWORD dst_unused:UNUSED_PAD src0_sel:DWORD src1_sel:WORD_1
    s_waitcnt vmcnt(8)
    v_mfma_f32_4x4x4_16b_bf16 v[104:107], v[142:143], v[84:85], 0 cbsz:4 abid:15
    s_nop 0
    v_mfma_f32_4x4x4_16b_bf16 v[108:111], v[142:143], v[86:87], 0 cbsz:4 abid:15
    v_lshlrev_b32_sdwa v137, v15, v123 dst_sel:DWORD dst_unused:UNUSED_PAD src0_sel:DWORD src1_sel:WORD_1
    ds_read_u16_d16_hi v132, v136 offset:32768
    ds_read_u16_d16_hi v133, v137 offset:32768
    v_cvt_pk_bf16_f32 v140, v148, v152
    v_cvt_pk_bf16_f32 v141, v156, v160
    s_waitcnt lgkmcnt(2)
    s_set_gpr_idx_on s60, 0xc
    v_pk_fma_f32 v[16:17], v[128:129], v[96:97], v[16:17] op_sel:[0,0,0] op_sel_hi:[0,1,1]
    v_pk_fma_f32 v[18:19], v[128:129], v[98:99], v[18:19] op_sel:[0,0,0] op_sel_hi:[0,1,1]
    v_pk_fma_f32 v[20:21], v[130:131], v[100:101], v[20:21] op_sel:[0,0,0] op_sel_hi:[0,1,1]
    v_pk_fma_f32 v[22:23], v[130:131], v[102:103], v[22:23] op_sel:[0,0,0] op_sel_hi:[0,1,1]
    s_set_gpr_idx_off
    s_sub_u32 s32, s32, 1
    s_cbranch_scc1 MAIN_DONE
    v_lshlrev_b32_sdwa v138, v15, v126 dst_sel:DWORD dst_unused:UNUSED_PAD src0_sel:DWORD src1_sel:WORD_1
    v_mfma_f32_4x4x4_16b_bf16 v[96:99], v[144:145], v[88:89], 0 cbsz:4 abid:15
    s_nop 0
    v_mfma_f32_4x4x4_16b_bf16 v[100:103], v[144:145], v[90:91], 0 cbsz:4 abid:15
    v_lshlrev_b32_sdwa v139, v15, v127 dst_sel:DWORD dst_unused:UNUSED_PAD src0_sel:DWORD src1_sel:WORD_1
    ds_read_u16_d16_hi v134, v138 offset:32768
    ds_read_u16_d16_hi v135, v139 offset:32768
    v_cvt_pk_bf16_f32 v142, v149, v153
    v_cvt_pk_bf16_f32 v143, v157, v161
    s_set_gpr_idx_on s61, 0xc
    v_pk_fma_f32 v[16:17], v[128:129], v[104:105], v[16:17] op_sel:[1,0,0] op_sel_hi:[1,1,1]
    v_pk_fma_f32 v[18:19], v[128:129], v[106:107], v[18:19] op_sel:[1,0,0] op_sel_hi:[1,1,1]
    v_pk_fma_f32 v[20:21], v[130:131], v[108:109], v[20:21] op_sel:[1,0,0] op_sel_hi:[1,1,1]
    v_pk_fma_f32 v[22:23], v[130:131], v[110:111], v[22:23] op_sel:[1,0,0] op_sel_hi:[1,1,1]
    s_set_gpr_idx_off
    s_branch MAIN_DONE
B_60:
    buffer_load_dwordx4 v[188:191], v1, s[16:19], s10 offen offset:0 sc1
    buffer_load_dwordx4 v[192:195], v1, s[16:19], s10 offen offset:1024 sc1
    buffer_load_dwordx4 v[196:199], v1, s[16:19], s10 offen offset:2048 sc1
    buffer_load_dwordx4 v[200:203], v1, s[16:19], s10 offen offset:3072 sc1
    buffer_load_dwordx4 v[204:207], v1, s[16:19], s11 offen offset:0 sc1
    buffer_load_dwordx4 v[208:211], v1, s[16:19], s11 offen offset:1024 sc1
    buffer_load_dwordx4 v[212:215], v1, s[16:19], s11 offen offset:2048 sc1
    buffer_load_dwordx4 v[216:219], v1, s[16:19], s11 offen offset:3072 sc1
    s_sub_u32 s32, s32, 1
    s_cbranch_scc1 MAIN_DONE
    v_mfma_f32_4x4x4_16b_bf16 v[116:119], v[172:173], v[178:179], 0 cbsz:4 abid:0
    v_lshlrev_b32_sdwa v136, v15, v122 dst_sel:DWORD dst_unused:UNUSED_PAD src0_sel:DWORD src1_sel:WORD_1
    s_waitcnt vmcnt(12)
    v_mfma_f32_4x4x4_16b_bf16 v[104:107], v[142:143], v[84:85], 0 cbsz:4 abid:15
    s_nop 0
    v_mfma_f32_4x4x4_16b_bf16 v[108:111], v[142:143], v[86:87], 0 cbsz:4 abid:15
    v_lshlrev_b32_sdwa v137, v15, v123 dst_sel:DWORD dst_unused:UNUSED_PAD src0_sel:DWORD src1_sel:WORD_1
    ds_read_u16_d16_hi v132, v136 offset:32768
    ds_read_u16_d16_hi v133, v137 offset:32768
    v_cvt_pk_bf16_f32 v140, v148, v152
    v_cvt_pk_bf16_f32 v141, v156, v160
    s_waitcnt lgkmcnt(2)
    s_set_gpr_idx_on s60, 0xc
    v_pk_fma_f32 v[16:17], v[128:129], v[96:97], v[16:17] op_sel:[0,0,0] op_sel_hi:[0,1,1]
    v_pk_fma_f32 v[18:19], v[128:129], v[98:99], v[18:19] op_sel:[0,0,0] op_sel_hi:[0,1,1]
    v_pk_fma_f32 v[20:21], v[130:131], v[100:101], v[20:21] op_sel:[0,0,0] op_sel_hi:[0,1,1]
    v_pk_fma_f32 v[22:23], v[130:131], v[102:103], v[22:23] op_sel:[0,0,0] op_sel_hi:[0,1,1]
    s_set_gpr_idx_off
    s_sub_u32 s32, s32, 1
    s_cbranch_scc1 MAIN_DONE
    v_lshlrev_b32_sdwa v138, v15, v126 dst_sel:DWORD dst_unused:UNUSED_PAD src0_sel:DWORD src1_sel:WORD_1
    s_waitcnt vmcnt(11)
    v_mfma_f32_4x4x4_16b_bf16 v[96:99], v[144:145], v[88:89], 0 cbsz:4 abid:15
    s_nop 0
    v_mfma_f32_4x4x4_16b_bf16 v[100:103], v[144:145], v[90:91], 0 cbsz:4 abid:15
    v_lshlrev_b32_sdwa v139, v15, v127 dst_sel:DWORD dst_unused:UNUSED_PAD src0_sel:DWORD src1_sel:WORD_1
    ds_read_u16_d16_hi v134, v138 offset:32768
    ds_read_u16_d16_hi v135, v139 offset:32768
    v_cvt_pk_bf16_f32 v142, v149, v153
    v_cvt_pk_bf16_f32 v143, v157, v161
    s_set_gpr_idx_on s61, 0xc
    v_pk_fma_f32 v[16:17], v[128:129], v[104:105], v[16:17] op_sel:[1,0,0] op_sel_hi:[1,1,1]
    v_pk_fma_f32 v[18:19], v[128:129], v[106:107], v[18:19] op_sel:[1,0,0] op_sel_hi:[1,1,1]
    v_pk_fma_f32 v[20:21], v[130:131], v[108:109], v[20:21] op_sel:[1,0,0] op_sel_hi:[1,1,1]
    v_pk_fma_f32 v[22:23], v[130:131], v[110:111], v[22:23] op_sel:[1,0,0] op_sel_hi:[1,1,1]
    s_set_gpr_idx_off
    s_sub_u32 s32, s32, 1
    s_cbranch_scc1 MAIN_DONE
    v_mfma_f32_4x4x4_16b_bf16 v[120:123], v[172:173], v[176:177], 0 cbsz:4 abid:1
    v_lshlrev_b32_sdwa v136, v15, v112 dst_sel:DWORD dst_unused:UNUSED_PAD src0_sel:DWORD src1_sel:WORD_1
    s_waitcnt vmcnt(10)
    v_mfma_f32_4x4x4_16b_bf16 v[104:107], v[146:147], v[92:93], 0 cbsz:4 abid:15
    s_nop 0
    v_mfma_f32_4x4x4_16b_bf16 v[108:111], v[146:147], v[94:95], 0 cbsz:4 abid:15
    v_lshlrev_b32_sdwa v137, v15, v113 dst_sel:DWORD dst_unused:UNUSED_PAD src0_sel:DWORD src1_sel:WORD_1
    ds_read_u16_d16_hi v128, v136 offset:32768
    ds_read_u16_d16_hi v129, v137 offset:32768
    v_cvt_pk_bf16_f32 v144, v150, v154
    v_cvt_pk_bf16_f32 v145, v158, v162
    s_waitcnt lgkmcnt(2)
    s_set_gpr_idx_on s62, 0xc
    v_pk_fma_f32 v[16:17], v[132:133], v[96:97], v[16:17] op_sel:[0,0,0] op_sel_hi:[0,1,1]
    v_pk_fma_f32 v[18:19], v[132:133], v[98:99], v[18:19] op_sel:[0,0,0] op_sel_hi:[0,1,1]
    v_pk_fma_f32 v[20:21], v[134:135], v[100:101], v[20:21] op_sel:[0,0,0] op_sel_hi:[0,1,1]
    v_pk_fma_f32 v[22:23], v[134:135], v[102:103], v[22:23] op_sel:[0,0,0] op_sel_hi:[0,1,1]
    s_set_gpr_idx_off
    s_sub_u32 s32, s32, 1
    s_cbranch_scc1 MAIN_DONE
    v_lshlrev_b32_sdwa v138, v15, v116 dst_sel:DWORD dst_unused:UNUSED_PAD src0_sel:DWORD src1_sel:WORD_1
    s_waitcnt vmcnt(9)
    v_mfma_f32_4x4x4_16b_bf16 v[96:99], v[140:141], v[64:65], 0 cbsz:4 abid:0
    s_nop 0
    v_mfma_f32_4x4x4_16b_bf16 v[100:103], v[140:141], v[66:67], 0 cbsz:4 abid:0
    v_lshlrev_b32_sdwa v139, v15, v117 dst_sel:DWORD dst_unused:UNUSED_PAD src0_sel:DWORD src1_sel:WORD_1
    ds_read_u16_d16_hi v130, v138 offset:32768
    ds_read_u16_d16_hi v131, v139 offset:32768
    v_cvt_pk_bf16_f32 v146, v151, v155
    v_cvt_pk_bf16_f32 v147, v159, v163
    s_set_gpr_idx_on s63, 0xc
    v_pk_fma_f32 v[16:17], v[132:133], v[104:105], v[16:17] op_sel:[1,0,0] op_sel_hi:[1,1,1]
    v_pk_fma_f32 v[18:19], v[132:133], v[106:107], v[18:19] op_sel:[1,0,0] op_sel_hi:[1,1,1]
    v_pk_fma_f32 v[20:21], v[134:135], v[108:109], v[20:21] op_sel:[1,0,0] op_sel_hi:[1,1,1]
    v_pk_fma_f32 v[22:23], v[134:135], v[110:111], v[22:23] op_sel:[1,0,0] op_sel_hi:[1,1,1]
    s_set_gpr_idx_off
    s_sub_u32 s32, s32, 1
    s_cbranch_scc1 MAIN_DONE
    v_mfma_f32_4x4x4_16b_bf16 v[124:127], v[172:173], v[178:179], 0 cbsz:4 abid:1
    v_lshlrev_b32_sdwa v136, v15, v114 dst_sel:DWORD dst_unused:UNUSED_PAD src0_sel:DWORD src1_sel:WORD_1
    s_waitcnt vmcnt(8)
    v_mfma_f32_4x4x4_16b_bf16 v[104:107], v[142:143], v[68:69], 0 cbsz:4 abid:0
    s_nop 0
    v_mfma_f32_4x4x4_16b_bf16 v[108:111], v[142:143], v[70:71], 0 cbsz:4 abid:0
    v_lshlrev_b32_sdwa v137, v15, v115 dst_sel:DWORD dst_unused:UNUSED_PAD src0_sel:DWORD src1_sel:WORD_1
    ds_read_u16_d16_hi v132, v136 offset:32768
    ds_read_u16_d16_hi v133, v137 offset:32768
    s_waitcnt lgkmcnt(2)
    s_set_gpr_idx_on s48, 0xc
    v_pk_fma_f32 v[16:17], v[128:129], v[96:97], v[16:17] op_sel:[0,0,0] op_sel_hi:[0,1,1]
    v_pk_fma_f32 v[18:19], v[128:129], v[98:99], v[18:19] op_sel:[0,0,0] op_sel_hi:[0,1,1]
    v_pk_fma_f32 v[20:21], v[130:131], v[100:101], v[20:21] op_sel:[0,0,0] op_sel_hi:[0,1,1]
    v_pk_fma_f32 v[22:23], v[130:131], v[102:103], v[22:23] op_sel:[0,0,0] op_sel_hi:[0,1,1]
    s_set_gpr_idx_off
    s_sub_u32 s32, s32, 1
    s_cbranch_scc1 MAIN_DONE
    v_lshlrev_b32_sdwa v138, v15, v118 dst_sel:DWORD dst_unused:UNUSED_PAD src0_sel:DWORD src1_sel:WORD_1
    v_mfma_f32_4x4x4_16b_bf16 v[96:99], v[144:145], v[72:73], 0 cbsz:4 abid:0
    s_nop 0
    v_mfma_f32_4x4x4_16b_bf16 v[100:103], v[144:145], v[74:75], 0 cbsz:4 abid:0
    v_lshlrev_b32_sdwa v139, v15, v119 dst_sel:DWORD dst_unused:UNUSED_PAD src0_sel:DWORD src1_sel:WORD_1
    ds_read_u16_d16_hi v134, v138 offset:32768
    ds_read_u16_d16_hi v135, v139 offset:32768
    s_set_gpr_idx_on s49, 0xc
    v_pk_fma_f32 v[16:17], v[128:129], v[104:105], v[16:17] op_sel:[1,0,0] op_sel_hi:[1,1,1]
    v_pk_fma_f32 v[18:19], v[128:129], v[106:107], v[18:19] op_sel:[1,0,0] op_sel_hi:[1,1,1]
    v_pk_fma_f32 v[20:21], v[130:131], v[108:109], v[20:21] op_sel:[1,0,0] op_sel_hi:[1,1,1]
    v_pk_fma_f32 v[22:23], v[130:131], v[110:111], v[22:23] op_sel:[1,0,0] op_sel_hi:[1,1,1]
    s_set_gpr_idx_off
    s_branch MAIN_DONE
MAIN_DONE:
    s_add_u32 s27, s27, 1472
    s_cmp_ge_u32 s27, s26
    s_cbranch_scc1 ALL_DONE
    s_waitcnt vmcnt(0) lgkmcnt(0)
    v_lshlrev_b32 v11, 2, v0
    v_mov_b32 v12, 0
    v_cmp_gt_u32 vcc, 0x100, v0
    s_and_saveexec_b64 s[42:43], vcc
    ds_write_b32 v11, v12 offset:0
    s_mov_b64 exec, s[42:43]
    s_waitcnt lgkmcnt(0)
    s_barrier
    s_branch ROUND
ALL_DONE:
    v_lshrrev_b32 v11, 8, v1
    s_lshr_b32 s42, s25, 2
    s_mul_i32 s43, s42, 80
    v_mul_u32_u24 v9, 20, v11
    v_add_u32 v9, s43, v9
    ds_read_b32 v112, v9 offset:1344
    ds_read_b32 v113, v9 offset:1348
    ds_read_b32 v114, v9 offset:1352
    ds_read_b32 v115, v9 offset:1356
    ds_read_b32 v116, v9 offset:1360
    v_cvt_pk_bf16_f32 v140, v16, v20
    v_cvt_pk_bf16_f32 v141, v17, v21
    v_cvt_pk_bf16_f32 v142, v18, v22
    v_cvt_pk_bf16_f32 v143, v19, v23
    v_cvt_pk_bf16_f32 v144, v24, v28
    v_cvt_pk_bf16_f32 v145, v25, v29
    v_cvt_pk_bf16_f32 v146, v26, v30
    v_cvt_pk_bf16_f32 v147, v27, v31
    v_cvt_pk_bf16_f32 v148, v32, v36
    v_cvt_pk_bf16_f32 v149, v33, v37
    v_cvt_pk_bf16_f32 v150, v34, v38
    v_cvt_pk_bf16_f32 v151, v35, v39
    v_cvt_pk_bf16_f32 v152, v40, v44
    v_cvt_pk_bf16_f32 v153, v41, v45
    v_cvt_pk_bf16_f32 v154, v42, v46
    v_cvt_pk_bf16_f32 v155, v43, v47
    v_cvt_pk_bf16_f32 v156, v48, v52
    v_cvt_pk_bf16_f32 v157, v49, v53
    v_cvt_pk_bf16_f32 v158, v50, v54
    v_cvt_pk_bf16_f32 v159, v51, v55
    s_mul_i32 s43, s25, 1152
    s_add_u32 s43, s43, 32768
    v_lshrrev_b32 v12, 2, v1
    v_add_u32 v12, s43, v12
    v_bfe_u32 v10, v1, 4, 4
    s_mul_i32 s43, s42, 4608
    s_add_u32 s43, s43, 32768
    v_mul_u32_u24 v8, 288, v10
    v_lshl_add_u32 v8, v11, 4, v8
    v_add_u32 v8, s43, v8
    s_lshl_b32 s42, s24, 10
    s_and_b32 s43, s25, 3
    s_lshl_b32 s43, s43, 8
    s_add_u32 s42, s42, s43
    v_lshl_add_u32 v10, v10, 4, s42
    s_waitcnt lgkmcnt(0)
    v_lshl_add_u32 v112, v112, 18, v10
    v_lshl_add_u32 v113, v113, 18, v10
    v_lshl_add_u32 v114, v114, 18, v10
    v_lshl_add_u32 v115, v115, 18, v10
    v_lshl_add_u32 v116, v116, 18, v10
    s_barrier
    ds_write_b32 v12, v140 offset:0
    ds_write_b32 v12, v141 offset:288
    ds_write_b32 v12, v142 offset:576
    ds_write_b32 v12, v143 offset:864
    ds_write_b32 v12, v144 offset:9216
    ds_write_b32 v12, v145 offset:9504
    ds_write_b32 v12, v146 offset:9792
    ds_write_b32 v12, v147 offset:10080
    s_waitcnt vmcnt(0) lgkmcnt(0)
    s_barrier
    ds_read_b128 v[64:67], v8 offset:0
    ds_read_b128 v[68:71], v8 offset:64
    ds_read_b128 v[72:75], v8 offset:128
    ds_read_b128 v[76:79], v8 offset:192
    ds_read_b128 v[80:83], v8 offset:9216
    ds_read_b128 v[84:87], v8 offset:9280
    ds_read_b128 v[88:91], v8 offset:9344
    ds_read_b128 v[92:95], v8 offset:9408
    s_waitcnt lgkmcnt(7)
    v_mfma_f32_16x16x32_bf16 v[16:19], v[64:67], v[188:191], 0
    v_mfma_f32_16x16x32_bf16 v[20:23], v[64:67], v[204:207], 0
    ds_write_b32 v12, v148 offset:18432
    ds_write_b32 v12, v149 offset:18720
    ds_write_b32 v12, v150 offset:19008
    s_waitcnt lgkmcnt(9)
    v_mfma_f32_16x16x32_bf16 v[16:19], v[68:71], v[192:195], v[16:19]
    v_mfma_f32_16x16x32_bf16 v[20:23], v[68:71], v[208:211], v[20:23]
    ds_write_b32 v12, v151 offset:19296
    ds_write_b32 v12, v152 offset:27648
    ds_write_b32 v12, v153 offset:27936
    s_waitcnt lgkmcnt(11)
    v_mfma_f32_16x16x32_bf16 v[16:19], v[72:75], v[196:199], v[16:19]
    v_mfma_f32_16x16x32_bf16 v[20:23], v[72:75], v[212:215], v[20:23]
    ds_write_b32 v12, v154 offset:28224
    ds_write_b32 v12, v155 offset:28512
    ds_write_b32 v12, v156 offset:36864
    s_waitcnt lgkmcnt(13)
    v_mfma_f32_16x16x32_bf16 v[16:19], v[76:79], v[200:203], v[16:19]
    v_mfma_f32_16x16x32_bf16 v[20:23], v[76:79], v[216:219], v[20:23]
    ds_write_b32 v12, v157 offset:37152
    ds_write_b32 v12, v158 offset:37440
    ds_write_b32 v12, v159 offset:37728
    s_waitcnt lgkmcnt(0)
    s_barrier
    ds_read_b128 v[64:67], v8 offset:18432
    ds_read_b128 v[68:71], v8 offset:18496
    ds_read_b128 v[72:75], v8 offset:18560
    ds_read_b128 v[76:79], v8 offset:18624
    v_mfma_f32_16x16x32_bf16 v[24:27], v[80:83], v[188:191], 0
    v_mfma_f32_16x16x32_bf16 v[28:31], v[80:83], v[204:207], 0
    v_mfma_f32_16x16x32_bf16 v[24:27], v[84:87], v[192:195], v[24:27]
    v_mfma_f32_16x16x32_bf16 v[28:31], v[84:87], v[208:211], v[28:31]
    v_mfma_f32_16x16x32_bf16 v[24:27], v[88:91], v[196:199], v[24:27]
    v_mfma_f32_16x16x32_bf16 v[28:31], v[88:91], v[212:215], v[28:31]
    v_mfma_f32_16x16x32_bf16 v[24:27], v[92:95], v[200:203], v[24:27]
    v_mfma_f32_16x16x32_bf16 v[28:31], v[92:95], v[216:219], v[28:31]
    v_cvt_pk_bf16_f32 v128, v16, v17
    v_cvt_pk_bf16_f32 v129, v18, v19
    v_cvt_pk_bf16_f32 v130, v20, v21
    v_cvt_pk_bf16_f32 v131, v22, v23
    buffer_store_dwordx4 v[128:131], v112, s[20:23], 0 offen sc0 sc1
    ds_read_b128 v[80:83], v8 offset:27648
    ds_read_b128 v[84:87], v8 offset:27712
    ds_read_b128 v[88:91], v8 offset:27776
    ds_read_b128 v[92:95], v8 offset:27840
    s_waitcnt lgkmcnt(7)
    v_mfma_f32_16x16x32_bf16 v[32:35], v[64:67], v[188:191], 0
    v_mfma_f32_16x16x32_bf16 v[36:39], v[64:67], v[204:207], 0
    s_waitcnt lgkmcnt(6)
    v_mfma_f32_16x16x32_bf16 v[32:35], v[68:71], v[192:195], v[32:35]
    v_mfma_f32_16x16x32_bf16 v[36:39], v[68:71], v[208:211], v[36:39]
    s_waitcnt lgkmcnt(5)
    v_mfma_f32_16x16x32_bf16 v[32:35], v[72:75], v[196:199], v[32:35]
    v_mfma_f32_16x16x32_bf16 v[36:39], v[72:75], v[212:215], v[36:39]
    s_waitcnt lgkmcnt(4)
    v_mfma_f32_16x16x32_bf16 v[32:35], v[76:79], v[200:203], v[32:35]
    v_mfma_f32_16x16x32_bf16 v[36:39], v[76:79], v[216:219], v[36:39]
    v_cvt_pk_bf16_f32 v132, v24, v25
    v_cvt_pk_bf16_f32 v133, v26, v27
    v_cvt_pk_bf16_f32 v134, v28, v29
    v_cvt_pk_bf16_f32 v135, v30, v31
    buffer_store_dwordx4 v[132:135], v113, s[20:23], 0 offen sc0 sc1
    ds_read_b128 v[64:67], v8 offset:36864
    ds_read_b128 v[68:71], v8 offset:36928
    ds_read_b128 v[72:75], v8 offset:36992
    ds_read_b128 v[76:79], v8 offset:37056
    s_waitcnt lgkmcnt(7)
    v_mfma_f32_16x16x32_bf16 v[40:43], v[80:83], v[188:191], 0
    v_mfma_f32_16x16x32_bf16 v[44:47], v[80:83], v[204:207], 0
    s_waitcnt lgkmcnt(6)
    v_mfma_f32_16x16x32_bf16 v[40:43], v[84:87], v[192:195], v[40:43]
    v_mfma_f32_16x16x32_bf16 v[44:47], v[84:87], v[208:211], v[44:47]
    s_waitcnt lgkmcnt(5)
    v_mfma_f32_16x16x32_bf16 v[40:43], v[88:91], v[196:199], v[40:43]
    v_mfma_f32_16x16x32_bf16 v[44:47], v[88:91], v[212:215], v[44:47]
    s_waitcnt lgkmcnt(4)
    v_mfma_f32_16x16x32_bf16 v[40:43], v[92:95], v[200:203], v[40:43]
    v_mfma_f32_16x16x32_bf16 v[44:47], v[92:95], v[216:219], v[44:47]
    v_cvt_pk_bf16_f32 v128, v32, v33
    v_cvt_pk_bf16_f32 v129, v34, v35
    v_cvt_pk_bf16_f32 v130, v36, v37
    v_cvt_pk_bf16_f32 v131, v38, v39
    buffer_store_dwordx4 v[128:131], v114, s[20:23], 0 offen sc0 sc1
    s_waitcnt lgkmcnt(3)
    v_mfma_f32_16x16x32_bf16 v[48:51], v[64:67], v[188:191], 0
    v_mfma_f32_16x16x32_bf16 v[52:55], v[64:67], v[204:207], 0
    s_waitcnt lgkmcnt(2)
    v_mfma_f32_16x16x32_bf16 v[48:51], v[68:71], v[192:195], v[48:51]
    v_mfma_f32_16x16x32_bf16 v[52:55], v[68:71], v[208:211], v[52:55]
    s_waitcnt lgkmcnt(1)
    v_mfma_f32_16x16x32_bf16 v[48:51], v[72:75], v[196:199], v[48:51]
    v_mfma_f32_16x16x32_bf16 v[52:55], v[72:75], v[212:215], v[52:55]
    s_waitcnt lgkmcnt(0)
    v_mfma_f32_16x16x32_bf16 v[48:51], v[76:79], v[200:203], v[48:51]
    v_mfma_f32_16x16x32_bf16 v[52:55], v[76:79], v[216:219], v[52:55]
    v_cvt_pk_bf16_f32 v132, v40, v41
    v_cvt_pk_bf16_f32 v133, v42, v43
    v_cvt_pk_bf16_f32 v134, v44, v45
    v_cvt_pk_bf16_f32 v135, v46, v47
    buffer_store_dwordx4 v[132:135], v115, s[20:23], 0 offen sc0 sc1
    s_nop 3
    v_cvt_pk_bf16_f32 v128, v48, v49
    v_cvt_pk_bf16_f32 v129, v50, v51
    v_cvt_pk_bf16_f32 v130, v52, v53
    v_cvt_pk_bf16_f32 v131, v54, v55
    buffer_store_dwordx4 v[128:131], v116, s[20:23], 0 offen sc0 sc1
END:
    s_endpgm
    .p2align 6
    .type DEAL_TABLE,@object
DEAL_TABLE:
    .short 8272, 4136, 8532, 14476, 12408, 6204, 2068, 10340, 0, 8792, 4396, 12668, 2328, 14736, 6464, 10600, 260, 9052, 14996, 6724, 520, 2588, 10860, 12928, 4656, 11120, 780, 2848, 13188, 15256, 6984, 4916, 1040, 11380, 7244, 3108, 13448, 15516, 5176, 9312, 0, 0, 0, 0, 0, 0, 0, 0, 0, 0, 0, 0, 0, 0, 0, 0, 0, 0, 0, 0, 0, 0, 0, 0, 0, 4136, 14476, 2068, 8272, 12408, 10340, 6204, 12668, 6464, 2328, 14736, 8532, 260, 4396, 10600, 8792, 6724, 10860, 12928, 14996, 2588, 520, 4656, 15256, 11120, 4916, 9052, 6984, 13188, 780, 2848, 11380, 3108, 7244, 13448, 9312, 5176, 15516, 1040, 0, 0, 0, 0, 0, 0, 0, 0, 0, 0, 0, 0, 0, 0, 0, 0, 0, 0, 0, 0, 0, 0, 0, 0
    .size DEAL_TABLE, 256
.section .rodata,"a"
.p2align 6
.amdhsa_kernel gather_scatter__tensor_product_equiv_tfn__graph_kernel
  .amdhsa_next_free_vgpr 220
  .amdhsa_next_free_sgpr 66
  .amdhsa_accum_offset 220
  .amdhsa_group_segment_fixed_size 0
  .amdhsa_kernarg_size 88
  .amdhsa_user_sgpr_count 2
  .amdhsa_user_sgpr_kernarg_segment_ptr 1
  .amdhsa_system_sgpr_workgroup_id_x 1
  .amdhsa_float_denorm_mode_32 3
.end_amdhsa_kernel
```
